```python
import torch

def _softmax(x, axis=-1):
    return torch.softmax(x, dim=axis)
def _gelu(x):
    return torch.nn.functional.gelu(x, approximate="tanh")
def _silu(x):
    return torch.nn.functional.silu(x)
def _sigmoid(x):
    return torch.sigmoid(x)
def _layernorm(x, axis=-1, eps=1e-5):
    m = x.mean(dim=axis, keepdim=True)
    v = x.var(dim=axis, keepdim=True, unbiased=False)
    return (x - m) / torch.sqrt(v + eps)
def _scatter_add(tgt, idx, src, axis=0):
    return tgt.clone().index_add_(axis, idx, src)
def _segment_sum(src, seg, n):
    out = torch.zeros((n,) + src.shape[1:], dtype=src.dtype)
    return out.index_add_(0, seg, src)
def _pad(x, pw):
    flat = tuple(v for pair in reversed(pw) for v in pair)
    return torch.nn.functional.pad(x, flat)

kernel_name = 'gated_mix__ssm_conv_h3__sliding_local_dilated__prompt'

def setup_inputs():

    _w = (lambda a: (lambda t: t.to(torch.bfloat16) if t.is_floating_point() else t)(torch.as_tensor(a)))
    def _A_setup():
        B, S, D = 1, 2048, 640
        ks = 4
        return {
            "q": _w((lambda *s: torch.randn(*s, dtype=torch.bfloat16) * 0.05)(B, S, D)),
            "k": _w((lambda *s: torch.randn(*s, dtype=torch.bfloat16) * 0.8)(B, S, D)),
            "v": _w((lambda *s: torch.randn(*s, dtype=torch.bfloat16) * 0.8)(B, S, D)),
            "shift_k": _w((lambda *s: torch.randn(*s, dtype=torch.bfloat16) * 0.8)(D, ks) * 0.5),
            "ssm_k": _w((lambda *s: torch.randn(*s, dtype=torch.bfloat16) * 3.2)(D, S) * (1.0 / S ** 0.5)),
            "ssm_D": _w((lambda *s: torch.randn(*s, dtype=torch.bfloat16) * 0.8)(D)),
        }
    _A_in = _A_setup()

    def _B_setup():
        B, S, D = 1, 2048, 640
        return {
            "x": _w((lambda *s: torch.randn(*s, dtype=torch.bfloat16) * 0.05)(B, S, D)),
            "wqkv": _w((lambda *s: torch.randn(*s, dtype=torch.bfloat16) * 0.8)(D, 3 * D)),
            "wo": _w((lambda *s: torch.randn(*s, dtype=torch.bfloat16) * 0.05)(D, D)),
        }
    _B_in = _B_setup()

    return {
        "A_q": _A_in["q"],
        "A_k": _A_in["k"],
        "A_v": _A_in["v"],
        "A_shift_k": _A_in["shift_k"],
        "A_ssm_k": _A_in["ssm_k"],
        "A_ssm_D": _A_in["ssm_D"],
        "B_x": _B_in["x"],
        "B_wqkv": _B_in["wqkv"],
        "B_wo": _B_in["wo"],
        "gate_w": _w((lambda *s: torch.randn(*s, dtype=torch.bfloat16) * 0.05)(640) * 16.0),
    }

def reference(A_q, A_k, A_v, A_shift_k, A_ssm_k, A_ssm_D, B_x, B_wqkv, B_wo, gate_w):
    def _A_ref(q, k, v, shift_k, ssm_k, ssm_D):
        B, S, D = q.shape
        ks = shift_k.shape[-1]
        k_pad = _pad(k, ((0, 0), (ks - 1, 0), (0, 0)))
        k_shift = torch.zeros_like(k)
        for t in range(ks):
            k_shift = k_shift + k_pad[:, t:t + S, :] * shift_k[:, ks - 1 - t][None, None, :]
        kv = k_shift * v
        L = 2 * S
        kv_pad = _pad(kv, ((0, 0), (0, S), (0, 0)))
        kf_pad = _pad(ssm_k, ((0, 0), (0, S)))
        kv_f = (lambda x, axes=(-2,-1): torch.fft.rfft2(x.float(), dim=axes))(kv_pad[:, None, :, :], axes=(1, 2))
        kf_f = (lambda x, axes=(-2,-1): torch.fft.rfft2(x.float(), dim=axes))(kf_pad[:, None, :], axes=(1, 2))
        kf_f = (lambda x, *d: x.permute(*d))(kf_f, 1, 2, 0)
        y_f = kv_f * kf_f[None, :, :, :]
        y = (lambda x, s, axes=(-2,-1): torch.fft.irfft2(x, s=s, dim=axes).to(torch.bfloat16))(y_f, (1, L), axes=(1, 2))[:, 0, :S, :]
        y = y + kv * ssm_D[None, None, :]
        return q * y

    def _B_ref(x, wqkv, wo):
        B, S, D = x.shape
        H = 32; Dh = D // H
        W, dil = 8, 2
        qkv = (lambda x, *d: x.permute(*d))((x @ wqkv).reshape(B, S, 3, H, Dh), 2, 0, 3, 1, 4)
        q, k, v = qkv[0], qkv[1], qkv[2]
        scale = Dh ** -0.5
        pos = torch.arange(S)
        off = torch.arange(W) * dil
        idx = pos[:, None] - off[None, :]
        mask = idx >= 0
        idx_c = torch.where(mask, idx, 0).reshape(-1)
        kg = k[:, :, idx_c, :].reshape(B, H, S, W, Dh)
        vg = v[:, :, idx_c, :].reshape(B, H, S, W, Dh)
        logits = torch.einsum("bhsd,bhswd->bhsw", q, kg) * scale
        logits = torch.where(mask[None, None, :, :], logits, -1e9)
        attn = _softmax(logits, axis=-1)
        o = torch.einsum("bhsw,bhswd->bhsd", attn, vg)
        return (lambda x, *d: x.permute(*d))(o, 0, 2, 1, 3).reshape(B, S, D) @ wo

    x = A_q
    g = _sigmoid((x * gate_w).sum(-1, keepdims=True))
    a = _A_ref(x, A_k, A_v, A_shift_k, A_ssm_k, A_ssm_D)
    b = _B_ref(x, B_wqkv, B_wo)
    return g * a + (1 - g) * b
```

```asm
; @launch grid=(256,1,1) block=(768,1,1) lds=163840
.amdgcn_target "amdgcn-amd-amdhsa--gfx950"
.text
.globl gated_mix__ssm_conv_h3__sliding_local_dilated__prompt_kernel
.p2align 8
.type gated_mix__ssm_conv_h3__sliding_local_dilated__prompt_kernel,@function
gated_mix__ssm_conv_h3__sliding_local_dilated__prompt_kernel:
    s_load_dwordx16 s[4:19], s[0:1], 0
    s_load_dwordx8 s[20:27], s[0:1], 64
    s_load_dwordx2 s[28:29], s[0:1], 96
    s_lshr_b32 s96, s2, 3
    s_getpc_b64 s[46:47]
L_pc:
    s_lshl_b32 s97, s96, 7
    v_lshl_add_u32 v5, v0, 12, s97
    v_cmp_gt_u32 vcc, L_codeend-L_pc-4, v5
    s_and_saveexec_b64 s[48:49], vcc
    s_cbranch_execz L_nopf
    global_load_dword v166, v5, s[46:47]
L_nopf:
    s_mov_b64 exec, -1
    v_lshrrev_b32 v4, 6, v0
    v_and_b32 v0, 63, v0
    v_readfirstlane_b32 s32, v4
    s_cmp_ge_u32 s2, 256
    s_cbranch_scc1 L_end
    v_lshrrev_b32 v2, 4, v0
    v_and_b32 v1, 15, v0
    v_lshrrev_b32 v4, 3, v0
    v_and_b32 v5, 7, v0
    s_bfe_u32 s97, s2, 131073
    s_mul_i32 s98, s97, 55
    s_add_u32 s98, s98, 1
    s_lshr_b32 s98, s98, 1
    s_and_b32 s99, s97, 1
    s_add_u32 s99, s99, s96
    s_and_b32 s31, s2, 1
    s_cmp_ge_u32 s99, 28
    s_cselect_b32 s35, 1, 0
    s_cbranch_scc1 L_a
    s_add_u32 s96, s98, s96
    s_mul_i32 s43, s31, 110
    s_add_u32 s43, s43, s96
    s_mul_i32 s30, s96, 205
    s_lshr_b32 s30, s30, 10
    s_mul_i32 s97, s30, 5
    s_sub_u32 s36, s96, s97
    s_mul_i32 s31, s31, 5
    s_add_u32 s31, s36, s31
    s_add_u32 s34, s30, s36
    s_and_b32 s34, s34, 1
    s_mul_i32 s34, s34, 5
    s_lshl_b32 s97, s2, 2
    s_lshr_b32 s97, 0x14423120, s97
    s_and_b32 s97, s97, 15
    s_add_u32 s34, s34, s97
    s_cmp_ge_u32 s32, 3
    s_cbranch_scc1 L_notld
    s_setprio 3
    s_mov_b32 s51, 0
    s_mov_b32 s53, s34
    s_mul_i32 s97, s30, 122880
    s_sub_u32 s55, s97, 20480
    s_cselect_b32 s55, 0x40000000, s55
    s_mul_i32 s52, s32, 12288
    s_add_u32 s52, s52, 2048
    s_mul_i32 s54, s32, 122880
    s_lshl_b32 s96, s31, 7
    s_add_u32 s54, s54, s96
    s_sub_u32 s54, s54, 122880
    s_min_u32 s98, s32, 1
    v_lshlrev_b32 v6, s98, v2
    v_and_b32 v6, 3, v6
    v_xor_b32 v5, v5, v6
    s_mul_i32 s99, s98, 2560
    s_add_u32 s99, s99, 1280
    v_mul_u32_u24 v4, s99, v4
    v_lshl_add_u32 v8, v5, 4, v4
    v_xor_b32 v9, 64, v8
    s_lshl_b32 s56, s99, 3
    s_mov_b32 s43, 0x00020000
    s_cmp_eq_u32 s32, 0
    s_cselect_b32 s54, s97, s54
    s_cselect_b32 s57, s56, 4294876416
    s_movk_i32 s58, 128
    s_cselect_b32 s58, s58, 245760
    s_mov_b32 s42, 2621440
    s_cselect_b32 s42, s42, 2457600
    s_waitcnt lgkmcnt(0)
    s_cselect_b64 s[40:41], s[4:5], s[18:19]
L_ld:
    s_mov_b32 m0, s52
    s_mul_i32 s96, s53, s58
    s_add_u32 s50, s96, s54
    buffer_load_dwordx4 v8, s[40:43], s50 offen lds
    s_add_u32 m0, m0, 1024
    s_add_u32 s50, s50, s56
    buffer_load_dwordx4 v9, s[40:43], s50 offen lds
    s_add_u32 m0, m0, 1024
    s_add_u32 s50, s50, s56
    buffer_load_dwordx4 v8, s[40:43], s50 offen lds
    s_add_u32 m0, m0, 1024
    s_add_u32 s50, s50, s56
    buffer_load_dwordx4 v9, s[40:43], s50 offen lds
    s_add_u32 m0, m0, 1024
    s_add_u32 s50, s50, s57
    buffer_load_dwordx4 v8, s[40:43], s50 offen lds
    s_add_u32 m0, m0, 1024
    s_add_u32 s50, s50, s56
    buffer_load_dwordx4 v9, s[40:43], s50 offen lds
    s_add_u32 m0, m0, 1024
    s_add_u32 s50, s50, s56
    buffer_load_dwordx4 v8, s[40:43], s50 offen lds
    s_add_u32 m0, m0, 1024
    s_add_u32 s50, s50, s56
    buffer_load_dwordx4 v9, s[40:43], s50 offen lds
    s_add_u32 m0, m0, 1024
    s_add_u32 s50, s50, s57
    buffer_load_dwordx4 v8, s[40:43], s50 offen lds
    s_add_u32 m0, m0, 1024
    s_add_u32 s50, s50, s56
    buffer_load_dwordx4 v9, s[40:43], s50 offen lds
    s_add_u32 m0, m0, 1024
    s_add_u32 s50, s50, s56
    buffer_load_dwordx4 v8, s[40:43], s50 offen lds
    s_add_u32 m0, m0, 1024
    s_add_u32 s50, s50, s56
    buffer_load_dwordx4 v9, s[40:43], s50 offen lds
    s_cmp_lg_u32 s32, 0
    s_cbranch_scc1 L_ldw
    s_sub_u32 m0, s52, 2048
    s_add_u32 s50, s96, s55
    buffer_load_dwordx4 v8, s[40:43], s50 offen lds
    s_add_u32 m0, m0, 1024
    s_add_u32 s50, s50, s56
    buffer_load_dwordx4 v9, s[40:43], s50 offen lds
L_ldw:
    s_add_u32 s52, s52, 38912
    s_cmp_ge_u32 s52, 116736
    s_cselect_b32 s96, 116736, 0
    s_sub_u32 s52, s52, s96
    s_add_u32 s53, s53, 1
    s_cmp_eq_u32 s53, 10
    s_cselect_b32 s53, 0, s53
    s_add_u32 s51, s51, 1
    s_cmp_lt_u32 s51, 2
    s_cbranch_scc1 L_ld
    s_cmp_lg_u32 s51, 3
    s_cbranch_scc1 L_ldt
    s_load_dword s33, s[28:29], 0
L_ldt:
    s_waitcnt vmcnt(14) lgkmcnt(0)
    s_cmp_eq_u32 s32, 0
    s_cbranch_scc1 L_ldb
    s_waitcnt vmcnt(12)
L_ldb:
    s_barrier
    s_cmp_lt_u32 s51, 10
    s_cbranch_scc1 L_ld
    s_setprio 0
    v_mov_b32 v3, 160960
    s_mov_b32 s37, 1
    s_cmp_lg_u32 s32, 0
    s_cbranch_scc1 L_ps
    s_branch L_s0
L_a:
    s_lshl_b32 s97, s97, 5
    s_sub_u32 s97, s97, s98
    s_add_u32 s97, s97, s99
    s_lshl1_add_u32 s97, s97, s31
    s_sub_u32 s97, s97, 56
    s_lshr_b32 s96, s32, 2
    s_lshl_b32 s98, s96, 5
    s_add_u32 s43, s98, s97
    s_mul_i32 s41, s96, 42752
    s_add_u32 s41, s41, 1024
    s_mov_b32 s54, s41
    s_cmp_lt_u32 s97, 32
    s_cbranch_scc1 L_c
    s_add_u32 s43, s43, 284
    s_cmp_eq_u32 s96, 0
    s_cbranch_scc1 L_c
    s_branch L_cexit
L_notld:
    s_cmp_lt_u32 s32, 8
    s_cbranch_scc1 L_hg
    s_add_u32 s43, s43, 96
    s_mov_b32 s41, 116736
    s_mov_b32 s54, 116736
L_c:
    s_and_b32 s40, s32, 3
    s_lshr_b32 s55, s43, 5
    s_and_b32 s63, s43, 31
    v_mul_u32_u24 v4, 1280, v4
    v_lshrrev_b32 v6, 1, v2
    v_xor_b32 v5, v5, v6
    s_lshl_b32 s96, s40, 2
    s_and_b32 s96, s96, 4
    v_xor_b32 v5, s96, v5
    v_lshl_add_u32 v22, v5, 4, v4
    v_xor_b32 v23, 32, v22
    s_lshl2_add_u32 s96, s55, s40
    s_lshl_b32 s96, s96, 7
    v_lshl_add_u32 v21, v1, 3, s96
    v_lshlrev_b32 v12, 4, v0
    s_lshr_b32 s96, s40, 1
    s_lshl1_add_u32 s42, s43, s96
    s_mul_i32 s96, s96, 8320
    s_add_u32 s96, s96, s41
    s_add_u32 s62, s96, 16960
    s_and_b32 s97, s40, 1
    s_lshl_b32 s98, s97, 11
    s_add_u32 s60, s98, s62
    s_lshl_b32 s96, s42, 12
    s_add_u32 s61, s96, s98
    s_mov_b32 s46, 2621440
    s_mov_b32 s47, 0x00020000
    s_mov_b64 s[50:51], s[46:47]
    s_setprio 3
    s_cmp_eq_u32 s35, 0
    s_cbranch_scc1 L_c2
    s_lshl2_add_u32 s96, s63, s40
    s_mul_i32 s96, s96, 20480
    s_lshl_b32 s97, s55, 7
    s_add_u32 s96, s96, s97
    s_lshl_b32 s97, s40, 11
    s_add_u32 s97, s97, s41
    s_add_u32 m0, s97, 8704
    s_add_u32 s98, s96, 9216
    s_waitcnt lgkmcnt(0)
    s_mov_b64 s[48:49], s[8:9]
    buffer_load_dwordx4 v22, s[48:51], s96 offen lds
    buffer_load_dwordx4 v23, s[48:51], s98 offen offset:1024 lds
    s_sub_u32 m0, m0, 8192
    s_mov_b64 s[44:45], s[6:7]
    buffer_load_dwordx4 v22, s[44:47], s96 offen lds
    buffer_load_dwordx4 v23, s[44:47], s98 offen offset:1024 lds
    global_load_dwordx2 v[14:15], v21, s[10:11]
    s_cmp_lg_u32 s40, 3
    s_cbranch_scc1 Lkv_1
    s_sub_u32 s96, s96, 71680
    s_cselect_b32 s96, 0x40000000, s96
    s_sub_u32 m0, s41, 512
    s_mov_b32 exec_lo, 0
    buffer_load_dwordx4 v23, s[44:47], s96 offen lds
    s_mov_b32 exec_lo, -1
Lkv_1:
L_c2:
    s_lshr_b32 s96, s32, 2
    s_lshl_b32 s96, s96, 6
    s_add_u32 s96, s96, 160768
    v_mov_b32 v3, s96
    v_mov_b32 v6, 0
    s_lshl_b32 s96, s40, 8
    s_add_u32 s96, s96, s41
    v_lshl_add_u32 v5, v0, 2, s96
    ds_write_b32 v5, v6 offset:41728
    s_mul_i32 s96, s40, 4160
    s_add_u32 s96, s96, s41
    v_lshl_add_u32 v5, v1, 2, s96
    ds_write_b32 v5, v6 offset:16896
    v_lshl_add_u32 v5, v1, 2, v3
    ds_write_b32 v5, v6
    v_and_b32 v4, 1, v2
    v_lshrrev_b32 v5, 1, v2
    v_lshlrev_b32 v6, 2, v1
    v_sub_u32 v6, v6, v4
    s_add_u32 s96, s41, 256
    v_lshl_add_u32 v6, v6, 7, s96
    s_lshl_b32 s97, s40, 1
    v_or_b32 v7, s97, v5
    v_sub_u32 v9, v1, v4
    v_subrev_u32 v10, 1, v1
    v_xor_b32 v8, v1, v7
    v_and_b32 v8, 7, v8
    v_lshl_add_u32 v8, v8, 4, v6
    v_xor_b32 v9, v9, v7
    v_and_b32 v9, 7, v9
    v_lshl_add_u32 v9, v9, 4, v6
    v_xor_b32 v10, v10, v7
    v_and_b32 v10, 7, v10
    v_lshl_add_u32 v10, v10, 4, v6
    v_mul_u32_u24 v7, 136, v4
    v_add_u32 v13, v8, v7
    v_and_b32 v6, 1, v1
    v_xor_b32 v16, v4, v6
    v_lshlrev_b32 v16, 4, v16
    v_lshlrev_b32 v6, 4, v6
    v_mov_b32 v7, 0xffff
    v_lshlrev_b32 v6, v6, v7
    v_lshrrev_b32 v7, 1, v1
    v_lshlrev_b32 v5, 2, v5
    v_sub_u32 v7, v7, v5
    v_cmp_eq_u32 vcc, 0, v7
    s_nop 1
    v_cndmask_b32 v17, 0, v6, vcc
    v_cmp_eq_u32 vcc, 1, v7
    s_nop 1
    v_cndmask_b32 v18, 0, v6, vcc
    v_cmp_eq_u32 vcc, 2, v7
    s_nop 1
    v_cndmask_b32 v19, 0, v6, vcc
    v_cmp_eq_u32 vcc, 3, v7
    s_nop 1
    v_cndmask_b32 v20, 0, v6, vcc
    v_not_b32 v4, v0
    v_bfe_u32 v5, v4, 1, 2
    v_lshlrev_b32 v5, 4, v5
    v_bfe_u32 v6, v4, 3, 1
    v_lshl_add_u32 v5, v6, 7, v5
    v_xor_b32 v6, s63, v4
    v_and_b32 v6, 1, v6
    v_lshl_add_u32 v5, v6, 6, v5
    v_lshl_add_u32 v5, v2, 14, v5
    s_lshl2_add_u32 s96, s55, s40
    s_lshl_b32 s97, s96, 16
    s_lshl_b32 s98, s63, 8
    s_sub_u32 s97, s97, s98
    s_add_u32 s97, s97, 1056512
    v_add_u32 v11, s97, v5
    s_lshl_b32 s97, s96, 10
    s_lshl2_add_u32 s97, s63, s97
    s_add_u32 s64, s97, 65536
    s_and_b32 s96, s43, -8
    s_cmp_ge_u32 s55, 3
    s_cselect_b32 s96, s96, s63
    s_lshl_b32 s96, s96, 7
    s_add_u32 s65, s96, 65536
    s_waitcnt lgkmcnt(0)
    s_load_dword s33, s[28:29], 0
    s_lshl_b32 s96, s43, 2
    s_load_dword s53, s[14:15], s96
    s_cmp_lg_u32 s35, 0
    s_cbranch_scc1 L_cs
    s_sub_u32 s80, s31, s34
    s_cselect_b32 s96, 10, 0
    s_add_u32 s80, s80, s96
    s_mul_i32 s96, s80, 43
    s_lshr_b32 s96, s96, 7
    s_mul_i32 s96, s96, 3
    s_sub_u32 s96, s80, s96
    s_mul_i32 s97, s96, 38912
    v_lshrrev_b32 v4, 1, v1
    v_lshrrev_b32 v5, 1, v2
    v_xor_b32 v4, v4, v5
    s_lshl_b32 s96, s40, 1
    v_xor_b32 v4, s96, v4
    v_lshlrev_b32 v4, 4, v4
    v_lshl_add_u32 v4, v1, 7, v4
    v_and_b32 v5, 1, v2
    v_lshl_add_u32 v4, v5, 3, v4
    v_add_u32 v166, s97, v4
    s_barrier
    s_cmp_lg_u32 s80, 0
    s_cbranch_scc1 Lq_2
    ds_read_b64 v[112:113], v166 offset:2048
    ds_read_b64 v[114:115], v166 offset:4096
    ds_read_b64 v[116:117], v166 offset:6144
    ds_read_b64 v[118:119], v166 offset:8192
    ds_read_b64 v[120:121], v166 offset:10240
    ds_read_b64 v[122:123], v166 offset:12288
    s_waitcnt lgkmcnt(0)
Lq_2:
    s_setprio 0
L_cs:
    s_and_b32 s97, s40, 1
    v_add_u32 v156, s60, v12
    s_lshl_b32 s98, s97, 8
    s_add_u32 s96, s62, s98
    s_add_u32 s96, s96, 4132
    v_lshrrev_b32 v4, 1, v1
    v_lshl_add_u32 v4, v2, 2, v4
    v_lshl_add_u32 v4, v4, 2, s96
    v_and_b32 v5, 1, v1
    v_mul_u32_u24 v5, 4160, v5
    v_sub_u32 v148, v4, v5
    v_add_u32 v149, 1024, v148
    v_add_u32 v150, 2048, v148
    v_add_u32 v151, 3072, v148
    v_lshlrev_b32 v4, 1, v1
    v_sub_u32 v4, v2, v4
    s_lshl_b32 s98, s97, 4
    s_add_u32 s98, s98, 30
    v_add_u32 v4, s98, v4
    s_lshr_b32 s98, s40, 1
    s_add_u32 s96, s41, 33536
    v_and_b32 v5, 3, v4
    v_lshl_add_u32 v5, v5, 4, s96
    v_lshrrev_b32 v6, 2, v4
    v_lshl_add_u32 v5, v6, 7, v5
    v_bfe_u32 v6, v4, 3, 1
    v_xor_b32 v6, s98, v6
    v_lshl_add_u32 v152, v6, 6, v5
    v_xor_b32 v154, 64, v152
    v_add_u32 v4, 4, v4
    v_and_b32 v5, 3, v4
    v_lshl_add_u32 v5, v5, 4, s96
    v_lshrrev_b32 v6, 2, v4
    v_lshl_add_u32 v5, v6, 7, v5
    v_bfe_u32 v6, v4, 3, 1
    v_xor_b32 v6, s98, v6
    v_lshl_add_u32 v153, v6, 6, v5
    v_xor_b32 v155, 64, v153
    v_and_b32 v5, 1, v2
    v_lshlrev_b32 v5, 9, v5
    v_lshl_add_u32 v5, v1, 5, v5
    v_lshrrev_b32 v6, 1, v2
    v_lshl_add_u32 v5, v6, 4, v5
    s_add_u32 s96, s61, 3670016
    v_add_u32 v157, s96, v5
    s_lshl_b32 s96, s40, 12
    s_add_u32 s96, s96, s54
    v_add_u32 v158, s96, v12
    s_xor_b32 s96, s40, 1
    s_lshl_b32 s96, s96, 12
    s_add_u32 s96, s96, s54
    v_add_u32 v159, s96, v12
    s_waitcnt lgkmcnt(0)
    s_mul_i32 s33, s33, 1664525
    s_add_u32 s33, s33, 1013904223
    s_mov_b32 s58, s33
    s_mov_b32 s59, s33
    s_add_u32 s56, s28, s65
    s_addc_u32 s57, s29, 0
    s_bitcmp1_b32 s40, 1
    s_cselect_b32 s96, 16, 0
    s_lshr_b32 s53, s53, s96
    s_and_b32 s53, s53, 0xffff
    s_bitcmp1_b32 s40, 0
    s_cselect_b32 s53, 0, s53
    v_not_b32 v5, v1
    v_and_b32 v6, 1, v5
    v_lshlrev_b32 v6, 4, v6
    v_lshlrev_b32 v6, v6, s53
    v_bfe_u32 v5, v5, 1, 3
    v_lshlrev_b32 v7, 2, v2
    v_sub_u32 v5, v5, v7
    v_cmp_eq_u32 vcc, 0, v5
    s_nop 1
    v_cndmask_b32 v144, 0, v6, vcc
    v_cmp_eq_u32 vcc, 1, v5
    s_nop 1
    v_cndmask_b32 v145, 0, v6, vcc
    v_cmp_eq_u32 vcc, 2, v5
    s_nop 1
    v_cndmask_b32 v146, 0, v6, vcc
    v_cmp_eq_u32 vcc, 3, v5
    s_nop 1
    v_cndmask_b32 v147, 0, v6, vcc
    s_setprio 3
    s_cmp_lg_u32 s35, 0
    s_cbranch_scc1 L_akv
    s_barrier
    s_cmp_lg_u32 s80, 1
    s_cbranch_scc1 Lq_3
    ds_read_b64 v[112:113], v166 offset:2048
    ds_read_b64 v[114:115], v166 offset:4096
    ds_read_b64 v[116:117], v166 offset:6144
    ds_read_b64 v[118:119], v166 offset:8192
    ds_read_b64 v[120:121], v166 offset:10240
    ds_read_b64 v[122:123], v166 offset:12288
    s_waitcnt lgkmcnt(0)
Lq_3:
    s_lshl2_add_u32 s96, s63, s40
    s_mul_i32 s96, s96, 20480
    s_lshl_b32 s97, s55, 7
    s_add_u32 s96, s96, s97
    s_lshl_b32 s97, s40, 11
    s_add_u32 s97, s97, s41
    s_add_u32 m0, s97, 8704
    s_add_u32 s98, s96, 9216
    s_waitcnt lgkmcnt(0)
    s_mov_b64 s[48:49], s[8:9]
    buffer_load_dwordx4 v22, s[48:51], s96 offen lds
    buffer_load_dwordx4 v23, s[48:51], s98 offen offset:1024 lds
    s_sub_u32 m0, m0, 8192
    s_mov_b64 s[44:45], s[6:7]
    buffer_load_dwordx4 v22, s[44:47], s96 offen lds
    buffer_load_dwordx4 v23, s[44:47], s98 offen offset:1024 lds
    global_load_dwordx2 v[14:15], v21, s[10:11]
    s_cmp_lg_u32 s40, 3
    s_cbranch_scc1 Lkv_4
    s_sub_u32 s96, s96, 71680
    s_cselect_b32 s96, 0x40000000, s96
    s_sub_u32 m0, s41, 512
    s_mov_b32 exec_lo, 0
    buffer_load_dwordx4 v23, s[44:47], s96 offen lds
    s_mov_b32 exec_lo, -1
Lkv_4:
    s_barrier
    s_cmp_lg_u32 s80, 2
    s_cbranch_scc1 Lq_5
    ds_read_b64 v[112:113], v166 offset:2048
    ds_read_b64 v[114:115], v166 offset:4096
    ds_read_b64 v[116:117], v166 offset:6144
    ds_read_b64 v[118:119], v166 offset:8192
    ds_read_b64 v[120:121], v166 offset:10240
    ds_read_b64 v[122:123], v166 offset:12288
    s_waitcnt lgkmcnt(0)
Lq_5:
    s_branch L_kvw
L_akv:
    s_mov_b32 s80, -1
    v_mov_b32 v166, 0
    s_load_dword s66, s[28:29], s65 glc
    s_cmp_lg_u32 s32, 1
    s_cbranch_scc1 L_kvw
    v_lshlrev_b32 v4, 21, v0
    s_mov_b64 exec, 0x3e
    global_load_dword v160, v4, s[28:29]
    s_mov_b64 exec, 3
    global_load_dword v161, v4, s[24:25]
    s_mov_b64 exec, 1
    global_load_dword v162, v4, s[20:21]
    global_load_dword v163, v4, s[26:27] offset:128
    s_mov_b64 exec, -1
    s_waitcnt vmcnt(4)
    s_branch L_kvw2
L_kvw:
    s_waitcnt vmcnt(0)
L_kvw2:
    s_mov_b64 s[48:49], s[12:13]
    s_barrier
    s_cmp_lg_u32 s80, 3
    s_cbranch_scc1 Lq_6
    ds_read_b64 v[112:113], v166 offset:2048
    ds_read_b64 v[114:115], v166 offset:4096
    ds_read_b64 v[116:117], v166 offset:6144
    ds_read_b64 v[118:119], v166 offset:8192
    ds_read_b64 v[120:121], v166 offset:10240
    ds_read_b64 v[122:123], v166 offset:12288
    s_waitcnt lgkmcnt(0)
Lq_6:
    ds_read_b128 v[32:35], v9 offset:256
    ds_read_b128 v[24:27], v10 offset:0
    ds_read_b128 v[36:39], v8 offset:384
    ds_read_b128 v[28:31], v10 offset:128
    ds_read_b128 v[40:43], v8 offset:512
    ds_read_b128 v[44:47], v8 offset:640
    ds_read_b64 v[48:49], v13 offset:8448
    ds_read_b64 v[50:51], v13 offset:8576
    ds_read_b64 v[52:53], v13 offset:8704
    ds_read_b64 v[54:55], v13 offset:8832
    v_alignbit_b32 v14, v14, v14, v16
    v_alignbit_b32 v15, v15, v15, v16
    v_and_b32 v72, v14, v17
    v_and_b32 v73, v14, v18
    v_and_b32 v74, v14, v19
    v_and_b32 v75, v14, v20
    v_and_b32 v76, v15, v17
    v_and_b32 v77, v15, v18
    v_and_b32 v78, v15, v19
    v_and_b32 v79, v15, v20
    s_mov_b32 s44, s28
    s_and_b32 s45, s29, 0xffff
    s_mov_b32 s46, 16777216
    s_mov_b32 s47, 0x00020000
    s_mov_b32 vcc_lo, 0xaaaaaaaa
    s_mov_b32 vcc_hi, 0xaaaaaaaa
    s_movk_i32 s96, 8192
    s_waitcnt lgkmcnt(0)
    v_mfma_f32_16x16x32_bf16 v[56:59], v[72:75], v[32:35], 0
    v_mfma_f32_16x16x32_bf16 v[56:59], v[76:79], v[24:27], v[56:59]
    v_lshlrev_b32 v96, 16, v48
    v_and_b32 v97, 0xffff0000, v48
    v_lshlrev_b32 v98, 16, v49
    v_and_b32 v99, 0xffff0000, v49
    v_mfma_f32_16x16x32_bf16 v[60:63], v[72:75], v[36:39], 0
    v_mfma_f32_16x16x32_bf16 v[60:63], v[76:79], v[28:31], v[60:63]
    v_lshlrev_b32 v100, 16, v50
    v_and_b32 v101, 0xffff0000, v50
    v_lshlrev_b32 v102, 16, v51
    v_and_b32 v103, 0xffff0000, v51
    v_mfma_f32_16x16x32_bf16 v[64:67], v[72:75], v[40:43], 0
    v_mfma_f32_16x16x32_bf16 v[64:67], v[76:79], v[32:35], v[64:67]
    v_lshlrev_b32 v104, 16, v52
    v_and_b32 v105, 0xffff0000, v52
    v_lshlrev_b32 v106, 16, v53
    v_and_b32 v107, 0xffff0000, v53
    v_mfma_f32_16x16x32_bf16 v[68:71], v[72:75], v[44:47], 0
    v_mfma_f32_16x16x32_bf16 v[68:71], v[76:79], v[36:39], v[68:71]
    v_lshlrev_b32 v108, 16, v54
    v_and_b32 v109, 0xffff0000, v54
    v_lshlrev_b32 v110, 16, v55
    v_and_b32 v111, 0xffff0000, v55
    v_mul_f32 v96, v56, v96
    v_mul_f32 v97, v57, v97
    v_mul_f32 v98, v58, v98
    v_mul_f32 v99, v59, v99
    v_mul_f32 v100, v60, v100
    v_mul_f32 v101, v61, v101
    v_mul_f32 v102, v62, v102
    v_mul_f32 v103, v63, v103
    v_mul_f32 v104, v64, v104
    v_mul_f32 v105, v65, v105
    v_mul_f32 v106, v66, v106
    v_mul_f32 v107, v67, v107
    v_mul_f32 v108, v68, v108
    v_mul_f32 v109, v69, v109
    v_mul_f32 v110, v70, v110
    v_mul_f32 v111, v71, v111
    v_cvt_pk_bf16_f32 v80, v108, v104
    v_cvt_pk_bf16_f32 v81, v100, v96
    v_cvt_pk_bf16_f32 v82, v109, v105
    v_cvt_pk_bf16_f32 v83, v101, v97
    v_cvt_pk_bf16_f32 v84, v110, v106
    v_cvt_pk_bf16_f32 v85, v102, v98
    v_cvt_pk_bf16_f32 v86, v111, v107
    v_cvt_pk_bf16_f32 v87, v103, v99
    v_cndmask_b32_dpp v88, v80, v82, vcc quad_perm:[1,0,3,2] row_mask:0xf bank_mask:0xf
    v_cndmask_b32_dpp v89, v81, v83, vcc quad_perm:[1,0,3,2] row_mask:0xf bank_mask:0xf
    v_cndmask_b32_dpp v92, v84, v86, vcc quad_perm:[1,0,3,2] row_mask:0xf bank_mask:0xf
    v_cndmask_b32_dpp v93, v85, v87, vcc quad_perm:[1,0,3,2] row_mask:0xf bank_mask:0xf
    s_not_b64 vcc, vcc
    v_cndmask_b32_dpp v90, v82, v80, vcc quad_perm:[1,0,3,2] row_mask:0xf bank_mask:0xf
    v_cndmask_b32_dpp v91, v83, v81, vcc quad_perm:[1,0,3,2] row_mask:0xf bank_mask:0xf
    buffer_store_dwordx4 v[88:91], v11, s[44:47], 0 offen sc1
    v_cndmask_b32_dpp v94, v86, v84, vcc quad_perm:[1,0,3,2] row_mask:0xf bank_mask:0xf
    v_cndmask_b32_dpp v95, v87, v85, vcc quad_perm:[1,0,3,2] row_mask:0xf bank_mask:0xf
    buffer_store_dwordx4 v[92:95], v11, s[44:47], s96 offen sc1
    s_cmp_lg_u32 s35, 0
    s_cbranch_scc1 L_asig
    s_setprio 0
    s_mov_b32 s52, s40
    s_barrier
    s_cmp_lg_u32 s80, 4
    s_cbranch_scc1 Lq_7
    ds_read_b64 v[112:113], v166 offset:2048
    ds_read_b64 v[114:115], v166 offset:4096
    ds_read_b64 v[116:117], v166 offset:6144
    ds_read_b64 v[118:119], v166 offset:8192
    ds_read_b64 v[120:121], v166 offset:10240
    ds_read_b64 v[122:123], v166 offset:12288
    s_waitcnt lgkmcnt(0)
Lq_7:
    s_waitcnt vmcnt(0)
    s_atomic_swap s33, s[28:29], s64
    s_barrier
    s_cmp_lg_u32 s80, 5
    s_cbranch_scc1 Lq_8
    ds_read_b64 v[112:113], v166 offset:2048
    ds_read_b64 v[114:115], v166 offset:4096
    ds_read_b64 v[116:117], v166 offset:6144
    ds_read_b64 v[118:119], v166 offset:8192
    ds_read_b64 v[120:121], v166 offset:10240
    ds_read_b64 v[122:123], v166 offset:12288
    s_waitcnt lgkmcnt(0)
Lq_8:
    s_barrier
    s_cmp_lg_u32 s80, 6
    s_cbranch_scc1 Lq_9
    ds_read_b64 v[112:113], v166 offset:2048
    ds_read_b64 v[114:115], v166 offset:4096
    ds_read_b64 v[116:117], v166 offset:6144
    ds_read_b64 v[118:119], v166 offset:8192
    ds_read_b64 v[120:121], v166 offset:10240
    ds_read_b64 v[122:123], v166 offset:12288
    s_waitcnt lgkmcnt(0)
Lq_9:
    s_barrier
    s_cmp_lg_u32 s80, 7
    s_cbranch_scc1 Lq_10
    ds_read_b64 v[112:113], v166 offset:2048
    ds_read_b64 v[114:115], v166 offset:4096
    ds_read_b64 v[116:117], v166 offset:6144
    ds_read_b64 v[118:119], v166 offset:8192
    ds_read_b64 v[120:121], v166 offset:10240
    ds_read_b64 v[122:123], v166 offset:12288
    s_waitcnt lgkmcnt(0)
Lq_10:
    s_cmp_lg_u32 s52, 0
    s_cbranch_scc1 Lud_12
Lup_11:
    s_load_dwordx16 s[64:79], s[56:57], 0 glc
    s_load_dwordx16 s[4:19], s[56:57], 64 glc
    s_waitcnt lgkmcnt(0)
    s_xor_b64 s[64:65], s[64:65], s[58:59]
    s_xor_b64 s[4:5], s[4:5], s[58:59]
    s_or_b64 s[64:65], s[64:65], s[4:5]
    s_xor_b64 s[66:67], s[66:67], s[58:59]
    s_xor_b64 s[6:7], s[6:7], s[58:59]
    s_or_b64 s[64:65], s[64:65], s[66:67]
    s_or_b64 s[64:65], s[64:65], s[6:7]
    s_xor_b64 s[68:69], s[68:69], s[58:59]
    s_xor_b64 s[8:9], s[8:9], s[58:59]
    s_or_b64 s[64:65], s[64:65], s[68:69]
    s_or_b64 s[64:65], s[64:65], s[8:9]
    s_xor_b64 s[70:71], s[70:71], s[58:59]
    s_xor_b64 s[10:11], s[10:11], s[58:59]
    s_or_b64 s[64:65], s[64:65], s[70:71]
    s_or_b64 s[64:65], s[64:65], s[10:11]
    s_xor_b64 s[72:73], s[72:73], s[58:59]
    s_xor_b64 s[12:13], s[12:13], s[58:59]
    s_or_b64 s[64:65], s[64:65], s[72:73]
    s_or_b64 s[64:65], s[64:65], s[12:13]
    s_xor_b64 s[74:75], s[74:75], s[58:59]
    s_xor_b64 s[14:15], s[14:15], s[58:59]
    s_or_b64 s[64:65], s[64:65], s[74:75]
    s_or_b64 s[64:65], s[64:65], s[14:15]
    s_xor_b64 s[76:77], s[76:77], s[58:59]
    s_xor_b64 s[16:17], s[16:17], s[58:59]
    s_or_b64 s[64:65], s[64:65], s[76:77]
    s_or_b64 s[64:65], s[64:65], s[16:17]
    s_xor_b64 s[78:79], s[78:79], s[58:59]
    s_xor_b64 s[18:19], s[18:19], s[58:59]
    s_or_b64 s[64:65], s[64:65], s[78:79]
    s_or_b64 s[64:65], s[64:65], s[18:19]
    s_cbranch_scc1 Lud_12
    s_mov_b32 s52, -1
Lud_12:
    s_barrier
    s_cmp_lg_u32 s80, 8
    s_cbranch_scc1 Lq_13
    ds_read_b64 v[112:113], v166 offset:2048
    ds_read_b64 v[114:115], v166 offset:4096
    ds_read_b64 v[116:117], v166 offset:6144
    ds_read_b64 v[118:119], v166 offset:8192
    ds_read_b64 v[120:121], v166 offset:10240
    ds_read_b64 v[122:123], v166 offset:12288
    s_waitcnt lgkmcnt(0)
Lq_13:
    s_mov_b32 m0, s60
    s_sub_u32 s96, s61, 16
    s_bitcmp1_b32 s40, 0
    s_cselect_b32 s96, s96, 0x40000000
    buffer_load_dwordx4 v12, s[48:51], s61 offen lds
    buffer_load_dwordx4 v12, s[48:51], s61 offen offset:1024 lds
    s_sub_u32 m0, s60, 16
    s_mov_b64 exec, 1
    buffer_load_dwordx4 v12, s[48:51], s96 offen lds
    s_mov_b64 exec, -1
    s_cmp_lg_u32 s52, 0
    s_cbranch_scc1 Lud_15
Lup_14:
    s_load_dwordx16 s[64:79], s[56:57], 0 glc
    s_load_dwordx16 s[4:19], s[56:57], 64 glc
    s_waitcnt lgkmcnt(0)
    s_xor_b64 s[64:65], s[64:65], s[58:59]
    s_xor_b64 s[4:5], s[4:5], s[58:59]
    s_or_b64 s[64:65], s[64:65], s[4:5]
    s_xor_b64 s[66:67], s[66:67], s[58:59]
    s_xor_b64 s[6:7], s[6:7], s[58:59]
    s_or_b64 s[64:65], s[64:65], s[66:67]
    s_or_b64 s[64:65], s[64:65], s[6:7]
    s_xor_b64 s[68:69], s[68:69], s[58:59]
    s_xor_b64 s[8:9], s[8:9], s[58:59]
    s_or_b64 s[64:65], s[64:65], s[68:69]
    s_or_b64 s[64:65], s[64:65], s[8:9]
    s_xor_b64 s[70:71], s[70:71], s[58:59]
    s_xor_b64 s[10:11], s[10:11], s[58:59]
    s_or_b64 s[64:65], s[64:65], s[70:71]
    s_or_b64 s[64:65], s[64:65], s[10:11]
    s_xor_b64 s[72:73], s[72:73], s[58:59]
    s_xor_b64 s[12:13], s[12:13], s[58:59]
    s_or_b64 s[64:65], s[64:65], s[72:73]
    s_or_b64 s[64:65], s[64:65], s[12:13]
    s_xor_b64 s[74:75], s[74:75], s[58:59]
    s_xor_b64 s[14:15], s[14:15], s[58:59]
    s_or_b64 s[64:65], s[64:65], s[74:75]
    s_or_b64 s[64:65], s[64:65], s[14:15]
    s_xor_b64 s[76:77], s[76:77], s[58:59]
    s_xor_b64 s[16:17], s[16:17], s[58:59]
    s_or_b64 s[64:65], s[64:65], s[76:77]
    s_or_b64 s[64:65], s[64:65], s[16:17]
    s_xor_b64 s[78:79], s[78:79], s[58:59]
    s_xor_b64 s[18:19], s[18:19], s[58:59]
    s_or_b64 s[64:65], s[64:65], s[78:79]
    s_or_b64 s[64:65], s[64:65], s[18:19]
    s_cbranch_scc1 Lud_15
    s_mov_b32 s52, -1
Lud_15:
    s_cmp_lg_u32 s52, -1
    s_cbranch_scc1 Lui_16
    s_add_u32 m0, s41, 33536
    s_lshl_b32 s96, s43, 13
    s_add_u32 s96, s96, 1048576
    buffer_load_dwordx4 v12, s[44:47], s96 offen offset:0 sc1 lds
    buffer_load_dwordx4 v12, s[44:47], s96 offen offset:1024 sc1 lds
    buffer_load_dwordx4 v12, s[44:47], s96 offen offset:2048 sc1 lds
    buffer_load_dwordx4 v12, s[44:47], s96 offen offset:3072 sc1 lds
    s_add_u32 m0, m0, 4096
    s_add_u32 s96, s96, 4096
    buffer_load_dwordx4 v12, s[44:47], s96 offen offset:0 sc1 lds
    buffer_load_dwordx4 v12, s[44:47], s96 offen offset:1024 sc1 lds
    buffer_load_dwordx4 v12, s[44:47], s96 offen offset:2048 sc1 lds
    buffer_load_dwordx4 v12, s[44:47], s96 offen offset:3072 sc1 lds
    s_mov_b32 s52, 9
Lui_16:
    s_barrier
    s_cmp_lg_u32 s80, 9
    s_cbranch_scc1 Lq_17
    ds_read_b64 v[112:113], v166 offset:2048
    ds_read_b64 v[114:115], v166 offset:4096
    ds_read_b64 v[116:117], v166 offset:6144
    ds_read_b64 v[118:119], v166 offset:8192
    ds_read_b64 v[120:121], v166 offset:10240
    ds_read_b64 v[122:123], v166 offset:12288
    s_waitcnt lgkmcnt(0)
Lq_17:
    s_setprio 3
    v_mov_b32 v8, v112
    v_mov_b32 v9, v113
    v_mov_b32 v10, v114
    v_mov_b32 v11, v115
    v_mov_b32 v14, v116
    v_mov_b32 v15, v117
    v_mov_b32 v160, v118
    v_mov_b32 v161, v119
    v_mov_b32 v162, v120
    v_mov_b32 v163, v121
    v_mov_b32 v164, v122
    v_mov_b32 v165, v123
    s_waitcnt vmcnt(0)
    s_cmp_lg_u32 s52, 9
    s_cbranch_scc1 L_nul
    v_mov_b32 v4, 1
    ds_write_b32 v3, v4 offset:0
    s_mov_b32 s52, 1
L_nul:
    v_subrev_u32 v4, 4, v156
    ds_read_b32 v21, v4 offset:0
    ds_read_b128 v[22:25], v156 offset:0
    ds_read_b32 v29, v4 offset:1024
    ds_read_b128 v[30:33], v156 offset:1024
    s_waitcnt lgkmcnt(0)
    v_alignbit_b32 v40, v22, v21, 16
    v_alignbit_b32 v41, v23, v22, 16
    v_alignbit_b32 v42, v24, v23, 16
    v_alignbit_b32 v43, v25, v24, 16
    ds_write_b128 v156, v[40:43] offset:4160
    v_alignbit_b32 v44, v30, v29, 16
    v_alignbit_b32 v45, v31, v30, 16
    v_alignbit_b32 v46, v32, v31, 16
    v_alignbit_b32 v47, v33, v32, 16
    ds_write_b128 v156, v[44:47] offset:5184
    s_waitcnt lgkmcnt(0)
    s_mov_b32 s81, 1
    s_barrier
    s_mov_b32 s81, 0
    s_setprio 0
    ds_read2_b32 v[48:49], v148 offset0:0 offset1:1
    ds_read2_b32 v[50:51], v148 offset0:2 offset1:3
    ds_read2_b32 v[52:53], v148 offset0:128 offset1:129
    ds_read2_b32 v[54:55], v148 offset0:130 offset1:131
    ds_read2_b32 v[56:57], v149 offset0:0 offset1:1
    ds_read2_b32 v[58:59], v149 offset0:2 offset1:3
    ds_read2_b32 v[60:61], v149 offset0:128 offset1:129
    ds_read2_b32 v[62:63], v149 offset0:130 offset1:131
    ds_read2_b32 v[64:65], v150 offset0:0 offset1:1
    ds_read2_b32 v[66:67], v150 offset0:2 offset1:3
    ds_read2_b32 v[68:69], v150 offset0:128 offset1:129
    ds_read2_b32 v[70:71], v150 offset0:130 offset1:131
    s_waitcnt lgkmcnt(6)
    ds_read2_b32 v[72:73], v151 offset0:0 offset1:1
    ds_read2_b32 v[74:75], v151 offset0:2 offset1:3
    ds_read2_b32 v[76:77], v151 offset0:128 offset1:129
    ds_read2_b32 v[78:79], v151 offset0:130 offset1:131
    s_cmp_lg_u32 s52, 0
    s_cbranch_scc1 Lud_19
    s_mov_b32 s100, 0
Lup_18:
    s_load_dwordx16 s[64:79], s[56:57], 0 glc
    s_load_dwordx16 s[4:19], s[56:57], 64 glc
    s_waitcnt lgkmcnt(0)
    s_xor_b64 s[64:65], s[64:65], s[58:59]
    s_xor_b64 s[4:5], s[4:5], s[58:59]
    s_or_b64 s[64:65], s[64:65], s[4:5]
    s_xor_b64 s[66:67], s[66:67], s[58:59]
    s_xor_b64 s[6:7], s[6:7], s[58:59]
    s_or_b64 s[64:65], s[64:65], s[66:67]
    s_or_b64 s[64:65], s[64:65], s[6:7]
    s_xor_b64 s[68:69], s[68:69], s[58:59]
    s_xor_b64 s[8:9], s[8:9], s[58:59]
    s_or_b64 s[64:65], s[64:65], s[68:69]
    s_or_b64 s[64:65], s[64:65], s[8:9]
    s_xor_b64 s[70:71], s[70:71], s[58:59]
    s_xor_b64 s[10:11], s[10:11], s[58:59]
    s_or_b64 s[64:65], s[64:65], s[70:71]
    s_or_b64 s[64:65], s[64:65], s[10:11]
    s_xor_b64 s[72:73], s[72:73], s[58:59]
    s_xor_b64 s[12:13], s[12:13], s[58:59]
    s_or_b64 s[64:65], s[64:65], s[72:73]
    s_or_b64 s[64:65], s[64:65], s[12:13]
    s_xor_b64 s[74:75], s[74:75], s[58:59]
    s_xor_b64 s[14:15], s[14:15], s[58:59]
    s_or_b64 s[64:65], s[64:65], s[74:75]
    s_or_b64 s[64:65], s[64:65], s[14:15]
    s_xor_b64 s[76:77], s[76:77], s[58:59]
    s_xor_b64 s[16:17], s[16:17], s[58:59]
    s_or_b64 s[64:65], s[64:65], s[76:77]
    s_or_b64 s[64:65], s[64:65], s[16:17]
    s_xor_b64 s[78:79], s[78:79], s[58:59]
    s_xor_b64 s[18:19], s[18:19], s[58:59]
    s_or_b64 s[64:65], s[64:65], s[78:79]
    s_or_b64 s[64:65], s[64:65], s[18:19]
    s_cbranch_scc0 Lug_20
    s_add_u32 s100, s100, 1
    s_cmp_lt_u32 s100, 1048576
    s_cbranch_scc1 Lup_18
Lug_20:
    s_mov_b32 s52, -1
Lud_19:
    s_cmp_lg_u32 s52, -1
    s_cbranch_scc1 Lui_21
    s_add_u32 m0, s41, 33536
    s_lshl_b32 s96, s43, 13
    s_add_u32 s96, s96, 1048576
    buffer_load_dwordx4 v12, s[44:47], s96 offen offset:0 sc1 lds
    buffer_load_dwordx4 v12, s[44:47], s96 offen offset:1024 sc1 lds
    buffer_load_dwordx4 v12, s[44:47], s96 offen offset:2048 sc1 lds
    buffer_load_dwordx4 v12, s[44:47], s96 offen offset:3072 sc1 lds
    s_add_u32 m0, m0, 4096
    s_add_u32 s96, s96, 4096
    buffer_load_dwordx4 v12, s[44:47], s96 offen offset:0 sc1 lds
    buffer_load_dwordx4 v12, s[44:47], s96 offen offset:1024 sc1 lds
    buffer_load_dwordx4 v12, s[44:47], s96 offen offset:2048 sc1 lds
    buffer_load_dwordx4 v12, s[44:47], s96 offen offset:3072 sc1 lds
    s_mov_b32 s52, 9
Lui_21:
    s_cmp_lg_u32 s52, 9
    s_cbranch_scc1 L_uwait
    s_waitcnt vmcnt(0)
    v_mov_b32 v4, 1
    ds_write_b32 v3, v4 offset:0
L_uwait:
    s_mov_b32 s100, 0
Lw_22:
    ds_read_b32 v4, v3 offset:0
    s_waitcnt lgkmcnt(0)
    v_readfirstlane_b32 s99, v4
    s_cmp_ge_u32 s99, 1
    s_cbranch_scc1 Lwd_23
    s_add_u32 s100, s100, 1
    s_cmp_lt_u32 s100, 8388608
    s_cbranch_scc1 Lw_22
Lwd_23:
    s_branch L_conv
L_asig:
    s_mov_b32 s81, 0
    v_lshl_add_u32 v4, v0, 7, s64
    v_mov_b32 v5, s33
    s_cmp_ge_u32 s55, 3
    s_cselect_b32 s97, 1, 0xff
    s_barrier
    s_mov_b32 m0, s60
    s_sub_u32 s96, s61, 16
    s_bitcmp1_b32 s40, 0
    s_cselect_b32 s96, s96, 0x40000000
    buffer_load_dwordx4 v12, s[48:51], s61 offen lds
    buffer_load_dwordx4 v12, s[48:51], s61 offen offset:1024 lds
    s_sub_u32 m0, s60, 16
    s_mov_b64 exec, 1
    buffer_load_dwordx4 v12, s[48:51], s96 offen lds
    s_mov_b64 exec, -1
    s_waitcnt vmcnt(3)
    s_barrier
    s_cmp_ge_u32 s32, 4
    s_cbranch_scc1 L_ansig
    s_mov_b32 exec_hi, 0
    s_mov_b32 exec_lo, s97
    global_atomic_swap v4, v5, s[28:29] sc1
    s_mov_b64 exec, -1
L_ansig:
    s_waitcnt vmcnt(0)
    v_subrev_u32 v4, 4, v156
    ds_read_b32 v21, v4 offset:0
    ds_read_b128 v[22:25], v156 offset:0
    ds_read_b32 v29, v4 offset:1024
    ds_read_b128 v[30:33], v156 offset:1024
    s_waitcnt lgkmcnt(0)
    v_alignbit_b32 v40, v22, v21, 16
    v_alignbit_b32 v41, v23, v22, 16
    v_alignbit_b32 v42, v24, v23, 16
    v_alignbit_b32 v43, v25, v24, 16
    ds_write_b128 v156, v[40:43] offset:4160
    v_alignbit_b32 v44, v30, v29, 16
    v_alignbit_b32 v45, v31, v30, 16
    v_alignbit_b32 v46, v32, v31, 16
    v_alignbit_b32 v47, v33, v32, 16
    ds_write_b128 v156, v[44:47] offset:5184
    s_waitcnt lgkmcnt(0)
    s_mov_b32 s52, s32
    s_cmp_lg_u32 s52, 0
    s_cbranch_scc1 Lud_25
    s_mov_b32 s100, 0
Lup_24:
    s_load_dwordx16 s[64:79], s[56:57], 0 glc
    s_load_dwordx16 s[4:19], s[56:57], 64 glc
    s_waitcnt lgkmcnt(0)
    s_xor_b64 s[64:65], s[64:65], s[58:59]
    s_xor_b64 s[4:5], s[4:5], s[58:59]
    s_or_b64 s[64:65], s[64:65], s[4:5]
    s_xor_b64 s[66:67], s[66:67], s[58:59]
    s_xor_b64 s[6:7], s[6:7], s[58:59]
    s_or_b64 s[64:65], s[64:65], s[66:67]
    s_or_b64 s[64:65], s[64:65], s[6:7]
    s_xor_b64 s[68:69], s[68:69], s[58:59]
    s_xor_b64 s[8:9], s[8:9], s[58:59]
    s_or_b64 s[64:65], s[64:65], s[68:69]
    s_or_b64 s[64:65], s[64:65], s[8:9]
    s_xor_b64 s[70:71], s[70:71], s[58:59]
    s_xor_b64 s[10:11], s[10:11], s[58:59]
    s_or_b64 s[64:65], s[64:65], s[70:71]
    s_or_b64 s[64:65], s[64:65], s[10:11]
    s_xor_b64 s[72:73], s[72:73], s[58:59]
    s_xor_b64 s[12:13], s[12:13], s[58:59]
    s_or_b64 s[64:65], s[64:65], s[72:73]
    s_or_b64 s[64:65], s[64:65], s[12:13]
    s_xor_b64 s[74:75], s[74:75], s[58:59]
    s_xor_b64 s[14:15], s[14:15], s[58:59]
    s_or_b64 s[64:65], s[64:65], s[74:75]
    s_or_b64 s[64:65], s[64:65], s[14:15]
    s_xor_b64 s[76:77], s[76:77], s[58:59]
    s_xor_b64 s[16:17], s[16:17], s[58:59]
    s_or_b64 s[64:65], s[64:65], s[76:77]
    s_or_b64 s[64:65], s[64:65], s[16:17]
    s_xor_b64 s[78:79], s[78:79], s[58:59]
    s_xor_b64 s[18:19], s[18:19], s[58:59]
    s_or_b64 s[64:65], s[64:65], s[78:79]
    s_or_b64 s[64:65], s[64:65], s[18:19]
    s_cbranch_scc0 Lug_26
    s_add_u32 s100, s100, 1
    s_cmp_lt_u32 s100, 1048576
    s_cbranch_scc1 Lup_24
Lug_26:
    s_mov_b32 s52, -1
Lud_25:
    s_lshl_b32 s97, s40, 11
    s_add_u32 s98, s41, s97
    s_add_u32 m0, s98, 33536
    s_lshl_b32 s96, s43, 13
    s_add_u32 s96, s96, s97
    s_add_u32 s96, s96, 1048576
    s_barrier
    buffer_load_dwordx4 v12, s[44:47], s96 offen offset:0 sc1 lds
    buffer_load_dwordx4 v12, s[44:47], s96 offen offset:1024 sc1 lds
    ds_read2_b32 v[48:49], v148 offset0:0 offset1:1
    ds_read2_b32 v[50:51], v148 offset0:2 offset1:3
    ds_read2_b32 v[52:53], v148 offset0:128 offset1:129
    ds_read2_b32 v[54:55], v148 offset0:130 offset1:131
    ds_read2_b32 v[56:57], v149 offset0:0 offset1:1
    ds_read2_b32 v[58:59], v149 offset0:2 offset1:3
    ds_read2_b32 v[60:61], v149 offset0:128 offset1:129
    ds_read2_b32 v[62:63], v149 offset0:130 offset1:131
    ds_read2_b32 v[64:65], v150 offset0:0 offset1:1
    ds_read2_b32 v[66:67], v150 offset0:2 offset1:3
    ds_read2_b32 v[68:69], v150 offset0:128 offset1:129
    ds_read2_b32 v[70:71], v150 offset0:130 offset1:131
    s_waitcnt lgkmcnt(6)
    ds_read2_b32 v[72:73], v151 offset0:0 offset1:1
    ds_read2_b32 v[74:75], v151 offset0:2 offset1:3
    ds_read2_b32 v[76:77], v151 offset0:128 offset1:129
    ds_read2_b32 v[78:79], v151 offset0:130 offset1:131
    s_waitcnt vmcnt(0) lgkmcnt(0)
    s_barrier
    s_cmp_lt_u32 s32, 8
    s_cbranch_scc1 L_conv
    s_lshl2_add_u32 s96, s63, s40
    s_mul_i32 s96, s96, 14336
    s_add_u32 s96, s96, 786432
    v_lshlrev_b32 v4, 7, v0
    s_add_u32 s97, s96, 8192
    buffer_load_dword v160, v4, s[48:51], s96 offen
    s_mov_b32 exec_hi, 0xffff
    buffer_load_dword v160, v4, s[48:51], s97 offen
    s_mov_b32 exec_hi, -1
L_conv:
    s_setprio 0
    s_waitcnt lgkmcnt(13)
    ds_read_b128 v[108:111], v152 offset:0
    ds_read_b128 v[104:107], v152 offset:1024
    s_waitcnt lgkmcnt(13)
    ds_read_b128 v[100:103], v152 offset:2048
    ds_read_b128 v[96:99], v152 offset:3072
    s_waitcnt lgkmcnt(13)
    ds_read_b128 v[92:95], v152 offset:4096
    ds_read_b128 v[88:91], v152 offset:5120
    s_waitcnt lgkmcnt(13)
    ds_read_b128 v[84:87], v152 offset:6144
    ds_read_b128 v[80:83], v152 offset:7168
    s_waitcnt lgkmcnt(7)
    v_mfma_f32_16x16x32_bf16 v[44:47], v[144:147], v[108:111], 0
    s_waitcnt lgkmcnt(6)
    v_mfma_f32_16x16x32_bf16 v[40:43], v[144:147], v[104:107], 0
    s_waitcnt lgkmcnt(5)
    v_mfma_f32_16x16x32_bf16 v[36:39], v[144:147], v[100:103], 0
    s_waitcnt lgkmcnt(4)
    v_mfma_f32_16x16x32_bf16 v[32:35], v[144:147], v[96:99], 0
    s_waitcnt lgkmcnt(3)
    v_mfma_f32_16x16x32_bf16 v[28:31], v[144:147], v[92:95], 0
    s_waitcnt lgkmcnt(2)
    v_mfma_f32_16x16x32_bf16 v[24:27], v[144:147], v[88:91], 0
    s_waitcnt lgkmcnt(1)
    v_mfma_f32_16x16x32_bf16 v[20:23], v[144:147], v[84:87], 0
    s_waitcnt lgkmcnt(0)
    v_mfma_f32_16x16x32_bf16 v[16:19], v[144:147], v[80:83], 0
    v_mfma_f32_16x16x32_bf16 v[44:47], v[48:51], v[108:111], v[44:47]
    v_mfma_f32_16x16x32_bf16 v[40:43], v[48:51], v[104:107], v[40:43]
    ds_read_b128 v[140:143], v153 offset:0
    v_mfma_f32_16x16x32_bf16 v[36:39], v[48:51], v[100:103], v[36:39]
    v_mfma_f32_16x16x32_bf16 v[32:35], v[48:51], v[96:99], v[32:35]
    ds_read_b128 v[136:139], v153 offset:1024
    v_mfma_f32_16x16x32_bf16 v[28:31], v[48:51], v[92:95], v[28:31]
    v_mfma_f32_16x16x32_bf16 v[24:27], v[48:51], v[88:91], v[24:27]
    ds_read_b128 v[132:135], v153 offset:2048
    v_mfma_f32_16x16x32_bf16 v[20:23], v[48:51], v[84:87], v[20:23]
    v_mfma_f32_16x16x32_bf16 v[16:19], v[48:51], v[80:83], v[16:19]
    ds_read_b128 v[128:131], v153 offset:3072
    v_mfma_f32_16x16x32_bf16 v[44:47], v[52:55], v[104:107], v[44:47]
    v_mfma_f32_16x16x32_bf16 v[40:43], v[52:55], v[100:103], v[40:43]
    ds_read2_b32 v[48:49], v148 offset0:16 offset1:17
    v_mfma_f32_16x16x32_bf16 v[36:39], v[52:55], v[96:99], v[36:39]
    v_mfma_f32_16x16x32_bf16 v[32:35], v[52:55], v[92:95], v[32:35]
    ds_read2_b32 v[50:51], v148 offset0:18 offset1:19
    v_mfma_f32_16x16x32_bf16 v[28:31], v[52:55], v[88:91], v[28:31]
    v_mfma_f32_16x16x32_bf16 v[24:27], v[52:55], v[84:87], v[24:27]
    ds_read_b128 v[124:127], v153 offset:4096
    v_mfma_f32_16x16x32_bf16 v[20:23], v[52:55], v[80:83], v[20:23]
    v_mfma_f32_16x16x32_bf16 v[44:47], v[56:59], v[100:103], v[44:47]
    v_mfma_f32_16x16x32_bf16 v[40:43], v[56:59], v[96:99], v[40:43]
    ds_read2_b32 v[52:53], v148 offset0:144 offset1:145
    v_mfma_f32_16x16x32_bf16 v[36:39], v[56:59], v[92:95], v[36:39]
    v_mfma_f32_16x16x32_bf16 v[32:35], v[56:59], v[88:91], v[32:35]
    ds_read2_b32 v[54:55], v148 offset0:146 offset1:147
    v_mfma_f32_16x16x32_bf16 v[28:31], v[56:59], v[84:87], v[28:31]
    v_mfma_f32_16x16x32_bf16 v[24:27], v[56:59], v[80:83], v[24:27]
    ds_read_b128 v[120:123], v153 offset:5120
    v_mfma_f32_16x16x32_bf16 v[44:47], v[60:63], v[96:99], v[44:47]
    v_mfma_f32_16x16x32_bf16 v[40:43], v[60:63], v[92:95], v[40:43]
    ds_read2_b32 v[56:57], v149 offset0:16 offset1:17
    v_mfma_f32_16x16x32_bf16 v[36:39], v[60:63], v[88:91], v[36:39]
    v_mfma_f32_16x16x32_bf16 v[32:35], v[60:63], v[84:87], v[32:35]
    ds_read2_b32 v[58:59], v149 offset0:18 offset1:19
    v_mfma_f32_16x16x32_bf16 v[28:31], v[60:63], v[80:83], v[28:31]
    v_mfma_f32_16x16x32_bf16 v[44:47], v[64:67], v[92:95], v[44:47]
    ds_read2_b32 v[60:61], v149 offset0:144 offset1:145
    v_mfma_f32_16x16x32_bf16 v[40:43], v[64:67], v[88:91], v[40:43]
    ds_read2_b32 v[62:63], v149 offset0:146 offset1:147
    v_mfma_f32_16x16x32_bf16 v[36:39], v[64:67], v[84:87], v[36:39]
    ds_read_b128 v[116:119], v153 offset:6144
    v_mfma_f32_16x16x32_bf16 v[32:35], v[64:67], v[80:83], v[32:35]
    s_waitcnt lgkmcnt(13)
    ds_read_b128 v[112:115], v153 offset:7168
    v_mfma_f32_16x16x32_bf16 v[44:47], v[68:71], v[88:91], v[44:47]
    ds_read2_b32 v[64:65], v150 offset0:16 offset1:17
    v_mfma_f32_16x16x32_bf16 v[40:43], v[68:71], v[84:87], v[40:43]
    s_waitcnt lgkmcnt(13)
    ds_read2_b32 v[66:67], v150 offset0:18 offset1:19
    v_mfma_f32_16x16x32_bf16 v[36:39], v[68:71], v[80:83], v[36:39]
    v_mfma_f32_16x16x32_bf16 v[44:47], v[72:75], v[84:87], v[44:47]
    ds_read2_b32 v[68:69], v150 offset0:144 offset1:145
    v_mfma_f32_16x16x32_bf16 v[40:43], v[72:75], v[80:83], v[40:43]
    s_waitcnt lgkmcnt(13)
    ds_read2_b32 v[70:71], v150 offset0:146 offset1:147
    v_mfma_f32_16x16x32_bf16 v[44:47], v[76:79], v[80:83], v[44:47]
    ds_read2_b32 v[72:73], v151 offset0:16 offset1:17
    s_waitcnt lgkmcnt(13)
    ds_read2_b32 v[76:77], v151 offset0:144 offset1:145
    ds_read2_b32 v[78:79], v151 offset0:146 offset1:147
    s_waitcnt lgkmcnt(13)
    ds_read2_b32 v[74:75], v151 offset0:18 offset1:19
    v_mfma_f32_16x16x32_bf16 v[44:47], v[48:51], v[140:143], v[44:47]
    v_mfma_f32_16x16x32_bf16 v[40:43], v[48:51], v[136:139], v[40:43]
    ds_read_b128 v[108:111], v154 offset:256
    v_mfma_f32_16x16x32_bf16 v[36:39], v[48:51], v[132:135], v[36:39]
    v_mfma_f32_16x16x32_bf16 v[32:35], v[48:51], v[128:131], v[32:35]
    s_waitcnt lgkmcnt(13)
    ds_read_b128 v[104:107], v154 offset:1280
    v_mfma_f32_16x16x32_bf16 v[28:31], v[48:51], v[124:127], v[28:31]
    v_mfma_f32_16x16x32_bf16 v[24:27], v[48:51], v[120:123], v[24:27]
    ds_read_b128 v[100:103], v154 offset:2304
    s_waitcnt lgkmcnt(12)
    v_mfma_f32_16x16x32_bf16 v[20:23], v[48:51], v[116:119], v[20:23]
    s_waitcnt lgkmcnt(11)
    v_mfma_f32_16x16x32_bf16 v[16:19], v[48:51], v[112:115], v[16:19]
    ds_read_b128 v[96:99], v154 offset:3328
    v_mfma_f32_16x16x32_bf16 v[44:47], v[52:55], v[136:139], v[44:47]
    v_mfma_f32_16x16x32_bf16 v[40:43], v[52:55], v[132:135], v[40:43]
    ds_read2_b32 v[48:49], v148 offset0:32 offset1:33
    v_mfma_f32_16x16x32_bf16 v[36:39], v[52:55], v[128:131], v[36:39]
    v_mfma_f32_16x16x32_bf16 v[32:35], v[52:55], v[124:127], v[32:35]
    ds_read2_b32 v[50:51], v148 offset0:34 offset1:35
    v_mfma_f32_16x16x32_bf16 v[28:31], v[52:55], v[120:123], v[28:31]
    v_mfma_f32_16x16x32_bf16 v[24:27], v[52:55], v[116:119], v[24:27]
    ds_read_b128 v[92:95], v154 offset:4352
    v_mfma_f32_16x16x32_bf16 v[20:23], v[52:55], v[112:115], v[20:23]
    v_mfma_f32_16x16x32_bf16 v[44:47], v[56:59], v[132:135], v[44:47]
    v_mfma_f32_16x16x32_bf16 v[40:43], v[56:59], v[128:131], v[40:43]
    s_waitcnt lgkmcnt(13)
    ds_read2_b32 v[52:53], v148 offset0:160 offset1:161
    v_mfma_f32_16x16x32_bf16 v[36:39], v[56:59], v[124:127], v[36:39]
    v_mfma_f32_16x16x32_bf16 v[32:35], v[56:59], v[120:123], v[32:35]
    ds_read2_b32 v[54:55], v148 offset0:162 offset1:163
    v_mfma_f32_16x16x32_bf16 v[28:31], v[56:59], v[116:119], v[28:31]
    v_mfma_f32_16x16x32_bf16 v[24:27], v[56:59], v[112:115], v[24:27]
    s_waitcnt lgkmcnt(13)
    ds_read_b128 v[88:91], v154 offset:5376
    v_mfma_f32_16x16x32_bf16 v[44:47], v[60:63], v[128:131], v[44:47]
    v_mfma_f32_16x16x32_bf16 v[40:43], v[60:63], v[124:127], v[40:43]
    ds_read2_b32 v[56:57], v149 offset0:32 offset1:33
    v_mfma_f32_16x16x32_bf16 v[36:39], v[60:63], v[120:123], v[36:39]
    v_mfma_f32_16x16x32_bf16 v[32:35], v[60:63], v[116:119], v[32:35]
    s_waitcnt lgkmcnt(13)
    ds_read2_b32 v[58:59], v149 offset0:34 offset1:35
    v_mfma_f32_16x16x32_bf16 v[28:31], v[60:63], v[112:115], v[28:31]
    v_mfma_f32_16x16x32_bf16 v[44:47], v[64:67], v[124:127], v[44:47]
    ds_read2_b32 v[60:61], v149 offset0:160 offset1:161
    v_mfma_f32_16x16x32_bf16 v[40:43], v[64:67], v[120:123], v[40:43]
    s_waitcnt lgkmcnt(13)
    ds_read2_b32 v[62:63], v149 offset0:162 offset1:163
    v_mfma_f32_16x16x32_bf16 v[36:39], v[64:67], v[116:119], v[36:39]
    ds_read_b128 v[84:87], v154 offset:6400
    v_mfma_f32_16x16x32_bf16 v[32:35], v[64:67], v[112:115], v[32:35]
    s_waitcnt lgkmcnt(13)
    ds_read_b128 v[80:83], v154 offset:7424
    v_mfma_f32_16x16x32_bf16 v[44:47], v[68:71], v[120:123], v[44:47]
    ds_read2_b32 v[64:65], v150 offset0:32 offset1:33
    v_mfma_f32_16x16x32_bf16 v[40:43], v[68:71], v[116:119], v[40:43]
    s_waitcnt lgkmcnt(13)
    ds_read2_b32 v[66:67], v150 offset0:34 offset1:35
    v_mfma_f32_16x16x32_bf16 v[36:39], v[68:71], v[112:115], v[36:39]
    v_mfma_f32_16x16x32_bf16 v[44:47], v[72:75], v[116:119], v[44:47]
    ds_read2_b32 v[68:69], v150 offset0:160 offset1:161
    v_mfma_f32_16x16x32_bf16 v[40:43], v[72:75], v[112:115], v[40:43]
    s_waitcnt lgkmcnt(13)
    ds_read2_b32 v[70:71], v150 offset0:162 offset1:163
    v_mfma_f32_16x16x32_bf16 v[44:47], v[76:79], v[112:115], v[44:47]
    ds_read2_b32 v[72:73], v151 offset0:32 offset1:33
    s_waitcnt lgkmcnt(13)
    ds_read2_b32 v[76:77], v151 offset0:160 offset1:161
    ds_read2_b32 v[78:79], v151 offset0:162 offset1:163
    s_waitcnt lgkmcnt(13)
    ds_read2_b32 v[74:75], v151 offset0:34 offset1:35
    v_mfma_f32_16x16x32_bf16 v[44:47], v[48:51], v[108:111], v[44:47]
    v_mfma_f32_16x16x32_bf16 v[40:43], v[48:51], v[104:107], v[40:43]
    ds_read_b128 v[140:143], v155 offset:256
    v_mfma_f32_16x16x32_bf16 v[36:39], v[48:51], v[100:103], v[36:39]
    v_mfma_f32_16x16x32_bf16 v[32:35], v[48:51], v[96:99], v[32:35]
    s_waitcnt lgkmcnt(13)
    ds_read_b128 v[136:139], v155 offset:1280
    v_mfma_f32_16x16x32_bf16 v[28:31], v[48:51], v[92:95], v[28:31]
    v_mfma_f32_16x16x32_bf16 v[24:27], v[48:51], v[88:91], v[24:27]
    ds_read_b128 v[132:135], v155 offset:2304
    s_waitcnt lgkmcnt(12)
    v_mfma_f32_16x16x32_bf16 v[20:23], v[48:51], v[84:87], v[20:23]
    s_waitcnt lgkmcnt(11)
    v_mfma_f32_16x16x32_bf16 v[16:19], v[48:51], v[80:83], v[16:19]
    ds_read_b128 v[128:131], v155 offset:3328
    v_mfma_f32_16x16x32_bf16 v[44:47], v[52:55], v[104:107], v[44:47]
    v_mfma_f32_16x16x32_bf16 v[40:43], v[52:55], v[100:103], v[40:43]
    ds_read2_b32 v[48:49], v148 offset0:48 offset1:49
    v_mfma_f32_16x16x32_bf16 v[36:39], v[52:55], v[96:99], v[36:39]
    v_mfma_f32_16x16x32_bf16 v[32:35], v[52:55], v[92:95], v[32:35]
    ds_read2_b32 v[50:51], v148 offset0:50 offset1:51
    v_mfma_f32_16x16x32_bf16 v[28:31], v[52:55], v[88:91], v[28:31]
    v_mfma_f32_16x16x32_bf16 v[24:27], v[52:55], v[84:87], v[24:27]
    ds_read_b128 v[124:127], v155 offset:4352
    v_mfma_f32_16x16x32_bf16 v[20:23], v[52:55], v[80:83], v[20:23]
    v_mfma_f32_16x16x32_bf16 v[44:47], v[56:59], v[100:103], v[44:47]
    v_mfma_f32_16x16x32_bf16 v[40:43], v[56:59], v[96:99], v[40:43]
    s_waitcnt lgkmcnt(13)
    ds_read2_b32 v[52:53], v148 offset0:176 offset1:177
    v_mfma_f32_16x16x32_bf16 v[36:39], v[56:59], v[92:95], v[36:39]
    v_mfma_f32_16x16x32_bf16 v[32:35], v[56:59], v[88:91], v[32:35]
    ds_read2_b32 v[54:55], v148 offset0:178 offset1:179
    v_mfma_f32_16x16x32_bf16 v[28:31], v[56:59], v[84:87], v[28:31]
    v_mfma_f32_16x16x32_bf16 v[24:27], v[56:59], v[80:83], v[24:27]
    s_waitcnt lgkmcnt(13)
    ds_read_b128 v[120:123], v155 offset:5376
    v_mfma_f32_16x16x32_bf16 v[44:47], v[60:63], v[96:99], v[44:47]
    v_mfma_f32_16x16x32_bf16 v[40:43], v[60:63], v[92:95], v[40:43]
    ds_read2_b32 v[56:57], v149 offset0:48 offset1:49
    v_mfma_f32_16x16x32_bf16 v[36:39], v[60:63], v[88:91], v[36:39]
    v_mfma_f32_16x16x32_bf16 v[32:35], v[60:63], v[84:87], v[32:35]
    s_waitcnt lgkmcnt(13)
    ds_read2_b32 v[58:59], v149 offset0:50 offset1:51
    v_mfma_f32_16x16x32_bf16 v[28:31], v[60:63], v[80:83], v[28:31]
    v_mfma_f32_16x16x32_bf16 v[44:47], v[64:67], v[92:95], v[44:47]
    ds_read2_b32 v[60:61], v149 offset0:176 offset1:177
    v_mfma_f32_16x16x32_bf16 v[40:43], v[64:67], v[88:91], v[40:43]
    s_waitcnt lgkmcnt(13)
    ds_read2_b32 v[62:63], v149 offset0:178 offset1:179
    v_mfma_f32_16x16x32_bf16 v[36:39], v[64:67], v[84:87], v[36:39]
    ds_read_b128 v[116:119], v155 offset:6400
    v_mfma_f32_16x16x32_bf16 v[32:35], v[64:67], v[80:83], v[32:35]
    s_waitcnt lgkmcnt(13)
    ds_read_b128 v[112:115], v155 offset:7424
    v_mfma_f32_16x16x32_bf16 v[44:47], v[68:71], v[88:91], v[44:47]
    ds_read2_b32 v[64:65], v150 offset0:48 offset1:49
    v_mfma_f32_16x16x32_bf16 v[40:43], v[68:71], v[84:87], v[40:43]
    s_waitcnt lgkmcnt(13)
    ds_read2_b32 v[66:67], v150 offset0:50 offset1:51
    v_mfma_f32_16x16x32_bf16 v[36:39], v[68:71], v[80:83], v[36:39]
    v_mfma_f32_16x16x32_bf16 v[44:47], v[72:75], v[84:87], v[44:47]
    ds_read2_b32 v[68:69], v150 offset0:176 offset1:177
    v_mfma_f32_16x16x32_bf16 v[40:43], v[72:75], v[80:83], v[40:43]
    s_waitcnt lgkmcnt(13)
    ds_read2_b32 v[70:71], v150 offset0:178 offset1:179
    v_mfma_f32_16x16x32_bf16 v[44:47], v[76:79], v[80:83], v[44:47]
    ds_read2_b32 v[72:73], v151 offset0:48 offset1:49
    s_waitcnt lgkmcnt(13)
    ds_read2_b32 v[76:77], v151 offset0:176 offset1:177
    ds_read2_b32 v[78:79], v151 offset0:178 offset1:179
    s_waitcnt lgkmcnt(13)
    ds_read2_b32 v[74:75], v151 offset0:50 offset1:51
    v_mfma_f32_16x16x32_bf16 v[44:47], v[48:51], v[140:143], v[44:47]
    v_mfma_f32_16x16x32_bf16 v[40:43], v[48:51], v[136:139], v[40:43]
    v_mfma_f32_16x16x32_bf16 v[36:39], v[48:51], v[132:135], v[36:39]
    v_mfma_f32_16x16x32_bf16 v[32:35], v[48:51], v[128:131], v[32:35]
    v_mfma_f32_16x16x32_bf16 v[28:31], v[48:51], v[124:127], v[28:31]
    v_mfma_f32_16x16x32_bf16 v[24:27], v[48:51], v[120:123], v[24:27]
    s_waitcnt lgkmcnt(9)
    v_mfma_f32_16x16x32_bf16 v[20:23], v[48:51], v[116:119], v[20:23]
    s_waitcnt lgkmcnt(8)
    v_mfma_f32_16x16x32_bf16 v[16:19], v[48:51], v[112:115], v[16:19]
    v_mfma_f32_16x16x32_bf16 v[44:47], v[52:55], v[136:139], v[44:47]
    v_mfma_f32_16x16x32_bf16 v[40:43], v[52:55], v[132:135], v[40:43]
    v_mfma_f32_16x16x32_bf16 v[36:39], v[52:55], v[128:131], v[36:39]
    v_mfma_f32_16x16x32_bf16 v[32:35], v[52:55], v[124:127], v[32:35]
    v_mfma_f32_16x16x32_bf16 v[28:31], v[52:55], v[120:123], v[28:31]
    v_mfma_f32_16x16x32_bf16 v[24:27], v[52:55], v[116:119], v[24:27]
    v_mfma_f32_16x16x32_bf16 v[20:23], v[52:55], v[112:115], v[20:23]
    v_mfma_f32_16x16x32_bf16 v[44:47], v[56:59], v[132:135], v[44:47]
    v_mfma_f32_16x16x32_bf16 v[40:43], v[56:59], v[128:131], v[40:43]
    v_mfma_f32_16x16x32_bf16 v[36:39], v[56:59], v[124:127], v[36:39]
    v_mfma_f32_16x16x32_bf16 v[32:35], v[56:59], v[120:123], v[32:35]
    v_mfma_f32_16x16x32_bf16 v[28:31], v[56:59], v[116:119], v[28:31]
    v_mfma_f32_16x16x32_bf16 v[24:27], v[56:59], v[112:115], v[24:27]
    v_mfma_f32_16x16x32_bf16 v[44:47], v[60:63], v[128:131], v[44:47]
    v_mfma_f32_16x16x32_bf16 v[40:43], v[60:63], v[124:127], v[40:43]
    v_mfma_f32_16x16x32_bf16 v[36:39], v[60:63], v[120:123], v[36:39]
    v_mfma_f32_16x16x32_bf16 v[32:35], v[60:63], v[116:119], v[32:35]
    v_mfma_f32_16x16x32_bf16 v[28:31], v[60:63], v[112:115], v[28:31]
    s_waitcnt lgkmcnt(6)
    v_mfma_f32_16x16x32_bf16 v[44:47], v[64:67], v[124:127], v[44:47]
    v_mfma_f32_16x16x32_bf16 v[40:43], v[64:67], v[120:123], v[40:43]
    v_mfma_f32_16x16x32_bf16 v[36:39], v[64:67], v[116:119], v[36:39]
    v_mfma_f32_16x16x32_bf16 v[32:35], v[64:67], v[112:115], v[32:35]
    s_waitcnt lgkmcnt(4)
    v_mfma_f32_16x16x32_bf16 v[44:47], v[68:71], v[120:123], v[44:47]
    v_mfma_f32_16x16x32_bf16 v[40:43], v[68:71], v[116:119], v[40:43]
    v_mfma_f32_16x16x32_bf16 v[36:39], v[68:71], v[112:115], v[36:39]
    s_waitcnt lgkmcnt(0)
    v_mfma_f32_16x16x32_bf16 v[44:47], v[72:75], v[116:119], v[44:47]
    v_mfma_f32_16x16x32_bf16 v[40:43], v[72:75], v[112:115], v[40:43]
    v_mfma_f32_16x16x32_bf16 v[44:47], v[76:79], v[112:115], v[44:47]
    s_setprio 3
    s_lshl_b32 s96, s40, 2
    v_add_u32 v5, s96, v3
    v_xor_b32 v6, 4, v5
    s_cmp_lg_u32 s35, 0
    s_cbranch_scc1 L_mrgok
    s_and_b32 s96, s36, 3
    s_cselect_b32 s96, 4, 6
    s_mov_b32 s100, 0
Lw_27:
    ds_read_b32 v4, v3 offset:64
    s_waitcnt lgkmcnt(0)
    v_readfirstlane_b32 s99, v4
    s_cmp_ge_u32 s99, s96
    s_cbranch_scc1 Lwd_28
    s_add_u32 s100, s100, 1
    s_cmp_lt_u32 s100, 8388608
    s_cbranch_scc1 Lw_27
Lwd_28:
L_mrgok:
    v_mov_b32 v7, 1
    s_bitcmp1_b32 s40, 0
    s_cbranch_scc1 L_mrg1
    ds_write_b128 v158, v[32:35] offset:0
    ds_write_b128 v158, v[36:39] offset:1024
    ds_write_b128 v158, v[40:43] offset:2048
    ds_write_b128 v158, v[44:47] offset:3072
    ds_write_b32 v5, v7 offset:8
    s_mov_b32 s100, 0
Lw_29:
    ds_read_b32 v4, v6 offset:8
    s_waitcnt lgkmcnt(0)
    v_readfirstlane_b32 s99, v4
    s_cmp_ge_u32 s99, 1
    s_cbranch_scc1 Lwd_30
    s_add_u32 s100, s100, 1
    s_cmp_lt_u32 s100, 8388608
    s_cbranch_scc1 Lw_29
Lwd_30:
    ds_read_b128 v[48:51], v159 offset:0
    ds_read_b128 v[52:55], v159 offset:1024
    ds_read_b128 v[56:59], v159 offset:2048
    ds_read_b128 v[60:63], v159 offset:3072
    s_waitcnt lgkmcnt(2)
    v_add_f32 v16, v16, v48
    v_add_f32 v17, v17, v49
    v_add_f32 v18, v18, v50
    v_add_f32 v19, v19, v51
    v_add_f32 v20, v20, v52
    v_add_f32 v21, v21, v53
    v_add_f32 v22, v22, v54
    v_add_f32 v23, v23, v55
    v_cvt_pk_bf16_f32 v80, v16, v17
    v_cvt_pk_bf16_f32 v81, v18, v19
    v_cvt_pk_bf16_f32 v82, v20, v21
    v_cvt_pk_bf16_f32 v83, v22, v23
    s_nop 0
    v_permlane16_swap_b32 v80, v82
    v_permlane16_swap_b32 v81, v83
    buffer_store_dwordx4 v[80:83], v157, s[44:47], 0 offen offset:0 sc1
    s_waitcnt lgkmcnt(0)
    v_add_f32 v24, v24, v56
    v_add_f32 v25, v25, v57
    v_add_f32 v26, v26, v58
    v_add_f32 v27, v27, v59
    v_add_f32 v28, v28, v60
    v_add_f32 v29, v29, v61
    v_add_f32 v30, v30, v62
    v_add_f32 v31, v31, v63
    v_cvt_pk_bf16_f32 v84, v24, v25
    v_cvt_pk_bf16_f32 v85, v26, v27
    v_cvt_pk_bf16_f32 v86, v28, v29
    v_cvt_pk_bf16_f32 v87, v30, v31
    s_nop 0
    v_permlane16_swap_b32 v84, v86
    v_permlane16_swap_b32 v85, v87
    buffer_store_dwordx4 v[84:87], v157, s[44:47], 0 offen offset:1024 sc1
    s_branch L_mrgd
L_mrg1:
    ds_write_b128 v158, v[16:19] offset:0
    ds_write_b128 v158, v[20:23] offset:1024
    ds_write_b128 v158, v[24:27] offset:2048
    ds_write_b128 v158, v[28:31] offset:3072
    ds_write_b32 v5, v7 offset:8
    s_mov_b32 s100, 0
Lw_31:
    ds_read_b32 v4, v6 offset:8
    s_waitcnt lgkmcnt(0)
    v_readfirstlane_b32 s99, v4
    s_cmp_ge_u32 s99, 1
    s_cbranch_scc1 Lwd_32
    s_add_u32 s100, s100, 1
    s_cmp_lt_u32 s100, 8388608
    s_cbranch_scc1 Lw_31
Lwd_32:
    ds_read_b128 v[48:51], v159 offset:0
    ds_read_b128 v[52:55], v159 offset:1024
    ds_read_b128 v[56:59], v159 offset:2048
    ds_read_b128 v[60:63], v159 offset:3072
    s_waitcnt lgkmcnt(2)
    v_add_f32 v32, v32, v48
    v_add_f32 v33, v33, v49
    v_add_f32 v34, v34, v50
    v_add_f32 v35, v35, v51
    v_add_f32 v36, v36, v52
    v_add_f32 v37, v37, v53
    v_add_f32 v38, v38, v54
    v_add_f32 v39, v39, v55
    v_cvt_pk_bf16_f32 v80, v32, v33
    v_cvt_pk_bf16_f32 v81, v34, v35
    v_cvt_pk_bf16_f32 v82, v36, v37
    v_cvt_pk_bf16_f32 v83, v38, v39
    s_nop 0
    v_permlane16_swap_b32 v80, v82
    v_permlane16_swap_b32 v81, v83
    buffer_store_dwordx4 v[80:83], v157, s[44:47], 0 offen offset:0 sc1
    s_waitcnt lgkmcnt(0)
    v_add_f32 v40, v40, v56
    v_add_f32 v41, v41, v57
    v_add_f32 v42, v42, v58
    v_add_f32 v43, v43, v59
    v_add_f32 v44, v44, v60
    v_add_f32 v45, v45, v61
    v_add_f32 v46, v46, v62
    v_add_f32 v47, v47, v63
    v_cvt_pk_bf16_f32 v84, v40, v41
    v_cvt_pk_bf16_f32 v85, v42, v43
    v_cvt_pk_bf16_f32 v86, v44, v45
    v_cvt_pk_bf16_f32 v87, v46, v47
    s_nop 0
    v_permlane16_swap_b32 v84, v86
    v_permlane16_swap_b32 v85, v87
    buffer_store_dwordx4 v[84:87], v157, s[44:47], 0 offen offset:1024 sc1
L_mrgd:
    s_lshl_b32 s97, s55, 16
    s_lshr_b32 s96, s63, 3
    s_lshl_b32 s96, s96, 7
    s_add_u32 s97, s97, s96
    s_and_b32 s96, s63, 7
    s_lshl3_add_u32 s97, s96, s97
    s_add_u32 s97, s97, 262144
    v_lshl_add_u32 v5, v0, 11, s97
    v_mov_b32 v6, s33
    s_waitcnt vmcnt(0)
    v_mov_b32 v4, 1
    s_mov_b64 exec, 1
    ds_add_rtn_u32 v4, v3, v4 offset:28
    s_waitcnt lgkmcnt(0)
    v_readfirstlane_b32 s98, v4
    s_mov_b64 exec, -1
    s_cmp_lg_u32 s98, 3
    s_cbranch_scc1 L_ynosig
    s_mov_b64 exec, 0x3fffff
    global_atomic_swap v5, v6, s[28:29] sc1
    s_mov_b64 exec, -1
L_ynosig:
    s_and_b32 s96, s63, 7
    s_or_b32 s96, s96, s40
    s_cbranch_scc1 L_noep
    s_mov_b32 s96, 1
    s_atomic_add s96, s[26:27], 0 glc
    s_waitcnt lgkmcnt(0)
    s_cmp_lg_u32 s96, 39
    s_cbranch_scc1 Lep_33
    s_atomic_swap s33, s[28:29], 0
Lep_33:
L_noep:
    s_cmp_lg_u32 s35, 0
    s_cbranch_scc1 L_cexit
    s_setprio 1
    v_lshlrev_b32 v20, 2, v1
    v_add_u32 v20, 161088, v20
    s_lshl_b32 s96, s40, 10
    s_add_u32 s96, s96, 133632
    v_add_u32 v21, s96, v12
    v_add_u32 v4, 0, v0
    v_mul_u32_u24 v5, 5462, v4
    v_lshrrev_b32 v5, 16, v5
    v_mul_u32_u24 v5, 3904, v5
    v_lshl_add_u32 v16, v4, 4, v5
    v_add_u32 v4, 64, v0
    v_mul_u32_u24 v5, 5462, v4
    v_lshrrev_b32 v5, 16, v5
    v_mul_u32_u24 v5, 3904, v5
    v_lshl_add_u32 v17, v4, 4, v5
    v_add_u32 v4, 128, v0
    v_mul_u32_u24 v5, 5462, v4
    v_lshrrev_b32 v5, 16, v5
    v_mul_u32_u24 v5, 3904, v5
    v_lshl_add_u32 v18, v4, 4, v5
    s_lshl2_add_u32 s66, s31, s40
    s_lshl_b32 s66, s66, 16
    s_mul_i32 s96, s30, 192
    s_add_u32 s66, s66, s96
    s_add_u32 s66, s66, 3670016
    s_lshl_b32 s96, s31, 5
    s_add_u32 s96, s96, s30
    s_lshl_b32 s96, s96, 11
    s_add_u32 s96, s96, 262144
    s_lshl_b32 s97, s40, 7
    s_add_u32 s96, s96, s97
    s_add_u32 s56, s28, s96
    s_addc_u32 s57, s29, 0
    s_lshr_b32 s96, s40, 1
    s_lshl_b32 s96, s96, 2
    v_add_u32 v22, s96, v3
    s_xor_b32 s96, s40, 1
    s_lshl_b32 s96, s96, 12
    s_add_u32 s67, s96, 116736
    v_lshrrev_b32 v4, 2, v0
    v_mul_u32_u24 v4, 192, v4
    v_and_b32 v5, 3, v0
    v_lshl_add_u32 v4, v5, 3, v4
    v_add_u32 v23, s67, v4
    s_mov_b32 s100, 0
Lw_34:
    ds_read_b32 v4, v3 offset:76
    s_waitcnt lgkmcnt(0)
    v_readfirstlane_b32 s99, v4
    s_cmp_ge_u32 s99, 1
    s_cbranch_scc1 Lwd_35
    s_sleep 1
    s_add_u32 s100, s100, 1
    s_cmp_lt_u32 s100, 8388608
    s_cbranch_scc1 Lw_34
Lwd_35:
    ds_read2_b32 v[32:33], v20 offset0:0 offset1:16
    ds_read2_b32 v[34:35], v20 offset0:32 offset1:48
    ds_read2_b32 v[36:37], v20 offset0:64 offset1:80
    s_mov_b32 s100, 0
Lw_36:
    ds_read_b32 v4, v3 offset:28
    s_waitcnt lgkmcnt(0)
    v_readfirstlane_b32 s99, v4
    s_cmp_ge_u32 s99, 4
    s_cbranch_scc1 Lwd_37
    s_add_u32 s100, s100, 1
    s_cmp_lt_u32 s100, 8388608
    s_cbranch_scc1 Lw_36
Lwd_37:
    v_lshlrev_b32 v40, 16, v8
    v_and_b32 v41, 0xffff0000, v8
    v_lshlrev_b32 v42, 16, v9
    v_and_b32 v43, 0xffff0000, v9
    v_mul_f32 v40, v32, v40
    v_mul_f32 v41, v32, v41
    v_mul_f32 v42, v32, v42
    v_mul_f32 v43, v32, v43
    v_lshlrev_b32 v44, 16, v10
    v_and_b32 v45, 0xffff0000, v10
    v_lshlrev_b32 v46, 16, v11
    v_and_b32 v47, 0xffff0000, v11
    v_mul_f32 v44, v33, v44
    v_mul_f32 v45, v33, v45
    v_mul_f32 v46, v33, v46
    v_mul_f32 v47, v33, v47
    v_lshlrev_b32 v48, 16, v14
    v_and_b32 v49, 0xffff0000, v14
    v_lshlrev_b32 v50, 16, v15
    v_and_b32 v51, 0xffff0000, v15
    v_mul_f32 v48, v34, v48
    v_mul_f32 v49, v34, v49
    v_mul_f32 v50, v34, v50
    v_mul_f32 v51, v34, v51
    v_lshlrev_b32 v52, 16, v160
    v_and_b32 v53, 0xffff0000, v160
    v_lshlrev_b32 v54, 16, v161
    v_and_b32 v55, 0xffff0000, v161
    v_mul_f32 v52, v35, v52
    v_mul_f32 v53, v35, v53
    v_mul_f32 v54, v35, v54
    v_mul_f32 v55, v35, v55
    v_lshlrev_b32 v56, 16, v162
    v_and_b32 v57, 0xffff0000, v162
    v_lshlrev_b32 v58, 16, v163
    v_and_b32 v59, 0xffff0000, v163
    v_mul_f32 v56, v36, v56
    v_mul_f32 v57, v36, v57
    v_mul_f32 v58, v36, v58
    v_mul_f32 v59, v36, v59
    v_lshlrev_b32 v60, 16, v164
    v_and_b32 v61, 0xffff0000, v164
    v_lshlrev_b32 v62, 16, v165
    v_and_b32 v63, 0xffff0000, v165
    v_mul_f32 v60, v37, v60
    v_mul_f32 v61, v37, v61
    v_mul_f32 v62, v37, v62
    v_mul_f32 v63, v37, v63
    s_mov_b32 m0, s67
    v_mov_b32 v4, 1
    s_setprio 3
    s_mov_b32 s100, 0
L_yp:
    s_add_u32 s100, s100, 1
    s_cmp_ge_u32 s100, 1048576
    s_cbranch_scc1 L_ypd
    s_load_dwordx16 s[4:19], s[56:57], 0 glc
    s_waitcnt lgkmcnt(0)
    s_cmp_lg_u32 s4, s33
    s_cbranch_scc1 L_yp
    s_cmp_lg_u32 s6, s33
    s_cbranch_scc1 L_yp
    s_cmp_lg_u32 s8, s33
    s_cbranch_scc1 L_yp
    s_cmp_lg_u32 s10, s33
    s_cbranch_scc1 L_yp
    s_cmp_lg_u32 s12, s33
    s_cbranch_scc1 L_yp
    s_cmp_lg_u32 s14, s33
    s_cbranch_scc1 L_yp
    s_cmp_lg_u32 s16, s33
    s_cbranch_scc1 L_yp
    s_cmp_lg_u32 s18, s33
    s_cbranch_scc1 L_yp
L_ypd:
    buffer_load_dwordx4 v16, s[44:47], s66 offen sc1 lds
    s_add_u32 m0, m0, 1024
    s_nop 0
    buffer_load_dwordx4 v17, s[44:47], s66 offen sc1 lds
    s_add_u32 m0, m0, 1024
    s_nop 0
    buffer_load_dwordx4 v18, s[44:47], s66 offen sc1 lds
    s_waitcnt vmcnt(0)
    ds_read_b64_tr_b16 v[64:65], v23 offset:0
    ds_read_b64_tr_b16 v[66:67], v23 offset:32
    ds_read_b64_tr_b16 v[68:69], v23 offset:64
    ds_read_b64_tr_b16 v[70:71], v23 offset:96
    ds_read_b64_tr_b16 v[72:73], v23 offset:128
    ds_read_b64_tr_b16 v[74:75], v23 offset:160
    s_waitcnt lgkmcnt(5)
    v_lshlrev_b32 v80, 16, v64
    v_and_b32 v81, 0xffff0000, v64
    v_lshlrev_b32 v82, 16, v65
    v_and_b32 v83, 0xffff0000, v65
    v_mul_f32 v40, v40, v80
    v_mul_f32 v41, v41, v81
    v_mul_f32 v42, v42, v82
    v_mul_f32 v43, v43, v83
    ds_write_b128 v21, v[40:43] offset:0
    s_waitcnt lgkmcnt(5)
    v_lshlrev_b32 v84, 16, v66
    v_and_b32 v85, 0xffff0000, v66
    v_lshlrev_b32 v86, 16, v67
    v_and_b32 v87, 0xffff0000, v67
    v_mul_f32 v44, v44, v84
    v_mul_f32 v45, v45, v85
    v_mul_f32 v46, v46, v86
    v_mul_f32 v47, v47, v87
    ds_write_b128 v21, v[44:47] offset:4096
    s_waitcnt lgkmcnt(5)
    v_lshlrev_b32 v88, 16, v68
    v_and_b32 v89, 0xffff0000, v68
    v_lshlrev_b32 v90, 16, v69
    v_and_b32 v91, 0xffff0000, v69
    v_mul_f32 v48, v48, v88
    v_mul_f32 v49, v49, v89
    v_mul_f32 v50, v50, v90
    v_mul_f32 v51, v51, v91
    ds_write_b128 v21, v[48:51] offset:8192
    s_waitcnt lgkmcnt(5)
    v_lshlrev_b32 v92, 16, v70
    v_and_b32 v93, 0xffff0000, v70
    v_lshlrev_b32 v94, 16, v71
    v_and_b32 v95, 0xffff0000, v71
    v_mul_f32 v52, v52, v92
    v_mul_f32 v53, v53, v93
    v_mul_f32 v54, v54, v94
    v_mul_f32 v55, v55, v95
    ds_write_b128 v21, v[52:55] offset:12288
    s_waitcnt lgkmcnt(5)
    v_lshlrev_b32 v96, 16, v72
    v_and_b32 v97, 0xffff0000, v72
    v_lshlrev_b32 v98, 16, v73
    v_and_b32 v99, 0xffff0000, v73
    v_mul_f32 v56, v56, v96
    v_mul_f32 v57, v57, v97
    v_mul_f32 v58, v58, v98
    v_mul_f32 v59, v59, v99
    ds_write_b128 v21, v[56:59] offset:16384
    s_waitcnt lgkmcnt(5)
    v_lshlrev_b32 v100, 16, v74
    v_and_b32 v101, 0xffff0000, v74
    v_lshlrev_b32 v102, 16, v75
    v_and_b32 v103, 0xffff0000, v75
    v_mul_f32 v60, v60, v100
    v_mul_f32 v61, v61, v101
    v_mul_f32 v62, v62, v102
    v_mul_f32 v63, v63, v103
    ds_write_b128 v21, v[60:63] offset:20480
    s_mov_b64 exec, 1
    ds_add_u32 v22, v4 offset:112
L_cexit:
    s_endpgm
L_hg:
    v_mov_b32 v3, 160960
    s_mov_b32 s37, 0
    s_cmp_ge_u32 s32, 4
    s_cbranch_scc1 L_ps
    v_mov_b32 v6, 0
    v_and_b32 v5, 31, v0
    v_lshl_add_u32 v5, v5, 2, v3
    ds_write_b32 v5, v6
    v_lshrrev_b32 v5, 1, v1
    v_xor_b32 v5, v5, v2
    v_lshlrev_b32 v5, 4, v5
    v_lshl_add_u32 v5, v1, 7, v5
    s_add_u32 s96, s31, 1
    s_min_u32 s96, s96, 6
    s_lshl_b32 s96, s96, 11
    v_add_u32 v15, s96, v5
    v_lshlrev_b32 v16, 4, v2
    v_add_u32 v16, 159488, v16
    v_mov_b32 v20, 0
    v_mov_b32 v21, 0
    v_mov_b32 v22, 0
    v_mov_b32 v23, 0
    v_lshlrev_b32 v17, 4, v0
    s_waitcnt lgkmcnt(0)
    s_mov_b32 s40, s22
    s_and_b32 s41, s23, 0xffff
    s_mov_b32 s42, 1280
    s_mov_b32 s43, 0x00020000
    s_mov_b32 m0, 159488
    s_nop 0
    buffer_load_dwordx4 v17, s[40:43], 0 offen lds
    s_mov_b64 exec, 0xffff
    buffer_load_dwordx4 v17, s[40:43], 0 offen offset:1024 lds
    s_mov_b64 exec, -1
    v_lshrrev_b32 v4, 3, v0
    v_and_b32 v5, 7, v0
    v_mul_u32_u24 v4, 1280, v4
    v_lshlrev_b32 v6, 1, v2
    v_xor_b32 v5, v5, v6
    v_lshl_add_u32 v4, v5, 4, v4
    s_lshl_b32 s96, s31, 7
    v_add_u32 v8, s96, v4
    v_lshrrev_b32 v4, 5, v0
    v_mul_u32_u24 v5, 20480, v4
    v_add_u32 v9, v8, v5
    v_mul_u32_u24 v5, 71680, v4
    v_add_u32 v10, v8, v5
    v_mul_u32_u24 v5, 327680, v4
    v_add_u32 v11, v8, v5
    s_mov_b32 s40, s20
    s_and_b32 s41, s21, 0xffff
    s_mov_b32 s42, 819200
    s_mov_b32 s43, 0x00020000
    s_mov_b32 s44, s28
    s_and_b32 s45, s29, 0xffff
    s_mov_b32 s46, 16777216
    s_mov_b32 s47, 0x00020000
    s_load_dword s33, s[28:29], 0
    s_mov_b32 s51, 0
    s_mov_b32 s52, 0
    s_lshl_b32 s53, s34, 7
    s_barrier
    s_waitcnt vmcnt(0)
L_hl:
    s_cmp_gt_u32 s31, 5
    s_cbranch_scc1 L_hng
    v_add_u32 v12, s52, v15
    v_add_u32 v14, s53, v16
    v_xor_b32 v13, 64, v12
    ds_read_b128 v[24:27], v12
    ds_read_b128 v[32:35], v14 offset:0
    ds_read_b128 v[28:31], v13
    ds_read_b128 v[36:39], v14 offset:64
    s_waitcnt lgkmcnt(0)
    v_mfma_f32_16x16x32_bf16 v[20:23], v[32:35], v[24:27], v[20:23]
    v_mfma_f32_16x16x32_bf16 v[20:23], v[36:39], v[28:31], v[20:23]
L_hng:
    s_waitcnt lgkmcnt(0)
    s_add_u32 s52, s52, 38912
    s_cmp_eq_u32 s52, 116736
    s_cselect_b32 s52, 0, s52
    s_add_u32 s53, s53, 128
    s_cmp_eq_u32 s53, 1280
    s_cselect_b32 s53, 0, s53
    s_cmp_lg_u32 s51, 9
    s_cbranch_scc1 L_hnw
    s_lshr_b32 s96, s2, 3
    s_mul_i32 s96, s96, 30720
    s_and_b32 s97, s2, 1
    s_mul_i32 s97, s97, 640
    s_add_u32 s96, s96, s97
    v_mul_u32_u24 v5, 13108, v0
    v_lshrrev_b32 v5, 16, v5
    v_mul_u32_u24 v5, 640, v5
    v_lshl_add_u32 v5, v0, 7, v5
    s_add_u32 s97, s96, 15360
    s_mov_b32 exec_hi, 0xfffffff
    buffer_load_dword v40, v5, s[40:43], s96 offen
    buffer_load_dword v41, v5, s[40:43], s97 offen
    s_mov_b32 exec_hi, -1
L_hnw:
    s_add_u32 s51, s51, 1
    s_cmp_ge_u32 s51, 10
    s_cbranch_scc1 L_hld
    s_barrier
    s_branch L_hl
L_hld:
    s_mul_i32 s33, s33, 1664525
    s_add_u32 s33, s33, 1013904223
    v_mov_b32 v24, s33
    s_mul_i32 s54, s30, 768
    s_add_u32 s54, s54, 131072
    v_lshlrev_b32 v26, 3, v0
    s_cmp_gt_u32 s31, 5
    s_cbranch_scc1 L_hgd
    v_cvt_pk_bf16_f32 v25, v20, v20
    v_and_b32 v25, 0xffff0000, v25
    v_mul_f32 v25, 0xbfb8aa3b, v25
    v_exp_f32 v25, v25
    s_nop 0
    v_add_f32 v25, 1.0, v25
    v_rcp_f32 v25, v25
    s_nop 0
    v_cvt_pk_bf16_f32 v25, v25, v25
    v_and_b32 v25, 0xffff0000, v25
    s_lshl_b32 s96, s31, 7
    s_add_u32 s96, s96, s54
    s_mov_b64 exec, 0xffff
    buffer_store_dwordx2 v[24:25], v26, s[44:47], s96 offen sc1
    s_mov_b64 exec, -1
L_hgd:
    s_setprio 1
    s_barrier
    s_sub_u32 s96, 0, s36
    s_cselect_b32 s97, 5, 0
    s_add_u32 s96, s96, s97
    s_lshl_b32 m0, s96, 12
    s_mov_b32 s96, 0
    buffer_load_dwordx4 v8, s[40:43], s96 offen offset:0 lds
    s_mov_b32 s96, 24576
    buffer_load_dwordx4 v8, s[40:43], s96 offen offset:1024 lds
    s_mov_b32 s96, 8192
    buffer_load_dwordx4 v8, s[40:43], s96 offen offset:2048 lds
    s_mov_b32 s96, 32768
    buffer_load_dwordx4 v8, s[40:43], s96 offen offset:3072 lds
    s_sub_u32 s96, 1, s36
    s_cselect_b32 s97, 5, 0
    s_add_u32 s96, s96, s97
    s_lshl_b32 m0, s96, 12
    s_mov_b32 s96, 102400
    buffer_load_dwordx4 v8, s[40:43], s96 offen offset:0 lds
    s_mov_b32 s96, 126976
    buffer_load_dwordx4 v8, s[40:43], s96 offen offset:1024 lds
    s_mov_b32 s96, 110592
    buffer_load_dwordx4 v8, s[40:43], s96 offen offset:2048 lds
    s_mov_b32 s96, 135168
    buffer_load_dwordx4 v8, s[40:43], s96 offen offset:3072 lds
    s_sub_u32 s96, 2, s36
    s_cselect_b32 s97, 5, 0
    s_add_u32 s96, s96, s97
    s_lshl_b32 m0, s96, 12
    s_mov_b32 s96, 179200
    buffer_load_dwordx4 v8, s[40:43], s96 offen offset:0 lds
    s_mov_b32 s96, 203776
    buffer_load_dwordx4 v8, s[40:43], s96 offen offset:1024 lds
    s_mov_b32 s96, 187392
    buffer_load_dwordx4 v8, s[40:43], s96 offen offset:2048 lds
    s_mov_b32 s96, 211968
    buffer_load_dwordx4 v8, s[40:43], s96 offen offset:3072 lds
    s_sub_u32 s96, 3, s36
    s_cselect_b32 s97, 5, 0
    s_add_u32 s96, s96, s97
    s_lshl_b32 m0, s96, 12
    s_mov_b32 s96, 256000
    buffer_load_dwordx4 v8, s[40:43], s96 offen offset:0 lds
    s_mov_b32 s96, 280576
    buffer_load_dwordx4 v8, s[40:43], s96 offen offset:1024 lds
    s_mov_b32 s96, 264192
    buffer_load_dwordx4 v8, s[40:43], s96 offen offset:2048 lds
    s_mov_b32 s96, 288768
    buffer_load_dwordx4 v8, s[40:43], s96 offen offset:3072 lds
    s_sub_u32 s96, 4, s36
    s_cselect_b32 s97, 5, 0
    s_add_u32 s96, s96, s97
    s_lshl_b32 m0, s96, 12
    s_mov_b32 s96, 332800
    buffer_load_dwordx4 v8, s[40:43], s96 offen offset:0 lds
    s_mov_b32 s96, 357376
    buffer_load_dwordx4 v8, s[40:43], s96 offen offset:1024 lds
    s_mov_b32 s96, 340992
    buffer_load_dwordx4 v8, s[40:43], s96 offen offset:2048 lds
    s_mov_b32 s96, 365568
    buffer_load_dwordx4 v8, s[40:43], s96 offen offset:3072 lds
    s_mov_b32 m0, 20480
    s_mov_b32 s96, 20480
    buffer_load_dwordx4 v9, s[40:43], s96 offen offset:0 lds
    s_mov_b32 s96, 121856
    buffer_load_dwordx4 v9, s[40:43], s96 offen offset:1024 lds
    s_mov_b32 s96, 197632
    buffer_load_dwordx4 v9, s[40:43], s96 offen offset:2048 lds
    s_mov_b32 s96, 273408
    buffer_load_dwordx4 v9, s[40:43], s96 offen offset:3072 lds
    s_mov_b32 m0, 61440
    s_mov_b32 s96, 430080
    buffer_load_dwordx4 v9, s[40:43], s96 offen offset:0 lds
    s_mov_b32 s96, 531456
    buffer_load_dwordx4 v9, s[40:43], s96 offen offset:1024 lds
    s_mov_b32 s96, 607232
    buffer_load_dwordx4 v9, s[40:43], s96 offen offset:2048 lds
    s_mov_b32 s96, 683008
    buffer_load_dwordx4 v9, s[40:43], s96 offen offset:3072 lds
    s_mov_b32 m0, 24576
    s_mov_b32 s96, 51200
    buffer_load_dwordx4 v8, s[40:43], s96 offen offset:0 lds
    s_mov_b32 s96, 382976
    buffer_load_dwordx4 v8, s[40:43], s96 offen offset:1024 lds
    s_mov_b32 s96, 59392
    buffer_load_dwordx4 v8, s[40:43], s96 offen offset:2048 lds
    s_mov_b32 s96, 391168
    buffer_load_dwordx4 v8, s[40:43], s96 offen offset:3072 lds
    s_mov_b32 m0, 65536
    s_mov_b32 s96, 460800
    buffer_load_dwordx4 v8, s[40:43], s96 offen offset:0 lds
    s_mov_b32 s96, 792576
    buffer_load_dwordx4 v8, s[40:43], s96 offen offset:1024 lds
    s_mov_b32 s96, 468992
    buffer_load_dwordx4 v8, s[40:43], s96 offen offset:2048 lds
    s_mov_b32 s96, 800768
    buffer_load_dwordx4 v8, s[40:43], s96 offen offset:3072 lds
    s_mov_b32 m0, 28672
    s_mov_b32 s96, 76800
    buffer_load_dwordx4 v8, s[40:43], s96 offen offset:0 lds
    s_mov_b32 s96, 152576
    buffer_load_dwordx4 v8, s[40:43], s96 offen offset:1024 lds
    s_mov_b32 s96, 84992
    buffer_load_dwordx4 v8, s[40:43], s96 offen offset:2048 lds
    s_mov_b32 s96, 160768
    buffer_load_dwordx4 v8, s[40:43], s96 offen offset:3072 lds
    s_mov_b32 m0, 69632
    s_mov_b32 s96, 486400
    buffer_load_dwordx4 v8, s[40:43], s96 offen offset:0 lds
    s_mov_b32 s96, 562176
    buffer_load_dwordx4 v8, s[40:43], s96 offen offset:1024 lds
    s_mov_b32 s96, 494592
    buffer_load_dwordx4 v8, s[40:43], s96 offen offset:2048 lds
    s_mov_b32 s96, 570368
    buffer_load_dwordx4 v8, s[40:43], s96 offen offset:3072 lds
    s_mov_b32 m0, 32768
    s_mov_b32 s96, 230400
    buffer_load_dwordx4 v8, s[40:43], s96 offen offset:0 lds
    s_mov_b32 s96, 306176
    buffer_load_dwordx4 v8, s[40:43], s96 offen offset:1024 lds
    s_mov_b32 s96, 238592
    buffer_load_dwordx4 v8, s[40:43], s96 offen offset:2048 lds
    s_mov_b32 s96, 314368
    buffer_load_dwordx4 v8, s[40:43], s96 offen offset:3072 lds
    s_mov_b32 m0, 73728
    s_mov_b32 s96, 640000
    buffer_load_dwordx4 v8, s[40:43], s96 offen offset:0 lds
    s_mov_b32 s96, 715776
    buffer_load_dwordx4 v8, s[40:43], s96 offen offset:1024 lds
    s_mov_b32 s96, 648192
    buffer_load_dwordx4 v8, s[40:43], s96 offen offset:2048 lds
    s_mov_b32 s96, 723968
    buffer_load_dwordx4 v8, s[40:43], s96 offen offset:3072 lds
    s_mov_b32 m0, 36864
    s_mov_b32 s96, 353280
    buffer_load_dwordx4 v9, s[40:43], s96 offen offset:0 lds
    s_mov_b32 s96, 70656
    buffer_load_dwordx4 v11, s[40:43], s96 offen offset:1024 lds
    s_mov_b32 s96, 95232
    buffer_load_dwordx4 v10, s[40:43], s96 offen offset:2048 lds
    s_mov_b32 s96, 247808
    buffer_load_dwordx4 v10, s[40:43], s96 offen offset:3072 lds
    s_mov_b32 m0, 77824
    s_mov_b32 s96, 762880
    buffer_load_dwordx4 v9, s[40:43], s96 offen offset:0 lds
    s_mov_b32 s96, 480256
    buffer_load_dwordx4 v11, s[40:43], s96 offen offset:1024 lds
    s_mov_b32 s96, 504832
    buffer_load_dwordx4 v10, s[40:43], s96 offen offset:2048 lds
    s_mov_b32 s96, 657408
    buffer_load_dwordx4 v10, s[40:43], s96 offen offset:3072 lds
    v_lshlrev_b32 v27, 2, v0
    v_add_u32 v27, 161088, v27
    s_waitcnt vmcnt(0)
    v_mov_b32 v4, 1
    s_mov_b64 exec, 1
    ds_add_u32 v3, v4 offset:4
    s_mov_b64 exec, -1
    s_mov_b32 s100, 0
    v_mov_b32 v30, s33
L_gp:
    buffer_load_dwordx2 v[28:29], v26, s[44:47], s54 offen sc1
    s_mov_b32 exec_hi, 0
    buffer_load_dwordx2 v[30:31], v26, s[44:47], s54 offen offset:512 sc1
    s_mov_b32 exec_hi, -1
    s_waitcnt vmcnt(0)
    v_cmp_ne_u32 vcc, s33, v28
    v_cmp_ne_u32 s[56:57], s33, v30
    s_or_b64 vcc, vcc, s[56:57]
    s_cbranch_scc0 L_gpd
    s_sleep 8
    s_add_u32 s100, s100, 1
    s_cmp_lt_u32 s100, 1048576
    s_cbranch_scc1 L_gp
L_gpd:
    ds_write_b32 v27, v29
    s_mov_b32 exec_hi, 0
    ds_write_b32 v27, v31 offset:256
    s_mov_b32 exec_hi, -1
    v_mov_b32 v4, 1
    ds_write_b32 v3, v4 offset:12
    s_endpgm
L_s0:
    s_mul_i32 s33, s33, 1664525
    s_add_u32 s33, s33, 1013904223
    s_mov_b32 s44, s28
    s_and_b32 s45, s29, 0xffff
    s_mov_b32 s46, 16777216
    s_mov_b32 s47, 0x00020000
    v_lshrrev_b32 v4, 3, v0
    v_and_b32 v5, 7, v0
    v_mul_u32_u24 v4, 1280, v4
    v_lshlrev_b32 v6, 1, v2
    v_xor_b32 v5, v5, v6
    v_lshl_add_u32 v4, v5, 4, v4
    s_lshl_b32 s96, s31, 7
    v_add_u32 v8, s96, v4
    v_lshrrev_b32 v4, 5, v0
    v_mul_u32_u24 v5, 20480, v4
    v_add_u32 v9, v8, v5
    v_mul_u32_u24 v5, 71680, v4
    v_add_u32 v10, v8, v5
    v_mul_u32_u24 v5, 327680, v4
    v_add_u32 v11, v8, v5
    s_mov_b32 s40, s20
    s_and_b32 s41, s21, 0xffff
    s_mov_b32 s42, 819200
    s_mov_b32 s43, 0x00020000
    v_lshlrev_b32 v17, 4, v0
    s_waitcnt vmcnt(0)
    s_barrier
    s_lshl_b32 s96, s31, 5
    s_add_u32 s96, s96, s30
    s_lshl_b32 s96, s96, 11
    s_add_u32 s96, s96, 262656
    s_add_u32 s48, s28, s96
    s_addc_u32 s49, s29, 0
    s_lshl_b32 s52, s31, 5
    s_add_u32 s52, s52, s30
    s_mul_i32 s52, s52, 10240
    s_add_u32 s52, s52, 8781824
    s_setprio 3
    s_barrier
    s_sub_u32 s96, 0, s36
    s_cselect_b32 s97, 15, 10
    s_add_u32 s96, s96, s97
    s_lshl_b32 m0, s96, 12
    s_mov_b32 s96, 409600
    buffer_load_dwordx4 v8, s[40:43], s96 offen offset:0 lds
    s_mov_b32 s96, 434176
    buffer_load_dwordx4 v8, s[40:43], s96 offen offset:1024 lds
    s_mov_b32 s96, 417792
    buffer_load_dwordx4 v8, s[40:43], s96 offen offset:2048 lds
    s_mov_b32 s96, 442368
    buffer_load_dwordx4 v8, s[40:43], s96 offen offset:3072 lds
    s_sub_u32 s96, 1, s36
    s_cselect_b32 s97, 15, 10
    s_add_u32 s96, s96, s97
    s_lshl_b32 m0, s96, 12
    s_mov_b32 s96, 512000
    buffer_load_dwordx4 v8, s[40:43], s96 offen offset:0 lds
    s_mov_b32 s96, 536576
    buffer_load_dwordx4 v8, s[40:43], s96 offen offset:1024 lds
    s_mov_b32 s96, 520192
    buffer_load_dwordx4 v8, s[40:43], s96 offen offset:2048 lds
    s_mov_b32 s96, 544768
    buffer_load_dwordx4 v8, s[40:43], s96 offen offset:3072 lds
    s_sub_u32 s96, 2, s36
    s_cselect_b32 s97, 15, 10
    s_add_u32 s96, s96, s97
    s_lshl_b32 m0, s96, 12
    s_mov_b32 s96, 588800
    buffer_load_dwordx4 v8, s[40:43], s96 offen offset:0 lds
    s_mov_b32 s96, 613376
    buffer_load_dwordx4 v8, s[40:43], s96 offen offset:1024 lds
    s_mov_b32 s96, 596992
    buffer_load_dwordx4 v8, s[40:43], s96 offen offset:2048 lds
    s_mov_b32 s96, 621568
    buffer_load_dwordx4 v8, s[40:43], s96 offen offset:3072 lds
    s_sub_u32 s96, 3, s36
    s_cselect_b32 s97, 15, 10
    s_add_u32 s96, s96, s97
    s_lshl_b32 m0, s96, 12
    s_mov_b32 s96, 665600
    buffer_load_dwordx4 v8, s[40:43], s96 offen offset:0 lds
    s_mov_b32 s96, 690176
    buffer_load_dwordx4 v8, s[40:43], s96 offen offset:1024 lds
    s_mov_b32 s96, 673792
    buffer_load_dwordx4 v8, s[40:43], s96 offen offset:2048 lds
    s_mov_b32 s96, 698368
    buffer_load_dwordx4 v8, s[40:43], s96 offen offset:3072 lds
    s_sub_u32 s96, 4, s36
    s_cselect_b32 s97, 15, 10
    s_add_u32 s96, s96, s97
    s_lshl_b32 m0, s96, 12
    s_mov_b32 s96, 742400
    buffer_load_dwordx4 v8, s[40:43], s96 offen offset:0 lds
    s_mov_b32 s96, 766976
    buffer_load_dwordx4 v8, s[40:43], s96 offen offset:1024 lds
    s_mov_b32 s96, 750592
    buffer_load_dwordx4 v8, s[40:43], s96 offen offset:2048 lds
    s_mov_b32 s96, 775168
    buffer_load_dwordx4 v8, s[40:43], s96 offen offset:3072 lds
    s_cmp_eq_u32 s36, 0
    s_cbranch_scc1 L_s0n
    s_mov_b32 s100, 0
L_xp:
    s_add_u32 s100, s100, 1
    s_cmp_ge_u32 s100, 1048576
    s_cbranch_scc1 L_xpd
    s_load_dwordx2 s[4:5], s[48:49], 0 glc
    s_waitcnt lgkmcnt(0)
    s_cmp_lg_u32 s4, s33
    s_cbranch_scc1 L_xp
L_xpd:
    s_mov_b32 m0, 81920
    s_nop 0
    buffer_load_dwordx4 v17, s[44:47], s52 offen offset:0 sc1 lds
    buffer_load_dwordx4 v17, s[44:47], s52 offen offset:1024 sc1 lds
    buffer_load_dwordx4 v17, s[44:47], s52 offen offset:2048 sc1 lds
    buffer_load_dwordx4 v17, s[44:47], s52 offen offset:3072 sc1 lds
    s_add_u32 m0, m0, 4096
    s_add_u32 s52, s52, 4096
    buffer_load_dwordx4 v17, s[44:47], s52 offen offset:0 sc1 lds
    buffer_load_dwordx4 v17, s[44:47], s52 offen offset:1024 sc1 lds
    buffer_load_dwordx4 v17, s[44:47], s52 offen offset:2048 sc1 lds
    buffer_load_dwordx4 v17, s[44:47], s52 offen offset:3072 sc1 lds
    s_add_u32 m0, m0, 4096
    s_add_u32 s52, s52, 4096
    buffer_load_dwordx4 v17, s[44:47], s52 offen offset:0 sc1 lds
    buffer_load_dwordx4 v17, s[44:47], s52 offen offset:1024 sc1 lds
L_s0n:
    s_waitcnt vmcnt(0)
    v_mov_b32 v4, 1
    ds_write_b32 v3, v4 offset:8
    v_mov_b32 v4, 1
    s_mov_b64 exec, 1
    ds_add_u32 v3, v4 offset:4
    s_mov_b64 exec, -1
    s_endpgm
L_ps:
    s_cmp_ge_u32 s32, 4
    s_cselect_b32 s96, -4, 3
    s_add_u32 s60, s32, s96
    s_and_b32 s61, s60, 1
    s_and_b32 s96, s36, 3
    s_cselect_b32 s96, 4, 6
    s_cmp_ge_u32 s60, s96
    s_cselect_b32 s62, 1, 0
    v_mov_b32 v7, 0xf149f2ca
    v_lshlrev_b32 v4, 2, v2
    v_sub_u32 v4, v1, v4
    v_subrev_u32 v5, 0, v4
    v_and_b32 v5, 0x80000001, v5
    v_cmp_eq_u32 vcc, 0, v5
    s_nop 1
    v_cndmask_b32 v146, v7, 0, vcc
    v_cmp_eq_u32 vcc, 0x80000000, v5
    s_nop 1
    v_cndmask_b32 v150, v7, 0, vcc
    v_subrev_u32 v5, 1, v4
    v_and_b32 v5, 0x80000001, v5
    v_cmp_eq_u32 vcc, 0, v5
    s_nop 1
    v_cndmask_b32 v147, v7, 0, vcc
    v_cmp_eq_u32 vcc, 0x80000000, v5
    s_nop 1
    v_cndmask_b32 v151, v7, 0, vcc
    v_subrev_u32 v5, 2, v4
    v_and_b32 v5, 0x80000001, v5
    v_cmp_eq_u32 vcc, 0, v5
    s_nop 1
    v_cndmask_b32 v148, v7, 0, vcc
    v_cmp_eq_u32 vcc, 0x80000000, v5
    s_nop 1
    v_cndmask_b32 v152, v7, 0, vcc
    v_subrev_u32 v5, 3, v4
    v_and_b32 v5, 0x80000001, v5
    v_cmp_eq_u32 vcc, 0, v5
    s_nop 1
    v_cndmask_b32 v149, v7, 0, vcc
    v_cmp_eq_u32 vcc, 0x80000000, v5
    s_nop 1
    v_cndmask_b32 v153, v7, 0, vcc
    v_and_b32 v5, 1, v1
    v_lshlrev_b32 v6, 4, v5
    v_sub_u32 v5, v4, v5
    v_mov_b32 v4, 0x0c0c0c0c
    v_mov_b32 v7, 0xc0c0100
    v_alignbit_b32 v7, v7, v7, v6
    v_cmp_le_i32 vcc, 0, v5
    s_nop 1
    v_cndmask_b32 v154, v4, v7, vcc
    v_cndmask_b32 v156, v7, v4, vcc
    v_mov_b32 v7, 0xc0c0302
    v_alignbit_b32 v7, v7, v7, v6
    v_cmp_le_i32 vcc, 2, v5
    s_nop 1
    v_cndmask_b32 v155, v4, v7, vcc
    v_cndmask_b32 v157, v7, v4, vcc
    v_cmp_eq_u32 vcc, 0, v2
    s_nop 1
    v_cndmask_b32 v159, 0, -1, vcc
    s_mov_b32 s66, 0x3ea52b5c
    s_or_b32 s96, s30, s61
    s_cselect_b32 s67, 0, 0xf149f2ca
    s_mul_i32 s64, s61, 6128
    s_add_u32 s64, s64, 3080
    s_mul_i32 s65, s61, 3064
    s_add_u32 s65, s65, 6152
    s_lshl1_add_u32 s96, s30, s61
    s_mul_i32 s68, s96, 61440
    s_add_u32 s68, s68, 6356992
    s_mov_b32 s69, 0
    s_cmp_lg_u32 s37, 1
    s_cbranch_scc1 L_us
    s_waitcnt vmcnt(0)
    s_barrier
L_us:
    s_min_u32 s96, s36, 1
    s_lshr_b32 s97, s60, 1
    s_add_u32 s96, s96, s97
    s_lshl1_add_u32 s99, s36, s97
    s_lshr_b32 s98, s36, 2
    s_add_u32 s98, s98, 10
    s_cmp_ge_u32 s60, 4
    s_cselect_b32 s63, s98, s99
    s_add_u32 s98, s36, 11
    s_cmp_lg_u32 s62, 0
    s_cselect_b32 s63, s98, s63
    s_cselect_b32 s96, 0, s96
    s_add_u32 s98, s36, 10
    v_sub_u32 v4, s98, v1
    v_mul_u32_u24 v5, 52, v4
    v_lshrrev_b32 v5, 8, v5
    v_mul_u32_u24 v5, 5, v5
    v_sub_u32 v4, v4, v5
    s_sub_u32 s99, s63, 5
    s_cmp_lt_u32 s60, 4
    s_cbranch_scc1 L_ufs
    v_mov_b32 v4, s99
L_ufs:
    s_and_b32 s98, s2, 1
    s_lshl4_add_u32 s63, s98, s63
    s_lshl1_add_u32 s98, s98, s61
    s_lshl3_add_u32 s98, s30, s98
    s_lshl_b32 s98, s98, 8
    s_add_u32 s98, s98, 263168
    v_lshl_add_u32 v4, v4, 3, s98
    v_lshl_add_u32 v164, v1, 16, v4
    s_mul_i32 s96, s96, 5
    s_add_u32 s96, s96, 4
    s_sub_u32 s96, s96, s36
    s_lshl3_add_u32 s97, s61, 81920
    v_add_u32 v4, s96, v2
    v_lshrrev_b32 v5, 2, v4
    v_mul_u32_u24 v5, 9216, v5
    v_lshl_add_u32 v5, v4, 8, v5
    v_lshl_add_u32 v6, v1, 4, s97
    v_add_u32 v158, v5, v6
    s_lshl_b32 s96, s96, 2
    v_lshl_add_u32 v6, v2, 8, s97
    v_add_u32 v4, s96, v1
    v_lshrrev_b32 v5, 4, v4
    v_mul_u32_u24 v5, 9984, v5
    v_lshl_add_u32 v5, v4, 4, v5
    v_add_u32 v160, v5, v6
    s_lshr_b32 s98, s96, 4
    s_mul_i32 s98, s98, 9984
    s_lshl4_add_u32 s98, s96, s98
    s_add_u32 s98, s98, 10240
    v_and_b32 v4, 3, v1
    v_lshl_add_u32 v4, v4, 4, s98
    v_add_u32 v161, v4, v6
    s_lshl_b32 s96, s63, 9
    v_lshrrev_b32 v4, 5, v0
    v_mul_u32_u24 v4, 19968, v4
    v_lshl_add_u32 v4, v0, 4, v4
    v_add_u32 v162, s96, v4
    s_lshl_b32 s96, s63, 7
    s_add_u32 s96, s96, 16384
    v_mul_u32_u24 v4, 20480, v2
    v_lshl_add_u32 v4, v1, 3, v4
    v_add_u32 v163, s96, v4
    s_cmp_eq_u32 s37, 1
    s_cbranch_scc1 L_pb10
    s_cmp_eq_u32 s37, 2
    s_cbranch_scc1 L_upre
    s_setprio 2
    v_lshrrev_b32 v5, 1, v1
    v_xor_b32 v5, v5, v2
    v_lshlrev_b32 v5, 4, v5
    v_lshl_add_u32 v140, v1, 7, v5
    v_bfe_u32 v4, v0, 2, 2
    v_lshl_add_u32 v5, v2, 3, v4
    v_lshlrev_b32 v5, 7, v5
    v_bfe_u32 v6, v0, 3, 2
    v_xor_b32 v6, s60, v6
    v_lshl_add_u32 v5, v6, 5, v5
    v_and_b32 v6, 3, v0
    v_lshl_add_u32 v5, v6, 3, v5
    v_add_u32 v141, 14336, v5
    v_mov_b32 v8, 0
    v_mov_b32 v9, 0
    v_mov_b32 v10, 0
    v_mov_b32 v11, 0
    v_mov_b32 v12, 0
    v_mov_b32 v13, 0
    v_mov_b32 v14, 0
    v_mov_b32 v15, 0
    v_mov_b32 v16, 0
    v_mov_b32 v17, 0
    v_mov_b32 v18, 0
    v_mov_b32 v19, 0
    v_mov_b32 v20, 0
    v_mov_b32 v21, 0
    v_mov_b32 v22, 0
    v_mov_b32 v23, 0
    v_mov_b32 v24, 0
    v_mov_b32 v25, 0
    v_mov_b32 v26, 0
    v_mov_b32 v27, 0
    v_mov_b32 v28, 0
    v_mov_b32 v29, 0
    v_mov_b32 v30, 0
    v_mov_b32 v31, 0
    v_mov_b32 v32, 0
    v_mov_b32 v33, 0
    v_mov_b32 v34, 0
    v_mov_b32 v35, 0
    v_mov_b32 v36, 0
    v_mov_b32 v37, 0
    v_mov_b32 v38, 0
    v_mov_b32 v39, 0
    v_mov_b32 v40, 0
    v_mov_b32 v41, 0
    v_mov_b32 v42, 0
    v_mov_b32 v43, 0
    v_mov_b32 v44, 0
    v_mov_b32 v45, 0
    v_mov_b32 v46, 0
    v_mov_b32 v47, 0
    v_mov_b32 v48, 0
    v_mov_b32 v49, 0
    v_mov_b32 v50, 0
    v_mov_b32 v51, 0
    v_mov_b32 v52, 0
    v_mov_b32 v53, 0
    v_mov_b32 v54, 0
    v_mov_b32 v55, 0
    v_mov_b32 v56, 0
    v_mov_b32 v57, 0
    v_mov_b32 v58, 0
    v_mov_b32 v59, 0
    v_mov_b32 v60, 0
    v_mov_b32 v61, 0
    v_mov_b32 v62, 0
    v_mov_b32 v63, 0
    v_mov_b32 v64, 0
    v_mov_b32 v65, 0
    v_mov_b32 v66, 0
    v_mov_b32 v67, 0
    v_mov_b32 v68, 0
    v_mov_b32 v69, 0
    v_mov_b32 v70, 0
    v_mov_b32 v71, 0
    v_mov_b32 v72, 0
    v_mov_b32 v73, 0
    v_mov_b32 v74, 0
    v_mov_b32 v75, 0
    v_mov_b32 v76, 0
    v_mov_b32 v77, 0
    v_mov_b32 v78, 0
    v_mov_b32 v79, 0
    v_mov_b32 v80, 0
    v_mov_b32 v81, 0
    v_mov_b32 v82, 0
    v_mov_b32 v83, 0
    v_mov_b32 v84, 0
    v_mov_b32 v85, 0
    v_mov_b32 v86, 0
    v_mov_b32 v87, 0
    s_mov_b32 s41, 0
    s_mov_b32 s42, 0
    v_mov_b32 v142, v140
    v_xor_b32 v143, 64, v140
    v_mov_b32 v144, v141
    s_add_u32 s96, s60, 1
    s_mul_i32 s96, s96, 10240
    s_add_u32 s96, s96, 81920
    v_lshl_add_u32 v145, v0, 4, s96
    v_lshlrev_b32 v7, 4, v0
    s_waitcnt lgkmcnt(0)
    s_mov_b32 s44, s28
    s_and_b32 s45, s29, 0xffff
    s_mov_b32 s46, 16777216
    s_mov_b32 s47, 0x00020000
    s_lshl_b32 s97, s31, 5
    s_add_u32 s97, s97, s30
    s_mul_i32 s70, s97, 10240
    s_add_u32 s70, s70, 9109504
    s_add_u32 s71, s70, 4096
    s_add_u32 s72, s70, 8192
    s_lshl_b32 s97, s97, 11
    s_add_u32 s97, s97, 328192
    s_cmp_eq_u32 s32, 7
    s_cselect_b32 s69, s97, 0
    s_cmp_eq_u32 s36, 4
    s_cselect_b32 s69, 0, s69
    s_load_dword s33, s[28:29], 0
    s_barrier
    ds_read_b64_tr_b16 v[120:121], v144 offset:4096
    ds_read_b64_tr_b16 v[122:123], v144 offset:4608
    ds_read_b128 v[88:91], v142 offset:0
    ds_read_b64_tr_b16 v[124:125], v144 offset:8192
    ds_read_b64_tr_b16 v[126:127], v144 offset:8704
    ds_read_b128 v[92:95], v142 offset:2048
    ds_read_b64_tr_b16 v[116:117], v144 offset:0
    ds_read_b64_tr_b16 v[118:119], v144 offset:512
    ds_read_b128 v[96:99], v142 offset:4096
    ds_read_b128 v[100:103], v142 offset:6144
    ds_read_b128 v[104:107], v142 offset:8192
    ds_read_b128 v[108:111], v142 offset:10240
    ds_read_b128 v[112:115], v142 offset:12288
    s_waitcnt lgkmcnt(0)
    s_mul_i32 s33, s33, 1664525
    s_add_u32 s33, s33, 1013904223
L_gl:
    s_waitcnt lgkmcnt(10)
    v_mfma_f32_16x16x32_bf16 v[32:35], v[120:123], v[88:91], v[32:35]
    ds_read_b64_tr_b16 v[132:133], v144 offset:16384
    s_waitcnt lgkmcnt(9)
    v_mfma_f32_16x16x32_bf16 v[60:63], v[88:91], v[124:127], v[60:63]
    ds_read_b64_tr_b16 v[134:135], v144 offset:16896
    s_waitcnt lgkmcnt(9)
    v_mfma_f32_16x16x32_bf16 v[36:39], v[120:123], v[92:95], v[36:39]
    ds_read_b128 v[88:91], v143 offset:0
    v_mfma_f32_16x16x32_bf16 v[64:67], v[92:95], v[124:127], v[64:67]
    ds_read_b64_tr_b16 v[136:137], v144 offset:20480
    s_waitcnt lgkmcnt(9)
    v_mfma_f32_16x16x32_bf16 v[8:11], v[116:119], v[92:95], v[8:11]
    ds_read_b64_tr_b16 v[138:139], v144 offset:20992
    s_waitcnt lgkmcnt(9)
    v_mfma_f32_16x16x32_bf16 v[40:43], v[120:123], v[96:99], v[40:43]
    ds_read_b128 v[92:95], v143 offset:2048
    v_mfma_f32_16x16x32_bf16 v[68:71], v[96:99], v[124:127], v[68:71]
    ds_read_b64_tr_b16 v[128:129], v144 offset:12288
    v_mfma_f32_16x16x32_bf16 v[12:15], v[116:119], v[96:99], v[12:15]
    ds_read_b64_tr_b16 v[130:131], v144 offset:12800
    s_waitcnt lgkmcnt(11)
    v_mfma_f32_16x16x32_bf16 v[44:47], v[120:123], v[100:103], v[44:47]
    ds_read_b128 v[96:99], v143 offset:4096
    v_mfma_f32_16x16x32_bf16 v[72:75], v[100:103], v[124:127], v[72:75]
    v_mfma_f32_16x16x32_bf16 v[16:19], v[116:119], v[100:103], v[16:19]
    ds_read_b128 v[100:103], v143 offset:6144
    s_waitcnt lgkmcnt(12)
    v_mfma_f32_16x16x32_bf16 v[48:51], v[120:123], v[104:107], v[48:51]
    v_mfma_f32_16x16x32_bf16 v[76:79], v[104:107], v[124:127], v[76:79]
    s_add_u32 s41, s41, 38912
    v_mfma_f32_16x16x32_bf16 v[20:23], v[116:119], v[104:107], v[20:23]
    ds_read_b128 v[104:107], v143 offset:8192
    s_waitcnt lgkmcnt(12)
    v_mfma_f32_16x16x32_bf16 v[52:55], v[120:123], v[108:111], v[52:55]
    s_cmp_eq_u32 s41, 116736
    s_cselect_b32 s41, 0, s41
    v_mfma_f32_16x16x32_bf16 v[80:83], v[108:111], v[124:127], v[80:83]
    v_add_u32 v144, s41, v141
    v_mfma_f32_16x16x32_bf16 v[24:27], v[116:119], v[108:111], v[24:27]
    ds_read_b128 v[108:111], v143 offset:10240
    s_waitcnt lgkmcnt(12)
    v_mfma_f32_16x16x32_bf16 v[56:59], v[120:123], v[112:115], v[56:59]
    v_add_u32 v142, s41, v140
    v_mfma_f32_16x16x32_bf16 v[84:87], v[112:115], v[124:127], v[84:87]
    v_mfma_f32_16x16x32_bf16 v[28:31], v[116:119], v[112:115], v[28:31]
    ds_read_b128 v[112:115], v143 offset:12288
    s_waitcnt lgkmcnt(10)
    v_mfma_f32_16x16x32_bf16 v[32:35], v[132:135], v[88:91], v[32:35]
    s_waitcnt lgkmcnt(8)
    v_mfma_f32_16x16x32_bf16 v[60:63], v[88:91], v[136:139], v[60:63]
    v_xor_b32 v143, 64, v142
    s_waitcnt lgkmcnt(7)
    v_mfma_f32_16x16x32_bf16 v[36:39], v[132:135], v[92:95], v[36:39]
    s_add_u32 s42, s42, 1
    v_mfma_f32_16x16x32_bf16 v[64:67], v[92:95], v[136:139], v[64:67]
    s_waitcnt lgkmcnt(5)
    v_mfma_f32_16x16x32_bf16 v[8:11], v[128:131], v[92:95], v[8:11]
    s_waitcnt lgkmcnt(4)
    v_mfma_f32_16x16x32_bf16 v[40:43], v[132:135], v[96:99], v[40:43]
    v_mfma_f32_16x16x32_bf16 v[68:71], v[96:99], v[136:139], v[68:71]
    v_mfma_f32_16x16x32_bf16 v[12:15], v[128:131], v[96:99], v[12:15]
    s_waitcnt lgkmcnt(3)
    v_mfma_f32_16x16x32_bf16 v[44:47], v[132:135], v[100:103], v[44:47]
    v_mfma_f32_16x16x32_bf16 v[72:75], v[100:103], v[136:139], v[72:75]
    v_mfma_f32_16x16x32_bf16 v[16:19], v[128:131], v[100:103], v[16:19]
    s_waitcnt lgkmcnt(2)
    v_mfma_f32_16x16x32_bf16 v[48:51], v[132:135], v[104:107], v[48:51]
    s_waitcnt lgkmcnt(0)

    s_barrier
    ds_read_b64_tr_b16 v[120:121], v144 offset:4096
    ds_read_b64_tr_b16 v[122:123], v144 offset:4608
    v_mfma_f32_16x16x32_bf16 v[76:79], v[104:107], v[136:139], v[76:79]
    ds_read_b128 v[88:91], v142 offset:0
    ds_read_b64_tr_b16 v[124:125], v144 offset:8192
    v_mfma_f32_16x16x32_bf16 v[20:23], v[128:131], v[104:107], v[20:23]
    ds_read_b64_tr_b16 v[126:127], v144 offset:8704
    ds_read_b128 v[92:95], v142 offset:2048
    v_mfma_f32_16x16x32_bf16 v[52:55], v[132:135], v[108:111], v[52:55]
    ds_read_b64_tr_b16 v[116:117], v144 offset:0
    ds_read_b64_tr_b16 v[118:119], v144 offset:512
    v_mfma_f32_16x16x32_bf16 v[80:83], v[108:111], v[136:139], v[80:83]
    ds_read_b128 v[96:99], v142 offset:4096
    ds_read_b128 v[100:103], v142 offset:6144
    v_mfma_f32_16x16x32_bf16 v[24:27], v[128:131], v[108:111], v[24:27]
    ds_read_b128 v[104:107], v142 offset:8192
    ds_read_b128 v[108:111], v142 offset:10240
    v_mfma_f32_16x16x32_bf16 v[56:59], v[132:135], v[112:115], v[56:59]
    v_mfma_f32_16x16x32_bf16 v[84:87], v[112:115], v[136:139], v[84:87]
    s_cmp_lt_u32 s42, 9
    v_mfma_f32_16x16x32_bf16 v[28:31], v[128:131], v[112:115], v[28:31]
    ds_read_b128 v[112:115], v142 offset:12288
    s_cbranch_scc1 L_gl
    s_cmp_eq_u32 s69, 0

    s_waitcnt lgkmcnt(10)
    v_mfma_f32_16x16x32_bf16 v[32:35], v[120:123], v[88:91], v[32:35]
    ds_read_b64_tr_b16 v[132:133], v144 offset:16384
    s_waitcnt lgkmcnt(9)
    v_mfma_f32_16x16x32_bf16 v[60:63], v[88:91], v[124:127], v[60:63]
    ds_read_b128 v[88:91], v143 offset:0
    s_waitcnt lgkmcnt(5)
    v_mfma_f32_16x16x32_bf16 v[44:47], v[120:123], v[100:103], v[44:47]
    ds_read_b64_tr_b16 v[134:135], v144 offset:16896
    v_mfma_f32_16x16x32_bf16 v[72:75], v[100:103], v[124:127], v[72:75]
    ds_read_b64_tr_b16 v[136:137], v144 offset:20480
    v_mfma_f32_16x16x32_bf16 v[16:19], v[116:119], v[100:103], v[16:19]
    ds_read_b128 v[100:103], v143 offset:6144
    v_mfma_f32_16x16x32_bf16 v[36:39], v[120:123], v[92:95], v[36:39]
    ds_read_b64_tr_b16 v[138:139], v144 offset:20992
    v_mfma_f32_16x16x32_bf16 v[64:67], v[92:95], v[124:127], v[64:67]
    ds_read_b64_tr_b16 v[128:129], v144 offset:12288
    v_mfma_f32_16x16x32_bf16 v[8:11], v[116:119], v[92:95], v[8:11]
    ds_read_b128 v[92:95], v143 offset:2048
    s_waitcnt lgkmcnt(8)
    v_mfma_f32_16x16x32_bf16 v[56:59], v[120:123], v[112:115], v[56:59]
    ds_read_b64_tr_b16 v[130:131], v144 offset:12800
    v_mfma_f32_16x16x32_bf16 v[84:87], v[112:115], v[124:127], v[84:87]
    v_mfma_f32_16x16x32_bf16 v[28:31], v[116:119], v[112:115], v[28:31]
    ds_read_b128 v[112:115], v143 offset:12288
    s_waitcnt lgkmcnt(7)
    v_mfma_f32_16x16x32_bf16 v[32:35], v[132:135], v[88:91], v[32:35]
    s_waitcnt lgkmcnt(4)
    v_mfma_f32_16x16x32_bf16 v[60:63], v[88:91], v[136:139], v[60:63]
    v_mfma_f32_16x16x32_bf16 v[44:47], v[132:135], v[100:103], v[44:47]
    v_mfma_f32_16x16x32_bf16 v[72:75], v[100:103], v[136:139], v[72:75]
    s_nop 3
    v_cvt_pk_bf16_f32 v32, v32, v33
    v_cvt_pk_bf16_f32 v33, v34, v35
    s_waitcnt lgkmcnt(1)
    v_mfma_f32_16x16x32_bf16 v[16:19], v[128:131], v[100:103], v[16:19]
    v_cvt_pk_bf16_f32 v60, v60, v61
    v_cvt_pk_bf16_f32 v61, v62, v63
    v_mfma_f32_16x16x32_bf16 v[48:51], v[120:123], v[104:107], v[48:51]
    v_cvt_pk_bf16_f32 v34, v44, v45
    v_cvt_pk_bf16_f32 v35, v46, v47
    v_mfma_f32_16x16x32_bf16 v[76:79], v[104:107], v[124:127], v[76:79]
    ds_write_b128 v145, v[32:35] offset:3072
    s_cbranch_scc1 Lx_38
    buffer_store_dwordx4 v[32:35], v7, s[44:47], s70 offen offset:3072 sc1
Lx_38:
    v_mfma_f32_16x16x32_bf16 v[20:23], v[116:119], v[104:107], v[20:23]
    ds_read_b128 v[104:107], v143 offset:8192
    v_cvt_pk_bf16_f32 v62, v72, v73
    s_waitcnt lgkmcnt(2)
    v_mfma_f32_16x16x32_bf16 v[56:59], v[132:135], v[112:115], v[56:59]
    v_cvt_pk_bf16_f32 v63, v74, v75
    ds_write_b128 v145, v[60:63] offset:6144
    v_mfma_f32_16x16x32_bf16 v[84:87], v[112:115], v[136:139], v[84:87]
    s_cbranch_scc1 Lx_39
    buffer_store_dwordx4 v[60:63], v7, s[44:47], s71 offen offset:2048 sc1
Lx_39:
    v_cvt_pk_bf16_f32 v16, v16, v17
    v_mfma_f32_16x16x32_bf16 v[28:31], v[128:131], v[112:115], v[28:31]
    v_cvt_pk_bf16_f32 v17, v18, v19
    v_mfma_f32_16x16x32_bf16 v[40:43], v[120:123], v[96:99], v[40:43]
    v_cvt_pk_bf16_f32 v56, v56, v57
    v_cvt_pk_bf16_f32 v57, v58, v59
    v_mfma_f32_16x16x32_bf16 v[68:71], v[96:99], v[124:127], v[68:71]
    v_cvt_pk_bf16_f32 v58, v84, v85
    v_cvt_pk_bf16_f32 v59, v86, v87
    v_mfma_f32_16x16x32_bf16 v[12:15], v[116:119], v[96:99], v[12:15]
    ds_read_b128 v[96:99], v143 offset:4096
    ds_write_b128 v145, v[56:59] offset:9216
    v_mfma_f32_16x16x32_bf16 v[36:39], v[132:135], v[92:95], v[36:39]
    s_cbranch_scc1 Lx_40
    buffer_store_dwordx4 v[56:59], v7, s[44:47], s72 offen offset:1024 sc1
Lx_40:
    v_cvt_pk_bf16_f32 v18, v28, v29
    v_mfma_f32_16x16x32_bf16 v[64:67], v[92:95], v[136:139], v[64:67]
    v_cvt_pk_bf16_f32 v19, v30, v31
    ds_write_b128 v145, v[16:19] offset:2048
    v_mfma_f32_16x16x32_bf16 v[8:11], v[128:131], v[92:95], v[8:11]
    s_cbranch_scc1 Lx_41
    buffer_store_dwordx4 v[16:19], v7, s[44:47], s70 offen offset:2048 sc1
Lx_41:
    v_mfma_f32_16x16x32_bf16 v[52:55], v[120:123], v[108:111], v[52:55]
    v_cvt_pk_bf16_f32 v36, v36, v37
    v_cvt_pk_bf16_f32 v37, v38, v39
    v_mfma_f32_16x16x32_bf16 v[80:83], v[108:111], v[124:127], v[80:83]
    v_cvt_pk_bf16_f32 v64, v64, v65
    v_cvt_pk_bf16_f32 v65, v66, v67
    v_mfma_f32_16x16x32_bf16 v[24:27], v[116:119], v[108:111], v[24:27]
    ds_read_b128 v[108:111], v143 offset:10240
    v_cvt_pk_bf16_f32 v8, v8, v9
    s_waitcnt lgkmcnt(5)
    v_mfma_f32_16x16x32_bf16 v[48:51], v[132:135], v[104:107], v[48:51]
    v_cvt_pk_bf16_f32 v9, v10, v11
    v_mfma_f32_16x16x32_bf16 v[76:79], v[104:107], v[136:139], v[76:79]
    v_mfma_f32_16x16x32_bf16 v[20:23], v[128:131], v[104:107], v[20:23]
    s_waitcnt lgkmcnt(3)
    v_mfma_f32_16x16x32_bf16 v[40:43], v[132:135], v[96:99], v[40:43]
    s_nop 2
    v_cvt_pk_bf16_f32 v38, v48, v49
    v_cvt_pk_bf16_f32 v39, v50, v51
    v_mfma_f32_16x16x32_bf16 v[68:71], v[96:99], v[136:139], v[68:71]
    ds_write_b128 v145, v[36:39] offset:4096
    s_cbranch_scc1 Lx_42
    buffer_store_dwordx4 v[36:39], v7, s[44:47], s71 offen offset:0 sc1
Lx_42:
    v_mfma_f32_16x16x32_bf16 v[12:15], v[128:131], v[96:99], v[12:15]
    v_cvt_pk_bf16_f32 v66, v76, v77
    v_cvt_pk_bf16_f32 v67, v78, v79
    s_waitcnt lgkmcnt(1)
    v_mfma_f32_16x16x32_bf16 v[52:55], v[132:135], v[108:111], v[52:55]
    ds_write_b128 v145, v[64:67] offset:7168
    s_cbranch_scc1 Lx_43
    buffer_store_dwordx4 v[64:67], v7, s[44:47], s71 offen offset:3072 sc1
Lx_43:
    v_mfma_f32_16x16x32_bf16 v[80:83], v[108:111], v[136:139], v[80:83]
    v_cvt_pk_bf16_f32 v10, v20, v21
    v_cvt_pk_bf16_f32 v11, v22, v23
    v_mfma_f32_16x16x32_bf16 v[24:27], v[128:131], v[108:111], v[24:27]
    ds_write_b128 v145, v[8:11] offset:0
    s_cbranch_scc1 Lx_44
    buffer_store_dwordx4 v[8:11], v7, s[44:47], s70 offen offset:0 sc1
Lx_44:
    s_cmp_eq_u32 s69, 0
    v_cvt_pk_bf16_f32 v40, v40, v41
    v_cvt_pk_bf16_f32 v41, v42, v43
    v_cvt_pk_bf16_f32 v68, v68, v69
    v_cvt_pk_bf16_f32 v69, v70, v71
    v_cvt_pk_bf16_f32 v12, v12, v13
    v_cvt_pk_bf16_f32 v13, v14, v15
    v_cvt_pk_bf16_f32 v42, v52, v53
    v_cvt_pk_bf16_f32 v43, v54, v55
    ds_write_b128 v145, v[40:43] offset:5120
    s_cbranch_scc1 Lx_45
    buffer_store_dwordx4 v[40:43], v7, s[44:47], s71 offen offset:1024 sc1
Lx_45:
    v_cvt_pk_bf16_f32 v70, v80, v81
    v_cvt_pk_bf16_f32 v71, v82, v83
    ds_write_b128 v145, v[68:71] offset:8192
    s_cbranch_scc1 Lx_46
    buffer_store_dwordx4 v[68:71], v7, s[44:47], s72 offen offset:0 sc1
Lx_46:
    v_cvt_pk_bf16_f32 v14, v24, v25
    v_cvt_pk_bf16_f32 v15, v26, v27
    ds_write_b128 v145, v[12:15] offset:1024
    s_cbranch_scc1 Lx_47
    buffer_store_dwordx4 v[12:15], v7, s[44:47], s70 offen offset:1024 sc1
Lx_47:
    s_branch L_pb10b
L_pb10:
    s_mov_b32 s44, s28
    s_and_b32 s45, s29, 0xffff
    s_mov_b32 s46, 16777216
    s_mov_b32 s47, 0x00020000
    s_mul_i32 s33, s33, 1664525
    s_add_u32 s33, s33, 1013904223
    s_setprio 1
L_pb10b:
    v_mov_b32 v165, s33
L_upre:
    v_add_u32 v132, s64, v158
    v_add_u32 v133, s65, v160
    v_add_u32 v134, s65, v161
    s_cmp_eq_u32 s37, 2
    s_cbranch_scc1 L_unit
    v_add_f32 v136, s67, v150
    v_add_f32 v137, s67, v151
    v_add_f32 v138, s67, v152
    v_add_f32 v139, s67, v153
    s_waitcnt lgkmcnt(0)
    s_barrier
L_unit:
    s_cmp_eq_u32 s62, 0
    s_cbranch_scc1 L_ugo
    s_mov_b32 s100, 0
Lw_48:
    ds_read_b32 v4, v3 offset:8
    s_waitcnt lgkmcnt(0)
    v_readfirstlane_b32 s99, v4
    s_cmp_ge_u32 s99, 1
    s_cbranch_scc1 Lwd_49
    s_add_u32 s100, s100, 1
    s_cmp_lt_u32 s100, 8388608
    s_cbranch_scc1 Lw_48
Lwd_49:
    s_setprio 3
L_ugo:
    ds_read_b64 v[104:105], v158 offset:0
    ds_read_b64 v[106:107], v158 offset:10240
    ds_read_b64 v[88:89], v158 offset:3072
    ds_read_b64 v[90:91], v158 offset:13312
    ds_read_b64 v[92:93], v158 offset:4096
    ds_read_b64 v[94:95], v158 offset:14336
    ds_read_b64 v[108:109], v158 offset:1024
    ds_read_b64 v[110:111], v158 offset:11264
    ds_read_b64 v[96:97], v158 offset:5120
    ds_read_b64 v[98:99], v158 offset:15360
    ds_read_b64 v[112:113], v158 offset:2048
    ds_read_b64 v[114:115], v158 offset:12288
    ds_read_b64 v[100:101], v132 offset:0
    ds_read_b64 v[102:103], v132 offset:10240
    s_waitcnt lgkmcnt(12)
    v_and_b32 v106, v106, v159
    v_and_b32 v107, v107, v159
    s_waitcnt lgkmcnt(8)
    s_nop 0
    v_mfma_f32_16x16x32_bf16 v[20:23], v[88:91], v[104:107], v[136:139]
    v_mfma_f32_16x16x32_bf16 v[8:11], v[92:95], v[104:107], v[146:149]
    s_waitcnt lgkmcnt(6)
    v_and_b32 v110, v110, v159
    v_and_b32 v111, v111, v159
    s_waitcnt lgkmcnt(4)
    s_nop 0
    v_mfma_f32_16x16x32_bf16 v[24:27], v[92:95], v[108:111], v[150:153]
    v_mfma_f32_16x16x32_bf16 v[12:15], v[96:99], v[108:111], v[146:149]
    s_waitcnt lgkmcnt(2)
    v_and_b32 v114, v114, v159
    v_and_b32 v115, v115, v159
    s_waitcnt lgkmcnt(0)
    s_nop 0
    v_mfma_f32_16x16x32_bf16 v[28:31], v[96:99], v[112:115], v[150:153]
    v_mfma_f32_16x16x32_bf16 v[16:19], v[100:103], v[112:115], v[146:149]
    ds_read_b64 v[120:121], v160 offset:7168
    ds_read_b64 v[122:123], v160 offset:6144
    ds_read_b64 v[118:119], v160 offset:8192
    ds_read_b64 v[116:117], v133 offset:0
    ds_read_b64 v[128:129], v161 offset:7168
    ds_read_b64 v[130:131], v161 offset:6144
    ds_read_b64 v[126:127], v161 offset:8192
    ds_read_b64 v[124:125], v134 offset:0
    v_max3_f32 v32, v20, v21, v8
    v_max3_f32 v36, v22, v23, v10
    v_max_f32 v32, v32, v9
    v_max_f32 v36, v36, v11
    v_max_f32 v40, v32, v36
    v_max3_f32 v33, v24, v25, v12
    v_max3_f32 v37, v26, v27, v14
    v_max_f32 v33, v33, v13
    v_max_f32 v37, v37, v15
    v_max_f32 v41, v33, v37
    v_max3_f32 v34, v28, v29, v16
    v_max3_f32 v38, v30, v31, v18
    v_max_f32 v34, v34, v17
    v_max_f32 v38, v38, v19
    v_permlane32_swap_b32 v40, v41
    v_max_f32 v42, v34, v38
    v_max_f32 v40, v40, v41
    s_add_u32 s96, s68, 40960
    v_permlane32_swap_b32 v42, v43
    v_max_f32 v42, v42, v43
    s_nop 1
    v_permlane16_swap_b32 v40, v42
    v_max_f32 v40, v40, v42
    v_mul_f32 v42, s66, v40
    v_mul_f32 v40, s66, v40
    s_nop 1
    v_permlane16_swap_b32 v40, v42
    v_mov_b32 v41, v40
    v_mov_b32 v43, v42
    s_nop 0
    v_permlane32_swap_b32 v40, v41
    v_permlane32_swap_b32 v42, v43
    v_fma_f32 v32, v32, s66, -v40
    v_fma_f32 v36, v36, s66, -v40
    v_fma_f32 v33, v33, s66, -v41
    v_fma_f32 v37, v37, s66, -v41
    v_fma_f32 v34, v34, s66, -v42
    v_fma_f32 v38, v38, s66, -v42
    v_exp_f32 v32, v32
    v_exp_f32 v36, v36
    v_exp_f32 v33, v33
    v_exp_f32 v37, v37
    v_exp_f32 v34, v34
    v_exp_f32 v38, v38
    v_add_f32 v40, v32, v36
    v_add_f32 v41, v33, v37
    v_add_f32 v42, v34, v38
    s_waitcnt lgkmcnt(0)
    v_permlane32_swap_b32 v40, v41
    v_permlane32_swap_b32 v42, v43
    v_add_f32 v40, v40, v41
    v_add_f32 v42, v42, v43
    s_nop 1
    v_permlane16_swap_b32 v40, v42
    v_add_f32 v40, v40, v42
    v_rcp_f32 v42, v40
    v_rcp_f32 v40, v40
    s_nop 1
    v_permlane16_swap_b32 v40, v42
    v_mov_b32 v41, v40
    v_mov_b32 v43, v42
    s_nop 0
    v_permlane32_swap_b32 v40, v41
    v_permlane32_swap_b32 v42, v43
    v_mul_f32 v32, v32, v40
    v_mul_f32 v36, v36, v40
    v_cvt_pk_bf16_f32 v32, v32, v36
    v_perm_b32 v44, v32, v32, v154
    v_perm_b32 v45, v32, v32, v155
    v_perm_b32 v46, v32, v32, v156
    v_perm_b32 v47, v32, v32, v157
    v_mul_f32 v33, v33, v41
    v_mul_f32 v37, v37, v41
    v_cvt_pk_bf16_f32 v33, v33, v37
    v_perm_b32 v48, v33, v33, v154
    v_perm_b32 v49, v33, v33, v155
    v_perm_b32 v50, v33, v33, v156
    v_perm_b32 v51, v33, v33, v157
    v_mfma_f32_16x16x32_bf16 v[8:11], v[120:123], v[44:47], 0
    v_mfma_f32_16x16x32_bf16 v[20:23], v[128:131], v[44:47], 0
    v_mul_f32 v34, v34, v42
    v_mul_f32 v38, v38, v42
    v_cvt_pk_bf16_f32 v34, v34, v38
    v_perm_b32 v52, v34, v34, v154
    v_perm_b32 v53, v34, v34, v155
    v_perm_b32 v54, v34, v34, v156
    v_perm_b32 v55, v34, v34, v157
    v_mfma_f32_16x16x32_bf16 v[12:15], v[118:121], v[48:51], 0
    v_mfma_f32_16x16x32_bf16 v[24:27], v[126:129], v[48:51], 0
    v_mfma_f32_16x16x32_bf16 v[16:19], v[116:119], v[52:55], 0
    v_mfma_f32_16x16x32_bf16 v[28:31], v[124:127], v[52:55], 0
    s_cmp_eq_u32 s69, 0
    s_cbranch_scc1 Lxs_50
    s_waitcnt vmcnt(0)
    s_atomic_swap s33, s[28:29], s69
Lxs_50:
    v_cvt_pk_bf16_f32 v60, v8, v9
    v_cvt_pk_bf16_f32 v61, v10, v11
    v_cvt_pk_bf16_f32 v68, v20, v21
    v_cvt_pk_bf16_f32 v69, v22, v23
    v_cvt_pk_bf16_f32 v62, v12, v13
    v_cvt_pk_bf16_f32 v63, v14, v15
    s_nop 0
    v_permlane32_swap_b32 v60, v62
    v_permlane32_swap_b32 v61, v63
    buffer_store_dwordx4 v[60:63], v162, s[44:47], s68 offen sc1
    v_cvt_pk_bf16_f32 v64, v16, v17
    v_cvt_pk_bf16_f32 v65, v18, v19
    s_nop 0
    v_permlane32_swap_b32 v64, v66
    v_permlane32_swap_b32 v65, v67
    s_mov_b32 exec_lo, 0
    v_cvt_pk_bf16_f32 v68, v28, v29
    v_cvt_pk_bf16_f32 v69, v30, v31
    s_mov_b64 exec, 0xffff0000
    v_cvt_pk_bf16_f32 v68, v24, v25
    v_cvt_pk_bf16_f32 v69, v26, v27
    s_mov_b32 exec_lo, -1
    buffer_store_dwordx4 v[64:67], v162, s[44:47], s96 offen sc1
    s_mov_b32 exec_hi, 0xffff
    buffer_store_dwordx2 v[68:69], v163, s[44:47], s68 offen sc1
    s_mov_b64 exec, -1
    s_cmp_lg_u32 s37, 0
    s_cbranch_scc1 L_nops
    s_lshr_b32 s75, s60, 1
    s_lshl_b32 s96, s75, 13
    s_add_u32 s72, s68, s96
    s_add_u32 s73, s72, 20480
    s_add_u32 s74, s72, 40960
    s_lshl_b32 s96, s31, 5
    s_add_u32 s96, s96, s30
    s_lshl_b32 s96, s96, 11
    s_add_u32 s96, s96, 263168
    s_lshl_b32 s97, s60, 8
    s_add_u32 s96, s96, s97
    s_add_u32 s76, s28, s96
    s_addc_u32 s77, s29, 0
    s_mul_i32 s80, s60, 6144
    s_add_u32 s80, s80, 81920
    s_xor_b32 s96, s60, 2
    s_mul_i32 s81, s96, 6144
    s_add_u32 s81, s81, 81920
    s_mul_i32 s82, s61, 12288
    s_lshl_b32 s96, s75, 11
    s_add_u32 s82, s82, s96
    s_add_u32 s82, s82, 133632
    s_lshl1_add_u32 s96, s30, s61
    s_mul_i32 s79, s96, 61440
    s_lshl1_add_u32 s96, s31, s75
    s_lshl_b32 s96, s96, 6
    s_add_u32 s79, s79, s96
    s_mov_b32 s48, s24
    s_and_b32 s49, s25, 0xffff
    s_mov_b32 s50, 2621440
    s_mov_b32 s51, 0x00020000
    v_lshrrev_b32 v58, 2, v0
    v_and_b32 v59, 3, v0
    v_bfe_u32 v57, v0, 3, 2
    s_mul_i32 s96, s75, 6144
    s_sub_u32 s96, 16384, s96
    v_lshl_add_u32 v7, v0, 3, s96
    s_mul_i32 s96, s75, 40960
    v_lshl_add_u32 v5, v58, 7, s96
    v_lshl_add_u32 v5, v59, 3, v5
    s_lshl_b32 s96, s75, 1
    v_xor_b32 v6, s96, v57
    v_lshl_add_u32 v160, v6, 5, v5
    v_xor_b32 v161, 32, v160
    v_xor_b32 v162, 64, v160
    v_xor_b32 v163, 96, v160
    v_lshlrev_b32 v5, 4, v0
    v_add_u32 v6, 4096, v5
    v_xor_b32 v59, v59, v57
    v_mul_u32_u24 v58, 1280, v58
    v_lshl_add_u32 v58, v59, 4, v58
    s_mul_i32 s96, s61, 192
    s_add_u32 s96, s96, 161088
    v_lshl_add_u32 v57, v1, 2, s96
    v_bfe_u32 v59, v1, 1, 2
    v_lshl_add_u32 v1, v1, 6, s81
    v_lshlrev_b32 v59, 1, v59
    v_xor_b32 v59, v59, v2
    v_lshl_add_u32 v1, v59, 3, v1
    v_mov_b32 v2, v58
L_nops:
    s_lshl_b32 s96, s62, 4
    v_add_u32 v56, s96, v3
    v_mov_b32 v4, 1
    s_mov_b64 exec, 1
    ds_add_u32 v56, v4 offset:0
    s_mov_b64 exec, -1
    s_cmp_lg_u32 s37, 0
    s_cbranch_scc1 L_lsig
    s_lshl_b32 s96, s61, 3
    v_add_u32 v56, s96, v3
    s_waitcnt vmcnt(0)
    v_mov_b32 v4, 1
    s_mov_b64 exec, 1
    ds_add_rtn_u32 v4, v56, v4 offset:24
    s_waitcnt lgkmcnt(0)
    v_readfirstlane_b32 s97, v4
    s_mov_b64 exec, -1
    s_cmp_lg_u32 s97, 1
    s_cbranch_scc1 L_nosig
L_lsig:
    s_waitcnt vmcnt(0)
    s_mov_b64 exec, 0x3ff
    global_atomic_swap v164, v165, s[28:29] sc1
    s_mov_b64 exec, -1
L_nosig:
    s_cmp_eq_u32 s37, 0
    s_cbranch_scc1 L_op
    s_lshr_b32 s97, s36, 2
    s_andn2_b32 s96, s97, s62
    s_cbranch_scc0 L_pexit
    s_mov_b32 s62, 1
    s_mov_b32 s37, 2
    s_branch L_us
L_op:
    s_lshl_b32 s85, s36, 10
    s_mov_b32 s100, 0
    v_mov_b32 v116, v57
    s_load_dwordx16 s[4:19], s[76:77], 0 glc
    s_load_dwordx8 s[20:27], s[76:77], 64 glc
    s_waitcnt lgkmcnt(0)
L_nb0:
    s_cmp_lg_u32 s4, s33
    s_cbranch_scc1 L_ns0
L_ng0:
    s_add_u32 s96, s72, s85
    buffer_load_dwordx4 v[56:59], v5, s[44:47], s96 offen sc1
    s_add_u32 s96, s73, s85
    buffer_load_dwordx4 v[60:63], v5, s[44:47], s96 offen sc1
    s_add_u32 s96, s74, s85
    buffer_load_dwordx4 v[64:67], v5, s[44:47], s96 offen sc1
    s_add_u32 s85, s85, 1024
    s_cmp_eq_u32 s85, 5120
    s_cselect_b32 s85, 0, s85
    s_mov_b32 s86, s100
    s_mov_b32 s100, 0
Lw_51:
    ds_read_b32 v4, v3 offset:4
    s_waitcnt lgkmcnt(0)
    v_readfirstlane_b32 s99, v4
    s_cmp_ge_u32 s99, 2
    s_cbranch_scc1 Lwd_52
    s_add_u32 s100, s100, 1
    s_cmp_lt_u32 s100, 8388608
    s_cbranch_scc1 Lw_51
Lwd_52:
    s_mov_b32 s100, s86
    ds_read_b64_tr_b16 v[140:141], v160 offset:0
    ds_read_b64_tr_b16 v[142:143], v160 offset:2048
    ds_read_b64_tr_b16 v[144:145], v161 offset:0
    ds_read_b64_tr_b16 v[146:147], v161 offset:2048
    ds_read_b64_tr_b16 v[148:149], v162 offset:0
    ds_read_b64_tr_b16 v[150:151], v162 offset:2048
    ds_read_b64_tr_b16 v[152:153], v163 offset:0
    ds_read_b64_tr_b16 v[154:155], v163 offset:2048
    ds_read_b64_tr_b16 v[156:157], v160 offset:4096
    ds_read_b64_tr_b16 v[158:159], v160 offset:6144
L_nb1:
    s_cmp_lg_u32 s6, s33
    s_cbranch_scc1 L_ns1
L_ng1:
    s_add_u32 s96, s72, s85
    buffer_load_dwordx4 v[68:71], v5, s[44:47], s96 offen sc1
    s_add_u32 s96, s73, s85
    buffer_load_dwordx4 v[72:75], v5, s[44:47], s96 offen sc1
    s_add_u32 s96, s74, s85
    buffer_load_dwordx4 v[76:79], v5, s[44:47], s96 offen sc1
    s_add_u32 s85, s85, 1024
    s_cmp_eq_u32 s85, 5120
    s_cselect_b32 s85, 0, s85
L_nb2:
    s_cmp_lg_u32 s8, s33
    s_cbranch_scc1 L_ns2
L_ng2:
    s_add_u32 s96, s72, s85
    buffer_load_dwordx4 v[80:83], v5, s[44:47], s96 offen sc1
    s_add_u32 s96, s73, s85
    buffer_load_dwordx4 v[84:87], v5, s[44:47], s96 offen sc1
    s_add_u32 s96, s74, s85
    buffer_load_dwordx4 v[88:91], v5, s[44:47], s96 offen sc1
    s_add_u32 s85, s85, 1024
    s_cmp_eq_u32 s85, 5120
    s_cselect_b32 s85, 0, s85
L_nb3:
    s_cmp_lg_u32 s10, s33
    s_cbranch_scc1 L_ns3
L_ng3:
    s_add_u32 s96, s72, s85
    buffer_load_dwordx4 v[92:95], v5, s[44:47], s96 offen sc1
    s_add_u32 s96, s73, s85
    buffer_load_dwordx4 v[96:99], v5, s[44:47], s96 offen sc1
    s_add_u32 s96, s74, s85
    buffer_load_dwordx4 v[100:103], v5, s[44:47], s96 offen sc1
    s_add_u32 s85, s85, 1024
    s_cmp_eq_u32 s85, 5120
    s_cselect_b32 s85, 0, s85

L_nb4:
    s_cmp_lg_u32 s12, s33
    s_cbranch_scc1 L_ns4
L_ng4:
    s_cmp_lg_u32 s14, s33
    s_cbranch_scc1 Lar_54
    s_cmp_eq_u32 s16, s33
    s_cbranch_scc1 Lah_53
Lar_54:
    s_load_dwordx16 s[4:19], s[76:77], 0 glc
Lah_53:
    s_waitcnt vmcnt(11)
    s_waitcnt lgkmcnt(8)
    v_mfma_f32_16x16x32_bf16 v[8:11], v[140:143], v[56:59], 0
    s_add_u32 s96, s72, s85
    buffer_load_dwordx4 v[104:107], v5, s[44:47], s96 offen sc1
    s_waitcnt vmcnt(11)
    v_mfma_f32_16x16x32_bf16 v[24:27], v[140:143], v[60:63], 0
    s_add_u32 s96, s73, s85
    buffer_load_dwordx4 v[108:111], v5, s[44:47], s96 offen sc1
    s_waitcnt vmcnt(11)
    v_mfma_f32_16x16x32_bf16 v[40:43], v[140:143], v[64:67], 0
    ds_read_b64_tr_b16 v[140:141], v161 offset:4096
    ds_read_b64_tr_b16 v[142:143], v161 offset:6144
    s_waitcnt lgkmcnt(8)
    v_mfma_f32_16x16x32_bf16 v[12:15], v[144:147], v[56:59], 0
    s_add_u32 s96, s74, s85
    buffer_load_dwordx4 v[112:115], v5, s[44:47], s96 offen sc1
    v_mfma_f32_16x16x32_bf16 v[28:31], v[144:147], v[60:63], 0
    v_mfma_f32_16x16x32_bf16 v[44:47], v[144:147], v[64:67], 0
    ds_read_b64_tr_b16 v[144:145], v162 offset:4096
    ds_read_b64_tr_b16 v[146:147], v162 offset:6144
    s_waitcnt lgkmcnt(8)
    v_mfma_f32_16x16x32_bf16 v[16:19], v[148:151], v[56:59], 0
    v_mfma_f32_16x16x32_bf16 v[32:35], v[148:151], v[60:63], 0
    v_mfma_f32_16x16x32_bf16 v[48:51], v[148:151], v[64:67], 0
    ds_read_b64_tr_b16 v[148:149], v163 offset:4096
    ds_read_b64_tr_b16 v[150:151], v163 offset:6144
    s_waitcnt lgkmcnt(8)
    v_mfma_f32_16x16x32_bf16 v[20:23], v[152:155], v[56:59], 0
    v_mfma_f32_16x16x32_bf16 v[36:39], v[152:155], v[60:63], 0
    v_mfma_f32_16x16x32_bf16 v[52:55], v[152:155], v[64:67], 0
    ds_read_b64_tr_b16 v[152:153], v160 offset:8192
    ds_read_b64_tr_b16 v[154:155], v160 offset:10240
    s_cmp_lg_u32 s14, s33
    s_cbranch_scc1 Lar_56
    s_cmp_eq_u32 s16, s33
    s_cbranch_scc1 Lah_55
Lar_56:
    s_load_dwordx16 s[4:19], s[76:77], 0 glc
Lah_55:
    s_waitcnt vmcnt(11)
    s_waitcnt lgkmcnt(8)
    v_mfma_f32_16x16x32_bf16 v[8:11], v[156:159], v[68:71], v[8:11]
    buffer_load_dwordx2 v[56:57], v7, s[44:47], s72 offen offset:0 sc1
    s_waitcnt vmcnt(11)
    v_mfma_f32_16x16x32_bf16 v[24:27], v[156:159], v[72:75], v[24:27]
    buffer_load_dwordx2 v[58:59], v7, s[44:47], s72 offen offset:512 sc1
    s_waitcnt vmcnt(11)
    v_mfma_f32_16x16x32_bf16 v[40:43], v[156:159], v[76:79], v[40:43]
    ds_read_b64_tr_b16 v[156:157], v161 offset:8192
    ds_read_b64_tr_b16 v[158:159], v161 offset:10240
    s_waitcnt lgkmcnt(8)
    v_mfma_f32_16x16x32_bf16 v[12:15], v[140:143], v[68:71], v[12:15]
    buffer_load_dwordx2 v[60:61], v7, s[44:47], s73 offen offset:0 sc1
    v_mfma_f32_16x16x32_bf16 v[28:31], v[140:143], v[72:75], v[28:31]
    buffer_load_dwordx2 v[62:63], v7, s[44:47], s73 offen offset:512 sc1
    v_mfma_f32_16x16x32_bf16 v[44:47], v[140:143], v[76:79], v[44:47]
    ds_read_b64_tr_b16 v[140:141], v162 offset:8192
    ds_read_b64_tr_b16 v[142:143], v162 offset:10240
    s_waitcnt lgkmcnt(8)
    v_mfma_f32_16x16x32_bf16 v[16:19], v[144:147], v[68:71], v[16:19]
    buffer_load_dwordx2 v[64:65], v7, s[44:47], s74 offen offset:0 sc1
    v_mfma_f32_16x16x32_bf16 v[32:35], v[144:147], v[72:75], v[32:35]
    buffer_load_dwordx2 v[66:67], v7, s[44:47], s74 offen offset:512 sc1
    v_mfma_f32_16x16x32_bf16 v[48:51], v[144:147], v[76:79], v[48:51]
    ds_read_b64_tr_b16 v[144:145], v163 offset:8192
    ds_read_b64_tr_b16 v[146:147], v163 offset:10240
    s_waitcnt lgkmcnt(8)
    v_mfma_f32_16x16x32_bf16 v[20:23], v[148:151], v[68:71], v[20:23]
    v_mfma_f32_16x16x32_bf16 v[36:39], v[148:151], v[72:75], v[36:39]
    v_mfma_f32_16x16x32_bf16 v[52:55], v[148:151], v[76:79], v[52:55]
    ds_read_b64_tr_b16 v[148:149], v160 offset:12288
    ds_read_b64_tr_b16 v[150:151], v160 offset:14336
L_nb6:
    s_cmp_lg_u32 s14, s33
    s_cbranch_scc1 L_ns6
    s_cmp_lg_u32 s16, s33
    s_cbranch_scc1 L_ns6
L_ng6:
    s_cmp_lg_u32 s18, s33
    s_cbranch_scc1 Lar_58
    s_cmp_eq_u32 s20, s33
    s_cbranch_scc1 Lah_57
Lar_58:
    s_load_dwordx16 s[4:19], s[76:77], 0 glc
    s_load_dwordx8 s[20:27], s[76:77], 64 glc
Lah_57:
    s_waitcnt vmcnt(14)
    s_waitcnt lgkmcnt(8)
    v_mfma_f32_16x16x32_bf16 v[8:11], v[152:155], v[80:83], v[8:11]
    buffer_load_dwordx4 v[68:71], v6, s[44:47], s72 offen offset:1024 sc1
    s_waitcnt vmcnt(14)
    v_mfma_f32_16x16x32_bf16 v[24:27], v[152:155], v[84:87], v[24:27]
    buffer_load_dwordx4 v[72:75], v6, s[44:47], s73 offen offset:1024 sc1
    s_waitcnt vmcnt(14)
    v_mfma_f32_16x16x32_bf16 v[40:43], v[152:155], v[88:91], v[40:43]
    ds_read_b64_tr_b16 v[152:153], v161 offset:12288
    ds_read_b64_tr_b16 v[154:155], v161 offset:14336
    s_waitcnt lgkmcnt(8)
    v_mfma_f32_16x16x32_bf16 v[12:15], v[156:159], v[80:83], v[12:15]
    buffer_load_dwordx4 v[76:79], v6, s[44:47], s74 offen offset:1024 sc1
    v_mfma_f32_16x16x32_bf16 v[28:31], v[156:159], v[84:87], v[28:31]
    v_mfma_f32_16x16x32_bf16 v[44:47], v[156:159], v[88:91], v[44:47]
    ds_read_b64_tr_b16 v[156:157], v162 offset:12288
    ds_read_b64_tr_b16 v[158:159], v162 offset:14336
    s_waitcnt lgkmcnt(8)
    v_mfma_f32_16x16x32_bf16 v[16:19], v[140:143], v[80:83], v[16:19]
    v_mfma_f32_16x16x32_bf16 v[32:35], v[140:143], v[84:87], v[32:35]
    v_mfma_f32_16x16x32_bf16 v[48:51], v[140:143], v[88:91], v[48:51]
    ds_read_b64_tr_b16 v[140:141], v163 offset:12288
    ds_read_b64_tr_b16 v[142:143], v163 offset:14336
    s_waitcnt lgkmcnt(8)
    v_mfma_f32_16x16x32_bf16 v[20:23], v[144:147], v[80:83], v[20:23]
    v_mfma_f32_16x16x32_bf16 v[36:39], v[144:147], v[84:87], v[36:39]
    v_mfma_f32_16x16x32_bf16 v[52:55], v[144:147], v[88:91], v[52:55]
    ds_read_b64_tr_b16 v[144:145], v160 offset:16384
    ds_read_b64_tr_b16 v[146:147], v160 offset:18432
    s_load_dwordx16 s[4:19], s[76:77], 0 glc
    s_load_dwordx8 s[20:27], s[76:77], 64 glc
    s_waitcnt vmcnt(14)
    s_waitcnt lgkmcnt(8)
    v_mfma_f32_16x16x32_bf16 v[8:11], v[148:151], v[92:95], v[8:11]
    s_waitcnt vmcnt(13)
    v_mfma_f32_16x16x32_bf16 v[24:27], v[148:151], v[96:99], v[24:27]
    s_waitcnt vmcnt(12)
    v_mfma_f32_16x16x32_bf16 v[40:43], v[148:151], v[100:103], v[40:43]
    ds_read_b64_tr_b16 v[148:149], v161 offset:16384
    ds_read_b64_tr_b16 v[150:151], v161 offset:18432
    s_waitcnt lgkmcnt(8)
    v_mfma_f32_16x16x32_bf16 v[12:15], v[152:155], v[92:95], v[12:15]
    v_mfma_f32_16x16x32_bf16 v[28:31], v[152:155], v[96:99], v[28:31]
    v_mfma_f32_16x16x32_bf16 v[44:47], v[152:155], v[100:103], v[44:47]
    ds_read_b64_tr_b16 v[152:153], v162 offset:16384
    ds_read_b64_tr_b16 v[154:155], v162 offset:18432
    s_waitcnt lgkmcnt(8)
    v_mfma_f32_16x16x32_bf16 v[16:19], v[156:159], v[92:95], v[16:19]
    v_mfma_f32_16x16x32_bf16 v[32:35], v[156:159], v[96:99], v[32:35]
    v_mfma_f32_16x16x32_bf16 v[48:51], v[156:159], v[100:103], v[48:51]
    ds_read_b64_tr_b16 v[156:157], v163 offset:16384
    ds_read_b64_tr_b16 v[158:159], v163 offset:18432
    s_waitcnt lgkmcnt(8)
    v_mfma_f32_16x16x32_bf16 v[20:23], v[140:143], v[92:95], v[20:23]
    v_mfma_f32_16x16x32_bf16 v[36:39], v[140:143], v[96:99], v[36:39]
    v_mfma_f32_16x16x32_bf16 v[52:55], v[140:143], v[100:103], v[52:55]
    ds_read_b64_tr_b16 v[140:141], v160 offset:20480
    ds_read_b64_tr_b16 v[142:143], v160 offset:22528
    s_waitcnt vmcnt(11)
    s_waitcnt lgkmcnt(8)
    v_mfma_f32_16x16x32_bf16 v[8:11], v[144:147], v[104:107], v[8:11]
    s_waitcnt vmcnt(10)
    v_mfma_f32_16x16x32_bf16 v[24:27], v[144:147], v[108:111], v[24:27]
    s_waitcnt vmcnt(9)
    v_mfma_f32_16x16x32_bf16 v[40:43], v[144:147], v[112:115], v[40:43]
    ds_read_b64_tr_b16 v[144:145], v161 offset:20480
    ds_read_b64_tr_b16 v[146:147], v161 offset:22528
    s_waitcnt lgkmcnt(8)
    v_mfma_f32_16x16x32_bf16 v[12:15], v[148:151], v[104:107], v[12:15]
    v_mfma_f32_16x16x32_bf16 v[28:31], v[148:151], v[108:111], v[28:31]
    v_mfma_f32_16x16x32_bf16 v[44:47], v[148:151], v[112:115], v[44:47]
    ds_read_b64_tr_b16 v[148:149], v162 offset:20480
    ds_read_b64_tr_b16 v[150:151], v162 offset:22528
    s_waitcnt lgkmcnt(8)
    v_mfma_f32_16x16x32_bf16 v[16:19], v[152:155], v[104:107], v[16:19]
    v_mfma_f32_16x16x32_bf16 v[32:35], v[152:155], v[108:111], v[32:35]
    v_mfma_f32_16x16x32_bf16 v[48:51], v[152:155], v[112:115], v[48:51]
    ds_read_b64_tr_b16 v[152:153], v163 offset:20480
    ds_read_b64_tr_b16 v[154:155], v163 offset:22528
    s_waitcnt lgkmcnt(8)
    v_mfma_f32_16x16x32_bf16 v[20:23], v[156:159], v[104:107], v[20:23]
    v_mfma_f32_16x16x32_bf16 v[36:39], v[156:159], v[108:111], v[36:39]
    v_mfma_f32_16x16x32_bf16 v[52:55], v[156:159], v[112:115], v[52:55]
    ds_read_b64_tr_b16 v[156:157], v160 offset:24576
    ds_read_b64_tr_b16 v[158:159], v160 offset:26624
L_nb7:
    s_cmp_lg_u32 s18, s33
    s_cbranch_scc1 L_ns7
    s_cmp_lg_u32 s20, s33
    s_cbranch_scc1 L_ns7
L_ng7:
L_nb8:
    s_cmp_lg_u32 s22, s33
    s_cbranch_scc1 L_ns8
    s_cmp_lg_u32 s24, s33
    s_cbranch_scc1 L_ns8
L_ng8:
    buffer_load_dwordx4 v[80:83], v6, s[44:47], s72 offen offset:2048 sc1
    buffer_load_dwordx4 v[84:87], v6, s[44:47], s73 offen offset:2048 sc1
    buffer_load_dwordx4 v[88:91], v6, s[44:47], s74 offen offset:2048 sc1
    s_waitcnt vmcnt(10)
    s_waitcnt lgkmcnt(8)
    v_mfma_f32_16x16x32_bf16 v[8:11], v[140:143], v[56:59], v[8:11]
    buffer_load_dwordx4 v[92:95], v6, s[44:47], s72 offen offset:3072 sc1
    s_waitcnt vmcnt(9)
    v_mfma_f32_16x16x32_bf16 v[24:27], v[140:143], v[60:63], v[24:27]
    buffer_load_dwordx4 v[96:99], v6, s[44:47], s73 offen offset:3072 sc1
    s_waitcnt vmcnt(8)
    v_mfma_f32_16x16x32_bf16 v[40:43], v[140:143], v[64:67], v[40:43]
    buffer_load_dwordx4 v[100:103], v6, s[44:47], s74 offen offset:3072 sc1
    ds_read_b64_tr_b16 v[140:141], v161 offset:24576
    ds_read_b64_tr_b16 v[142:143], v161 offset:26624
    s_waitcnt lgkmcnt(8)
    v_mfma_f32_16x16x32_bf16 v[12:15], v[144:147], v[56:59], v[12:15]
    buffer_load_dwordx2 v[104:105], v7, s[44:47], s72 offen offset:1024 sc1
    v_mfma_f32_16x16x32_bf16 v[28:31], v[144:147], v[60:63], v[28:31]
    buffer_load_dwordx2 v[106:107], v7, s[44:47], s72 offen offset:1536 sc1
    v_mfma_f32_16x16x32_bf16 v[44:47], v[144:147], v[64:67], v[44:47]
    buffer_load_dwordx2 v[108:109], v7, s[44:47], s73 offen offset:1024 sc1
    ds_read_b64_tr_b16 v[144:145], v162 offset:24576
    ds_read_b64_tr_b16 v[146:147], v162 offset:26624
    s_waitcnt lgkmcnt(8)
    v_mfma_f32_16x16x32_bf16 v[16:19], v[148:151], v[56:59], v[16:19]
    buffer_load_dwordx2 v[110:111], v7, s[44:47], s73 offen offset:1536 sc1
    v_mfma_f32_16x16x32_bf16 v[32:35], v[148:151], v[60:63], v[32:35]
    buffer_load_dwordx2 v[112:113], v7, s[44:47], s74 offen offset:1024 sc1
    v_mfma_f32_16x16x32_bf16 v[48:51], v[148:151], v[64:67], v[48:51]
    buffer_load_dwordx2 v[114:115], v7, s[44:47], s74 offen offset:1536 sc1
    ds_read_b64_tr_b16 v[148:149], v163 offset:24576
    ds_read_b64_tr_b16 v[150:151], v163 offset:26624
    s_waitcnt lgkmcnt(8)
    v_mfma_f32_16x16x32_bf16 v[20:23], v[152:155], v[56:59], v[20:23]
    v_mfma_f32_16x16x32_bf16 v[36:39], v[152:155], v[60:63], v[36:39]
    v_mfma_f32_16x16x32_bf16 v[52:55], v[152:155], v[64:67], v[52:55]
    ds_read_b64_tr_b16 v[152:153], v160 offset:28672
    ds_read_b64_tr_b16 v[154:155], v160 offset:30720
    s_waitcnt vmcnt(14)
    s_waitcnt lgkmcnt(8)
    v_mfma_f32_16x16x32_bf16 v[8:11], v[156:159], v[68:71], v[8:11]
    s_waitcnt vmcnt(13)
    v_mfma_f32_16x16x32_bf16 v[24:27], v[156:159], v[72:75], v[24:27]
    s_waitcnt vmcnt(12)
    v_mfma_f32_16x16x32_bf16 v[40:43], v[156:159], v[76:79], v[40:43]
    ds_read_b64_tr_b16 v[156:157], v161 offset:28672
    ds_read_b64_tr_b16 v[158:159], v161 offset:30720
    s_waitcnt lgkmcnt(8)
    v_mfma_f32_16x16x32_bf16 v[12:15], v[140:143], v[68:71], v[12:15]
    v_mfma_f32_16x16x32_bf16 v[28:31], v[140:143], v[72:75], v[28:31]
    v_mfma_f32_16x16x32_bf16 v[44:47], v[140:143], v[76:79], v[44:47]
    ds_read_b64_tr_b16 v[140:141], v162 offset:28672
    ds_read_b64_tr_b16 v[142:143], v162 offset:30720
    s_waitcnt lgkmcnt(8)
    v_mfma_f32_16x16x32_bf16 v[16:19], v[144:147], v[68:71], v[16:19]
    v_mfma_f32_16x16x32_bf16 v[32:35], v[144:147], v[72:75], v[32:35]
    v_mfma_f32_16x16x32_bf16 v[48:51], v[144:147], v[76:79], v[48:51]
    ds_read_b64_tr_b16 v[144:145], v163 offset:28672
    ds_read_b64_tr_b16 v[146:147], v163 offset:30720
    s_waitcnt lgkmcnt(8)
    v_mfma_f32_16x16x32_bf16 v[20:23], v[148:151], v[68:71], v[20:23]
    v_mfma_f32_16x16x32_bf16 v[36:39], v[148:151], v[72:75], v[36:39]
    v_mfma_f32_16x16x32_bf16 v[52:55], v[148:151], v[76:79], v[52:55]
    ds_read_b64_tr_b16 v[148:149], v162 offset:32768
    ds_read_b64_tr_b16 v[150:151], v162 offset:34816
    s_waitcnt vmcnt(11)
    s_waitcnt lgkmcnt(8)
    v_mfma_f32_16x16x32_bf16 v[8:11], v[152:155], v[80:83], v[8:11]
    s_waitcnt vmcnt(10)
    v_mfma_f32_16x16x32_bf16 v[24:27], v[152:155], v[84:87], v[24:27]
    s_waitcnt vmcnt(9)
    v_mfma_f32_16x16x32_bf16 v[40:43], v[152:155], v[88:91], v[40:43]
    ds_read_b64_tr_b16 v[152:153], v163 offset:32768
    ds_read_b64_tr_b16 v[154:155], v163 offset:34816
    s_waitcnt lgkmcnt(8)
    v_mfma_f32_16x16x32_bf16 v[12:15], v[156:159], v[80:83], v[12:15]
    v_mfma_f32_16x16x32_bf16 v[28:31], v[156:159], v[84:87], v[28:31]
    v_mfma_f32_16x16x32_bf16 v[44:47], v[156:159], v[88:91], v[44:47]
    ds_read_b64_tr_b16 v[156:157], v162 offset:36864
    ds_read_b64_tr_b16 v[158:159], v162 offset:38912
    s_waitcnt lgkmcnt(8)
    v_mfma_f32_16x16x32_bf16 v[16:19], v[140:143], v[80:83], v[16:19]
    v_mfma_f32_16x16x32_bf16 v[32:35], v[140:143], v[84:87], v[32:35]
    v_mfma_f32_16x16x32_bf16 v[48:51], v[140:143], v[88:91], v[48:51]
    ds_read_b64_tr_b16 v[140:141], v163 offset:36864
    ds_read_b64_tr_b16 v[142:143], v163 offset:38912
    s_waitcnt lgkmcnt(8)
    v_mfma_f32_16x16x32_bf16 v[20:23], v[144:147], v[80:83], v[20:23]
    v_mfma_f32_16x16x32_bf16 v[36:39], v[144:147], v[84:87], v[36:39]
    v_mfma_f32_16x16x32_bf16 v[52:55], v[144:147], v[88:91], v[52:55]
    ds_read_b64_tr_b16 v[144:145], v160 offset:32768
    ds_read_b64_tr_b16 v[146:147], v160 offset:34816
    s_waitcnt vmcnt(8)
    s_waitcnt lgkmcnt(8)
    v_mfma_f32_16x16x32_bf16 v[16:19], v[148:151], v[92:95], v[16:19]
    s_waitcnt vmcnt(7)
    v_mfma_f32_16x16x32_bf16 v[32:35], v[148:151], v[96:99], v[32:35]
    s_waitcnt vmcnt(6)
    v_mfma_f32_16x16x32_bf16 v[48:51], v[148:151], v[100:103], v[48:51]
    ds_read_b64_tr_b16 v[148:149], v161 offset:32768
    ds_read_b64_tr_b16 v[150:151], v161 offset:34816
    ds_read2_b32 v[120:121], v3 offset0:0 offset1:4
    v_add_u32 v6, s80, v5
    v_add_u32 v7, s82, v5
    v_add_u32 v5, s81, v5
    s_waitcnt lgkmcnt(9)
    v_mfma_f32_16x16x32_bf16 v[20:23], v[152:155], v[92:95], v[20:23]
    v_mfma_f32_16x16x32_bf16 v[36:39], v[152:155], v[96:99], v[36:39]
    v_mfma_f32_16x16x32_bf16 v[52:55], v[152:155], v[100:103], v[52:55]
    ds_read_b64_tr_b16 v[152:153], v160 offset:36864
    ds_read_b64_tr_b16 v[154:155], v160 offset:38912
    s_lshl_b32 s96, s60, 2
    v_add_u32 v164, s96, v3
    v_xor_b32 v165, 8, v164
    s_lshl_b32 s96, s75, 2
    v_add_u32 v166, s96, v3
    s_waitcnt vmcnt(4)
    s_waitcnt lgkmcnt(9)
    v_mfma_f32_16x16x32_bf16 v[16:19], v[156:159], v[104:107], v[16:19]
    s_waitcnt vmcnt(2)
    v_mfma_f32_16x16x32_bf16 v[32:35], v[156:159], v[108:111], v[32:35]
    s_waitcnt vmcnt(0)
    v_mfma_f32_16x16x32_bf16 v[48:51], v[156:159], v[112:115], v[48:51]
    ds_read_b64_tr_b16 v[156:157], v161 offset:36864
    ds_read_b64_tr_b16 v[158:159], v161 offset:38912
    s_waitcnt lgkmcnt(4)
    v_add_u32 v120, v120, v121
    s_lshr_b32 s96, s36, 2
    v_readfirstlane_b32 s97, v120
    s_lshl1_add_u32 s84, s96, 6
    v_mfma_f32_16x16x32_bf16 v[20:23], v[140:143], v[104:107], v[20:23]
    v_mfma_f32_16x16x32_bf16 v[36:39], v[140:143], v[108:111], v[36:39]
    v_mfma_f32_16x16x32_bf16 v[52:55], v[140:143], v[112:115], v[52:55]
    s_cmp_lt_u32 s97, s84
    s_cbranch_scc1 L_fslow
L_fgo:
    v_mfma_f32_16x16x32_bf16 v[8:11], v[144:147], v[92:95], v[8:11]
    v_mfma_f32_16x16x32_bf16 v[24:27], v[144:147], v[96:99], v[24:27]
    ds_write_b128 v6, v[16:19] offset:0
    v_mfma_f32_16x16x32_bf16 v[40:43], v[144:147], v[100:103], v[40:43]
    ds_write_b128 v6, v[32:35] offset:2048
    v_mfma_f32_16x16x32_bf16 v[12:15], v[148:151], v[92:95], v[12:15]
    ds_write_b128 v6, v[48:51] offset:4096
    v_mfma_f32_16x16x32_bf16 v[28:31], v[148:151], v[96:99], v[28:31]
    ds_write_b128 v6, v[20:23] offset:1024
    v_mfma_f32_16x16x32_bf16 v[44:47], v[148:151], v[100:103], v[44:47]
    ds_write_b128 v6, v[36:39] offset:3072
    s_waitcnt lgkmcnt(7)
    v_mfma_f32_16x16x32_bf16 v[8:11], v[152:155], v[104:107], v[8:11]
    ds_write_b128 v6, v[52:55] offset:5120
    v_mfma_f32_16x16x32_bf16 v[24:27], v[152:155], v[108:111], v[24:27]
    ds_write_b32 v164, v164 offset:64
    v_mfma_f32_16x16x32_bf16 v[40:43], v[152:155], v[112:115], v[40:43]
    s_waitcnt lgkmcnt(7)
    v_mfma_f32_16x16x32_bf16 v[12:15], v[156:159], v[104:107], v[12:15]
    v_mfma_f32_16x16x32_bf16 v[28:31], v[156:159], v[108:111], v[28:31]
    v_mfma_f32_16x16x32_bf16 v[44:47], v[156:159], v[112:115], v[44:47]
    v_mov_b32 v143, v116
    s_waitcnt lgkmcnt(0)
    v_xor_b32 v6, 32, v1
L_fb:
    ds_read_b32 v140, v165 offset:64
    ds_read_b32 v141, v166 offset:48
    ds_read_b128 v[56:59], v5 offset:0
    ds_read_b128 v[60:63], v5 offset:1024
    ds_read_b128 v[64:67], v5 offset:2048
    ds_read_b128 v[68:71], v5 offset:3072
    ds_read_b128 v[72:75], v5 offset:4096
    ds_read_b128 v[76:79], v5 offset:5120
    s_waitcnt lgkmcnt(6)
    ds_read2_b32 v[144:145], v143 offset0:0 offset1:16
    ds_read_b32 v148, v143 offset:128
    ds_read_b128 v[116:119], v7 offset:0
    ds_read_b128 v[120:123], v7 offset:1024
    ds_read_b128 v[124:127], v7 offset:4096
    ds_read_b128 v[128:131], v7 offset:5120
    ds_read_b128 v[132:135], v7 offset:8192
    ds_read_b128 v[136:139], v7 offset:9216
    v_readfirstlane_b32 s96, v140
    v_readfirstlane_b32 s97, v141
    s_cmp_lg_u32 s96, 0
    s_cbranch_scc1 L_fx
    s_mov_b32 s100, 0
Lw_59:
    ds_read_b32 v4, v165 offset:64
    s_waitcnt lgkmcnt(0)
    v_readfirstlane_b32 s99, v4
    s_cmp_ge_u32 s99, 1
    s_cbranch_scc1 Lwd_60
    s_add_u32 s100, s100, 1
    s_cmp_lt_u32 s100, 8388608
    s_cbranch_scc1 Lw_59
Lwd_60:
    s_branch L_fb
L_fx:
    s_waitcnt lgkmcnt(13)
    v_pk_add_f32 v[56:57], v[56:57], v[8:9]
    v_pk_add_f32 v[58:59], v[58:59], v[10:11]
    s_waitcnt lgkmcnt(12)
    v_pk_add_f32 v[60:61], v[60:61], v[12:13]
    v_pk_add_f32 v[62:63], v[62:63], v[14:15]
    s_waitcnt lgkmcnt(11)
    v_pk_add_f32 v[64:65], v[64:65], v[24:25]
    v_pk_add_f32 v[66:67], v[66:67], v[26:27]
    s_waitcnt lgkmcnt(10)
    v_pk_add_f32 v[68:69], v[68:69], v[28:29]
    v_pk_add_f32 v[70:71], v[70:71], v[30:31]
    s_waitcnt lgkmcnt(9)
    v_pk_add_f32 v[72:73], v[72:73], v[40:41]
    v_pk_add_f32 v[74:75], v[74:75], v[42:43]
    s_waitcnt lgkmcnt(8)
    v_pk_add_f32 v[76:77], v[76:77], v[44:45]
    v_pk_add_f32 v[78:79], v[78:79], v[46:47]
    s_cmp_ge_u32 s97, 2
    s_cbranch_scc1 L_yok
    s_mov_b32 s100, 0
Lw_61:
    ds_read_b32 v4, v166 offset:48
    s_waitcnt lgkmcnt(0)
    v_readfirstlane_b32 s99, v4
    s_cmp_ge_u32 s99, 2
    s_cbranch_scc1 Lwd_62
    s_add_u32 s100, s100, 1
    s_cmp_lt_u32 s100, 8388608
    s_cbranch_scc1 Lw_61
Lwd_62:
    ds_read2_b32 v[144:145], v143 offset0:0 offset1:16
    ds_read_b32 v148, v143 offset:128
    ds_read_b128 v[116:119], v7 offset:0
    ds_read_b128 v[120:123], v7 offset:1024
    ds_read_b128 v[124:127], v7 offset:4096
    ds_read_b128 v[128:131], v7 offset:5120
    ds_read_b128 v[132:135], v7 offset:8192
    ds_read_b128 v[136:139], v7 offset:9216
L_yok:
    s_waitcnt lgkmcnt(6)
    v_sub_f32 v146, 1.0, v145
    v_sub_f32 v144, 1.0, v144
    v_sub_f32 v148, 1.0, v148
    s_waitcnt lgkmcnt(5)
    v_pk_fma_f32 v[116:117], v[56:57], v[144:145], v[116:117] op_sel_hi:[1,0,1]
    v_pk_fma_f32 v[118:119], v[58:59], v[144:145], v[118:119] op_sel_hi:[1,0,1]
    v_cvt_pk_bf16_f32 v8, v116, v117
    v_cvt_pk_bf16_f32 v9, v118, v119
    ds_write_b64 v1, v[8:9] offset:0
    s_waitcnt lgkmcnt(5)
    v_pk_fma_f32 v[120:121], v[60:61], v[144:145], v[120:121] op_sel_hi:[1,0,1]
    v_pk_fma_f32 v[122:123], v[62:63], v[144:145], v[122:123] op_sel_hi:[1,0,1]
    v_cvt_pk_bf16_f32 v10, v120, v121
    v_cvt_pk_bf16_f32 v11, v122, v123
    ds_write_b64 v6, v[10:11] offset:0
    ds_read_b128 v[24:27], v5 offset:0
    s_waitcnt lgkmcnt(6)
    v_pk_fma_f32 v[124:125], v[64:65], v[146:147], v[124:125] op_sel_hi:[1,0,1]
    v_pk_fma_f32 v[126:127], v[66:67], v[146:147], v[126:127] op_sel_hi:[1,0,1]
    v_cvt_pk_bf16_f32 v12, v124, v125
    v_cvt_pk_bf16_f32 v13, v126, v127
    ds_write_b64 v1, v[12:13] offset:1024
    s_waitcnt lgkmcnt(6)
    v_pk_fma_f32 v[128:129], v[68:69], v[146:147], v[128:129] op_sel_hi:[1,0,1]
    v_pk_fma_f32 v[130:131], v[70:71], v[146:147], v[130:131] op_sel_hi:[1,0,1]
    v_cvt_pk_bf16_f32 v14, v128, v129
    v_cvt_pk_bf16_f32 v15, v130, v131
    ds_write_b64 v6, v[14:15] offset:1024
    ds_read_b128 v[28:31], v5 offset:1024
    s_waitcnt lgkmcnt(7)
    v_pk_fma_f32 v[132:133], v[72:73], v[148:149], v[132:133] op_sel_hi:[1,0,1]
    v_pk_fma_f32 v[134:135], v[74:75], v[148:149], v[134:135] op_sel_hi:[1,0,1]
    v_cvt_pk_bf16_f32 v16, v132, v133
    v_cvt_pk_bf16_f32 v17, v134, v135
    ds_write_b64 v1, v[16:17] offset:2048
    s_waitcnt lgkmcnt(7)
    v_pk_fma_f32 v[136:137], v[76:77], v[148:149], v[136:137] op_sel_hi:[1,0,1]
    v_pk_fma_f32 v[138:139], v[78:79], v[148:149], v[138:139] op_sel_hi:[1,0,1]
    v_cvt_pk_bf16_f32 v18, v136, v137
    v_cvt_pk_bf16_f32 v19, v138, v139
    ds_write_b64 v6, v[18:19] offset:2048
    ds_read_b128 v[32:35], v5 offset:2048
    s_waitcnt lgkmcnt(6)
    buffer_store_dwordx4 v[24:27], v2, s[48:51], s79 offen
    s_add_u32 s79, s79, 20480
    s_waitcnt lgkmcnt(3)
    buffer_store_dwordx4 v[28:31], v2, s[48:51], s79 offen
    s_add_u32 s79, s79, 20480
    s_waitcnt lgkmcnt(0)
    buffer_store_dwordx4 v[32:35], v2, s[48:51], s79 offen
L_pexit:
    s_endpgm
L_fslow:
    s_mov_b32 s100, 0
L_fs2:
    ds_read2_b32 v[120:121], v3 offset0:0 offset1:4
    s_waitcnt lgkmcnt(0)
    v_add_u32 v120, v120, v121
    s_nop 0
    v_readfirstlane_b32 s97, v120
    s_cmp_ge_u32 s97, s84
    s_cbranch_scc1 L_fgo
    s_add_u32 s100, s100, 1
    s_cmp_lt_u32 s100, 8388608
    s_cbranch_scc1 L_fs2
    s_branch L_fgo
L_ns0:
    s_load_dwordx16 s[4:19], s[76:77], 0 glc
    s_load_dwordx8 s[20:27], s[76:77], 64 glc
    s_waitcnt lgkmcnt(0)
    s_add_u32 s100, s100, 1
    s_cmp_lt_u32 s100, 1048576
    s_cbranch_scc1 L_nb0
    s_branch L_ng0
L_ns1:
    s_load_dwordx16 s[4:19], s[76:77], 0 glc
    s_load_dwordx8 s[20:27], s[76:77], 64 glc
    s_waitcnt lgkmcnt(0)
    s_add_u32 s100, s100, 1
    s_cmp_lt_u32 s100, 1048576
    s_cbranch_scc1 L_nb1
    s_branch L_ng1
L_ns2:
    s_load_dwordx16 s[4:19], s[76:77], 0 glc
    s_load_dwordx8 s[20:27], s[76:77], 64 glc
    s_waitcnt lgkmcnt(0)
    s_add_u32 s100, s100, 1
    s_cmp_lt_u32 s100, 1048576
    s_cbranch_scc1 L_nb2
    s_branch L_ng2
L_ns3:
    s_load_dwordx16 s[4:19], s[76:77], 0 glc
    s_load_dwordx8 s[20:27], s[76:77], 64 glc
    s_waitcnt lgkmcnt(0)
    s_add_u32 s100, s100, 1
    s_cmp_lt_u32 s100, 1048576
    s_cbranch_scc1 L_nb3
    s_branch L_ng3
L_ns4:
    s_load_dwordx16 s[4:19], s[76:77], 0 glc
    s_load_dwordx8 s[20:27], s[76:77], 64 glc
    s_waitcnt lgkmcnt(0)
    s_add_u32 s100, s100, 1
    s_cmp_lt_u32 s100, 1048576
    s_cbranch_scc1 L_nb4
    s_branch L_ng4
L_ns6:
    s_load_dwordx16 s[4:19], s[76:77], 0 glc
    s_load_dwordx8 s[20:27], s[76:77], 64 glc
    s_waitcnt lgkmcnt(0)
    s_add_u32 s100, s100, 1
    s_cmp_lt_u32 s100, 1048576
    s_cbranch_scc1 L_nb6
    s_branch L_ng6
L_ns7:
    s_load_dwordx16 s[4:19], s[76:77], 0 glc
    s_load_dwordx8 s[20:27], s[76:77], 64 glc
    s_waitcnt lgkmcnt(0)
    s_add_u32 s100, s100, 1
    s_cmp_lt_u32 s100, 1048576
    s_cbranch_scc1 L_nb7
    s_branch L_ng7
L_ns8:
    s_load_dwordx16 s[4:19], s[76:77], 0 glc
    s_load_dwordx8 s[20:27], s[76:77], 64 glc
    s_waitcnt lgkmcnt(0)
    s_add_u32 s100, s100, 1
    s_cmp_lt_u32 s100, 1048576
    s_cbranch_scc1 L_nb8
    s_branch L_ng8
L_end:
    s_endpgm
L_codeend:
.section .rodata,"a"
.p2align 6
.amdhsa_kernel gated_mix__ssm_conv_h3__sliding_local_dilated__prompt_kernel
  .amdhsa_next_free_vgpr 168
  .amdhsa_next_free_sgpr 102
  .amdhsa_accum_offset 168
  .amdhsa_group_segment_fixed_size 0
  .amdhsa_kernarg_size 104
  .amdhsa_user_sgpr_count 2
  .amdhsa_user_sgpr_kernarg_segment_ptr 1
  .amdhsa_system_sgpr_workgroup_id_x 1
.end_amdhsa_kernel
```

```asm
; @launch grid=(256,1,1) block=(768,1,1) lds=163840
.amdgcn_target "amdgcn-amd-amdhsa--gfx950"
.text
.globl gated_mix__ssm_conv_h3__sliding_local_dilated__prompt_kernel
.p2align 8
.type gated_mix__ssm_conv_h3__sliding_local_dilated__prompt_kernel,@function
gated_mix__ssm_conv_h3__sliding_local_dilated__prompt_kernel:
    s_load_dwordx16 s[4:19], s[0:1], 0
    s_load_dwordx8 s[20:27], s[0:1], 64
    s_load_dwordx2 s[28:29], s[0:1], 96
    s_lshr_b32 s96, s2, 3
    s_getpc_b64 s[46:47]
L_pc:
    s_lshl_b32 s97, s96, 7
    v_lshl_add_u32 v5, v0, 12, s97
    v_cmp_gt_u32 vcc, L_codeend-L_pc-4, v5
    s_and_saveexec_b64 s[48:49], vcc
    s_cbranch_execz L_nopf
    global_load_dword v166, v5, s[46:47]
L_nopf:
    s_mov_b64 exec, -1
    v_lshrrev_b32 v4, 6, v0
    v_and_b32 v0, 63, v0
    v_readfirstlane_b32 s32, v4
    s_cmp_ge_u32 s2, 256
    s_cbranch_scc1 L_end
    v_lshrrev_b32 v2, 4, v0
    v_and_b32 v1, 15, v0
    v_lshrrev_b32 v4, 3, v0
    v_and_b32 v5, 7, v0
    s_bfe_u32 s97, s2, 131073
    s_mul_i32 s98, s97, 55
    s_add_u32 s98, s98, 1
    s_lshr_b32 s98, s98, 1
    s_and_b32 s99, s97, 1
    s_add_u32 s99, s99, s96
    s_and_b32 s31, s2, 1
    s_cmp_ge_u32 s99, 28
    s_cselect_b32 s35, 1, 0
    s_cbranch_scc1 L_a
    s_add_u32 s96, s98, s96
    s_mul_i32 s43, s31, 110
    s_add_u32 s43, s43, s96
    s_mul_i32 s30, s96, 205
    s_lshr_b32 s30, s30, 10
    s_mul_i32 s97, s30, 5
    s_sub_u32 s36, s96, s97
    s_mul_i32 s31, s31, 5
    s_add_u32 s31, s36, s31
    s_add_u32 s3, s30, s36
    s_mul_i32 s97, s3, 86
    s_lshr_b32 s97, s97, 8
    s_mul_i32 s97, s97, 3
    s_sub_u32 s3, s3, s97
    s_lshl_b32 s97, s2, 2
    s_lshr_b32 s97, 0x38058350, s97
    s_and_b32 s34, s97, 15
    s_cmp_ge_u32 s32, 3
    s_cbranch_scc1 L_notld
    s_setprio 3
    s_mov_b32 s51, 0
    s_mov_b32 s38, 0x76543210
    s_movk_i32 s39, 0x98
    s_cmp_eq_u32 s3, 1
    s_cselect_b32 s38, 0x87354021, s38
    s_cselect_b32 s39, 0x96, s39
    s_cmp_eq_u32 s3, 2
    s_cselect_b32 s38, 0x68435102, s38
    s_cselect_b32 s39, 0x97, s39
    s_and_b32 s53, s38, 15
    s_lshr_b64 s[38:39], s[38:39], 4
    s_add_u32 s53, s53, s34
    s_sub_u32 s96, s53, 10
    s_cselect_b32 s53, s53, s96
    s_mul_i32 s97, s30, 122880
    s_sub_u32 s55, s97, 20480
    s_cselect_b32 s55, 0x40000000, s55
    s_mul_i32 s52, s32, 12288
    s_add_u32 s52, s52, 2048
    s_mul_i32 s54, s32, 122880
    s_lshl_b32 s96, s31, 7
    s_add_u32 s54, s54, s96
    s_sub_u32 s54, s54, 122880
    s_min_u32 s98, s32, 1
    v_lshlrev_b32 v6, s98, v2
    v_and_b32 v6, 3, v6
    v_xor_b32 v5, v5, v6
    s_mul_i32 s99, s98, 2560
    s_add_u32 s99, s99, 1280
    v_mul_u32_u24 v4, s99, v4
    v_lshl_add_u32 v8, v5, 4, v4
    v_xor_b32 v9, 64, v8
    s_lshl_b32 s56, s99, 3
    s_mov_b32 s43, 0x00020000
    s_cmp_eq_u32 s32, 0
    s_cselect_b32 s54, s97, s54
    s_cselect_b32 s57, s56, 4294876416
    s_movk_i32 s58, 128
    s_cselect_b32 s58, s58, 245760
    s_mov_b32 s42, 2621440
    s_cselect_b32 s42, s42, 2457600
    s_waitcnt lgkmcnt(0)
    s_cselect_b64 s[40:41], s[4:5], s[18:19]
L_ld:
    s_mov_b32 m0, s52
    s_mul_i32 s96, s53, s58
    s_add_u32 s50, s96, s54
    buffer_load_dwordx4 v8, s[40:43], s50 offen lds
    s_add_u32 m0, m0, 1024
    s_add_u32 s50, s50, s56
    buffer_load_dwordx4 v9, s[40:43], s50 offen lds
    s_add_u32 m0, m0, 1024
    s_add_u32 s50, s50, s56
    buffer_load_dwordx4 v8, s[40:43], s50 offen lds
    s_add_u32 m0, m0, 1024
    s_add_u32 s50, s50, s56
    buffer_load_dwordx4 v9, s[40:43], s50 offen lds
    s_add_u32 m0, m0, 1024
    s_add_u32 s50, s50, s57
    buffer_load_dwordx4 v8, s[40:43], s50 offen lds
    s_add_u32 m0, m0, 1024
    s_add_u32 s50, s50, s56
    buffer_load_dwordx4 v9, s[40:43], s50 offen lds
    s_add_u32 m0, m0, 1024
    s_add_u32 s50, s50, s56
    buffer_load_dwordx4 v8, s[40:43], s50 offen lds
    s_add_u32 m0, m0, 1024
    s_add_u32 s50, s50, s56
    buffer_load_dwordx4 v9, s[40:43], s50 offen lds
    s_add_u32 m0, m0, 1024
    s_add_u32 s50, s50, s57
    buffer_load_dwordx4 v8, s[40:43], s50 offen lds
    s_add_u32 m0, m0, 1024
    s_add_u32 s50, s50, s56
    buffer_load_dwordx4 v9, s[40:43], s50 offen lds
    s_add_u32 m0, m0, 1024
    s_add_u32 s50, s50, s56
    buffer_load_dwordx4 v8, s[40:43], s50 offen lds
    s_add_u32 m0, m0, 1024
    s_add_u32 s50, s50, s56
    buffer_load_dwordx4 v9, s[40:43], s50 offen lds
    s_cmp_lg_u32 s32, 0
    s_cbranch_scc1 L_ldw
    s_sub_u32 m0, s52, 2048
    s_add_u32 s50, s96, s55
    buffer_load_dwordx4 v8, s[40:43], s50 offen lds
    s_add_u32 m0, m0, 1024
    s_add_u32 s50, s50, s56
    buffer_load_dwordx4 v9, s[40:43], s50 offen lds
L_ldw:
    s_add_u32 s52, s52, 38912
    s_cmp_ge_u32 s52, 116736
    s_cselect_b32 s96, 116736, 0
    s_sub_u32 s52, s52, s96
    s_and_b32 s53, s38, 15
    s_lshr_b64 s[38:39], s[38:39], 4
    s_add_u32 s53, s53, s34
    s_sub_u32 s96, s53, 10
    s_cselect_b32 s53, s53, s96
    s_add_u32 s51, s51, 1
    s_cmp_lt_u32 s51, 2
    s_cbranch_scc1 L_ld
    s_cmp_lg_u32 s51, 3
    s_cbranch_scc1 L_ldt
    s_load_dword s33, s[28:29], 0
L_ldt:
    s_waitcnt vmcnt(14) lgkmcnt(0)
    s_cmp_eq_u32 s32, 0
    s_cbranch_scc1 L_ldb
    s_waitcnt vmcnt(12)
L_ldb:
    s_barrier
    s_cmp_lt_u32 s51, 10
    s_cbranch_scc1 L_ld
    s_setprio 0
    v_mov_b32 v3, 160960
    s_mov_b32 s37, 1
    s_cmp_lg_u32 s32, 0
    s_cbranch_scc1 L_ps
    s_branch L_s0
L_a:
    s_lshl_b32 s97, s97, 5
    s_sub_u32 s97, s97, s98
    s_add_u32 s97, s97, s99
    s_lshl1_add_u32 s97, s97, s31
    s_sub_u32 s97, s97, 56
    s_lshr_b32 s96, s32, 2
    s_lshl_b32 s98, s96, 5
    s_add_u32 s43, s98, s97
    s_mul_i32 s41, s96, 42752
    s_add_u32 s41, s41, 1024
    s_mov_b32 s54, s41
    s_cmp_lt_u32 s97, 32
    s_cbranch_scc1 L_c
    s_add_u32 s43, s43, 284
    s_cmp_eq_u32 s96, 0
    s_cbranch_scc1 L_c
    s_branch L_idle
L_notld:
    s_cmp_lt_u32 s32, 8
    s_cbranch_scc1 L_hg
    s_add_u32 s43, s43, 96
    s_mov_b32 s41, 116736
    s_mov_b32 s54, 116736
L_c:
    s_and_b32 s40, s32, 3
    s_lshr_b32 s55, s43, 5
    s_and_b32 s63, s43, 31
    v_mul_u32_u24 v4, 1280, v4
    v_lshrrev_b32 v6, 1, v2
    v_xor_b32 v5, v5, v6
    s_lshl_b32 s96, s40, 2
    s_and_b32 s96, s96, 4
    v_xor_b32 v5, s96, v5
    v_lshl_add_u32 v22, v5, 4, v4
    v_xor_b32 v23, 32, v22
    s_lshl2_add_u32 s96, s55, s40
    s_lshl_b32 s96, s96, 7
    v_lshl_add_u32 v21, v1, 3, s96
    v_lshlrev_b32 v12, 4, v0
    s_lshr_b32 s96, s40, 1
    s_lshl1_add_u32 s42, s43, s96
    s_mul_i32 s96, s96, 8320
    s_add_u32 s96, s96, s41
    s_add_u32 s62, s96, 16960
    s_and_b32 s97, s40, 1
    s_lshl_b32 s98, s97, 11
    s_add_u32 s60, s98, s62
    s_lshl_b32 s96, s42, 12
    s_add_u32 s61, s96, s98
    s_mov_b32 s46, 2621440
    s_mov_b32 s47, 0x00020000
    s_mov_b64 s[50:51], s[46:47]
    s_setprio 1
    s_cmp_ge_u32 s32, 4
    s_cbranch_scc1 L_c2
    s_lshl2_add_u32 s96, s63, s40
    s_mul_i32 s96, s96, 20480
    s_lshl_b32 s97, s55, 7
    s_add_u32 s96, s96, s97
    s_lshl_b32 s97, s40, 11
    s_add_u32 s97, s97, s41
    s_add_u32 m0, s97, 8704
    s_add_u32 s98, s96, 9216
    s_waitcnt lgkmcnt(0)
    s_mov_b64 s[48:49], s[8:9]
    buffer_load_dwordx4 v22, s[48:51], s96 offen lds
    buffer_load_dwordx4 v23, s[48:51], s98 offen offset:1024 lds
    s_sub_u32 m0, m0, 8192
    s_mov_b64 s[44:45], s[6:7]
    buffer_load_dwordx4 v22, s[44:47], s96 offen lds
    buffer_load_dwordx4 v23, s[44:47], s98 offen offset:1024 lds
    global_load_dwordx2 v[14:15], v21, s[10:11]
    s_cmp_lg_u32 s40, 3
    s_cbranch_scc1 Lkv_1
    s_sub_u32 s96, s96, 71680
    s_cselect_b32 s96, 0x40000000, s96
    s_sub_u32 m0, s41, 512
    s_mov_b32 exec_lo, 0
    buffer_load_dwordx4 v23, s[44:47], s96 offen lds
    s_mov_b32 exec_lo, -1
Lkv_1:
    s_mov_b64 s[48:49], s[12:13]
    s_mov_b32 m0, s60
    s_sub_u32 s96, s61, 16
    s_bitcmp1_b32 s40, 0
    s_cselect_b32 s96, s96, 0x40000000
    buffer_load_dwordx4 v12, s[48:51], s61 offen lds
    buffer_load_dwordx4 v12, s[48:51], s61 offen offset:1024 lds
    s_sub_u32 m0, s60, 16
    s_mov_b64 exec, 1
    buffer_load_dwordx4 v12, s[48:51], s96 offen lds
    s_mov_b64 exec, -1
L_c2:
    s_lshr_b32 s96, s32, 2
    s_lshl_b32 s96, s96, 6
    s_add_u32 s96, s96, 160768
    v_mov_b32 v3, s96
    v_mov_b32 v6, 0
    s_lshl_b32 s96, s40, 8
    s_add_u32 s96, s96, s41
    v_lshl_add_u32 v5, v0, 2, s96
    ds_write_b32 v5, v6 offset:41728
    s_mul_i32 s96, s40, 4160
    s_add_u32 s96, s96, s41
    v_lshl_add_u32 v5, v1, 2, s96
    ds_write_b32 v5, v6 offset:16896
    v_lshl_add_u32 v5, v1, 2, v3
    ds_write_b32 v5, v6
    v_and_b32 v4, 1, v2
    v_lshrrev_b32 v5, 1, v2
    v_lshlrev_b32 v6, 2, v1
    v_sub_u32 v6, v6, v4
    s_add_u32 s96, s41, 256
    v_lshl_add_u32 v6, v6, 7, s96
    s_lshl_b32 s97, s40, 1
    v_or_b32 v7, s97, v5
    v_sub_u32 v9, v1, v4
    v_subrev_u32 v10, 1, v1
    v_xor_b32 v8, v1, v7
    v_and_b32 v8, 7, v8
    v_lshl_add_u32 v8, v8, 4, v6
    v_xor_b32 v9, v9, v7
    v_and_b32 v9, 7, v9
    v_lshl_add_u32 v9, v9, 4, v6
    v_xor_b32 v10, v10, v7
    v_and_b32 v10, 7, v10
    v_lshl_add_u32 v10, v10, 4, v6
    v_mul_u32_u24 v7, 136, v4
    v_add_u32 v13, v8, v7
    v_and_b32 v6, 1, v1
    v_xor_b32 v16, v4, v6
    v_lshlrev_b32 v16, 4, v16
    v_lshlrev_b32 v6, 4, v6
    v_mov_b32 v7, 0xffff
    v_lshlrev_b32 v6, v6, v7
    v_lshrrev_b32 v7, 1, v1
    v_lshlrev_b32 v5, 2, v5
    v_sub_u32 v7, v7, v5
    v_cmp_eq_u32 vcc, 0, v7
    s_nop 1
    v_cndmask_b32 v17, 0, v6, vcc
    v_cmp_eq_u32 vcc, 1, v7
    s_nop 1
    v_cndmask_b32 v18, 0, v6, vcc
    v_cmp_eq_u32 vcc, 2, v7
    s_nop 1
    v_cndmask_b32 v19, 0, v6, vcc
    v_cmp_eq_u32 vcc, 3, v7
    s_nop 1
    v_cndmask_b32 v20, 0, v6, vcc
    v_not_b32 v4, v0
    v_bfe_u32 v5, v4, 1, 2
    v_lshlrev_b32 v5, 4, v5
    v_bfe_u32 v6, v4, 3, 1
    v_lshl_add_u32 v5, v6, 7, v5
    v_xor_b32 v6, s63, v4
    v_and_b32 v6, 1, v6
    v_lshl_add_u32 v5, v6, 6, v5
    v_lshl_add_u32 v5, v2, 14, v5
    s_lshl2_add_u32 s96, s55, s40
    s_lshl_b32 s97, s96, 16
    s_lshl_b32 s98, s63, 8
    s_sub_u32 s97, s97, s98
    s_add_u32 s97, s97, 1056512
    v_add_u32 v11, s97, v5
    s_lshl_b32 s97, s96, 10
    s_lshl2_add_u32 s97, s63, s97
    s_add_u32 s64, s97, 65536
    s_and_b32 s96, s43, -8
    s_cmp_ge_u32 s55, 3
    s_cselect_b32 s96, s96, s43
    s_lshl_b32 s96, s96, 7
    s_add_u32 s65, s96, 65536
    s_waitcnt lgkmcnt(0)
    s_load_dword s33, s[28:29], 0
    s_lshl_b32 s96, s43, 2
    s_load_dword s53, s[14:15], s96
    s_cmp_lg_u32 s35, 0
    s_cbranch_scc1 L_akv
    s_sub_u32 s80, s31, s34
    s_cselect_b32 s96, 10, 0
    s_add_u32 s80, s80, s96
    s_mov_b32 s38, 0x76543210
    s_movk_i32 s39, 0x98
    s_cmp_eq_u32 s3, 1
    s_cselect_b32 s38, 0x68435102, s38
    s_cselect_b32 s39, 0x97, s39
    s_cmp_eq_u32 s3, 2
    s_cselect_b32 s38, 0x87354021, s38
    s_cselect_b32 s39, 0x96, s39
    s_lshl_b32 s80, s80, 2
    s_lshr_b64 s[38:39], s[38:39], s80
    s_and_b32 s80, s38, 15
    s_mul_i32 s96, s80, 43
    s_lshr_b32 s96, s96, 7
    s_mul_i32 s96, s96, 3
    s_sub_u32 s96, s80, s96
    s_mul_i32 s97, s96, 38912
    v_lshrrev_b32 v4, 1, v1
    v_lshrrev_b32 v5, 1, v2
    v_xor_b32 v4, v4, v5
    s_lshl_b32 s96, s40, 1
    v_xor_b32 v4, s96, v4
    v_lshlrev_b32 v4, 4, v4
    v_lshl_add_u32 v4, v1, 7, v4
    v_and_b32 v5, 1, v2
    v_lshl_add_u32 v4, v5, 3, v4
    v_add_u32 v166, s97, v4
    s_barrier
    s_cmp_lg_u32 s80, 0
    s_cbranch_scc1 Lq_2
    ds_read_b64 v[112:113], v166 offset:2048
    ds_read_b64 v[114:115], v166 offset:4096
    ds_read_b64 v[116:117], v166 offset:6144
    ds_read_b64 v[118:119], v166 offset:8192
    ds_read_b64 v[120:121], v166 offset:10240
    ds_read_b64 v[122:123], v166 offset:12288
    s_waitcnt lgkmcnt(0)
Lq_2:
    s_setprio 0
    v_add_u32 v4, 0, v0
    v_mul_u32_u24 v5, 5462, v4
    v_lshrrev_b32 v5, 16, v5
    v_mul_u32_u24 v5, 3904, v5
    v_lshl_add_u32 v144, v4, 4, v5
    v_add_u32 v4, 64, v0
    v_mul_u32_u24 v5, 5462, v4
    v_lshrrev_b32 v5, 16, v5
    v_mul_u32_u24 v5, 3904, v5
    v_lshl_add_u32 v145, v4, 4, v5
    v_add_u32 v4, 128, v0
    v_mul_u32_u24 v5, 5462, v4
    v_lshrrev_b32 v5, 16, v5
    v_mul_u32_u24 v5, 3904, v5
    v_lshl_add_u32 v146, v4, 4, v5
    s_xor_b32 s96, s40, 1
    s_lshl_b32 s96, s96, 12
    s_add_u32 s96, s96, 116736
    v_lshrrev_b32 v4, 2, v0
    v_mul_u32_u24 v4, 192, v4
    v_and_b32 v5, 3, v0
    v_lshl_add_u32 v4, v5, 3, v4
    v_add_u32 v147, s96, v4
L_cs:
    s_and_b32 s97, s40, 1
    v_add_u32 v156, s60, v12
    s_lshl_b32 s98, s97, 8
    s_add_u32 s96, s62, s98
    s_add_u32 s96, s96, 4132
    v_lshrrev_b32 v4, 1, v1
    v_lshl_add_u32 v4, v2, 2, v4
    v_lshl_add_u32 v4, v4, 2, s96
    v_and_b32 v5, 1, v1
    v_mul_u32_u24 v5, 4160, v5
    v_sub_u32 v148, v4, v5
    v_add_u32 v149, 1024, v148
    v_add_u32 v150, 2048, v148
    v_add_u32 v151, 3072, v148
    v_lshlrev_b32 v4, 1, v1
    v_sub_u32 v4, v2, v4
    s_lshl_b32 s98, s97, 4
    s_add_u32 s98, s98, 30
    v_add_u32 v4, s98, v4
    s_lshr_b32 s98, s40, 1
    s_add_u32 s96, s41, 33536
    v_and_b32 v5, 3, v4
    v_lshl_add_u32 v5, v5, 4, s96
    v_lshrrev_b32 v6, 2, v4
    v_lshl_add_u32 v5, v6, 7, v5
    v_bfe_u32 v6, v4, 3, 1
    v_xor_b32 v6, s98, v6
    v_lshl_add_u32 v152, v6, 6, v5
    v_xor_b32 v154, 64, v152
    v_add_u32 v4, 4, v4
    v_and_b32 v5, 3, v4
    v_lshl_add_u32 v5, v5, 4, s96
    v_lshrrev_b32 v6, 2, v4
    v_lshl_add_u32 v5, v6, 7, v5
    v_bfe_u32 v6, v4, 3, 1
    v_xor_b32 v6, s98, v6
    v_lshl_add_u32 v153, v6, 6, v5
    v_xor_b32 v155, 64, v153
    v_and_b32 v5, 1, v2
    v_lshlrev_b32 v5, 9, v5
    v_lshl_add_u32 v5, v1, 5, v5
    v_lshrrev_b32 v6, 1, v2
    v_lshl_add_u32 v5, v6, 4, v5
    s_lshl_b32 s96, s42, 12
    s_add_u32 s96, s96, 3670016
    v_add_u32 v157, s96, v5
    s_mul_i32 s97, s55, 2176
    s_lshr_b32 s96, s63, 3
    s_lshl_b32 s96, s96, 7
    s_add_u32 s97, s97, s96
    s_and_b32 s96, s63, 7
    s_lshl3_add_u32 s97, s96, s97
    s_add_u32 s82, s97, 262144
    s_lshl_b32 s96, s40, 12
    s_add_u32 s96, s96, s54
    v_add_u32 v158, s96, v12
    s_xor_b32 s96, s40, 1
    s_lshl_b32 s96, s96, 12
    s_add_u32 s96, s96, s54
    v_add_u32 v159, s96, v12
    s_waitcnt lgkmcnt(0)
    s_mul_i32 s33, s33, 1664525
    s_add_u32 s33, s33, 1013904223
    s_mov_b32 s58, s33
    s_mov_b32 s59, s33
    s_add_u32 s56, s28, s65
    s_addc_u32 s57, s29, 0
    s_bitcmp1_b32 s40, 1
    s_cselect_b32 s96, 0, 16
    s_lshl_b32 s53, s53, s96
    s_and_b32 s53, s53, 0xffff0000
    s_bitcmp1_b32 s40, 0
    s_cselect_b32 s53, 0, s53
    s_cmp_lg_u32 s35, 0
    s_cbranch_scc1 L_asig
    s_setprio 1
    s_lshl2_add_u32 s96, s63, s40
    s_mul_i32 s96, s96, 20480
    s_lshl_b32 s97, s55, 7
    s_add_u32 s96, s96, s97
    s_lshl_b32 s97, s40, 11
    s_add_u32 s97, s97, s41
    s_add_u32 m0, s97, 8704
    s_add_u32 s98, s96, 9216
    s_waitcnt lgkmcnt(0)
    s_mov_b64 s[48:49], s[8:9]
    buffer_load_dwordx4 v22, s[48:51], s96 offen lds
    buffer_load_dwordx4 v23, s[48:51], s98 offen offset:1024 lds
    s_sub_u32 m0, m0, 8192
    s_mov_b64 s[44:45], s[6:7]
    buffer_load_dwordx4 v22, s[44:47], s96 offen lds
    buffer_load_dwordx4 v23, s[44:47], s98 offen offset:1024 lds
    global_load_dwordx2 v[14:15], v21, s[10:11]
    s_cmp_lg_u32 s40, 3
    s_cbranch_scc1 Lkv_3
    s_sub_u32 s96, s96, 71680
    s_cselect_b32 s96, 0x40000000, s96
    s_sub_u32 m0, s41, 512
    s_mov_b32 exec_lo, 0
    buffer_load_dwordx4 v23, s[44:47], s96 offen lds
    s_mov_b32 exec_lo, -1
Lkv_3:
    s_barrier
    s_cmp_lg_u32 s80, 1
    s_cbranch_scc1 Lq_4
    ds_read_b64 v[112:113], v166 offset:2048
    ds_read_b64 v[114:115], v166 offset:4096
    ds_read_b64 v[116:117], v166 offset:6144
    ds_read_b64 v[118:119], v166 offset:8192
    ds_read_b64 v[120:121], v166 offset:10240
    ds_read_b64 v[122:123], v166 offset:12288
    s_waitcnt lgkmcnt(0)
Lq_4:
    s_waitcnt vmcnt(0)
    s_mov_b64 s[48:49], s[12:13]
    s_barrier
    s_cmp_lg_u32 s80, 2
    s_cbranch_scc1 Lq_5
    ds_read_b64 v[112:113], v166 offset:2048
    ds_read_b64 v[114:115], v166 offset:4096
    ds_read_b64 v[116:117], v166 offset:6144
    ds_read_b64 v[118:119], v166 offset:8192
    ds_read_b64 v[120:121], v166 offset:10240
    ds_read_b64 v[122:123], v166 offset:12288
    s_waitcnt lgkmcnt(0)
Lq_5:
    s_branch L_kvc
L_akv:
    v_mov_b32 v144, 0
    v_mov_b32 v145, 0
    v_mov_b32 v146, 0
    s_barrier
    s_cmp_lt_u32 s32, 4
    s_cbranch_scc1 L_akw
    v_mov_b32 v5, 160768
    s_cmp_lt_u32 s32, 8
    s_cbranch_scc1 L_ak1
    s_mov_b32 s100, 0
Lw_6:
    ds_read_b32 v4, v5 offset:40
    s_waitcnt lgkmcnt(0)
    v_readfirstlane_b32 s99, v4
    s_cmp_ge_u32 s99, 5
    s_cbranch_scc1 Lwd_7
    s_sleep 2
    s_add_u32 s100, s100, 1
    s_cmp_lt_u32 s100, 8388608
    s_cbranch_scc1 Lw_6
Lwd_7:
L_ak1:
    s_lshl2_add_u32 s96, s63, s40
    s_mul_i32 s96, s96, 20480
    s_lshl_b32 s97, s55, 7
    s_add_u32 s96, s96, s97
    s_lshl_b32 s97, s40, 11
    s_add_u32 s97, s97, s41
    s_add_u32 m0, s97, 8704
    s_add_u32 s98, s96, 9216
    s_waitcnt lgkmcnt(0)
    s_mov_b64 s[48:49], s[8:9]
    buffer_load_dwordx4 v22, s[48:51], s96 offen lds
    buffer_load_dwordx4 v23, s[48:51], s98 offen offset:1024 lds
    s_sub_u32 m0, m0, 8192
    s_mov_b64 s[44:45], s[6:7]
    buffer_load_dwordx4 v22, s[44:47], s96 offen lds
    buffer_load_dwordx4 v23, s[44:47], s98 offen offset:1024 lds
    global_load_dwordx2 v[14:15], v21, s[10:11]
    s_cmp_lg_u32 s40, 3
    s_cbranch_scc1 Lkv_8
    s_sub_u32 s96, s96, 71680
    s_cselect_b32 s96, 0x40000000, s96
    s_sub_u32 m0, s41, 512
    s_mov_b32 exec_lo, 0
    buffer_load_dwordx4 v23, s[44:47], s96 offen lds
    s_mov_b32 exec_lo, -1
Lkv_8:
    s_mov_b64 s[48:49], s[12:13]
    s_mov_b32 m0, s60
    s_sub_u32 s96, s61, 16
    s_bitcmp1_b32 s40, 0
    s_cselect_b32 s96, s96, 0x40000000
    buffer_load_dwordx4 v12, s[48:51], s61 offen lds
    buffer_load_dwordx4 v12, s[48:51], s61 offen offset:1024 lds
    s_sub_u32 m0, s60, 16
    s_mov_b64 exec, 1
    buffer_load_dwordx4 v12, s[48:51], s96 offen lds
    s_mov_b64 exec, -1
L_akw:
    s_mov_b64 s[48:49], s[12:13]
    s_waitcnt vmcnt(3)
    v_mov_b32 v4, 1
    s_mov_b64 exec, 1
    ds_add_u32 v3, v4 offset:36
    s_mov_b64 exec, -1
    s_mov_b32 s100, 0
Lw_9:
    ds_read_b32 v4, v3 offset:36
    s_waitcnt lgkmcnt(0)
    v_readfirstlane_b32 s99, v4
    s_cmp_ge_u32 s99, 4
    s_cbranch_scc1 Lwd_10
    s_add_u32 s100, s100, 1
    s_cmp_lt_u32 s100, 8388608
    s_cbranch_scc1 Lw_9
Lwd_10:
L_kvc:
    ds_read_b128 v[32:35], v9 offset:256
    ds_read_b128 v[24:27], v10 offset:0
    ds_read_b128 v[36:39], v8 offset:384
    ds_read_b128 v[28:31], v10 offset:128
    ds_read_b128 v[40:43], v8 offset:512
    ds_read_b128 v[44:47], v8 offset:640
    ds_read_b64 v[48:49], v13 offset:8448
    ds_read_b64 v[50:51], v13 offset:8576
    ds_read_b64 v[52:53], v13 offset:8704
    ds_read_b64 v[54:55], v13 offset:8832
    v_alignbit_b32 v14, v14, v14, v16
    v_alignbit_b32 v15, v15, v15, v16
    v_and_b32 v72, v14, v17
    v_and_b32 v73, v14, v18
    v_and_b32 v74, v14, v19
    v_and_b32 v75, v14, v20
    v_and_b32 v76, v15, v17
    v_and_b32 v77, v15, v18
    v_and_b32 v78, v15, v19
    v_and_b32 v79, v15, v20
    s_mov_b32 s44, s28
    s_and_b32 s45, s29, 0xffff
    s_mov_b32 s46, 16777216
    s_mov_b32 s47, 0x00020000
    s_mov_b32 vcc_lo, 0xaaaaaaaa
    s_mov_b32 vcc_hi, 0xaaaaaaaa
    s_movk_i32 s96, 8192
    s_waitcnt lgkmcnt(0)
    v_mfma_f32_16x16x32_bf16 v[56:59], v[72:75], v[32:35], 0
    v_mfma_f32_16x16x32_bf16 v[56:59], v[76:79], v[24:27], v[56:59]
    v_lshlrev_b32 v96, 16, v48
    v_and_b32 v97, 0xffff0000, v48
    v_lshlrev_b32 v98, 16, v49
    v_and_b32 v99, 0xffff0000, v49
    v_mfma_f32_16x16x32_bf16 v[60:63], v[72:75], v[36:39], 0
    v_mfma_f32_16x16x32_bf16 v[60:63], v[76:79], v[28:31], v[60:63]
    v_lshlrev_b32 v100, 16, v50
    v_and_b32 v101, 0xffff0000, v50
    v_lshlrev_b32 v102, 16, v51
    v_and_b32 v103, 0xffff0000, v51
    v_mfma_f32_16x16x32_bf16 v[64:67], v[72:75], v[40:43], 0
    v_mfma_f32_16x16x32_bf16 v[64:67], v[76:79], v[32:35], v[64:67]
    v_lshlrev_b32 v104, 16, v52
    v_and_b32 v105, 0xffff0000, v52
    v_lshlrev_b32 v106, 16, v53
    v_and_b32 v107, 0xffff0000, v53
    v_mfma_f32_16x16x32_bf16 v[68:71], v[72:75], v[44:47], 0
    v_mfma_f32_16x16x32_bf16 v[68:71], v[76:79], v[36:39], v[68:71]
    v_lshlrev_b32 v108, 16, v54
    v_and_b32 v109, 0xffff0000, v54
    v_lshlrev_b32 v110, 16, v55
    v_and_b32 v111, 0xffff0000, v55
    v_mul_f32 v96, v56, v96
    v_mul_f32 v97, v57, v97
    v_mul_f32 v98, v58, v98
    v_mul_f32 v99, v59, v99
    v_mul_f32 v100, v60, v100
    v_mul_f32 v101, v61, v101
    v_mul_f32 v102, v62, v102
    v_mul_f32 v103, v63, v103
    v_mul_f32 v104, v64, v104
    v_mul_f32 v105, v65, v105
    v_mul_f32 v106, v66, v106
    v_mul_f32 v107, v67, v107
    v_mul_f32 v108, v68, v108
    v_mul_f32 v109, v69, v109
    v_mul_f32 v110, v70, v110
    v_mul_f32 v111, v71, v111
    v_cvt_pk_bf16_f32 v80, v108, v104
    v_cvt_pk_bf16_f32 v81, v100, v96
    v_cvt_pk_bf16_f32 v82, v109, v105
    v_cvt_pk_bf16_f32 v83, v101, v97
    v_cvt_pk_bf16_f32 v84, v110, v106
    v_cvt_pk_bf16_f32 v85, v102, v98
    v_cvt_pk_bf16_f32 v86, v111, v107
    v_cvt_pk_bf16_f32 v87, v103, v99
    v_cndmask_b32_dpp v88, v80, v82, vcc quad_perm:[1,0,3,2] row_mask:0xf bank_mask:0xf
    v_cndmask_b32_dpp v89, v81, v83, vcc quad_perm:[1,0,3,2] row_mask:0xf bank_mask:0xf
    v_cndmask_b32_dpp v92, v84, v86, vcc quad_perm:[1,0,3,2] row_mask:0xf bank_mask:0xf
    v_cndmask_b32_dpp v93, v85, v87, vcc quad_perm:[1,0,3,2] row_mask:0xf bank_mask:0xf
    s_not_b64 vcc, vcc
    v_cndmask_b32_dpp v90, v82, v80, vcc quad_perm:[1,0,3,2] row_mask:0xf bank_mask:0xf
    v_cndmask_b32_dpp v91, v83, v81, vcc quad_perm:[1,0,3,2] row_mask:0xf bank_mask:0xf
    buffer_store_dwordx4 v[88:91], v11, s[44:47], 0 offen sc1
    v_cndmask_b32_dpp v94, v86, v84, vcc quad_perm:[1,0,3,2] row_mask:0xf bank_mask:0xf
    v_cndmask_b32_dpp v95, v87, v85, vcc quad_perm:[1,0,3,2] row_mask:0xf bank_mask:0xf
    buffer_store_dwordx4 v[92:95], v11, s[44:47], s96 offen sc1
    s_cmp_eq_u32 s35, 0
    s_cbranch_scc1 L_gk
    v_mov_b32 v4, 1
    s_mov_b64 exec, 1
    ds_add_u32 v3, v4 offset:40
    s_mov_b64 exec, -1
    s_branch L_cs
L_gk:
    s_setprio 0
    s_mov_b32 s52, s40
    s_barrier
    s_cmp_lg_u32 s80, 3
    s_cbranch_scc1 Lq_11
    ds_read_b64 v[112:113], v166 offset:2048
    ds_read_b64 v[114:115], v166 offset:4096
    ds_read_b64 v[116:117], v166 offset:6144
    ds_read_b64 v[118:119], v166 offset:8192
    ds_read_b64 v[120:121], v166 offset:10240
    ds_read_b64 v[122:123], v166 offset:12288
    s_waitcnt lgkmcnt(0)
Lq_11:
    s_waitcnt vmcnt(0)
    s_atomic_swap s33, s[28:29], s64
    s_barrier
    s_cmp_lg_u32 s80, 4
    s_cbranch_scc1 Lq_12
    ds_read_b64 v[112:113], v166 offset:2048
    ds_read_b64 v[114:115], v166 offset:4096
    ds_read_b64 v[116:117], v166 offset:6144
    ds_read_b64 v[118:119], v166 offset:8192
    ds_read_b64 v[120:121], v166 offset:10240
    ds_read_b64 v[122:123], v166 offset:12288
    s_waitcnt lgkmcnt(0)
Lq_12:
    s_barrier
    s_cmp_lg_u32 s80, 5
    s_cbranch_scc1 Lq_13
    ds_read_b64 v[112:113], v166 offset:2048
    ds_read_b64 v[114:115], v166 offset:4096
    ds_read_b64 v[116:117], v166 offset:6144
    ds_read_b64 v[118:119], v166 offset:8192
    ds_read_b64 v[120:121], v166 offset:10240
    ds_read_b64 v[122:123], v166 offset:12288
    s_waitcnt lgkmcnt(0)
Lq_13:
    s_barrier
    s_cmp_lg_u32 s80, 6
    s_cbranch_scc1 Lq_14
    ds_read_b64 v[112:113], v166 offset:2048
    ds_read_b64 v[114:115], v166 offset:4096
    ds_read_b64 v[116:117], v166 offset:6144
    ds_read_b64 v[118:119], v166 offset:8192
    ds_read_b64 v[120:121], v166 offset:10240
    ds_read_b64 v[122:123], v166 offset:12288
    s_waitcnt lgkmcnt(0)
Lq_14:
    s_barrier
    s_cmp_lg_u32 s80, 7
    s_cbranch_scc1 Lq_15
    ds_read_b64 v[112:113], v166 offset:2048
    ds_read_b64 v[114:115], v166 offset:4096
    ds_read_b64 v[116:117], v166 offset:6144
    ds_read_b64 v[118:119], v166 offset:8192
    ds_read_b64 v[120:121], v166 offset:10240
    ds_read_b64 v[122:123], v166 offset:12288
    s_waitcnt lgkmcnt(0)
Lq_15:
    s_cmp_lg_u32 s52, 0
    s_cbranch_scc1 Lud_17
Lup_16:
    s_load_dwordx16 s[64:79], s[56:57], 0 glc
    s_load_dwordx16 s[4:19], s[56:57], 64 glc
    s_waitcnt lgkmcnt(0)
    s_xor_b64 s[64:65], s[64:65], s[58:59]
    s_xor_b64 s[4:5], s[4:5], s[58:59]
    s_or_b64 s[64:65], s[64:65], s[4:5]
    s_xor_b64 s[66:67], s[66:67], s[58:59]
    s_xor_b64 s[6:7], s[6:7], s[58:59]
    s_or_b64 s[64:65], s[64:65], s[66:67]
    s_or_b64 s[64:65], s[64:65], s[6:7]
    s_xor_b64 s[68:69], s[68:69], s[58:59]
    s_xor_b64 s[8:9], s[8:9], s[58:59]
    s_or_b64 s[64:65], s[64:65], s[68:69]
    s_or_b64 s[64:65], s[64:65], s[8:9]
    s_xor_b64 s[70:71], s[70:71], s[58:59]
    s_xor_b64 s[10:11], s[10:11], s[58:59]
    s_or_b64 s[64:65], s[64:65], s[70:71]
    s_or_b64 s[64:65], s[64:65], s[10:11]
    s_xor_b64 s[72:73], s[72:73], s[58:59]
    s_xor_b64 s[12:13], s[12:13], s[58:59]
    s_or_b64 s[64:65], s[64:65], s[72:73]
    s_or_b64 s[64:65], s[64:65], s[12:13]
    s_xor_b64 s[74:75], s[74:75], s[58:59]
    s_xor_b64 s[14:15], s[14:15], s[58:59]
    s_or_b64 s[64:65], s[64:65], s[74:75]
    s_or_b64 s[64:65], s[64:65], s[14:15]
    s_xor_b64 s[76:77], s[76:77], s[58:59]
    s_xor_b64 s[16:17], s[16:17], s[58:59]
    s_or_b64 s[64:65], s[64:65], s[76:77]
    s_or_b64 s[64:65], s[64:65], s[16:17]
    s_xor_b64 s[78:79], s[78:79], s[58:59]
    s_xor_b64 s[18:19], s[18:19], s[58:59]
    s_or_b64 s[64:65], s[64:65], s[78:79]
    s_or_b64 s[64:65], s[64:65], s[18:19]
    s_cbranch_scc1 Lud_17
    s_mov_b32 s52, -1
Lud_17:
    s_barrier
    s_cmp_lg_u32 s80, 8
    s_cbranch_scc1 Lq_18
    ds_read_b64 v[112:113], v166 offset:2048
    ds_read_b64 v[114:115], v166 offset:4096
    ds_read_b64 v[116:117], v166 offset:6144
    ds_read_b64 v[118:119], v166 offset:8192
    ds_read_b64 v[120:121], v166 offset:10240
    ds_read_b64 v[122:123], v166 offset:12288
    s_waitcnt lgkmcnt(0)
Lq_18:
    s_mov_b32 m0, s60
    s_sub_u32 s96, s61, 16
    s_bitcmp1_b32 s40, 0
    s_cselect_b32 s96, s96, 0x40000000
    buffer_load_dwordx4 v12, s[48:51], s61 offen lds
    buffer_load_dwordx4 v12, s[48:51], s61 offen offset:1024 lds
    s_sub_u32 m0, s60, 16
    s_mov_b64 exec, 1
    buffer_load_dwordx4 v12, s[48:51], s96 offen lds
    s_mov_b64 exec, -1
    s_cmp_lg_u32 s52, 0
    s_cbranch_scc1 Lud_20
Lup_19:
    s_load_dwordx16 s[64:79], s[56:57], 0 glc
    s_load_dwordx16 s[4:19], s[56:57], 64 glc
    s_waitcnt lgkmcnt(0)
    s_xor_b64 s[64:65], s[64:65], s[58:59]
    s_xor_b64 s[4:5], s[4:5], s[58:59]
    s_or_b64 s[64:65], s[64:65], s[4:5]
    s_xor_b64 s[66:67], s[66:67], s[58:59]
    s_xor_b64 s[6:7], s[6:7], s[58:59]
    s_or_b64 s[64:65], s[64:65], s[66:67]
    s_or_b64 s[64:65], s[64:65], s[6:7]
    s_xor_b64 s[68:69], s[68:69], s[58:59]
    s_xor_b64 s[8:9], s[8:9], s[58:59]
    s_or_b64 s[64:65], s[64:65], s[68:69]
    s_or_b64 s[64:65], s[64:65], s[8:9]
    s_xor_b64 s[70:71], s[70:71], s[58:59]
    s_xor_b64 s[10:11], s[10:11], s[58:59]
    s_or_b64 s[64:65], s[64:65], s[70:71]
    s_or_b64 s[64:65], s[64:65], s[10:11]
    s_xor_b64 s[72:73], s[72:73], s[58:59]
    s_xor_b64 s[12:13], s[12:13], s[58:59]
    s_or_b64 s[64:65], s[64:65], s[72:73]
    s_or_b64 s[64:65], s[64:65], s[12:13]
    s_xor_b64 s[74:75], s[74:75], s[58:59]
    s_xor_b64 s[14:15], s[14:15], s[58:59]
    s_or_b64 s[64:65], s[64:65], s[74:75]
    s_or_b64 s[64:65], s[64:65], s[14:15]
    s_xor_b64 s[76:77], s[76:77], s[58:59]
    s_xor_b64 s[16:17], s[16:17], s[58:59]
    s_or_b64 s[64:65], s[64:65], s[76:77]
    s_or_b64 s[64:65], s[64:65], s[16:17]
    s_xor_b64 s[78:79], s[78:79], s[58:59]
    s_xor_b64 s[18:19], s[18:19], s[58:59]
    s_or_b64 s[64:65], s[64:65], s[78:79]
    s_or_b64 s[64:65], s[64:65], s[18:19]
    s_cbranch_scc1 Lud_20
    s_mov_b32 s52, -1
Lud_20:
    s_cmp_lg_u32 s52, -1
    s_cbranch_scc1 Lui_21
    s_add_u32 m0, s41, 33536
    s_lshl_b32 s96, s43, 13
    s_add_u32 s96, s96, 1048576
    buffer_load_dwordx4 v12, s[44:47], s96 offen offset:0 sc1 lds
    buffer_load_dwordx4 v12, s[44:47], s96 offen offset:1024 sc1 lds
    buffer_load_dwordx4 v12, s[44:47], s96 offen offset:2048 sc1 lds
    buffer_load_dwordx4 v12, s[44:47], s96 offen offset:3072 sc1 lds
    s_add_u32 m0, m0, 4096
    s_add_u32 s96, s96, 4096
    buffer_load_dwordx4 v12, s[44:47], s96 offen offset:0 sc1 lds
    buffer_load_dwordx4 v12, s[44:47], s96 offen offset:1024 sc1 lds
    buffer_load_dwordx4 v12, s[44:47], s96 offen offset:2048 sc1 lds
    buffer_load_dwordx4 v12, s[44:47], s96 offen offset:3072 sc1 lds
    s_mov_b32 s52, 9
Lui_21:
    s_barrier
    s_cmp_lg_u32 s80, 9
    s_cbranch_scc1 Lq_22
    ds_read_b64 v[112:113], v166 offset:2048
    ds_read_b64 v[114:115], v166 offset:4096
    ds_read_b64 v[116:117], v166 offset:6144
    ds_read_b64 v[118:119], v166 offset:8192
    ds_read_b64 v[120:121], v166 offset:10240
    ds_read_b64 v[122:123], v166 offset:12288
    s_waitcnt lgkmcnt(0)
Lq_22:
    s_setprio 1
    v_mov_b32 v8, v112
    v_mov_b32 v9, v113
    v_mov_b32 v10, v114
    v_mov_b32 v11, v115
    v_mov_b32 v14, v116
    v_mov_b32 v15, v117
    v_mov_b32 v160, v118
    v_mov_b32 v161, v119
    v_mov_b32 v162, v120
    v_mov_b32 v163, v121
    v_mov_b32 v164, v122
    v_mov_b32 v165, v123
    s_waitcnt vmcnt(0)
    s_cmp_lg_u32 s52, 9
    s_cbranch_scc1 L_nul
    v_mov_b32 v4, 1
    ds_write_b32 v3, v4 offset:0
    s_mov_b32 s52, 1
L_nul:
    v_subrev_u32 v4, 4, v156
    ds_read_b32 v21, v4 offset:0
    ds_read_b128 v[22:25], v156 offset:0
    ds_read_b32 v29, v4 offset:1024
    ds_read_b128 v[30:33], v156 offset:1024
    s_waitcnt lgkmcnt(0)
    s_mov_b64 exec, 1
    v_lshlrev_b32 v26, 16, v22
    v_and_b32 v27, 0xffff0000, v22
    v_add_f32 v26, s53, v26
    v_cvt_pk_bf16_f32 v22, v26, v27
    ds_write_b32 v156, v22
    s_mov_b64 exec, -1
    v_alignbit_b32 v40, v22, v21, 16
    v_alignbit_b32 v41, v23, v22, 16
    v_alignbit_b32 v42, v24, v23, 16
    v_alignbit_b32 v43, v25, v24, 16
    ds_write_b128 v156, v[40:43] offset:4160
    v_alignbit_b32 v44, v30, v29, 16
    v_alignbit_b32 v45, v31, v30, 16
    v_alignbit_b32 v46, v32, v31, 16
    v_alignbit_b32 v47, v33, v32, 16
    ds_write_b128 v156, v[44:47] offset:5184
    s_waitcnt lgkmcnt(0)
    s_setprio 0
    s_barrier
    s_sleep 8
    ds_read_b32 v5, v3 offset:0
    ds_read2_b32 v[48:49], v148 offset0:0 offset1:1
    ds_read2_b32 v[50:51], v148 offset0:2 offset1:3
    ds_read2_b32 v[52:53], v148 offset0:128 offset1:129
    ds_read2_b32 v[54:55], v148 offset0:130 offset1:131
    ds_read2_b32 v[56:57], v149 offset0:0 offset1:1
    ds_read2_b32 v[58:59], v149 offset0:2 offset1:3
    ds_read2_b32 v[60:61], v149 offset0:128 offset1:129
    ds_read2_b32 v[62:63], v149 offset0:130 offset1:131
    ds_read2_b32 v[64:65], v150 offset0:0 offset1:1
    ds_read2_b32 v[66:67], v150 offset0:2 offset1:3
    ds_read2_b32 v[68:69], v150 offset0:128 offset1:129
    ds_read2_b32 v[70:71], v150 offset0:130 offset1:131
    s_waitcnt lgkmcnt(6)
    ds_read2_b32 v[72:73], v151 offset0:0 offset1:1
    ds_read2_b32 v[74:75], v151 offset0:2 offset1:3
    ds_read2_b32 v[76:77], v151 offset0:128 offset1:129
    ds_read2_b32 v[78:79], v151 offset0:130 offset1:131
    v_readfirstlane_b32 s81, v5
    s_waitcnt lgkmcnt(6)
    ds_read_b128 v[108:111], v152 offset:0
    ds_read_b128 v[104:107], v152 offset:1024
    ds_read_b128 v[100:103], v152 offset:2048
    ds_read_b128 v[96:99], v152 offset:3072
    ds_read_b128 v[92:95], v152 offset:4096
    ds_read_b128 v[88:91], v152 offset:5120
    ds_read_b128 v[84:87], v152 offset:6144
    ds_read_b128 v[80:83], v152 offset:7168
    s_cmp_lg_u32 s81, 0
    s_cbranch_scc1 L_conv2
L_upoll:
    s_cmp_lg_u32 s52, 0
    s_cbranch_scc1 Lud_24
    s_mov_b32 s100, 0
Lup_23:
    s_load_dwordx16 s[64:79], s[56:57], 0 glc
    s_load_dwordx16 s[4:19], s[56:57], 64 glc
    s_waitcnt lgkmcnt(0)
    s_xor_b64 s[64:65], s[64:65], s[58:59]
    s_xor_b64 s[4:5], s[4:5], s[58:59]
    s_or_b64 s[64:65], s[64:65], s[4:5]
    s_xor_b64 s[66:67], s[66:67], s[58:59]
    s_xor_b64 s[6:7], s[6:7], s[58:59]
    s_or_b64 s[64:65], s[64:65], s[66:67]
    s_or_b64 s[64:65], s[64:65], s[6:7]
    s_xor_b64 s[68:69], s[68:69], s[58:59]
    s_xor_b64 s[8:9], s[8:9], s[58:59]
    s_or_b64 s[64:65], s[64:65], s[68:69]
    s_or_b64 s[64:65], s[64:65], s[8:9]
    s_xor_b64 s[70:71], s[70:71], s[58:59]
    s_xor_b64 s[10:11], s[10:11], s[58:59]
    s_or_b64 s[64:65], s[64:65], s[70:71]
    s_or_b64 s[64:65], s[64:65], s[10:11]
    s_xor_b64 s[72:73], s[72:73], s[58:59]
    s_xor_b64 s[12:13], s[12:13], s[58:59]
    s_or_b64 s[64:65], s[64:65], s[72:73]
    s_or_b64 s[64:65], s[64:65], s[12:13]
    s_xor_b64 s[74:75], s[74:75], s[58:59]
    s_xor_b64 s[14:15], s[14:15], s[58:59]
    s_or_b64 s[64:65], s[64:65], s[74:75]
    s_or_b64 s[64:65], s[64:65], s[14:15]
    s_xor_b64 s[76:77], s[76:77], s[58:59]
    s_xor_b64 s[16:17], s[16:17], s[58:59]
    s_or_b64 s[64:65], s[64:65], s[76:77]
    s_or_b64 s[64:65], s[64:65], s[16:17]
    s_xor_b64 s[78:79], s[78:79], s[58:59]
    s_xor_b64 s[18:19], s[18:19], s[58:59]
    s_or_b64 s[64:65], s[64:65], s[78:79]
    s_or_b64 s[64:65], s[64:65], s[18:19]
    s_cbranch_scc0 Lug_25
    s_add_u32 s100, s100, 1
    s_cmp_lt_u32 s100, 1048576
    s_cbranch_scc1 Lup_23
Lug_25:
    s_mov_b32 s52, -1
Lud_24:
    s_cmp_lg_u32 s52, -1
    s_cbranch_scc1 Lui_26
    s_add_u32 m0, s41, 33536
    s_lshl_b32 s96, s43, 13
    s_add_u32 s96, s96, 1048576
    buffer_load_dwordx4 v12, s[44:47], s96 offen offset:0 sc1 lds
    buffer_load_dwordx4 v12, s[44:47], s96 offen offset:1024 sc1 lds
    buffer_load_dwordx4 v12, s[44:47], s96 offen offset:2048 sc1 lds
    buffer_load_dwordx4 v12, s[44:47], s96 offen offset:3072 sc1 lds
    s_add_u32 m0, m0, 4096
    s_add_u32 s96, s96, 4096
    buffer_load_dwordx4 v12, s[44:47], s96 offen offset:0 sc1 lds
    buffer_load_dwordx4 v12, s[44:47], s96 offen offset:1024 sc1 lds
    buffer_load_dwordx4 v12, s[44:47], s96 offen offset:2048 sc1 lds
    buffer_load_dwordx4 v12, s[44:47], s96 offen offset:3072 sc1 lds
    s_mov_b32 s52, 9
Lui_26:
    s_cmp_lg_u32 s52, 9
    s_cbranch_scc1 L_uwait
    v_mov_b32 v4, 1
    s_mov_b64 exec, 1
    ds_add_u32 v3, v4 offset:40
    s_mov_b64 exec, -1
    s_waitcnt vmcnt(0)
    v_mov_b32 v4, 1
    ds_write_b32 v3, v4 offset:0
L_uwait:
    s_mov_b32 s100, 0
Lw_27:
    ds_read_b32 v4, v3 offset:0
    s_waitcnt lgkmcnt(0)
    v_readfirstlane_b32 s99, v4
    s_cmp_ge_u32 s99, 1
    s_cbranch_scc1 Lwd_28
    s_sleep 1
    s_add_u32 s100, s100, 1
    s_cmp_lt_u32 s100, 8388608
    s_cbranch_scc1 Lw_27
Lwd_28:
    s_cmp_eq_u32 s35, 0
    s_cbranch_scc1 L_conv
    s_branch L_touch
L_asig:
    s_waitcnt vmcnt(2)
    v_subrev_u32 v4, 4, v156
    ds_read_b32 v21, v4 offset:0
    ds_read_b128 v[22:25], v156 offset:0
    ds_read_b32 v29, v4 offset:1024
    ds_read_b128 v[30:33], v156 offset:1024
    s_waitcnt lgkmcnt(0)
    s_mov_b64 exec, 1
    v_lshlrev_b32 v26, 16, v22
    v_and_b32 v27, 0xffff0000, v22
    v_add_f32 v26, s53, v26
    v_cvt_pk_bf16_f32 v22, v26, v27
    ds_write_b32 v156, v22
    s_mov_b64 exec, -1
    v_alignbit_b32 v40, v22, v21, 16
    v_alignbit_b32 v41, v23, v22, 16
    v_alignbit_b32 v42, v24, v23, 16
    v_alignbit_b32 v43, v25, v24, 16
    ds_write_b128 v156, v[40:43] offset:4160
    v_alignbit_b32 v44, v30, v29, 16
    v_alignbit_b32 v45, v31, v30, 16
    v_alignbit_b32 v46, v32, v31, 16
    v_alignbit_b32 v47, v33, v32, 16
    ds_write_b128 v156, v[44:47] offset:5184
    s_waitcnt lgkmcnt(0)
    v_mov_b32 v4, 1
    s_mov_b64 exec, 1
    ds_add_u32 v3, v4 offset:32
    s_mov_b64 exec, -1
    v_lshl_add_u32 v6, v0, 7, s64
    v_mov_b32 v5, s33
    s_cmp_ge_u32 s55, 3
    s_cselect_b32 s97, 1, 0xff
    s_waitcnt vmcnt(0)
    s_mov_b32 exec_hi, 0
    s_mov_b32 exec_lo, s97
    global_atomic_swap v6, v5, s[28:29] sc1
    s_mov_b64 exec, -1
    s_mov_b32 s100, 0
Lw_29:
    ds_read_b32 v4, v3 offset:32
    s_waitcnt lgkmcnt(0)
    v_readfirstlane_b32 s99, v4
    s_cmp_ge_u32 s99, 4
    s_cbranch_scc1 Lwd_30
    s_sleep 1
    s_add_u32 s100, s100, 1
    s_cmp_lt_u32 s100, 8388608
    s_cbranch_scc1 Lw_29
Lwd_30:
    ds_read2_b32 v[48:49], v148 offset0:0 offset1:1
    ds_read2_b32 v[50:51], v148 offset0:2 offset1:3
    ds_read2_b32 v[52:53], v148 offset0:128 offset1:129
    ds_read2_b32 v[54:55], v148 offset0:130 offset1:131
    ds_read2_b32 v[56:57], v149 offset0:0 offset1:1
    ds_read2_b32 v[58:59], v149 offset0:2 offset1:3
    ds_read2_b32 v[60:61], v149 offset0:128 offset1:129
    ds_read2_b32 v[62:63], v149 offset0:130 offset1:131
    ds_read2_b32 v[64:65], v150 offset0:0 offset1:1
    ds_read2_b32 v[66:67], v150 offset0:2 offset1:3
    ds_read2_b32 v[68:69], v150 offset0:128 offset1:129
    ds_read2_b32 v[70:71], v150 offset0:130 offset1:131
    s_waitcnt lgkmcnt(6)
    ds_read2_b32 v[72:73], v151 offset0:0 offset1:1
    ds_read2_b32 v[74:75], v151 offset0:2 offset1:3
    ds_read2_b32 v[76:77], v151 offset0:128 offset1:129
    ds_read2_b32 v[78:79], v151 offset0:130 offset1:131
    s_mov_b32 s52, s40
    s_branch L_upoll
L_touch:
    s_cmp_lg_u32 s55, 1
    s_cbranch_scc1 L_conv
    s_lshl2_add_u32 s96, s63, s40
    s_mul_i32 s96, s96, 14336
    s_add_u32 s96, s96, 786432
    v_lshlrev_b32 v4, 7, v0
    s_add_u32 s97, s96, 8192
    buffer_load_dword v160, v4, s[48:51], s96 offen
    s_mov_b32 exec_hi, 0xffff
    buffer_load_dword v160, v4, s[48:51], s97 offen
    s_mov_b32 exec_hi, -1
L_conv:
    s_setprio 0
    ds_read_b128 v[108:111], v152 offset:0
    ds_read_b128 v[104:107], v152 offset:1024
    ds_read_b128 v[100:103], v152 offset:2048
    ds_read_b128 v[96:99], v152 offset:3072
    ds_read_b128 v[92:95], v152 offset:4096
    ds_read_b128 v[88:91], v152 offset:5120
    ds_read_b128 v[84:87], v152 offset:6144
    ds_read_b128 v[80:83], v152 offset:7168
L_conv2:

    s_waitcnt lgkmcnt(7)
    v_mfma_f32_16x16x32_bf16 v[44:47], v[48:51], v[108:111], 0
    s_waitcnt lgkmcnt(6)
    v_mfma_f32_16x16x32_bf16 v[40:43], v[48:51], v[104:107], 0
    ds_read_b128 v[140:143], v153 offset:0
    s_waitcnt lgkmcnt(6)
    v_mfma_f32_16x16x32_bf16 v[36:39], v[48:51], v[100:103], 0
    s_waitcnt lgkmcnt(5)
    v_mfma_f32_16x16x32_bf16 v[32:35], v[48:51], v[96:99], 0
    ds_read_b128 v[136:139], v153 offset:1024
    s_waitcnt lgkmcnt(5)
    v_mfma_f32_16x16x32_bf16 v[28:31], v[48:51], v[92:95], 0
    s_waitcnt lgkmcnt(4)
    v_mfma_f32_16x16x32_bf16 v[24:27], v[48:51], v[88:91], 0
    ds_read_b128 v[132:135], v153 offset:2048
    s_waitcnt lgkmcnt(4)
    v_mfma_f32_16x16x32_bf16 v[20:23], v[48:51], v[84:87], 0
    s_waitcnt lgkmcnt(3)
    v_mfma_f32_16x16x32_bf16 v[16:19], v[48:51], v[80:83], 0
    ds_read_b128 v[128:131], v153 offset:3072
    v_mfma_f32_16x16x32_bf16 v[44:47], v[52:55], v[104:107], v[44:47]
    v_mfma_f32_16x16x32_bf16 v[40:43], v[52:55], v[100:103], v[40:43]
    ds_read2_b32 v[48:49], v148 offset0:16 offset1:17
    v_mfma_f32_16x16x32_bf16 v[36:39], v[52:55], v[96:99], v[36:39]
    v_mfma_f32_16x16x32_bf16 v[32:35], v[52:55], v[92:95], v[32:35]
    ds_read2_b32 v[50:51], v148 offset0:18 offset1:19
    v_mfma_f32_16x16x32_bf16 v[28:31], v[52:55], v[88:91], v[28:31]
    v_mfma_f32_16x16x32_bf16 v[24:27], v[52:55], v[84:87], v[24:27]
    ds_read_b128 v[124:127], v153 offset:4096
    v_mfma_f32_16x16x32_bf16 v[20:23], v[52:55], v[80:83], v[20:23]
    v_mfma_f32_16x16x32_bf16 v[44:47], v[56:59], v[100:103], v[44:47]
    v_mfma_f32_16x16x32_bf16 v[40:43], v[56:59], v[96:99], v[40:43]
    ds_read2_b32 v[52:53], v148 offset0:144 offset1:145
    v_mfma_f32_16x16x32_bf16 v[36:39], v[56:59], v[92:95], v[36:39]
    v_mfma_f32_16x16x32_bf16 v[32:35], v[56:59], v[88:91], v[32:35]
    ds_read2_b32 v[54:55], v148 offset0:146 offset1:147
    v_mfma_f32_16x16x32_bf16 v[28:31], v[56:59], v[84:87], v[28:31]
    v_mfma_f32_16x16x32_bf16 v[24:27], v[56:59], v[80:83], v[24:27]
    ds_read_b128 v[120:123], v153 offset:5120
    v_mfma_f32_16x16x32_bf16 v[44:47], v[60:63], v[96:99], v[44:47]
    v_mfma_f32_16x16x32_bf16 v[40:43], v[60:63], v[92:95], v[40:43]
    ds_read2_b32 v[56:57], v149 offset0:16 offset1:17
    v_mfma_f32_16x16x32_bf16 v[36:39], v[60:63], v[88:91], v[36:39]
    v_mfma_f32_16x16x32_bf16 v[32:35], v[60:63], v[84:87], v[32:35]
    ds_read2_b32 v[58:59], v149 offset0:18 offset1:19
    v_mfma_f32_16x16x32_bf16 v[28:31], v[60:63], v[80:83], v[28:31]
    v_mfma_f32_16x16x32_bf16 v[44:47], v[64:67], v[92:95], v[44:47]
    ds_read2_b32 v[60:61], v149 offset0:144 offset1:145
    v_mfma_f32_16x16x32_bf16 v[40:43], v[64:67], v[88:91], v[40:43]
    ds_read2_b32 v[62:63], v149 offset0:146 offset1:147
    v_mfma_f32_16x16x32_bf16 v[36:39], v[64:67], v[84:87], v[36:39]
    ds_read_b128 v[116:119], v153 offset:6144
    v_mfma_f32_16x16x32_bf16 v[32:35], v[64:67], v[80:83], v[32:35]
    s_waitcnt lgkmcnt(13)
    ds_read_b128 v[112:115], v153 offset:7168
    v_mfma_f32_16x16x32_bf16 v[44:47], v[68:71], v[88:91], v[44:47]
    ds_read2_b32 v[64:65], v150 offset0:16 offset1:17
    v_mfma_f32_16x16x32_bf16 v[40:43], v[68:71], v[84:87], v[40:43]
    s_waitcnt lgkmcnt(13)
    ds_read2_b32 v[66:67], v150 offset0:18 offset1:19
    v_mfma_f32_16x16x32_bf16 v[36:39], v[68:71], v[80:83], v[36:39]
    v_mfma_f32_16x16x32_bf16 v[44:47], v[72:75], v[84:87], v[44:47]
    ds_read2_b32 v[68:69], v150 offset0:144 offset1:145
    v_mfma_f32_16x16x32_bf16 v[40:43], v[72:75], v[80:83], v[40:43]
    s_waitcnt lgkmcnt(13)
    ds_read2_b32 v[70:71], v150 offset0:146 offset1:147
    v_mfma_f32_16x16x32_bf16 v[44:47], v[76:79], v[80:83], v[44:47]
    ds_read2_b32 v[72:73], v151 offset0:16 offset1:17
    s_waitcnt lgkmcnt(13)
    ds_read2_b32 v[76:77], v151 offset0:144 offset1:145
    ds_read2_b32 v[78:79], v151 offset0:146 offset1:147
    s_waitcnt lgkmcnt(13)
    ds_read2_b32 v[74:75], v151 offset0:18 offset1:19
    v_mfma_f32_16x16x32_bf16 v[44:47], v[48:51], v[140:143], v[44:47]
    v_mfma_f32_16x16x32_bf16 v[40:43], v[48:51], v[136:139], v[40:43]
    ds_read_b128 v[108:111], v154 offset:256
    v_mfma_f32_16x16x32_bf16 v[36:39], v[48:51], v[132:135], v[36:39]
    v_mfma_f32_16x16x32_bf16 v[32:35], v[48:51], v[128:131], v[32:35]
    s_waitcnt lgkmcnt(13)
    ds_read_b128 v[104:107], v154 offset:1280
    v_mfma_f32_16x16x32_bf16 v[28:31], v[48:51], v[124:127], v[28:31]
    v_mfma_f32_16x16x32_bf16 v[24:27], v[48:51], v[120:123], v[24:27]
    ds_read_b128 v[100:103], v154 offset:2304
    s_waitcnt lgkmcnt(12)
    v_mfma_f32_16x16x32_bf16 v[20:23], v[48:51], v[116:119], v[20:23]
    s_waitcnt lgkmcnt(11)
    v_mfma_f32_16x16x32_bf16 v[16:19], v[48:51], v[112:115], v[16:19]
    ds_read_b128 v[96:99], v154 offset:3328
    v_mfma_f32_16x16x32_bf16 v[44:47], v[52:55], v[136:139], v[44:47]
    v_mfma_f32_16x16x32_bf16 v[40:43], v[52:55], v[132:135], v[40:43]
    ds_read2_b32 v[48:49], v148 offset0:32 offset1:33
    v_mfma_f32_16x16x32_bf16 v[36:39], v[52:55], v[128:131], v[36:39]
    v_mfma_f32_16x16x32_bf16 v[32:35], v[52:55], v[124:127], v[32:35]
    ds_read2_b32 v[50:51], v148 offset0:34 offset1:35
    v_mfma_f32_16x16x32_bf16 v[28:31], v[52:55], v[120:123], v[28:31]
    v_mfma_f32_16x16x32_bf16 v[24:27], v[52:55], v[116:119], v[24:27]
    ds_read_b128 v[92:95], v154 offset:4352
    v_mfma_f32_16x16x32_bf16 v[20:23], v[52:55], v[112:115], v[20:23]
    v_mfma_f32_16x16x32_bf16 v[44:47], v[56:59], v[132:135], v[44:47]
    v_mfma_f32_16x16x32_bf16 v[40:43], v[56:59], v[128:131], v[40:43]
    s_waitcnt lgkmcnt(13)
    ds_read2_b32 v[52:53], v148 offset0:160 offset1:161
    v_mfma_f32_16x16x32_bf16 v[36:39], v[56:59], v[124:127], v[36:39]
    v_mfma_f32_16x16x32_bf16 v[32:35], v[56:59], v[120:123], v[32:35]
    ds_read2_b32 v[54:55], v148 offset0:162 offset1:163
    v_mfma_f32_16x16x32_bf16 v[28:31], v[56:59], v[116:119], v[28:31]
    v_mfma_f32_16x16x32_bf16 v[24:27], v[56:59], v[112:115], v[24:27]
    s_waitcnt lgkmcnt(13)
    ds_read_b128 v[88:91], v154 offset:5376
    v_mfma_f32_16x16x32_bf16 v[44:47], v[60:63], v[128:131], v[44:47]
    v_mfma_f32_16x16x32_bf16 v[40:43], v[60:63], v[124:127], v[40:43]
    ds_read2_b32 v[56:57], v149 offset0:32 offset1:33
    v_mfma_f32_16x16x32_bf16 v[36:39], v[60:63], v[120:123], v[36:39]
    v_mfma_f32_16x16x32_bf16 v[32:35], v[60:63], v[116:119], v[32:35]
    s_waitcnt lgkmcnt(13)
    ds_read2_b32 v[58:59], v149 offset0:34 offset1:35
    v_mfma_f32_16x16x32_bf16 v[28:31], v[60:63], v[112:115], v[28:31]
    v_mfma_f32_16x16x32_bf16 v[44:47], v[64:67], v[124:127], v[44:47]
    ds_read2_b32 v[60:61], v149 offset0:160 offset1:161
    v_mfma_f32_16x16x32_bf16 v[40:43], v[64:67], v[120:123], v[40:43]
    s_waitcnt lgkmcnt(13)
    ds_read2_b32 v[62:63], v149 offset0:162 offset1:163
    v_mfma_f32_16x16x32_bf16 v[36:39], v[64:67], v[116:119], v[36:39]
    ds_read_b128 v[84:87], v154 offset:6400
    v_mfma_f32_16x16x32_bf16 v[32:35], v[64:67], v[112:115], v[32:35]
    s_waitcnt lgkmcnt(13)
    ds_read_b128 v[80:83], v154 offset:7424
    v_mfma_f32_16x16x32_bf16 v[44:47], v[68:71], v[120:123], v[44:47]
    ds_read2_b32 v[64:65], v150 offset0:32 offset1:33
    v_mfma_f32_16x16x32_bf16 v[40:43], v[68:71], v[116:119], v[40:43]
    s_waitcnt lgkmcnt(13)
    ds_read2_b32 v[66:67], v150 offset0:34 offset1:35
    v_mfma_f32_16x16x32_bf16 v[36:39], v[68:71], v[112:115], v[36:39]
    v_mfma_f32_16x16x32_bf16 v[44:47], v[72:75], v[116:119], v[44:47]
    ds_read2_b32 v[68:69], v150 offset0:160 offset1:161
    v_mfma_f32_16x16x32_bf16 v[40:43], v[72:75], v[112:115], v[40:43]
    s_waitcnt lgkmcnt(13)
    ds_read2_b32 v[70:71], v150 offset0:162 offset1:163
    v_mfma_f32_16x16x32_bf16 v[44:47], v[76:79], v[112:115], v[44:47]
    ds_read2_b32 v[72:73], v151 offset0:32 offset1:33
    s_waitcnt lgkmcnt(13)
    ds_read2_b32 v[76:77], v151 offset0:160 offset1:161
    ds_read2_b32 v[78:79], v151 offset0:162 offset1:163
    s_waitcnt lgkmcnt(13)
    ds_read2_b32 v[74:75], v151 offset0:34 offset1:35
    v_mfma_f32_16x16x32_bf16 v[44:47], v[48:51], v[108:111], v[44:47]
    v_mfma_f32_16x16x32_bf16 v[40:43], v[48:51], v[104:107], v[40:43]
    ds_read_b128 v[140:143], v155 offset:256
    v_mfma_f32_16x16x32_bf16 v[36:39], v[48:51], v[100:103], v[36:39]
    v_mfma_f32_16x16x32_bf16 v[32:35], v[48:51], v[96:99], v[32:35]
    s_waitcnt lgkmcnt(13)
    ds_read_b128 v[136:139], v155 offset:1280
    v_mfma_f32_16x16x32_bf16 v[28:31], v[48:51], v[92:95], v[28:31]
    v_mfma_f32_16x16x32_bf16 v[24:27], v[48:51], v[88:91], v[24:27]
    ds_read_b128 v[132:135], v155 offset:2304
    s_waitcnt lgkmcnt(12)
    v_mfma_f32_16x16x32_bf16 v[20:23], v[48:51], v[84:87], v[20:23]
    s_waitcnt lgkmcnt(11)
    v_mfma_f32_16x16x32_bf16 v[16:19], v[48:51], v[80:83], v[16:19]
    ds_read_b128 v[128:131], v155 offset:3328
    v_mfma_f32_16x16x32_bf16 v[44:47], v[52:55], v[104:107], v[44:47]
    v_mfma_f32_16x16x32_bf16 v[40:43], v[52:55], v[100:103], v[40:43]
    ds_read2_b32 v[48:49], v148 offset0:48 offset1:49
    v_mfma_f32_16x16x32_bf16 v[36:39], v[52:55], v[96:99], v[36:39]
    v_mfma_f32_16x16x32_bf16 v[32:35], v[52:55], v[92:95], v[32:35]
    ds_read2_b32 v[50:51], v148 offset0:50 offset1:51
    v_mfma_f32_16x16x32_bf16 v[28:31], v[52:55], v[88:91], v[28:31]
    v_mfma_f32_16x16x32_bf16 v[24:27], v[52:55], v[84:87], v[24:27]
    ds_read_b128 v[124:127], v155 offset:4352
    v_mfma_f32_16x16x32_bf16 v[20:23], v[52:55], v[80:83], v[20:23]
    v_mfma_f32_16x16x32_bf16 v[44:47], v[56:59], v[100:103], v[44:47]
    v_mfma_f32_16x16x32_bf16 v[40:43], v[56:59], v[96:99], v[40:43]
    s_waitcnt lgkmcnt(13)
    ds_read2_b32 v[52:53], v148 offset0:176 offset1:177
    v_mfma_f32_16x16x32_bf16 v[36:39], v[56:59], v[92:95], v[36:39]
    v_mfma_f32_16x16x32_bf16 v[32:35], v[56:59], v[88:91], v[32:35]
    ds_read2_b32 v[54:55], v148 offset0:178 offset1:179
    v_mfma_f32_16x16x32_bf16 v[28:31], v[56:59], v[84:87], v[28:31]
    v_mfma_f32_16x16x32_bf16 v[24:27], v[56:59], v[80:83], v[24:27]
    s_waitcnt lgkmcnt(13)
    ds_read_b128 v[120:123], v155 offset:5376
    s_lshl_b32 s96, s40, 2
    v_add_u32 v5, s96, v3
    v_mfma_f32_16x16x32_bf16 v[44:47], v[60:63], v[96:99], v[44:47]
    v_mfma_f32_16x16x32_bf16 v[40:43], v[60:63], v[92:95], v[40:43]
    ds_read2_b32 v[56:57], v149 offset0:48 offset1:49
    v_mfma_f32_16x16x32_bf16 v[36:39], v[60:63], v[88:91], v[36:39]
    v_mfma_f32_16x16x32_bf16 v[32:35], v[60:63], v[84:87], v[32:35]
    s_waitcnt lgkmcnt(13)
    ds_read2_b32 v[58:59], v149 offset0:50 offset1:51
    v_xor_b32 v6, 4, v5
    s_and_b32 s96, s36, 3
    v_mfma_f32_16x16x32_bf16 v[28:31], v[60:63], v[80:83], v[28:31]
    v_mfma_f32_16x16x32_bf16 v[44:47], v[64:67], v[92:95], v[44:47]
    ds_read2_b32 v[60:61], v149 offset0:176 offset1:177
    v_mfma_f32_16x16x32_bf16 v[40:43], v[64:67], v[88:91], v[40:43]
    s_waitcnt lgkmcnt(13)
    ds_read2_b32 v[62:63], v149 offset0:178 offset1:179
    v_mfma_f32_16x16x32_bf16 v[36:39], v[64:67], v[84:87], v[36:39]
    s_cselect_b32 s96, 4, 6
    s_cmp_eq_u32 s35, 0
    ds_read_b128 v[116:119], v155 offset:6400
    v_mfma_f32_16x16x32_bf16 v[32:35], v[64:67], v[80:83], v[32:35]
    s_waitcnt lgkmcnt(13)
    ds_read_b128 v[112:115], v155 offset:7424
    v_mfma_f32_16x16x32_bf16 v[44:47], v[68:71], v[88:91], v[44:47]
    ds_read2_b32 v[64:65], v150 offset0:48 offset1:49
    v_mfma_f32_16x16x32_bf16 v[40:43], v[68:71], v[84:87], v[40:43]
    s_cselect_b32 s81, s96, 0
    s_bitcmp1_b32 s40, 0
    s_waitcnt lgkmcnt(13)
    ds_read2_b32 v[66:67], v150 offset0:50 offset1:51
    v_mfma_f32_16x16x32_bf16 v[36:39], v[68:71], v[80:83], v[36:39]
    ds_read_b32 v4, v3 offset:64
    v_mfma_f32_16x16x32_bf16 v[44:47], v[72:75], v[84:87], v[44:47]
    s_waitcnt lgkmcnt(13)
    ds_read2_b32 v[68:69], v150 offset0:176 offset1:177
    v_mfma_f32_16x16x32_bf16 v[40:43], v[72:75], v[80:83], v[40:43]
    ds_read2_b32 v[70:71], v150 offset0:178 offset1:179
    v_mfma_f32_16x16x32_bf16 v[44:47], v[76:79], v[80:83], v[44:47]
    s_waitcnt lgkmcnt(13)
    ds_read2_b32 v[72:73], v151 offset0:48 offset1:49
    ds_read2_b32 v[76:77], v151 offset0:176 offset1:177
    s_waitcnt lgkmcnt(13)
    ds_read2_b32 v[78:79], v151 offset0:178 offset1:179
    ds_read2_b32 v[74:75], v151 offset0:50 offset1:51
    s_cbranch_scc1 L_mrg1

    s_waitcnt lgkmcnt(14)
    v_mfma_f32_16x16x32_bf16 v[36:39], v[48:51], v[132:135], v[36:39]
    v_mfma_f32_16x16x32_bf16 v[32:35], v[48:51], v[128:131], v[32:35]
    v_mfma_f32_16x16x32_bf16 v[28:31], v[48:51], v[124:127], v[28:31]
    v_mfma_f32_16x16x32_bf16 v[24:27], v[48:51], v[120:123], v[24:27]
    v_mfma_f32_16x16x32_bf16 v[36:39], v[52:55], v[128:131], v[36:39]
    v_mfma_f32_16x16x32_bf16 v[32:35], v[52:55], v[124:127], v[32:35]
    v_mfma_f32_16x16x32_bf16 v[28:31], v[52:55], v[120:123], v[28:31]
    s_waitcnt lgkmcnt(10)
    v_mfma_f32_16x16x32_bf16 v[24:27], v[52:55], v[116:119], v[24:27]
    v_mfma_f32_16x16x32_bf16 v[36:39], v[56:59], v[124:127], v[36:39]
    v_mfma_f32_16x16x32_bf16 v[32:35], v[56:59], v[120:123], v[32:35]
    v_mfma_f32_16x16x32_bf16 v[28:31], v[56:59], v[116:119], v[28:31]
    s_waitcnt lgkmcnt(9)
    v_mfma_f32_16x16x32_bf16 v[24:27], v[56:59], v[112:115], v[24:27]
    v_mfma_f32_16x16x32_bf16 v[36:39], v[60:63], v[120:123], v[36:39]
    v_mfma_f32_16x16x32_bf16 v[32:35], v[60:63], v[116:119], v[32:35]
    v_mfma_f32_16x16x32_bf16 v[28:31], v[60:63], v[112:115], v[28:31]
    s_waitcnt lgkmcnt(7)
    v_mfma_f32_16x16x32_bf16 v[36:39], v[64:67], v[116:119], v[36:39]
    v_mfma_f32_16x16x32_bf16 v[32:35], v[64:67], v[112:115], v[32:35]
    s_waitcnt lgkmcnt(4)
    v_mfma_f32_16x16x32_bf16 v[36:39], v[68:71], v[112:115], v[36:39]

    v_readfirstlane_b32 s99, v4
    s_cmp_lt_u32 s99, s81
    s_cbranch_scc1 L_mslow0
L_mgo0:
    v_mfma_f32_16x16x32_bf16 v[44:47], v[48:51], v[140:143], v[44:47]
    v_mfma_f32_16x16x32_bf16 v[40:43], v[48:51], v[136:139], v[40:43]
    v_mfma_f32_16x16x32_bf16 v[20:23], v[48:51], v[116:119], v[20:23]
    ds_write_b128 v158, v[24:27] offset:0
    v_mfma_f32_16x16x32_bf16 v[16:19], v[48:51], v[112:115], v[16:19]
    ds_write_b128 v158, v[28:31] offset:1024
    v_mfma_f32_16x16x32_bf16 v[44:47], v[52:55], v[136:139], v[44:47]
    ds_write_b128 v158, v[32:35] offset:2048
    v_mfma_f32_16x16x32_bf16 v[40:43], v[52:55], v[132:135], v[40:43]
    ds_write_b128 v158, v[36:39] offset:3072
    v_mfma_f32_16x16x32_bf16 v[20:23], v[52:55], v[112:115], v[20:23]
    ds_write_b32 v5, v5 offset:8
    v_mfma_f32_16x16x32_bf16 v[44:47], v[56:59], v[132:135], v[44:47]
    v_mfma_f32_16x16x32_bf16 v[40:43], v[56:59], v[128:131], v[40:43]
    v_mfma_f32_16x16x32_bf16 v[44:47], v[60:63], v[128:131], v[44:47]
    v_mfma_f32_16x16x32_bf16 v[40:43], v[60:63], v[124:127], v[40:43]
    v_mfma_f32_16x16x32_bf16 v[44:47], v[64:67], v[124:127], v[44:47]
    v_mfma_f32_16x16x32_bf16 v[40:43], v[64:67], v[120:123], v[40:43]
    v_mfma_f32_16x16x32_bf16 v[44:47], v[68:71], v[120:123], v[44:47]
    v_mfma_f32_16x16x32_bf16 v[40:43], v[68:71], v[116:119], v[40:43]
    s_waitcnt lgkmcnt(5)
    v_mfma_f32_16x16x32_bf16 v[44:47], v[72:75], v[116:119], v[44:47]
    v_mfma_f32_16x16x32_bf16 v[40:43], v[72:75], v[112:115], v[40:43]
    v_mfma_f32_16x16x32_bf16 v[44:47], v[76:79], v[112:115], v[44:47]
    s_setprio 3
L_mb0:
    ds_read_b32 v4, v6 offset:8
    ds_read_b128 v[80:83], v159 offset:0
    ds_read_b128 v[84:87], v159 offset:1024
    ds_read_b128 v[88:91], v159 offset:2048
    ds_read_b128 v[92:95], v159 offset:3072
    s_waitcnt lgkmcnt(4)
    v_readfirstlane_b32 s99, v4
    s_cmp_eq_u32 s99, 0
    s_cbranch_scc1 L_mw0
    s_waitcnt lgkmcnt(2)
    v_add_f32 v16, v16, v80
    v_add_f32 v17, v17, v81
    v_add_f32 v18, v18, v82
    v_add_f32 v19, v19, v83
    v_add_f32 v20, v20, v84
    v_add_f32 v21, v21, v85
    v_add_f32 v22, v22, v86
    v_add_f32 v23, v23, v87
    v_cvt_pk_bf16_f32 v96, v16, v17
    v_cvt_pk_bf16_f32 v97, v18, v19
    v_cvt_pk_bf16_f32 v98, v20, v21
    v_cvt_pk_bf16_f32 v99, v22, v23
    s_nop 0
    v_permlane16_swap_b32 v96, v98
    v_permlane16_swap_b32 v97, v99
    buffer_store_dwordx4 v[96:99], v157, s[44:47], 0 offen offset:0 sc1
    s_waitcnt lgkmcnt(0)
    v_add_f32 v40, v40, v88
    v_add_f32 v41, v41, v89
    v_add_f32 v42, v42, v90
    v_add_f32 v43, v43, v91
    v_add_f32 v44, v44, v92
    v_add_f32 v45, v45, v93
    v_add_f32 v46, v46, v94
    v_add_f32 v47, v47, v95
    v_cvt_pk_bf16_f32 v100, v40, v41
    v_cvt_pk_bf16_f32 v101, v42, v43
    v_cvt_pk_bf16_f32 v102, v44, v45
    v_cvt_pk_bf16_f32 v103, v46, v47
    s_nop 0
    v_permlane16_swap_b32 v100, v102
    v_permlane16_swap_b32 v101, v103
    buffer_store_dwordx4 v[100:103], v157, s[44:47], 0 offen offset:3072 sc1
    s_branch L_mrgd
L_mw0:
    s_mov_b32 s100, 0
Lw_31:
    ds_read_b32 v4, v6 offset:8
    s_waitcnt lgkmcnt(0)
    v_readfirstlane_b32 s99, v4
    s_cmp_ge_u32 s99, 1
    s_cbranch_scc1 Lwd_32
    s_add_u32 s100, s100, 1
    s_cmp_lt_u32 s100, 8388608
    s_cbranch_scc1 Lw_31
Lwd_32:
    s_branch L_mb0
L_mslow0:
    s_mov_b32 s100, 0
Lw_33:
    ds_read_b32 v4, v3 offset:64
    s_waitcnt lgkmcnt(0)
    v_readfirstlane_b32 s99, v4
    s_cmp_ge_u32 s99, s81
    s_cbranch_scc1 Lwd_34
    s_add_u32 s100, s100, 1
    s_cmp_lt_u32 s100, 8388608
    s_cbranch_scc1 Lw_33
Lwd_34:
    s_branch L_mgo0
L_mrg1:

    s_waitcnt lgkmcnt(14)
    v_mfma_f32_16x16x32_bf16 v[44:47], v[48:51], v[140:143], v[44:47]
    v_mfma_f32_16x16x32_bf16 v[40:43], v[48:51], v[136:139], v[40:43]
    s_waitcnt lgkmcnt(10)
    v_mfma_f32_16x16x32_bf16 v[20:23], v[48:51], v[116:119], v[20:23]
    s_waitcnt lgkmcnt(9)
    v_mfma_f32_16x16x32_bf16 v[16:19], v[48:51], v[112:115], v[16:19]
    v_mfma_f32_16x16x32_bf16 v[44:47], v[52:55], v[136:139], v[44:47]
    v_mfma_f32_16x16x32_bf16 v[40:43], v[52:55], v[132:135], v[40:43]
    v_mfma_f32_16x16x32_bf16 v[20:23], v[52:55], v[112:115], v[20:23]
    v_mfma_f32_16x16x32_bf16 v[44:47], v[56:59], v[132:135], v[44:47]
    v_mfma_f32_16x16x32_bf16 v[40:43], v[56:59], v[128:131], v[40:43]
    v_mfma_f32_16x16x32_bf16 v[44:47], v[60:63], v[128:131], v[44:47]
    v_mfma_f32_16x16x32_bf16 v[40:43], v[60:63], v[124:127], v[40:43]
    s_waitcnt lgkmcnt(7)
    v_mfma_f32_16x16x32_bf16 v[44:47], v[64:67], v[124:127], v[44:47]
    v_mfma_f32_16x16x32_bf16 v[40:43], v[64:67], v[120:123], v[40:43]
    s_waitcnt lgkmcnt(4)
    v_mfma_f32_16x16x32_bf16 v[44:47], v[68:71], v[120:123], v[44:47]
    v_mfma_f32_16x16x32_bf16 v[40:43], v[68:71], v[116:119], v[40:43]
    s_waitcnt lgkmcnt(0)
    v_mfma_f32_16x16x32_bf16 v[44:47], v[72:75], v[116:119], v[44:47]
    v_mfma_f32_16x16x32_bf16 v[40:43], v[72:75], v[112:115], v[40:43]
    v_mfma_f32_16x16x32_bf16 v[44:47], v[76:79], v[112:115], v[44:47]

    v_readfirstlane_b32 s99, v4
    s_cmp_lt_u32 s99, s81
    s_cbranch_scc1 L_mslow1
L_mgo1:
    v_mfma_f32_16x16x32_bf16 v[36:39], v[48:51], v[132:135], v[36:39]
    v_mfma_f32_16x16x32_bf16 v[32:35], v[48:51], v[128:131], v[32:35]
    v_mfma_f32_16x16x32_bf16 v[28:31], v[48:51], v[124:127], v[28:31]
    ds_write_b128 v158, v[16:19] offset:0
    v_mfma_f32_16x16x32_bf16 v[24:27], v[48:51], v[120:123], v[24:27]
    ds_write_b128 v158, v[20:23] offset:1024
    v_mfma_f32_16x16x32_bf16 v[36:39], v[52:55], v[128:131], v[36:39]
    ds_write_b128 v158, v[40:43] offset:2048
    v_mfma_f32_16x16x32_bf16 v[32:35], v[52:55], v[124:127], v[32:35]
    ds_write_b128 v158, v[44:47] offset:3072
    v_mfma_f32_16x16x32_bf16 v[28:31], v[52:55], v[120:123], v[28:31]
    ds_write_b32 v5, v5 offset:8
    v_mfma_f32_16x16x32_bf16 v[24:27], v[52:55], v[116:119], v[24:27]
    v_mfma_f32_16x16x32_bf16 v[36:39], v[56:59], v[124:127], v[36:39]
    v_mfma_f32_16x16x32_bf16 v[32:35], v[56:59], v[120:123], v[32:35]
    v_mfma_f32_16x16x32_bf16 v[28:31], v[56:59], v[116:119], v[28:31]
    v_mfma_f32_16x16x32_bf16 v[24:27], v[56:59], v[112:115], v[24:27]
    v_mfma_f32_16x16x32_bf16 v[36:39], v[60:63], v[120:123], v[36:39]
    v_mfma_f32_16x16x32_bf16 v[32:35], v[60:63], v[116:119], v[32:35]
    v_mfma_f32_16x16x32_bf16 v[28:31], v[60:63], v[112:115], v[28:31]
    v_mfma_f32_16x16x32_bf16 v[36:39], v[64:67], v[116:119], v[36:39]
    v_mfma_f32_16x16x32_bf16 v[32:35], v[64:67], v[112:115], v[32:35]
    v_mfma_f32_16x16x32_bf16 v[36:39], v[68:71], v[112:115], v[36:39]
    s_setprio 3
L_mb1:
    ds_read_b32 v4, v6 offset:8
    ds_read_b128 v[80:83], v159 offset:0
    ds_read_b128 v[84:87], v159 offset:1024
    ds_read_b128 v[88:91], v159 offset:2048
    ds_read_b128 v[92:95], v159 offset:3072
    s_waitcnt lgkmcnt(4)
    v_readfirstlane_b32 s99, v4
    s_cmp_eq_u32 s99, 0
    s_cbranch_scc1 L_mw1
    s_waitcnt lgkmcnt(2)
    v_add_f32 v24, v24, v80
    v_add_f32 v25, v25, v81
    v_add_f32 v26, v26, v82
    v_add_f32 v27, v27, v83
    v_add_f32 v28, v28, v84
    v_add_f32 v29, v29, v85
    v_add_f32 v30, v30, v86
    v_add_f32 v31, v31, v87
    v_cvt_pk_bf16_f32 v96, v24, v25
    v_cvt_pk_bf16_f32 v97, v26, v27
    v_cvt_pk_bf16_f32 v98, v28, v29
    v_cvt_pk_bf16_f32 v99, v30, v31
    s_nop 0
    v_permlane16_swap_b32 v96, v98
    v_permlane16_swap_b32 v97, v99
    buffer_store_dwordx4 v[96:99], v157, s[44:47], 0 offen offset:1024 sc1
    s_waitcnt lgkmcnt(0)
    v_add_f32 v32, v32, v88
    v_add_f32 v33, v33, v89
    v_add_f32 v34, v34, v90
    v_add_f32 v35, v35, v91
    v_add_f32 v36, v36, v92
    v_add_f32 v37, v37, v93
    v_add_f32 v38, v38, v94
    v_add_f32 v39, v39, v95
    v_cvt_pk_bf16_f32 v100, v32, v33
    v_cvt_pk_bf16_f32 v101, v34, v35
    v_cvt_pk_bf16_f32 v102, v36, v37
    v_cvt_pk_bf16_f32 v103, v38, v39
    s_nop 0
    v_permlane16_swap_b32 v100, v102
    v_permlane16_swap_b32 v101, v103
    buffer_store_dwordx4 v[100:103], v157, s[44:47], 0 offen offset:2048 sc1
    s_branch L_mrgd
L_mw1:
    s_mov_b32 s100, 0
Lw_35:
    ds_read_b32 v4, v6 offset:8
    s_waitcnt lgkmcnt(0)
    v_readfirstlane_b32 s99, v4
    s_cmp_ge_u32 s99, 1
    s_cbranch_scc1 Lwd_36
    s_add_u32 s100, s100, 1
    s_cmp_lt_u32 s100, 8388608
    s_cbranch_scc1 Lw_35
Lwd_36:
    s_branch L_mb1
L_mslow1:
    s_mov_b32 s100, 0
Lw_37:
    ds_read_b32 v4, v3 offset:64
    s_waitcnt lgkmcnt(0)
    v_readfirstlane_b32 s99, v4
    s_cmp_ge_u32 s99, s81
    s_cbranch_scc1 Lwd_38
    s_add_u32 s100, s100, 1
    s_cmp_lt_u32 s100, 8388608
    s_cbranch_scc1 Lw_37
Lwd_38:
    s_branch L_mgo1
L_mrgd:
    s_cmp_lg_u32 s35, 0
    s_cbranch_scc1 L_nogq
    s_setprio 3
    ds_read_b32 v4, v3 offset:76
    v_lshlrev_b32 v20, 2, v1
    v_add_u32 v20, 161088, v20
L_gqr:
    ds_read2_b32 v[32:33], v20 offset0:0 offset1:16
    ds_read2_b32 v[34:35], v20 offset0:32 offset1:48
    ds_read2_b32 v[36:37], v20 offset0:64 offset1:80
    v_lshlrev_b32 v40, 16, v8
    v_and_b32 v41, 0xffff0000, v8
    v_lshlrev_b32 v42, 16, v9
    v_and_b32 v43, 0xffff0000, v9
    v_lshlrev_b32 v44, 16, v10
    v_and_b32 v45, 0xffff0000, v10
    v_lshlrev_b32 v46, 16, v11
    v_and_b32 v47, 0xffff0000, v11
    v_lshlrev_b32 v48, 16, v14
    v_and_b32 v49, 0xffff0000, v14
    v_lshlrev_b32 v50, 16, v15
    v_and_b32 v51, 0xffff0000, v15
    v_lshlrev_b32 v52, 16, v160
    v_and_b32 v53, 0xffff0000, v160
    v_lshlrev_b32 v54, 16, v161
    v_and_b32 v55, 0xffff0000, v161
    v_lshlrev_b32 v56, 16, v162
    v_and_b32 v57, 0xffff0000, v162
    v_lshlrev_b32 v58, 16, v163
    v_and_b32 v59, 0xffff0000, v163
    v_lshlrev_b32 v60, 16, v164
    v_and_b32 v61, 0xffff0000, v164
    v_lshlrev_b32 v62, 16, v165
    v_and_b32 v63, 0xffff0000, v165
    s_waitcnt lgkmcnt(0)
    v_readfirstlane_b32 s67, v4
    v_mul_f32 v40, v32, v40
    v_mul_f32 v41, v32, v41
    v_mul_f32 v42, v32, v42
    v_mul_f32 v43, v32, v43
    v_mul_f32 v44, v33, v44
    v_mul_f32 v45, v33, v45
    v_mul_f32 v46, v33, v46
    v_mul_f32 v47, v33, v47
    v_mul_f32 v48, v34, v48
    v_mul_f32 v49, v34, v49
    v_mul_f32 v50, v34, v50
    v_mul_f32 v51, v34, v51
    v_mul_f32 v52, v35, v52
    v_mul_f32 v53, v35, v53
    v_mul_f32 v54, v35, v54
    v_mul_f32 v55, v35, v55
    v_mul_f32 v56, v36, v56
    v_mul_f32 v57, v36, v57
    v_mul_f32 v58, v36, v58
    v_mul_f32 v59, v36, v59
    v_mul_f32 v60, v37, v60
    v_mul_f32 v61, v37, v61
    v_mul_f32 v62, v37, v62
    v_mul_f32 v63, v37, v63
    s_cmp_eq_u32 s67, 2
    s_cbranch_scc1 L_gqd
    s_lshl_b32 s96, s40, 10
    s_add_u32 s96, s96, 133632
    v_add_u32 v21, s96, v12
    s_lshr_b32 s96, s40, 1
    s_lshl_b32 s96, s96, 2
    v_add_u32 v22, s96, v3
    s_mul_i32 s96, s31, 2176
    s_mul_i32 s100, s30, 21760
    s_add_u32 s96, s96, s100
    s_add_u32 s96, s96, 262144
    s_lshl_b32 s97, s40, 7
    s_add_u32 s96, s96, s97
    s_add_u32 s56, s28, s96
    s_addc_u32 s57, s29, 0
    s_xor_b32 s96, s40, 1
    s_lshl_b32 s96, s96, 12
    s_add_u32 m0, s96, 116736
    s_lshl2_add_u32 s66, s31, s40
    s_lshl_b32 s66, s66, 16
    s_mul_i32 s96, s30, 192
    s_add_u32 s66, s66, s96
    s_add_u32 s66, s66, 3670016
    s_setprio 3
L_nogq:
    v_mul_u32_u24 v5, 21760, v0
    v_add_u32 v5, s82, v5
    v_mov_b32 v6, s33
    s_waitcnt vmcnt(0)
    v_mov_b32 v4, 1
    s_mov_b64 exec, 1
    ds_add_rtn_u32 v4, v3, v4 offset:28
    s_waitcnt lgkmcnt(0)
    v_readfirstlane_b32 s98, v4
    s_mov_b64 exec, -1
    s_cmp_lg_u32 s98, 3
    s_cbranch_scc1 L_ynosig
    s_mov_b64 exec, 0x3fffff
    global_atomic_swap v5, v6, s[28:29] sc1
    s_mov_b64 exec, -1
L_ynosig:
    s_and_b32 s96, s63, 7
    s_or_b32 s96, s96, s40
    s_cbranch_scc1 L_noep
    s_mov_b32 s96, 1
    s_atomic_add s96, s[26:27], 0 glc
    s_waitcnt lgkmcnt(0)
    s_cmp_lg_u32 s96, 39
    s_cbranch_scc1 Lep_39
    s_atomic_swap s33, s[28:29], 0
Lep_39:
L_noep:
    s_cmp_lg_u32 s35, 0
    s_cbranch_scc1 L_cexit
    s_mov_b32 s100, 0
L_yp:
    s_add_u32 s100, s100, 1
    s_cmp_ge_u32 s100, 1048576
    s_cbranch_scc1 L_ypd
    s_load_dwordx16 s[4:19], s[56:57], 0 glc
    s_waitcnt lgkmcnt(0)
    s_cmp_lg_u32 s4, s33
    s_cbranch_scc1 L_yp
    s_cmp_lg_u32 s6, s33
    s_cbranch_scc1 L_yp
    s_cmp_lg_u32 s8, s33
    s_cbranch_scc1 L_yp
    s_cmp_lg_u32 s10, s33
    s_cbranch_scc1 L_yp
    s_cmp_lg_u32 s12, s33
    s_cbranch_scc1 L_yp
    s_cmp_lg_u32 s14, s33
    s_cbranch_scc1 L_yp
    s_cmp_lg_u32 s16, s33
    s_cbranch_scc1 L_yp
    s_cmp_lg_u32 s18, s33
    s_cbranch_scc1 L_yp
L_ypd:
    buffer_load_dwordx4 v144, s[44:47], s66 offen sc1 lds
    s_add_u32 m0, m0, 1024
    s_nop 0
    buffer_load_dwordx4 v145, s[44:47], s66 offen sc1 lds
    s_add_u32 m0, m0, 1024
    s_nop 0
    buffer_load_dwordx4 v146, s[44:47], s66 offen sc1 lds
    s_mov_b32 s100, 0
Lw_40:
    ds_read_b32 v4, v3 offset:28
    s_waitcnt lgkmcnt(0)
    v_readfirstlane_b32 s99, v4
    s_cmp_ge_u32 s99, 4
    s_cbranch_scc1 Lwd_41
    s_add_u32 s100, s100, 1
    s_cmp_lt_u32 s100, 8388608
    s_cbranch_scc1 Lw_40
Lwd_41:
    s_cmp_lg_u32 s67, 0
    s_cbranch_scc1 L_gqd
    s_mov_b32 s100, 0
Lw_42:
    ds_read_b32 v4, v3 offset:76
    s_waitcnt lgkmcnt(0)
    v_readfirstlane_b32 s99, v4
    s_cmp_ge_u32 s99, 1
    s_cbranch_scc1 Lwd_43
    s_sleep 1
    s_add_u32 s100, s100, 1
    s_cmp_lt_u32 s100, 8388608
    s_cbranch_scc1 Lw_42
Lwd_43:
    v_mov_b32 v4, 2
    s_branch L_gqr
L_gqd:
    v_mov_b32 v4, 1
    s_waitcnt vmcnt(0)
    ds_read_b64_tr_b16 v[64:65], v147 offset:0
    ds_read_b64_tr_b16 v[66:67], v147 offset:32
    ds_read_b64_tr_b16 v[68:69], v147 offset:64
    ds_read_b64_tr_b16 v[70:71], v147 offset:96
    ds_read_b64_tr_b16 v[72:73], v147 offset:128
    ds_read_b64_tr_b16 v[74:75], v147 offset:160
    s_waitcnt lgkmcnt(5)
    v_lshlrev_b32 v80, 16, v64
    v_and_b32 v81, 0xffff0000, v64
    v_lshlrev_b32 v82, 16, v65
    v_and_b32 v83, 0xffff0000, v65
    v_mul_f32 v40, v40, v80
    v_mul_f32 v41, v41, v81
    v_mul_f32 v42, v42, v82
    v_mul_f32 v43, v43, v83
    ds_write_b128 v21, v[40:43] offset:0
    s_waitcnt lgkmcnt(5)
    v_lshlrev_b32 v84, 16, v66
    v_and_b32 v85, 0xffff0000, v66
    v_lshlrev_b32 v86, 16, v67
    v_and_b32 v87, 0xffff0000, v67
    v_mul_f32 v44, v44, v84
    v_mul_f32 v45, v45, v85
    v_mul_f32 v46, v46, v86
    v_mul_f32 v47, v47, v87
    ds_write_b128 v21, v[44:47] offset:4096
    s_waitcnt lgkmcnt(5)
    v_lshlrev_b32 v88, 16, v68
    v_and_b32 v89, 0xffff0000, v68
    v_lshlrev_b32 v90, 16, v69
    v_and_b32 v91, 0xffff0000, v69
    v_mul_f32 v48, v48, v88
    v_mul_f32 v49, v49, v89
    v_mul_f32 v50, v50, v90
    v_mul_f32 v51, v51, v91
    ds_write_b128 v21, v[48:51] offset:8192
    s_waitcnt lgkmcnt(5)
    v_lshlrev_b32 v92, 16, v70
    v_and_b32 v93, 0xffff0000, v70
    v_lshlrev_b32 v94, 16, v71
    v_and_b32 v95, 0xffff0000, v71
    v_mul_f32 v52, v52, v92
    v_mul_f32 v53, v53, v93
    v_mul_f32 v54, v54, v94
    v_mul_f32 v55, v55, v95
    ds_write_b128 v21, v[52:55] offset:12288
    s_waitcnt lgkmcnt(5)
    v_lshlrev_b32 v96, 16, v72
    v_and_b32 v97, 0xffff0000, v72
    v_lshlrev_b32 v98, 16, v73
    v_and_b32 v99, 0xffff0000, v73
    v_mul_f32 v56, v56, v96
    v_mul_f32 v57, v57, v97
    v_mul_f32 v58, v58, v98
    v_mul_f32 v59, v59, v99
    ds_write_b128 v21, v[56:59] offset:16384
    s_waitcnt lgkmcnt(5)
    v_lshlrev_b32 v100, 16, v74
    v_and_b32 v101, 0xffff0000, v74
    v_lshlrev_b32 v102, 16, v75
    v_and_b32 v103, 0xffff0000, v75
    v_mul_f32 v60, v60, v100
    v_mul_f32 v61, v61, v101
    v_mul_f32 v62, v62, v102
    v_mul_f32 v63, v63, v103
    ds_write_b128 v21, v[60:63] offset:20480
    s_mov_b64 exec, 1
    ds_add_u32 v22, v4 offset:112
L_cexit:
    s_endpgm
L_idle:
    s_lshl3_add_u32 s96, s97, s32
    s_sub_u32 s96, s96, 260
    v_lshlrev_b32 v4, 7, v0
    v_lshlrev_b32 v5, 10, v0
    s_waitcnt lgkmcnt(0)
    s_mov_b32 s44, s28
    s_and_b32 s45, s29, 0xffff
    s_mov_b32 s46, 1048576
    s_mov_b32 s47, 0x00020000
    s_cmp_lg_u32 s96, 31
    s_cbranch_scc1 L_idl2
    s_mov_b32 s98, 77824
    s_mov_b64 exec, 0xfffffff
    buffer_load_dword v8, v5, s[44:47], s98 offen sc1
    s_mov_b64 exec, -1
L_idl2:
    s_cmp_gt_u32 s96, 1
    s_cbranch_scc1 L_idl3
    s_lshl_b32 s98, s96, 13
    s_add_u32 s98, s98, 65536
    buffer_load_dword v8, v4, s[44:47], s98 offen sc1
L_idl3:
    v_mul_u32_u24 v5, 21760, v2
    v_lshl_add_u32 v5, v1, 7, v5
    s_mov_b32 exec_lo, 0xff1fff1f
    s_mov_b32 exec_hi, 0xff1fff1f
    s_mul_i32 s98, s96, 43
    s_lshr_b32 s98, s98, 8
    s_mul_i32 s99, s98, 4294447232
    s_mul_i32 s98, s96, 87040
    s_add_u32 s98, s98, s99
    s_add_u32 s98, s98, 262144
    buffer_load_dword v9, v5, s[44:47], s98 offen sc1
    s_add_u32 s96, s96, 32
    s_min_u32 s96, s96, 59
    s_mul_i32 s98, s96, 43
    s_lshr_b32 s98, s98, 8
    s_mul_i32 s99, s98, 4294447232
    s_mul_i32 s98, s96, 87040
    s_add_u32 s98, s98, s99
    s_add_u32 s98, s98, 262144
    buffer_load_dword v10, v5, s[44:47], s98 offen sc1
    s_add_u32 s96, s96, 32
    s_min_u32 s96, s96, 59
    s_branch L_cexit
L_hg:
    v_mov_b32 v3, 160960
    s_mov_b32 s37, 0
    s_cmp_ge_u32 s32, 4
    s_cbranch_scc1 L_ps
    v_mov_b32 v6, 0
    v_and_b32 v5, 31, v0
    v_lshl_add_u32 v5, v5, 2, v3
    ds_write_b32 v5, v6
    v_lshrrev_b32 v5, 1, v1
    v_xor_b32 v5, v5, v2
    v_lshlrev_b32 v5, 4, v5
    v_lshl_add_u32 v5, v1, 7, v5
    s_add_u32 s96, s31, 1
    s_min_u32 s96, s96, 6
    s_lshl_b32 s96, s96, 11
    v_add_u32 v15, s96, v5
    v_lshlrev_b32 v16, 4, v2
    v_add_u32 v16, 159488, v16
    v_mov_b32 v20, 0
    v_mov_b32 v21, 0
    v_mov_b32 v22, 0
    v_mov_b32 v23, 0
    v_lshlrev_b32 v17, 4, v0
    s_waitcnt lgkmcnt(0)
    s_mov_b32 s40, s22
    s_and_b32 s41, s23, 0xffff
    s_mov_b32 s42, 1280
    s_mov_b32 s43, 0x00020000
    s_mov_b32 m0, 159488
    s_nop 0
    buffer_load_dwordx4 v17, s[40:43], 0 offen lds
    s_mov_b64 exec, 0xffff
    buffer_load_dwordx4 v17, s[40:43], 0 offen offset:1024 lds
    s_mov_b64 exec, -1
    v_lshrrev_b32 v4, 3, v0
    v_and_b32 v5, 7, v0
    v_mul_u32_u24 v4, 1280, v4
    v_lshlrev_b32 v6, 1, v2
    v_xor_b32 v5, v5, v6
    v_lshl_add_u32 v4, v5, 4, v4
    s_lshl_b32 s96, s31, 7
    v_add_u32 v8, s96, v4
    v_lshrrev_b32 v4, 5, v0
    v_mul_u32_u24 v5, 20480, v4
    v_add_u32 v9, v8, v5
    v_mul_u32_u24 v5, 71680, v4
    v_add_u32 v10, v8, v5
    v_mul_u32_u24 v5, 327680, v4
    v_add_u32 v11, v8, v5
    s_mov_b32 s40, s20
    s_and_b32 s41, s21, 0xffff
    s_mov_b32 s42, 819200
    s_mov_b32 s43, 0x00020000
    s_mov_b32 s44, s28
    s_and_b32 s45, s29, 0xffff
    s_mov_b32 s46, 16777216
    s_mov_b32 s47, 0x00020000
    s_load_dword s33, s[28:29], 0
    s_mov_b32 s51, 0
    s_mov_b32 s52, 0
    s_mov_b32 s38, 0x76543210
    s_movk_i32 s39, 0x98
    s_cmp_eq_u32 s3, 1
    s_cselect_b32 s38, 0x87354021, s38
    s_cselect_b32 s39, 0x96, s39
    s_cmp_eq_u32 s3, 2
    s_cselect_b32 s38, 0x68435102, s38
    s_cselect_b32 s39, 0x97, s39
    s_and_b32 s53, s38, 15
    s_lshr_b64 s[38:39], s[38:39], 4
    s_add_u32 s53, s53, s34
    s_sub_u32 s96, s53, 10
    s_cselect_b32 s53, s53, s96
    s_lshl_b32 s53, s53, 7
    s_barrier
    s_waitcnt vmcnt(0)
L_hl:
    s_cmp_gt_u32 s31, 5
    s_cbranch_scc1 L_hng
    v_add_u32 v12, s52, v15
    v_add_u32 v14, s53, v16
    v_xor_b32 v13, 64, v12
    ds_read_b128 v[24:27], v12
    ds_read_b128 v[32:35], v14 offset:0
    ds_read_b128 v[28:31], v13
    ds_read_b128 v[36:39], v14 offset:64
    s_waitcnt lgkmcnt(0)
    v_mfma_f32_16x16x32_bf16 v[20:23], v[32:35], v[24:27], v[20:23]
    v_mfma_f32_16x16x32_bf16 v[20:23], v[36:39], v[28:31], v[20:23]
L_hng:
    s_waitcnt lgkmcnt(0)
    s_add_u32 s52, s52, 38912
    s_cmp_eq_u32 s52, 116736
    s_cselect_b32 s52, 0, s52
    s_and_b32 s53, s38, 15
    s_lshr_b64 s[38:39], s[38:39], 4
    s_add_u32 s53, s53, s34
    s_sub_u32 s96, s53, 10
    s_cselect_b32 s53, s53, s96
    s_lshl_b32 s53, s53, 7
    s_cmp_lg_u32 s51, 9
    s_cbranch_scc1 L_hnw
    s_lshr_b32 s96, s2, 3
    s_mul_i32 s96, s96, 30720
    s_and_b32 s97, s2, 1
    s_mul_i32 s97, s97, 640
    s_add_u32 s96, s96, s97
    v_mul_u32_u24 v5, 13108, v0
    v_lshrrev_b32 v5, 16, v5
    v_mul_u32_u24 v5, 640, v5
    v_lshl_add_u32 v5, v0, 7, v5
    s_add_u32 s97, s96, 15360
    s_mov_b32 exec_hi, 0xfffffff
    buffer_load_dword v40, v5, s[40:43], s96 offen
    buffer_load_dword v41, v5, s[40:43], s97 offen
    s_mov_b64 exec, -1
L_hnw:
    s_add_u32 s51, s51, 1
    s_cmp_ge_u32 s51, 10
    s_cbranch_scc1 L_hld
    s_barrier
    s_branch L_hl
L_hld:
    s_mul_i32 s33, s33, 1664525
    s_add_u32 s33, s33, 1013904223
    v_mov_b32 v24, s33
    s_mul_i32 s54, s30, 768
    s_add_u32 s54, s54, 131072
    v_lshlrev_b32 v26, 3, v0
    s_cmp_gt_u32 s31, 5
    s_cbranch_scc1 L_hgd
    v_cvt_pk_bf16_f32 v25, v20, v20
    v_and_b32 v25, 0xffff0000, v25
    v_mul_f32 v25, 0xbfb8aa3b, v25
    v_exp_f32 v25, v25
    s_nop 0
    v_add_f32 v25, 1.0, v25
    v_rcp_f32 v25, v25
    s_nop 0
    v_cvt_pk_bf16_f32 v25, v25, v25
    v_and_b32 v25, 0xffff0000, v25
    s_lshl_b32 s96, s31, 7
    s_add_u32 s96, s96, s54
    s_mov_b64 exec, 0xffff
    buffer_store_dwordx2 v[24:25], v26, s[44:47], s96 offen sc1
    s_mov_b64 exec, -1
L_hgd:
    s_setprio 1
    s_barrier
    s_sub_u32 s96, 0, s36
    s_cselect_b32 s97, 5, 0
    s_add_u32 s96, s96, s97
    s_lshl_b32 m0, s96, 12
    s_mov_b32 s96, 0
    buffer_load_dwordx4 v8, s[40:43], s96 offen offset:0 lds
    s_mov_b32 s96, 24576
    buffer_load_dwordx4 v8, s[40:43], s96 offen offset:1024 lds
    s_mov_b32 s96, 8192
    buffer_load_dwordx4 v8, s[40:43], s96 offen offset:2048 lds
    s_mov_b32 s96, 32768
    buffer_load_dwordx4 v8, s[40:43], s96 offen offset:3072 lds
    s_sub_u32 s96, 1, s36
    s_cselect_b32 s97, 5, 0
    s_add_u32 s96, s96, s97
    s_lshl_b32 m0, s96, 12
    s_mov_b32 s96, 102400
    buffer_load_dwordx4 v8, s[40:43], s96 offen offset:0 lds
    s_mov_b32 s96, 126976
    buffer_load_dwordx4 v8, s[40:43], s96 offen offset:1024 lds
    s_mov_b32 s96, 110592
    buffer_load_dwordx4 v8, s[40:43], s96 offen offset:2048 lds
    s_mov_b32 s96, 135168
    buffer_load_dwordx4 v8, s[40:43], s96 offen offset:3072 lds
    s_sub_u32 s96, 2, s36
    s_cselect_b32 s97, 5, 0
    s_add_u32 s96, s96, s97
    s_lshl_b32 m0, s96, 12
    s_mov_b32 s96, 179200
    buffer_load_dwordx4 v8, s[40:43], s96 offen offset:0 lds
    s_mov_b32 s96, 203776
    buffer_load_dwordx4 v8, s[40:43], s96 offen offset:1024 lds
    s_mov_b32 s96, 187392
    buffer_load_dwordx4 v8, s[40:43], s96 offen offset:2048 lds
    s_mov_b32 s96, 211968
    buffer_load_dwordx4 v8, s[40:43], s96 offen offset:3072 lds
    s_sub_u32 s96, 3, s36
    s_cselect_b32 s97, 5, 0
    s_add_u32 s96, s96, s97
    s_lshl_b32 m0, s96, 12
    s_mov_b32 s96, 256000
    buffer_load_dwordx4 v8, s[40:43], s96 offen offset:0 lds
    s_mov_b32 s96, 280576
    buffer_load_dwordx4 v8, s[40:43], s96 offen offset:1024 lds
    s_mov_b32 s96, 264192
    buffer_load_dwordx4 v8, s[40:43], s96 offen offset:2048 lds
    s_mov_b32 s96, 288768
    buffer_load_dwordx4 v8, s[40:43], s96 offen offset:3072 lds
    s_sub_u32 s96, 4, s36
    s_cselect_b32 s97, 5, 0
    s_add_u32 s96, s96, s97
    s_lshl_b32 m0, s96, 12
    s_mov_b32 s96, 332800
    buffer_load_dwordx4 v8, s[40:43], s96 offen offset:0 lds
    s_mov_b32 s96, 357376
    buffer_load_dwordx4 v8, s[40:43], s96 offen offset:1024 lds
    s_mov_b32 s96, 340992
    buffer_load_dwordx4 v8, s[40:43], s96 offen offset:2048 lds
    s_mov_b32 s96, 365568
    buffer_load_dwordx4 v8, s[40:43], s96 offen offset:3072 lds
    s_mov_b32 m0, 20480
    s_mov_b32 s96, 20480
    buffer_load_dwordx4 v9, s[40:43], s96 offen offset:0 lds
    s_mov_b32 s96, 121856
    buffer_load_dwordx4 v9, s[40:43], s96 offen offset:1024 lds
    s_mov_b32 s96, 197632
    buffer_load_dwordx4 v9, s[40:43], s96 offen offset:2048 lds
    s_mov_b32 s96, 273408
    buffer_load_dwordx4 v9, s[40:43], s96 offen offset:3072 lds
    s_mov_b32 m0, 61440
    s_mov_b32 s96, 430080
    buffer_load_dwordx4 v9, s[40:43], s96 offen offset:0 lds
    s_mov_b32 s96, 531456
    buffer_load_dwordx4 v9, s[40:43], s96 offen offset:1024 lds
    s_mov_b32 s96, 607232
    buffer_load_dwordx4 v9, s[40:43], s96 offen offset:2048 lds
    s_mov_b32 s96, 683008
    buffer_load_dwordx4 v9, s[40:43], s96 offen offset:3072 lds
    s_mov_b32 m0, 24576
    s_mov_b32 s96, 51200
    buffer_load_dwordx4 v8, s[40:43], s96 offen offset:0 lds
    s_mov_b32 s96, 382976
    buffer_load_dwordx4 v8, s[40:43], s96 offen offset:1024 lds
    s_mov_b32 s96, 59392
    buffer_load_dwordx4 v8, s[40:43], s96 offen offset:2048 lds
    s_mov_b32 s96, 391168
    buffer_load_dwordx4 v8, s[40:43], s96 offen offset:3072 lds
    s_mov_b32 m0, 65536
    s_mov_b32 s96, 460800
    buffer_load_dwordx4 v8, s[40:43], s96 offen offset:0 lds
    s_mov_b32 s96, 792576
    buffer_load_dwordx4 v8, s[40:43], s96 offen offset:1024 lds
    s_mov_b32 s96, 468992
    buffer_load_dwordx4 v8, s[40:43], s96 offen offset:2048 lds
    s_mov_b32 s96, 800768
    buffer_load_dwordx4 v8, s[40:43], s96 offen offset:3072 lds
    s_mov_b32 m0, 28672
    s_mov_b32 s96, 76800
    buffer_load_dwordx4 v8, s[40:43], s96 offen offset:0 lds
    s_mov_b32 s96, 152576
    buffer_load_dwordx4 v8, s[40:43], s96 offen offset:1024 lds
    s_mov_b32 s96, 84992
    buffer_load_dwordx4 v8, s[40:43], s96 offen offset:2048 lds
    s_mov_b32 s96, 160768
    buffer_load_dwordx4 v8, s[40:43], s96 offen offset:3072 lds
    s_mov_b32 m0, 69632
    s_mov_b32 s96, 486400
    buffer_load_dwordx4 v8, s[40:43], s96 offen offset:0 lds
    s_mov_b32 s96, 562176
    buffer_load_dwordx4 v8, s[40:43], s96 offen offset:1024 lds
    s_mov_b32 s96, 494592
    buffer_load_dwordx4 v8, s[40:43], s96 offen offset:2048 lds
    s_mov_b32 s96, 570368
    buffer_load_dwordx4 v8, s[40:43], s96 offen offset:3072 lds
    s_mov_b32 m0, 32768
    s_mov_b32 s96, 230400
    buffer_load_dwordx4 v8, s[40:43], s96 offen offset:0 lds
    s_mov_b32 s96, 306176
    buffer_load_dwordx4 v8, s[40:43], s96 offen offset:1024 lds
    s_mov_b32 s96, 238592
    buffer_load_dwordx4 v8, s[40:43], s96 offen offset:2048 lds
    s_mov_b32 s96, 314368
    buffer_load_dwordx4 v8, s[40:43], s96 offen offset:3072 lds
    s_mov_b32 m0, 73728
    s_mov_b32 s96, 640000
    buffer_load_dwordx4 v8, s[40:43], s96 offen offset:0 lds
    s_mov_b32 s96, 715776
    buffer_load_dwordx4 v8, s[40:43], s96 offen offset:1024 lds
    s_mov_b32 s96, 648192
    buffer_load_dwordx4 v8, s[40:43], s96 offen offset:2048 lds
    s_mov_b32 s96, 723968
    buffer_load_dwordx4 v8, s[40:43], s96 offen offset:3072 lds
    s_mov_b32 m0, 36864
    s_mov_b32 s96, 353280
    buffer_load_dwordx4 v9, s[40:43], s96 offen offset:0 lds
    s_mov_b32 s96, 70656
    buffer_load_dwordx4 v11, s[40:43], s96 offen offset:1024 lds
    s_mov_b32 s96, 95232
    buffer_load_dwordx4 v10, s[40:43], s96 offen offset:2048 lds
    s_mov_b32 s96, 247808
    buffer_load_dwordx4 v10, s[40:43], s96 offen offset:3072 lds
    s_mov_b32 m0, 77824
    s_mov_b32 s96, 762880
    buffer_load_dwordx4 v9, s[40:43], s96 offen offset:0 lds
    s_mov_b32 s96, 480256
    buffer_load_dwordx4 v11, s[40:43], s96 offen offset:1024 lds
    s_mov_b32 s96, 504832
    buffer_load_dwordx4 v10, s[40:43], s96 offen offset:2048 lds
    s_mov_b32 s96, 657408
    buffer_load_dwordx4 v10, s[40:43], s96 offen offset:3072 lds
    v_lshlrev_b32 v27, 2, v0
    v_add_u32 v27, 161088, v27
    s_waitcnt vmcnt(0)
    v_mov_b32 v4, 1
    s_mov_b64 exec, 1
    ds_add_u32 v3, v4 offset:4
    s_mov_b64 exec, -1
    s_mov_b32 s100, 0
    v_mov_b32 v30, s33
L_gp:
    buffer_load_dwordx2 v[28:29], v26, s[44:47], s54 offen sc1
    s_mov_b32 exec_hi, 0
    buffer_load_dwordx2 v[30:31], v26, s[44:47], s54 offen offset:512 sc1
    s_mov_b32 exec_hi, -1
    s_waitcnt vmcnt(0)
    v_cmp_ne_u32 vcc, s33, v28
    v_cmp_ne_u32 s[56:57], s33, v30
    s_or_b64 vcc, vcc, s[56:57]
    s_cbranch_scc0 L_gpd
    s_sleep 8
    s_add_u32 s100, s100, 1
    s_cmp_lt_u32 s100, 1048576
    s_cbranch_scc1 L_gp
L_gpd:
    ds_write_b32 v27, v29
    s_mov_b32 exec_hi, 0
    ds_write_b32 v27, v31 offset:256
    s_mov_b32 exec_hi, -1
    v_mov_b32 v4, 1
    ds_write_b32 v3, v4 offset:12
    s_endpgm
L_s0:
    s_mul_i32 s33, s33, 1664525
    s_add_u32 s33, s33, 1013904223
    s_mov_b32 s44, s28
    s_and_b32 s45, s29, 0xffff
    s_mov_b32 s46, 16777216
    s_mov_b32 s47, 0x00020000
    v_lshrrev_b32 v4, 3, v0
    v_and_b32 v5, 7, v0
    v_mul_u32_u24 v4, 1280, v4
    v_lshlrev_b32 v6, 1, v2
    v_xor_b32 v5, v5, v6
    v_lshl_add_u32 v4, v5, 4, v4
    s_lshl_b32 s96, s31, 7
    v_add_u32 v8, s96, v4
    v_lshrrev_b32 v4, 5, v0
    v_mul_u32_u24 v5, 20480, v4
    v_add_u32 v9, v8, v5
    v_mul_u32_u24 v5, 71680, v4
    v_add_u32 v10, v8, v5
    v_mul_u32_u24 v5, 327680, v4
    v_add_u32 v11, v8, v5
    s_mov_b32 s40, s20
    s_and_b32 s41, s21, 0xffff
    s_mov_b32 s42, 819200
    s_mov_b32 s43, 0x00020000
    v_lshlrev_b32 v17, 4, v0
    s_waitcnt vmcnt(0)
    s_barrier
    s_mul_i32 s96, s31, 2176
    s_mul_i32 s100, s30, 21760
    s_add_u32 s96, s96, s100
    s_add_u32 s96, s96, 262656
    s_add_u32 s48, s28, s96
    s_addc_u32 s49, s29, 0
    s_lshl_b32 s52, s31, 5
    s_add_u32 s52, s52, s30
    s_mul_i32 s52, s52, 10240
    s_add_u32 s52, s52, 8781824
    s_setprio 3
    s_barrier
    s_sub_u32 s96, 0, s36
    s_cselect_b32 s97, 15, 10
    s_add_u32 s96, s96, s97
    s_lshl_b32 m0, s96, 12
    s_mov_b32 s96, 409600
    buffer_load_dwordx4 v8, s[40:43], s96 offen offset:0 lds
    s_mov_b32 s96, 434176
    buffer_load_dwordx4 v8, s[40:43], s96 offen offset:1024 lds
    s_mov_b32 s96, 417792
    buffer_load_dwordx4 v8, s[40:43], s96 offen offset:2048 lds
    s_mov_b32 s96, 442368
    buffer_load_dwordx4 v8, s[40:43], s96 offen offset:3072 lds
    s_sub_u32 s96, 1, s36
    s_cselect_b32 s97, 15, 10
    s_add_u32 s96, s96, s97
    s_lshl_b32 m0, s96, 12
    s_mov_b32 s96, 512000
    buffer_load_dwordx4 v8, s[40:43], s96 offen offset:0 lds
    s_mov_b32 s96, 536576
    buffer_load_dwordx4 v8, s[40:43], s96 offen offset:1024 lds
    s_mov_b32 s96, 520192
    buffer_load_dwordx4 v8, s[40:43], s96 offen offset:2048 lds
    s_mov_b32 s96, 544768
    buffer_load_dwordx4 v8, s[40:43], s96 offen offset:3072 lds
    s_sub_u32 s96, 2, s36
    s_cselect_b32 s97, 15, 10
    s_add_u32 s96, s96, s97
    s_lshl_b32 m0, s96, 12
    s_mov_b32 s96, 588800
    buffer_load_dwordx4 v8, s[40:43], s96 offen offset:0 lds
    s_mov_b32 s96, 613376
    buffer_load_dwordx4 v8, s[40:43], s96 offen offset:1024 lds
    s_mov_b32 s96, 596992
    buffer_load_dwordx4 v8, s[40:43], s96 offen offset:2048 lds
    s_mov_b32 s96, 621568
    buffer_load_dwordx4 v8, s[40:43], s96 offen offset:3072 lds
    s_sub_u32 s96, 3, s36
    s_cselect_b32 s97, 15, 10
    s_add_u32 s96, s96, s97
    s_lshl_b32 m0, s96, 12
    s_mov_b32 s96, 665600
    buffer_load_dwordx4 v8, s[40:43], s96 offen offset:0 lds
    s_mov_b32 s96, 690176
    buffer_load_dwordx4 v8, s[40:43], s96 offen offset:1024 lds
    s_mov_b32 s96, 673792
    buffer_load_dwordx4 v8, s[40:43], s96 offen offset:2048 lds
    s_mov_b32 s96, 698368
    buffer_load_dwordx4 v8, s[40:43], s96 offen offset:3072 lds
    s_sub_u32 s96, 4, s36
    s_cselect_b32 s97, 15, 10
    s_add_u32 s96, s96, s97
    s_lshl_b32 m0, s96, 12
    s_mov_b32 s96, 742400
    buffer_load_dwordx4 v8, s[40:43], s96 offen offset:0 lds
    s_mov_b32 s96, 766976
    buffer_load_dwordx4 v8, s[40:43], s96 offen offset:1024 lds
    s_mov_b32 s96, 750592
    buffer_load_dwordx4 v8, s[40:43], s96 offen offset:2048 lds
    s_mov_b32 s96, 775168
    buffer_load_dwordx4 v8, s[40:43], s96 offen offset:3072 lds
    s_cmp_eq_u32 s36, 0
    s_cbranch_scc1 L_s0n
    s_mov_b32 s100, 0
L_xp:
    s_add_u32 s100, s100, 1
    s_cmp_ge_u32 s100, 1048576
    s_cbranch_scc1 L_xpd
    s_load_dwordx2 s[4:5], s[48:49], 0 glc
    s_waitcnt lgkmcnt(0)
    s_cmp_lg_u32 s4, s33
    s_cbranch_scc1 L_xp
L_xpd:
    s_mov_b32 m0, 81920
    s_nop 0
    buffer_load_dwordx4 v17, s[44:47], s52 offen offset:0 sc1 lds
    buffer_load_dwordx4 v17, s[44:47], s52 offen offset:1024 sc1 lds
    buffer_load_dwordx4 v17, s[44:47], s52 offen offset:2048 sc1 lds
    buffer_load_dwordx4 v17, s[44:47], s52 offen offset:3072 sc1 lds
    s_add_u32 m0, m0, 4096
    s_add_u32 s52, s52, 4096
    buffer_load_dwordx4 v17, s[44:47], s52 offen offset:0 sc1 lds
    buffer_load_dwordx4 v17, s[44:47], s52 offen offset:1024 sc1 lds
    buffer_load_dwordx4 v17, s[44:47], s52 offen offset:2048 sc1 lds
    buffer_load_dwordx4 v17, s[44:47], s52 offen offset:3072 sc1 lds
    s_add_u32 m0, m0, 4096
    s_add_u32 s52, s52, 4096
    buffer_load_dwordx4 v17, s[44:47], s52 offen offset:0 sc1 lds
    buffer_load_dwordx4 v17, s[44:47], s52 offen offset:1024 sc1 lds
L_s0n:
    s_waitcnt vmcnt(0)
    v_mov_b32 v4, 1
    ds_write_b32 v3, v4 offset:8
    v_mov_b32 v4, 1
    s_mov_b64 exec, 1
    ds_add_u32 v3, v4 offset:4
    s_mov_b64 exec, -1
    s_endpgm
L_ps:
    s_cmp_ge_u32 s32, 4
    s_cselect_b32 s96, -4, 3
    s_add_u32 s60, s32, s96
    s_and_b32 s61, s60, 1
    s_and_b32 s96, s36, 3
    s_cselect_b32 s96, 4, 6
    s_cmp_ge_u32 s60, s96
    s_cselect_b32 s62, 1, 0
    v_mov_b32 v7, 0xf149f2ca
    v_lshlrev_b32 v4, 2, v2
    v_sub_u32 v4, v1, v4
    v_subrev_u32 v5, 0, v4
    v_and_b32 v5, 0x80000001, v5
    v_cmp_eq_u32 vcc, 0, v5
    s_nop 1
    v_cndmask_b32 v146, v7, 0, vcc
    v_cmp_eq_u32 vcc, 0x80000000, v5
    s_nop 1
    v_cndmask_b32 v150, v7, 0, vcc
    v_subrev_u32 v5, 1, v4
    v_and_b32 v5, 0x80000001, v5
    v_cmp_eq_u32 vcc, 0, v5
    s_nop 1
    v_cndmask_b32 v147, v7, 0, vcc
    v_cmp_eq_u32 vcc, 0x80000000, v5
    s_nop 1
    v_cndmask_b32 v151, v7, 0, vcc
    v_subrev_u32 v5, 2, v4
    v_and_b32 v5, 0x80000001, v5
    v_cmp_eq_u32 vcc, 0, v5
    s_nop 1
    v_cndmask_b32 v148, v7, 0, vcc
    v_cmp_eq_u32 vcc, 0x80000000, v5
    s_nop 1
    v_cndmask_b32 v152, v7, 0, vcc
    v_subrev_u32 v5, 3, v4
    v_and_b32 v5, 0x80000001, v5
    v_cmp_eq_u32 vcc, 0, v5
    s_nop 1
    v_cndmask_b32 v149, v7, 0, vcc
    v_cmp_eq_u32 vcc, 0x80000000, v5
    s_nop 1
    v_cndmask_b32 v153, v7, 0, vcc
    v_and_b32 v5, 1, v1
    v_lshlrev_b32 v6, 4, v5
    v_sub_u32 v5, v4, v5
    v_mov_b32 v4, 0x0c0c0c0c
    v_mov_b32 v7, 0xc0c0100
    v_alignbit_b32 v7, v7, v7, v6
    v_cmp_le_i32 vcc, 0, v5
    s_nop 1
    v_cndmask_b32 v154, v4, v7, vcc
    v_cndmask_b32 v156, v7, v4, vcc
    v_mov_b32 v7, 0xc0c0302
    v_alignbit_b32 v7, v7, v7, v6
    v_cmp_le_i32 vcc, 2, v5
    s_nop 1
    v_cndmask_b32 v155, v4, v7, vcc
    v_cndmask_b32 v157, v7, v4, vcc
    v_cmp_eq_u32 vcc, 0, v2
    s_nop 1
    v_cndmask_b32 v159, 0, -1, vcc
    s_mov_b32 s66, 0x3ea52b5c
    s_or_b32 s96, s30, s61
    s_cselect_b32 s67, 0, 0xf149f2ca
    s_mul_i32 s64, s61, 6128
    s_add_u32 s64, s64, 3080
    s_mul_i32 s65, s61, 3064
    s_add_u32 s65, s65, 6152
    s_lshl1_add_u32 s96, s30, s61
    s_mul_i32 s68, s96, 61440
    s_add_u32 s68, s68, 6356992
    s_mov_b32 s69, 0
    s_cmp_lg_u32 s37, 1
    s_cbranch_scc1 L_us
    s_waitcnt vmcnt(0)
    s_barrier
L_us:
    s_min_u32 s96, s36, 1
    s_lshr_b32 s97, s60, 1
    s_add_u32 s96, s96, s97
    s_lshl1_add_u32 s99, s36, s97
    s_lshr_b32 s98, s36, 2
    s_add_u32 s98, s98, 10
    s_cmp_ge_u32 s60, 4
    s_cselect_b32 s63, s98, s99
    s_add_u32 s98, s36, 11
    s_cmp_lg_u32 s62, 0
    s_cselect_b32 s63, s98, s63
    s_cselect_b32 s96, 0, s96
    s_add_u32 s98, s36, 10
    v_sub_u32 v4, s98, v1
    v_mul_u32_u24 v5, 52, v4
    v_lshrrev_b32 v5, 8, v5
    v_mul_u32_u24 v5, 5, v5
    v_sub_u32 v4, v4, v5
    s_sub_u32 s99, s63, 5
    s_cmp_lt_u32 s60, 4
    s_cbranch_scc1 L_ufs
    v_mov_b32 v4, s99
L_ufs:
    s_and_b32 s98, s2, 1
    s_lshl4_add_u32 s63, s98, s63
    s_lshl1_add_u32 s98, s98, s61
    s_lshl_b32 s98, s98, 8
    s_mul_i32 s99, s30, 21760
    s_add_u32 s98, s98, s99
    s_add_u32 s98, s98, 263168
    v_lshl_add_u32 v4, v4, 3, s98
    v_mul_u32_u24 v164, 2176, v1
    v_add_u32 v164, v164, v4
    s_mul_i32 s96, s96, 5
    s_add_u32 s96, s96, 4
    s_sub_u32 s96, s96, s36
    s_lshl3_add_u32 s97, s61, 81920
    v_add_u32 v4, s96, v2
    v_lshrrev_b32 v5, 2, v4
    v_mul_u32_u24 v5, 9216, v5
    v_lshl_add_u32 v5, v4, 8, v5
    v_lshl_add_u32 v6, v1, 4, s97
    v_add_u32 v158, v5, v6
    s_lshl_b32 s96, s96, 2
    v_lshl_add_u32 v6, v2, 8, s97
    v_add_u32 v4, s96, v1
    v_lshrrev_b32 v5, 4, v4
    v_mul_u32_u24 v5, 9984, v5
    v_lshl_add_u32 v5, v4, 4, v5
    v_add_u32 v160, v5, v6
    s_lshr_b32 s98, s96, 4
    s_mul_i32 s98, s98, 9984
    s_lshl4_add_u32 s98, s96, s98
    s_add_u32 s98, s98, 10240
    v_and_b32 v4, 3, v1
    v_lshl_add_u32 v4, v4, 4, s98
    v_add_u32 v161, v4, v6
    s_lshl_b32 s96, s63, 9
    v_lshrrev_b32 v4, 5, v0
    v_mul_u32_u24 v4, 19968, v4
    v_lshl_add_u32 v4, v0, 4, v4
    v_add_u32 v162, s96, v4
    s_lshl_b32 s96, s63, 7
    s_add_u32 s96, s96, 16384
    v_mul_u32_u24 v4, 20480, v2
    v_lshl_add_u32 v4, v1, 3, v4
    v_add_u32 v163, s96, v4
    s_cmp_eq_u32 s37, 1
    s_cbranch_scc1 L_pb10
    s_cmp_eq_u32 s37, 2
    s_cbranch_scc1 L_upre
    s_setprio 2
    v_lshrrev_b32 v5, 1, v1
    v_xor_b32 v5, v5, v2
    v_lshlrev_b32 v5, 4, v5
    v_lshl_add_u32 v140, v1, 7, v5
    v_bfe_u32 v4, v0, 2, 2
    v_lshl_add_u32 v5, v2, 3, v4
    v_lshlrev_b32 v5, 7, v5
    v_bfe_u32 v6, v0, 3, 2
    v_xor_b32 v6, s60, v6
    v_lshl_add_u32 v5, v6, 5, v5
    v_and_b32 v6, 3, v0
    v_lshl_add_u32 v5, v6, 3, v5
    v_add_u32 v141, 14336, v5
    v_mov_b32 v8, 0
    v_mov_b32 v9, 0
    v_mov_b32 v10, 0
    v_mov_b32 v11, 0
    v_mov_b32 v12, 0
    v_mov_b32 v13, 0
    v_mov_b32 v14, 0
    v_mov_b32 v15, 0
    v_mov_b32 v16, 0
    v_mov_b32 v17, 0
    v_mov_b32 v18, 0
    v_mov_b32 v19, 0
    v_mov_b32 v20, 0
    v_mov_b32 v21, 0
    v_mov_b32 v22, 0
    v_mov_b32 v23, 0
    v_mov_b32 v24, 0
    v_mov_b32 v25, 0
    v_mov_b32 v26, 0
    v_mov_b32 v27, 0
    v_mov_b32 v28, 0
    v_mov_b32 v29, 0
    v_mov_b32 v30, 0
    v_mov_b32 v31, 0
    v_mov_b32 v32, 0
    v_mov_b32 v33, 0
    v_mov_b32 v34, 0
    v_mov_b32 v35, 0
    v_mov_b32 v36, 0
    v_mov_b32 v37, 0
    v_mov_b32 v38, 0
    v_mov_b32 v39, 0
    v_mov_b32 v40, 0
    v_mov_b32 v41, 0
    v_mov_b32 v42, 0
    v_mov_b32 v43, 0
    v_mov_b32 v44, 0
    v_mov_b32 v45, 0
    v_mov_b32 v46, 0
    v_mov_b32 v47, 0
    v_mov_b32 v48, 0
    v_mov_b32 v49, 0
    v_mov_b32 v50, 0
    v_mov_b32 v51, 0
    v_mov_b32 v52, 0
    v_mov_b32 v53, 0
    v_mov_b32 v54, 0
    v_mov_b32 v55, 0
    v_mov_b32 v56, 0
    v_mov_b32 v57, 0
    v_mov_b32 v58, 0
    v_mov_b32 v59, 0
    v_mov_b32 v60, 0
    v_mov_b32 v61, 0
    v_mov_b32 v62, 0
    v_mov_b32 v63, 0
    v_mov_b32 v64, 0
    v_mov_b32 v65, 0
    v_mov_b32 v66, 0
    v_mov_b32 v67, 0
    v_mov_b32 v68, 0
    v_mov_b32 v69, 0
    v_mov_b32 v70, 0
    v_mov_b32 v71, 0
    v_mov_b32 v72, 0
    v_mov_b32 v73, 0
    v_mov_b32 v74, 0
    v_mov_b32 v75, 0
    v_mov_b32 v76, 0
    v_mov_b32 v77, 0
    v_mov_b32 v78, 0
    v_mov_b32 v79, 0
    v_mov_b32 v80, 0
    v_mov_b32 v81, 0
    v_mov_b32 v82, 0
    v_mov_b32 v83, 0
    v_mov_b32 v84, 0
    v_mov_b32 v85, 0
    v_mov_b32 v86, 0
    v_mov_b32 v87, 0
    s_mov_b32 s41, 0
    s_mov_b32 s42, 0
    v_mov_b32 v142, v140
    v_xor_b32 v143, 64, v140
    v_mov_b32 v144, v141
    s_add_u32 s96, s60, 1
    s_mul_i32 s96, s96, 10240
    s_add_u32 s96, s96, 81920
    v_lshl_add_u32 v145, v0, 4, s96
    v_lshlrev_b32 v7, 4, v0
    s_waitcnt lgkmcnt(0)
    s_mov_b32 s44, s28
    s_and_b32 s45, s29, 0xffff
    s_mov_b32 s46, 16777216
    s_mov_b32 s47, 0x00020000
    s_lshl_b32 s97, s31, 5
    s_add_u32 s97, s97, s30
    s_mul_i32 s70, s97, 10240
    s_add_u32 s70, s70, 9109504
    s_add_u32 s71, s70, 4096
    s_add_u32 s72, s70, 8192
    s_mul_i32 s97, s31, 2176
    s_mul_i32 s100, s30, 21760
    s_add_u32 s97, s97, s100
    s_add_u32 s97, s97, 264832
    s_cmp_eq_u32 s32, 7
    s_cselect_b32 s69, s97, 0
    s_cmp_eq_u32 s36, 4
    s_cselect_b32 s69, 0, s69
    s_load_dword s33, s[28:29], 0
    s_barrier
    ds_read_b64_tr_b16 v[120:121], v144 offset:4096
    ds_read_b64_tr_b16 v[122:123], v144 offset:4608
    ds_read_b128 v[88:91], v142 offset:0
    ds_read_b64_tr_b16 v[124:125], v144 offset:8192
    ds_read_b64_tr_b16 v[126:127], v144 offset:8704
    ds_read_b128 v[92:95], v142 offset:2048
    ds_read_b64_tr_b16 v[116:117], v144 offset:0
    ds_read_b64_tr_b16 v[118:119], v144 offset:512
    ds_read_b128 v[96:99], v142 offset:4096
    ds_read_b128 v[100:103], v142 offset:6144
    ds_read_b128 v[104:107], v142 offset:8192
    ds_read_b128 v[108:111], v142 offset:10240
    ds_read_b128 v[112:115], v142 offset:12288
    s_waitcnt lgkmcnt(0)
    s_mul_i32 s33, s33, 1664525
    s_add_u32 s33, s33, 1013904223
L_gl:
    s_waitcnt lgkmcnt(10)
    v_mfma_f32_16x16x32_bf16 v[32:35], v[120:123], v[88:91], v[32:35]
    ds_read_b64_tr_b16 v[132:133], v144 offset:16384
    s_waitcnt lgkmcnt(9)
    v_mfma_f32_16x16x32_bf16 v[60:63], v[88:91], v[124:127], v[60:63]
    ds_read_b64_tr_b16 v[134:135], v144 offset:16896
    s_waitcnt lgkmcnt(9)
    v_mfma_f32_16x16x32_bf16 v[36:39], v[120:123], v[92:95], v[36:39]
    ds_read_b128 v[88:91], v143 offset:0
    v_mfma_f32_16x16x32_bf16 v[64:67], v[92:95], v[124:127], v[64:67]
    ds_read_b64_tr_b16 v[136:137], v144 offset:20480
    s_waitcnt lgkmcnt(9)
    v_mfma_f32_16x16x32_bf16 v[8:11], v[116:119], v[92:95], v[8:11]
    ds_read_b64_tr_b16 v[138:139], v144 offset:20992
    s_waitcnt lgkmcnt(9)
    v_mfma_f32_16x16x32_bf16 v[40:43], v[120:123], v[96:99], v[40:43]
    ds_read_b128 v[92:95], v143 offset:2048
    v_mfma_f32_16x16x32_bf16 v[68:71], v[96:99], v[124:127], v[68:71]
    ds_read_b64_tr_b16 v[128:129], v144 offset:12288
    v_mfma_f32_16x16x32_bf16 v[12:15], v[116:119], v[96:99], v[12:15]
    ds_read_b64_tr_b16 v[130:131], v144 offset:12800
    s_waitcnt lgkmcnt(11)
    v_mfma_f32_16x16x32_bf16 v[44:47], v[120:123], v[100:103], v[44:47]
    ds_read_b128 v[96:99], v143 offset:4096
    v_mfma_f32_16x16x32_bf16 v[72:75], v[100:103], v[124:127], v[72:75]
    v_mfma_f32_16x16x32_bf16 v[16:19], v[116:119], v[100:103], v[16:19]
    ds_read_b128 v[100:103], v143 offset:6144
    s_waitcnt lgkmcnt(12)
    v_mfma_f32_16x16x32_bf16 v[48:51], v[120:123], v[104:107], v[48:51]
    v_mfma_f32_16x16x32_bf16 v[76:79], v[104:107], v[124:127], v[76:79]
    s_add_u32 s41, s41, 38912
    v_mfma_f32_16x16x32_bf16 v[20:23], v[116:119], v[104:107], v[20:23]
    ds_read_b128 v[104:107], v143 offset:8192
    s_waitcnt lgkmcnt(12)
    v_mfma_f32_16x16x32_bf16 v[52:55], v[120:123], v[108:111], v[52:55]
    s_cmp_eq_u32 s41, 116736
    s_cselect_b32 s41, 0, s41
    v_mfma_f32_16x16x32_bf16 v[80:83], v[108:111], v[124:127], v[80:83]
    v_add_u32 v144, s41, v141
    v_mfma_f32_16x16x32_bf16 v[24:27], v[116:119], v[108:111], v[24:27]
    ds_read_b128 v[108:111], v143 offset:10240
    s_waitcnt lgkmcnt(12)
    v_mfma_f32_16x16x32_bf16 v[56:59], v[120:123], v[112:115], v[56:59]
    v_add_u32 v142, s41, v140
    v_mfma_f32_16x16x32_bf16 v[84:87], v[112:115], v[124:127], v[84:87]
    v_mfma_f32_16x16x32_bf16 v[28:31], v[116:119], v[112:115], v[28:31]
    ds_read_b128 v[112:115], v143 offset:12288
    s_waitcnt lgkmcnt(10)
    v_mfma_f32_16x16x32_bf16 v[32:35], v[132:135], v[88:91], v[32:35]
    s_waitcnt lgkmcnt(8)
    v_mfma_f32_16x16x32_bf16 v[60:63], v[88:91], v[136:139], v[60:63]
    v_xor_b32 v143, 64, v142
    s_waitcnt lgkmcnt(7)
    v_mfma_f32_16x16x32_bf16 v[36:39], v[132:135], v[92:95], v[36:39]
    s_add_u32 s42, s42, 1
    v_mfma_f32_16x16x32_bf16 v[64:67], v[92:95], v[136:139], v[64:67]
    s_waitcnt lgkmcnt(5)
    v_mfma_f32_16x16x32_bf16 v[8:11], v[128:131], v[92:95], v[8:11]
    s_waitcnt lgkmcnt(0)

    v_mfma_f32_16x16x32_bf16 v[40:43], v[132:135], v[96:99], v[40:43]
    v_mfma_f32_16x16x32_bf16 v[68:71], v[96:99], v[136:139], v[68:71]
    s_barrier
    v_mfma_f32_16x16x32_bf16 v[12:15], v[128:131], v[96:99], v[12:15]
    ds_read_b64_tr_b16 v[120:121], v144 offset:4096
    v_mfma_f32_16x16x32_bf16 v[44:47], v[132:135], v[100:103], v[44:47]
    ds_read_b64_tr_b16 v[122:123], v144 offset:4608
    v_mfma_f32_16x16x32_bf16 v[72:75], v[100:103], v[136:139], v[72:75]
    ds_read_b128 v[88:91], v142 offset:0
    v_mfma_f32_16x16x32_bf16 v[16:19], v[128:131], v[100:103], v[16:19]
    ds_read_b64_tr_b16 v[124:125], v144 offset:8192
    v_mfma_f32_16x16x32_bf16 v[48:51], v[132:135], v[104:107], v[48:51]
    ds_read_b64_tr_b16 v[126:127], v144 offset:8704
    v_mfma_f32_16x16x32_bf16 v[76:79], v[104:107], v[136:139], v[76:79]
    ds_read_b128 v[92:95], v142 offset:2048
    v_mfma_f32_16x16x32_bf16 v[20:23], v[128:131], v[104:107], v[20:23]
    ds_read_b64_tr_b16 v[116:117], v144 offset:0
    v_mfma_f32_16x16x32_bf16 v[52:55], v[132:135], v[108:111], v[52:55]
    ds_read_b64_tr_b16 v[118:119], v144 offset:512
    v_mfma_f32_16x16x32_bf16 v[80:83], v[108:111], v[136:139], v[80:83]
    ds_read_b128 v[96:99], v142 offset:4096
    v_mfma_f32_16x16x32_bf16 v[24:27], v[128:131], v[108:111], v[24:27]
    ds_read_b128 v[100:103], v142 offset:6144
    v_mfma_f32_16x16x32_bf16 v[56:59], v[132:135], v[112:115], v[56:59]
    ds_read_b128 v[104:107], v142 offset:8192
    v_mfma_f32_16x16x32_bf16 v[84:87], v[112:115], v[136:139], v[84:87]
    ds_read_b128 v[108:111], v142 offset:10240
    s_cmp_lt_u32 s42, 9
    v_mfma_f32_16x16x32_bf16 v[28:31], v[128:131], v[112:115], v[28:31]
    ds_read_b128 v[112:115], v142 offset:12288
    s_cbranch_scc1 L_gl
    s_cmp_lg_u32 s69, 0
    s_cbranch_scc1 L_lsend

    s_waitcnt lgkmcnt(10)
    v_mfma_f32_16x16x32_bf16 v[32:35], v[120:123], v[88:91], v[32:35]
    ds_read_b64_tr_b16 v[132:133], v144 offset:16384
    s_waitcnt lgkmcnt(9)
    v_mfma_f32_16x16x32_bf16 v[60:63], v[88:91], v[124:127], v[60:63]
    ds_read_b128 v[88:91], v143 offset:0
    s_waitcnt lgkmcnt(5)
    v_mfma_f32_16x16x32_bf16 v[44:47], v[120:123], v[100:103], v[44:47]
    ds_read_b64_tr_b16 v[134:135], v144 offset:16896
    v_mfma_f32_16x16x32_bf16 v[72:75], v[100:103], v[124:127], v[72:75]
    ds_read_b64_tr_b16 v[136:137], v144 offset:20480
    v_mfma_f32_16x16x32_bf16 v[16:19], v[116:119], v[100:103], v[16:19]
    ds_read_b128 v[100:103], v143 offset:6144
    v_mfma_f32_16x16x32_bf16 v[36:39], v[120:123], v[92:95], v[36:39]
    ds_read_b64_tr_b16 v[138:139], v144 offset:20992
    v_mfma_f32_16x16x32_bf16 v[64:67], v[92:95], v[124:127], v[64:67]
    ds_read_b64_tr_b16 v[128:129], v144 offset:12288
    v_mfma_f32_16x16x32_bf16 v[8:11], v[116:119], v[92:95], v[8:11]
    ds_read_b128 v[92:95], v143 offset:2048
    s_waitcnt lgkmcnt(8)
    v_mfma_f32_16x16x32_bf16 v[56:59], v[120:123], v[112:115], v[56:59]
    ds_read_b64_tr_b16 v[130:131], v144 offset:12800
    v_mfma_f32_16x16x32_bf16 v[84:87], v[112:115], v[124:127], v[84:87]
    v_mfma_f32_16x16x32_bf16 v[28:31], v[116:119], v[112:115], v[28:31]
    ds_read_b128 v[112:115], v143 offset:12288
    s_waitcnt lgkmcnt(7)
    v_mfma_f32_16x16x32_bf16 v[32:35], v[132:135], v[88:91], v[32:35]
    s_waitcnt lgkmcnt(4)
    v_mfma_f32_16x16x32_bf16 v[60:63], v[88:91], v[136:139], v[60:63]
    v_mfma_f32_16x16x32_bf16 v[44:47], v[132:135], v[100:103], v[44:47]
    v_mfma_f32_16x16x32_bf16 v[72:75], v[100:103], v[136:139], v[72:75]
    s_waitcnt lgkmcnt(1)
    v_mfma_f32_16x16x32_bf16 v[16:19], v[128:131], v[100:103], v[16:19]
    s_nop 1
    v_cvt_pk_bf16_f32 v32, v32, v33
    v_cvt_pk_bf16_f32 v33, v34, v35
    v_mfma_f32_16x16x32_bf16 v[48:51], v[120:123], v[104:107], v[48:51]
    v_cvt_pk_bf16_f32 v60, v60, v61
    v_cvt_pk_bf16_f32 v61, v62, v63
    v_mfma_f32_16x16x32_bf16 v[76:79], v[104:107], v[124:127], v[76:79]
    v_cvt_pk_bf16_f32 v34, v44, v45
    v_cvt_pk_bf16_f32 v35, v46, v47
    v_mfma_f32_16x16x32_bf16 v[20:23], v[116:119], v[104:107], v[20:23]
    ds_read_b128 v[104:107], v143 offset:8192
    ds_write_b128 v145, v[32:35] offset:3072
    s_waitcnt lgkmcnt(2)
    v_mfma_f32_16x16x32_bf16 v[56:59], v[132:135], v[112:115], v[56:59]
    v_cvt_pk_bf16_f32 v62, v72, v73
    v_cvt_pk_bf16_f32 v63, v74, v75
    v_mfma_f32_16x16x32_bf16 v[84:87], v[112:115], v[136:139], v[84:87]
    ds_write_b128 v145, v[60:63] offset:6144
    v_cvt_pk_bf16_f32 v16, v16, v17
    v_mfma_f32_16x16x32_bf16 v[28:31], v[128:131], v[112:115], v[28:31]
    v_cvt_pk_bf16_f32 v17, v18, v19
    v_mfma_f32_16x16x32_bf16 v[40:43], v[120:123], v[96:99], v[40:43]
    v_mfma_f32_16x16x32_bf16 v[68:71], v[96:99], v[124:127], v[68:71]
    v_cvt_pk_bf16_f32 v56, v56, v57
    v_cvt_pk_bf16_f32 v57, v58, v59
    v_mfma_f32_16x16x32_bf16 v[12:15], v[116:119], v[96:99], v[12:15]
    ds_read_b128 v[96:99], v143 offset:4096
    v_cvt_pk_bf16_f32 v58, v84, v85
    v_mfma_f32_16x16x32_bf16 v[36:39], v[132:135], v[92:95], v[36:39]
    v_cvt_pk_bf16_f32 v59, v86, v87
    ds_write_b128 v145, v[56:59] offset:9216
    v_mfma_f32_16x16x32_bf16 v[64:67], v[92:95], v[136:139], v[64:67]
    v_cvt_pk_bf16_f32 v18, v28, v29
    v_cvt_pk_bf16_f32 v19, v30, v31
    v_mfma_f32_16x16x32_bf16 v[8:11], v[128:131], v[92:95], v[8:11]
    ds_write_b128 v145, v[16:19] offset:2048
    v_mfma_f32_16x16x32_bf16 v[52:55], v[120:123], v[108:111], v[52:55]
    v_mfma_f32_16x16x32_bf16 v[80:83], v[108:111], v[124:127], v[80:83]
    v_cvt_pk_bf16_f32 v36, v36, v37
    v_cvt_pk_bf16_f32 v37, v38, v39
    v_mfma_f32_16x16x32_bf16 v[24:27], v[116:119], v[108:111], v[24:27]
    ds_read_b128 v[108:111], v143 offset:10240
    v_cvt_pk_bf16_f32 v64, v64, v65
    s_waitcnt lgkmcnt(6)
    v_mfma_f32_16x16x32_bf16 v[48:51], v[132:135], v[104:107], v[48:51]
    v_cvt_pk_bf16_f32 v65, v66, v67
    v_cvt_pk_bf16_f32 v8, v8, v9
    v_mfma_f32_16x16x32_bf16 v[76:79], v[104:107], v[136:139], v[76:79]
    v_cvt_pk_bf16_f32 v9, v10, v11
    v_mfma_f32_16x16x32_bf16 v[20:23], v[128:131], v[104:107], v[20:23]
    s_waitcnt lgkmcnt(3)
    v_mfma_f32_16x16x32_bf16 v[40:43], v[132:135], v[96:99], v[40:43]
    v_mfma_f32_16x16x32_bf16 v[68:71], v[96:99], v[136:139], v[68:71]
    v_cvt_pk_bf16_f32 v38, v48, v49
    v_cvt_pk_bf16_f32 v39, v50, v51
    v_mfma_f32_16x16x32_bf16 v[12:15], v[128:131], v[96:99], v[12:15]
    ds_write_b128 v145, v[36:39] offset:4096
    v_cvt_pk_bf16_f32 v66, v76, v77
    s_waitcnt lgkmcnt(1)
    v_mfma_f32_16x16x32_bf16 v[52:55], v[132:135], v[108:111], v[52:55]
    v_cvt_pk_bf16_f32 v67, v78, v79
    ds_write_b128 v145, v[64:67] offset:7168
    v_mfma_f32_16x16x32_bf16 v[80:83], v[108:111], v[136:139], v[80:83]
    v_cvt_pk_bf16_f32 v10, v20, v21
    v_cvt_pk_bf16_f32 v11, v22, v23
    v_mfma_f32_16x16x32_bf16 v[24:27], v[128:131], v[108:111], v[24:27]
    ds_write_b128 v145, v[8:11] offset:0
    v_cvt_pk_bf16_f32 v40, v40, v41
    v_cvt_pk_bf16_f32 v41, v42, v43
    v_cvt_pk_bf16_f32 v68, v68, v69
    v_cvt_pk_bf16_f32 v69, v70, v71
    v_cvt_pk_bf16_f32 v12, v12, v13
    v_cvt_pk_bf16_f32 v13, v14, v15
    v_cvt_pk_bf16_f32 v42, v52, v53
    v_cvt_pk_bf16_f32 v43, v54, v55
    ds_write_b128 v145, v[40:43] offset:5120
    v_cvt_pk_bf16_f32 v70, v80, v81
    v_cvt_pk_bf16_f32 v71, v82, v83
    ds_write_b128 v145, v[68:71] offset:8192
    v_cvt_pk_bf16_f32 v14, v24, v25
    v_cvt_pk_bf16_f32 v15, v26, v27
    ds_write_b128 v145, v[12:15] offset:1024
    s_branch L_pb10b
L_lsend:

    s_waitcnt lgkmcnt(10)
    v_mfma_f32_16x16x32_bf16 v[32:35], v[120:123], v[88:91], v[32:35]
    ds_read_b64_tr_b16 v[132:133], v144 offset:16384
    s_waitcnt lgkmcnt(9)
    v_mfma_f32_16x16x32_bf16 v[60:63], v[88:91], v[124:127], v[60:63]
    ds_read_b128 v[88:91], v143 offset:0
    s_waitcnt lgkmcnt(5)
    v_mfma_f32_16x16x32_bf16 v[44:47], v[120:123], v[100:103], v[44:47]
    ds_read_b64_tr_b16 v[134:135], v144 offset:16896
    v_mfma_f32_16x16x32_bf16 v[72:75], v[100:103], v[124:127], v[72:75]
    ds_read_b64_tr_b16 v[136:137], v144 offset:20480
    v_mfma_f32_16x16x32_bf16 v[16:19], v[116:119], v[100:103], v[16:19]
    ds_read_b128 v[100:103], v143 offset:6144
    v_mfma_f32_16x16x32_bf16 v[36:39], v[120:123], v[92:95], v[36:39]
    ds_read_b64_tr_b16 v[138:139], v144 offset:20992
    v_mfma_f32_16x16x32_bf16 v[64:67], v[92:95], v[124:127], v[64:67]
    ds_read_b64_tr_b16 v[128:129], v144 offset:12288
    v_mfma_f32_16x16x32_bf16 v[8:11], v[116:119], v[92:95], v[8:11]
    ds_read_b128 v[92:95], v143 offset:2048
    s_waitcnt lgkmcnt(8)
    v_mfma_f32_16x16x32_bf16 v[56:59], v[120:123], v[112:115], v[56:59]
    ds_read_b64_tr_b16 v[130:131], v144 offset:12800
    v_mfma_f32_16x16x32_bf16 v[84:87], v[112:115], v[124:127], v[84:87]
    v_mfma_f32_16x16x32_bf16 v[28:31], v[116:119], v[112:115], v[28:31]
    ds_read_b128 v[112:115], v143 offset:12288
    s_waitcnt lgkmcnt(7)
    v_mfma_f32_16x16x32_bf16 v[32:35], v[132:135], v[88:91], v[32:35]
    s_waitcnt lgkmcnt(4)
    v_mfma_f32_16x16x32_bf16 v[60:63], v[88:91], v[136:139], v[60:63]
    v_mfma_f32_16x16x32_bf16 v[44:47], v[132:135], v[100:103], v[44:47]
    v_mfma_f32_16x16x32_bf16 v[72:75], v[100:103], v[136:139], v[72:75]
    s_waitcnt lgkmcnt(1)
    v_mfma_f32_16x16x32_bf16 v[16:19], v[128:131], v[100:103], v[16:19]
    s_nop 1
    v_cvt_pk_bf16_f32 v32, v32, v33
    v_cvt_pk_bf16_f32 v33, v34, v35
    v_mfma_f32_16x16x32_bf16 v[48:51], v[120:123], v[104:107], v[48:51]
    v_cvt_pk_bf16_f32 v60, v60, v61
    v_cvt_pk_bf16_f32 v61, v62, v63
    v_mfma_f32_16x16x32_bf16 v[76:79], v[104:107], v[124:127], v[76:79]
    v_cvt_pk_bf16_f32 v34, v44, v45
    v_cvt_pk_bf16_f32 v35, v46, v47
    v_mfma_f32_16x16x32_bf16 v[20:23], v[116:119], v[104:107], v[20:23]
    ds_read_b128 v[104:107], v143 offset:8192
    buffer_store_dwordx4 v[32:35], v7, s[44:47], s70 offen offset:3072 sc1
    s_waitcnt lgkmcnt(1)
    v_mfma_f32_16x16x32_bf16 v[56:59], v[132:135], v[112:115], v[56:59]
    ds_write_b128 v145, v[32:35] offset:3072
    v_cvt_pk_bf16_f32 v62, v72, v73
    v_mfma_f32_16x16x32_bf16 v[84:87], v[112:115], v[136:139], v[84:87]
    v_cvt_pk_bf16_f32 v63, v74, v75
    buffer_store_dwordx4 v[60:63], v7, s[44:47], s71 offen offset:2048 sc1
    v_mfma_f32_16x16x32_bf16 v[28:31], v[128:131], v[112:115], v[28:31]
    ds_write_b128 v145, v[60:63] offset:6144
    v_cvt_pk_bf16_f32 v16, v16, v17
    v_mfma_f32_16x16x32_bf16 v[40:43], v[120:123], v[96:99], v[40:43]
    v_cvt_pk_bf16_f32 v17, v18, v19
    v_mfma_f32_16x16x32_bf16 v[68:71], v[96:99], v[124:127], v[68:71]
    v_cvt_pk_bf16_f32 v56, v56, v57
    v_cvt_pk_bf16_f32 v57, v58, v59
    v_mfma_f32_16x16x32_bf16 v[12:15], v[116:119], v[96:99], v[12:15]
    ds_read_b128 v[96:99], v143 offset:4096
    v_cvt_pk_bf16_f32 v58, v84, v85
    v_mfma_f32_16x16x32_bf16 v[36:39], v[132:135], v[92:95], v[36:39]
    v_cvt_pk_bf16_f32 v59, v86, v87
    buffer_store_dwordx4 v[56:59], v7, s[44:47], s72 offen offset:1024 sc1
    v_mfma_f32_16x16x32_bf16 v[64:67], v[92:95], v[136:139], v[64:67]
    ds_write_b128 v145, v[56:59] offset:9216
    v_cvt_pk_bf16_f32 v18, v28, v29
    v_mfma_f32_16x16x32_bf16 v[8:11], v[128:131], v[92:95], v[8:11]
    v_cvt_pk_bf16_f32 v19, v30, v31
    buffer_store_dwordx4 v[16:19], v7, s[44:47], s70 offen offset:2048 sc1
    v_mfma_f32_16x16x32_bf16 v[52:55], v[120:123], v[108:111], v[52:55]
    ds_write_b128 v145, v[16:19] offset:2048
    v_mfma_f32_16x16x32_bf16 v[80:83], v[108:111], v[124:127], v[80:83]
    v_cvt_pk_bf16_f32 v36, v36, v37
    v_cvt_pk_bf16_f32 v37, v38, v39
    v_mfma_f32_16x16x32_bf16 v[24:27], v[116:119], v[108:111], v[24:27]
    ds_read_b128 v[108:111], v143 offset:10240
    v_cvt_pk_bf16_f32 v64, v64, v65
    s_waitcnt lgkmcnt(6)
    v_mfma_f32_16x16x32_bf16 v[48:51], v[132:135], v[104:107], v[48:51]
    v_cvt_pk_bf16_f32 v65, v66, v67
    v_cvt_pk_bf16_f32 v8, v8, v9
    v_mfma_f32_16x16x32_bf16 v[76:79], v[104:107], v[136:139], v[76:79]
    v_cvt_pk_bf16_f32 v9, v10, v11
    v_mfma_f32_16x16x32_bf16 v[20:23], v[128:131], v[104:107], v[20:23]
    s_waitcnt lgkmcnt(3)
    v_mfma_f32_16x16x32_bf16 v[40:43], v[132:135], v[96:99], v[40:43]
    v_mfma_f32_16x16x32_bf16 v[68:71], v[96:99], v[136:139], v[68:71]
    v_cvt_pk_bf16_f32 v38, v48, v49
    v_cvt_pk_bf16_f32 v39, v50, v51
    v_mfma_f32_16x16x32_bf16 v[12:15], v[128:131], v[96:99], v[12:15]
    buffer_store_dwordx4 v[36:39], v7, s[44:47], s71 offen offset:0 sc1
    ds_write_b128 v145, v[36:39] offset:4096
    s_waitcnt lgkmcnt(1)
    v_mfma_f32_16x16x32_bf16 v[52:55], v[132:135], v[108:111], v[52:55]
    v_cvt_pk_bf16_f32 v66, v76, v77
    v_cvt_pk_bf16_f32 v67, v78, v79
    v_mfma_f32_16x16x32_bf16 v[80:83], v[108:111], v[136:139], v[80:83]
    buffer_store_dwordx4 v[64:67], v7, s[44:47], s71 offen offset:3072 sc1
    ds_write_b128 v145, v[64:67] offset:7168
    v_mfma_f32_16x16x32_bf16 v[24:27], v[128:131], v[108:111], v[24:27]
    v_cvt_pk_bf16_f32 v10, v20, v21
    v_cvt_pk_bf16_f32 v11, v22, v23
    buffer_store_dwordx4 v[8:11], v7, s[44:47], s70 offen offset:0 sc1
    ds_write_b128 v145, v[8:11] offset:0
    v_cvt_pk_bf16_f32 v40, v40, v41
    v_cvt_pk_bf16_f32 v41, v42, v43
    v_cvt_pk_bf16_f32 v68, v68, v69
    v_cvt_pk_bf16_f32 v69, v70, v71
    v_cvt_pk_bf16_f32 v12, v12, v13
    v_cvt_pk_bf16_f32 v13, v14, v15
    v_cvt_pk_bf16_f32 v42, v52, v53
    v_cvt_pk_bf16_f32 v43, v54, v55
    buffer_store_dwordx4 v[40:43], v7, s[44:47], s71 offen offset:1024 sc1
    ds_write_b128 v145, v[40:43] offset:5120
    v_cvt_pk_bf16_f32 v70, v80, v81
    v_cvt_pk_bf16_f32 v71, v82, v83
    buffer_store_dwordx4 v[68:71], v7, s[44:47], s72 offen offset:0 sc1
    ds_write_b128 v145, v[68:71] offset:8192
    v_cvt_pk_bf16_f32 v14, v24, v25
    v_cvt_pk_bf16_f32 v15, v26, v27
    buffer_store_dwordx4 v[12:15], v7, s[44:47], s70 offen offset:1024 sc1
    ds_write_b128 v145, v[12:15] offset:1024
    s_branch L_pb10b
L_pb10:
    s_mov_b32 s44, s28
    s_and_b32 s45, s29, 0xffff
    s_mov_b32 s46, 16777216
    s_mov_b32 s47, 0x00020000
    s_mul_i32 s33, s33, 1664525
    s_add_u32 s33, s33, 1013904223
    s_setprio 1
L_pb10b:
    v_mov_b32 v165, s33
L_upre:
    v_add_u32 v132, s64, v158
    v_add_u32 v133, s65, v160
    v_add_u32 v134, s65, v161
    s_cmp_eq_u32 s37, 2
    s_cbranch_scc1 L_unit
    v_add_f32 v136, s67, v150
    v_add_f32 v137, s67, v151
    v_add_f32 v138, s67, v152
    v_add_f32 v139, s67, v153
    s_waitcnt lgkmcnt(0)
    s_barrier
L_unit:
    s_cmp_eq_u32 s62, 0
    s_cbranch_scc1 L_ugo
    s_mov_b32 s100, 0
Lw_44:
    ds_read_b32 v4, v3 offset:8
    s_waitcnt lgkmcnt(0)
    v_readfirstlane_b32 s99, v4
    s_cmp_ge_u32 s99, 1
    s_cbranch_scc1 Lwd_45
    s_sleep 1
    s_add_u32 s100, s100, 1
    s_cmp_lt_u32 s100, 8388608
    s_cbranch_scc1 Lw_44
Lwd_45:
    s_setprio 3
L_ugo:
    ds_read_b64 v[104:105], v158 offset:0
    ds_read_b64 v[106:107], v158 offset:10240
    ds_read_b64 v[88:89], v158 offset:3072
    ds_read_b64 v[90:91], v158 offset:13312
    ds_read_b64 v[92:93], v158 offset:4096
    ds_read_b64 v[94:95], v158 offset:14336
    ds_read_b64 v[108:109], v158 offset:1024
    ds_read_b64 v[110:111], v158 offset:11264
    ds_read_b64 v[96:97], v158 offset:5120
    ds_read_b64 v[98:99], v158 offset:15360
    ds_read_b64 v[112:113], v158 offset:2048
    ds_read_b64 v[114:115], v158 offset:12288
    ds_read_b64 v[100:101], v132 offset:0
    ds_read_b64 v[102:103], v132 offset:10240
    s_waitcnt lgkmcnt(12)
    v_and_b32 v106, v106, v159
    v_and_b32 v107, v107, v159
    s_waitcnt lgkmcnt(8)
    s_nop 0
    v_mfma_f32_16x16x32_bf16 v[20:23], v[88:91], v[104:107], v[136:139]
    v_mfma_f32_16x16x32_bf16 v[8:11], v[92:95], v[104:107], v[146:149]
    s_waitcnt lgkmcnt(6)
    v_and_b32 v110, v110, v159
    v_and_b32 v111, v111, v159
    s_waitcnt lgkmcnt(4)
    s_nop 0
    v_mfma_f32_16x16x32_bf16 v[24:27], v[92:95], v[108:111], v[150:153]
    v_mfma_f32_16x16x32_bf16 v[12:15], v[96:99], v[108:111], v[146:149]
    s_waitcnt lgkmcnt(2)
    v_and_b32 v114, v114, v159
    v_and_b32 v115, v115, v159
    s_waitcnt lgkmcnt(0)
    s_nop 0
    v_mfma_f32_16x16x32_bf16 v[28:31], v[96:99], v[112:115], v[150:153]
    v_mfma_f32_16x16x32_bf16 v[16:19], v[100:103], v[112:115], v[146:149]
    ds_read_b64 v[120:121], v160 offset:7168
    ds_read_b64 v[122:123], v160 offset:6144
    ds_read_b64 v[118:119], v160 offset:8192
    ds_read_b64 v[116:117], v133 offset:0
    ds_read_b64 v[128:129], v161 offset:7168
    ds_read_b64 v[130:131], v161 offset:6144
    ds_read_b64 v[126:127], v161 offset:8192
    ds_read_b64 v[124:125], v134 offset:0
    v_max3_f32 v32, v20, v21, v8
    v_max3_f32 v36, v22, v23, v10
    v_max_f32 v32, v32, v9
    v_max_f32 v36, v36, v11
    v_max_f32 v40, v32, v36
    v_max3_f32 v33, v24, v25, v12
    v_max3_f32 v37, v26, v27, v14
    v_max_f32 v33, v33, v13
    v_max_f32 v37, v37, v15
    v_max_f32 v41, v33, v37
    v_max3_f32 v34, v28, v29, v16
    v_max3_f32 v38, v30, v31, v18
    v_max_f32 v34, v34, v17
    v_max_f32 v38, v38, v19
    v_permlane32_swap_b32 v40, v41
    v_max_f32 v42, v34, v38
    v_max_f32 v40, v40, v41
    s_add_u32 s96, s68, 40960
    v_permlane32_swap_b32 v42, v43
    v_max_f32 v42, v42, v43
    s_nop 1
    v_permlane16_swap_b32 v40, v42
    v_max_f32 v40, v40, v42
    v_mul_f32 v42, s66, v40
    v_mul_f32 v40, s66, v40
    s_nop 1
    v_permlane16_swap_b32 v40, v42
    v_mov_b32 v41, v40
    v_mov_b32 v43, v42
    s_waitcnt lgkmcnt(0)
    v_permlane32_swap_b32 v40, v41
    v_permlane32_swap_b32 v42, v43
    s_cmp_eq_u32 s69, 0
    s_cbranch_scc1 Lxs_46
    s_waitcnt vmcnt(0)
    s_atomic_swap s33, s[28:29], s69
Lxs_46:
    v_fma_f32 v32, v32, s66, -v40
    v_fma_f32 v36, v36, s66, -v40
    v_fma_f32 v33, v33, s66, -v41
    v_fma_f32 v37, v37, s66, -v41
    v_fma_f32 v34, v34, s66, -v42
    v_fma_f32 v38, v38, s66, -v42
    v_exp_f32 v32, v32
    v_exp_f32 v36, v36
    v_exp_f32 v33, v33
    v_exp_f32 v37, v37
    v_exp_f32 v34, v34
    v_exp_f32 v38, v38
    v_add_f32 v40, v32, v36
    v_add_f32 v41, v33, v37
    v_add_f32 v42, v34, v38
    s_nop 0
    v_permlane32_swap_b32 v40, v41
    v_permlane32_swap_b32 v42, v43
    v_add_f32 v40, v40, v41
    v_add_f32 v42, v42, v43
    s_nop 1
    v_permlane16_swap_b32 v40, v42
    v_add_f32 v40, v40, v42
    v_rcp_f32 v42, v40
    v_rcp_f32 v40, v40
    s_nop 1
    v_permlane16_swap_b32 v40, v42
    v_mov_b32 v41, v40
    v_mov_b32 v43, v42
    s_nop 0
    v_permlane32_swap_b32 v40, v41
    v_permlane32_swap_b32 v42, v43
    v_mul_f32 v32, v32, v40
    v_mul_f32 v36, v36, v40
    v_cvt_pk_bf16_f32 v32, v32, v36
    v_perm_b32 v44, v32, v32, v154
    v_perm_b32 v45, v32, v32, v155
    v_perm_b32 v46, v32, v32, v156
    v_perm_b32 v47, v32, v32, v157
    v_mul_f32 v33, v33, v41
    v_mul_f32 v37, v37, v41
    v_cvt_pk_bf16_f32 v33, v33, v37
    v_perm_b32 v48, v33, v33, v154
    v_perm_b32 v49, v33, v33, v155
    v_perm_b32 v50, v33, v33, v156
    v_perm_b32 v51, v33, v33, v157
    v_mfma_f32_16x16x32_bf16 v[8:11], v[120:123], v[44:47], 0
    v_mfma_f32_16x16x32_bf16 v[20:23], v[128:131], v[44:47], 0
    v_mul_f32 v34, v34, v42
    v_mul_f32 v38, v38, v42
    v_cvt_pk_bf16_f32 v34, v34, v38
    v_perm_b32 v52, v34, v34, v154
    v_perm_b32 v53, v34, v34, v155
    v_perm_b32 v54, v34, v34, v156
    v_perm_b32 v55, v34, v34, v157
    v_mfma_f32_16x16x32_bf16 v[12:15], v[118:121], v[48:51], 0
    v_mfma_f32_16x16x32_bf16 v[24:27], v[126:129], v[48:51], 0
    v_mfma_f32_16x16x32_bf16 v[16:19], v[116:119], v[52:55], 0
    v_mfma_f32_16x16x32_bf16 v[28:31], v[124:127], v[52:55], 0
    v_cvt_pk_bf16_f32 v60, v8, v9
    v_cvt_pk_bf16_f32 v61, v10, v11
    v_cvt_pk_bf16_f32 v68, v20, v21
    v_cvt_pk_bf16_f32 v69, v22, v23
    s_nop 0
    v_cvt_pk_bf16_f32 v62, v12, v13
    v_cvt_pk_bf16_f32 v63, v14, v15
    s_nop 0
    v_permlane32_swap_b32 v60, v62
    v_permlane32_swap_b32 v61, v63
    buffer_store_dwordx4 v[60:63], v162, s[44:47], s68 offen sc1
    v_cvt_pk_bf16_f32 v64, v16, v17
    v_cvt_pk_bf16_f32 v65, v18, v19
    s_nop 0
    v_permlane32_swap_b32 v64, v66
    v_permlane32_swap_b32 v65, v67
    s_mov_b32 exec_lo, 0
    v_cvt_pk_bf16_f32 v68, v28, v29
    v_cvt_pk_bf16_f32 v69, v30, v31
    s_mov_b64 exec, 0xffff0000
    v_cvt_pk_bf16_f32 v68, v24, v25
    v_cvt_pk_bf16_f32 v69, v26, v27
    s_mov_b32 exec_lo, -1
    buffer_store_dwordx4 v[64:67], v162, s[44:47], s96 offen sc1
    s_mov_b32 exec_hi, 0xffff
    buffer_store_dwordx2 v[68:69], v163, s[44:47], s68 offen sc1
    s_mov_b64 exec, -1
    s_cmp_lg_u32 s37, 0
    s_cbranch_scc1 L_nops
    s_lshr_b32 s75, s60, 1
    s_lshl_b32 s96, s75, 13
    s_add_u32 s72, s68, s96
    s_add_u32 s73, s72, 20480
    s_add_u32 s74, s72, 40960
    s_mul_i32 s96, s31, 2176
    s_mul_i32 s100, s30, 21760
    s_add_u32 s96, s96, s100
    s_add_u32 s96, s96, 263168
    s_lshl_b32 s97, s60, 8
    s_add_u32 s96, s96, s97
    s_add_u32 s76, s28, s96
    s_addc_u32 s77, s29, 0
    s_mul_i32 s80, s60, 6144
    s_add_u32 s80, s80, 81920
    s_xor_b32 s96, s60, 2
    s_mul_i32 s81, s96, 6144
    s_add_u32 s81, s81, 81920
    s_mul_i32 s82, s61, 12288
    s_lshl_b32 s96, s75, 11
    s_add_u32 s82, s82, s96
    s_add_u32 s82, s82, 133632
    s_lshl1_add_u32 s96, s30, s61
    s_mul_i32 s79, s96, 61440
    s_lshl1_add_u32 s96, s31, s75
    s_lshl_b32 s96, s96, 6
    s_add_u32 s79, s79, s96
    s_mov_b32 s48, s24
    s_and_b32 s49, s25, 0xffff
    s_mov_b32 s50, 2621440
    s_mov_b32 s51, 0x00020000
    v_lshrrev_b32 v58, 2, v0
    v_and_b32 v59, 3, v0
    v_bfe_u32 v57, v0, 3, 2
    s_mul_i32 s96, s75, 6144
    s_sub_u32 s96, 16384, s96
    v_lshl_add_u32 v7, v0, 3, s96
    s_mul_i32 s96, s75, 40960
    v_lshl_add_u32 v5, v58, 7, s96
    v_lshl_add_u32 v5, v59, 3, v5
    s_lshl_b32 s96, s75, 1
    v_xor_b32 v6, s96, v57
    v_lshl_add_u32 v160, v6, 5, v5
    v_xor_b32 v161, 32, v160
    v_xor_b32 v162, 64, v160
    v_xor_b32 v163, 96, v160
    v_lshlrev_b32 v5, 4, v0
    v_add_u32 v6, 4096, v5
    v_xor_b32 v59, v59, v57
    v_mul_u32_u24 v58, 1280, v58
    v_lshl_add_u32 v58, v59, 4, v58
    s_mul_i32 s96, s61, 192
    s_add_u32 s96, s96, 161088
    v_lshl_add_u32 v57, v1, 2, s96
    v_bfe_u32 v59, v1, 1, 2
    v_lshl_add_u32 v1, v1, 6, s81
    v_lshlrev_b32 v59, 1, v59
    v_xor_b32 v59, v59, v2
    v_lshl_add_u32 v1, v59, 3, v1
    v_mov_b32 v2, v58
L_nops:
    s_lshl_b32 s96, s62, 4
    v_add_u32 v56, s96, v3
    v_mov_b32 v4, 1
    s_mov_b64 exec, 1
    ds_add_u32 v56, v4 offset:0
    s_mov_b64 exec, -1
    s_cmp_lg_u32 s37, 0
    s_cbranch_scc1 L_lsig
    s_lshl_b32 s96, s61, 3
    v_add_u32 v56, s96, v3
    s_waitcnt vmcnt(0)
    v_mov_b32 v4, 1
    s_mov_b64 exec, 1
    ds_add_rtn_u32 v4, v56, v4 offset:24
    s_waitcnt lgkmcnt(0)
    v_readfirstlane_b32 s97, v4
    s_mov_b64 exec, -1
    s_cmp_lg_u32 s97, 1
    s_cbranch_scc1 L_nosig
L_lsig:
    s_waitcnt vmcnt(0)
    s_mov_b64 exec, 0x3ff
    global_atomic_swap v164, v165, s[28:29] sc1
    s_mov_b64 exec, -1
L_nosig:
    s_cmp_eq_u32 s37, 0
    s_cbranch_scc1 L_op
    s_lshr_b32 s97, s36, 2
    s_andn2_b32 s96, s97, s62
    s_cbranch_scc0 L_pexit
    s_mov_b32 s62, 1
    s_mov_b32 s37, 2
    s_branch L_us
L_op:
    s_lshl_b32 s85, s36, 10
    s_mov_b32 s100, 0
    v_mov_b32 v116, v57
    s_lshl_b32 s96, s60, 2
    v_add_u32 v164, s96, v3
    s_load_dwordx16 s[4:19], s[76:77], 0 glc
    s_load_dwordx8 s[20:27], s[76:77], 64 glc
    s_mov_b32 s100, 0
Lw_47:
    ds_read_b32 v4, v3 offset:4
    s_waitcnt lgkmcnt(0)
    v_readfirstlane_b32 s99, v4
    s_cmp_ge_u32 s99, 2
    s_cbranch_scc1 Lwd_48
    s_add_u32 s100, s100, 1
    s_cmp_lt_u32 s100, 8388608
    s_cbranch_scc1 Lw_47
Lwd_48:
    s_mov_b32 s100, 0
    ds_read_b64_tr_b16 v[140:141], v160 offset:0
    ds_read_b64_tr_b16 v[142:143], v160 offset:2048
    ds_read_b64_tr_b16 v[144:145], v161 offset:0
    ds_read_b64_tr_b16 v[146:147], v161 offset:2048
    ds_read_b64_tr_b16 v[148:149], v162 offset:0
    ds_read_b64_tr_b16 v[150:151], v162 offset:2048
    ds_read_b64_tr_b16 v[152:153], v163 offset:0
    ds_read_b64_tr_b16 v[154:155], v163 offset:2048
    ds_read_b64_tr_b16 v[156:157], v160 offset:4096
    ds_read_b64_tr_b16 v[158:159], v160 offset:6144
L_nb0:
    s_cmp_lg_u32 s4, s33
    s_cbranch_scc1 L_ns0
L_ng0:
    s_add_u32 s96, s72, s85
    buffer_load_dwordx4 v[56:59], v5, s[44:47], s96 offen sc1
    s_add_u32 s96, s73, s85
    buffer_load_dwordx4 v[60:63], v5, s[44:47], s96 offen sc1
    s_add_u32 s96, s74, s85
    buffer_load_dwordx4 v[64:67], v5, s[44:47], s96 offen sc1
    s_add_u32 s85, s85, 1024
    s_cmp_eq_u32 s85, 5120
    s_cselect_b32 s85, 0, s85
L_nb1:
    s_cmp_lg_u32 s6, s33
    s_cbranch_scc1 L_ns1
L_ng1:
    s_add_u32 s96, s72, s85
    buffer_load_dwordx4 v[68:71], v5, s[44:47], s96 offen sc1
    s_add_u32 s96, s73, s85
    buffer_load_dwordx4 v[72:75], v5, s[44:47], s96 offen sc1
    s_add_u32 s96, s74, s85
    buffer_load_dwordx4 v[76:79], v5, s[44:47], s96 offen sc1
    s_add_u32 s85, s85, 1024
    s_cmp_eq_u32 s85, 5120
    s_cselect_b32 s85, 0, s85
L_nb2:
    s_cmp_lg_u32 s8, s33
    s_cbranch_scc1 L_ns2
L_ng2:
    s_add_u32 s96, s72, s85
    buffer_load_dwordx4 v[80:83], v5, s[44:47], s96 offen sc1
    s_add_u32 s96, s73, s85
    buffer_load_dwordx4 v[84:87], v5, s[44:47], s96 offen sc1
    s_add_u32 s96, s74, s85
    buffer_load_dwordx4 v[88:91], v5, s[44:47], s96 offen sc1
    s_add_u32 s85, s85, 1024
    s_cmp_eq_u32 s85, 5120
    s_cselect_b32 s85, 0, s85
L_nb3:
    s_cmp_lg_u32 s10, s33
    s_cbranch_scc1 L_ns3
L_ng3:
    s_add_u32 s96, s72, s85
    buffer_load_dwordx4 v[92:95], v5, s[44:47], s96 offen sc1
    s_add_u32 s96, s73, s85
    buffer_load_dwordx4 v[96:99], v5, s[44:47], s96 offen sc1
    s_add_u32 s96, s74, s85
    buffer_load_dwordx4 v[100:103], v5, s[44:47], s96 offen sc1
    s_add_u32 s85, s85, 1024
    s_cmp_eq_u32 s85, 5120
    s_cselect_b32 s85, 0, s85

L_nb4:
    s_cmp_lg_u32 s12, s33
    s_cbranch_scc1 L_ns4
L_ng4:
    s_cmp_lg_u32 s14, s33
    s_cbranch_scc1 Lar_50
    s_cmp_eq_u32 s16, s33
    s_cbranch_scc1 Lah_49
Lar_50:
    s_load_dwordx16 s[4:19], s[76:77], 0 glc
Lah_49:
    s_waitcnt vmcnt(11)
    s_waitcnt lgkmcnt(8)
    v_mfma_f32_16x16x32_bf16 v[8:11], v[140:143], v[56:59], 0
    s_waitcnt vmcnt(10)
    v_mfma_f32_16x16x32_bf16 v[24:27], v[140:143], v[60:63], 0
    s_waitcnt vmcnt(9)
    v_mfma_f32_16x16x32_bf16 v[40:43], v[140:143], v[64:67], 0
    s_add_u32 s96, s72, s85
    buffer_load_dwordx4 v[104:107], v5, s[44:47], s96 offen sc1
    s_waitcnt lgkmcnt(6)
    v_mfma_f32_16x16x32_bf16 v[12:15], v[144:147], v[56:59], 0
    ds_read_b64_tr_b16 v[140:141], v161 offset:4096
    v_mfma_f32_16x16x32_bf16 v[28:31], v[144:147], v[60:63], 0
    ds_read_b64_tr_b16 v[142:143], v161 offset:6144
    v_mfma_f32_16x16x32_bf16 v[44:47], v[144:147], v[64:67], 0
    s_add_u32 s96, s73, s85
    buffer_load_dwordx4 v[108:111], v5, s[44:47], s96 offen sc1
    s_waitcnt lgkmcnt(6)
    v_mfma_f32_16x16x32_bf16 v[16:19], v[148:151], v[56:59], 0
    ds_read_b64_tr_b16 v[144:145], v162 offset:4096
    v_mfma_f32_16x16x32_bf16 v[32:35], v[148:151], v[60:63], 0
    ds_read_b64_tr_b16 v[146:147], v162 offset:6144
    v_mfma_f32_16x16x32_bf16 v[48:51], v[148:151], v[64:67], 0
    s_add_u32 s96, s74, s85
    buffer_load_dwordx4 v[112:115], v5, s[44:47], s96 offen sc1
    s_waitcnt lgkmcnt(6)
    v_mfma_f32_16x16x32_bf16 v[20:23], v[152:155], v[56:59], 0
    ds_read_b64_tr_b16 v[148:149], v163 offset:4096
    v_mfma_f32_16x16x32_bf16 v[36:39], v[152:155], v[60:63], 0
    ds_read_b64_tr_b16 v[150:151], v163 offset:6144
    v_mfma_f32_16x16x32_bf16 v[52:55], v[152:155], v[64:67], 0
    s_cmp_lg_u32 s14, s33
    s_cbranch_scc1 Lar_52
    s_cmp_eq_u32 s16, s33
    s_cbranch_scc1 Lah_51
Lar_52:
    s_load_dwordx16 s[4:19], s[76:77], 0 glc
Lah_51:
    s_waitcnt vmcnt(11)
    s_waitcnt lgkmcnt(6)
    v_mfma_f32_16x16x32_bf16 v[8:11], v[156:159], v[68:71], v[8:11]
    ds_read_b64_tr_b16 v[152:153], v160 offset:8192
    buffer_load_dwordx2 v[56:57], v7, s[44:47], s72 offen offset:0 sc1
    s_waitcnt vmcnt(11)
    v_mfma_f32_16x16x32_bf16 v[24:27], v[156:159], v[72:75], v[24:27]
    ds_read_b64_tr_b16 v[154:155], v160 offset:10240
    buffer_load_dwordx2 v[58:59], v7, s[44:47], s72 offen offset:512 sc1
    s_waitcnt vmcnt(11)
    v_mfma_f32_16x16x32_bf16 v[40:43], v[156:159], v[76:79], v[40:43]
    buffer_load_dwordx2 v[60:61], v7, s[44:47], s73 offen offset:0 sc1
    s_waitcnt lgkmcnt(6)
    v_mfma_f32_16x16x32_bf16 v[12:15], v[140:143], v[68:71], v[12:15]
    ds_read_b64_tr_b16 v[156:157], v161 offset:8192
    v_mfma_f32_16x16x32_bf16 v[28:31], v[140:143], v[72:75], v[28:31]
    ds_read_b64_tr_b16 v[158:159], v161 offset:10240
    v_mfma_f32_16x16x32_bf16 v[44:47], v[140:143], v[76:79], v[44:47]
    buffer_load_dwordx2 v[62:63], v7, s[44:47], s73 offen offset:512 sc1
    s_waitcnt lgkmcnt(6)
    v_mfma_f32_16x16x32_bf16 v[16:19], v[144:147], v[68:71], v[16:19]
    ds_read_b64_tr_b16 v[140:141], v162 offset:8192
    v_mfma_f32_16x16x32_bf16 v[32:35], v[144:147], v[72:75], v[32:35]
    ds_read_b64_tr_b16 v[142:143], v162 offset:10240
    v_mfma_f32_16x16x32_bf16 v[48:51], v[144:147], v[76:79], v[48:51]
    buffer_load_dwordx2 v[64:65], v7, s[44:47], s74 offen offset:0 sc1
    s_waitcnt lgkmcnt(6)
    v_mfma_f32_16x16x32_bf16 v[20:23], v[148:151], v[68:71], v[20:23]
    ds_read_b64_tr_b16 v[144:145], v163 offset:8192
    v_mfma_f32_16x16x32_bf16 v[36:39], v[148:151], v[72:75], v[36:39]
    ds_read_b64_tr_b16 v[146:147], v163 offset:10240
    v_mfma_f32_16x16x32_bf16 v[52:55], v[148:151], v[76:79], v[52:55]
    buffer_load_dwordx2 v[66:67], v7, s[44:47], s74 offen offset:512 sc1
L_nb6:
    s_cmp_lg_u32 s14, s33
    s_cbranch_scc1 L_ns6
    s_cmp_lg_u32 s16, s33
    s_cbranch_scc1 L_ns6
L_ng6:
    s_waitcnt vmcnt(14)
    s_waitcnt lgkmcnt(6)
    v_mfma_f32_16x16x32_bf16 v[8:11], v[152:155], v[80:83], v[8:11]
    ds_read_b64_tr_b16 v[148:149], v160 offset:12288
    s_waitcnt vmcnt(13)
    v_mfma_f32_16x16x32_bf16 v[24:27], v[152:155], v[84:87], v[24:27]
    ds_read_b64_tr_b16 v[150:151], v160 offset:14336
    s_waitcnt vmcnt(12)
    v_mfma_f32_16x16x32_bf16 v[40:43], v[152:155], v[88:91], v[40:43]
    buffer_load_dwordx4 v[68:71], v6, s[44:47], s72 offen offset:1024 sc1
    s_waitcnt lgkmcnt(6)
    v_mfma_f32_16x16x32_bf16 v[12:15], v[156:159], v[80:83], v[12:15]
    ds_read_b64_tr_b16 v[152:153], v161 offset:12288
    v_mfma_f32_16x16x32_bf16 v[28:31], v[156:159], v[84:87], v[28:31]
    ds_read_b64_tr_b16 v[154:155], v161 offset:14336
    v_mfma_f32_16x16x32_bf16 v[44:47], v[156:159], v[88:91], v[44:47]
    buffer_load_dwordx4 v[72:75], v6, s[44:47], s73 offen offset:1024 sc1
    s_waitcnt lgkmcnt(6)
    v_mfma_f32_16x16x32_bf16 v[16:19], v[140:143], v[80:83], v[16:19]
    ds_read_b64_tr_b16 v[156:157], v162 offset:12288
    v_mfma_f32_16x16x32_bf16 v[32:35], v[140:143], v[84:87], v[32:35]
    ds_read_b64_tr_b16 v[158:159], v162 offset:14336
    v_mfma_f32_16x16x32_bf16 v[48:51], v[140:143], v[88:91], v[48:51]
    buffer_load_dwordx4 v[76:79], v6, s[44:47], s74 offen offset:1024 sc1
    s_waitcnt lgkmcnt(6)
    v_mfma_f32_16x16x32_bf16 v[20:23], v[144:147], v[80:83], v[20:23]
    ds_read_b64_tr_b16 v[140:141], v163 offset:12288
    v_mfma_f32_16x16x32_bf16 v[36:39], v[144:147], v[84:87], v[36:39]
    ds_read_b64_tr_b16 v[142:143], v163 offset:14336
    v_mfma_f32_16x16x32_bf16 v[52:55], v[144:147], v[88:91], v[52:55]
    s_load_dwordx16 s[4:19], s[76:77], 0 glc
    s_load_dwordx8 s[20:27], s[76:77], 64 glc
    s_waitcnt vmcnt(14)
    s_waitcnt lgkmcnt(6)
    v_mfma_f32_16x16x32_bf16 v[8:11], v[148:151], v[92:95], v[8:11]
    ds_read_b64_tr_b16 v[144:145], v160 offset:16384
    s_waitcnt vmcnt(13)
    v_mfma_f32_16x16x32_bf16 v[24:27], v[148:151], v[96:99], v[24:27]
    ds_read_b64_tr_b16 v[146:147], v160 offset:18432
    s_waitcnt vmcnt(12)
    v_mfma_f32_16x16x32_bf16 v[40:43], v[148:151], v[100:103], v[40:43]
    s_waitcnt lgkmcnt(6)
    v_mfma_f32_16x16x32_bf16 v[12:15], v[152:155], v[92:95], v[12:15]
    ds_read_b64_tr_b16 v[148:149], v161 offset:16384
    v_mfma_f32_16x16x32_bf16 v[28:31], v[152:155], v[96:99], v[28:31]
    ds_read_b64_tr_b16 v[150:151], v161 offset:18432
    v_mfma_f32_16x16x32_bf16 v[44:47], v[152:155], v[100:103], v[44:47]
    s_waitcnt lgkmcnt(6)
    v_mfma_f32_16x16x32_bf16 v[16:19], v[156:159], v[92:95], v[16:19]
    ds_read_b64_tr_b16 v[152:153], v162 offset:16384
    v_mfma_f32_16x16x32_bf16 v[32:35], v[156:159], v[96:99], v[32:35]
    ds_read_b64_tr_b16 v[154:155], v162 offset:18432
    v_mfma_f32_16x16x32_bf16 v[48:51], v[156:159], v[100:103], v[48:51]
    s_waitcnt lgkmcnt(6)
    v_mfma_f32_16x16x32_bf16 v[20:23], v[140:143], v[92:95], v[20:23]
    ds_read_b64_tr_b16 v[156:157], v163 offset:16384
    v_mfma_f32_16x16x32_bf16 v[36:39], v[140:143], v[96:99], v[36:39]
    ds_read_b64_tr_b16 v[158:159], v163 offset:18432
    v_mfma_f32_16x16x32_bf16 v[52:55], v[140:143], v[100:103], v[52:55]
    s_waitcnt vmcnt(11)
    s_waitcnt lgkmcnt(6)
    v_mfma_f32_16x16x32_bf16 v[8:11], v[144:147], v[104:107], v[8:11]
    ds_read_b64_tr_b16 v[140:141], v160 offset:20480
    s_waitcnt vmcnt(10)
    v_mfma_f32_16x16x32_bf16 v[24:27], v[144:147], v[108:111], v[24:27]
    ds_read_b64_tr_b16 v[142:143], v160 offset:22528
    s_waitcnt vmcnt(9)
    v_mfma_f32_16x16x32_bf16 v[40:43], v[144:147], v[112:115], v[40:43]
    s_waitcnt lgkmcnt(6)
    v_mfma_f32_16x16x32_bf16 v[12:15], v[148:151], v[104:107], v[12:15]
    ds_read_b64_tr_b16 v[144:145], v161 offset:20480
    v_mfma_f32_16x16x32_bf16 v[28:31], v[148:151], v[108:111], v[28:31]
    ds_read_b64_tr_b16 v[146:147], v161 offset:22528
    v_mfma_f32_16x16x32_bf16 v[44:47], v[148:151], v[112:115], v[44:47]
    s_waitcnt lgkmcnt(6)
    v_mfma_f32_16x16x32_bf16 v[16:19], v[152:155], v[104:107], v[16:19]
    ds_read_b64_tr_b16 v[148:149], v162 offset:20480
    v_mfma_f32_16x16x32_bf16 v[32:35], v[152:155], v[108:111], v[32:35]
    ds_read_b64_tr_b16 v[150:151], v162 offset:22528
    v_mfma_f32_16x16x32_bf16 v[48:51], v[152:155], v[112:115], v[48:51]
    s_waitcnt lgkmcnt(6)
    v_mfma_f32_16x16x32_bf16 v[20:23], v[156:159], v[104:107], v[20:23]
    ds_read_b64_tr_b16 v[152:153], v163 offset:20480
    v_mfma_f32_16x16x32_bf16 v[36:39], v[156:159], v[108:111], v[36:39]
    ds_read_b64_tr_b16 v[154:155], v163 offset:22528
    v_mfma_f32_16x16x32_bf16 v[52:55], v[156:159], v[112:115], v[52:55]
L_nb7:
    s_cmp_lg_u32 s18, s33
    s_cbranch_scc1 L_ns7
    s_cmp_lg_u32 s20, s33
    s_cbranch_scc1 L_ns7
L_ng7:
L_nb8:
    s_cmp_lg_u32 s22, s33
    s_cbranch_scc1 L_ns8
    s_cmp_lg_u32 s24, s33
    s_cbranch_scc1 L_ns8
L_ng8:
    buffer_load_dwordx4 v[80:83], v6, s[44:47], s72 offen offset:2048 sc1
    buffer_load_dwordx4 v[84:87], v6, s[44:47], s73 offen offset:2048 sc1
    buffer_load_dwordx4 v[88:91], v6, s[44:47], s74 offen offset:2048 sc1
    s_waitcnt vmcnt(10)
    s_waitcnt lgkmcnt(6)
    v_mfma_f32_16x16x32_bf16 v[8:11], v[140:143], v[56:59], v[8:11]
    ds_read_b64_tr_b16 v[156:157], v160 offset:24576
    buffer_load_dwordx4 v[92:95], v6, s[44:47], s72 offen offset:3072 sc1
    s_waitcnt vmcnt(9)
    v_mfma_f32_16x16x32_bf16 v[24:27], v[140:143], v[60:63], v[24:27]
    ds_read_b64_tr_b16 v[158:159], v160 offset:26624
    buffer_load_dwordx4 v[96:99], v6, s[44:47], s73 offen offset:3072 sc1
    s_waitcnt vmcnt(8)
    v_mfma_f32_16x16x32_bf16 v[40:43], v[140:143], v[64:67], v[40:43]
    buffer_load_dwordx4 v[100:103], v6, s[44:47], s74 offen offset:3072 sc1
    s_waitcnt lgkmcnt(6)
    v_mfma_f32_16x16x32_bf16 v[12:15], v[144:147], v[56:59], v[12:15]
    ds_read_b64_tr_b16 v[140:141], v161 offset:24576
    buffer_load_dwordx2 v[104:105], v7, s[44:47], s72 offen offset:1024 sc1
    v_mfma_f32_16x16x32_bf16 v[28:31], v[144:147], v[60:63], v[28:31]
    ds_read_b64_tr_b16 v[142:143], v161 offset:26624
    buffer_load_dwordx2 v[106:107], v7, s[44:47], s72 offen offset:1536 sc1
    v_mfma_f32_16x16x32_bf16 v[44:47], v[144:147], v[64:67], v[44:47]
    buffer_load_dwordx2 v[108:109], v7, s[44:47], s73 offen offset:1024 sc1
    s_waitcnt lgkmcnt(6)
    v_mfma_f32_16x16x32_bf16 v[16:19], v[148:151], v[56:59], v[16:19]
    ds_read_b64_tr_b16 v[144:145], v162 offset:24576
    buffer_load_dwordx2 v[110:111], v7, s[44:47], s73 offen offset:1536 sc1
    v_mfma_f32_16x16x32_bf16 v[32:35], v[148:151], v[60:63], v[32:35]
    ds_read_b64_tr_b16 v[146:147], v162 offset:26624
    v_mfma_f32_16x16x32_bf16 v[48:51], v[148:151], v[64:67], v[48:51]
    buffer_load_dwordx2 v[112:113], v7, s[44:47], s74 offen offset:1024 sc1
    s_waitcnt lgkmcnt(6)
    v_mfma_f32_16x16x32_bf16 v[20:23], v[152:155], v[56:59], v[20:23]
    ds_read_b64_tr_b16 v[148:149], v163 offset:24576
    v_mfma_f32_16x16x32_bf16 v[36:39], v[152:155], v[60:63], v[36:39]
    ds_read_b64_tr_b16 v[150:151], v163 offset:26624
    v_mfma_f32_16x16x32_bf16 v[52:55], v[152:155], v[64:67], v[52:55]
    buffer_load_dwordx2 v[114:115], v7, s[44:47], s74 offen offset:1536 sc1
    s_waitcnt vmcnt(14)
    s_waitcnt lgkmcnt(6)
    v_mfma_f32_16x16x32_bf16 v[8:11], v[156:159], v[68:71], v[8:11]
    ds_read_b64_tr_b16 v[152:153], v162 offset:28672
    s_waitcnt vmcnt(13)
    v_mfma_f32_16x16x32_bf16 v[24:27], v[156:159], v[72:75], v[24:27]
    ds_read_b64_tr_b16 v[154:155], v162 offset:30720
    s_waitcnt vmcnt(12)
    v_mfma_f32_16x16x32_bf16 v[40:43], v[156:159], v[76:79], v[40:43]
    s_waitcnt lgkmcnt(6)
    v_mfma_f32_16x16x32_bf16 v[12:15], v[140:143], v[68:71], v[12:15]
    ds_read_b64_tr_b16 v[156:157], v163 offset:28672
    v_mfma_f32_16x16x32_bf16 v[28:31], v[140:143], v[72:75], v[28:31]
    ds_read_b64_tr_b16 v[158:159], v163 offset:30720
    v_mfma_f32_16x16x32_bf16 v[44:47], v[140:143], v[76:79], v[44:47]
    s_waitcnt lgkmcnt(6)
    v_mfma_f32_16x16x32_bf16 v[16:19], v[144:147], v[68:71], v[16:19]
    ds_read_b64_tr_b16 v[140:141], v162 offset:32768
    v_mfma_f32_16x16x32_bf16 v[32:35], v[144:147], v[72:75], v[32:35]
    ds_read_b64_tr_b16 v[142:143], v162 offset:34816
    v_mfma_f32_16x16x32_bf16 v[48:51], v[144:147], v[76:79], v[48:51]
    s_waitcnt lgkmcnt(6)
    v_mfma_f32_16x16x32_bf16 v[20:23], v[148:151], v[68:71], v[20:23]
    ds_read_b64_tr_b16 v[144:145], v163 offset:32768
    v_mfma_f32_16x16x32_bf16 v[36:39], v[148:151], v[72:75], v[36:39]
    ds_read_b64_tr_b16 v[146:147], v163 offset:34816
    v_mfma_f32_16x16x32_bf16 v[52:55], v[148:151], v[76:79], v[52:55]
    s_waitcnt vmcnt(11)
    s_waitcnt lgkmcnt(6)
    v_mfma_f32_16x16x32_bf16 v[16:19], v[152:155], v[80:83], v[16:19]
    ds_read_b64_tr_b16 v[148:149], v162 offset:36864
    s_waitcnt vmcnt(10)
    v_mfma_f32_16x16x32_bf16 v[32:35], v[152:155], v[84:87], v[32:35]
    ds_read_b64_tr_b16 v[150:151], v162 offset:38912
    s_waitcnt vmcnt(9)
    v_mfma_f32_16x16x32_bf16 v[48:51], v[152:155], v[88:91], v[48:51]
    s_waitcnt lgkmcnt(6)
    v_mfma_f32_16x16x32_bf16 v[20:23], v[156:159], v[80:83], v[20:23]
    ds_read_b64_tr_b16 v[152:153], v163 offset:36864
    v_mfma_f32_16x16x32_bf16 v[36:39], v[156:159], v[84:87], v[36:39]
    ds_read_b64_tr_b16 v[154:155], v163 offset:38912
    v_mfma_f32_16x16x32_bf16 v[52:55], v[156:159], v[88:91], v[52:55]
    s_waitcnt vmcnt(8)
    s_waitcnt lgkmcnt(6)
    v_mfma_f32_16x16x32_bf16 v[16:19], v[140:143], v[92:95], v[16:19]
    ds_read_b64_tr_b16 v[156:157], v160 offset:28672
    s_waitcnt vmcnt(7)
    v_mfma_f32_16x16x32_bf16 v[32:35], v[140:143], v[96:99], v[32:35]
    ds_read_b64_tr_b16 v[158:159], v160 offset:30720
    s_waitcnt vmcnt(6)
    v_mfma_f32_16x16x32_bf16 v[48:51], v[140:143], v[100:103], v[48:51]
    ds_read2_b32 v[120:121], v3 offset0:0 offset1:4
    v_add_u32 v6, s80, v5
    v_add_u32 v7, s82, v5
    v_add_u32 v5, s81, v5
    s_waitcnt lgkmcnt(7)
    v_mfma_f32_16x16x32_bf16 v[20:23], v[144:147], v[92:95], v[20:23]
    ds_read_b64_tr_b16 v[140:141], v161 offset:28672
    v_mfma_f32_16x16x32_bf16 v[36:39], v[144:147], v[96:99], v[36:39]
    ds_read_b64_tr_b16 v[142:143], v161 offset:30720
    v_mfma_f32_16x16x32_bf16 v[52:55], v[144:147], v[100:103], v[52:55]
    v_xor_b32 v165, 8, v164
    s_lshl_b32 s96, s75, 2
    v_add_u32 v166, s96, v3
    s_waitcnt vmcnt(4)
    s_waitcnt lgkmcnt(7)
    v_mfma_f32_16x16x32_bf16 v[16:19], v[148:151], v[104:107], v[16:19]
    ds_read_b64_tr_b16 v[144:145], v160 offset:32768
    s_waitcnt vmcnt(2)
    v_mfma_f32_16x16x32_bf16 v[32:35], v[148:151], v[108:111], v[32:35]
    ds_read_b64_tr_b16 v[146:147], v160 offset:34816
    s_waitcnt vmcnt(0)
    v_mfma_f32_16x16x32_bf16 v[48:51], v[148:151], v[112:115], v[48:51]
    s_waitcnt lgkmcnt(4)
    v_add_u32 v120, v120, v121
    s_lshr_b32 s96, s36, 2
    v_readfirstlane_b32 s97, v120
    s_lshl1_add_u32 s84, s96, 6
    v_mfma_f32_16x16x32_bf16 v[20:23], v[152:155], v[104:107], v[20:23]
    ds_read_b64_tr_b16 v[148:149], v161 offset:32768
    v_mfma_f32_16x16x32_bf16 v[36:39], v[152:155], v[108:111], v[36:39]
    ds_read_b64_tr_b16 v[150:151], v161 offset:34816
    v_mfma_f32_16x16x32_bf16 v[52:55], v[152:155], v[112:115], v[52:55]
    s_cmp_lt_u32 s97, s84
    s_cbranch_scc1 L_fslow
L_fgo:
    v_mfma_f32_16x16x32_bf16 v[8:11], v[156:159], v[80:83], v[8:11]
    ds_read_b64_tr_b16 v[152:153], v160 offset:36864
    v_mfma_f32_16x16x32_bf16 v[24:27], v[156:159], v[84:87], v[24:27]
    ds_read_b64_tr_b16 v[154:155], v160 offset:38912
    ds_write_b128 v6, v[16:19] offset:0
    v_mfma_f32_16x16x32_bf16 v[40:43], v[156:159], v[88:91], v[40:43]
    ds_write_b128 v6, v[32:35] offset:2048
    s_waitcnt lgkmcnt(8)
    v_mfma_f32_16x16x32_bf16 v[12:15], v[140:143], v[80:83], v[12:15]
    ds_read_b64_tr_b16 v[156:157], v161 offset:36864
    ds_write_b128 v6, v[48:51] offset:4096
    v_mfma_f32_16x16x32_bf16 v[28:31], v[140:143], v[84:87], v[28:31]
    ds_read_b64_tr_b16 v[158:159], v161 offset:38912
    ds_write_b128 v6, v[20:23] offset:1024
    v_mfma_f32_16x16x32_bf16 v[44:47], v[140:143], v[88:91], v[44:47]
    ds_write_b128 v6, v[36:39] offset:3072
    s_waitcnt lgkmcnt(11)
    v_mfma_f32_16x16x32_bf16 v[8:11], v[144:147], v[92:95], v[8:11]
    ds_write_b128 v6, v[52:55] offset:5120
    v_mfma_f32_16x16x32_bf16 v[24:27], v[144:147], v[96:99], v[24:27]
    ds_write_b32 v164, v164 offset:64
    v_mfma_f32_16x16x32_bf16 v[40:43], v[144:147], v[100:103], v[40:43]
    v_mov_b32 v162, v116
    v_xor_b32 v6, 32, v1
    s_waitcnt lgkmcnt(11)
    v_mfma_f32_16x16x32_bf16 v[12:15], v[148:151], v[92:95], v[12:15]
    ds_read_b32 v21, v166 offset:48
    v_mfma_f32_16x16x32_bf16 v[28:31], v[148:151], v[96:99], v[28:31]
    ds_read2_b32 v[16:17], v162 offset0:0 offset1:16
    v_mfma_f32_16x16x32_bf16 v[44:47], v[148:151], v[100:103], v[44:47]
    ds_read_b32 v20, v162 offset:128
    s_waitcnt lgkmcnt(12)
    v_mfma_f32_16x16x32_bf16 v[8:11], v[152:155], v[104:107], v[8:11]
    ds_read_b128 v[116:119], v7 offset:0
    v_mfma_f32_16x16x32_bf16 v[24:27], v[152:155], v[108:111], v[24:27]
    ds_read_b128 v[120:123], v7 offset:1024
    v_mfma_f32_16x16x32_bf16 v[40:43], v[152:155], v[112:115], v[40:43]
    ds_read_b128 v[124:127], v7 offset:4096
    s_waitcnt lgkmcnt(10)
    v_mfma_f32_16x16x32_bf16 v[12:15], v[156:159], v[104:107], v[12:15]
    ds_read_b128 v[128:131], v7 offset:5120
    v_mfma_f32_16x16x32_bf16 v[28:31], v[156:159], v[108:111], v[28:31]
    ds_read_b128 v[132:135], v7 offset:8192
    v_mfma_f32_16x16x32_bf16 v[44:47], v[156:159], v[112:115], v[44:47]
    ds_read_b128 v[136:139], v7 offset:9216
    s_waitcnt lgkmcnt(8)
L_fb:
    ds_read_b32 v140, v165 offset:64
    ds_read_b128 v[56:59], v5 offset:0
    ds_read_b128 v[60:63], v5 offset:1024
    ds_read_b128 v[64:67], v5 offset:2048
    ds_read_b128 v[68:71], v5 offset:3072
    ds_read_b128 v[72:75], v5 offset:4096
    ds_read_b128 v[76:79], v5 offset:5120
    s_waitcnt lgkmcnt(6)
    v_readfirstlane_b32 s96, v140
    v_readfirstlane_b32 s97, v21
    s_cmp_eq_u32 s96, 0
    s_cbranch_scc1 L_fxw
    s_cmp_lt_u32 s97, 2
    s_cbranch_scc1 L_fyw
L_yok:
    v_sub_f32 v18, 1.0, v17
    v_sub_f32 v16, 1.0, v16
    v_sub_f32 v20, 1.0, v20
    s_waitcnt lgkmcnt(5)
    v_pk_add_f32 v[56:57], v[56:57], v[8:9]
    v_pk_add_f32 v[58:59], v[58:59], v[10:11]
    v_pk_fma_f32 v[116:117], v[56:57], v[16:17], v[116:117] op_sel_hi:[1,0,1]
    v_pk_fma_f32 v[118:119], v[58:59], v[16:17], v[118:119] op_sel_hi:[1,0,1]
    v_cvt_pk_bf16_f32 v80, v116, v117
    v_cvt_pk_bf16_f32 v81, v118, v119
    ds_write_b64 v1, v[80:81] offset:0
    s_waitcnt lgkmcnt(5)
    v_pk_add_f32 v[60:61], v[60:61], v[12:13]
    v_pk_add_f32 v[62:63], v[62:63], v[14:15]
    v_pk_fma_f32 v[120:121], v[60:61], v[16:17], v[120:121] op_sel_hi:[1,0,1]
    v_pk_fma_f32 v[122:123], v[62:63], v[16:17], v[122:123] op_sel_hi:[1,0,1]
    v_cvt_pk_bf16_f32 v82, v120, v121
    v_cvt_pk_bf16_f32 v83, v122, v123
    ds_write_b64 v6, v[82:83] offset:0
    ds_read_b128 v[92:95], v5 offset:0
    s_waitcnt lgkmcnt(6)
    v_pk_add_f32 v[64:65], v[64:65], v[24:25]
    v_pk_add_f32 v[66:67], v[66:67], v[26:27]
    v_pk_fma_f32 v[124:125], v[64:65], v[18:19], v[124:125] op_sel_hi:[1,0,1]
    v_pk_fma_f32 v[126:127], v[66:67], v[18:19], v[126:127] op_sel_hi:[1,0,1]
    v_cvt_pk_bf16_f32 v84, v124, v125
    v_cvt_pk_bf16_f32 v85, v126, v127
    ds_write_b64 v1, v[84:85] offset:1024
    s_waitcnt lgkmcnt(6)
    v_pk_add_f32 v[68:69], v[68:69], v[28:29]
    v_pk_add_f32 v[70:71], v[70:71], v[30:31]
    v_pk_fma_f32 v[128:129], v[68:69], v[18:19], v[128:129] op_sel_hi:[1,0,1]
    v_pk_fma_f32 v[130:131], v[70:71], v[18:19], v[130:131] op_sel_hi:[1,0,1]
    v_cvt_pk_bf16_f32 v86, v128, v129
    v_cvt_pk_bf16_f32 v87, v130, v131
    ds_write_b64 v6, v[86:87] offset:1024
    ds_read_b128 v[96:99], v5 offset:1024
    s_waitcnt lgkmcnt(7)
    v_pk_add_f32 v[72:73], v[72:73], v[40:41]
    v_pk_add_f32 v[74:75], v[74:75], v[42:43]
    v_pk_fma_f32 v[132:133], v[72:73], v[20:21], v[132:133] op_sel_hi:[1,0,1]
    v_pk_fma_f32 v[134:135], v[74:75], v[20:21], v[134:135] op_sel_hi:[1,0,1]
    v_cvt_pk_bf16_f32 v88, v132, v133
    v_cvt_pk_bf16_f32 v89, v134, v135
    ds_write_b64 v1, v[88:89] offset:2048
    s_waitcnt lgkmcnt(7)
    v_pk_add_f32 v[76:77], v[76:77], v[44:45]
    v_pk_add_f32 v[78:79], v[78:79], v[46:47]
    v_pk_fma_f32 v[136:137], v[76:77], v[20:21], v[136:137] op_sel_hi:[1,0,1]
    v_pk_fma_f32 v[138:139], v[78:79], v[20:21], v[138:139] op_sel_hi:[1,0,1]
    v_cvt_pk_bf16_f32 v90, v136, v137
    v_cvt_pk_bf16_f32 v91, v138, v139
    ds_write_b64 v6, v[90:91] offset:2048
    ds_read_b128 v[100:103], v5 offset:2048
    s_waitcnt lgkmcnt(6)
    buffer_store_dwordx4 v[92:95], v2, s[48:51], s79 offen
    s_add_u32 s79, s79, 20480
    s_waitcnt lgkmcnt(3)
    buffer_store_dwordx4 v[96:99], v2, s[48:51], s79 offen
    s_add_u32 s79, s79, 20480
    s_waitcnt lgkmcnt(0)
    buffer_store_dwordx4 v[100:103], v2, s[48:51], s79 offen
L_pexit:
    s_endpgm
L_fxw:
    s_mov_b32 s100, 0
Lw_53:
    ds_read_b32 v4, v165 offset:64
    s_waitcnt lgkmcnt(0)
    v_readfirstlane_b32 s99, v4
    s_cmp_ge_u32 s99, 1
    s_cbranch_scc1 Lwd_54
    s_add_u32 s100, s100, 1
    s_cmp_lt_u32 s100, 8388608
    s_cbranch_scc1 Lw_53
Lwd_54:
    ds_read_b32 v21, v166 offset:48
    ds_read2_b32 v[16:17], v162 offset0:0 offset1:16
    ds_read_b32 v20, v162 offset:128
    ds_read_b128 v[116:119], v7 offset:0
    ds_read_b128 v[120:123], v7 offset:1024
    ds_read_b128 v[124:127], v7 offset:4096
    ds_read_b128 v[128:131], v7 offset:5120
    ds_read_b128 v[132:135], v7 offset:8192
    ds_read_b128 v[136:139], v7 offset:9216
    s_waitcnt lgkmcnt(8)
    s_branch L_fb
L_fyw:
    s_mov_b32 s100, 0
Lw_55:
    ds_read_b32 v4, v166 offset:48
    s_waitcnt lgkmcnt(0)
    v_readfirstlane_b32 s99, v4
    s_cmp_ge_u32 s99, 2
    s_cbranch_scc1 Lwd_56
    s_add_u32 s100, s100, 1
    s_cmp_lt_u32 s100, 8388608
    s_cbranch_scc1 Lw_55
Lwd_56:
    ds_read2_b32 v[16:17], v162 offset0:0 offset1:16
    ds_read_b32 v20, v162 offset:128
    ds_read_b128 v[116:119], v7 offset:0
    ds_read_b128 v[120:123], v7 offset:1024
    ds_read_b128 v[124:127], v7 offset:4096
    ds_read_b128 v[128:131], v7 offset:5120
    ds_read_b128 v[132:135], v7 offset:8192
    ds_read_b128 v[136:139], v7 offset:9216
    s_waitcnt lgkmcnt(0)
    s_branch L_yok
L_fslow:
    s_mov_b32 s100, 0
L_fs2:
    ds_read2_b32 v[120:121], v3 offset0:0 offset1:4
    s_waitcnt lgkmcnt(0)
    v_add_u32 v120, v120, v121
    s_nop 0
    v_readfirstlane_b32 s97, v120
    s_cmp_ge_u32 s97, s84
    s_cbranch_scc1 L_fgo
    s_add_u32 s100, s100, 1
    s_cmp_lt_u32 s100, 8388608
    s_cbranch_scc1 L_fs2
    s_branch L_fgo
L_ns0:
    s_load_dwordx16 s[4:19], s[76:77], 0 glc
    s_load_dwordx8 s[20:27], s[76:77], 64 glc
    s_waitcnt lgkmcnt(0)
    s_add_u32 s100, s100, 1
    s_cmp_lt_u32 s100, 1048576
    s_cbranch_scc1 L_nb0
    s_branch L_ng0
L_ns1:
    s_load_dwordx16 s[4:19], s[76:77], 0 glc
    s_load_dwordx8 s[20:27], s[76:77], 64 glc
    s_waitcnt lgkmcnt(0)
    s_add_u32 s100, s100, 1
    s_cmp_lt_u32 s100, 1048576
    s_cbranch_scc1 L_nb1
    s_branch L_ng1
L_ns2:
    s_load_dwordx16 s[4:19], s[76:77], 0 glc
    s_load_dwordx8 s[20:27], s[76:77], 64 glc
    s_waitcnt lgkmcnt(0)
    s_add_u32 s100, s100, 1
    s_cmp_lt_u32 s100, 1048576
    s_cbranch_scc1 L_nb2
    s_branch L_ng2
L_ns3:
    s_load_dwordx16 s[4:19], s[76:77], 0 glc
    s_load_dwordx8 s[20:27], s[76:77], 64 glc
    s_waitcnt lgkmcnt(0)
    s_add_u32 s100, s100, 1
    s_cmp_lt_u32 s100, 1048576
    s_cbranch_scc1 L_nb3
    s_branch L_ng3
L_ns4:
    s_load_dwordx16 s[4:19], s[76:77], 0 glc
    s_load_dwordx8 s[20:27], s[76:77], 64 glc
    s_waitcnt lgkmcnt(0)
    s_add_u32 s100, s100, 1
    s_cmp_lt_u32 s100, 1048576
    s_cbranch_scc1 L_nb4
    s_branch L_ng4
L_ns6:
    s_load_dwordx16 s[4:19], s[76:77], 0 glc
    s_load_dwordx8 s[20:27], s[76:77], 64 glc
    s_waitcnt lgkmcnt(0)
    s_add_u32 s100, s100, 1
    s_cmp_lt_u32 s100, 1048576
    s_cbranch_scc1 L_nb6
    s_branch L_ng6
L_ns7:
    s_load_dwordx16 s[4:19], s[76:77], 0 glc
    s_load_dwordx8 s[20:27], s[76:77], 64 glc
    s_waitcnt lgkmcnt(0)
    s_add_u32 s100, s100, 1
    s_cmp_lt_u32 s100, 1048576
    s_cbranch_scc1 L_nb7
    s_branch L_ng7
L_ns8:
    s_load_dwordx16 s[4:19], s[76:77], 0 glc
    s_load_dwordx8 s[20:27], s[76:77], 64 glc
    s_waitcnt lgkmcnt(0)
    s_add_u32 s100, s100, 1
    s_cmp_lt_u32 s100, 1048576
    s_cbranch_scc1 L_nb8
    s_branch L_ng8
L_end:
    s_endpgm
L_codeend:
.section .rodata,"a"
.p2align 6
.amdhsa_kernel gated_mix__ssm_conv_h3__sliding_local_dilated__prompt_kernel
  .amdhsa_next_free_vgpr 168
  .amdhsa_next_free_sgpr 102
  .amdhsa_accum_offset 168
  .amdhsa_group_segment_fixed_size 0
  .amdhsa_kernarg_size 104
  .amdhsa_user_sgpr_count 2
  .amdhsa_user_sgpr_kernarg_segment_ptr 1
  .amdhsa_system_sgpr_workgroup_id_x 1
.end_amdhsa_kernel
```

```asm
; @launch grid=(256,1,1) block=(768,1,1) lds=163840
.amdgcn_target "amdgcn-amd-amdhsa--gfx950"
.text
.globl gated_mix__ssm_conv_h3__sliding_local_dilated__prompt_kernel
.p2align 8
.type gated_mix__ssm_conv_h3__sliding_local_dilated__prompt_kernel,@function
gated_mix__ssm_conv_h3__sliding_local_dilated__prompt_kernel:
    s_load_dwordx16 s[4:19], s[0:1], 0
    s_getpc_b64 s[46:47]
L_pc:
    s_add_u32 s44, s46, wg_table@rel32@lo+4
    s_addc_u32 s45, s47, wg_table@rel32@hi+12
    s_and_b32 s97, s2, 255
    s_lshl_b32 s97, s97, 5
    s_load_dwordx8 s[32:39], s[44:45], s97
    s_lshr_b32 s96, s2, 3
    s_lshl_b32 s97, s96, 7
    v_lshl_add_u32 v5, v0, 12, s97
    v_cmp_gt_u32 vcc, L_codeend-L_pc-4, v5
    s_and_saveexec_b64 s[50:51], vcc
    s_cbranch_execz L_nopf
    global_load_dword v166, v5, s[46:47]
L_nopf:
    s_mov_b64 exec, -1
    s_load_dwordx8 s[20:27], s[0:1], 64
    s_load_dwordx2 s[28:29], s[0:1], 96
    v_lshrrev_b32 v4, 6, v0
    v_and_b32 v0, 63, v0
    v_readfirstlane_b32 s30, v4
    s_cmp_ge_u32 s96, 32
    s_cbranch_scc1 L_end
    v_lshrrev_b32 v2, 4, v0
    v_and_b32 v1, 15, v0
    v_lshrrev_b32 v4, 3, v0
    v_and_b32 v5, 7, v0
    s_bfe_u32 s99, s2, 65537
    s_add_u32 s99, s99, s96
    s_cmp_ge_u32 s99, 28
    s_cselect_b32 s3, 1, 0
    s_cbranch_scc1 L_a
    s_cmp_ge_u32 s30, 3
    s_cbranch_scc1 L_notld
    s_setprio 3
    s_mov_b32 s51, 0
    s_mul_i32 s52, s30, 12288
    s_addk_i32 s52, 2048
    s_min_u32 s98, s30, 1
    s_lshr_b32 s54, s30, 1
    s_mul_i32 s54, s54, 122880
    v_lshlrev_b32 v6, s98, v2
    v_and_b32 v6, 3, v6
    v_xor_b32 v5, v5, v6
    s_mulk_i32 s98, 2560
    s_addk_i32 s98, 1280
    v_mul_u32_u24 v4, s98, v4
    v_lshl_add_u32 v8, v5, 4, v4
    v_xor_b32 v9, 64, v8
    s_lshl_b32 s56, s98, 3
    s_mov_b32 s43, 0x00020000
    s_cmp_eq_u32 s30, 0
    s_cselect_b32 s57, s56, 4294876416
    s_movk_i32 s58, 128
    s_cselect_b32 s58, s58, 245760
    s_mov_b32 s42, 2621440
    s_cselect_b32 s42, s42, 2457600
    s_waitcnt lgkmcnt(0)
    s_cselect_b64 s[40:41], s[4:5], s[18:19]
    s_mul_i32 s96, s33, 128
    s_cselect_b32 s96, s37, s96
    s_add_u32 s54, s54, s96
L_ld:
    s_and_b32 s53, s38, 15
    s_lshr_b64 s[38:39], s[38:39], 4
    s_mov_b32 m0, s52
    s_mul_i32 s96, s53, s58
    s_add_u32 s50, s96, s54
    buffer_load_dwordx4 v8, s[40:43], s50 offen lds
    s_add_u32 m0, m0, 1024
    s_add_u32 s50, s50, s56
    buffer_load_dwordx4 v9, s[40:43], s50 offen lds
    s_add_u32 m0, m0, 1024
    s_add_u32 s50, s50, s56
    buffer_load_dwordx4 v8, s[40:43], s50 offen lds
    s_add_u32 m0, m0, 1024
    s_add_u32 s50, s50, s56
    buffer_load_dwordx4 v9, s[40:43], s50 offen lds
    s_add_u32 m0, m0, 1024
    s_add_u32 s50, s50, s57
    buffer_load_dwordx4 v8, s[40:43], s50 offen lds
    s_add_u32 m0, m0, 1024
    s_add_u32 s50, s50, s56
    buffer_load_dwordx4 v9, s[40:43], s50 offen lds
    s_add_u32 m0, m0, 1024
    s_add_u32 s50, s50, s56
    buffer_load_dwordx4 v8, s[40:43], s50 offen lds
    s_add_u32 m0, m0, 1024
    s_add_u32 s50, s50, s56
    buffer_load_dwordx4 v9, s[40:43], s50 offen lds
    s_add_u32 m0, m0, 1024
    s_add_u32 s50, s50, s57
    buffer_load_dwordx4 v8, s[40:43], s50 offen lds
    s_add_u32 m0, m0, 1024
    s_add_u32 s50, s50, s56
    buffer_load_dwordx4 v9, s[40:43], s50 offen lds
    s_add_u32 m0, m0, 1024
    s_add_u32 s50, s50, s56
    buffer_load_dwordx4 v8, s[40:43], s50 offen lds
    s_add_u32 m0, m0, 1024
    s_add_u32 s50, s50, s56
    buffer_load_dwordx4 v9, s[40:43], s50 offen lds
    s_cmp_lg_u32 s30, 0
    s_cbranch_scc1 L_ldw
    s_sub_u32 s55, s54, 20480
    s_cselect_b32 s55, 0x40000000, s55
    s_sub_u32 m0, s52, 2048
    s_add_u32 s50, s96, s55
    buffer_load_dwordx4 v8, s[40:43], s50 offen lds
    s_add_u32 m0, m0, 1024
    s_add_u32 s50, s50, s56
    buffer_load_dwordx4 v9, s[40:43], s50 offen lds
L_ldw:
    s_add_u32 s52, s52, 38912
    s_cmp_ge_u32 s52, 116736
    s_cselect_b32 s96, 116736, 0
    s_sub_u32 s52, s52, s96
    s_add_u32 s51, s51, 1
    s_cmp_lt_u32 s51, 2
    s_cbranch_scc1 L_ld
    s_cmp_lg_u32 s51, 3
    s_cbranch_scc1 L_ldt
    s_load_dword s31, s[28:29], 0
L_ldt:
    s_waitcnt vmcnt(14) lgkmcnt(0)
    s_cmp_eq_u32 s30, 0
    s_cbranch_scc1 L_ldb
    s_waitcnt vmcnt(12)
L_ldb:
    s_barrier
    s_cmp_lt_u32 s51, 10
    s_cbranch_scc1 L_ld
    s_setprio 0
    v_mov_b32 v3, 160960
    s_mov_b32 s101, 1
    s_cmp_lg_u32 s30, 0
    s_cbranch_scc1 L_ps
    s_branch L_s0
L_a:
    s_lshr_b32 s96, s30, 2
    s_lshl_b32 s98, s96, 5
    s_mul_i32 s41, s96, 42752
    s_add_u32 s41, s41, 1024
    s_mov_b32 s54, s41
    s_branch L_c
L_notld:
    s_cmp_lt_u32 s30, 8
    s_cbranch_scc1 L_hg
    s_mov_b32 s98, 0
    s_mov_b32 s41, 116736
    s_mov_b32 s54, 116736
L_c:
    s_and_b32 s40, s30, 3
    v_mul_u32_u24 v4, 1280, v4
    v_lshrrev_b32 v6, 1, v2
    v_xor_b32 v5, v5, v6
    s_lshl_b32 s96, s40, 2
    s_and_b32 s96, s96, 4
    v_xor_b32 v5, s96, v5
    v_lshl_add_u32 v22, v5, 4, v4
    v_xor_b32 v23, 32, v22
    s_waitcnt lgkmcnt(0)
    s_add_u32 s43, s35, s98
    s_cmp_ge_u32 s43, 320
    s_cbranch_scc1 L_idle
    s_lshr_b32 s55, s43, 5
    s_and_b32 s63, s43, 31
    s_lshl2_add_u32 s96, s55, s40
    s_lshl_b32 s96, s96, 7
    v_lshl_add_u32 v21, v1, 3, s96
    v_lshlrev_b32 v12, 4, v0
    s_lshr_b32 s96, s40, 1
    s_lshl1_add_u32 s42, s43, s96
    s_mul_i32 s96, s96, 8320
    s_add_u32 s96, s96, s41
    s_add_u32 s62, s96, 16960
    s_and_b32 s97, s40, 1
    s_lshl_b32 s98, s97, 11
    s_add_u32 s60, s98, s62
    s_lshl_b32 s96, s42, 12
    s_add_u32 s61, s96, s98
    s_mov_b32 s46, 2621440
    s_mov_b32 s47, 0x00020000
    s_mov_b64 s[50:51], s[46:47]
    s_setprio 1
    s_cmp_ge_u32 s30, 4
    s_cbranch_scc1 L_c2
    s_lshl2_add_u32 s96, s63, s40
    s_mul_i32 s96, s96, 20480
    s_lshl_b32 s97, s55, 7
    s_add_u32 s96, s96, s97
    s_lshl_b32 s97, s40, 11
    s_add_u32 s97, s97, s41
    s_add_u32 m0, s97, 8704
    s_add_u32 s98, s96, 9216
    s_waitcnt lgkmcnt(0)
    s_mov_b64 s[48:49], s[8:9]
    buffer_load_dwordx4 v22, s[48:51], s96 offen lds
    buffer_load_dwordx4 v23, s[48:51], s98 offen offset:1024 lds
    s_sub_u32 m0, m0, 8192
    s_mov_b64 s[44:45], s[6:7]
    buffer_load_dwordx4 v22, s[44:47], s96 offen lds
    buffer_load_dwordx4 v23, s[44:47], s98 offen offset:1024 lds
    global_load_dwordx2 v[14:15], v21, s[10:11]
    s_cmp_lg_u32 s40, 3
    s_cbranch_scc1 Lkv_1
    s_sub_u32 s96, s96, 71680
    s_cselect_b32 s96, 0x40000000, s96
    s_sub_u32 m0, s41, 512
    s_mov_b32 exec_lo, 0
    buffer_load_dwordx4 v23, s[44:47], s96 offen lds
    s_mov_b32 exec_lo, -1
Lkv_1:
    s_mov_b64 s[48:49], s[12:13]
    s_mov_b32 m0, s60
    s_sub_u32 s96, s61, 16
    s_bitcmp1_b32 s40, 0
    s_cselect_b32 s96, s96, 0x40000000
    buffer_load_dwordx4 v12, s[48:51], s61 offen lds
    buffer_load_dwordx4 v12, s[48:51], s61 offen offset:1024 lds
    s_sub_u32 m0, s60, 16
    s_mov_b64 exec, 1
    buffer_load_dwordx4 v12, s[48:51], s96 offen lds
    s_mov_b64 exec, -1
L_c2:
    s_lshr_b32 s96, s30, 2
    s_lshl_b32 s96, s96, 6
    s_add_u32 s96, s96, 160768
    v_mov_b32 v3, s96
    v_mov_b32 v6, 0
    s_lshl_b32 s96, s40, 8
    s_add_u32 s96, s96, s41
    v_lshl_add_u32 v5, v0, 2, s96
    ds_write_b32 v5, v6 offset:41728
    s_mul_i32 s96, s40, 4160
    s_add_u32 s96, s96, s41
    v_lshl_add_u32 v5, v1, 2, s96
    ds_write_b32 v5, v6 offset:16896
    v_lshl_add_u32 v5, v1, 2, v3
    ds_write_b32 v5, v6
    v_and_b32 v4, 1, v2
    v_lshrrev_b32 v5, 1, v2
    v_lshlrev_b32 v6, 2, v1
    v_sub_u32 v6, v6, v4
    s_add_u32 s96, s41, 256
    v_lshl_add_u32 v6, v6, 7, s96
    s_lshl_b32 s97, s40, 1
    v_or_b32 v7, s97, v5
    v_sub_u32 v9, v1, v4
    v_subrev_u32 v10, 1, v1
    v_xor_b32 v8, v1, v7
    v_and_b32 v8, 7, v8
    v_lshl_add_u32 v8, v8, 4, v6
    v_xor_b32 v9, v9, v7
    v_and_b32 v9, 7, v9
    v_lshl_add_u32 v9, v9, 4, v6
    v_xor_b32 v10, v10, v7
    v_and_b32 v10, 7, v10
    v_lshl_add_u32 v10, v10, 4, v6
    v_mul_u32_u24 v7, 136, v4
    v_add_u32 v13, v8, v7
    v_and_b32 v6, 1, v1
    v_xor_b32 v16, v4, v6
    v_lshlrev_b32 v16, 4, v16
    v_lshlrev_b32 v6, 4, v6
    v_mov_b32 v7, 0xffff
    v_lshlrev_b32 v6, v6, v7
    v_lshrrev_b32 v7, 1, v1
    v_lshlrev_b32 v5, 2, v5
    v_sub_u32 v7, v7, v5
    v_cmp_eq_u32 vcc, 0, v7
    s_nop 1
    v_cndmask_b32 v17, 0, v6, vcc
    v_cmp_eq_u32 vcc, 1, v7
    s_nop 1
    v_cndmask_b32 v18, 0, v6, vcc
    v_cmp_eq_u32 vcc, 2, v7
    s_nop 1
    v_cndmask_b32 v19, 0, v6, vcc
    v_cmp_eq_u32 vcc, 3, v7
    s_nop 1
    v_cndmask_b32 v20, 0, v6, vcc
    v_not_b32 v4, v0
    v_bfe_u32 v5, v4, 1, 2
    v_lshlrev_b32 v5, 4, v5
    v_bfe_u32 v6, v4, 3, 1
    v_lshl_add_u32 v5, v6, 7, v5
    v_xor_b32 v6, s63, v4
    v_and_b32 v6, 1, v6
    v_lshl_add_u32 v5, v6, 6, v5
    v_lshl_add_u32 v5, v2, 14, v5
    s_lshl2_add_u32 s96, s55, s40
    s_lshl_b32 s97, s96, 16
    s_lshl_b32 s98, s63, 8
    s_sub_u32 s97, s97, s98
    s_add_u32 s97, s97, 1056512
    v_add_u32 v11, s97, v5
    s_lshl_b32 s97, s96, 10
    s_lshl2_add_u32 s97, s63, s97
    s_add_u32 s64, s97, 65536
    s_and_b32 s96, s43, -8
    s_cmp_ge_u32 s55, 3
    s_cselect_b32 s96, s96, s43
    s_lshl_b32 s96, s96, 7
    s_add_u32 s65, s96, 65536
    s_waitcnt lgkmcnt(0)
    s_load_dword s31, s[28:29], 0
    s_lshl_b32 s96, s43, 2
    s_load_dword s53, s[14:15], s96
    s_cmp_lg_u32 s3, 0
    s_cbranch_scc1 L_akv
    s_mul_i32 s96, s36, 43
    s_lshr_b32 s96, s96, 7
    s_mul_i32 s96, s96, 3
    s_sub_u32 s96, s36, s96
    s_mul_i32 s97, s96, 38912
    v_lshrrev_b32 v4, 1, v1
    v_lshrrev_b32 v5, 1, v2
    v_xor_b32 v4, v4, v5
    s_lshl_b32 s96, s40, 1
    v_xor_b32 v4, s96, v4
    v_lshlrev_b32 v4, 4, v4
    v_lshl_add_u32 v4, v1, 7, v4
    v_and_b32 v5, 1, v2
    v_lshl_add_u32 v4, v5, 3, v4
    v_add_u32 v166, s97, v4
    s_barrier
    s_cmp_lg_u32 s36, 0
    s_cbranch_scc1 Lq_2
    ds_read_b64 v[112:113], v166 offset:2048
    ds_read_b64 v[114:115], v166 offset:4096
    ds_read_b64 v[116:117], v166 offset:6144
    ds_read_b64 v[118:119], v166 offset:8192
    ds_read_b64 v[120:121], v166 offset:10240
    ds_read_b64 v[122:123], v166 offset:12288
    s_waitcnt lgkmcnt(0)
Lq_2:
    s_setprio 0
    v_add_u32 v4, 0, v0
    v_mul_u32_u24 v5, 5462, v4
    v_lshrrev_b32 v5, 16, v5
    v_mul_u32_u24 v5, 3904, v5
    v_lshl_add_u32 v144, v4, 4, v5
    v_add_u32 v4, 64, v0
    v_mul_u32_u24 v5, 5462, v4
    v_lshrrev_b32 v5, 16, v5
    v_mul_u32_u24 v5, 3904, v5
    v_lshl_add_u32 v145, v4, 4, v5
    v_add_u32 v4, 128, v0
    v_mul_u32_u24 v5, 5462, v4
    v_lshrrev_b32 v5, 16, v5
    v_mul_u32_u24 v5, 3904, v5
    v_lshl_add_u32 v146, v4, 4, v5
    s_xor_b32 s96, s40, 1
    s_lshl_b32 s96, s96, 12
    s_add_u32 s96, s96, 116736
    v_lshrrev_b32 v4, 2, v0
    v_mul_u32_u24 v4, 192, v4
    v_and_b32 v5, 3, v0
    v_lshl_add_u32 v4, v5, 3, v4
    v_add_u32 v147, s96, v4
L_cs:
    s_and_b32 s97, s40, 1
    v_add_u32 v156, s60, v12
    s_lshl_b32 s98, s97, 8
    s_add_u32 s96, s62, s98
    s_add_u32 s96, s96, 4132
    v_lshrrev_b32 v4, 1, v1
    v_lshl_add_u32 v4, v2, 2, v4
    v_lshl_add_u32 v4, v4, 2, s96
    v_and_b32 v5, 1, v1
    v_mul_u32_u24 v5, 4160, v5
    v_sub_u32 v148, v4, v5
    v_add_u32 v149, 1024, v148
    v_add_u32 v150, 2048, v148
    v_add_u32 v151, 3072, v148
    v_lshlrev_b32 v4, 1, v1
    v_sub_u32 v4, v2, v4
    s_lshl_b32 s98, s97, 4
    s_add_u32 s98, s98, 30
    v_add_u32 v4, s98, v4
    s_lshr_b32 s98, s40, 1
    s_add_u32 s96, s41, 33536
    v_and_b32 v5, 3, v4
    v_lshl_add_u32 v5, v5, 4, s96
    v_lshrrev_b32 v6, 2, v4
    v_lshl_add_u32 v5, v6, 7, v5
    v_bfe_u32 v6, v4, 3, 1
    v_xor_b32 v6, s98, v6
    v_lshl_add_u32 v152, v6, 6, v5
    v_xor_b32 v154, 64, v152
    v_add_u32 v4, 4, v4
    v_and_b32 v5, 3, v4
    v_lshl_add_u32 v5, v5, 4, s96
    v_lshrrev_b32 v6, 2, v4
    v_lshl_add_u32 v5, v6, 7, v5
    v_bfe_u32 v6, v4, 3, 1
    v_xor_b32 v6, s98, v6
    v_lshl_add_u32 v153, v6, 6, v5
    v_xor_b32 v155, 64, v153
    v_and_b32 v5, 1, v2
    v_lshlrev_b32 v5, 9, v5
    v_lshl_add_u32 v5, v1, 5, v5
    v_lshrrev_b32 v6, 1, v2
    v_lshl_add_u32 v5, v6, 4, v5
    s_lshl_b32 s96, s42, 12
    s_add_u32 s96, s96, 3670016
    v_add_u32 v157, s96, v5
    s_mul_i32 s97, s55, 2176
    s_lshr_b32 s96, s63, 3
    s_lshl_b32 s96, s96, 7
    s_add_u32 s97, s97, s96
    s_and_b32 s96, s63, 7
    s_lshl3_add_u32 s97, s96, s97
    s_add_u32 s82, s97, 262144
    s_lshl_b32 s96, s40, 12
    s_add_u32 s96, s96, s54
    v_add_u32 v158, s96, v12
    s_xor_b32 s96, s40, 1
    s_lshl_b32 s96, s96, 12
    s_add_u32 s96, s96, s54
    v_add_u32 v159, s96, v12
    s_waitcnt lgkmcnt(0)
    s_mul_i32 s31, s31, 1664525
    s_add_u32 s31, s31, 1013904223
    s_mov_b32 s58, s31
    s_mov_b32 s59, s31
    s_add_u32 s56, s28, s65
    s_addc_u32 s57, s29, 0
    s_bitcmp1_b32 s40, 1
    s_cselect_b32 s96, 0, 16
    s_lshl_b32 s53, s53, s96
    s_and_b32 s53, s53, 0xffff0000
    s_bitcmp1_b32 s40, 0
    s_cselect_b32 s53, 0, s53
    s_cmp_lg_u32 s3, 0
    s_cbranch_scc1 L_asig
    s_setprio 1
    s_lshl2_add_u32 s96, s63, s40
    s_mul_i32 s96, s96, 20480
    s_lshl_b32 s97, s55, 7
    s_add_u32 s96, s96, s97
    s_lshl_b32 s97, s40, 11
    s_add_u32 s97, s97, s41
    s_add_u32 m0, s97, 8704
    s_add_u32 s98, s96, 9216
    s_waitcnt lgkmcnt(0)
    s_mov_b64 s[48:49], s[8:9]
    buffer_load_dwordx4 v22, s[48:51], s96 offen lds
    buffer_load_dwordx4 v23, s[48:51], s98 offen offset:1024 lds
    s_sub_u32 m0, m0, 8192
    s_mov_b64 s[44:45], s[6:7]
    buffer_load_dwordx4 v22, s[44:47], s96 offen lds
    buffer_load_dwordx4 v23, s[44:47], s98 offen offset:1024 lds
    global_load_dwordx2 v[14:15], v21, s[10:11]
    s_cmp_lg_u32 s40, 3
    s_cbranch_scc1 Lkv_3
    s_sub_u32 s96, s96, 71680
    s_cselect_b32 s96, 0x40000000, s96
    s_sub_u32 m0, s41, 512
    s_mov_b32 exec_lo, 0
    buffer_load_dwordx4 v23, s[44:47], s96 offen lds
    s_mov_b32 exec_lo, -1
Lkv_3:
    s_barrier
    s_cmp_lg_u32 s36, 1
    s_cbranch_scc1 Lq_4
    ds_read_b64 v[112:113], v166 offset:2048
    ds_read_b64 v[114:115], v166 offset:4096
    ds_read_b64 v[116:117], v166 offset:6144
    ds_read_b64 v[118:119], v166 offset:8192
    ds_read_b64 v[120:121], v166 offset:10240
    ds_read_b64 v[122:123], v166 offset:12288
    s_waitcnt lgkmcnt(0)
Lq_4:
    s_waitcnt vmcnt(0)
    s_mov_b64 s[48:49], s[12:13]
    s_barrier
    s_cmp_lg_u32 s36, 2
    s_cbranch_scc1 Lq_5
    ds_read_b64 v[112:113], v166 offset:2048
    ds_read_b64 v[114:115], v166 offset:4096
    ds_read_b64 v[116:117], v166 offset:6144
    ds_read_b64 v[118:119], v166 offset:8192
    ds_read_b64 v[120:121], v166 offset:10240
    ds_read_b64 v[122:123], v166 offset:12288
    s_waitcnt lgkmcnt(0)
Lq_5:
    s_branch L_kvc
L_akv:
    v_mov_b32 v144, 0
    v_mov_b32 v145, 0
    v_mov_b32 v146, 0
    s_barrier
    s_cmp_lt_u32 s30, 4
    s_cbranch_scc1 L_akw
    v_mov_b32 v5, 160768
    s_cmp_lt_u32 s30, 8
    s_cbranch_scc1 L_ak1
    s_mov_b32 s100, 0
Lw_6:
    ds_read_b32 v4, v5 offset:40
    s_waitcnt lgkmcnt(0)
    v_readfirstlane_b32 s99, v4
    s_cmp_ge_u32 s99, 5
    s_cbranch_scc1 Lwd_7
    s_sleep 2
    s_add_u32 s100, s100, 1
    s_cmp_lt_u32 s100, 8388608
    s_cbranch_scc1 Lw_6
Lwd_7:
L_ak1:
    s_lshl2_add_u32 s96, s63, s40
    s_mul_i32 s96, s96, 20480
    s_lshl_b32 s97, s55, 7
    s_add_u32 s96, s96, s97
    s_lshl_b32 s97, s40, 11
    s_add_u32 s97, s97, s41
    s_add_u32 m0, s97, 8704
    s_add_u32 s98, s96, 9216
    s_waitcnt lgkmcnt(0)
    s_mov_b64 s[48:49], s[8:9]
    buffer_load_dwordx4 v22, s[48:51], s96 offen lds
    buffer_load_dwordx4 v23, s[48:51], s98 offen offset:1024 lds
    s_sub_u32 m0, m0, 8192
    s_mov_b64 s[44:45], s[6:7]
    buffer_load_dwordx4 v22, s[44:47], s96 offen lds
    buffer_load_dwordx4 v23, s[44:47], s98 offen offset:1024 lds
    global_load_dwordx2 v[14:15], v21, s[10:11]
    s_cmp_lg_u32 s40, 3
    s_cbranch_scc1 Lkv_8
    s_sub_u32 s96, s96, 71680
    s_cselect_b32 s96, 0x40000000, s96
    s_sub_u32 m0, s41, 512
    s_mov_b32 exec_lo, 0
    buffer_load_dwordx4 v23, s[44:47], s96 offen lds
    s_mov_b32 exec_lo, -1
Lkv_8:
    s_mov_b64 s[48:49], s[12:13]
    s_mov_b32 m0, s60
    s_sub_u32 s96, s61, 16
    s_bitcmp1_b32 s40, 0
    s_cselect_b32 s96, s96, 0x40000000
    buffer_load_dwordx4 v12, s[48:51], s61 offen lds
    buffer_load_dwordx4 v12, s[48:51], s61 offen offset:1024 lds
    s_sub_u32 m0, s60, 16
    s_mov_b64 exec, 1
    buffer_load_dwordx4 v12, s[48:51], s96 offen lds
    s_mov_b64 exec, -1
L_akw:
    s_mov_b64 s[48:49], s[12:13]
    s_waitcnt vmcnt(3)
    v_mov_b32 v4, 1
    s_mov_b64 exec, 1
    ds_add_u32 v3, v4 offset:36
    s_mov_b64 exec, -1
    s_mov_b32 s100, 0
Lw_9:
    ds_read_b32 v4, v3 offset:36
    s_waitcnt lgkmcnt(0)
    v_readfirstlane_b32 s99, v4
    s_cmp_ge_u32 s99, 4
    s_cbranch_scc1 Lwd_10
    s_add_u32 s100, s100, 1
    s_cmp_lt_u32 s100, 8388608
    s_cbranch_scc1 Lw_9
Lwd_10:
L_kvc:
    ds_read_b128 v[32:35], v9 offset:256
    ds_read_b128 v[24:27], v10 offset:0
    ds_read_b128 v[36:39], v8 offset:384
    ds_read_b128 v[28:31], v10 offset:128
    ds_read_b128 v[40:43], v8 offset:512
    ds_read_b128 v[44:47], v8 offset:640
    ds_read_b64 v[48:49], v13 offset:8448
    ds_read_b64 v[50:51], v13 offset:8576
    ds_read_b64 v[52:53], v13 offset:8704
    ds_read_b64 v[54:55], v13 offset:8832
    v_alignbit_b32 v14, v14, v14, v16
    v_alignbit_b32 v15, v15, v15, v16
    v_and_b32 v72, v14, v17
    v_and_b32 v73, v14, v18
    v_and_b32 v74, v14, v19
    v_and_b32 v75, v14, v20
    v_and_b32 v76, v15, v17
    v_and_b32 v77, v15, v18
    v_and_b32 v78, v15, v19
    v_and_b32 v79, v15, v20
    s_mov_b32 s44, s28
    s_and_b32 s45, s29, 0xffff
    s_mov_b32 s46, 16777216
    s_mov_b32 s47, 0x00020000
    s_mov_b32 vcc_lo, 0xaaaaaaaa
    s_mov_b32 vcc_hi, 0xaaaaaaaa
    s_movk_i32 s96, 8192
    s_waitcnt lgkmcnt(0)
    v_mfma_f32_16x16x32_bf16 v[56:59], v[72:75], v[32:35], 0
    v_mfma_f32_16x16x32_bf16 v[56:59], v[76:79], v[24:27], v[56:59]
    v_lshlrev_b32 v96, 16, v48
    v_and_b32 v97, 0xffff0000, v48
    v_lshlrev_b32 v98, 16, v49
    v_and_b32 v99, 0xffff0000, v49
    v_mfma_f32_16x16x32_bf16 v[60:63], v[72:75], v[36:39], 0
    v_mfma_f32_16x16x32_bf16 v[60:63], v[76:79], v[28:31], v[60:63]
    v_lshlrev_b32 v100, 16, v50
    v_and_b32 v101, 0xffff0000, v50
    v_lshlrev_b32 v102, 16, v51
    v_and_b32 v103, 0xffff0000, v51
    v_mfma_f32_16x16x32_bf16 v[64:67], v[72:75], v[40:43], 0
    v_mfma_f32_16x16x32_bf16 v[64:67], v[76:79], v[32:35], v[64:67]
    v_lshlrev_b32 v104, 16, v52
    v_and_b32 v105, 0xffff0000, v52
    v_lshlrev_b32 v106, 16, v53
    v_and_b32 v107, 0xffff0000, v53
    v_mfma_f32_16x16x32_bf16 v[68:71], v[72:75], v[44:47], 0
    v_mfma_f32_16x16x32_bf16 v[68:71], v[76:79], v[36:39], v[68:71]
    v_lshlrev_b32 v108, 16, v54
    v_and_b32 v109, 0xffff0000, v54
    v_lshlrev_b32 v110, 16, v55
    v_and_b32 v111, 0xffff0000, v55
    v_mul_f32 v96, v56, v96
    v_mul_f32 v97, v57, v97
    v_mul_f32 v98, v58, v98
    v_mul_f32 v99, v59, v99
    v_mul_f32 v100, v60, v100
    v_mul_f32 v101, v61, v101
    v_mul_f32 v102, v62, v102
    v_mul_f32 v103, v63, v103
    v_mul_f32 v104, v64, v104
    v_mul_f32 v105, v65, v105
    v_mul_f32 v106, v66, v106
    v_mul_f32 v107, v67, v107
    v_mul_f32 v108, v68, v108
    v_mul_f32 v109, v69, v109
    v_mul_f32 v110, v70, v110
    v_mul_f32 v111, v71, v111
    v_cvt_pk_bf16_f32 v80, v108, v104
    v_cvt_pk_bf16_f32 v81, v100, v96
    v_cvt_pk_bf16_f32 v82, v109, v105
    v_cvt_pk_bf16_f32 v83, v101, v97
    v_cvt_pk_bf16_f32 v84, v110, v106
    v_cvt_pk_bf16_f32 v85, v102, v98
    v_cvt_pk_bf16_f32 v86, v111, v107
    v_cvt_pk_bf16_f32 v87, v103, v99
    v_cndmask_b32_dpp v88, v80, v82, vcc quad_perm:[1,0,3,2] row_mask:0xf bank_mask:0xf
    v_cndmask_b32_dpp v89, v81, v83, vcc quad_perm:[1,0,3,2] row_mask:0xf bank_mask:0xf
    v_cndmask_b32_dpp v92, v84, v86, vcc quad_perm:[1,0,3,2] row_mask:0xf bank_mask:0xf
    v_cndmask_b32_dpp v93, v85, v87, vcc quad_perm:[1,0,3,2] row_mask:0xf bank_mask:0xf
    s_not_b64 vcc, vcc
    v_cndmask_b32_dpp v90, v82, v80, vcc quad_perm:[1,0,3,2] row_mask:0xf bank_mask:0xf
    v_cndmask_b32_dpp v91, v83, v81, vcc quad_perm:[1,0,3,2] row_mask:0xf bank_mask:0xf
    buffer_store_dwordx4 v[88:91], v11, s[44:47], 0 offen sc1
    v_cndmask_b32_dpp v94, v86, v84, vcc quad_perm:[1,0,3,2] row_mask:0xf bank_mask:0xf
    v_cndmask_b32_dpp v95, v87, v85, vcc quad_perm:[1,0,3,2] row_mask:0xf bank_mask:0xf
    buffer_store_dwordx4 v[92:95], v11, s[44:47], s96 offen sc1
    s_cmp_eq_u32 s3, 0
    s_cbranch_scc1 L_gk
    v_mov_b32 v4, 1
    s_mov_b64 exec, 1
    ds_add_u32 v3, v4 offset:40
    s_mov_b64 exec, -1
    s_branch L_cs
L_gk:
    s_setprio 0
    s_mov_b32 s52, s40
    s_barrier
    s_cmp_lg_u32 s36, 3
    s_cbranch_scc1 Lq_11
    ds_read_b64 v[112:113], v166 offset:2048
    ds_read_b64 v[114:115], v166 offset:4096
    ds_read_b64 v[116:117], v166 offset:6144
    ds_read_b64 v[118:119], v166 offset:8192
    ds_read_b64 v[120:121], v166 offset:10240
    ds_read_b64 v[122:123], v166 offset:12288
    s_waitcnt lgkmcnt(0)
Lq_11:
    s_barrier
    s_cmp_lg_u32 s36, 4
    s_cbranch_scc1 Lq_12
    ds_read_b64 v[112:113], v166 offset:2048
    ds_read_b64 v[114:115], v166 offset:4096
    ds_read_b64 v[116:117], v166 offset:6144
    ds_read_b64 v[118:119], v166 offset:8192
    ds_read_b64 v[120:121], v166 offset:10240
    ds_read_b64 v[122:123], v166 offset:12288
    s_waitcnt lgkmcnt(0)
Lq_12:
    s_waitcnt vmcnt(0)
    s_atomic_swap s31, s[28:29], s64
    s_barrier
    s_cmp_lg_u32 s36, 5
    s_cbranch_scc1 Lq_13
    ds_read_b64 v[112:113], v166 offset:2048
    ds_read_b64 v[114:115], v166 offset:4096
    ds_read_b64 v[116:117], v166 offset:6144
    ds_read_b64 v[118:119], v166 offset:8192
    ds_read_b64 v[120:121], v166 offset:10240
    ds_read_b64 v[122:123], v166 offset:12288
    s_waitcnt lgkmcnt(0)
Lq_13:
    s_barrier
    s_cmp_lg_u32 s36, 6
    s_cbranch_scc1 Lq_14
    ds_read_b64 v[112:113], v166 offset:2048
    ds_read_b64 v[114:115], v166 offset:4096
    ds_read_b64 v[116:117], v166 offset:6144
    ds_read_b64 v[118:119], v166 offset:8192
    ds_read_b64 v[120:121], v166 offset:10240
    ds_read_b64 v[122:123], v166 offset:12288
    s_waitcnt lgkmcnt(0)
Lq_14:
    s_cmp_lg_u32 s52, 0
    s_cbranch_scc1 Lud_16
Lup_15:
    s_load_dwordx16 s[64:79], s[56:57], 0 glc
    s_load_dwordx16 s[4:19], s[56:57], 64 glc
Lud_16:
    s_barrier
    s_cmp_lg_u32 s36, 7
    s_cbranch_scc1 Lq_17
    ds_read_b64 v[112:113], v166 offset:2048
    ds_read_b64 v[114:115], v166 offset:4096
    ds_read_b64 v[116:117], v166 offset:6144
    ds_read_b64 v[118:119], v166 offset:8192
    ds_read_b64 v[120:121], v166 offset:10240
    ds_read_b64 v[122:123], v166 offset:12288
    s_waitcnt lgkmcnt(0)
Lq_17:
    s_cmp_lg_u32 s52, 0
    s_cbranch_scc1 Lud_19
Lup_18:
    s_waitcnt lgkmcnt(0)
    s_xor_b64 s[64:65], s[64:65], s[58:59]
    s_xor_b64 s[4:5], s[4:5], s[58:59]
    s_or_b64 s[64:65], s[64:65], s[4:5]
    s_xor_b64 s[66:67], s[66:67], s[58:59]
    s_xor_b64 s[6:7], s[6:7], s[58:59]
    s_or_b64 s[64:65], s[64:65], s[66:67]
    s_or_b64 s[64:65], s[64:65], s[6:7]
    s_xor_b64 s[68:69], s[68:69], s[58:59]
    s_xor_b64 s[8:9], s[8:9], s[58:59]
    s_or_b64 s[64:65], s[64:65], s[68:69]
    s_or_b64 s[64:65], s[64:65], s[8:9]
    s_xor_b64 s[70:71], s[70:71], s[58:59]
    s_xor_b64 s[10:11], s[10:11], s[58:59]
    s_or_b64 s[64:65], s[64:65], s[70:71]
    s_or_b64 s[64:65], s[64:65], s[10:11]
    s_xor_b64 s[72:73], s[72:73], s[58:59]
    s_xor_b64 s[12:13], s[12:13], s[58:59]
    s_or_b64 s[64:65], s[64:65], s[72:73]
    s_or_b64 s[64:65], s[64:65], s[12:13]
    s_xor_b64 s[74:75], s[74:75], s[58:59]
    s_xor_b64 s[14:15], s[14:15], s[58:59]
    s_or_b64 s[64:65], s[64:65], s[74:75]
    s_or_b64 s[64:65], s[64:65], s[14:15]
    s_xor_b64 s[76:77], s[76:77], s[58:59]
    s_xor_b64 s[16:17], s[16:17], s[58:59]
    s_or_b64 s[64:65], s[64:65], s[76:77]
    s_or_b64 s[64:65], s[64:65], s[16:17]
    s_xor_b64 s[78:79], s[78:79], s[58:59]
    s_xor_b64 s[18:19], s[18:19], s[58:59]
    s_or_b64 s[64:65], s[64:65], s[78:79]
    s_or_b64 s[64:65], s[64:65], s[18:19]
    s_cbranch_scc1 Lud_19
    s_mov_b32 s52, -1
Lud_19:
    s_cmp_lg_u32 s52, 0
    s_cbranch_scc1 Lud_21
Lup_20:
    s_load_dwordx16 s[64:79], s[56:57], 0 glc
    s_load_dwordx16 s[4:19], s[56:57], 64 glc
Lud_21:
    s_barrier
    s_cmp_lg_u32 s36, 8
    s_cbranch_scc1 Lq_22
    ds_read_b64 v[112:113], v166 offset:2048
    ds_read_b64 v[114:115], v166 offset:4096
    ds_read_b64 v[116:117], v166 offset:6144
    ds_read_b64 v[118:119], v166 offset:8192
    ds_read_b64 v[120:121], v166 offset:10240
    ds_read_b64 v[122:123], v166 offset:12288
    s_waitcnt lgkmcnt(0)
Lq_22:
    s_mov_b32 m0, s60
    s_sub_u32 s96, s61, 16
    s_bitcmp1_b32 s40, 0
    s_cselect_b32 s96, s96, 0x40000000
    buffer_load_dwordx4 v12, s[48:51], s61 offen lds
    buffer_load_dwordx4 v12, s[48:51], s61 offen offset:1024 lds
    s_sub_u32 m0, s60, 16
    s_mov_b64 exec, 1
    buffer_load_dwordx4 v12, s[48:51], s96 offen lds
    s_mov_b64 exec, -1
    s_cmp_lg_u32 s52, 0
    s_cbranch_scc1 Lud_24
Lup_23:
    s_waitcnt lgkmcnt(0)
    s_xor_b64 s[64:65], s[64:65], s[58:59]
    s_xor_b64 s[4:5], s[4:5], s[58:59]
    s_or_b64 s[64:65], s[64:65], s[4:5]
    s_xor_b64 s[66:67], s[66:67], s[58:59]
    s_xor_b64 s[6:7], s[6:7], s[58:59]
    s_or_b64 s[64:65], s[64:65], s[66:67]
    s_or_b64 s[64:65], s[64:65], s[6:7]
    s_xor_b64 s[68:69], s[68:69], s[58:59]
    s_xor_b64 s[8:9], s[8:9], s[58:59]
    s_or_b64 s[64:65], s[64:65], s[68:69]
    s_or_b64 s[64:65], s[64:65], s[8:9]
    s_xor_b64 s[70:71], s[70:71], s[58:59]
    s_xor_b64 s[10:11], s[10:11], s[58:59]
    s_or_b64 s[64:65], s[64:65], s[70:71]
    s_or_b64 s[64:65], s[64:65], s[10:11]
    s_xor_b64 s[72:73], s[72:73], s[58:59]
    s_xor_b64 s[12:13], s[12:13], s[58:59]
    s_or_b64 s[64:65], s[64:65], s[72:73]
    s_or_b64 s[64:65], s[64:65], s[12:13]
    s_xor_b64 s[74:75], s[74:75], s[58:59]
    s_xor_b64 s[14:15], s[14:15], s[58:59]
    s_or_b64 s[64:65], s[64:65], s[74:75]
    s_or_b64 s[64:65], s[64:65], s[14:15]
    s_xor_b64 s[76:77], s[76:77], s[58:59]
    s_xor_b64 s[16:17], s[16:17], s[58:59]
    s_or_b64 s[64:65], s[64:65], s[76:77]
    s_or_b64 s[64:65], s[64:65], s[16:17]
    s_xor_b64 s[78:79], s[78:79], s[58:59]
    s_xor_b64 s[18:19], s[18:19], s[58:59]
    s_or_b64 s[64:65], s[64:65], s[78:79]
    s_or_b64 s[64:65], s[64:65], s[18:19]
    s_cbranch_scc1 Lud_24
    s_mov_b32 s52, -1
Lud_24:
    s_cmp_lg_u32 s52, -1
    s_cbranch_scc1 Lui_25
    s_add_u32 m0, s41, 33536
    s_lshl_b32 s96, s43, 13
    s_add_u32 s96, s96, 1048576
    buffer_load_dwordx4 v12, s[44:47], s96 offen offset:0 sc1 lds
    buffer_load_dwordx4 v12, s[44:47], s96 offen offset:1024 sc1 lds
    buffer_load_dwordx4 v12, s[44:47], s96 offen offset:2048 sc1 lds
    buffer_load_dwordx4 v12, s[44:47], s96 offen offset:3072 sc1 lds
    s_add_u32 m0, m0, 4096
    s_add_u32 s96, s96, 4096
    buffer_load_dwordx4 v12, s[44:47], s96 offen offset:0 sc1 lds
    buffer_load_dwordx4 v12, s[44:47], s96 offen offset:1024 sc1 lds
    buffer_load_dwordx4 v12, s[44:47], s96 offen offset:2048 sc1 lds
    buffer_load_dwordx4 v12, s[44:47], s96 offen offset:3072 sc1 lds
    s_mov_b32 s52, 9
Lui_25:
    s_barrier
    s_cmp_lg_u32 s36, 9
    s_cbranch_scc1 Lq_26
    ds_read_b64 v[112:113], v166 offset:2048
    ds_read_b64 v[114:115], v166 offset:4096
    ds_read_b64 v[116:117], v166 offset:6144
    ds_read_b64 v[118:119], v166 offset:8192
    ds_read_b64 v[120:121], v166 offset:10240
    ds_read_b64 v[122:123], v166 offset:12288
    s_waitcnt lgkmcnt(0)
Lq_26:
    s_setprio 1
    v_mov_b32 v8, v112
    v_mov_b32 v9, v113
    v_mov_b32 v10, v114
    v_mov_b32 v11, v115
    v_mov_b32 v14, v116
    v_mov_b32 v15, v117
    v_mov_b32 v160, v118
    v_mov_b32 v161, v119
    v_mov_b32 v162, v120
    v_mov_b32 v163, v121
    v_mov_b32 v164, v122
    v_mov_b32 v165, v123
    s_waitcnt vmcnt(0)
    s_cmp_lg_u32 s52, 9
    s_cbranch_scc1 L_nul
    v_mov_b32 v4, 1
    ds_write_b32 v3, v4 offset:0
    s_mov_b32 s52, 1
L_nul:
    v_subrev_u32 v4, 4, v156
    ds_read_b32 v21, v4 offset:0
    ds_read_b128 v[22:25], v156 offset:0
    ds_read_b32 v29, v4 offset:1024
    ds_read_b128 v[30:33], v156 offset:1024
    s_waitcnt lgkmcnt(0)
    s_mov_b64 exec, 1
    v_lshlrev_b32 v26, 16, v22
    v_and_b32 v27, 0xffff0000, v22
    v_add_f32 v26, s53, v26
    v_cvt_pk_bf16_f32 v22, v26, v27
    ds_write_b32 v156, v22
    s_mov_b64 exec, -1
    v_alignbit_b32 v40, v22, v21, 16
    v_alignbit_b32 v41, v23, v22, 16
    v_alignbit_b32 v42, v24, v23, 16
    v_alignbit_b32 v43, v25, v24, 16
    ds_write_b128 v156, v[40:43] offset:4160
    v_alignbit_b32 v44, v30, v29, 16
    v_alignbit_b32 v45, v31, v30, 16
    v_alignbit_b32 v46, v32, v31, 16
    v_alignbit_b32 v47, v33, v32, 16
    ds_write_b128 v156, v[44:47] offset:5184
    s_waitcnt lgkmcnt(0)
    s_setprio 1
    s_barrier
    s_sleep 8
    ds_read_b32 v5, v3 offset:0
    ds_read2_b32 v[48:49], v148 offset0:0 offset1:1
    ds_read2_b32 v[50:51], v148 offset0:2 offset1:3
    ds_read2_b32 v[52:53], v148 offset0:128 offset1:129
    ds_read2_b32 v[54:55], v148 offset0:130 offset1:131
    ds_read2_b32 v[56:57], v149 offset0:0 offset1:1
    ds_read2_b32 v[58:59], v149 offset0:2 offset1:3
    ds_read2_b32 v[60:61], v149 offset0:128 offset1:129
    ds_read2_b32 v[62:63], v149 offset0:130 offset1:131
    ds_read2_b32 v[64:65], v150 offset0:0 offset1:1
    ds_read2_b32 v[66:67], v150 offset0:2 offset1:3
    ds_read2_b32 v[68:69], v150 offset0:128 offset1:129
    ds_read2_b32 v[70:71], v150 offset0:130 offset1:131
    s_waitcnt lgkmcnt(6)
    ds_read2_b32 v[72:73], v151 offset0:0 offset1:1
    ds_read2_b32 v[74:75], v151 offset0:2 offset1:3
    ds_read2_b32 v[76:77], v151 offset0:128 offset1:129
    ds_read2_b32 v[78:79], v151 offset0:130 offset1:131
    v_readfirstlane_b32 s81, v5
    s_waitcnt lgkmcnt(6)
    ds_read_b128 v[108:111], v152 offset:0
    ds_read_b128 v[104:107], v152 offset:1024
    ds_read_b128 v[100:103], v152 offset:2048
    ds_read_b128 v[96:99], v152 offset:3072
    ds_read_b128 v[92:95], v152 offset:4096
    ds_read_b128 v[88:91], v152 offset:5120
    ds_read_b128 v[84:87], v152 offset:6144
    ds_read_b128 v[80:83], v152 offset:7168
    s_cmp_lg_u32 s81, 0
    s_cbranch_scc1 L_conv2
L_upoll:
    s_cmp_lg_u32 s52, 0
    s_cbranch_scc1 Lud_28
    s_mov_b32 s100, 0
Lup_27:
    s_load_dwordx16 s[64:79], s[56:57], 0 glc
    s_load_dwordx16 s[4:19], s[56:57], 64 glc
    s_waitcnt lgkmcnt(0)
    s_xor_b64 s[64:65], s[64:65], s[58:59]
    s_xor_b64 s[4:5], s[4:5], s[58:59]
    s_or_b64 s[64:65], s[64:65], s[4:5]
    s_xor_b64 s[66:67], s[66:67], s[58:59]
    s_xor_b64 s[6:7], s[6:7], s[58:59]
    s_or_b64 s[64:65], s[64:65], s[66:67]
    s_or_b64 s[64:65], s[64:65], s[6:7]
    s_xor_b64 s[68:69], s[68:69], s[58:59]
    s_xor_b64 s[8:9], s[8:9], s[58:59]
    s_or_b64 s[64:65], s[64:65], s[68:69]
    s_or_b64 s[64:65], s[64:65], s[8:9]
    s_xor_b64 s[70:71], s[70:71], s[58:59]
    s_xor_b64 s[10:11], s[10:11], s[58:59]
    s_or_b64 s[64:65], s[64:65], s[70:71]
    s_or_b64 s[64:65], s[64:65], s[10:11]
    s_xor_b64 s[72:73], s[72:73], s[58:59]
    s_xor_b64 s[12:13], s[12:13], s[58:59]
    s_or_b64 s[64:65], s[64:65], s[72:73]
    s_or_b64 s[64:65], s[64:65], s[12:13]
    s_xor_b64 s[74:75], s[74:75], s[58:59]
    s_xor_b64 s[14:15], s[14:15], s[58:59]
    s_or_b64 s[64:65], s[64:65], s[74:75]
    s_or_b64 s[64:65], s[64:65], s[14:15]
    s_xor_b64 s[76:77], s[76:77], s[58:59]
    s_xor_b64 s[16:17], s[16:17], s[58:59]
    s_or_b64 s[64:65], s[64:65], s[76:77]
    s_or_b64 s[64:65], s[64:65], s[16:17]
    s_xor_b64 s[78:79], s[78:79], s[58:59]
    s_xor_b64 s[18:19], s[18:19], s[58:59]
    s_or_b64 s[64:65], s[64:65], s[78:79]
    s_or_b64 s[64:65], s[64:65], s[18:19]
    s_cbranch_scc0 Lug_29
    s_add_u32 s100, s100, 1
    s_cmp_lt_u32 s100, 1048576
    s_cbranch_scc1 Lup_27
Lug_29:
    s_mov_b32 s52, -1
Lud_28:
    s_cmp_lg_u32 s52, -1
    s_cbranch_scc1 Lui_30
    s_add_u32 m0, s41, 33536
    s_lshl_b32 s96, s43, 13
    s_add_u32 s96, s96, 1048576
    buffer_load_dwordx4 v12, s[44:47], s96 offen offset:0 sc1 lds
    buffer_load_dwordx4 v12, s[44:47], s96 offen offset:1024 sc1 lds
    buffer_load_dwordx4 v12, s[44:47], s96 offen offset:2048 sc1 lds
    buffer_load_dwordx4 v12, s[44:47], s96 offen offset:3072 sc1 lds
    s_add_u32 m0, m0, 4096
    s_add_u32 s96, s96, 4096
    buffer_load_dwordx4 v12, s[44:47], s96 offen offset:0 sc1 lds
    buffer_load_dwordx4 v12, s[44:47], s96 offen offset:1024 sc1 lds
    buffer_load_dwordx4 v12, s[44:47], s96 offen offset:2048 sc1 lds
    buffer_load_dwordx4 v12, s[44:47], s96 offen offset:3072 sc1 lds
    s_mov_b32 s52, 9
Lui_30:
    s_cmp_lg_u32 s52, 9
    s_cbranch_scc1 L_uwait
    v_mov_b32 v4, 1
    s_mov_b64 exec, 1
    ds_add_u32 v3, v4 offset:40
    s_mov_b64 exec, -1
    s_waitcnt vmcnt(0)
    v_mov_b32 v4, 1
    ds_write_b32 v3, v4 offset:0
L_uwait:
    s_mov_b32 s100, 0
Lw_31:
    ds_read_b32 v4, v3 offset:0
    s_waitcnt lgkmcnt(0)
    v_readfirstlane_b32 s99, v4
    s_cmp_ge_u32 s99, 1
    s_cbranch_scc1 Lwd_32
    s_sleep 1
    s_add_u32 s100, s100, 1
    s_cmp_lt_u32 s100, 8388608
    s_cbranch_scc1 Lw_31
Lwd_32:
    s_cmp_eq_u32 s3, 0
    s_cbranch_scc1 L_conv
    s_branch L_touch
L_asig:
    s_waitcnt vmcnt(2)
    v_subrev_u32 v4, 4, v156
    ds_read_b32 v21, v4 offset:0
    ds_read_b128 v[22:25], v156 offset:0
    ds_read_b32 v29, v4 offset:1024
    ds_read_b128 v[30:33], v156 offset:1024
    s_waitcnt lgkmcnt(0)
    s_mov_b64 exec, 1
    v_lshlrev_b32 v26, 16, v22
    v_and_b32 v27, 0xffff0000, v22
    v_add_f32 v26, s53, v26
    v_cvt_pk_bf16_f32 v22, v26, v27
    ds_write_b32 v156, v22
    s_mov_b64 exec, -1
    v_alignbit_b32 v40, v22, v21, 16
    v_alignbit_b32 v41, v23, v22, 16
    v_alignbit_b32 v42, v24, v23, 16
    v_alignbit_b32 v43, v25, v24, 16
    ds_write_b128 v156, v[40:43] offset:4160
    v_alignbit_b32 v44, v30, v29, 16
    v_alignbit_b32 v45, v31, v30, 16
    v_alignbit_b32 v46, v32, v31, 16
    v_alignbit_b32 v47, v33, v32, 16
    ds_write_b128 v156, v[44:47] offset:5184
    s_waitcnt lgkmcnt(0)
    v_mov_b32 v4, 1
    s_mov_b64 exec, 1
    ds_add_u32 v3, v4 offset:32
    s_mov_b64 exec, -1
    v_lshl_add_u32 v6, v0, 7, s64
    v_mov_b32 v5, s31
    s_cmp_ge_u32 s55, 3
    s_cselect_b32 s97, 1, 0xff
    s_waitcnt vmcnt(0)
    s_mov_b32 exec_hi, 0
    s_mov_b32 exec_lo, s97
    global_atomic_swap v6, v5, s[28:29] sc1
    s_mov_b64 exec, -1
    s_mov_b32 s100, 0
Lw_33:
    ds_read_b32 v4, v3 offset:32
    s_waitcnt lgkmcnt(0)
    v_readfirstlane_b32 s99, v4
    s_cmp_ge_u32 s99, 4
    s_cbranch_scc1 Lwd_34
    s_sleep 1
    s_add_u32 s100, s100, 1
    s_cmp_lt_u32 s100, 8388608
    s_cbranch_scc1 Lw_33
Lwd_34:
    ds_read2_b32 v[48:49], v148 offset0:0 offset1:1
    ds_read2_b32 v[50:51], v148 offset0:2 offset1:3
    ds_read2_b32 v[52:53], v148 offset0:128 offset1:129
    ds_read2_b32 v[54:55], v148 offset0:130 offset1:131
    ds_read2_b32 v[56:57], v149 offset0:0 offset1:1
    ds_read2_b32 v[58:59], v149 offset0:2 offset1:3
    ds_read2_b32 v[60:61], v149 offset0:128 offset1:129
    ds_read2_b32 v[62:63], v149 offset0:130 offset1:131
    ds_read2_b32 v[64:65], v150 offset0:0 offset1:1
    ds_read2_b32 v[66:67], v150 offset0:2 offset1:3
    ds_read2_b32 v[68:69], v150 offset0:128 offset1:129
    ds_read2_b32 v[70:71], v150 offset0:130 offset1:131
    s_waitcnt lgkmcnt(6)
    ds_read2_b32 v[72:73], v151 offset0:0 offset1:1
    ds_read2_b32 v[74:75], v151 offset0:2 offset1:3
    ds_read2_b32 v[76:77], v151 offset0:128 offset1:129
    ds_read2_b32 v[78:79], v151 offset0:130 offset1:131
    s_mov_b32 s52, s40
    s_branch L_upoll
L_touch:
    s_cmp_lg_u32 s55, 1
    s_cbranch_scc1 L_conv
    s_lshl2_add_u32 s96, s63, s40
    s_mul_i32 s96, s96, 14336
    s_add_u32 s96, s96, 786432
    v_lshlrev_b32 v4, 7, v0
    s_add_u32 s97, s96, 8192
    buffer_load_dword v160, v4, s[48:51], s96 offen
    s_mov_b32 exec_hi, 0xffff
    buffer_load_dword v160, v4, s[48:51], s97 offen
    s_mov_b32 exec_hi, -1
L_conv:
    s_setprio 1
    ds_read_b128 v[108:111], v152 offset:0
    ds_read_b128 v[104:107], v152 offset:1024
    ds_read_b128 v[100:103], v152 offset:2048
    ds_read_b128 v[96:99], v152 offset:3072
    ds_read_b128 v[92:95], v152 offset:4096
    ds_read_b128 v[88:91], v152 offset:5120
    ds_read_b128 v[84:87], v152 offset:6144
    ds_read_b128 v[80:83], v152 offset:7168
L_conv2:

    s_waitcnt lgkmcnt(7)
    v_mfma_f32_16x16x32_bf16 v[44:47], v[48:51], v[108:111], 0
    s_waitcnt lgkmcnt(6)
    v_mfma_f32_16x16x32_bf16 v[40:43], v[48:51], v[104:107], 0
    ds_read_b128 v[140:143], v153 offset:0
    s_waitcnt lgkmcnt(6)
    v_mfma_f32_16x16x32_bf16 v[36:39], v[48:51], v[100:103], 0
    s_waitcnt lgkmcnt(5)
    v_mfma_f32_16x16x32_bf16 v[32:35], v[48:51], v[96:99], 0
    ds_read_b128 v[136:139], v153 offset:1024
    s_waitcnt lgkmcnt(5)
    v_mfma_f32_16x16x32_bf16 v[28:31], v[48:51], v[92:95], 0
    s_waitcnt lgkmcnt(4)
    v_mfma_f32_16x16x32_bf16 v[24:27], v[48:51], v[88:91], 0
    ds_read_b128 v[132:135], v153 offset:2048
    s_waitcnt lgkmcnt(4)
    v_mfma_f32_16x16x32_bf16 v[20:23], v[48:51], v[84:87], 0
    s_waitcnt lgkmcnt(3)
    v_mfma_f32_16x16x32_bf16 v[16:19], v[48:51], v[80:83], 0
    ds_read_b128 v[128:131], v153 offset:3072
    v_mfma_f32_16x16x32_bf16 v[44:47], v[52:55], v[104:107], v[44:47]
    v_mfma_f32_16x16x32_bf16 v[40:43], v[52:55], v[100:103], v[40:43]
    ds_read2_b32 v[48:49], v148 offset0:16 offset1:17
    v_mfma_f32_16x16x32_bf16 v[36:39], v[52:55], v[96:99], v[36:39]
    v_mfma_f32_16x16x32_bf16 v[32:35], v[52:55], v[92:95], v[32:35]
    ds_read2_b32 v[50:51], v148 offset0:18 offset1:19
    v_mfma_f32_16x16x32_bf16 v[28:31], v[52:55], v[88:91], v[28:31]
    v_mfma_f32_16x16x32_bf16 v[24:27], v[52:55], v[84:87], v[24:27]
    ds_read_b128 v[124:127], v153 offset:4096
    v_mfma_f32_16x16x32_bf16 v[20:23], v[52:55], v[80:83], v[20:23]
    v_mfma_f32_16x16x32_bf16 v[44:47], v[56:59], v[100:103], v[44:47]
    v_mfma_f32_16x16x32_bf16 v[40:43], v[56:59], v[96:99], v[40:43]
    ds_read2_b32 v[52:53], v148 offset0:144 offset1:145
    v_mfma_f32_16x16x32_bf16 v[36:39], v[56:59], v[92:95], v[36:39]
    v_mfma_f32_16x16x32_bf16 v[32:35], v[56:59], v[88:91], v[32:35]
    ds_read2_b32 v[54:55], v148 offset0:146 offset1:147
    v_mfma_f32_16x16x32_bf16 v[28:31], v[56:59], v[84:87], v[28:31]
    v_mfma_f32_16x16x32_bf16 v[24:27], v[56:59], v[80:83], v[24:27]
    ds_read_b128 v[120:123], v153 offset:5120
    v_mfma_f32_16x16x32_bf16 v[44:47], v[60:63], v[96:99], v[44:47]
    v_mfma_f32_16x16x32_bf16 v[40:43], v[60:63], v[92:95], v[40:43]
    ds_read2_b32 v[56:57], v149 offset0:16 offset1:17
    v_mfma_f32_16x16x32_bf16 v[36:39], v[60:63], v[88:91], v[36:39]
    v_mfma_f32_16x16x32_bf16 v[32:35], v[60:63], v[84:87], v[32:35]
    ds_read2_b32 v[58:59], v149 offset0:18 offset1:19
    v_mfma_f32_16x16x32_bf16 v[28:31], v[60:63], v[80:83], v[28:31]
    v_mfma_f32_16x16x32_bf16 v[44:47], v[64:67], v[92:95], v[44:47]
    ds_read2_b32 v[60:61], v149 offset0:144 offset1:145
    v_mfma_f32_16x16x32_bf16 v[40:43], v[64:67], v[88:91], v[40:43]
    ds_read2_b32 v[62:63], v149 offset0:146 offset1:147
    v_mfma_f32_16x16x32_bf16 v[36:39], v[64:67], v[84:87], v[36:39]
    ds_read_b128 v[116:119], v153 offset:6144
    v_mfma_f32_16x16x32_bf16 v[32:35], v[64:67], v[80:83], v[32:35]
    s_waitcnt lgkmcnt(13)
    ds_read_b128 v[112:115], v153 offset:7168
    v_mfma_f32_16x16x32_bf16 v[44:47], v[68:71], v[88:91], v[44:47]
    ds_read2_b32 v[64:65], v150 offset0:16 offset1:17
    v_mfma_f32_16x16x32_bf16 v[40:43], v[68:71], v[84:87], v[40:43]
    s_waitcnt lgkmcnt(13)
    ds_read2_b32 v[66:67], v150 offset0:18 offset1:19
    v_mfma_f32_16x16x32_bf16 v[36:39], v[68:71], v[80:83], v[36:39]
    v_mfma_f32_16x16x32_bf16 v[44:47], v[72:75], v[84:87], v[44:47]
    ds_read2_b32 v[68:69], v150 offset0:144 offset1:145
    v_mfma_f32_16x16x32_bf16 v[40:43], v[72:75], v[80:83], v[40:43]
    s_waitcnt lgkmcnt(13)
    ds_read2_b32 v[70:71], v150 offset0:146 offset1:147
    v_mfma_f32_16x16x32_bf16 v[44:47], v[76:79], v[80:83], v[44:47]
    ds_read2_b32 v[72:73], v151 offset0:16 offset1:17
    s_waitcnt lgkmcnt(13)
    ds_read2_b32 v[76:77], v151 offset0:144 offset1:145
    ds_read2_b32 v[78:79], v151 offset0:146 offset1:147
    s_waitcnt lgkmcnt(13)
    ds_read2_b32 v[74:75], v151 offset0:18 offset1:19
    v_mfma_f32_16x16x32_bf16 v[44:47], v[48:51], v[140:143], v[44:47]
    v_mfma_f32_16x16x32_bf16 v[40:43], v[48:51], v[136:139], v[40:43]
    ds_read_b128 v[108:111], v154 offset:256
    v_mfma_f32_16x16x32_bf16 v[36:39], v[48:51], v[132:135], v[36:39]
    v_mfma_f32_16x16x32_bf16 v[32:35], v[48:51], v[128:131], v[32:35]
    s_waitcnt lgkmcnt(13)
    ds_read_b128 v[104:107], v154 offset:1280
    v_mfma_f32_16x16x32_bf16 v[28:31], v[48:51], v[124:127], v[28:31]
    v_mfma_f32_16x16x32_bf16 v[24:27], v[48:51], v[120:123], v[24:27]
    ds_read_b128 v[100:103], v154 offset:2304
    s_waitcnt lgkmcnt(12)
    v_mfma_f32_16x16x32_bf16 v[20:23], v[48:51], v[116:119], v[20:23]
    s_waitcnt lgkmcnt(11)
    v_mfma_f32_16x16x32_bf16 v[16:19], v[48:51], v[112:115], v[16:19]
    ds_read_b128 v[96:99], v154 offset:3328
    v_mfma_f32_16x16x32_bf16 v[44:47], v[52:55], v[136:139], v[44:47]
    v_mfma_f32_16x16x32_bf16 v[40:43], v[52:55], v[132:135], v[40:43]
    ds_read2_b32 v[48:49], v148 offset0:32 offset1:33
    v_mfma_f32_16x16x32_bf16 v[36:39], v[52:55], v[128:131], v[36:39]
    v_mfma_f32_16x16x32_bf16 v[32:35], v[52:55], v[124:127], v[32:35]
    ds_read2_b32 v[50:51], v148 offset0:34 offset1:35
    v_mfma_f32_16x16x32_bf16 v[28:31], v[52:55], v[120:123], v[28:31]
    v_mfma_f32_16x16x32_bf16 v[24:27], v[52:55], v[116:119], v[24:27]
    ds_read_b128 v[92:95], v154 offset:4352
    v_mfma_f32_16x16x32_bf16 v[20:23], v[52:55], v[112:115], v[20:23]
    v_mfma_f32_16x16x32_bf16 v[44:47], v[56:59], v[132:135], v[44:47]
    v_mfma_f32_16x16x32_bf16 v[40:43], v[56:59], v[128:131], v[40:43]
    s_waitcnt lgkmcnt(13)
    ds_read2_b32 v[52:53], v148 offset0:160 offset1:161
    v_mfma_f32_16x16x32_bf16 v[36:39], v[56:59], v[124:127], v[36:39]
    v_mfma_f32_16x16x32_bf16 v[32:35], v[56:59], v[120:123], v[32:35]
    ds_read2_b32 v[54:55], v148 offset0:162 offset1:163
    v_mfma_f32_16x16x32_bf16 v[28:31], v[56:59], v[116:119], v[28:31]
    v_mfma_f32_16x16x32_bf16 v[24:27], v[56:59], v[112:115], v[24:27]
    s_waitcnt lgkmcnt(13)
    ds_read_b128 v[88:91], v154 offset:5376
    v_mfma_f32_16x16x32_bf16 v[44:47], v[60:63], v[128:131], v[44:47]
    v_mfma_f32_16x16x32_bf16 v[40:43], v[60:63], v[124:127], v[40:43]
    ds_read2_b32 v[56:57], v149 offset0:32 offset1:33
    v_mfma_f32_16x16x32_bf16 v[36:39], v[60:63], v[120:123], v[36:39]
    v_mfma_f32_16x16x32_bf16 v[32:35], v[60:63], v[116:119], v[32:35]
    s_waitcnt lgkmcnt(13)
    ds_read2_b32 v[58:59], v149 offset0:34 offset1:35
    v_mfma_f32_16x16x32_bf16 v[28:31], v[60:63], v[112:115], v[28:31]
    v_mfma_f32_16x16x32_bf16 v[44:47], v[64:67], v[124:127], v[44:47]
    ds_read2_b32 v[60:61], v149 offset0:160 offset1:161
    v_mfma_f32_16x16x32_bf16 v[40:43], v[64:67], v[120:123], v[40:43]
    s_waitcnt lgkmcnt(13)
    ds_read2_b32 v[62:63], v149 offset0:162 offset1:163
    v_mfma_f32_16x16x32_bf16 v[36:39], v[64:67], v[116:119], v[36:39]
    ds_read_b128 v[84:87], v154 offset:6400
    v_mfma_f32_16x16x32_bf16 v[32:35], v[64:67], v[112:115], v[32:35]
    s_waitcnt lgkmcnt(13)
    ds_read_b128 v[80:83], v154 offset:7424
    v_mfma_f32_16x16x32_bf16 v[44:47], v[68:71], v[120:123], v[44:47]
    ds_read2_b32 v[64:65], v150 offset0:32 offset1:33
    v_mfma_f32_16x16x32_bf16 v[40:43], v[68:71], v[116:119], v[40:43]
    s_waitcnt lgkmcnt(13)
    ds_read2_b32 v[66:67], v150 offset0:34 offset1:35
    v_mfma_f32_16x16x32_bf16 v[36:39], v[68:71], v[112:115], v[36:39]
    v_mfma_f32_16x16x32_bf16 v[44:47], v[72:75], v[116:119], v[44:47]
    ds_read2_b32 v[68:69], v150 offset0:160 offset1:161
    v_mfma_f32_16x16x32_bf16 v[40:43], v[72:75], v[112:115], v[40:43]
    s_waitcnt lgkmcnt(13)
    ds_read2_b32 v[70:71], v150 offset0:162 offset1:163
    v_mfma_f32_16x16x32_bf16 v[44:47], v[76:79], v[112:115], v[44:47]
    ds_read2_b32 v[72:73], v151 offset0:32 offset1:33
    s_waitcnt lgkmcnt(13)
    ds_read2_b32 v[76:77], v151 offset0:160 offset1:161
    ds_read2_b32 v[78:79], v151 offset0:162 offset1:163
    s_waitcnt lgkmcnt(13)
    ds_read2_b32 v[74:75], v151 offset0:34 offset1:35
    v_mfma_f32_16x16x32_bf16 v[44:47], v[48:51], v[108:111], v[44:47]
    v_mfma_f32_16x16x32_bf16 v[40:43], v[48:51], v[104:107], v[40:43]
    ds_read_b128 v[140:143], v155 offset:256
    v_mfma_f32_16x16x32_bf16 v[36:39], v[48:51], v[100:103], v[36:39]
    v_mfma_f32_16x16x32_bf16 v[32:35], v[48:51], v[96:99], v[32:35]
    s_waitcnt lgkmcnt(13)
    ds_read_b128 v[136:139], v155 offset:1280
    v_mfma_f32_16x16x32_bf16 v[28:31], v[48:51], v[92:95], v[28:31]
    v_mfma_f32_16x16x32_bf16 v[24:27], v[48:51], v[88:91], v[24:27]
    ds_read_b128 v[132:135], v155 offset:2304
    s_waitcnt lgkmcnt(12)
    v_mfma_f32_16x16x32_bf16 v[20:23], v[48:51], v[84:87], v[20:23]
    s_waitcnt lgkmcnt(11)
    v_mfma_f32_16x16x32_bf16 v[16:19], v[48:51], v[80:83], v[16:19]
    ds_read_b128 v[128:131], v155 offset:3328
    v_mfma_f32_16x16x32_bf16 v[44:47], v[52:55], v[104:107], v[44:47]
    v_mfma_f32_16x16x32_bf16 v[40:43], v[52:55], v[100:103], v[40:43]
    ds_read2_b32 v[48:49], v148 offset0:48 offset1:49
    v_mfma_f32_16x16x32_bf16 v[36:39], v[52:55], v[96:99], v[36:39]
    v_mfma_f32_16x16x32_bf16 v[32:35], v[52:55], v[92:95], v[32:35]
    ds_read2_b32 v[50:51], v148 offset0:50 offset1:51
    v_mfma_f32_16x16x32_bf16 v[28:31], v[52:55], v[88:91], v[28:31]
    v_mfma_f32_16x16x32_bf16 v[24:27], v[52:55], v[84:87], v[24:27]
    ds_read_b128 v[124:127], v155 offset:4352
    v_mfma_f32_16x16x32_bf16 v[20:23], v[52:55], v[80:83], v[20:23]
    v_mfma_f32_16x16x32_bf16 v[44:47], v[56:59], v[100:103], v[44:47]
    v_mfma_f32_16x16x32_bf16 v[40:43], v[56:59], v[96:99], v[40:43]
    s_waitcnt lgkmcnt(13)
    ds_read2_b32 v[52:53], v148 offset0:176 offset1:177
    v_mfma_f32_16x16x32_bf16 v[36:39], v[56:59], v[92:95], v[36:39]
    v_mfma_f32_16x16x32_bf16 v[32:35], v[56:59], v[88:91], v[32:35]
    ds_read2_b32 v[54:55], v148 offset0:178 offset1:179
    v_mfma_f32_16x16x32_bf16 v[28:31], v[56:59], v[84:87], v[28:31]
    v_mfma_f32_16x16x32_bf16 v[24:27], v[56:59], v[80:83], v[24:27]
    s_waitcnt lgkmcnt(13)
    ds_read_b128 v[120:123], v155 offset:5376
    s_lshl_b32 s96, s40, 2
    v_add_u32 v5, s96, v3
    v_mfma_f32_16x16x32_bf16 v[44:47], v[60:63], v[96:99], v[44:47]
    v_mfma_f32_16x16x32_bf16 v[40:43], v[60:63], v[92:95], v[40:43]
    ds_read2_b32 v[56:57], v149 offset0:48 offset1:49
    v_mfma_f32_16x16x32_bf16 v[36:39], v[60:63], v[88:91], v[36:39]
    v_mfma_f32_16x16x32_bf16 v[32:35], v[60:63], v[84:87], v[32:35]
    s_waitcnt lgkmcnt(13)
    ds_read2_b32 v[58:59], v149 offset0:50 offset1:51
    v_xor_b32 v6, 4, v5
    s_and_b32 s96, s34, 3
    v_mfma_f32_16x16x32_bf16 v[28:31], v[60:63], v[80:83], v[28:31]
    v_mfma_f32_16x16x32_bf16 v[44:47], v[64:67], v[92:95], v[44:47]
    ds_read2_b32 v[60:61], v149 offset0:176 offset1:177
    v_mfma_f32_16x16x32_bf16 v[40:43], v[64:67], v[88:91], v[40:43]
    s_waitcnt lgkmcnt(13)
    ds_read2_b32 v[62:63], v149 offset0:178 offset1:179
    v_mfma_f32_16x16x32_bf16 v[36:39], v[64:67], v[84:87], v[36:39]
    s_cselect_b32 s96, 4, 6
    s_cmp_eq_u32 s3, 0
    ds_read_b128 v[116:119], v155 offset:6400
    v_mfma_f32_16x16x32_bf16 v[32:35], v[64:67], v[80:83], v[32:35]
    s_waitcnt lgkmcnt(13)
    ds_read_b128 v[112:115], v155 offset:7424
    v_mfma_f32_16x16x32_bf16 v[44:47], v[68:71], v[88:91], v[44:47]
    ds_read2_b32 v[64:65], v150 offset0:48 offset1:49
    v_mfma_f32_16x16x32_bf16 v[40:43], v[68:71], v[84:87], v[40:43]
    s_cselect_b32 s81, s96, 0
    s_bitcmp1_b32 s40, 0
    s_waitcnt lgkmcnt(13)
    ds_read2_b32 v[66:67], v150 offset0:50 offset1:51
    v_mfma_f32_16x16x32_bf16 v[36:39], v[68:71], v[80:83], v[36:39]
    ds_read_b32 v4, v3 offset:64
    v_mfma_f32_16x16x32_bf16 v[44:47], v[72:75], v[84:87], v[44:47]
    s_waitcnt lgkmcnt(13)
    ds_read2_b32 v[68:69], v150 offset0:176 offset1:177
    v_mfma_f32_16x16x32_bf16 v[40:43], v[72:75], v[80:83], v[40:43]
    ds_read2_b32 v[70:71], v150 offset0:178 offset1:179
    v_mfma_f32_16x16x32_bf16 v[44:47], v[76:79], v[80:83], v[44:47]
    s_waitcnt lgkmcnt(13)
    ds_read2_b32 v[72:73], v151 offset0:48 offset1:49
    ds_read2_b32 v[76:77], v151 offset0:176 offset1:177
    s_waitcnt lgkmcnt(13)
    ds_read2_b32 v[78:79], v151 offset0:178 offset1:179
    ds_read2_b32 v[74:75], v151 offset0:50 offset1:51
    s_cbranch_scc1 L_mrg1

    s_waitcnt lgkmcnt(14)
    v_mfma_f32_16x16x32_bf16 v[36:39], v[48:51], v[132:135], v[36:39]
    v_mfma_f32_16x16x32_bf16 v[32:35], v[48:51], v[128:131], v[32:35]
    v_mfma_f32_16x16x32_bf16 v[28:31], v[48:51], v[124:127], v[28:31]
    v_mfma_f32_16x16x32_bf16 v[24:27], v[48:51], v[120:123], v[24:27]
    v_mfma_f32_16x16x32_bf16 v[36:39], v[52:55], v[128:131], v[36:39]
    v_mfma_f32_16x16x32_bf16 v[32:35], v[52:55], v[124:127], v[32:35]
    v_mfma_f32_16x16x32_bf16 v[28:31], v[52:55], v[120:123], v[28:31]
    s_waitcnt lgkmcnt(10)
    v_mfma_f32_16x16x32_bf16 v[24:27], v[52:55], v[116:119], v[24:27]
    v_mfma_f32_16x16x32_bf16 v[36:39], v[56:59], v[124:127], v[36:39]
    v_mfma_f32_16x16x32_bf16 v[32:35], v[56:59], v[120:123], v[32:35]
    v_mfma_f32_16x16x32_bf16 v[28:31], v[56:59], v[116:119], v[28:31]
    s_waitcnt lgkmcnt(9)
    v_mfma_f32_16x16x32_bf16 v[24:27], v[56:59], v[112:115], v[24:27]
    v_mfma_f32_16x16x32_bf16 v[36:39], v[60:63], v[120:123], v[36:39]
    v_mfma_f32_16x16x32_bf16 v[32:35], v[60:63], v[116:119], v[32:35]
    v_mfma_f32_16x16x32_bf16 v[28:31], v[60:63], v[112:115], v[28:31]
    s_waitcnt lgkmcnt(7)
    v_mfma_f32_16x16x32_bf16 v[36:39], v[64:67], v[116:119], v[36:39]
    v_mfma_f32_16x16x32_bf16 v[32:35], v[64:67], v[112:115], v[32:35]
    s_waitcnt lgkmcnt(4)
    v_mfma_f32_16x16x32_bf16 v[36:39], v[68:71], v[112:115], v[36:39]

    v_readfirstlane_b32 s99, v4
    s_cmp_lt_u32 s99, s81
    s_cbranch_scc1 L_mslow0
L_mgo0:
    v_mfma_f32_16x16x32_bf16 v[44:47], v[48:51], v[140:143], v[44:47]
    v_mfma_f32_16x16x32_bf16 v[40:43], v[48:51], v[136:139], v[40:43]
    v_mfma_f32_16x16x32_bf16 v[20:23], v[48:51], v[116:119], v[20:23]
    ds_write_b128 v158, v[24:27] offset:0
    v_mfma_f32_16x16x32_bf16 v[16:19], v[48:51], v[112:115], v[16:19]
    ds_write_b128 v158, v[28:31] offset:1024
    v_mfma_f32_16x16x32_bf16 v[44:47], v[52:55], v[136:139], v[44:47]
    ds_write_b128 v158, v[32:35] offset:2048
    v_mfma_f32_16x16x32_bf16 v[40:43], v[52:55], v[132:135], v[40:43]
    ds_write_b128 v158, v[36:39] offset:3072
    v_mfma_f32_16x16x32_bf16 v[20:23], v[52:55], v[112:115], v[20:23]
    ds_write_b32 v5, v5 offset:8
    v_mfma_f32_16x16x32_bf16 v[44:47], v[56:59], v[132:135], v[44:47]
    v_mfma_f32_16x16x32_bf16 v[40:43], v[56:59], v[128:131], v[40:43]
    v_mfma_f32_16x16x32_bf16 v[44:47], v[60:63], v[128:131], v[44:47]
    v_mfma_f32_16x16x32_bf16 v[40:43], v[60:63], v[124:127], v[40:43]
    v_mfma_f32_16x16x32_bf16 v[44:47], v[64:67], v[124:127], v[44:47]
    v_mfma_f32_16x16x32_bf16 v[40:43], v[64:67], v[120:123], v[40:43]
    v_mfma_f32_16x16x32_bf16 v[44:47], v[68:71], v[120:123], v[44:47]
    v_mfma_f32_16x16x32_bf16 v[40:43], v[68:71], v[116:119], v[40:43]
    s_waitcnt lgkmcnt(5)
    v_mfma_f32_16x16x32_bf16 v[44:47], v[72:75], v[116:119], v[44:47]
    v_mfma_f32_16x16x32_bf16 v[40:43], v[72:75], v[112:115], v[40:43]
    v_mfma_f32_16x16x32_bf16 v[44:47], v[76:79], v[112:115], v[44:47]
    s_setprio 3
L_mb0:
    ds_read_b32 v4, v6 offset:8
    ds_read_b128 v[80:83], v159 offset:0
    ds_read_b128 v[84:87], v159 offset:1024
    ds_read_b128 v[88:91], v159 offset:2048
    ds_read_b128 v[92:95], v159 offset:3072
    s_waitcnt lgkmcnt(4)
    v_readfirstlane_b32 s99, v4
    s_cmp_eq_u32 s99, 0
    s_cbranch_scc1 L_mw0
    s_waitcnt lgkmcnt(2)
    v_add_f32 v16, v16, v80
    v_add_f32 v17, v17, v81
    v_add_f32 v18, v18, v82
    v_add_f32 v19, v19, v83
    v_add_f32 v20, v20, v84
    v_add_f32 v21, v21, v85
    v_add_f32 v22, v22, v86
    v_add_f32 v23, v23, v87
    v_cvt_pk_bf16_f32 v96, v16, v17
    v_cvt_pk_bf16_f32 v97, v18, v19
    v_cvt_pk_bf16_f32 v98, v20, v21
    v_cvt_pk_bf16_f32 v99, v22, v23
    s_nop 0
    v_permlane16_swap_b32 v96, v98
    v_permlane16_swap_b32 v97, v99
    buffer_store_dwordx4 v[96:99], v157, s[44:47], 0 offen offset:0 sc1
    s_waitcnt lgkmcnt(0)
    v_add_f32 v40, v40, v88
    v_add_f32 v41, v41, v89
    v_add_f32 v42, v42, v90
    v_add_f32 v43, v43, v91
    v_add_f32 v44, v44, v92
    v_add_f32 v45, v45, v93
    v_add_f32 v46, v46, v94
    v_add_f32 v47, v47, v95
    v_cvt_pk_bf16_f32 v100, v40, v41
    v_cvt_pk_bf16_f32 v101, v42, v43
    v_cvt_pk_bf16_f32 v102, v44, v45
    v_cvt_pk_bf16_f32 v103, v46, v47
    s_nop 0
    v_permlane16_swap_b32 v100, v102
    v_permlane16_swap_b32 v101, v103
    buffer_store_dwordx4 v[100:103], v157, s[44:47], 0 offen offset:3072 sc1
    s_branch L_mrgd
L_mw0:
    s_mov_b32 s100, 0
Lw_35:
    ds_read_b32 v4, v6 offset:8
    s_waitcnt lgkmcnt(0)
    v_readfirstlane_b32 s99, v4
    s_cmp_ge_u32 s99, 1
    s_cbranch_scc1 Lwd_36
    s_add_u32 s100, s100, 1
    s_cmp_lt_u32 s100, 8388608
    s_cbranch_scc1 Lw_35
Lwd_36:
    s_branch L_mb0
L_mslow0:
    s_mov_b32 s100, 0
Lw_37:
    ds_read_b32 v4, v3 offset:64
    s_waitcnt lgkmcnt(0)
    v_readfirstlane_b32 s99, v4
    s_cmp_ge_u32 s99, s81
    s_cbranch_scc1 Lwd_38
    s_add_u32 s100, s100, 1
    s_cmp_lt_u32 s100, 8388608
    s_cbranch_scc1 Lw_37
Lwd_38:
    s_branch L_mgo0
L_mrg1:

    s_waitcnt lgkmcnt(14)
    v_mfma_f32_16x16x32_bf16 v[44:47], v[48:51], v[140:143], v[44:47]
    v_mfma_f32_16x16x32_bf16 v[40:43], v[48:51], v[136:139], v[40:43]
    s_waitcnt lgkmcnt(10)
    v_mfma_f32_16x16x32_bf16 v[20:23], v[48:51], v[116:119], v[20:23]
    s_waitcnt lgkmcnt(9)
    v_mfma_f32_16x16x32_bf16 v[16:19], v[48:51], v[112:115], v[16:19]
    v_mfma_f32_16x16x32_bf16 v[44:47], v[52:55], v[136:139], v[44:47]
    v_mfma_f32_16x16x32_bf16 v[40:43], v[52:55], v[132:135], v[40:43]
    v_mfma_f32_16x16x32_bf16 v[20:23], v[52:55], v[112:115], v[20:23]
    v_mfma_f32_16x16x32_bf16 v[44:47], v[56:59], v[132:135], v[44:47]
    v_mfma_f32_16x16x32_bf16 v[40:43], v[56:59], v[128:131], v[40:43]
    v_mfma_f32_16x16x32_bf16 v[44:47], v[60:63], v[128:131], v[44:47]
    v_mfma_f32_16x16x32_bf16 v[40:43], v[60:63], v[124:127], v[40:43]
    s_waitcnt lgkmcnt(7)
    v_mfma_f32_16x16x32_bf16 v[44:47], v[64:67], v[124:127], v[44:47]
    v_mfma_f32_16x16x32_bf16 v[40:43], v[64:67], v[120:123], v[40:43]
    s_waitcnt lgkmcnt(4)
    v_mfma_f32_16x16x32_bf16 v[44:47], v[68:71], v[120:123], v[44:47]
    v_mfma_f32_16x16x32_bf16 v[40:43], v[68:71], v[116:119], v[40:43]
    s_waitcnt lgkmcnt(0)
    v_mfma_f32_16x16x32_bf16 v[44:47], v[72:75], v[116:119], v[44:47]
    v_mfma_f32_16x16x32_bf16 v[40:43], v[72:75], v[112:115], v[40:43]
    v_mfma_f32_16x16x32_bf16 v[44:47], v[76:79], v[112:115], v[44:47]

    v_readfirstlane_b32 s99, v4
    s_cmp_lt_u32 s99, s81
    s_cbranch_scc1 L_mslow1
L_mgo1:
    v_mfma_f32_16x16x32_bf16 v[36:39], v[48:51], v[132:135], v[36:39]
    v_mfma_f32_16x16x32_bf16 v[32:35], v[48:51], v[128:131], v[32:35]
    v_mfma_f32_16x16x32_bf16 v[28:31], v[48:51], v[124:127], v[28:31]
    ds_write_b128 v158, v[16:19] offset:0
    v_mfma_f32_16x16x32_bf16 v[24:27], v[48:51], v[120:123], v[24:27]
    ds_write_b128 v158, v[20:23] offset:1024
    v_mfma_f32_16x16x32_bf16 v[36:39], v[52:55], v[128:131], v[36:39]
    ds_write_b128 v158, v[40:43] offset:2048
    v_mfma_f32_16x16x32_bf16 v[32:35], v[52:55], v[124:127], v[32:35]
    ds_write_b128 v158, v[44:47] offset:3072
    v_mfma_f32_16x16x32_bf16 v[28:31], v[52:55], v[120:123], v[28:31]
    ds_write_b32 v5, v5 offset:8
    v_mfma_f32_16x16x32_bf16 v[24:27], v[52:55], v[116:119], v[24:27]
    v_mfma_f32_16x16x32_bf16 v[36:39], v[56:59], v[124:127], v[36:39]
    v_mfma_f32_16x16x32_bf16 v[32:35], v[56:59], v[120:123], v[32:35]
    v_mfma_f32_16x16x32_bf16 v[28:31], v[56:59], v[116:119], v[28:31]
    v_mfma_f32_16x16x32_bf16 v[24:27], v[56:59], v[112:115], v[24:27]
    v_mfma_f32_16x16x32_bf16 v[36:39], v[60:63], v[120:123], v[36:39]
    v_mfma_f32_16x16x32_bf16 v[32:35], v[60:63], v[116:119], v[32:35]
    v_mfma_f32_16x16x32_bf16 v[28:31], v[60:63], v[112:115], v[28:31]
    v_mfma_f32_16x16x32_bf16 v[36:39], v[64:67], v[116:119], v[36:39]
    v_mfma_f32_16x16x32_bf16 v[32:35], v[64:67], v[112:115], v[32:35]
    v_mfma_f32_16x16x32_bf16 v[36:39], v[68:71], v[112:115], v[36:39]
    s_setprio 3
L_mb1:
    ds_read_b32 v4, v6 offset:8
    ds_read_b128 v[80:83], v159 offset:0
    ds_read_b128 v[84:87], v159 offset:1024
    ds_read_b128 v[88:91], v159 offset:2048
    ds_read_b128 v[92:95], v159 offset:3072
    s_waitcnt lgkmcnt(4)
    v_readfirstlane_b32 s99, v4
    s_cmp_eq_u32 s99, 0
    s_cbranch_scc1 L_mw1
    s_waitcnt lgkmcnt(2)
    v_add_f32 v24, v24, v80
    v_add_f32 v25, v25, v81
    v_add_f32 v26, v26, v82
    v_add_f32 v27, v27, v83
    v_add_f32 v28, v28, v84
    v_add_f32 v29, v29, v85
    v_add_f32 v30, v30, v86
    v_add_f32 v31, v31, v87
    v_cvt_pk_bf16_f32 v96, v24, v25
    v_cvt_pk_bf16_f32 v97, v26, v27
    v_cvt_pk_bf16_f32 v98, v28, v29
    v_cvt_pk_bf16_f32 v99, v30, v31
    s_nop 0
    v_permlane16_swap_b32 v96, v98
    v_permlane16_swap_b32 v97, v99
    buffer_store_dwordx4 v[96:99], v157, s[44:47], 0 offen offset:1024 sc1
    s_waitcnt lgkmcnt(0)
    v_add_f32 v32, v32, v88
    v_add_f32 v33, v33, v89
    v_add_f32 v34, v34, v90
    v_add_f32 v35, v35, v91
    v_add_f32 v36, v36, v92
    v_add_f32 v37, v37, v93
    v_add_f32 v38, v38, v94
    v_add_f32 v39, v39, v95
    v_cvt_pk_bf16_f32 v100, v32, v33
    v_cvt_pk_bf16_f32 v101, v34, v35
    v_cvt_pk_bf16_f32 v102, v36, v37
    v_cvt_pk_bf16_f32 v103, v38, v39
    s_nop 0
    v_permlane16_swap_b32 v100, v102
    v_permlane16_swap_b32 v101, v103
    buffer_store_dwordx4 v[100:103], v157, s[44:47], 0 offen offset:2048 sc1
    s_branch L_mrgd
L_mw1:
    s_mov_b32 s100, 0
Lw_39:
    ds_read_b32 v4, v6 offset:8
    s_waitcnt lgkmcnt(0)
    v_readfirstlane_b32 s99, v4
    s_cmp_ge_u32 s99, 1
    s_cbranch_scc1 Lwd_40
    s_add_u32 s100, s100, 1
    s_cmp_lt_u32 s100, 8388608
    s_cbranch_scc1 Lw_39
Lwd_40:
    s_branch L_mb1
L_mslow1:
    s_mov_b32 s100, 0
Lw_41:
    ds_read_b32 v4, v3 offset:64
    s_waitcnt lgkmcnt(0)
    v_readfirstlane_b32 s99, v4
    s_cmp_ge_u32 s99, s81
    s_cbranch_scc1 Lwd_42
    s_add_u32 s100, s100, 1
    s_cmp_lt_u32 s100, 8388608
    s_cbranch_scc1 Lw_41
Lwd_42:
    s_branch L_mgo1
L_mrgd:
    s_cmp_lg_u32 s3, 0
    s_cbranch_scc1 L_nogq
    s_setprio 3
    ds_read_b32 v4, v3 offset:76
    v_lshlrev_b32 v20, 2, v1
    v_add_u32 v20, 161088, v20
L_gqr:
    ds_read2_b32 v[32:33], v20 offset0:0 offset1:16
    ds_read2_b32 v[34:35], v20 offset0:32 offset1:48
    ds_read2_b32 v[36:37], v20 offset0:64 offset1:80
    v_lshlrev_b32 v40, 16, v8
    v_and_b32 v41, 0xffff0000, v8
    v_lshlrev_b32 v42, 16, v9
    v_and_b32 v43, 0xffff0000, v9
    v_lshlrev_b32 v44, 16, v10
    v_and_b32 v45, 0xffff0000, v10
    v_lshlrev_b32 v46, 16, v11
    v_and_b32 v47, 0xffff0000, v11
    v_lshlrev_b32 v48, 16, v14
    v_and_b32 v49, 0xffff0000, v14
    v_lshlrev_b32 v50, 16, v15
    v_and_b32 v51, 0xffff0000, v15
    v_lshlrev_b32 v52, 16, v160
    v_and_b32 v53, 0xffff0000, v160
    v_lshlrev_b32 v54, 16, v161
    v_and_b32 v55, 0xffff0000, v161
    v_lshlrev_b32 v56, 16, v162
    v_and_b32 v57, 0xffff0000, v162
    v_lshlrev_b32 v58, 16, v163
    v_and_b32 v59, 0xffff0000, v163
    v_lshlrev_b32 v60, 16, v164
    v_and_b32 v61, 0xffff0000, v164
    v_lshlrev_b32 v62, 16, v165
    v_and_b32 v63, 0xffff0000, v165
    s_waitcnt lgkmcnt(0)
    v_readfirstlane_b32 s67, v4
    v_mul_f32 v40, v32, v40
    v_mul_f32 v41, v32, v41
    v_mul_f32 v42, v32, v42
    v_mul_f32 v43, v32, v43
    v_mul_f32 v44, v33, v44
    v_mul_f32 v45, v33, v45
    v_mul_f32 v46, v33, v46
    v_mul_f32 v47, v33, v47
    v_mul_f32 v48, v34, v48
    v_mul_f32 v49, v34, v49
    v_mul_f32 v50, v34, v50
    v_mul_f32 v51, v34, v51
    v_mul_f32 v52, v35, v52
    v_mul_f32 v53, v35, v53
    v_mul_f32 v54, v35, v54
    v_mul_f32 v55, v35, v55
    v_mul_f32 v56, v36, v56
    v_mul_f32 v57, v36, v57
    v_mul_f32 v58, v36, v58
    v_mul_f32 v59, v36, v59
    v_mul_f32 v60, v37, v60
    v_mul_f32 v61, v37, v61
    v_mul_f32 v62, v37, v62
    v_mul_f32 v63, v37, v63
    s_cmp_eq_u32 s67, 2
    s_cbranch_scc1 L_gqd
    s_lshl_b32 s96, s40, 10
    s_add_u32 s96, s96, 133632
    v_add_u32 v21, s96, v12
    s_lshr_b32 s96, s40, 1
    s_lshl_b32 s96, s96, 2
    v_add_u32 v22, s96, v3
    s_mul_i32 s96, s33, 2176
    s_mul_i32 s100, s32, 21760
    s_add_u32 s96, s96, s100
    s_add_u32 s96, s96, 262144
    s_lshl_b32 s97, s40, 7
    s_add_u32 s96, s96, s97
    s_add_u32 s56, s28, s96
    s_addc_u32 s57, s29, 0
    s_xor_b32 s96, s40, 1
    s_lshl_b32 s96, s96, 12
    s_add_u32 m0, s96, 116736
    s_lshl2_add_u32 s66, s33, s40
    s_lshl_b32 s66, s66, 16
    s_mul_i32 s96, s32, 192
    s_add_u32 s66, s66, s96
    s_add_u32 s66, s66, 3670016
    s_setprio 3
L_nogq:
    v_mul_u32_u24 v5, 21760, v0
    v_add_u32 v5, s82, v5
    v_mov_b32 v6, s31
    s_waitcnt vmcnt(0)
    v_mov_b32 v4, 1
    s_mov_b64 exec, 1
    ds_add_rtn_u32 v4, v3, v4 offset:28
    s_waitcnt lgkmcnt(0)
    v_readfirstlane_b32 s98, v4
    s_mov_b64 exec, -1
    s_cmp_lg_u32 s98, 3
    s_cbranch_scc1 L_ynosig
    s_mov_b64 exec, 0x3fffff
    global_atomic_swap v5, v6, s[28:29] sc1
    s_mov_b64 exec, -1
L_ynosig:
    s_and_b32 s96, s63, 7
    s_or_b32 s96, s96, s40
    s_cbranch_scc1 L_noep
    s_mov_b32 s96, 1
    s_atomic_add s96, s[26:27], 0 glc
    s_waitcnt lgkmcnt(0)
    s_cmp_lg_u32 s96, 39
    s_cbranch_scc1 Lep_43
    s_atomic_swap s31, s[28:29], 0
Lep_43:
L_noep:
    s_cmp_lg_u32 s3, 0
    s_cbranch_scc1 L_cexit
    s_mov_b32 s100, 0
L_yp:
    s_add_u32 s100, s100, 1
    s_cmp_ge_u32 s100, 1048576
    s_cbranch_scc1 L_ypd
    s_load_dwordx16 s[4:19], s[56:57], 0 glc
    s_waitcnt lgkmcnt(0)
    s_cmp_lg_u32 s4, s31
    s_cbranch_scc1 L_yp
    s_cmp_lg_u32 s6, s31
    s_cbranch_scc1 L_yp
    s_cmp_lg_u32 s8, s31
    s_cbranch_scc1 L_yp
    s_cmp_lg_u32 s10, s31
    s_cbranch_scc1 L_yp
    s_cmp_lg_u32 s12, s31
    s_cbranch_scc1 L_yp
    s_cmp_lg_u32 s14, s31
    s_cbranch_scc1 L_yp
    s_cmp_lg_u32 s16, s31
    s_cbranch_scc1 L_yp
    s_cmp_lg_u32 s18, s31
    s_cbranch_scc1 L_yp
L_ypd:
    buffer_load_dwordx4 v144, s[44:47], s66 offen sc1 lds
    s_add_u32 m0, m0, 1024
    s_nop 0
    buffer_load_dwordx4 v145, s[44:47], s66 offen sc1 lds
    s_add_u32 m0, m0, 1024
    s_nop 0
    buffer_load_dwordx4 v146, s[44:47], s66 offen sc1 lds
    s_mov_b32 s100, 0
Lw_44:
    ds_read_b32 v4, v3 offset:28
    s_waitcnt lgkmcnt(0)
    v_readfirstlane_b32 s99, v4
    s_cmp_ge_u32 s99, 4
    s_cbranch_scc1 Lwd_45
    s_add_u32 s100, s100, 1
    s_cmp_lt_u32 s100, 8388608
    s_cbranch_scc1 Lw_44
Lwd_45:
    s_cmp_lg_u32 s67, 0
    s_cbranch_scc1 L_gqd
    s_mov_b32 s100, 0
Lw_46:
    ds_read_b32 v4, v3 offset:76
    s_waitcnt lgkmcnt(0)
    v_readfirstlane_b32 s99, v4
    s_cmp_ge_u32 s99, 1
    s_cbranch_scc1 Lwd_47
    s_sleep 1
    s_add_u32 s100, s100, 1
    s_cmp_lt_u32 s100, 8388608
    s_cbranch_scc1 Lw_46
Lwd_47:
    v_mov_b32 v4, 2
    s_branch L_gqr
L_gqd:
    v_mov_b32 v4, 1
    s_waitcnt vmcnt(0)
    ds_read_b64_tr_b16 v[64:65], v147 offset:0
    ds_read_b64_tr_b16 v[66:67], v147 offset:32
    ds_read_b64_tr_b16 v[68:69], v147 offset:64
    ds_read_b64_tr_b16 v[70:71], v147 offset:96
    ds_read_b64_tr_b16 v[72:73], v147 offset:128
    ds_read_b64_tr_b16 v[74:75], v147 offset:160
    s_waitcnt lgkmcnt(5)
    v_lshlrev_b32 v80, 16, v64
    v_and_b32 v81, 0xffff0000, v64
    v_lshlrev_b32 v82, 16, v65
    v_and_b32 v83, 0xffff0000, v65
    v_mul_f32 v40, v40, v80
    v_mul_f32 v41, v41, v81
    v_mul_f32 v42, v42, v82
    v_mul_f32 v43, v43, v83
    ds_write_b128 v21, v[40:43] offset:0
    s_waitcnt lgkmcnt(5)
    v_lshlrev_b32 v84, 16, v66
    v_and_b32 v85, 0xffff0000, v66
    v_lshlrev_b32 v86, 16, v67
    v_and_b32 v87, 0xffff0000, v67
    v_mul_f32 v44, v44, v84
    v_mul_f32 v45, v45, v85
    v_mul_f32 v46, v46, v86
    v_mul_f32 v47, v47, v87
    ds_write_b128 v21, v[44:47] offset:4096
    s_waitcnt lgkmcnt(5)
    v_lshlrev_b32 v88, 16, v68
    v_and_b32 v89, 0xffff0000, v68
    v_lshlrev_b32 v90, 16, v69
    v_and_b32 v91, 0xffff0000, v69
    v_mul_f32 v48, v48, v88
    v_mul_f32 v49, v49, v89
    v_mul_f32 v50, v50, v90
    v_mul_f32 v51, v51, v91
    ds_write_b128 v21, v[48:51] offset:8192
    s_waitcnt lgkmcnt(5)
    v_lshlrev_b32 v92, 16, v70
    v_and_b32 v93, 0xffff0000, v70
    v_lshlrev_b32 v94, 16, v71
    v_and_b32 v95, 0xffff0000, v71
    v_mul_f32 v52, v52, v92
    v_mul_f32 v53, v53, v93
    v_mul_f32 v54, v54, v94
    v_mul_f32 v55, v55, v95
    ds_write_b128 v21, v[52:55] offset:12288
    s_waitcnt lgkmcnt(5)
    v_lshlrev_b32 v96, 16, v72
    v_and_b32 v97, 0xffff0000, v72
    v_lshlrev_b32 v98, 16, v73
    v_and_b32 v99, 0xffff0000, v73
    v_mul_f32 v56, v56, v96
    v_mul_f32 v57, v57, v97
    v_mul_f32 v58, v58, v98
    v_mul_f32 v59, v59, v99
    ds_write_b128 v21, v[56:59] offset:16384
    s_waitcnt lgkmcnt(5)
    v_lshlrev_b32 v100, 16, v74
    v_and_b32 v101, 0xffff0000, v74
    v_lshlrev_b32 v102, 16, v75
    v_and_b32 v103, 0xffff0000, v75
    v_mul_f32 v60, v60, v100
    v_mul_f32 v61, v61, v101
    v_mul_f32 v62, v62, v102
    v_mul_f32 v63, v63, v103
    ds_write_b128 v21, v[60:63] offset:20480
    s_mov_b64 exec, 1
    ds_add_u32 v22, v4 offset:112
L_cexit:
    s_endpgm
L_idle:
    s_and_b32 s97, s35, 3
    s_lshl3_add_u32 s96, s97, s30
    s_sub_u32 s96, s96, 4
    v_lshlrev_b32 v4, 7, v0
    v_lshlrev_b32 v5, 10, v0
    s_waitcnt lgkmcnt(0)
    s_mov_b32 s44, s28
    s_and_b32 s45, s29, 0xffff
    s_mov_b32 s46, 1048576
    s_mov_b32 s47, 0x00020000
    s_cmp_lg_u32 s96, 31
    s_cbranch_scc1 L_idl2
    s_mov_b32 s98, 77824
    s_mov_b64 exec, 0xfffffff
    buffer_load_dword v8, v5, s[44:47], s98 offen sc1
    s_mov_b64 exec, -1
L_idl2:
    s_cmp_gt_u32 s96, 1
    s_cbranch_scc1 L_idl3
    s_lshl_b32 s98, s96, 13
    s_add_u32 s98, s98, 65536
    buffer_load_dword v8, v4, s[44:47], s98 offen sc1
L_idl3:
    v_mul_u32_u24 v5, 21760, v2
    v_lshl_add_u32 v5, v1, 7, v5
    s_mov_b32 exec_lo, 0xff1fff1f
    s_mov_b32 exec_hi, 0xff1fff1f
    s_mul_i32 s98, s96, 43
    s_lshr_b32 s98, s98, 8
    s_mul_i32 s99, s98, 4294447232
    s_mul_i32 s98, s96, 87040
    s_add_u32 s98, s98, s99
    s_add_u32 s98, s98, 262144
    buffer_load_dword v9, v5, s[44:47], s98 offen sc1
    s_add_u32 s96, s96, 32
    s_min_u32 s96, s96, 59
    s_mul_i32 s98, s96, 43
    s_lshr_b32 s98, s98, 8
    s_mul_i32 s99, s98, 4294447232
    s_mul_i32 s98, s96, 87040
    s_add_u32 s98, s98, s99
    s_add_u32 s98, s98, 262144
    buffer_load_dword v10, v5, s[44:47], s98 offen sc1
    s_add_u32 s96, s96, 32
    s_min_u32 s96, s96, 59
    s_branch L_cexit
L_hg:
    v_mov_b32 v3, 160960
    s_mov_b32 s101, 0
    s_waitcnt lgkmcnt(0)
    s_cmp_ge_u32 s30, 4
    s_cbranch_scc1 L_ps
    v_mov_b32 v6, 0
    v_and_b32 v5, 31, v0
    v_lshl_add_u32 v5, v5, 2, v3
    ds_write_b32 v5, v6
    v_lshrrev_b32 v5, 1, v1
    v_xor_b32 v5, v5, v2
    v_lshlrev_b32 v5, 4, v5
    v_lshl_add_u32 v5, v1, 7, v5
    s_add_u32 s96, s33, 1
    s_min_u32 s96, s96, 6
    s_lshl_b32 s96, s96, 11
    v_add_u32 v15, s96, v5
    v_lshlrev_b32 v16, 4, v2
    v_add_u32 v16, 159488, v16
    v_mov_b32 v20, 0
    v_mov_b32 v21, 0
    v_mov_b32 v22, 0
    v_mov_b32 v23, 0
    v_lshlrev_b32 v17, 4, v0
    s_waitcnt lgkmcnt(0)
    s_mov_b32 s40, s22
    s_and_b32 s41, s23, 0xffff
    s_mov_b32 s42, 1280
    s_mov_b32 s43, 0x00020000
    s_mov_b32 m0, 159488
    s_nop 0
    buffer_load_dwordx4 v17, s[40:43], 0 offen lds
    s_mov_b64 exec, 0xffff
    buffer_load_dwordx4 v17, s[40:43], 0 offen offset:1024 lds
    s_mov_b64 exec, -1
    v_lshrrev_b32 v4, 3, v0
    v_and_b32 v5, 7, v0
    v_mul_u32_u24 v4, 1280, v4
    v_lshlrev_b32 v6, 1, v2
    v_xor_b32 v5, v5, v6
    v_lshl_add_u32 v4, v5, 4, v4
    s_lshl_b32 s96, s33, 7
    v_add_u32 v8, s96, v4
    v_lshrrev_b32 v4, 5, v0
    v_mul_u32_u24 v5, 20480, v4
    v_add_u32 v9, v8, v5
    v_mul_u32_u24 v5, 71680, v4
    v_add_u32 v10, v8, v5
    v_mul_u32_u24 v5, 327680, v4
    v_add_u32 v11, v8, v5
    s_mov_b32 s40, s20
    s_and_b32 s41, s21, 0xffff
    s_mov_b32 s42, 819200
    s_mov_b32 s43, 0x00020000
    s_mov_b32 s44, s28
    s_and_b32 s45, s29, 0xffff
    s_mov_b32 s46, 16777216
    s_mov_b32 s47, 0x00020000
    s_load_dword s31, s[28:29], 0
    s_mov_b32 s51, 0
    s_mov_b32 s52, 0
    s_and_b32 s53, s38, 15
    s_lshr_b64 s[38:39], s[38:39], 4
    s_lshl_b32 s53, s53, 7
    s_barrier
    s_waitcnt vmcnt(0)
L_hl:
    s_cmp_gt_u32 s33, 5
    s_cbranch_scc1 L_hng
    v_add_u32 v12, s52, v15
    v_add_u32 v14, s53, v16
    v_xor_b32 v13, 64, v12
    ds_read_b128 v[24:27], v12
    ds_read_b128 v[32:35], v14 offset:0
    ds_read_b128 v[28:31], v13
    ds_read_b128 v[36:39], v14 offset:64
    s_waitcnt lgkmcnt(0)
    v_mfma_f32_16x16x32_bf16 v[20:23], v[32:35], v[24:27], v[20:23]
    v_mfma_f32_16x16x32_bf16 v[20:23], v[36:39], v[28:31], v[20:23]
L_hng:
    s_waitcnt lgkmcnt(0)
    s_add_u32 s52, s52, 38912
    s_cmp_eq_u32 s52, 116736
    s_cselect_b32 s52, 0, s52
    s_and_b32 s53, s38, 15
    s_lshr_b64 s[38:39], s[38:39], 4
    s_lshl_b32 s53, s53, 7
    s_cmp_lg_u32 s51, 9
    s_cbranch_scc1 L_hnw
    s_lshr_b32 s96, s2, 3
    s_mul_i32 s96, s96, 30720
    s_and_b32 s97, s2, 1
    s_mul_i32 s97, s97, 640
    s_add_u32 s96, s96, s97
    v_mul_u32_u24 v5, 13108, v0
    v_lshrrev_b32 v5, 16, v5
    v_mul_u32_u24 v5, 640, v5
    v_lshl_add_u32 v5, v0, 7, v5
    s_add_u32 s97, s96, 15360
    s_mov_b32 exec_hi, 0xfffffff
    buffer_load_dword v40, v5, s[40:43], s96 offen
    buffer_load_dword v41, v5, s[40:43], s97 offen
    s_mov_b64 exec, -1
L_hnw:
    s_add_u32 s51, s51, 1
    s_cmp_ge_u32 s51, 10
    s_cbranch_scc1 L_hld
    s_barrier
    s_branch L_hl
L_hld:
    s_mul_i32 s31, s31, 1664525
    s_add_u32 s31, s31, 1013904223
    v_mov_b32 v24, s31
    s_mul_i32 s54, s32, 768
    s_add_u32 s54, s54, 131072
    v_lshlrev_b32 v26, 3, v0
    s_cmp_gt_u32 s33, 5
    s_cbranch_scc1 L_hgd
    v_cvt_pk_bf16_f32 v25, v20, v20
    v_and_b32 v25, 0xffff0000, v25
    v_mul_f32 v25, 0xbfb8aa3b, v25
    v_exp_f32 v25, v25
    s_nop 0
    v_add_f32 v25, 1.0, v25
    v_rcp_f32 v25, v25
    s_nop 0
    v_cvt_pk_bf16_f32 v25, v25, v25
    v_and_b32 v25, 0xffff0000, v25
    s_lshl_b32 s96, s33, 7
    s_add_u32 s96, s96, s54
    s_mov_b64 exec, 0xffff
    buffer_store_dwordx2 v[24:25], v26, s[44:47], s96 offen sc1
    s_mov_b64 exec, -1
L_hgd:
    s_setprio 1
    s_barrier
    s_sub_u32 s96, 0, s34
    s_cselect_b32 s97, 5, 0
    s_add_u32 s96, s96, s97
    s_lshl_b32 m0, s96, 12
    s_mov_b32 s96, 0
    buffer_load_dwordx4 v8, s[40:43], s96 offen offset:0 lds
    s_mov_b32 s96, 24576
    buffer_load_dwordx4 v8, s[40:43], s96 offen offset:1024 lds
    s_mov_b32 s96, 8192
    buffer_load_dwordx4 v8, s[40:43], s96 offen offset:2048 lds
    s_mov_b32 s96, 32768
    buffer_load_dwordx4 v8, s[40:43], s96 offen offset:3072 lds
    s_sub_u32 s96, 1, s34
    s_cselect_b32 s97, 5, 0
    s_add_u32 s96, s96, s97
    s_lshl_b32 m0, s96, 12
    s_mov_b32 s96, 102400
    buffer_load_dwordx4 v8, s[40:43], s96 offen offset:0 lds
    s_mov_b32 s96, 126976
    buffer_load_dwordx4 v8, s[40:43], s96 offen offset:1024 lds
    s_mov_b32 s96, 110592
    buffer_load_dwordx4 v8, s[40:43], s96 offen offset:2048 lds
    s_mov_b32 s96, 135168
    buffer_load_dwordx4 v8, s[40:43], s96 offen offset:3072 lds
    s_sub_u32 s96, 2, s34
    s_cselect_b32 s97, 5, 0
    s_add_u32 s96, s96, s97
    s_lshl_b32 m0, s96, 12
    s_mov_b32 s96, 179200
    buffer_load_dwordx4 v8, s[40:43], s96 offen offset:0 lds
    s_mov_b32 s96, 203776
    buffer_load_dwordx4 v8, s[40:43], s96 offen offset:1024 lds
    s_mov_b32 s96, 187392
    buffer_load_dwordx4 v8, s[40:43], s96 offen offset:2048 lds
    s_mov_b32 s96, 211968
    buffer_load_dwordx4 v8, s[40:43], s96 offen offset:3072 lds
    s_sub_u32 s96, 3, s34
    s_cselect_b32 s97, 5, 0
    s_add_u32 s96, s96, s97
    s_lshl_b32 m0, s96, 12
    s_mov_b32 s96, 256000
    buffer_load_dwordx4 v8, s[40:43], s96 offen offset:0 lds
    s_mov_b32 s96, 280576
    buffer_load_dwordx4 v8, s[40:43], s96 offen offset:1024 lds
    s_mov_b32 s96, 264192
    buffer_load_dwordx4 v8, s[40:43], s96 offen offset:2048 lds
    s_mov_b32 s96, 288768
    buffer_load_dwordx4 v8, s[40:43], s96 offen offset:3072 lds
    s_sub_u32 s96, 4, s34
    s_cselect_b32 s97, 5, 0
    s_add_u32 s96, s96, s97
    s_lshl_b32 m0, s96, 12
    s_mov_b32 s96, 332800
    buffer_load_dwordx4 v8, s[40:43], s96 offen offset:0 lds
    s_mov_b32 s96, 357376
    buffer_load_dwordx4 v8, s[40:43], s96 offen offset:1024 lds
    s_mov_b32 s96, 340992
    buffer_load_dwordx4 v8, s[40:43], s96 offen offset:2048 lds
    s_mov_b32 s96, 365568
    buffer_load_dwordx4 v8, s[40:43], s96 offen offset:3072 lds
    s_mov_b32 m0, 20480
    s_mov_b32 s96, 20480
    buffer_load_dwordx4 v9, s[40:43], s96 offen offset:0 lds
    s_mov_b32 s96, 121856
    buffer_load_dwordx4 v9, s[40:43], s96 offen offset:1024 lds
    s_mov_b32 s96, 197632
    buffer_load_dwordx4 v9, s[40:43], s96 offen offset:2048 lds
    s_mov_b32 s96, 273408
    buffer_load_dwordx4 v9, s[40:43], s96 offen offset:3072 lds
    s_mov_b32 m0, 61440
    s_mov_b32 s96, 430080
    buffer_load_dwordx4 v9, s[40:43], s96 offen offset:0 lds
    s_mov_b32 s96, 531456
    buffer_load_dwordx4 v9, s[40:43], s96 offen offset:1024 lds
    s_mov_b32 s96, 607232
    buffer_load_dwordx4 v9, s[40:43], s96 offen offset:2048 lds
    s_mov_b32 s96, 683008
    buffer_load_dwordx4 v9, s[40:43], s96 offen offset:3072 lds
    s_mov_b32 m0, 24576
    s_mov_b32 s96, 51200
    buffer_load_dwordx4 v8, s[40:43], s96 offen offset:0 lds
    s_mov_b32 s96, 382976
    buffer_load_dwordx4 v8, s[40:43], s96 offen offset:1024 lds
    s_mov_b32 s96, 59392
    buffer_load_dwordx4 v8, s[40:43], s96 offen offset:2048 lds
    s_mov_b32 s96, 391168
    buffer_load_dwordx4 v8, s[40:43], s96 offen offset:3072 lds
    s_mov_b32 m0, 65536
    s_mov_b32 s96, 460800
    buffer_load_dwordx4 v8, s[40:43], s96 offen offset:0 lds
    s_mov_b32 s96, 792576
    buffer_load_dwordx4 v8, s[40:43], s96 offen offset:1024 lds
    s_mov_b32 s96, 468992
    buffer_load_dwordx4 v8, s[40:43], s96 offen offset:2048 lds
    s_mov_b32 s96, 800768
    buffer_load_dwordx4 v8, s[40:43], s96 offen offset:3072 lds
    s_mov_b32 m0, 28672
    s_mov_b32 s96, 76800
    buffer_load_dwordx4 v8, s[40:43], s96 offen offset:0 lds
    s_mov_b32 s96, 152576
    buffer_load_dwordx4 v8, s[40:43], s96 offen offset:1024 lds
    s_mov_b32 s96, 84992
    buffer_load_dwordx4 v8, s[40:43], s96 offen offset:2048 lds
    s_mov_b32 s96, 160768
    buffer_load_dwordx4 v8, s[40:43], s96 offen offset:3072 lds
    s_mov_b32 m0, 69632
    s_mov_b32 s96, 486400
    buffer_load_dwordx4 v8, s[40:43], s96 offen offset:0 lds
    s_mov_b32 s96, 562176
    buffer_load_dwordx4 v8, s[40:43], s96 offen offset:1024 lds
    s_mov_b32 s96, 494592
    buffer_load_dwordx4 v8, s[40:43], s96 offen offset:2048 lds
    s_mov_b32 s96, 570368
    buffer_load_dwordx4 v8, s[40:43], s96 offen offset:3072 lds
    s_mov_b32 m0, 32768
    s_mov_b32 s96, 230400
    buffer_load_dwordx4 v8, s[40:43], s96 offen offset:0 lds
    s_mov_b32 s96, 306176
    buffer_load_dwordx4 v8, s[40:43], s96 offen offset:1024 lds
    s_mov_b32 s96, 238592
    buffer_load_dwordx4 v8, s[40:43], s96 offen offset:2048 lds
    s_mov_b32 s96, 314368
    buffer_load_dwordx4 v8, s[40:43], s96 offen offset:3072 lds
    s_mov_b32 m0, 73728
    s_mov_b32 s96, 640000
    buffer_load_dwordx4 v8, s[40:43], s96 offen offset:0 lds
    s_mov_b32 s96, 715776
    buffer_load_dwordx4 v8, s[40:43], s96 offen offset:1024 lds
    s_mov_b32 s96, 648192
    buffer_load_dwordx4 v8, s[40:43], s96 offen offset:2048 lds
    s_mov_b32 s96, 723968
    buffer_load_dwordx4 v8, s[40:43], s96 offen offset:3072 lds
    s_mov_b32 m0, 36864
    s_mov_b32 s96, 353280
    buffer_load_dwordx4 v9, s[40:43], s96 offen offset:0 lds
    s_mov_b32 s96, 70656
    buffer_load_dwordx4 v11, s[40:43], s96 offen offset:1024 lds
    s_mov_b32 s96, 95232
    buffer_load_dwordx4 v10, s[40:43], s96 offen offset:2048 lds
    s_mov_b32 s96, 247808
    buffer_load_dwordx4 v10, s[40:43], s96 offen offset:3072 lds
    s_mov_b32 m0, 77824
    s_mov_b32 s96, 762880
    buffer_load_dwordx4 v9, s[40:43], s96 offen offset:0 lds
    s_mov_b32 s96, 480256
    buffer_load_dwordx4 v11, s[40:43], s96 offen offset:1024 lds
    s_mov_b32 s96, 504832
    buffer_load_dwordx4 v10, s[40:43], s96 offen offset:2048 lds
    s_mov_b32 s96, 657408
    buffer_load_dwordx4 v10, s[40:43], s96 offen offset:3072 lds
    v_lshlrev_b32 v27, 2, v0
    v_add_u32 v27, 161088, v27
    s_waitcnt vmcnt(0)
    v_mov_b32 v4, 1
    s_mov_b64 exec, 1
    ds_add_u32 v3, v4 offset:4
    s_mov_b64 exec, -1
    s_mov_b32 s100, 0
    v_mov_b32 v30, s31
L_gp:
    buffer_load_dwordx2 v[28:29], v26, s[44:47], s54 offen sc1
    s_mov_b32 exec_hi, 0
    buffer_load_dwordx2 v[30:31], v26, s[44:47], s54 offen offset:512 sc1
    s_mov_b32 exec_hi, -1
    s_waitcnt vmcnt(0)
    v_cmp_ne_u32 vcc, s31, v28
    v_cmp_ne_u32 s[56:57], s31, v30
    s_or_b64 vcc, vcc, s[56:57]
    s_cbranch_scc0 L_gpd
    s_sleep 8
    s_add_u32 s100, s100, 1
    s_cmp_lt_u32 s100, 1048576
    s_cbranch_scc1 L_gp
L_gpd:
    ds_write_b32 v27, v29
    s_mov_b32 exec_hi, 0
    ds_write_b32 v27, v31 offset:256
    s_mov_b32 exec_hi, -1
    v_mov_b32 v4, 1
    ds_write_b32 v3, v4 offset:12
    s_mul_i32 s96, s33, 2176
    s_mul_i32 s100, s32, 21760
    s_add_u32 s96, s96, s100
    s_add_u32 s96, s96, 263808
    s_add_u32 s48, s28, s96
    s_addc_u32 s49, s29, 0
    s_mov_b32 s50, 0
    s_mov_b32 s100, 0
    v_mov_b32 v5, 1
Lrl_48:
    s_load_dwordx8 s[4:11], s[48:49], 0 glc
    s_load_dwordx8 s[12:19], s[48:49], 256 glc
    s_waitcnt lgkmcnt(0)
    s_cmp_lg_u32 s4, s31
    s_cbranch_scc1 Lrn_50
    s_cmp_lg_u32 s6, s31
    s_cbranch_scc1 Lrn_50
    s_cmp_lg_u32 s8, s31
    s_cbranch_scc1 Lrn_50
    s_cmp_lg_u32 s10, s31
    s_cbranch_scc1 Lrn_50
    s_bitcmp1_b32 s50, 0
    s_cbranch_scc1 Lrn_50
    ds_write_b32 v3, v5 offset:88
    s_bitset1_b32 s50, 0
Lrn_50:
    s_cmp_lg_u32 s12, s31
    s_cbranch_scc1 Lrn_51
    s_cmp_lg_u32 s14, s31
    s_cbranch_scc1 Lrn_51
    s_cmp_lg_u32 s16, s31
    s_cbranch_scc1 Lrn_51
    s_cmp_lg_u32 s18, s31
    s_cbranch_scc1 Lrn_51
    s_bitcmp1_b32 s50, 1
    s_cbranch_scc1 Lrn_51
    ds_write_b32 v3, v5 offset:92
    s_bitset1_b32 s50, 1
Lrn_51:
    s_cmp_eq_u32 s50, 3
    s_cbranch_scc1 Lrd_49
    s_add_u32 s100, s100, 1
    s_cmp_lt_u32 s100, 1048576
    s_cbranch_scc1 Lrl_48
Lrd_49:
    s_endpgm
L_s0:
    s_mul_i32 s31, s31, 1664525
    s_add_u32 s31, s31, 1013904223
    s_mov_b32 s44, s28
    s_and_b32 s45, s29, 0xffff
    s_mov_b32 s46, 16777216
    s_mov_b32 s47, 0x00020000
    v_lshrrev_b32 v4, 3, v0
    v_and_b32 v5, 7, v0
    v_mul_u32_u24 v4, 1280, v4
    v_lshlrev_b32 v6, 1, v2
    v_xor_b32 v5, v5, v6
    v_lshl_add_u32 v4, v5, 4, v4
    s_lshl_b32 s96, s33, 7
    v_add_u32 v8, s96, v4
    v_lshrrev_b32 v4, 5, v0
    v_mul_u32_u24 v5, 20480, v4
    v_add_u32 v9, v8, v5
    v_mul_u32_u24 v5, 71680, v4
    v_add_u32 v10, v8, v5
    v_mul_u32_u24 v5, 327680, v4
    v_add_u32 v11, v8, v5
    s_mov_b32 s40, s20
    s_and_b32 s41, s21, 0xffff
    s_mov_b32 s42, 819200
    s_mov_b32 s43, 0x00020000
    v_lshlrev_b32 v17, 4, v0
    s_waitcnt vmcnt(0)
    s_barrier
    s_mul_i32 s96, s33, 2176
    s_mul_i32 s100, s32, 21760
    s_add_u32 s96, s96, s100
    s_add_u32 s96, s96, 262656
    s_add_u32 s48, s28, s96
    s_addc_u32 s49, s29, 0
    s_lshl_b32 s52, s33, 5
    s_add_u32 s52, s52, s32
    s_mul_i32 s52, s52, 10240
    s_add_u32 s52, s52, 8781824
    s_setprio 3
    s_barrier
    s_sub_u32 s96, 0, s34
    s_cselect_b32 s97, 15, 10
    s_add_u32 s96, s96, s97
    s_lshl_b32 m0, s96, 12
    s_mov_b32 s96, 409600
    buffer_load_dwordx4 v8, s[40:43], s96 offen offset:0 lds
    s_mov_b32 s96, 434176
    buffer_load_dwordx4 v8, s[40:43], s96 offen offset:1024 lds
    s_mov_b32 s96, 417792
    buffer_load_dwordx4 v8, s[40:43], s96 offen offset:2048 lds
    s_mov_b32 s96, 442368
    buffer_load_dwordx4 v8, s[40:43], s96 offen offset:3072 lds
    s_sub_u32 s96, 1, s34
    s_cselect_b32 s97, 15, 10
    s_add_u32 s96, s96, s97
    s_lshl_b32 m0, s96, 12
    s_mov_b32 s96, 512000
    buffer_load_dwordx4 v8, s[40:43], s96 offen offset:0 lds
    s_mov_b32 s96, 536576
    buffer_load_dwordx4 v8, s[40:43], s96 offen offset:1024 lds
    s_mov_b32 s96, 520192
    buffer_load_dwordx4 v8, s[40:43], s96 offen offset:2048 lds
    s_mov_b32 s96, 544768
    buffer_load_dwordx4 v8, s[40:43], s96 offen offset:3072 lds
    s_sub_u32 s96, 2, s34
    s_cselect_b32 s97, 15, 10
    s_add_u32 s96, s96, s97
    s_lshl_b32 m0, s96, 12
    s_mov_b32 s96, 588800
    buffer_load_dwordx4 v8, s[40:43], s96 offen offset:0 lds
    s_mov_b32 s96, 613376
    buffer_load_dwordx4 v8, s[40:43], s96 offen offset:1024 lds
    s_mov_b32 s96, 596992
    buffer_load_dwordx4 v8, s[40:43], s96 offen offset:2048 lds
    s_mov_b32 s96, 621568
    buffer_load_dwordx4 v8, s[40:43], s96 offen offset:3072 lds
    s_sub_u32 s96, 3, s34
    s_cselect_b32 s97, 15, 10
    s_add_u32 s96, s96, s97
    s_lshl_b32 m0, s96, 12
    s_mov_b32 s96, 665600
    buffer_load_dwordx4 v8, s[40:43], s96 offen offset:0 lds
    s_mov_b32 s96, 690176
    buffer_load_dwordx4 v8, s[40:43], s96 offen offset:1024 lds
    s_mov_b32 s96, 673792
    buffer_load_dwordx4 v8, s[40:43], s96 offen offset:2048 lds
    s_mov_b32 s96, 698368
    buffer_load_dwordx4 v8, s[40:43], s96 offen offset:3072 lds
    s_sub_u32 s96, 4, s34
    s_cselect_b32 s97, 15, 10
    s_add_u32 s96, s96, s97
    s_lshl_b32 m0, s96, 12
    s_mov_b32 s96, 742400
    buffer_load_dwordx4 v8, s[40:43], s96 offen offset:0 lds
    s_mov_b32 s96, 766976
    buffer_load_dwordx4 v8, s[40:43], s96 offen offset:1024 lds
    s_mov_b32 s96, 750592
    buffer_load_dwordx4 v8, s[40:43], s96 offen offset:2048 lds
    s_mov_b32 s96, 775168
    buffer_load_dwordx4 v8, s[40:43], s96 offen offset:3072 lds
    s_cmp_eq_u32 s34, 0
    s_cbranch_scc1 L_s0n
    s_mov_b32 s100, 0
L_xp:
    s_add_u32 s100, s100, 1
    s_cmp_ge_u32 s100, 1048576
    s_cbranch_scc1 L_xpd
    s_load_dwordx2 s[4:5], s[48:49], 0 glc
    s_waitcnt lgkmcnt(0)
    s_cmp_lg_u32 s4, s31
    s_cbranch_scc1 L_xp
L_xpd:
    s_mov_b32 m0, 81920
    s_nop 0
    buffer_load_dwordx4 v17, s[44:47], s52 offen offset:0 sc1 lds
    buffer_load_dwordx4 v17, s[44:47], s52 offen offset:1024 sc1 lds
    buffer_load_dwordx4 v17, s[44:47], s52 offen offset:2048 sc1 lds
    buffer_load_dwordx4 v17, s[44:47], s52 offen offset:3072 sc1 lds
    s_add_u32 m0, m0, 4096
    s_add_u32 s52, s52, 4096
    buffer_load_dwordx4 v17, s[44:47], s52 offen offset:0 sc1 lds
    buffer_load_dwordx4 v17, s[44:47], s52 offen offset:1024 sc1 lds
    buffer_load_dwordx4 v17, s[44:47], s52 offen offset:2048 sc1 lds
    buffer_load_dwordx4 v17, s[44:47], s52 offen offset:3072 sc1 lds
    s_add_u32 m0, m0, 4096
    s_add_u32 s52, s52, 4096
    buffer_load_dwordx4 v17, s[44:47], s52 offen offset:0 sc1 lds
    buffer_load_dwordx4 v17, s[44:47], s52 offen offset:1024 sc1 lds
L_s0n:
    s_waitcnt vmcnt(0)
    v_mov_b32 v4, 1
    ds_write_b32 v3, v4 offset:8
    v_mov_b32 v4, 1
    s_mov_b64 exec, 1
    ds_add_u32 v3, v4 offset:4
    s_mov_b64 exec, -1
    s_mul_i32 s96, s33, 2176
    s_mul_i32 s100, s32, 21760
    s_add_u32 s96, s96, s100
    s_add_u32 s96, s96, 263296
    s_add_u32 s48, s28, s96
    s_addc_u32 s49, s29, 0
    s_mov_b32 s50, 0
    s_mov_b32 s100, 0
    v_mov_b32 v5, 1
Lrl_52:
    s_load_dwordx8 s[4:11], s[48:49], 0 glc
    s_load_dwordx8 s[12:19], s[48:49], 256 glc
    s_waitcnt lgkmcnt(0)
    s_cmp_lg_u32 s4, s31
    s_cbranch_scc1 Lrn_54
    s_cmp_lg_u32 s6, s31
    s_cbranch_scc1 Lrn_54
    s_cmp_lg_u32 s8, s31
    s_cbranch_scc1 Lrn_54
    s_cmp_lg_u32 s10, s31
    s_cbranch_scc1 Lrn_54
    s_bitcmp1_b32 s50, 0
    s_cbranch_scc1 Lrn_54
    ds_write_b32 v3, v5 offset:80
    s_bitset1_b32 s50, 0
Lrn_54:
    s_cmp_lg_u32 s12, s31
    s_cbranch_scc1 Lrn_55
    s_cmp_lg_u32 s14, s31
    s_cbranch_scc1 Lrn_55
    s_cmp_lg_u32 s16, s31
    s_cbranch_scc1 Lrn_55
    s_cmp_lg_u32 s18, s31
    s_cbranch_scc1 Lrn_55
    s_bitcmp1_b32 s50, 1
    s_cbranch_scc1 Lrn_55
    ds_write_b32 v3, v5 offset:84
    s_bitset1_b32 s50, 1
Lrn_55:
    s_cmp_eq_u32 s50, 3
    s_cbranch_scc1 Lrd_53
    s_add_u32 s100, s100, 1
    s_cmp_lt_u32 s100, 1048576
    s_cbranch_scc1 Lrl_52
Lrd_53:
    s_endpgm
L_ps:
    s_cmp_ge_u32 s30, 4
    s_cselect_b32 s96, -4, 3
    s_add_u32 s60, s30, s96
    s_and_b32 s61, s60, 1
    s_and_b32 s96, s34, 3
    s_cselect_b32 s96, 4, 6
    s_cmp_ge_u32 s60, s96
    s_cselect_b32 s62, 1, 0
    v_mov_b32 v7, 0xf149f2ca
    v_lshlrev_b32 v4, 2, v2
    v_sub_u32 v4, v1, v4
    v_subrev_u32 v5, 0, v4
    v_and_b32 v5, 0x80000001, v5
    v_cmp_eq_u32 vcc, 0, v5
    s_nop 1
    v_cndmask_b32 v146, v7, 0, vcc
    v_cmp_eq_u32 vcc, 0x80000000, v5
    s_nop 1
    v_cndmask_b32 v150, v7, 0, vcc
    v_subrev_u32 v5, 1, v4
    v_and_b32 v5, 0x80000001, v5
    v_cmp_eq_u32 vcc, 0, v5
    s_nop 1
    v_cndmask_b32 v147, v7, 0, vcc
    v_cmp_eq_u32 vcc, 0x80000000, v5
    s_nop 1
    v_cndmask_b32 v151, v7, 0, vcc
    v_subrev_u32 v5, 2, v4
    v_and_b32 v5, 0x80000001, v5
    v_cmp_eq_u32 vcc, 0, v5
    s_nop 1
    v_cndmask_b32 v148, v7, 0, vcc
    v_cmp_eq_u32 vcc, 0x80000000, v5
    s_nop 1
    v_cndmask_b32 v152, v7, 0, vcc
    v_subrev_u32 v5, 3, v4
    v_and_b32 v5, 0x80000001, v5
    v_cmp_eq_u32 vcc, 0, v5
    s_nop 1
    v_cndmask_b32 v149, v7, 0, vcc
    v_cmp_eq_u32 vcc, 0x80000000, v5
    s_nop 1
    v_cndmask_b32 v153, v7, 0, vcc
    v_and_b32 v5, 1, v1
    v_lshlrev_b32 v6, 4, v5
    v_sub_u32 v5, v4, v5
    v_mov_b32 v4, 0x0c0c0c0c
    v_mov_b32 v7, 0xc0c0100
    v_alignbit_b32 v7, v7, v7, v6
    v_cmp_le_i32 vcc, 0, v5
    s_nop 1
    v_cndmask_b32 v154, v4, v7, vcc
    v_cndmask_b32 v156, v7, v4, vcc
    v_mov_b32 v7, 0xc0c0302
    v_alignbit_b32 v7, v7, v7, v6
    v_cmp_le_i32 vcc, 2, v5
    s_nop 1
    v_cndmask_b32 v155, v4, v7, vcc
    v_cndmask_b32 v157, v7, v4, vcc
    v_cmp_eq_u32 vcc, 0, v2
    s_nop 1
    v_cndmask_b32 v159, 0, -1, vcc
    s_mov_b32 s66, 0x3ea52b5c
    s_or_b32 s96, s32, s61
    s_cselect_b32 s67, 0, 0xf149f2ca
    s_mul_i32 s64, s61, 6128
    s_add_u32 s64, s64, 3080
    s_mul_i32 s65, s61, 3064
    s_add_u32 s65, s65, 6152
    s_lshl1_add_u32 s96, s32, s61
    s_mul_i32 s68, s96, 61440
    s_add_u32 s68, s68, 6356992
    s_mov_b32 s69, 0
    s_cmp_lg_u32 s101, 1
    s_cbranch_scc1 L_us
    s_waitcnt vmcnt(0)
    s_barrier
L_us:
    s_min_u32 s96, s34, 1
    s_lshr_b32 s97, s60, 1
    s_add_u32 s96, s96, s97
    s_lshl1_add_u32 s99, s34, s97
    s_lshr_b32 s98, s34, 2
    s_add_u32 s98, s98, 10
    s_cmp_ge_u32 s60, 4
    s_cselect_b32 s63, s98, s99
    s_add_u32 s98, s34, 11
    s_cmp_lg_u32 s62, 0
    s_cselect_b32 s63, s98, s63
    s_cselect_b32 s96, 0, s96
    s_add_u32 s98, s34, 10
    v_sub_u32 v4, s98, v1
    v_mul_u32_u24 v5, 52, v4
    v_lshrrev_b32 v5, 8, v5
    v_mul_u32_u24 v5, 5, v5
    v_sub_u32 v4, v4, v5
    s_sub_u32 s99, s63, 5
    s_mul_i32 s98, s62, 9
    s_add_u32 s99, s99, s98
    s_cmp_lt_u32 s60, 4
    s_cbranch_scc1 L_ufs
    v_mov_b32 v4, s99
L_ufs:
    s_and_b32 s98, s2, 1
    s_lshl4_add_u32 s63, s98, s63
    s_lshl1_add_u32 s98, s98, s61
    s_lshl_b32 s98, s98, 8
    s_mul_i32 s99, s32, 21760
    s_add_u32 s98, s98, s99
    s_add_u32 s98, s98, 263168
    v_lshl_add_u32 v4, v4, 3, s98
    v_mul_u32_u24 v164, 2176, v1
    v_add_u32 v164, v164, v4
    s_mul_i32 s96, s96, 5
    s_add_u32 s96, s96, 4
    s_sub_u32 s96, s96, s34
    s_lshl3_add_u32 s97, s61, 81920
    v_add_u32 v4, s96, v2
    v_lshrrev_b32 v5, 2, v4
    v_mul_u32_u24 v5, 9216, v5
    v_lshl_add_u32 v5, v4, 8, v5
    v_lshl_add_u32 v6, v1, 4, s97
    v_add_u32 v158, v5, v6
    s_lshl_b32 s96, s96, 2
    v_lshl_add_u32 v6, v2, 8, s97
    v_add_u32 v4, s96, v1
    v_lshrrev_b32 v5, 4, v4
    v_mul_u32_u24 v5, 9984, v5
    v_lshl_add_u32 v5, v4, 4, v5
    v_add_u32 v160, v5, v6
    s_lshr_b32 s98, s96, 4
    s_mul_i32 s98, s98, 9984
    s_lshl4_add_u32 s98, s96, s98
    s_add_u32 s98, s98, 10240
    v_and_b32 v4, 3, v1
    v_lshl_add_u32 v4, v4, 4, s98
    v_add_u32 v161, v4, v6
    s_lshl_b32 s96, s63, 9
    v_lshrrev_b32 v4, 5, v0
    v_mul_u32_u24 v4, 19968, v4
    v_lshl_add_u32 v4, v0, 4, v4
    v_add_u32 v162, s96, v4
    s_lshl_b32 s96, s63, 7
    s_add_u32 s96, s96, 16384
    v_mul_u32_u24 v4, 20480, v2
    v_lshl_add_u32 v4, v1, 3, v4
    v_add_u32 v163, s96, v4
    s_cmp_eq_u32 s101, 1
    s_cbranch_scc1 L_pb10
    s_cmp_eq_u32 s101, 2
    s_cbranch_scc1 L_upre
    s_setprio 2
    v_lshrrev_b32 v5, 1, v1
    v_xor_b32 v5, v5, v2
    v_lshlrev_b32 v5, 4, v5
    v_lshl_add_u32 v140, v1, 7, v5
    v_bfe_u32 v4, v0, 2, 2
    v_lshl_add_u32 v5, v2, 3, v4
    v_lshlrev_b32 v5, 7, v5
    v_bfe_u32 v6, v0, 3, 2
    v_xor_b32 v6, s60, v6
    v_lshl_add_u32 v5, v6, 5, v5
    v_and_b32 v6, 3, v0
    v_lshl_add_u32 v5, v6, 3, v5
    v_add_u32 v141, 14336, v5
    v_mov_b32 v8, 0
    v_mov_b32 v9, 0
    v_mov_b32 v10, 0
    v_mov_b32 v11, 0
    v_mov_b32 v12, 0
    v_mov_b32 v13, 0
    v_mov_b32 v14, 0
    v_mov_b32 v15, 0
    v_mov_b32 v16, 0
    v_mov_b32 v17, 0
    v_mov_b32 v18, 0
    v_mov_b32 v19, 0
    v_mov_b32 v20, 0
    v_mov_b32 v21, 0
    v_mov_b32 v22, 0
    v_mov_b32 v23, 0
    v_mov_b32 v24, 0
    v_mov_b32 v25, 0
    v_mov_b32 v26, 0
    v_mov_b32 v27, 0
    v_mov_b32 v28, 0
    v_mov_b32 v29, 0
    v_mov_b32 v30, 0
    v_mov_b32 v31, 0
    v_mov_b32 v32, 0
    v_mov_b32 v33, 0
    v_mov_b32 v34, 0
    v_mov_b32 v35, 0
    v_mov_b32 v36, 0
    v_mov_b32 v37, 0
    v_mov_b32 v38, 0
    v_mov_b32 v39, 0
    v_mov_b32 v40, 0
    v_mov_b32 v41, 0
    v_mov_b32 v42, 0
    v_mov_b32 v43, 0
    v_mov_b32 v44, 0
    v_mov_b32 v45, 0
    v_mov_b32 v46, 0
    v_mov_b32 v47, 0
    v_mov_b32 v48, 0
    v_mov_b32 v49, 0
    v_mov_b32 v50, 0
    v_mov_b32 v51, 0
    v_mov_b32 v52, 0
    v_mov_b32 v53, 0
    v_mov_b32 v54, 0
    v_mov_b32 v55, 0
    v_mov_b32 v56, 0
    v_mov_b32 v57, 0
    v_mov_b32 v58, 0
    v_mov_b32 v59, 0
    v_mov_b32 v60, 0
    v_mov_b32 v61, 0
    v_mov_b32 v62, 0
    v_mov_b32 v63, 0
    v_mov_b32 v64, 0
    v_mov_b32 v65, 0
    v_mov_b32 v66, 0
    v_mov_b32 v67, 0
    v_mov_b32 v68, 0
    v_mov_b32 v69, 0
    v_mov_b32 v70, 0
    v_mov_b32 v71, 0
    v_mov_b32 v72, 0
    v_mov_b32 v73, 0
    v_mov_b32 v74, 0
    v_mov_b32 v75, 0
    v_mov_b32 v76, 0
    v_mov_b32 v77, 0
    v_mov_b32 v78, 0
    v_mov_b32 v79, 0
    v_mov_b32 v80, 0
    v_mov_b32 v81, 0
    v_mov_b32 v82, 0
    v_mov_b32 v83, 0
    v_mov_b32 v84, 0
    v_mov_b32 v85, 0
    v_mov_b32 v86, 0
    v_mov_b32 v87, 0
    s_mov_b32 s41, 0
    s_mov_b32 s42, 0
    v_mov_b32 v142, v140
    v_xor_b32 v143, 64, v140
    v_mov_b32 v144, v141
    s_add_u32 s96, s60, 1
    s_mul_i32 s96, s96, 10240
    s_add_u32 s96, s96, 81920
    v_lshl_add_u32 v145, v0, 4, s96
    v_lshlrev_b32 v7, 4, v0
    s_waitcnt lgkmcnt(0)
    s_mov_b32 s44, s28
    s_and_b32 s45, s29, 0xffff
    s_mov_b32 s46, 16777216
    s_mov_b32 s47, 0x00020000
    s_lshl_b32 s97, s33, 5
    s_add_u32 s97, s97, s32
    s_mul_i32 s70, s97, 10240
    s_add_u32 s70, s70, 9109504
    s_add_u32 s71, s70, 4096
    s_add_u32 s72, s70, 8192
    s_mul_i32 s97, s33, 2176
    s_mul_i32 s100, s32, 21760
    s_add_u32 s97, s97, s100
    s_add_u32 s97, s97, 264832
    s_cmp_eq_u32 s30, 7
    s_cselect_b32 s69, s97, 0
    s_cmp_eq_u32 s34, 4
    s_cselect_b32 s69, 0, s69
    s_load_dword s31, s[28:29], 0
    s_barrier
    ds_read_b64_tr_b16 v[120:121], v144 offset:4096
    ds_read_b64_tr_b16 v[122:123], v144 offset:4608
    ds_read_b128 v[88:91], v142 offset:0
    ds_read_b64_tr_b16 v[124:125], v144 offset:8192
    ds_read_b64_tr_b16 v[126:127], v144 offset:8704
    ds_read_b128 v[92:95], v142 offset:2048
    ds_read_b64_tr_b16 v[116:117], v144 offset:0
    ds_read_b64_tr_b16 v[118:119], v144 offset:512
    ds_read_b128 v[96:99], v142 offset:4096
    ds_read_b128 v[100:103], v142 offset:6144
    ds_read_b128 v[104:107], v142 offset:8192
    ds_read_b128 v[108:111], v142 offset:10240
    ds_read_b128 v[112:115], v142 offset:12288
    s_waitcnt lgkmcnt(0)
    s_mul_i32 s31, s31, 1664525
    s_add_u32 s31, s31, 1013904223
L_gl:
    s_waitcnt lgkmcnt(10)
    v_mfma_f32_16x16x32_bf16 v[32:35], v[120:123], v[88:91], v[32:35]
    ds_read_b64_tr_b16 v[132:133], v144 offset:16384
    s_waitcnt lgkmcnt(9)
    v_mfma_f32_16x16x32_bf16 v[60:63], v[88:91], v[124:127], v[60:63]
    ds_read_b64_tr_b16 v[134:135], v144 offset:16896
    s_waitcnt lgkmcnt(9)
    v_mfma_f32_16x16x32_bf16 v[36:39], v[120:123], v[92:95], v[36:39]
    ds_read_b128 v[88:91], v143 offset:0
    v_mfma_f32_16x16x32_bf16 v[64:67], v[92:95], v[124:127], v[64:67]
    ds_read_b64_tr_b16 v[136:137], v144 offset:20480
    s_waitcnt lgkmcnt(9)
    v_mfma_f32_16x16x32_bf16 v[8:11], v[116:119], v[92:95], v[8:11]
    ds_read_b64_tr_b16 v[138:139], v144 offset:20992
    s_waitcnt lgkmcnt(9)
    v_mfma_f32_16x16x32_bf16 v[40:43], v[120:123], v[96:99], v[40:43]
    ds_read_b128 v[92:95], v143 offset:2048
    v_mfma_f32_16x16x32_bf16 v[68:71], v[96:99], v[124:127], v[68:71]
    ds_read_b64_tr_b16 v[128:129], v144 offset:12288
    v_mfma_f32_16x16x32_bf16 v[12:15], v[116:119], v[96:99], v[12:15]
    ds_read_b64_tr_b16 v[130:131], v144 offset:12800
    s_waitcnt lgkmcnt(11)
    v_mfma_f32_16x16x32_bf16 v[44:47], v[120:123], v[100:103], v[44:47]
    ds_read_b128 v[96:99], v143 offset:4096
    v_mfma_f32_16x16x32_bf16 v[72:75], v[100:103], v[124:127], v[72:75]
    v_mfma_f32_16x16x32_bf16 v[16:19], v[116:119], v[100:103], v[16:19]
    ds_read_b128 v[100:103], v143 offset:6144
    s_waitcnt lgkmcnt(12)
    v_mfma_f32_16x16x32_bf16 v[48:51], v[120:123], v[104:107], v[48:51]
    v_mfma_f32_16x16x32_bf16 v[76:79], v[104:107], v[124:127], v[76:79]
    s_add_u32 s41, s41, 38912
    v_mfma_f32_16x16x32_bf16 v[20:23], v[116:119], v[104:107], v[20:23]
    ds_read_b128 v[104:107], v143 offset:8192
    s_waitcnt lgkmcnt(12)
    v_mfma_f32_16x16x32_bf16 v[52:55], v[120:123], v[108:111], v[52:55]
    s_cmp_eq_u32 s41, 116736
    s_cselect_b32 s41, 0, s41
    v_mfma_f32_16x16x32_bf16 v[80:83], v[108:111], v[124:127], v[80:83]
    v_add_u32 v144, s41, v141
    v_mfma_f32_16x16x32_bf16 v[24:27], v[116:119], v[108:111], v[24:27]
    ds_read_b128 v[108:111], v143 offset:10240
    s_waitcnt lgkmcnt(12)
    v_mfma_f32_16x16x32_bf16 v[56:59], v[120:123], v[112:115], v[56:59]
    v_add_u32 v142, s41, v140
    v_mfma_f32_16x16x32_bf16 v[84:87], v[112:115], v[124:127], v[84:87]
    v_mfma_f32_16x16x32_bf16 v[28:31], v[116:119], v[112:115], v[28:31]
    ds_read_b128 v[112:115], v143 offset:12288
    s_waitcnt lgkmcnt(10)
    v_mfma_f32_16x16x32_bf16 v[32:35], v[132:135], v[88:91], v[32:35]
    s_waitcnt lgkmcnt(8)
    v_mfma_f32_16x16x32_bf16 v[60:63], v[88:91], v[136:139], v[60:63]
    v_xor_b32 v143, 64, v142
    s_waitcnt lgkmcnt(7)
    v_mfma_f32_16x16x32_bf16 v[36:39], v[132:135], v[92:95], v[36:39]
    s_add_u32 s42, s42, 1
    v_mfma_f32_16x16x32_bf16 v[64:67], v[92:95], v[136:139], v[64:67]
    s_waitcnt lgkmcnt(5)
    v_mfma_f32_16x16x32_bf16 v[8:11], v[128:131], v[92:95], v[8:11]
    s_waitcnt lgkmcnt(0)

    v_mfma_f32_16x16x32_bf16 v[40:43], v[132:135], v[96:99], v[40:43]
    v_mfma_f32_16x16x32_bf16 v[68:71], v[96:99], v[136:139], v[68:71]
    s_barrier
    v_mfma_f32_16x16x32_bf16 v[12:15], v[128:131], v[96:99], v[12:15]
    ds_read_b64_tr_b16 v[120:121], v144 offset:4096
    v_mfma_f32_16x16x32_bf16 v[44:47], v[132:135], v[100:103], v[44:47]
    ds_read_b64_tr_b16 v[122:123], v144 offset:4608
    v_mfma_f32_16x16x32_bf16 v[72:75], v[100:103], v[136:139], v[72:75]
    ds_read_b128 v[88:91], v142 offset:0
    v_mfma_f32_16x16x32_bf16 v[16:19], v[128:131], v[100:103], v[16:19]
    ds_read_b64_tr_b16 v[124:125], v144 offset:8192
    v_mfma_f32_16x16x32_bf16 v[48:51], v[132:135], v[104:107], v[48:51]
    ds_read_b64_tr_b16 v[126:127], v144 offset:8704
    v_mfma_f32_16x16x32_bf16 v[76:79], v[104:107], v[136:139], v[76:79]
    ds_read_b128 v[92:95], v142 offset:2048
    v_mfma_f32_16x16x32_bf16 v[20:23], v[128:131], v[104:107], v[20:23]
    ds_read_b64_tr_b16 v[116:117], v144 offset:0
    v_mfma_f32_16x16x32_bf16 v[52:55], v[132:135], v[108:111], v[52:55]
    ds_read_b64_tr_b16 v[118:119], v144 offset:512
    v_mfma_f32_16x16x32_bf16 v[80:83], v[108:111], v[136:139], v[80:83]
    ds_read_b128 v[96:99], v142 offset:4096
    v_mfma_f32_16x16x32_bf16 v[24:27], v[128:131], v[108:111], v[24:27]
    ds_read_b128 v[100:103], v142 offset:6144
    v_mfma_f32_16x16x32_bf16 v[56:59], v[132:135], v[112:115], v[56:59]
    ds_read_b128 v[104:107], v142 offset:8192
    v_mfma_f32_16x16x32_bf16 v[84:87], v[112:115], v[136:139], v[84:87]
    ds_read_b128 v[108:111], v142 offset:10240
    s_cmp_lt_u32 s42, 9
    v_mfma_f32_16x16x32_bf16 v[28:31], v[128:131], v[112:115], v[28:31]
    ds_read_b128 v[112:115], v142 offset:12288
    s_cbranch_scc1 L_gl
    s_cmp_lg_u32 s69, 0
    s_cbranch_scc1 L_lsend

    s_waitcnt lgkmcnt(10)
    v_mfma_f32_16x16x32_bf16 v[32:35], v[120:123], v[88:91], v[32:35]
    ds_read_b64_tr_b16 v[132:133], v144 offset:16384
    s_waitcnt lgkmcnt(9)
    v_mfma_f32_16x16x32_bf16 v[60:63], v[88:91], v[124:127], v[60:63]
    ds_read_b128 v[88:91], v143 offset:0
    s_waitcnt lgkmcnt(5)
    v_mfma_f32_16x16x32_bf16 v[44:47], v[120:123], v[100:103], v[44:47]
    ds_read_b64_tr_b16 v[134:135], v144 offset:16896
    v_mfma_f32_16x16x32_bf16 v[72:75], v[100:103], v[124:127], v[72:75]
    ds_read_b64_tr_b16 v[136:137], v144 offset:20480
    v_mfma_f32_16x16x32_bf16 v[16:19], v[116:119], v[100:103], v[16:19]
    ds_read_b128 v[100:103], v143 offset:6144
    v_mfma_f32_16x16x32_bf16 v[36:39], v[120:123], v[92:95], v[36:39]
    ds_read_b64_tr_b16 v[138:139], v144 offset:20992
    v_mfma_f32_16x16x32_bf16 v[64:67], v[92:95], v[124:127], v[64:67]
    ds_read_b64_tr_b16 v[128:129], v144 offset:12288
    v_mfma_f32_16x16x32_bf16 v[8:11], v[116:119], v[92:95], v[8:11]
    ds_read_b128 v[92:95], v143 offset:2048
    s_waitcnt lgkmcnt(8)
    v_mfma_f32_16x16x32_bf16 v[56:59], v[120:123], v[112:115], v[56:59]
    ds_read_b64_tr_b16 v[130:131], v144 offset:12800
    v_mfma_f32_16x16x32_bf16 v[84:87], v[112:115], v[124:127], v[84:87]
    v_mfma_f32_16x16x32_bf16 v[28:31], v[116:119], v[112:115], v[28:31]
    ds_read_b128 v[112:115], v143 offset:12288
    s_waitcnt lgkmcnt(7)
    v_mfma_f32_16x16x32_bf16 v[32:35], v[132:135], v[88:91], v[32:35]
    s_waitcnt lgkmcnt(4)
    v_mfma_f32_16x16x32_bf16 v[60:63], v[88:91], v[136:139], v[60:63]
    v_mfma_f32_16x16x32_bf16 v[44:47], v[132:135], v[100:103], v[44:47]
    v_mfma_f32_16x16x32_bf16 v[72:75], v[100:103], v[136:139], v[72:75]
    s_waitcnt lgkmcnt(1)
    v_mfma_f32_16x16x32_bf16 v[16:19], v[128:131], v[100:103], v[16:19]
    s_nop 1
    v_cvt_pk_bf16_f32 v32, v32, v33
    v_cvt_pk_bf16_f32 v33, v34, v35
    v_mfma_f32_16x16x32_bf16 v[48:51], v[120:123], v[104:107], v[48:51]
    v_cvt_pk_bf16_f32 v60, v60, v61
    v_cvt_pk_bf16_f32 v61, v62, v63
    v_mfma_f32_16x16x32_bf16 v[76:79], v[104:107], v[124:127], v[76:79]
    v_cvt_pk_bf16_f32 v34, v44, v45
    v_cvt_pk_bf16_f32 v35, v46, v47
    v_mfma_f32_16x16x32_bf16 v[20:23], v[116:119], v[104:107], v[20:23]
    ds_read_b128 v[104:107], v143 offset:8192
    ds_write_b128 v145, v[32:35] offset:3072
    s_waitcnt lgkmcnt(2)
    v_mfma_f32_16x16x32_bf16 v[56:59], v[132:135], v[112:115], v[56:59]
    v_cvt_pk_bf16_f32 v62, v72, v73
    v_cvt_pk_bf16_f32 v63, v74, v75
    v_mfma_f32_16x16x32_bf16 v[84:87], v[112:115], v[136:139], v[84:87]
    ds_write_b128 v145, v[60:63] offset:6144
    v_cvt_pk_bf16_f32 v16, v16, v17
    v_mfma_f32_16x16x32_bf16 v[28:31], v[128:131], v[112:115], v[28:31]
    v_cvt_pk_bf16_f32 v17, v18, v19
    v_mfma_f32_16x16x32_bf16 v[40:43], v[120:123], v[96:99], v[40:43]
    v_mfma_f32_16x16x32_bf16 v[68:71], v[96:99], v[124:127], v[68:71]
    v_cvt_pk_bf16_f32 v56, v56, v57
    v_cvt_pk_bf16_f32 v57, v58, v59
    v_mfma_f32_16x16x32_bf16 v[12:15], v[116:119], v[96:99], v[12:15]
    ds_read_b128 v[96:99], v143 offset:4096
    v_cvt_pk_bf16_f32 v58, v84, v85
    v_mfma_f32_16x16x32_bf16 v[36:39], v[132:135], v[92:95], v[36:39]
    v_cvt_pk_bf16_f32 v59, v86, v87
    ds_write_b128 v145, v[56:59] offset:9216
    v_mfma_f32_16x16x32_bf16 v[64:67], v[92:95], v[136:139], v[64:67]
    v_cvt_pk_bf16_f32 v18, v28, v29
    v_cvt_pk_bf16_f32 v19, v30, v31
    v_mfma_f32_16x16x32_bf16 v[8:11], v[128:131], v[92:95], v[8:11]
    ds_write_b128 v145, v[16:19] offset:2048
    v_mfma_f32_16x16x32_bf16 v[52:55], v[120:123], v[108:111], v[52:55]
    v_mfma_f32_16x16x32_bf16 v[80:83], v[108:111], v[124:127], v[80:83]
    v_cvt_pk_bf16_f32 v36, v36, v37
    v_cvt_pk_bf16_f32 v37, v38, v39
    v_mfma_f32_16x16x32_bf16 v[24:27], v[116:119], v[108:111], v[24:27]
    ds_read_b128 v[108:111], v143 offset:10240
    v_cvt_pk_bf16_f32 v64, v64, v65
    s_waitcnt lgkmcnt(6)
    v_mfma_f32_16x16x32_bf16 v[48:51], v[132:135], v[104:107], v[48:51]
    v_cvt_pk_bf16_f32 v65, v66, v67
    v_cvt_pk_bf16_f32 v8, v8, v9
    v_mfma_f32_16x16x32_bf16 v[76:79], v[104:107], v[136:139], v[76:79]
    v_cvt_pk_bf16_f32 v9, v10, v11
    v_mfma_f32_16x16x32_bf16 v[20:23], v[128:131], v[104:107], v[20:23]
    s_waitcnt lgkmcnt(3)
    v_mfma_f32_16x16x32_bf16 v[40:43], v[132:135], v[96:99], v[40:43]
    v_mfma_f32_16x16x32_bf16 v[68:71], v[96:99], v[136:139], v[68:71]
    v_cvt_pk_bf16_f32 v38, v48, v49
    v_cvt_pk_bf16_f32 v39, v50, v51
    v_mfma_f32_16x16x32_bf16 v[12:15], v[128:131], v[96:99], v[12:15]
    ds_write_b128 v145, v[36:39] offset:4096
    v_cvt_pk_bf16_f32 v66, v76, v77
    s_waitcnt lgkmcnt(1)
    v_mfma_f32_16x16x32_bf16 v[52:55], v[132:135], v[108:111], v[52:55]
    v_cvt_pk_bf16_f32 v67, v78, v79
    ds_write_b128 v145, v[64:67] offset:7168
    v_mfma_f32_16x16x32_bf16 v[80:83], v[108:111], v[136:139], v[80:83]
    v_cvt_pk_bf16_f32 v10, v20, v21
    v_cvt_pk_bf16_f32 v11, v22, v23
    v_mfma_f32_16x16x32_bf16 v[24:27], v[128:131], v[108:111], v[24:27]
    ds_write_b128 v145, v[8:11] offset:0
    v_cvt_pk_bf16_f32 v40, v40, v41
    v_cvt_pk_bf16_f32 v41, v42, v43
    v_cvt_pk_bf16_f32 v68, v68, v69
    v_cvt_pk_bf16_f32 v69, v70, v71
    v_cvt_pk_bf16_f32 v12, v12, v13
    v_cvt_pk_bf16_f32 v13, v14, v15
    v_cvt_pk_bf16_f32 v42, v52, v53
    v_cvt_pk_bf16_f32 v43, v54, v55
    ds_write_b128 v145, v[40:43] offset:5120
    v_cvt_pk_bf16_f32 v70, v80, v81
    v_cvt_pk_bf16_f32 v71, v82, v83
    ds_write_b128 v145, v[68:71] offset:8192
    v_cvt_pk_bf16_f32 v14, v24, v25
    v_cvt_pk_bf16_f32 v15, v26, v27
    ds_write_b128 v145, v[12:15] offset:1024
    s_branch L_pb10b
L_lsend:

    s_waitcnt lgkmcnt(10)
    v_mfma_f32_16x16x32_bf16 v[32:35], v[120:123], v[88:91], v[32:35]
    ds_read_b64_tr_b16 v[132:133], v144 offset:16384
    s_waitcnt lgkmcnt(9)
    v_mfma_f32_16x16x32_bf16 v[60:63], v[88:91], v[124:127], v[60:63]
    ds_read_b128 v[88:91], v143 offset:0
    s_waitcnt lgkmcnt(5)
    v_mfma_f32_16x16x32_bf16 v[44:47], v[120:123], v[100:103], v[44:47]
    ds_read_b64_tr_b16 v[134:135], v144 offset:16896
    v_mfma_f32_16x16x32_bf16 v[72:75], v[100:103], v[124:127], v[72:75]
    ds_read_b64_tr_b16 v[136:137], v144 offset:20480
    v_mfma_f32_16x16x32_bf16 v[16:19], v[116:119], v[100:103], v[16:19]
    ds_read_b128 v[100:103], v143 offset:6144
    v_mfma_f32_16x16x32_bf16 v[36:39], v[120:123], v[92:95], v[36:39]
    ds_read_b64_tr_b16 v[138:139], v144 offset:20992
    v_mfma_f32_16x16x32_bf16 v[64:67], v[92:95], v[124:127], v[64:67]
    ds_read_b64_tr_b16 v[128:129], v144 offset:12288
    v_mfma_f32_16x16x32_bf16 v[8:11], v[116:119], v[92:95], v[8:11]
    ds_read_b128 v[92:95], v143 offset:2048
    s_waitcnt lgkmcnt(8)
    v_mfma_f32_16x16x32_bf16 v[56:59], v[120:123], v[112:115], v[56:59]
    ds_read_b64_tr_b16 v[130:131], v144 offset:12800
    v_mfma_f32_16x16x32_bf16 v[84:87], v[112:115], v[124:127], v[84:87]
    v_mfma_f32_16x16x32_bf16 v[28:31], v[116:119], v[112:115], v[28:31]
    ds_read_b128 v[112:115], v143 offset:12288
    s_waitcnt lgkmcnt(7)
    v_mfma_f32_16x16x32_bf16 v[32:35], v[132:135], v[88:91], v[32:35]
    s_waitcnt lgkmcnt(4)
    v_mfma_f32_16x16x32_bf16 v[60:63], v[88:91], v[136:139], v[60:63]
    v_mfma_f32_16x16x32_bf16 v[44:47], v[132:135], v[100:103], v[44:47]
    v_mfma_f32_16x16x32_bf16 v[72:75], v[100:103], v[136:139], v[72:75]
    s_waitcnt lgkmcnt(1)
    v_mfma_f32_16x16x32_bf16 v[16:19], v[128:131], v[100:103], v[16:19]
    s_nop 1
    v_cvt_pk_bf16_f32 v32, v32, v33
    v_cvt_pk_bf16_f32 v33, v34, v35
    v_mfma_f32_16x16x32_bf16 v[48:51], v[120:123], v[104:107], v[48:51]
    v_cvt_pk_bf16_f32 v60, v60, v61
    v_cvt_pk_bf16_f32 v61, v62, v63
    v_mfma_f32_16x16x32_bf16 v[76:79], v[104:107], v[124:127], v[76:79]
    v_cvt_pk_bf16_f32 v34, v44, v45
    v_cvt_pk_bf16_f32 v35, v46, v47
    v_mfma_f32_16x16x32_bf16 v[20:23], v[116:119], v[104:107], v[20:23]
    ds_read_b128 v[104:107], v143 offset:8192
    buffer_store_dwordx4 v[32:35], v7, s[44:47], s70 offen offset:3072 sc1
    s_waitcnt lgkmcnt(1)
    v_mfma_f32_16x16x32_bf16 v[56:59], v[132:135], v[112:115], v[56:59]
    ds_write_b128 v145, v[32:35] offset:3072
    v_cvt_pk_bf16_f32 v62, v72, v73
    v_mfma_f32_16x16x32_bf16 v[84:87], v[112:115], v[136:139], v[84:87]
    v_cvt_pk_bf16_f32 v63, v74, v75
    buffer_store_dwordx4 v[60:63], v7, s[44:47], s71 offen offset:2048 sc1
    v_mfma_f32_16x16x32_bf16 v[28:31], v[128:131], v[112:115], v[28:31]
    ds_write_b128 v145, v[60:63] offset:6144
    v_cvt_pk_bf16_f32 v16, v16, v17
    v_mfma_f32_16x16x32_bf16 v[40:43], v[120:123], v[96:99], v[40:43]
    v_cvt_pk_bf16_f32 v17, v18, v19
    v_mfma_f32_16x16x32_bf16 v[68:71], v[96:99], v[124:127], v[68:71]
    v_cvt_pk_bf16_f32 v56, v56, v57
    v_cvt_pk_bf16_f32 v57, v58, v59
    v_mfma_f32_16x16x32_bf16 v[12:15], v[116:119], v[96:99], v[12:15]
    ds_read_b128 v[96:99], v143 offset:4096
    v_cvt_pk_bf16_f32 v58, v84, v85
    v_mfma_f32_16x16x32_bf16 v[36:39], v[132:135], v[92:95], v[36:39]
    v_cvt_pk_bf16_f32 v59, v86, v87
    buffer_store_dwordx4 v[56:59], v7, s[44:47], s72 offen offset:1024 sc1
    v_mfma_f32_16x16x32_bf16 v[64:67], v[92:95], v[136:139], v[64:67]
    ds_write_b128 v145, v[56:59] offset:9216
    v_cvt_pk_bf16_f32 v18, v28, v29
    v_mfma_f32_16x16x32_bf16 v[8:11], v[128:131], v[92:95], v[8:11]
    v_cvt_pk_bf16_f32 v19, v30, v31
    buffer_store_dwordx4 v[16:19], v7, s[44:47], s70 offen offset:2048 sc1
    v_mfma_f32_16x16x32_bf16 v[52:55], v[120:123], v[108:111], v[52:55]
    ds_write_b128 v145, v[16:19] offset:2048
    v_mfma_f32_16x16x32_bf16 v[80:83], v[108:111], v[124:127], v[80:83]
    v_cvt_pk_bf16_f32 v36, v36, v37
    v_cvt_pk_bf16_f32 v37, v38, v39
    v_mfma_f32_16x16x32_bf16 v[24:27], v[116:119], v[108:111], v[24:27]
    ds_read_b128 v[108:111], v143 offset:10240
    v_cvt_pk_bf16_f32 v64, v64, v65
    s_waitcnt lgkmcnt(6)
    v_mfma_f32_16x16x32_bf16 v[48:51], v[132:135], v[104:107], v[48:51]
    v_cvt_pk_bf16_f32 v65, v66, v67
    v_cvt_pk_bf16_f32 v8, v8, v9
    v_mfma_f32_16x16x32_bf16 v[76:79], v[104:107], v[136:139], v[76:79]
    v_cvt_pk_bf16_f32 v9, v10, v11
    v_mfma_f32_16x16x32_bf16 v[20:23], v[128:131], v[104:107], v[20:23]
    s_waitcnt lgkmcnt(3)
    v_mfma_f32_16x16x32_bf16 v[40:43], v[132:135], v[96:99], v[40:43]
    v_mfma_f32_16x16x32_bf16 v[68:71], v[96:99], v[136:139], v[68:71]
    v_cvt_pk_bf16_f32 v38, v48, v49
    v_cvt_pk_bf16_f32 v39, v50, v51
    v_mfma_f32_16x16x32_bf16 v[12:15], v[128:131], v[96:99], v[12:15]
    buffer_store_dwordx4 v[36:39], v7, s[44:47], s71 offen offset:0 sc1
    ds_write_b128 v145, v[36:39] offset:4096
    s_waitcnt lgkmcnt(1)
    v_mfma_f32_16x16x32_bf16 v[52:55], v[132:135], v[108:111], v[52:55]
    v_cvt_pk_bf16_f32 v66, v76, v77
    v_cvt_pk_bf16_f32 v67, v78, v79
    v_mfma_f32_16x16x32_bf16 v[80:83], v[108:111], v[136:139], v[80:83]
    buffer_store_dwordx4 v[64:67], v7, s[44:47], s71 offen offset:3072 sc1
    ds_write_b128 v145, v[64:67] offset:7168
    v_mfma_f32_16x16x32_bf16 v[24:27], v[128:131], v[108:111], v[24:27]
    v_cvt_pk_bf16_f32 v10, v20, v21
    v_cvt_pk_bf16_f32 v11, v22, v23
    buffer_store_dwordx4 v[8:11], v7, s[44:47], s70 offen offset:0 sc1
    ds_write_b128 v145, v[8:11] offset:0
    v_cvt_pk_bf16_f32 v40, v40, v41
    v_cvt_pk_bf16_f32 v41, v42, v43
    v_cvt_pk_bf16_f32 v68, v68, v69
    v_cvt_pk_bf16_f32 v69, v70, v71
    v_cvt_pk_bf16_f32 v12, v12, v13
    v_cvt_pk_bf16_f32 v13, v14, v15
    v_cvt_pk_bf16_f32 v42, v52, v53
    v_cvt_pk_bf16_f32 v43, v54, v55
    buffer_store_dwordx4 v[40:43], v7, s[44:47], s71 offen offset:1024 sc1
    ds_write_b128 v145, v[40:43] offset:5120
    v_cvt_pk_bf16_f32 v70, v80, v81
    v_cvt_pk_bf16_f32 v71, v82, v83
    buffer_store_dwordx4 v[68:71], v7, s[44:47], s72 offen offset:0 sc1
    ds_write_b128 v145, v[68:71] offset:8192
    v_cvt_pk_bf16_f32 v14, v24, v25
    v_cvt_pk_bf16_f32 v15, v26, v27
    buffer_store_dwordx4 v[12:15], v7, s[44:47], s70 offen offset:1024 sc1
    ds_write_b128 v145, v[12:15] offset:1024
    s_branch L_pb10b
L_pb10:
    s_mov_b32 s44, s28
    s_and_b32 s45, s29, 0xffff
    s_mov_b32 s46, 16777216
    s_mov_b32 s47, 0x00020000
    s_mul_i32 s31, s31, 1664525
    s_add_u32 s31, s31, 1013904223
    s_setprio 1
L_pb10b:
    v_mov_b32 v165, s31
L_upre:
    v_add_u32 v132, s64, v158
    v_add_u32 v133, s65, v160
    v_add_u32 v134, s65, v161
    s_cmp_eq_u32 s101, 2
    s_cbranch_scc1 L_unit
    v_add_f32 v136, s67, v150
    v_add_f32 v137, s67, v151
    v_add_f32 v138, s67, v152
    v_add_f32 v139, s67, v153
    s_waitcnt lgkmcnt(0)
    s_barrier
L_unit:
    s_cmp_eq_u32 s62, 0
    s_cbranch_scc1 L_ugo
    s_mov_b32 s100, 0
Lw_56:
    ds_read_b32 v4, v3 offset:8
    s_waitcnt lgkmcnt(0)
    v_readfirstlane_b32 s99, v4
    s_cmp_ge_u32 s99, 1
    s_cbranch_scc1 Lwd_57
    s_sleep 1
    s_add_u32 s100, s100, 1
    s_cmp_lt_u32 s100, 8388608
    s_cbranch_scc1 Lw_56
Lwd_57:
    s_setprio 3
L_ugo:
    ds_read_b64 v[104:105], v158 offset:0
    ds_read_b64 v[106:107], v158 offset:10240
    ds_read_b64 v[88:89], v158 offset:3072
    ds_read_b64 v[90:91], v158 offset:13312
    ds_read_b64 v[92:93], v158 offset:4096
    ds_read_b64 v[94:95], v158 offset:14336
    ds_read_b64 v[108:109], v158 offset:1024
    ds_read_b64 v[110:111], v158 offset:11264
    ds_read_b64 v[96:97], v158 offset:5120
    ds_read_b64 v[98:99], v158 offset:15360
    ds_read_b64 v[112:113], v158 offset:2048
    ds_read_b64 v[114:115], v158 offset:12288
    ds_read_b64 v[100:101], v132 offset:0
    ds_read_b64 v[102:103], v132 offset:10240
    s_waitcnt lgkmcnt(12)
    v_and_b32 v106, v106, v159
    v_and_b32 v107, v107, v159
    s_waitcnt lgkmcnt(8)
    s_nop 0
    v_mfma_f32_16x16x32_bf16 v[20:23], v[88:91], v[104:107], v[136:139]
    v_mfma_f32_16x16x32_bf16 v[8:11], v[92:95], v[104:107], v[146:149]
    s_waitcnt lgkmcnt(6)
    v_and_b32 v110, v110, v159
    v_and_b32 v111, v111, v159
    s_waitcnt lgkmcnt(4)
    s_nop 0
    v_mfma_f32_16x16x32_bf16 v[24:27], v[92:95], v[108:111], v[150:153]
    v_mfma_f32_16x16x32_bf16 v[12:15], v[96:99], v[108:111], v[146:149]
    s_waitcnt lgkmcnt(2)
    v_and_b32 v114, v114, v159
    v_and_b32 v115, v115, v159
    s_waitcnt lgkmcnt(0)
    s_nop 0
    v_mfma_f32_16x16x32_bf16 v[28:31], v[96:99], v[112:115], v[150:153]
    v_mfma_f32_16x16x32_bf16 v[16:19], v[100:103], v[112:115], v[146:149]
    ds_read_b64 v[120:121], v160 offset:7168
    ds_read_b64 v[122:123], v160 offset:6144
    ds_read_b64 v[118:119], v160 offset:8192
    ds_read_b64 v[116:117], v133 offset:0
    ds_read_b64 v[128:129], v161 offset:7168
    ds_read_b64 v[130:131], v161 offset:6144
    ds_read_b64 v[126:127], v161 offset:8192
    ds_read_b64 v[124:125], v134 offset:0
    v_max3_f32 v32, v20, v21, v8
    v_max3_f32 v36, v22, v23, v10
    v_max_f32 v32, v32, v9
    v_max_f32 v36, v36, v11
    v_max_f32 v40, v32, v36
    v_max3_f32 v33, v24, v25, v12
    v_max3_f32 v37, v26, v27, v14
    v_max_f32 v33, v33, v13
    v_max_f32 v37, v37, v15
    v_max_f32 v41, v33, v37
    v_max3_f32 v34, v28, v29, v16
    v_max3_f32 v38, v30, v31, v18
    v_max_f32 v34, v34, v17
    v_max_f32 v38, v38, v19
    v_permlane32_swap_b32 v40, v41
    v_max_f32 v42, v34, v38
    v_max_f32 v40, v40, v41
    s_add_u32 s96, s68, 40960
    v_permlane32_swap_b32 v42, v43
    v_max_f32 v42, v42, v43
    s_nop 1
    v_permlane16_swap_b32 v40, v42
    v_max_f32 v40, v40, v42
    v_mul_f32 v42, s66, v40
    v_mul_f32 v40, s66, v40
    s_nop 1
    v_permlane16_swap_b32 v40, v42
    v_mov_b32 v41, v40
    v_mov_b32 v43, v42
    s_waitcnt lgkmcnt(0)
    v_permlane32_swap_b32 v40, v41
    v_permlane32_swap_b32 v42, v43
    s_cmp_eq_u32 s69, 0
    s_cbranch_scc1 Lxs_58
    s_waitcnt vmcnt(0)
    s_atomic_swap s31, s[28:29], s69
Lxs_58:
    v_fma_f32 v32, v32, s66, -v40
    v_fma_f32 v36, v36, s66, -v40
    v_fma_f32 v33, v33, s66, -v41
    v_fma_f32 v37, v37, s66, -v41
    v_fma_f32 v34, v34, s66, -v42
    v_fma_f32 v38, v38, s66, -v42
    v_exp_f32 v32, v32
    v_exp_f32 v36, v36
    v_exp_f32 v33, v33
    v_exp_f32 v37, v37
    v_exp_f32 v34, v34
    v_exp_f32 v38, v38
    v_add_f32 v40, v32, v36
    v_add_f32 v41, v33, v37
    v_add_f32 v42, v34, v38
    s_nop 0
    v_permlane32_swap_b32 v40, v41
    v_permlane32_swap_b32 v42, v43
    v_add_f32 v40, v40, v41
    v_add_f32 v42, v42, v43
    s_nop 1
    v_permlane16_swap_b32 v40, v42
    v_add_f32 v40, v40, v42
    v_rcp_f32 v42, v40
    v_rcp_f32 v40, v40
    s_nop 1
    v_permlane16_swap_b32 v40, v42
    v_mov_b32 v41, v40
    v_mov_b32 v43, v42
    s_nop 0
    v_permlane32_swap_b32 v40, v41
    v_permlane32_swap_b32 v42, v43
    v_mul_f32 v32, v32, v40
    v_mul_f32 v36, v36, v40
    v_cvt_pk_bf16_f32 v32, v32, v36
    v_perm_b32 v44, v32, v32, v154
    v_perm_b32 v45, v32, v32, v155
    v_perm_b32 v46, v32, v32, v156
    v_perm_b32 v47, v32, v32, v157
    v_mul_f32 v33, v33, v41
    v_mul_f32 v37, v37, v41
    v_cvt_pk_bf16_f32 v33, v33, v37
    v_perm_b32 v48, v33, v33, v154
    v_perm_b32 v49, v33, v33, v155
    v_perm_b32 v50, v33, v33, v156
    v_perm_b32 v51, v33, v33, v157
    v_mfma_f32_16x16x32_bf16 v[8:11], v[120:123], v[44:47], 0
    v_mfma_f32_16x16x32_bf16 v[20:23], v[128:131], v[44:47], 0
    v_mul_f32 v34, v34, v42
    v_mul_f32 v38, v38, v42
    v_cvt_pk_bf16_f32 v34, v34, v38
    v_perm_b32 v52, v34, v34, v154
    v_perm_b32 v53, v34, v34, v155
    v_perm_b32 v54, v34, v34, v156
    v_perm_b32 v55, v34, v34, v157
    v_mfma_f32_16x16x32_bf16 v[12:15], v[118:121], v[48:51], 0
    v_mfma_f32_16x16x32_bf16 v[24:27], v[126:129], v[48:51], 0
    v_mfma_f32_16x16x32_bf16 v[16:19], v[116:119], v[52:55], 0
    v_mfma_f32_16x16x32_bf16 v[28:31], v[124:127], v[52:55], 0
    v_cvt_pk_bf16_f32 v60, v8, v9
    v_cvt_pk_bf16_f32 v61, v10, v11
    v_cvt_pk_bf16_f32 v68, v20, v21
    v_cvt_pk_bf16_f32 v69, v22, v23
    s_nop 0
    v_cvt_pk_bf16_f32 v62, v12, v13
    v_cvt_pk_bf16_f32 v63, v14, v15
    s_nop 0
    v_permlane32_swap_b32 v60, v62
    v_permlane32_swap_b32 v61, v63
    buffer_store_dwordx4 v[60:63], v162, s[44:47], s68 offen sc1
    v_cvt_pk_bf16_f32 v64, v16, v17
    v_cvt_pk_bf16_f32 v65, v18, v19
    s_nop 0
    v_permlane32_swap_b32 v64, v66
    v_permlane32_swap_b32 v65, v67
    s_mov_b32 exec_lo, 0
    v_cvt_pk_bf16_f32 v68, v28, v29
    v_cvt_pk_bf16_f32 v69, v30, v31
    s_mov_b64 exec, 0xffff0000
    v_cvt_pk_bf16_f32 v68, v24, v25
    v_cvt_pk_bf16_f32 v69, v26, v27
    s_mov_b32 exec_lo, -1
    buffer_store_dwordx4 v[64:67], v162, s[44:47], s96 offen sc1
    s_mov_b32 exec_hi, 0xffff
    buffer_store_dwordx2 v[68:69], v163, s[44:47], s68 offen sc1
    s_mov_b64 exec, -1
    s_cmp_lg_u32 s101, 0
    s_cbranch_scc1 L_nops
    s_lshr_b32 s75, s60, 1
    s_lshl_b32 s96, s75, 13
    s_add_u32 s72, s68, s96
    s_add_u32 s73, s72, 20480
    s_add_u32 s74, s72, 40960
    s_mul_i32 s96, s33, 2176
    s_mul_i32 s100, s32, 21760
    s_add_u32 s96, s96, s100
    s_add_u32 s96, s96, 263168
    s_lshl_b32 s97, s60, 8
    s_add_u32 s96, s96, s97
    s_add_u32 s76, s28, s96
    s_addc_u32 s77, s29, 0
    s_mul_i32 s80, s60, 6144
    s_add_u32 s80, s80, 81920
    s_xor_b32 s96, s60, 2
    s_mul_i32 s81, s96, 6144
    s_add_u32 s81, s81, 81920
    s_mul_i32 s82, s61, 12288
    s_lshl_b32 s96, s75, 11
    s_add_u32 s82, s82, s96
    s_add_u32 s82, s82, 133632
    s_lshl1_add_u32 s96, s32, s61
    s_mul_i32 s79, s96, 61440
    s_lshl1_add_u32 s96, s33, s75
    s_lshl_b32 s96, s96, 6
    s_add_u32 s79, s79, s96
    s_mov_b32 s48, s24
    s_and_b32 s49, s25, 0xffff
    s_mov_b32 s50, 2621440
    s_mov_b32 s51, 0x00020000
    v_lshrrev_b32 v58, 2, v0
    v_and_b32 v59, 3, v0
    v_bfe_u32 v57, v0, 3, 2
    s_mul_i32 s96, s75, 6144
    s_sub_u32 s96, 16384, s96
    v_lshl_add_u32 v7, v0, 3, s96
    s_mul_i32 s96, s75, 40960
    v_lshl_add_u32 v5, v58, 7, s96
    v_lshl_add_u32 v5, v59, 3, v5
    s_lshl_b32 s96, s75, 1
    v_xor_b32 v6, s96, v57
    v_lshl_add_u32 v160, v6, 5, v5
    v_xor_b32 v161, 32, v160
    v_xor_b32 v162, 64, v160
    v_xor_b32 v163, 96, v160
    v_lshlrev_b32 v5, 4, v0
    v_add_u32 v6, 4096, v5
    v_xor_b32 v59, v59, v57
    v_mul_u32_u24 v58, 1280, v58
    v_lshl_add_u32 v58, v59, 4, v58
    s_mul_i32 s96, s61, 192
    s_add_u32 s96, s96, 161088
    v_lshl_add_u32 v57, v1, 2, s96
    v_bfe_u32 v59, v1, 1, 2
    v_lshl_add_u32 v1, v1, 6, s81
    v_lshlrev_b32 v59, 1, v59
    v_xor_b32 v59, v59, v2
    v_lshl_add_u32 v1, v59, 3, v1
    v_mov_b32 v2, v58
L_nops:
    s_lshl_b32 s96, s62, 4
    v_add_u32 v56, s96, v3
    v_mov_b32 v4, 1
    s_mov_b64 exec, 1
    ds_add_u32 v56, v4 offset:0
    s_mov_b64 exec, -1
    s_cmp_lg_u32 s101, 0
    s_cbranch_scc1 L_lsig
    s_lshl_b32 s96, s61, 3
    v_add_u32 v56, s96, v3
    s_waitcnt vmcnt(0)
    v_mov_b32 v4, 1
    s_mov_b64 exec, 1
    ds_add_rtn_u32 v4, v56, v4 offset:24
    s_waitcnt lgkmcnt(0)
    v_readfirstlane_b32 s97, v4
    s_mov_b64 exec, -1
    s_cmp_lg_u32 s97, 1
    s_cbranch_scc1 L_nosig
L_lsig:
    s_waitcnt vmcnt(0)
    s_mov_b64 exec, 0x3ff
    global_atomic_swap v164, v165, s[28:29] sc1
    s_mov_b64 exec, -1
L_nosig:
    s_cmp_eq_u32 s101, 0
    s_cbranch_scc1 L_op
    s_lshr_b32 s97, s34, 2
    s_andn2_b32 s96, s97, s62
    s_cbranch_scc0 L_pexit
    s_mov_b32 s62, 1
    s_mov_b32 s101, 2
    s_branch L_us
L_op:
    s_setprio 0
    s_lshl_b32 s85, s34, 10
    s_mov_b32 s100, 0
    v_mov_b32 v116, v57
    s_lshl_b32 s96, s60, 2
    v_add_u32 v164, s96, v3
    s_load_dwordx16 s[4:19], s[76:77], 0 glc
    s_mov_b32 s100, 0
Lw_59:
    ds_read_b32 v4, v3 offset:4
    s_waitcnt lgkmcnt(0)
    v_readfirstlane_b32 s99, v4
    s_cmp_ge_u32 s99, 2
    s_cbranch_scc1 Lwd_60
    s_add_u32 s100, s100, 1
    s_cmp_lt_u32 s100, 8388608
    s_cbranch_scc1 Lw_59
Lwd_60:
    s_mov_b32 s100, 0
    ds_read_b64_tr_b16 v[140:141], v160 offset:0
    ds_read_b64_tr_b16 v[142:143], v160 offset:2048
    ds_read_b64_tr_b16 v[144:145], v161 offset:0
    ds_read_b64_tr_b16 v[146:147], v161 offset:2048
    ds_read_b64_tr_b16 v[148:149], v162 offset:0
    ds_read_b64_tr_b16 v[150:151], v162 offset:2048
    ds_read_b64_tr_b16 v[152:153], v163 offset:0
    ds_read_b64_tr_b16 v[154:155], v163 offset:2048
    ds_read_b64_tr_b16 v[156:157], v160 offset:4096
    ds_read_b64_tr_b16 v[158:159], v160 offset:6144
L_nb0:
    s_cmp_lg_u32 s4, s31
    s_cbranch_scc1 L_ns0
L_ng0:
    s_add_u32 s96, s72, s85
    buffer_load_dwordx4 v[56:59], v5, s[44:47], s96 offen sc1
    s_add_u32 s96, s73, s85
    buffer_load_dwordx4 v[60:63], v5, s[44:47], s96 offen sc1
    s_add_u32 s96, s74, s85
    buffer_load_dwordx4 v[64:67], v5, s[44:47], s96 offen sc1
    s_add_u32 s85, s85, 1024
    s_cmp_eq_u32 s85, 5120
    s_cselect_b32 s85, 0, s85
L_nb1:
    s_cmp_lg_u32 s6, s31
    s_cbranch_scc1 L_ns1
L_ng1:
    s_add_u32 s96, s72, s85
    buffer_load_dwordx4 v[68:71], v5, s[44:47], s96 offen sc1
    s_add_u32 s96, s73, s85
    buffer_load_dwordx4 v[72:75], v5, s[44:47], s96 offen sc1
    s_add_u32 s96, s74, s85
    buffer_load_dwordx4 v[76:79], v5, s[44:47], s96 offen sc1
    s_add_u32 s85, s85, 1024
    s_cmp_eq_u32 s85, 5120
    s_cselect_b32 s85, 0, s85
L_nb2:
    s_cmp_lg_u32 s8, s31
    s_cbranch_scc1 L_ns2
L_ng2:
    s_add_u32 s96, s72, s85
    buffer_load_dwordx4 v[80:83], v5, s[44:47], s96 offen sc1
    s_add_u32 s96, s73, s85
    buffer_load_dwordx4 v[84:87], v5, s[44:47], s96 offen sc1
    s_add_u32 s96, s74, s85
    buffer_load_dwordx4 v[88:91], v5, s[44:47], s96 offen sc1
    s_add_u32 s85, s85, 1024
    s_cmp_eq_u32 s85, 5120
    s_cselect_b32 s85, 0, s85
L_nb3:
    s_cmp_lg_u32 s10, s31
    s_cbranch_scc1 L_ns3
L_ng3:
    s_add_u32 s96, s72, s85
    buffer_load_dwordx4 v[92:95], v5, s[44:47], s96 offen sc1
    s_add_u32 s96, s73, s85
    buffer_load_dwordx4 v[96:99], v5, s[44:47], s96 offen sc1
    s_add_u32 s96, s74, s85
    buffer_load_dwordx4 v[100:103], v5, s[44:47], s96 offen sc1
    s_add_u32 s85, s85, 1024
    s_cmp_eq_u32 s85, 5120
    s_cselect_b32 s85, 0, s85
L_nb4:
    s_cmp_lg_u32 s12, s31
    s_cbranch_scc1 L_ns4
L_ng4:
    s_add_u32 s96, s72, s85
    buffer_load_dwordx4 v[104:107], v5, s[44:47], s96 offen sc1
    s_add_u32 s96, s73, s85
    buffer_load_dwordx4 v[108:111], v5, s[44:47], s96 offen sc1
    s_add_u32 s96, s74, s85
    buffer_load_dwordx4 v[112:115], v5, s[44:47], s96 offen sc1

    s_waitcnt vmcnt(14)
    s_waitcnt lgkmcnt(8)
    v_mfma_f32_16x16x32_bf16 v[8:11], v[140:143], v[56:59], 0
    s_waitcnt vmcnt(13)
    v_mfma_f32_16x16x32_bf16 v[24:27], v[140:143], v[60:63], 0
    s_waitcnt vmcnt(12)
    v_mfma_f32_16x16x32_bf16 v[40:43], v[140:143], v[64:67], 0
    s_waitcnt lgkmcnt(6)
    v_mfma_f32_16x16x32_bf16 v[12:15], v[144:147], v[56:59], 0
    ds_read_b64_tr_b16 v[140:141], v161 offset:4096
    v_mfma_f32_16x16x32_bf16 v[28:31], v[144:147], v[60:63], 0
    ds_read_b64_tr_b16 v[142:143], v161 offset:6144
    v_mfma_f32_16x16x32_bf16 v[44:47], v[144:147], v[64:67], 0
    s_waitcnt lgkmcnt(6)
    v_mfma_f32_16x16x32_bf16 v[16:19], v[148:151], v[56:59], 0
    ds_read_b64_tr_b16 v[144:145], v162 offset:4096
    v_mfma_f32_16x16x32_bf16 v[32:35], v[148:151], v[60:63], 0
    ds_read_b64_tr_b16 v[146:147], v162 offset:6144
    v_mfma_f32_16x16x32_bf16 v[48:51], v[148:151], v[64:67], 0
    s_waitcnt lgkmcnt(6)
    v_mfma_f32_16x16x32_bf16 v[20:23], v[152:155], v[56:59], 0
    ds_read_b64_tr_b16 v[148:149], v163 offset:4096
    v_mfma_f32_16x16x32_bf16 v[36:39], v[152:155], v[60:63], 0
    ds_read_b64_tr_b16 v[150:151], v163 offset:6144
    v_mfma_f32_16x16x32_bf16 v[52:55], v[152:155], v[64:67], 0
    s_waitcnt vmcnt(11)
    s_waitcnt lgkmcnt(6)
    v_mfma_f32_16x16x32_bf16 v[8:11], v[156:159], v[68:71], v[8:11]
    ds_read_b64_tr_b16 v[152:153], v160 offset:8192
    buffer_load_dwordx2 v[56:57], v7, s[44:47], s72 offen offset:0 sc1
    s_waitcnt vmcnt(11)
    v_mfma_f32_16x16x32_bf16 v[24:27], v[156:159], v[72:75], v[24:27]
    ds_read_b64_tr_b16 v[154:155], v160 offset:10240
    buffer_load_dwordx2 v[58:59], v7, s[44:47], s72 offen offset:512 sc1
    s_waitcnt vmcnt(11)
    v_mfma_f32_16x16x32_bf16 v[40:43], v[156:159], v[76:79], v[40:43]
    buffer_load_dwordx2 v[60:61], v7, s[44:47], s73 offen offset:0 sc1
    s_waitcnt lgkmcnt(6)
    v_mfma_f32_16x16x32_bf16 v[12:15], v[140:143], v[68:71], v[12:15]
    ds_read_b64_tr_b16 v[156:157], v161 offset:8192
    v_mfma_f32_16x16x32_bf16 v[28:31], v[140:143], v[72:75], v[28:31]
    ds_read_b64_tr_b16 v[158:159], v161 offset:10240
    v_mfma_f32_16x16x32_bf16 v[44:47], v[140:143], v[76:79], v[44:47]
    buffer_load_dwordx2 v[62:63], v7, s[44:47], s73 offen offset:512 sc1
    s_waitcnt lgkmcnt(6)
    v_mfma_f32_16x16x32_bf16 v[16:19], v[144:147], v[68:71], v[16:19]
    ds_read_b64_tr_b16 v[140:141], v162 offset:8192
    v_mfma_f32_16x16x32_bf16 v[32:35], v[144:147], v[72:75], v[32:35]
    ds_read_b64_tr_b16 v[142:143], v162 offset:10240
    v_mfma_f32_16x16x32_bf16 v[48:51], v[144:147], v[76:79], v[48:51]
    buffer_load_dwordx2 v[64:65], v7, s[44:47], s74 offen offset:0 sc1
    s_waitcnt lgkmcnt(6)
    v_mfma_f32_16x16x32_bf16 v[20:23], v[148:151], v[68:71], v[20:23]
    ds_read_b64_tr_b16 v[144:145], v163 offset:8192
    v_mfma_f32_16x16x32_bf16 v[36:39], v[148:151], v[72:75], v[36:39]
    ds_read_b64_tr_b16 v[146:147], v163 offset:10240
    v_mfma_f32_16x16x32_bf16 v[52:55], v[148:151], v[76:79], v[52:55]
    buffer_load_dwordx2 v[66:67], v7, s[44:47], s74 offen offset:512 sc1
L_nb6:
    s_cmp_lg_u32 s14, s31
    s_cbranch_scc1 L_ns6
    s_cmp_lg_u32 s16, s31
    s_cbranch_scc1 L_ns6
L_ng6:
    s_waitcnt vmcnt(14)
    s_waitcnt lgkmcnt(6)
    v_mfma_f32_16x16x32_bf16 v[8:11], v[152:155], v[80:83], v[8:11]
    ds_read_b64_tr_b16 v[148:149], v160 offset:12288
    s_waitcnt vmcnt(13)
    v_mfma_f32_16x16x32_bf16 v[24:27], v[152:155], v[84:87], v[24:27]
    ds_read_b64_tr_b16 v[150:151], v160 offset:14336
    s_waitcnt vmcnt(12)
    v_mfma_f32_16x16x32_bf16 v[40:43], v[152:155], v[88:91], v[40:43]
    buffer_load_dwordx4 v[68:71], v6, s[44:47], s72 offen offset:1024 sc1
    s_waitcnt lgkmcnt(6)
    v_mfma_f32_16x16x32_bf16 v[12:15], v[156:159], v[80:83], v[12:15]
    ds_read_b64_tr_b16 v[152:153], v161 offset:12288
    v_mfma_f32_16x16x32_bf16 v[28:31], v[156:159], v[84:87], v[28:31]
    ds_read_b64_tr_b16 v[154:155], v161 offset:14336
    v_mfma_f32_16x16x32_bf16 v[44:47], v[156:159], v[88:91], v[44:47]
    buffer_load_dwordx4 v[72:75], v6, s[44:47], s73 offen offset:1024 sc1
    s_waitcnt lgkmcnt(6)
    v_mfma_f32_16x16x32_bf16 v[16:19], v[140:143], v[80:83], v[16:19]
    ds_read_b64_tr_b16 v[156:157], v162 offset:12288
    v_mfma_f32_16x16x32_bf16 v[32:35], v[140:143], v[84:87], v[32:35]
    ds_read_b64_tr_b16 v[158:159], v162 offset:14336
    v_mfma_f32_16x16x32_bf16 v[48:51], v[140:143], v[88:91], v[48:51]
    buffer_load_dwordx4 v[76:79], v6, s[44:47], s74 offen offset:1024 sc1
    s_waitcnt lgkmcnt(6)
    v_mfma_f32_16x16x32_bf16 v[20:23], v[144:147], v[80:83], v[20:23]
    ds_read_b64_tr_b16 v[140:141], v163 offset:12288
    v_mfma_f32_16x16x32_bf16 v[36:39], v[144:147], v[84:87], v[36:39]
    ds_read_b64_tr_b16 v[142:143], v163 offset:14336
    v_mfma_f32_16x16x32_bf16 v[52:55], v[144:147], v[88:91], v[52:55]
    s_waitcnt vmcnt(14)
    s_waitcnt lgkmcnt(6)
    v_mfma_f32_16x16x32_bf16 v[8:11], v[148:151], v[92:95], v[8:11]
    ds_read_b64_tr_b16 v[144:145], v160 offset:16384
    s_waitcnt vmcnt(13)
    v_mfma_f32_16x16x32_bf16 v[24:27], v[148:151], v[96:99], v[24:27]
    ds_read_b64_tr_b16 v[146:147], v160 offset:18432
    s_waitcnt vmcnt(12)
    v_mfma_f32_16x16x32_bf16 v[40:43], v[148:151], v[100:103], v[40:43]
    s_waitcnt lgkmcnt(6)
    v_mfma_f32_16x16x32_bf16 v[12:15], v[152:155], v[92:95], v[12:15]
    ds_read_b64_tr_b16 v[148:149], v161 offset:16384
    v_mfma_f32_16x16x32_bf16 v[28:31], v[152:155], v[96:99], v[28:31]
    ds_read_b64_tr_b16 v[150:151], v161 offset:18432
    v_mfma_f32_16x16x32_bf16 v[44:47], v[152:155], v[100:103], v[44:47]
    s_waitcnt lgkmcnt(6)
    v_mfma_f32_16x16x32_bf16 v[16:19], v[156:159], v[92:95], v[16:19]
    ds_read_b64_tr_b16 v[152:153], v162 offset:16384
    v_mfma_f32_16x16x32_bf16 v[32:35], v[156:159], v[96:99], v[32:35]
    ds_read_b64_tr_b16 v[154:155], v162 offset:18432
    v_mfma_f32_16x16x32_bf16 v[48:51], v[156:159], v[100:103], v[48:51]
    s_waitcnt lgkmcnt(6)
    v_mfma_f32_16x16x32_bf16 v[20:23], v[140:143], v[92:95], v[20:23]
    ds_read_b64_tr_b16 v[156:157], v163 offset:16384
    v_mfma_f32_16x16x32_bf16 v[36:39], v[140:143], v[96:99], v[36:39]
    ds_read_b64_tr_b16 v[158:159], v163 offset:18432
    v_mfma_f32_16x16x32_bf16 v[52:55], v[140:143], v[100:103], v[52:55]
    s_waitcnt vmcnt(11)
    s_waitcnt lgkmcnt(6)
    v_mfma_f32_16x16x32_bf16 v[8:11], v[144:147], v[104:107], v[8:11]
    ds_read_b64_tr_b16 v[140:141], v160 offset:20480
    s_waitcnt vmcnt(10)
    v_mfma_f32_16x16x32_bf16 v[24:27], v[144:147], v[108:111], v[24:27]
    ds_read_b64_tr_b16 v[142:143], v160 offset:22528
    s_waitcnt vmcnt(9)
    v_mfma_f32_16x16x32_bf16 v[40:43], v[144:147], v[112:115], v[40:43]
    s_waitcnt lgkmcnt(6)
    v_mfma_f32_16x16x32_bf16 v[12:15], v[148:151], v[104:107], v[12:15]
    ds_read_b64_tr_b16 v[144:145], v161 offset:20480
    v_mfma_f32_16x16x32_bf16 v[28:31], v[148:151], v[108:111], v[28:31]
    ds_read_b64_tr_b16 v[146:147], v161 offset:22528
    v_mfma_f32_16x16x32_bf16 v[44:47], v[148:151], v[112:115], v[44:47]
    s_waitcnt lgkmcnt(6)
    v_mfma_f32_16x16x32_bf16 v[16:19], v[152:155], v[104:107], v[16:19]
    ds_read_b64_tr_b16 v[148:149], v162 offset:20480
    v_mfma_f32_16x16x32_bf16 v[32:35], v[152:155], v[108:111], v[32:35]
    ds_read_b64_tr_b16 v[150:151], v162 offset:22528
    v_mfma_f32_16x16x32_bf16 v[48:51], v[152:155], v[112:115], v[48:51]
    ds_read_b32 v122, v164 offset:80
    s_waitcnt lgkmcnt(7)
    v_mfma_f32_16x16x32_bf16 v[20:23], v[156:159], v[104:107], v[20:23]
    ds_read_b64_tr_b16 v[152:153], v163 offset:20480
    v_mfma_f32_16x16x32_bf16 v[36:39], v[156:159], v[108:111], v[36:39]
    ds_read_b64_tr_b16 v[154:155], v163 offset:22528
    v_mfma_f32_16x16x32_bf16 v[52:55], v[156:159], v[112:115], v[52:55]
    s_waitcnt lgkmcnt(2)
    v_readfirstlane_b32 s97, v122
    s_cmp_eq_u32 s97, 0
    s_cbranch_scc1 L_lts
L_ltg:
    buffer_load_dwordx4 v[80:83], v6, s[44:47], s72 offen offset:2048 sc1
    buffer_load_dwordx4 v[84:87], v6, s[44:47], s73 offen offset:2048 sc1
    buffer_load_dwordx4 v[88:91], v6, s[44:47], s74 offen offset:2048 sc1
    s_waitcnt vmcnt(10)
    v_mfma_f32_16x16x32_bf16 v[8:11], v[140:143], v[56:59], v[8:11]
    ds_read_b64_tr_b16 v[156:157], v160 offset:24576
    buffer_load_dwordx4 v[92:95], v6, s[44:47], s72 offen offset:3072 sc1
    s_waitcnt vmcnt(9)
    v_mfma_f32_16x16x32_bf16 v[24:27], v[140:143], v[60:63], v[24:27]
    ds_read_b64_tr_b16 v[158:159], v160 offset:26624
    buffer_load_dwordx4 v[96:99], v6, s[44:47], s73 offen offset:3072 sc1
    s_waitcnt vmcnt(8)
    v_mfma_f32_16x16x32_bf16 v[40:43], v[140:143], v[64:67], v[40:43]
    buffer_load_dwordx4 v[100:103], v6, s[44:47], s74 offen offset:3072 sc1
    v_mfma_f32_16x16x32_bf16 v[12:15], v[144:147], v[56:59], v[12:15]
    ds_read_b64_tr_b16 v[140:141], v161 offset:24576
    buffer_load_dwordx2 v[104:105], v7, s[44:47], s72 offen offset:1024 sc1
    v_mfma_f32_16x16x32_bf16 v[28:31], v[144:147], v[60:63], v[28:31]
    ds_read_b64_tr_b16 v[142:143], v161 offset:26624
    buffer_load_dwordx2 v[106:107], v7, s[44:47], s72 offen offset:1536 sc1
    v_mfma_f32_16x16x32_bf16 v[44:47], v[144:147], v[64:67], v[44:47]
    buffer_load_dwordx2 v[108:109], v7, s[44:47], s73 offen offset:1024 sc1
    v_mfma_f32_16x16x32_bf16 v[16:19], v[148:151], v[56:59], v[16:19]
    ds_read_b64_tr_b16 v[144:145], v162 offset:24576
    buffer_load_dwordx2 v[110:111], v7, s[44:47], s73 offen offset:1536 sc1
    v_mfma_f32_16x16x32_bf16 v[32:35], v[148:151], v[60:63], v[32:35]
    ds_read_b64_tr_b16 v[146:147], v162 offset:26624
    v_mfma_f32_16x16x32_bf16 v[48:51], v[148:151], v[64:67], v[48:51]
    buffer_load_dwordx2 v[112:113], v7, s[44:47], s74 offen offset:1024 sc1
    s_waitcnt lgkmcnt(6)
    v_mfma_f32_16x16x32_bf16 v[20:23], v[152:155], v[56:59], v[20:23]
    ds_read_b64_tr_b16 v[148:149], v163 offset:24576
    v_mfma_f32_16x16x32_bf16 v[36:39], v[152:155], v[60:63], v[36:39]
    ds_read_b64_tr_b16 v[150:151], v163 offset:26624
    v_mfma_f32_16x16x32_bf16 v[52:55], v[152:155], v[64:67], v[52:55]
    buffer_load_dwordx2 v[114:115], v7, s[44:47], s74 offen offset:1536 sc1
    s_waitcnt vmcnt(14)
    s_waitcnt lgkmcnt(6)
    v_mfma_f32_16x16x32_bf16 v[8:11], v[156:159], v[68:71], v[8:11]
    ds_read_b64_tr_b16 v[152:153], v162 offset:28672
    s_waitcnt vmcnt(13)
    v_mfma_f32_16x16x32_bf16 v[24:27], v[156:159], v[72:75], v[24:27]
    ds_read_b64_tr_b16 v[154:155], v162 offset:30720
    s_waitcnt vmcnt(12)
    v_mfma_f32_16x16x32_bf16 v[40:43], v[156:159], v[76:79], v[40:43]
    s_waitcnt lgkmcnt(6)
    v_mfma_f32_16x16x32_bf16 v[12:15], v[140:143], v[68:71], v[12:15]
    ds_read_b64_tr_b16 v[156:157], v163 offset:28672
    v_mfma_f32_16x16x32_bf16 v[28:31], v[140:143], v[72:75], v[28:31]
    ds_read_b64_tr_b16 v[158:159], v163 offset:30720
    v_mfma_f32_16x16x32_bf16 v[44:47], v[140:143], v[76:79], v[44:47]
    s_waitcnt lgkmcnt(6)
    v_mfma_f32_16x16x32_bf16 v[16:19], v[144:147], v[68:71], v[16:19]
    ds_read_b64_tr_b16 v[140:141], v162 offset:32768
    v_mfma_f32_16x16x32_bf16 v[32:35], v[144:147], v[72:75], v[32:35]
    ds_read_b64_tr_b16 v[142:143], v162 offset:34816
    v_mfma_f32_16x16x32_bf16 v[48:51], v[144:147], v[76:79], v[48:51]
    s_waitcnt lgkmcnt(6)
    v_mfma_f32_16x16x32_bf16 v[20:23], v[148:151], v[68:71], v[20:23]
    ds_read_b64_tr_b16 v[144:145], v163 offset:32768
    v_mfma_f32_16x16x32_bf16 v[36:39], v[148:151], v[72:75], v[36:39]
    ds_read_b64_tr_b16 v[146:147], v163 offset:34816
    v_mfma_f32_16x16x32_bf16 v[52:55], v[148:151], v[76:79], v[52:55]
    s_waitcnt vmcnt(11)
    s_waitcnt lgkmcnt(6)
    v_mfma_f32_16x16x32_bf16 v[16:19], v[152:155], v[80:83], v[16:19]
    ds_read_b64_tr_b16 v[148:149], v162 offset:36864
    s_waitcnt vmcnt(10)
    v_mfma_f32_16x16x32_bf16 v[32:35], v[152:155], v[84:87], v[32:35]
    ds_read_b64_tr_b16 v[150:151], v162 offset:38912
    s_waitcnt vmcnt(9)
    v_mfma_f32_16x16x32_bf16 v[48:51], v[152:155], v[88:91], v[48:51]
    s_waitcnt lgkmcnt(6)
    v_mfma_f32_16x16x32_bf16 v[20:23], v[156:159], v[80:83], v[20:23]
    ds_read_b64_tr_b16 v[152:153], v163 offset:36864
    v_mfma_f32_16x16x32_bf16 v[36:39], v[156:159], v[84:87], v[36:39]
    ds_read_b64_tr_b16 v[154:155], v163 offset:38912
    v_mfma_f32_16x16x32_bf16 v[52:55], v[156:159], v[88:91], v[52:55]
    s_waitcnt vmcnt(8)
    s_waitcnt lgkmcnt(6)
    v_mfma_f32_16x16x32_bf16 v[16:19], v[140:143], v[92:95], v[16:19]
    ds_read_b64_tr_b16 v[156:157], v160 offset:28672
    s_waitcnt vmcnt(7)
    v_mfma_f32_16x16x32_bf16 v[32:35], v[140:143], v[96:99], v[32:35]
    ds_read_b64_tr_b16 v[158:159], v160 offset:30720
    s_waitcnt vmcnt(6)
    v_mfma_f32_16x16x32_bf16 v[48:51], v[140:143], v[100:103], v[48:51]
    ds_read2_b32 v[120:121], v3 offset0:0 offset1:4
    v_add_u32 v6, s80, v5
    v_add_u32 v7, s82, v5
    v_add_u32 v5, s81, v5
    s_waitcnt lgkmcnt(7)
    v_mfma_f32_16x16x32_bf16 v[20:23], v[144:147], v[92:95], v[20:23]
    ds_read_b64_tr_b16 v[140:141], v161 offset:28672
    v_mfma_f32_16x16x32_bf16 v[36:39], v[144:147], v[96:99], v[36:39]
    ds_read_b64_tr_b16 v[142:143], v161 offset:30720
    v_mfma_f32_16x16x32_bf16 v[52:55], v[144:147], v[100:103], v[52:55]
    v_xor_b32 v165, 8, v164
    s_lshl_b32 s96, s75, 2
    v_add_u32 v166, s96, v3
    s_waitcnt vmcnt(4)
    s_waitcnt lgkmcnt(7)
    v_mfma_f32_16x16x32_bf16 v[16:19], v[148:151], v[104:107], v[16:19]
    ds_read_b64_tr_b16 v[144:145], v160 offset:32768
    s_waitcnt vmcnt(2)
    v_mfma_f32_16x16x32_bf16 v[32:35], v[148:151], v[108:111], v[32:35]
    ds_read_b64_tr_b16 v[146:147], v160 offset:34816
    s_waitcnt vmcnt(0)
    v_mfma_f32_16x16x32_bf16 v[48:51], v[148:151], v[112:115], v[48:51]
    s_waitcnt lgkmcnt(4)
    v_add_u32 v120, v120, v121
    s_lshr_b32 s96, s34, 2
    v_readfirstlane_b32 s97, v120
    s_lshl1_add_u32 s84, s96, 6
    v_mfma_f32_16x16x32_bf16 v[20:23], v[152:155], v[104:107], v[20:23]
    ds_read_b64_tr_b16 v[148:149], v161 offset:32768
    v_mfma_f32_16x16x32_bf16 v[36:39], v[152:155], v[108:111], v[36:39]
    ds_read_b64_tr_b16 v[150:151], v161 offset:34816
    v_mfma_f32_16x16x32_bf16 v[52:55], v[152:155], v[112:115], v[52:55]
    s_cmp_lt_u32 s97, s84
    s_cbranch_scc1 L_fslow
L_fgo:
    v_mfma_f32_16x16x32_bf16 v[8:11], v[156:159], v[80:83], v[8:11]
    ds_read_b64_tr_b16 v[152:153], v160 offset:36864
    v_mfma_f32_16x16x32_bf16 v[24:27], v[156:159], v[84:87], v[24:27]
    ds_read_b64_tr_b16 v[154:155], v160 offset:38912
    ds_write_b128 v6, v[16:19] offset:0
    v_mfma_f32_16x16x32_bf16 v[40:43], v[156:159], v[88:91], v[40:43]
    ds_write_b128 v6, v[32:35] offset:2048
    s_waitcnt lgkmcnt(8)
    v_mfma_f32_16x16x32_bf16 v[12:15], v[140:143], v[80:83], v[12:15]
    ds_read_b64_tr_b16 v[156:157], v161 offset:36864
    ds_write_b128 v6, v[48:51] offset:4096
    v_mfma_f32_16x16x32_bf16 v[28:31], v[140:143], v[84:87], v[28:31]
    ds_read_b64_tr_b16 v[158:159], v161 offset:38912
    ds_write_b128 v6, v[20:23] offset:1024
    v_mfma_f32_16x16x32_bf16 v[44:47], v[140:143], v[88:91], v[44:47]
    ds_write_b128 v6, v[36:39] offset:3072
    s_waitcnt lgkmcnt(11)
    v_mfma_f32_16x16x32_bf16 v[8:11], v[144:147], v[92:95], v[8:11]
    ds_write_b128 v6, v[52:55] offset:5120
    v_mfma_f32_16x16x32_bf16 v[24:27], v[144:147], v[96:99], v[24:27]
    ds_write_b32 v164, v164 offset:64
    v_mfma_f32_16x16x32_bf16 v[40:43], v[144:147], v[100:103], v[40:43]
    v_mov_b32 v162, v116
    v_xor_b32 v6, 32, v1
    s_waitcnt lgkmcnt(11)
    v_mfma_f32_16x16x32_bf16 v[12:15], v[148:151], v[92:95], v[12:15]
    ds_read_b32 v21, v166 offset:48
    v_mfma_f32_16x16x32_bf16 v[28:31], v[148:151], v[96:99], v[28:31]
    ds_read2_b32 v[16:17], v162 offset0:0 offset1:16
    v_mfma_f32_16x16x32_bf16 v[44:47], v[148:151], v[100:103], v[44:47]
    ds_read_b32 v20, v162 offset:128
    s_waitcnt lgkmcnt(12)
    v_mfma_f32_16x16x32_bf16 v[8:11], v[152:155], v[104:107], v[8:11]
    ds_read_b128 v[116:119], v7 offset:0
    v_mfma_f32_16x16x32_bf16 v[24:27], v[152:155], v[108:111], v[24:27]
    ds_read_b128 v[120:123], v7 offset:1024
    v_mfma_f32_16x16x32_bf16 v[40:43], v[152:155], v[112:115], v[40:43]
    ds_read_b128 v[124:127], v7 offset:4096
    s_waitcnt lgkmcnt(10)
    v_mfma_f32_16x16x32_bf16 v[12:15], v[156:159], v[104:107], v[12:15]
    ds_read_b128 v[128:131], v7 offset:5120
    v_mfma_f32_16x16x32_bf16 v[28:31], v[156:159], v[108:111], v[28:31]
    ds_read_b128 v[132:135], v7 offset:8192
    v_mfma_f32_16x16x32_bf16 v[44:47], v[156:159], v[112:115], v[44:47]
    ds_read_b128 v[136:139], v7 offset:9216
    s_waitcnt lgkmcnt(8)
L_fb:
    ds_read_b32 v140, v165 offset:64
    ds_read_b128 v[56:59], v5 offset:0
    ds_read_b128 v[60:63], v5 offset:1024
    ds_read_b128 v[64:67], v5 offset:2048
    ds_read_b128 v[68:71], v5 offset:3072
    ds_read_b128 v[72:75], v5 offset:4096
    ds_read_b128 v[76:79], v5 offset:5120
    s_waitcnt lgkmcnt(6)
    v_readfirstlane_b32 s96, v140
    v_readfirstlane_b32 s97, v21
    s_cmp_eq_u32 s96, 0
    s_cbranch_scc1 L_fxw
    s_cmp_lt_u32 s97, 2
    s_cbranch_scc1 L_fyw
L_yok:
    v_sub_f32 v18, 1.0, v17
    v_sub_f32 v16, 1.0, v16
    v_sub_f32 v20, 1.0, v20
    s_waitcnt lgkmcnt(5)
    v_pk_add_f32 v[56:57], v[56:57], v[8:9]
    v_pk_add_f32 v[58:59], v[58:59], v[10:11]
    v_pk_fma_f32 v[116:117], v[56:57], v[16:17], v[116:117] op_sel_hi:[1,0,1]
    v_pk_fma_f32 v[118:119], v[58:59], v[16:17], v[118:119] op_sel_hi:[1,0,1]
    v_cvt_pk_bf16_f32 v80, v116, v117
    v_cvt_pk_bf16_f32 v81, v118, v119
    ds_write_b64 v1, v[80:81] offset:0
    s_waitcnt lgkmcnt(5)
    v_pk_add_f32 v[60:61], v[60:61], v[12:13]
    v_pk_add_f32 v[62:63], v[62:63], v[14:15]
    v_pk_fma_f32 v[120:121], v[60:61], v[16:17], v[120:121] op_sel_hi:[1,0,1]
    v_pk_fma_f32 v[122:123], v[62:63], v[16:17], v[122:123] op_sel_hi:[1,0,1]
    v_cvt_pk_bf16_f32 v82, v120, v121
    v_cvt_pk_bf16_f32 v83, v122, v123
    ds_write_b64 v6, v[82:83] offset:0
    ds_read_b128 v[92:95], v5 offset:0
    s_waitcnt lgkmcnt(6)
    v_pk_add_f32 v[64:65], v[64:65], v[24:25]
    v_pk_add_f32 v[66:67], v[66:67], v[26:27]
    v_pk_fma_f32 v[124:125], v[64:65], v[18:19], v[124:125] op_sel_hi:[1,0,1]
    v_pk_fma_f32 v[126:127], v[66:67], v[18:19], v[126:127] op_sel_hi:[1,0,1]
    v_cvt_pk_bf16_f32 v84, v124, v125
    v_cvt_pk_bf16_f32 v85, v126, v127
    ds_write_b64 v1, v[84:85] offset:1024
    s_waitcnt lgkmcnt(6)
    v_pk_add_f32 v[68:69], v[68:69], v[28:29]
    v_pk_add_f32 v[70:71], v[70:71], v[30:31]
    v_pk_fma_f32 v[128:129], v[68:69], v[18:19], v[128:129] op_sel_hi:[1,0,1]
    v_pk_fma_f32 v[130:131], v[70:71], v[18:19], v[130:131] op_sel_hi:[1,0,1]
    v_cvt_pk_bf16_f32 v86, v128, v129
    v_cvt_pk_bf16_f32 v87, v130, v131
    ds_write_b64 v6, v[86:87] offset:1024
    ds_read_b128 v[96:99], v5 offset:1024
    s_waitcnt lgkmcnt(7)
    v_pk_add_f32 v[72:73], v[72:73], v[40:41]
    v_pk_add_f32 v[74:75], v[74:75], v[42:43]
    v_pk_fma_f32 v[132:133], v[72:73], v[20:21], v[132:133] op_sel_hi:[1,0,1]
    v_pk_fma_f32 v[134:135], v[74:75], v[20:21], v[134:135] op_sel_hi:[1,0,1]
    v_cvt_pk_bf16_f32 v88, v132, v133
    v_cvt_pk_bf16_f32 v89, v134, v135
    ds_write_b64 v1, v[88:89] offset:2048
    s_waitcnt lgkmcnt(7)
    v_pk_add_f32 v[76:77], v[76:77], v[44:45]
    v_pk_add_f32 v[78:79], v[78:79], v[46:47]
    v_pk_fma_f32 v[136:137], v[76:77], v[20:21], v[136:137] op_sel_hi:[1,0,1]
    v_pk_fma_f32 v[138:139], v[78:79], v[20:21], v[138:139] op_sel_hi:[1,0,1]
    v_cvt_pk_bf16_f32 v90, v136, v137
    v_cvt_pk_bf16_f32 v91, v138, v139
    ds_write_b64 v6, v[90:91] offset:2048
    ds_read_b128 v[100:103], v5 offset:2048
    s_waitcnt lgkmcnt(6)
    buffer_store_dwordx4 v[92:95], v2, s[48:51], s79 offen
    s_add_u32 s79, s79, 20480
    s_waitcnt lgkmcnt(3)
    buffer_store_dwordx4 v[96:99], v2, s[48:51], s79 offen
    s_add_u32 s79, s79, 20480
    s_waitcnt lgkmcnt(0)
    buffer_store_dwordx4 v[100:103], v2, s[48:51], s79 offen
L_pexit:
    s_endpgm
L_lts:
    s_mov_b32 s100, 0
Lw_61:
    ds_read_b32 v4, v164 offset:80
    s_waitcnt lgkmcnt(0)
    v_readfirstlane_b32 s99, v4
    s_cmp_ge_u32 s99, 1
    s_cbranch_scc1 Lwd_62
    s_add_u32 s100, s100, 1
    s_cmp_lt_u32 s100, 8388608
    s_cbranch_scc1 Lw_61
Lwd_62:
    s_branch L_ltg
L_fxw:
    s_mov_b32 s100, 0
Lw_63:
    ds_read_b32 v4, v165 offset:64
    s_waitcnt lgkmcnt(0)
    v_readfirstlane_b32 s99, v4
    s_cmp_ge_u32 s99, 1
    s_cbranch_scc1 Lwd_64
    s_add_u32 s100, s100, 1
    s_cmp_lt_u32 s100, 8388608
    s_cbranch_scc1 Lw_63
Lwd_64:
    ds_read_b32 v21, v166 offset:48
    ds_read2_b32 v[16:17], v162 offset0:0 offset1:16
    ds_read_b32 v20, v162 offset:128
    ds_read_b128 v[116:119], v7 offset:0
    ds_read_b128 v[120:123], v7 offset:1024
    ds_read_b128 v[124:127], v7 offset:4096
    ds_read_b128 v[128:131], v7 offset:5120
    ds_read_b128 v[132:135], v7 offset:8192
    ds_read_b128 v[136:139], v7 offset:9216
    s_waitcnt lgkmcnt(8)
    s_branch L_fb
L_fyw:
    s_mov_b32 s100, 0
Lw_65:
    ds_read_b32 v4, v166 offset:48
    s_waitcnt lgkmcnt(0)
    v_readfirstlane_b32 s99, v4
    s_cmp_ge_u32 s99, 2
    s_cbranch_scc1 Lwd_66
    s_add_u32 s100, s100, 1
    s_cmp_lt_u32 s100, 8388608
    s_cbranch_scc1 Lw_65
Lwd_66:
    ds_read2_b32 v[16:17], v162 offset0:0 offset1:16
    ds_read_b32 v20, v162 offset:128
    ds_read_b128 v[116:119], v7 offset:0
    ds_read_b128 v[120:123], v7 offset:1024
    ds_read_b128 v[124:127], v7 offset:4096
    ds_read_b128 v[128:131], v7 offset:5120
    ds_read_b128 v[132:135], v7 offset:8192
    ds_read_b128 v[136:139], v7 offset:9216
    s_waitcnt lgkmcnt(0)
    s_branch L_yok
L_fslow:
    s_mov_b32 s100, 0
L_fs2:
    ds_read2_b32 v[120:121], v3 offset0:0 offset1:4
    s_waitcnt lgkmcnt(0)
    v_add_u32 v120, v120, v121
    s_nop 0
    v_readfirstlane_b32 s97, v120
    s_cmp_ge_u32 s97, s84
    s_cbranch_scc1 L_fgo
    s_add_u32 s100, s100, 1
    s_cmp_lt_u32 s100, 8388608
    s_cbranch_scc1 L_fs2
    s_branch L_fgo
L_ns0:
    s_load_dwordx16 s[4:19], s[76:77], 0 glc
    s_waitcnt lgkmcnt(0)
    s_add_u32 s100, s100, 1
    s_cmp_lt_u32 s100, 1048576
    s_cbranch_scc1 L_nb0
    s_branch L_ng0
L_ns1:
    s_load_dwordx16 s[4:19], s[76:77], 0 glc
    s_waitcnt lgkmcnt(0)
    s_add_u32 s100, s100, 1
    s_cmp_lt_u32 s100, 1048576
    s_cbranch_scc1 L_nb1
    s_branch L_ng1
L_ns2:
    s_load_dwordx16 s[4:19], s[76:77], 0 glc
    s_waitcnt lgkmcnt(0)
    s_add_u32 s100, s100, 1
    s_cmp_lt_u32 s100, 1048576
    s_cbranch_scc1 L_nb2
    s_branch L_ng2
L_ns3:
    s_load_dwordx16 s[4:19], s[76:77], 0 glc
    s_waitcnt lgkmcnt(0)
    s_add_u32 s100, s100, 1
    s_cmp_lt_u32 s100, 1048576
    s_cbranch_scc1 L_nb3
    s_branch L_ng3
L_ns4:
    s_load_dwordx16 s[4:19], s[76:77], 0 glc
    s_waitcnt lgkmcnt(0)
    s_add_u32 s100, s100, 1
    s_cmp_lt_u32 s100, 1048576
    s_cbranch_scc1 L_nb4
    s_branch L_ng4
L_ns6:
    s_load_dwordx16 s[4:19], s[76:77], 0 glc
    s_waitcnt lgkmcnt(0)
    s_add_u32 s100, s100, 1
    s_cmp_lt_u32 s100, 1048576
    s_cbranch_scc1 L_nb6
    s_branch L_ng6
L_end:
    s_endpgm
L_codeend:
.section .rodata,"a"
.p2align 6
.amdhsa_kernel gated_mix__ssm_conv_h3__sliding_local_dilated__prompt_kernel
  .amdhsa_next_free_vgpr 168
  .amdhsa_next_free_sgpr 102
  .amdhsa_accum_offset 168
  .amdhsa_group_segment_fixed_size 0
  .amdhsa_kernarg_size 104
  .amdhsa_user_sgpr_count 2
  .amdhsa_user_sgpr_kernarg_segment_ptr 1
  .amdhsa_system_sgpr_workgroup_id_x 1
.end_amdhsa_kernel
.p2align 7
wg_table:
  .long 0, 0, 0, 96, 0, 0, 1985229328, 152
  .long 0, 5, 0, 206, 0, 0, 554272613, 67
  .long 5, 3, 3, 124, 1, 614400, 2440463413, 32
  .long 5, 8, 3, 234, 1, 614400, 1176582528, 117
  .long 11, 0, 0, 151, 3, 1351680, 328730199, 66
  .long 11, 5, 0, 261, 3, 1351680, 1749242114, 151
  .long 16, 3, 3, 179, 4, 1966080, 1695754249, 116
  .long 16, 8, 3, 289, 4, 1966080, 275280724, 41
  .long 0, 1, 1, 97, 0, 0, 2268413985, 150
  .long 0, 6, 1, 207, 0, 0, 847287670, 65
  .long 5, 4, 4, 125, 1, 614400, 159868227, 33
  .long 5, 9, 4, 235, 1, 614400, 1412567192, 118
  .long 11, 1, 1, 152, 6, 1351680, 554272613, 67
  .long 11, 6, 1, 262, 6, 1351680, 1985229328, 152
  .long 16, 4, 4, 180, 7, 1966080, 1176582528, 117
  .long 16, 9, 4, 290, 7, 1966080, 2440463413, 32
  .long 0, 2, 2, 98, 0, 0, 1749242114, 151
  .long 0, 7, 2, 208, 0, 0, 328730199, 66
  .long 6, 0, 0, 126, 7, 737280, 159868227, 33
  .long 6, 5, 0, 236, 7, 737280, 1412567192, 118
  .long 11, 2, 2, 153, 6, 1351680, 847287670, 65
  .long 11, 7, 2, 263, 6, 1351680, 2268413985, 150
  .long 17, 0, 0, 181, 0, 2088960, 1176582528, 117
  .long 17, 5, 0, 291, 0, 2088960, 2440463413, 32
  .long 0, 3, 3, 99, 3, 0, 1985229328, 152
  .long 0, 8, 3, 209, 3, 0, 554272613, 67
  .long 6, 1, 1, 127, 7, 737280, 275280724, 41
  .long 6, 6, 1, 237, 7, 737280, 1695754249, 116
  .long 11, 3, 3, 154, 6, 1351680, 328730199, 66
  .long 11, 8, 3, 264, 6, 1351680, 1749242114, 151
  .long 17, 1, 1, 182, 3, 2088960, 1412567192, 118
  .long 17, 6, 1, 292, 3, 2088960, 159868227, 33
  .long 0, 4, 4, 100, 3, 0, 2268413985, 150
  .long 0, 9, 4, 210, 3, 0, 847287670, 65
  .long 6, 2, 2, 128, 9, 737280, 2440463413, 32
  .long 6, 7, 2, 238, 9, 737280, 1176582528, 117
  .long 11, 4, 4, 155, 9, 1351680, 554272613, 67
  .long 11, 9, 4, 265, 9, 1351680, 1985229328, 152
  .long 17, 2, 2, 183, 3, 2088960, 1695754249, 116
  .long 17, 7, 2, 293, 3, 2088960, 275280724, 41
  .long 1, 0, 0, 101, 2, 122880, 2268413985, 150
  .long 1, 5, 0, 211, 2, 122880, 847287670, 65
  .long 6, 3, 3, 129, 0, 737280, 159868227, 33
  .long 6, 8, 3, 239, 0, 737280, 1412567192, 118
  .long 12, 0, 0, 156, 5, 1474560, 554272613, 67
  .long 12, 5, 0, 266, 5, 1474560, 1985229328, 152
  .long 17, 3, 3, 184, 3, 2088960, 1176582528, 117
  .long 17, 8, 3, 294, 3, 2088960, 2440463413, 32
  .long 1, 1, 1, 102, 2, 122880, 1749242114, 151
  .long 1, 6, 1, 212, 2, 122880, 328730199, 66
  .long 6, 4, 4, 130, 0, 737280, 275280724, 41
  .long 6, 9, 4, 240, 0, 737280, 1695754249, 116
  .long 12, 1, 1, 157, 8, 1474560, 847287670, 65
  .long 12, 6, 1, 267, 8, 1474560, 2268413985, 150
  .long 17, 4, 4, 185, 6, 2088960, 1412567192, 118
  .long 17, 9, 4, 295, 6, 2088960, 159868227, 33
  .long 1, 2, 2, 103, 2, 122880, 1985229328, 152
  .long 1, 7, 2, 213, 2, 122880, 554272613, 67
  .long 7, 0, 0, 131, 6, 860160, 275280724, 41
  .long 7, 5, 0, 241, 6, 860160, 1695754249, 116
  .long 12, 2, 2, 158, 8, 1474560, 328730199, 66
  .long 12, 7, 2, 268, 8, 1474560, 1749242114, 151
  .long 18, 0, 0, 186, 2, 2211840, 1412567192, 118
  .long 18, 5, 0, 296, 2, 2211840, 159868227, 33
  .long 1, 3, 3, 104, 5, 122880, 2268413985, 150
  .long 1, 8, 3, 214, 5, 122880, 847287670, 65
  .long 7, 1, 1, 132, 6, 860160, 2440463413, 32
  .long 7, 6, 1, 242, 6, 860160, 1176582528, 117
  .long 12, 3, 3, 159, 8, 1474560, 554272613, 67
  .long 12, 8, 3, 269, 8, 1474560, 1985229328, 152
  .long 18, 1, 1, 187, 5, 2211840, 1695754249, 116
  .long 18, 6, 1, 297, 5, 2211840, 275280724, 41
  .long 1, 4, 4, 105, 5, 122880, 1749242114, 151
  .long 1, 9, 4, 215, 5, 122880, 328730199, 66
  .long 7, 2, 2, 133, 9, 860160, 159868227, 33
  .long 7, 7, 2, 243, 9, 860160, 1412567192, 118
  .long 12, 4, 4, 160, 9, 1474560, 847287670, 65
  .long 12, 9, 4, 270, 9, 1474560, 2268413985, 150
  .long 18, 2, 2, 188, 5, 2211840, 1176582528, 117
  .long 18, 7, 2, 298, 5, 2211840, 2440463413, 32
  .long 2, 0, 0, 106, 1, 245760, 1749242114, 151
  .long 2, 5, 0, 216, 1, 245760, 328730199, 66
  .long 7, 3, 3, 134, 2, 860160, 275280724, 41
  .long 7, 8, 3, 244, 2, 860160, 1695754249, 116
  .long 13, 0, 0, 161, 4, 1597440, 847287670, 65
  .long 13, 5, 0, 271, 4, 1597440, 2268413985, 150
  .long 18, 3, 3, 189, 5, 2211840, 1412567192, 118
  .long 18, 8, 3, 299, 5, 2211840, 159868227, 33
  .long 2, 1, 1, 107, 1, 245760, 1985229328, 152
  .long 2, 6, 1, 217, 1, 245760, 554272613, 67
  .long 7, 4, 4, 135, 2, 860160, 2440463413, 32
  .long 7, 9, 4, 245, 2, 860160, 1176582528, 117
  .long 13, 1, 1, 162, 7, 1597440, 328730199, 66
  .long 13, 6, 1, 272, 7, 1597440, 1749242114, 151
  .long 18, 4, 4, 190, 8, 2211840, 1695754249, 116
  .long 18, 9, 4, 300, 8, 2211840, 275280724, 41
  .long 2, 2, 2, 108, 1, 245760, 2268413985, 150
  .long 2, 7, 2, 218, 1, 245760, 847287670, 65
  .long 8, 0, 0, 136, 8, 983040, 2440463413, 32
  .long 8, 5, 0, 246, 8, 983040, 1176582528, 117
  .long 13, 2, 2, 163, 7, 1597440, 554272613, 67
  .long 13, 7, 2, 273, 7, 1597440, 1985229328, 152
  .long 19, 0, 0, 191, 1, 2334720, 1695754249, 116
  .long 19, 5, 0, 301, 1, 2334720, 275280724, 41
  .long 2, 3, 3, 109, 4, 245760, 1749242114, 151
  .long 2, 8, 3, 219, 4, 245760, 328730199, 66
  .long 8, 1, 1, 137, 8, 983040, 159868227, 33
  .long 8, 6, 1, 247, 8, 983040, 1412567192, 118
  .long 13, 3, 3, 164, 7, 1597440, 847287670, 65
  .long 13, 8, 3, 274, 7, 1597440, 2268413985, 150
  .long 19, 1, 1, 192, 4, 2334720, 1176582528, 117
  .long 19, 6, 1, 302, 4, 2334720, 2440463413, 32
  .long 2, 4, 4, 110, 4, 245760, 1985229328, 152
  .long 2, 9, 4, 220, 4, 245760, 554272613, 67
  .long 8, 2, 2, 138, 9, 983040, 275280724, 41
  .long 8, 7, 2, 248, 9, 983040, 1695754249, 116
  .long 13, 4, 4, 165, 9, 1597440, 328730199, 66
  .long 13, 9, 4, 275, 9, 1597440, 1749242114, 151
  .long 19, 2, 2, 193, 4, 2334720, 1412567192, 118
  .long 19, 7, 2, 303, 4, 2334720, 159868227, 33
  .long 3, 0, 0, 111, 0, 368640, 1985229328, 152
  .long 3, 5, 0, 221, 0, 368640, 554272613, 67
  .long 8, 3, 3, 139, 1, 983040, 2440463413, 32
  .long 8, 8, 3, 249, 1, 983040, 1176582528, 117
  .long 14, 0, 0, 166, 3, 1720320, 328730199, 66
  .long 14, 5, 0, 276, 3, 1720320, 1749242114, 151
  .long 19, 3, 3, 194, 4, 2334720, 1695754249, 116
  .long 19, 8, 3, 304, 4, 2334720, 275280724, 41
  .long 3, 1, 1, 112, 0, 368640, 2268413985, 150
  .long 3, 6, 1, 222, 0, 368640, 847287670, 65
  .long 8, 4, 4, 140, 1, 983040, 159868227, 33
  .long 8, 9, 4, 250, 1, 983040, 1412567192, 118
  .long 14, 1, 1, 167, 6, 1720320, 554272613, 67
  .long 14, 6, 1, 277, 6, 1720320, 1985229328, 152
  .long 19, 4, 4, 195, 7, 2334720, 1176582528, 117
  .long 19, 9, 4, 305, 7, 2334720, 2440463413, 32
  .long 3, 2, 2, 113, 0, 368640, 1749242114, 151
  .long 3, 7, 2, 223, 0, 368640, 328730199, 66
  .long 9, 0, 0, 141, 7, 1105920, 159868227, 33
  .long 9, 5, 0, 251, 7, 1105920, 1412567192, 118
  .long 14, 2, 2, 168, 6, 1720320, 847287670, 65
  .long 14, 7, 2, 278, 6, 1720320, 2268413985, 150
  .long 20, 0, 0, 196, 0, 2457600, 1176582528, 117
  .long 20, 5, 0, 306, 0, 2457600, 2440463413, 32
  .long 3, 3, 3, 114, 3, 368640, 1985229328, 152
  .long 3, 8, 3, 224, 3, 368640, 554272613, 67
  .long 9, 1, 1, 142, 7, 1105920, 275280724, 41
  .long 9, 6, 1, 252, 7, 1105920, 1695754249, 116
  .long 14, 3, 3, 169, 6, 1720320, 328730199, 66
  .long 14, 8, 3, 279, 6, 1720320, 1749242114, 151
  .long 20, 1, 1, 197, 3, 2457600, 1412567192, 118
  .long 20, 6, 1, 307, 3, 2457600, 159868227, 33
  .long 3, 4, 4, 115, 3, 368640, 2268413985, 150
  .long 3, 9, 4, 225, 3, 368640, 847287670, 65
  .long 9, 2, 2, 143, 9, 1105920, 2440463413, 32
  .long 9, 7, 2, 253, 9, 1105920, 1176582528, 117
  .long 14, 4, 4, 170, 9, 1720320, 554272613, 67
  .long 14, 9, 4, 280, 9, 1720320, 1985229328, 152
  .long 20, 2, 2, 198, 3, 2457600, 1695754249, 116
  .long 20, 7, 2, 308, 3, 2457600, 275280724, 41
  .long 4, 0, 0, 116, 2, 491520, 2268413985, 150
  .long 4, 5, 0, 226, 2, 491520, 847287670, 65
  .long 9, 3, 3, 144, 0, 1105920, 159868227, 33
  .long 9, 8, 3, 254, 0, 1105920, 1412567192, 118
  .long 15, 0, 0, 171, 5, 1843200, 554272613, 67
  .long 15, 5, 0, 281, 5, 1843200, 1985229328, 152
  .long 20, 3, 3, 199, 3, 2457600, 1176582528, 117
  .long 20, 8, 3, 309, 3, 2457600, 2440463413, 32
  .long 4, 1, 1, 117, 2, 491520, 1749242114, 151
  .long 4, 6, 1, 227, 2, 491520, 328730199, 66
  .long 9, 4, 4, 145, 0, 1105920, 275280724, 41
  .long 9, 9, 4, 255, 0, 1105920, 1695754249, 116
  .long 15, 1, 1, 172, 8, 1843200, 847287670, 65
  .long 15, 6, 1, 282, 8, 1843200, 2268413985, 150
  .long 20, 4, 4, 200, 6, 2457600, 1412567192, 118
  .long 20, 9, 4, 310, 6, 2457600, 159868227, 33
  .long 4, 2, 2, 118, 2, 491520, 1985229328, 152
  .long 4, 7, 2, 228, 2, 491520, 554272613, 67
  .long 10, 0, 0, 146, 6, 1228800, 275280724, 41
  .long 10, 5, 0, 256, 6, 1228800, 1695754249, 116
  .long 15, 2, 2, 173, 8, 1843200, 328730199, 66
  .long 15, 7, 2, 283, 8, 1843200, 1749242114, 151
  .long 21, 0, 0, 201, 2, 2580480, 1412567192, 118
  .long 21, 5, 0, 311, 2, 2580480, 159868227, 33
  .long 4, 3, 3, 119, 5, 491520, 2268413985, 150
  .long 4, 8, 3, 229, 5, 491520, 847287670, 65
  .long 10, 1, 1, 147, 6, 1228800, 2440463413, 32
  .long 10, 6, 1, 257, 6, 1228800, 1176582528, 117
  .long 15, 3, 3, 174, 8, 1843200, 554272613, 67
  .long 15, 8, 3, 284, 8, 1843200, 1985229328, 152
  .long 21, 1, 1, 202, 5, 2580480, 1695754249, 116
  .long 21, 6, 1, 312, 5, 2580480, 275280724, 41
  .long 4, 4, 4, 120, 5, 491520, 1749242114, 151
  .long 4, 9, 4, 230, 5, 491520, 328730199, 66
  .long 10, 2, 2, 148, 9, 1228800, 159868227, 33
  .long 10, 7, 2, 258, 9, 1228800, 1412567192, 118
  .long 15, 4, 4, 175, 9, 1843200, 847287670, 65
  .long 15, 9, 4, 285, 9, 1843200, 2268413985, 150
  .long 21, 2, 2, 203, 5, 2580480, 1176582528, 117
  .long 21, 7, 2, 313, 5, 2580480, 2440463413, 32
  .long 5, 0, 0, 121, 1, 614400, 1749242114, 151
  .long 5, 5, 0, 231, 1, 614400, 328730199, 66
  .long 10, 3, 3, 149, 2, 1228800, 275280724, 41
  .long 10, 8, 3, 259, 2, 1228800, 1695754249, 116
  .long 16, 0, 0, 176, 4, 1966080, 847287670, 65
  .long 16, 5, 0, 286, 4, 1966080, 2268413985, 150
  .long 21, 3, 3, 204, 5, 2580480, 1412567192, 118
  .long 21, 8, 3, 314, 5, 2580480, 159868227, 33
  .long 5, 1, 1, 122, 1, 614400, 1985229328, 152
  .long 5, 6, 1, 232, 1, 614400, 554272613, 67
  .long 10, 4, 4, 150, 2, 1228800, 2440463413, 32
  .long 10, 9, 4, 260, 2, 1228800, 1176582528, 117
  .long 16, 1, 1, 177, 7, 1966080, 328730199, 66
  .long 16, 6, 1, 287, 7, 1966080, 1749242114, 151
  .long 21, 4, 4, 205, 8, 2580480, 1695754249, 116
  .long 21, 9, 4, 315, 8, 2580480, 275280724, 41
  .long 5, 2, 2, 123, 1, 614400, 2268413985, 150
  .long 5, 7, 2, 233, 1, 614400, 847287670, 65
  .long 0, 0, 0, 8, 0, 0, 0, 0
  .long 0, 1, 0, 9, 0, 0, 0, 0
  .long 16, 2, 2, 178, 7, 1966080, 554272613, 67
  .long 16, 7, 2, 288, 7, 1966080, 1985229328, 152
  .long 0, 0, 0, 26, 0, 0, 0, 0
  .long 0, 1, 0, 27, 0, 0, 0, 0
  .long 0, 0, 0, 0, 0, 0, 0, 0
  .long 0, 1, 0, 1, 0, 0, 0, 0
  .long 0, 0, 0, 10, 0, 0, 0, 0
  .long 0, 1, 0, 11, 0, 0, 0, 0
  .long 0, 0, 0, 18, 0, 0, 0, 0
  .long 0, 1, 0, 19, 0, 0, 0, 0
  .long 0, 0, 0, 28, 0, 0, 0, 0
  .long 0, 1, 0, 29, 0, 0, 0, 0
  .long 0, 0, 0, 2, 0, 0, 0, 0
  .long 0, 1, 0, 3, 0, 0, 0, 0
  .long 0, 0, 0, 12, 0, 0, 0, 0
  .long 0, 1, 0, 13, 0, 0, 0, 0
  .long 0, 0, 0, 20, 0, 0, 0, 0
  .long 0, 1, 0, 21, 0, 0, 0, 0
  .long 0, 0, 0, 30, 0, 0, 0, 0
  .long 0, 1, 0, 31, 0, 0, 0, 0
  .long 0, 0, 0, 4, 0, 0, 0, 0
  .long 0, 1, 0, 5, 0, 0, 0, 0
  .long 0, 0, 0, 14, 0, 0, 0, 0
  .long 0, 1, 0, 15, 0, 0, 0, 0
  .long 0, 0, 0, 22, 0, 0, 0, 0
  .long 0, 1, 0, 23, 0, 0, 0, 0
  .long 0, 0, 0, 316, 0, 0, 0, 0
  .long 0, 1, 0, 317, 0, 0, 0, 0
  .long 0, 0, 0, 6, 0, 0, 0, 0
  .long 0, 1, 0, 7, 0, 0, 0, 0
  .long 0, 0, 0, 16, 0, 0, 0, 0
  .long 0, 1, 0, 17, 0, 0, 0, 0
  .long 0, 0, 0, 24, 0, 0, 0, 0
  .long 0, 1, 0, 25, 0, 0, 0, 0
  .long 0, 0, 0, 318, 0, 0, 0, 0
  .long 0, 1, 0, 319, 0, 0, 0, 0
```

```asm
; @launch grid=(256,1,1) block=(768,1,1) lds=163840
.amdgcn_target "amdgcn-amd-amdhsa--gfx950"
.text
.globl gated_mix__ssm_conv_h3__sliding_local_dilated__prompt_kernel
.p2align 8
.type gated_mix__ssm_conv_h3__sliding_local_dilated__prompt_kernel,@function
gated_mix__ssm_conv_h3__sliding_local_dilated__prompt_kernel:
    s_load_dwordx16 s[4:19], s[0:1], 0
    s_getpc_b64 s[46:47]
L_pc:
    s_add_u32 s44, s46, wg_table@rel32@lo+4
    s_addc_u32 s45, s47, wg_table@rel32@hi+12
    s_and_b32 s97, s2, 255
    s_lshl_b32 s97, s97, 5
    s_load_dwordx8 s[32:39], s[44:45], s97
    s_lshr_b32 s96, s2, 3
    s_lshl_b32 s97, s96, 7
    v_lshl_add_u32 v5, v0, 12, s97
    v_cmp_gt_u32 vcc, L_codeend-L_pc-4, v5
    s_and_saveexec_b64 s[50:51], vcc
    s_cbranch_execz L_nopf
    global_load_dword v166, v5, s[46:47]
L_nopf:
    s_mov_b64 exec, -1
    s_load_dwordx8 s[20:27], s[0:1], 64
    s_load_dwordx2 s[28:29], s[0:1], 96
    v_lshrrev_b32 v4, 6, v0
    v_and_b32 v0, 63, v0
    v_readfirstlane_b32 s30, v4
    s_cmp_ge_u32 s96, 32
    s_cbranch_scc1 L_end
    v_lshrrev_b32 v2, 4, v0
    v_and_b32 v1, 15, v0
    v_lshrrev_b32 v4, 3, v0
    v_and_b32 v5, 7, v0
    s_lshl_b32 s99, s2, 2
    s_lshr_b32 s99, 0x55445544, s99
    s_and_b32 s99, s99, 15
    s_add_u32 s99, s99, s96
    s_lshr_b32 s3, s99, 5
    s_cbranch_scc1 L_a
    s_cmp_ge_u32 s30, 3
    s_cbranch_scc1 L_notld
    s_setprio 3
    s_mov_b32 s51, 0
    s_mul_i32 s52, s30, 12288
    s_addk_i32 s52, 2048
    s_min_u32 s98, s30, 1
    s_lshr_b32 s54, s30, 1
    s_mul_i32 s54, s54, 122880
    v_lshlrev_b32 v6, s98, v2
    v_and_b32 v6, 3, v6
    v_xor_b32 v5, v5, v6
    s_mulk_i32 s98, 2560
    s_addk_i32 s98, 1280
    v_mul_u32_u24 v4, s98, v4
    v_lshl_add_u32 v8, v5, 4, v4
    v_xor_b32 v9, 64, v8
    s_lshl_b32 s56, s98, 3
    s_mov_b32 s43, 0x00020000
    s_cmp_eq_u32 s30, 0
    s_cselect_b32 s57, s56, 4294876416
    s_movk_i32 s58, 128
    s_cselect_b32 s58, s58, 245760
    s_mov_b32 s42, 2621440
    s_cselect_b32 s42, s42, 2457600
    s_waitcnt lgkmcnt(0)
    s_cselect_b64 s[40:41], s[4:5], s[18:19]
    s_mul_i32 s96, s33, 128
    s_cselect_b32 s96, s37, s96
    s_add_u32 s54, s54, s96
L_ld:
    s_and_b32 s53, s38, 15
    s_lshr_b64 s[38:39], s[38:39], 4
    s_mov_b32 m0, s52
    s_mul_i32 s96, s53, s58
    s_add_u32 s50, s96, s54
    buffer_load_dwordx4 v8, s[40:43], s50 offen lds
    s_add_u32 m0, m0, 1024
    s_add_u32 s50, s50, s56
    buffer_load_dwordx4 v9, s[40:43], s50 offen lds
    s_add_u32 m0, m0, 1024
    s_add_u32 s50, s50, s56
    buffer_load_dwordx4 v8, s[40:43], s50 offen lds
    s_add_u32 m0, m0, 1024
    s_add_u32 s50, s50, s56
    buffer_load_dwordx4 v9, s[40:43], s50 offen lds
    s_add_u32 m0, m0, 1024
    s_add_u32 s50, s50, s57
    buffer_load_dwordx4 v8, s[40:43], s50 offen lds
    s_add_u32 m0, m0, 1024
    s_add_u32 s50, s50, s56
    buffer_load_dwordx4 v9, s[40:43], s50 offen lds
    s_add_u32 m0, m0, 1024
    s_add_u32 s50, s50, s56
    buffer_load_dwordx4 v8, s[40:43], s50 offen lds
    s_add_u32 m0, m0, 1024
    s_add_u32 s50, s50, s56
    buffer_load_dwordx4 v9, s[40:43], s50 offen lds
    s_add_u32 m0, m0, 1024
    s_add_u32 s50, s50, s57
    buffer_load_dwordx4 v8, s[40:43], s50 offen lds
    s_add_u32 m0, m0, 1024
    s_add_u32 s50, s50, s56
    buffer_load_dwordx4 v9, s[40:43], s50 offen lds
    s_add_u32 m0, m0, 1024
    s_add_u32 s50, s50, s56
    buffer_load_dwordx4 v8, s[40:43], s50 offen lds
    s_add_u32 m0, m0, 1024
    s_add_u32 s50, s50, s56
    buffer_load_dwordx4 v9, s[40:43], s50 offen lds
    s_cmp_lg_u32 s30, 0
    s_cbranch_scc1 L_ldw
    s_sub_u32 s55, s54, 20480
    s_cselect_b32 s55, 0x40000000, s55
    s_sub_u32 m0, s52, 2048
    s_add_u32 s50, s96, s55
    buffer_load_dwordx4 v8, s[40:43], s50 offen lds
    s_add_u32 m0, m0, 1024
    s_add_u32 s50, s50, s56
    buffer_load_dwordx4 v9, s[40:43], s50 offen lds
L_ldw:
    s_add_u32 s52, s52, 38912
    s_cmp_ge_u32 s52, 116736
    s_cselect_b32 s96, 116736, 0
    s_sub_u32 s52, s52, s96
    s_add_u32 s51, s51, 1
    s_cmp_lt_u32 s51, 2
    s_cbranch_scc1 L_ld
    s_cmp_lg_u32 s51, 3
    s_cbranch_scc1 L_ldt
    s_load_dword s31, s[28:29], 0
L_ldt:
    s_cmp_lg_u32 s51, 10
    s_cbranch_scc1 L_ldp
    s_lshl_b32 s92, s2, 7
    s_and_b32 s92, s92, 0x1f80
    s_load_dwordx2 s[86:87], s[28:29], s92 offset:8192
L_ldp:
    s_waitcnt vmcnt(14) lgkmcnt(0)
    s_cmp_eq_u32 s30, 0
    s_cbranch_scc1 L_ldb
    s_waitcnt vmcnt(12)
L_ldb:
    s_barrier
    s_cmp_lt_u32 s51, 10
    s_cbranch_scc1 L_ld
    s_setprio 0
    v_mov_b32 v3, 160960
    s_mov_b32 s101, 1
    s_cmp_lg_u32 s30, 0
    s_cbranch_scc1 L_ps
    s_branch L_s0
L_a:
    s_lshr_b32 s96, s30, 2
    s_lshl_b32 s98, s96, 5
    s_mul_i32 s41, s96, 42752
    s_add_u32 s41, s41, 1024
    s_mov_b32 s54, s41
    s_branch L_c
L_notld:
    s_cmp_lt_u32 s30, 8
    s_cbranch_scc1 L_hg
    s_mov_b32 s98, 0
    s_mov_b32 s41, 116736
    s_mov_b32 s54, 116736
L_c:
    s_and_b32 s40, s30, 3
    v_mul_u32_u24 v4, 1280, v4
    v_lshrrev_b32 v6, 1, v2
    v_xor_b32 v5, v5, v6
    s_lshl_b32 s96, s40, 2
    s_and_b32 s96, s96, 4
    v_xor_b32 v5, s96, v5
    v_lshl_add_u32 v22, v5, 4, v4
    v_xor_b32 v23, 32, v22
    s_waitcnt lgkmcnt(0)
    s_add_u32 s43, s35, s98
    s_cmp_ge_u32 s43, 320
    s_cbranch_scc1 L_idle
    s_lshr_b32 s55, s43, 5
    s_and_b32 s63, s43, 31
    s_lshl2_add_u32 s96, s55, s40
    s_lshl_b32 s96, s96, 7
    v_lshl_add_u32 v21, v1, 3, s96
    v_lshlrev_b32 v12, 4, v0
    s_lshr_b32 s96, s40, 1
    s_lshl1_add_u32 s42, s43, s96
    s_mul_i32 s96, s96, 8320
    s_add_u32 s96, s96, s41
    s_add_u32 s62, s96, 16960
    s_and_b32 s97, s40, 1
    s_lshl_b32 s98, s97, 11
    s_add_u32 s60, s98, s62
    s_lshl_b32 s96, s42, 12
    s_add_u32 s61, s96, s98
    s_mov_b32 s46, 2621440
    s_mov_b32 s47, 0x00020000
    s_mov_b64 s[50:51], s[46:47]
    s_setprio 1
    s_cmp_ge_u32 s30, 4
    s_cbranch_scc1 L_c2
    s_lshl2_add_u32 s96, s63, s40
    s_mul_i32 s96, s96, 20480
    s_lshl_b32 s97, s55, 7
    s_add_u32 s96, s96, s97
    s_lshl_b32 s97, s40, 11
    s_add_u32 s97, s97, s41
    s_add_u32 m0, s97, 8704
    s_add_u32 s98, s96, 9216
    s_waitcnt lgkmcnt(0)
    s_mov_b64 s[48:49], s[8:9]
    buffer_load_dwordx4 v22, s[48:51], s96 offen lds
    buffer_load_dwordx4 v23, s[48:51], s98 offen offset:1024 lds
    s_sub_u32 m0, m0, 8192
    s_mov_b64 s[44:45], s[6:7]
    buffer_load_dwordx4 v22, s[44:47], s96 offen lds
    buffer_load_dwordx4 v23, s[44:47], s98 offen offset:1024 lds
    global_load_dwordx2 v[14:15], v21, s[10:11]
    s_cmp_lg_u32 s40, 3
    s_cbranch_scc1 Lkv_1
    s_sub_u32 s96, s96, 71680
    s_cselect_b32 s96, 0x40000000, s96
    s_sub_u32 m0, s41, 512
    s_mov_b32 exec_lo, 0
    buffer_load_dwordx4 v23, s[44:47], s96 offen lds
    s_mov_b32 exec_lo, -1
Lkv_1:
    s_mov_b64 s[48:49], s[12:13]
    s_mov_b32 m0, s60
    s_sub_u32 s96, s61, 16
    s_bitcmp1_b32 s40, 0
    s_cselect_b32 s96, s96, 0x40000000
    buffer_load_dwordx4 v12, s[48:51], s61 offen lds
    buffer_load_dwordx4 v12, s[48:51], s61 offen offset:1024 lds
    s_sub_u32 m0, s60, 16
    s_mov_b64 exec, 1
    buffer_load_dwordx4 v12, s[48:51], s96 offen lds
    s_mov_b64 exec, -1
L_c2:
    s_lshr_b32 s96, s30, 2
    s_lshl_b32 s96, s96, 6
    s_add_u32 s96, s96, 160768
    v_mov_b32 v3, s96
    v_mov_b32 v6, 0
    s_lshl_b32 s96, s40, 8
    s_add_u32 s96, s96, s41
    v_lshl_add_u32 v5, v0, 2, s96
    ds_write_b32 v5, v6 offset:41728
    s_mul_i32 s96, s40, 4160
    s_add_u32 s96, s96, s41
    v_lshl_add_u32 v5, v1, 2, s96
    ds_write_b32 v5, v6 offset:16896
    v_lshl_add_u32 v5, v1, 2, v3
    ds_write_b32 v5, v6
    v_and_b32 v4, 1, v2
    v_lshrrev_b32 v5, 1, v2
    v_lshlrev_b32 v6, 2, v1
    v_sub_u32 v6, v6, v4
    s_add_u32 s96, s41, 256
    v_lshl_add_u32 v6, v6, 7, s96
    s_lshl_b32 s97, s40, 1
    v_or_b32 v7, s97, v5
    v_sub_u32 v9, v1, v4
    v_subrev_u32 v10, 1, v1
    v_xor_b32 v8, v1, v7
    v_and_b32 v8, 7, v8
    v_lshl_add_u32 v8, v8, 4, v6
    v_xor_b32 v9, v9, v7
    v_and_b32 v9, 7, v9
    v_lshl_add_u32 v9, v9, 4, v6
    v_xor_b32 v10, v10, v7
    v_and_b32 v10, 7, v10
    v_lshl_add_u32 v10, v10, 4, v6
    v_mul_u32_u24 v7, 136, v4
    v_add_u32 v13, v8, v7
    v_and_b32 v6, 1, v1
    v_xor_b32 v16, v4, v6
    v_lshlrev_b32 v16, 4, v16
    v_lshlrev_b32 v6, 4, v6
    v_mov_b32 v7, 0xffff
    v_lshlrev_b32 v6, v6, v7
    v_lshrrev_b32 v7, 1, v1
    v_lshlrev_b32 v5, 2, v5
    v_sub_u32 v7, v7, v5
    v_cmp_eq_u32 vcc, 0, v7
    s_nop 1
    v_cndmask_b32 v17, 0, v6, vcc
    v_cmp_eq_u32 vcc, 1, v7
    s_nop 1
    v_cndmask_b32 v18, 0, v6, vcc
    v_cmp_eq_u32 vcc, 2, v7
    s_nop 1
    v_cndmask_b32 v19, 0, v6, vcc
    v_cmp_eq_u32 vcc, 3, v7
    s_nop 1
    v_cndmask_b32 v20, 0, v6, vcc
    v_not_b32 v4, v0
    v_bfe_u32 v5, v4, 1, 2
    v_lshlrev_b32 v5, 4, v5
    v_bfe_u32 v6, v4, 3, 1
    v_lshl_add_u32 v5, v6, 7, v5
    v_xor_b32 v6, s63, v4
    v_and_b32 v6, 1, v6
    v_lshl_add_u32 v5, v6, 6, v5
    v_lshl_add_u32 v5, v2, 14, v5
    s_lshl2_add_u32 s96, s55, s40
    s_lshl_b32 s97, s96, 16
    s_lshl_b32 s98, s63, 8
    s_sub_u32 s97, s97, s98
    s_add_u32 s97, s97, 2105088
    v_add_u32 v11, s97, v5
    s_lshl_b32 s97, s96, 10
    s_lshl2_add_u32 s97, s63, s97
    s_add_u32 s64, s97, 65536
    s_and_b32 s96, s43, -8
    s_cmp_ge_u32 s55, 3
    s_cselect_b32 s96, s96, s43
    s_lshl_b32 s96, s96, 7
    s_add_u32 s65, s96, 65536
    s_waitcnt lgkmcnt(0)
    s_load_dword s31, s[28:29], 0
    s_lshl_b32 s96, s43, 2
    s_load_dword s53, s[14:15], s96
    s_cmp_lg_u32 s3, 0
    s_cbranch_scc1 L_akv
    s_mul_i32 s96, s36, 43
    s_lshr_b32 s96, s96, 7
    s_mul_i32 s96, s96, 3
    s_sub_u32 s96, s36, s96
    s_mul_i32 s97, s96, 38912
    v_lshrrev_b32 v4, 1, v1
    v_lshrrev_b32 v5, 1, v2
    v_xor_b32 v4, v4, v5
    s_lshl_b32 s96, s40, 1
    v_xor_b32 v4, s96, v4
    v_lshlrev_b32 v4, 4, v4
    v_lshl_add_u32 v4, v1, 7, v4
    v_and_b32 v5, 1, v2
    v_lshl_add_u32 v4, v5, 3, v4
    v_add_u32 v166, s97, v4
    s_barrier
    s_cmp_lg_u32 s36, 0
    s_cbranch_scc1 Lq_2
    ds_read_b64 v[112:113], v166 offset:2048
    ds_read_b64 v[114:115], v166 offset:4096
    ds_read_b64 v[116:117], v166 offset:6144
    ds_read_b64 v[118:119], v166 offset:8192
    ds_read_b64 v[120:121], v166 offset:10240
    ds_read_b64 v[122:123], v166 offset:12288
    s_waitcnt lgkmcnt(0)
Lq_2:
    s_setprio 0
    s_cmp_eq_u32 s32, 21
    s_cselect_b32 s97, 0xc0, 0
    v_add_u32 v4, 0, v0
    v_mul_u32_u24 v5, 5462, v4
    v_lshrrev_b32 v5, 16, v5
    v_lshrrev_b32 v6, 1, v5
    v_mul_u32_u24 v5, 3904, v5
    v_lshl_add_u32 v5, v6, 13, v5
    v_lshl_add_u32 v144, v4, 4, v5
    v_and_b32 v5, s97, v144
    v_lshl_add_u32 v144, v5, 22, v144
    v_add_u32 v4, 64, v0
    v_mul_u32_u24 v5, 5462, v4
    v_lshrrev_b32 v5, 16, v5
    v_lshrrev_b32 v6, 1, v5
    v_mul_u32_u24 v5, 3904, v5
    v_lshl_add_u32 v5, v6, 13, v5
    v_lshl_add_u32 v145, v4, 4, v5
    v_and_b32 v5, s97, v145
    v_lshl_add_u32 v145, v5, 22, v145
    v_add_u32 v4, 128, v0
    v_mul_u32_u24 v5, 5462, v4
    v_lshrrev_b32 v5, 16, v5
    v_lshrrev_b32 v6, 1, v5
    v_mul_u32_u24 v5, 3904, v5
    v_lshl_add_u32 v5, v6, 13, v5
    v_lshl_add_u32 v146, v4, 4, v5
    v_and_b32 v5, s97, v146
    v_lshl_add_u32 v146, v5, 22, v146
    s_xor_b32 s96, s40, 1
    s_lshl_b32 s96, s96, 12
    s_add_u32 s96, s96, 116736
    v_lshrrev_b32 v4, 2, v0
    v_mul_u32_u24 v4, 192, v4
    v_and_b32 v5, 3, v0
    v_lshl_add_u32 v4, v5, 3, v4
    v_add_u32 v147, s96, v4
L_cs:
    s_and_b32 s97, s40, 1
    v_add_u32 v156, s60, v12
    s_lshl_b32 s98, s97, 8
    s_add_u32 s96, s62, s98
    s_add_u32 s96, s96, 4132
    v_lshrrev_b32 v4, 1, v1
    v_lshl_add_u32 v4, v2, 2, v4
    v_lshl_add_u32 v4, v4, 2, s96
    v_and_b32 v5, 1, v1
    v_mul_u32_u24 v5, 4160, v5
    v_sub_u32 v148, v4, v5
    v_add_u32 v149, 1024, v148
    v_add_u32 v150, 2048, v148
    v_add_u32 v151, 3072, v148
    v_lshlrev_b32 v4, 1, v1
    v_sub_u32 v4, v2, v4
    s_lshl_b32 s98, s97, 4
    s_add_u32 s98, s98, 30
    v_add_u32 v4, s98, v4
    s_lshr_b32 s98, s40, 1
    s_add_u32 s96, s41, 33536
    v_and_b32 v5, 3, v4
    v_lshl_add_u32 v5, v5, 4, s96
    v_lshrrev_b32 v6, 2, v4
    v_lshl_add_u32 v5, v6, 7, v5
    v_bfe_u32 v6, v4, 3, 1
    v_xor_b32 v6, s98, v6
    v_lshl_add_u32 v152, v6, 6, v5
    v_xor_b32 v154, 64, v152
    v_add_u32 v4, 4, v4
    v_and_b32 v5, 3, v4
    v_lshl_add_u32 v5, v5, 4, s96
    v_lshrrev_b32 v6, 2, v4
    v_lshl_add_u32 v5, v6, 7, v5
    v_bfe_u32 v6, v4, 3, 1
    v_xor_b32 v6, s98, v6
    v_lshl_add_u32 v153, v6, 6, v5
    v_xor_b32 v155, 64, v153
    v_and_b32 v5, 1, v2
    v_lshlrev_b32 v5, 9, v5
    v_lshl_add_u32 v5, v1, 5, v5
    v_lshrrev_b32 v6, 1, v2
    v_lshl_add_u32 v5, v6, 4, v5
    s_lshl_b32 s96, s43, 14
    s_lshl_b32 s97, s40, 11
    s_and_b32 s97, s97, 4096
    s_add_u32 s96, s96, s97
    s_add_u32 s96, s96, 4718592
    s_lshr_b32 s100, s96, 8
    s_and_b32 s100, s100, 8192
    s_xor_b32 s96, s96, s100
    v_add_u32 v157, s96, v5
    s_mul_i32 s97, s55, 16640
    s_lshr_b32 s96, s63, 3
    s_lshl_b32 s96, s96, 7
    s_add_u32 s97, s97, s96
    s_and_b32 s96, s63, 7
    s_lshl3_add_u32 s97, s96, s97
    s_add_u32 s82, s97, 262144
    s_lshl_b32 s96, s40, 12
    s_add_u32 s96, s96, s54
    v_add_u32 v158, s96, v12
    s_xor_b32 s96, s40, 1
    s_lshl_b32 s96, s96, 12
    s_add_u32 s96, s96, s54
    v_add_u32 v159, s96, v12
    s_waitcnt lgkmcnt(0)
    s_mul_i32 s31, s31, 1664525
    s_add_u32 s31, s31, 1013904223
    s_mov_b32 s58, s31
    s_mov_b32 s59, s31
    s_add_u32 s56, s28, s65
    s_addc_u32 s57, s29, 0
    s_bitcmp1_b32 s40, 1
    s_cselect_b32 s96, 0, 16
    s_lshl_b32 s53, s53, s96
    s_and_b32 s53, s53, 0xffff0000
    s_bitcmp1_b32 s40, 0
    s_cselect_b32 s53, 0, s53
    s_cmp_lg_u32 s3, 0
    s_cbranch_scc1 L_asig
    s_setprio 1
    s_lshl2_add_u32 s96, s63, s40
    s_mul_i32 s96, s96, 20480
    s_lshl_b32 s97, s55, 7
    s_add_u32 s96, s96, s97
    s_lshl_b32 s97, s40, 11
    s_add_u32 s97, s97, s41
    s_add_u32 m0, s97, 8704
    s_add_u32 s98, s96, 9216
    s_waitcnt lgkmcnt(0)
    s_mov_b64 s[48:49], s[8:9]
    buffer_load_dwordx4 v22, s[48:51], s96 offen lds
    buffer_load_dwordx4 v23, s[48:51], s98 offen offset:1024 lds
    s_sub_u32 m0, m0, 8192
    s_mov_b64 s[44:45], s[6:7]
    buffer_load_dwordx4 v22, s[44:47], s96 offen lds
    buffer_load_dwordx4 v23, s[44:47], s98 offen offset:1024 lds
    global_load_dwordx2 v[14:15], v21, s[10:11]
    s_cmp_lg_u32 s40, 3
    s_cbranch_scc1 Lkv_3
    s_sub_u32 s96, s96, 71680
    s_cselect_b32 s96, 0x40000000, s96
    s_sub_u32 m0, s41, 512
    s_mov_b32 exec_lo, 0
    buffer_load_dwordx4 v23, s[44:47], s96 offen lds
    s_mov_b32 exec_lo, -1
Lkv_3:
    s_barrier
    s_cmp_lg_u32 s36, 1
    s_cbranch_scc1 Lq_4
    ds_read_b64 v[112:113], v166 offset:2048
    ds_read_b64 v[114:115], v166 offset:4096
    ds_read_b64 v[116:117], v166 offset:6144
    ds_read_b64 v[118:119], v166 offset:8192
    ds_read_b64 v[120:121], v166 offset:10240
    ds_read_b64 v[122:123], v166 offset:12288
    s_waitcnt lgkmcnt(0)
Lq_4:
    s_waitcnt vmcnt(0)
    s_mov_b64 s[48:49], s[12:13]
    s_barrier
    s_cmp_lg_u32 s36, 2
    s_cbranch_scc1 Lq_5
    ds_read_b64 v[112:113], v166 offset:2048
    ds_read_b64 v[114:115], v166 offset:4096
    ds_read_b64 v[116:117], v166 offset:6144
    ds_read_b64 v[118:119], v166 offset:8192
    ds_read_b64 v[120:121], v166 offset:10240
    ds_read_b64 v[122:123], v166 offset:12288
    s_waitcnt lgkmcnt(0)
Lq_5:
    s_branch L_kvc
L_akv:
    v_mov_b32 v144, 0
    v_mov_b32 v145, 0
    v_mov_b32 v146, 0
    s_barrier
    s_cmp_lt_u32 s30, 4
    s_cbranch_scc1 L_akw
    v_mov_b32 v5, 160768
    s_cmp_lt_u32 s30, 8
    s_cbranch_scc1 L_ak1
    s_mov_b32 s100, 0
Lw_6:
    ds_read_b32 v4, v5 offset:40
    s_waitcnt lgkmcnt(0)
    v_readfirstlane_b32 s99, v4
    s_cmp_ge_u32 s99, 5
    s_cbranch_scc1 Lwd_7
    s_sleep 2
    s_add_u32 s100, s100, 1
    s_cmp_lt_u32 s100, 8388608
    s_cbranch_scc1 Lw_6
Lwd_7:
L_ak1:
    s_lshl2_add_u32 s96, s63, s40
    s_mul_i32 s96, s96, 20480
    s_lshl_b32 s97, s55, 7
    s_add_u32 s96, s96, s97
    s_lshl_b32 s97, s40, 11
    s_add_u32 s97, s97, s41
    s_add_u32 m0, s97, 8704
    s_add_u32 s98, s96, 9216
    s_waitcnt lgkmcnt(0)
    s_mov_b64 s[48:49], s[8:9]
    buffer_load_dwordx4 v22, s[48:51], s96 offen lds
    buffer_load_dwordx4 v23, s[48:51], s98 offen offset:1024 lds
    s_sub_u32 m0, m0, 8192
    s_mov_b64 s[44:45], s[6:7]
    buffer_load_dwordx4 v22, s[44:47], s96 offen lds
    buffer_load_dwordx4 v23, s[44:47], s98 offen offset:1024 lds
    global_load_dwordx2 v[14:15], v21, s[10:11]
    s_cmp_lg_u32 s40, 3
    s_cbranch_scc1 Lkv_8
    s_sub_u32 s96, s96, 71680
    s_cselect_b32 s96, 0x40000000, s96
    s_sub_u32 m0, s41, 512
    s_mov_b32 exec_lo, 0
    buffer_load_dwordx4 v23, s[44:47], s96 offen lds
    s_mov_b32 exec_lo, -1
Lkv_8:
    s_mov_b64 s[48:49], s[12:13]
    s_mov_b32 m0, s60
    s_sub_u32 s96, s61, 16
    s_bitcmp1_b32 s40, 0
    s_cselect_b32 s96, s96, 0x40000000
    buffer_load_dwordx4 v12, s[48:51], s61 offen lds
    buffer_load_dwordx4 v12, s[48:51], s61 offen offset:1024 lds
    s_sub_u32 m0, s60, 16
    s_mov_b64 exec, 1
    buffer_load_dwordx4 v12, s[48:51], s96 offen lds
    s_mov_b64 exec, -1
L_akw:
    s_mov_b64 s[48:49], s[12:13]
    s_waitcnt vmcnt(3)
    v_mov_b32 v4, 1
    s_mov_b64 exec, 1
    ds_add_u32 v3, v4 offset:36
    s_mov_b64 exec, -1
    s_mov_b32 s100, 0
Lw_9:
    ds_read_b32 v4, v3 offset:36
    s_waitcnt lgkmcnt(0)
    v_readfirstlane_b32 s99, v4
    s_cmp_ge_u32 s99, 4
    s_cbranch_scc1 Lwd_10
    s_add_u32 s100, s100, 1
    s_cmp_lt_u32 s100, 8388608
    s_cbranch_scc1 Lw_9
Lwd_10:
L_kvc:
    ds_read_b128 v[32:35], v9 offset:256
    ds_read_b128 v[24:27], v10 offset:0
    ds_read_b128 v[36:39], v8 offset:384
    ds_read_b128 v[28:31], v10 offset:128
    ds_read_b128 v[40:43], v8 offset:512
    ds_read_b128 v[44:47], v8 offset:640
    ds_read_b64 v[48:49], v13 offset:8448
    ds_read_b64 v[50:51], v13 offset:8576
    ds_read_b64 v[52:53], v13 offset:8704
    ds_read_b64 v[54:55], v13 offset:8832
    v_alignbit_b32 v14, v14, v14, v16
    v_alignbit_b32 v15, v15, v15, v16
    v_and_b32 v72, v14, v17
    v_and_b32 v73, v14, v18
    v_and_b32 v74, v14, v19
    v_and_b32 v75, v14, v20
    v_and_b32 v76, v15, v17
    v_and_b32 v77, v15, v18
    v_and_b32 v78, v15, v19
    v_and_b32 v79, v15, v20
    s_mov_b32 s44, s28
    s_and_b32 s45, s29, 0xffff
    s_mov_b32 s46, 16777216
    s_mov_b32 s47, 0x00020000
    s_mov_b32 vcc_lo, 0xaaaaaaaa
    s_mov_b32 vcc_hi, 0xaaaaaaaa
    s_movk_i32 s96, 8192
    s_waitcnt lgkmcnt(0)
    v_mfma_f32_16x16x32_bf16 v[56:59], v[72:75], v[32:35], 0
    v_mfma_f32_16x16x32_bf16 v[56:59], v[76:79], v[24:27], v[56:59]
    v_lshlrev_b32 v96, 16, v48
    v_and_b32 v97, 0xffff0000, v48
    v_lshlrev_b32 v98, 16, v49
    v_and_b32 v99, 0xffff0000, v49
    v_mfma_f32_16x16x32_bf16 v[60:63], v[72:75], v[36:39], 0
    v_mfma_f32_16x16x32_bf16 v[60:63], v[76:79], v[28:31], v[60:63]
    v_lshlrev_b32 v100, 16, v50
    v_and_b32 v101, 0xffff0000, v50
    v_lshlrev_b32 v102, 16, v51
    v_and_b32 v103, 0xffff0000, v51
    v_mfma_f32_16x16x32_bf16 v[64:67], v[72:75], v[40:43], 0
    v_mfma_f32_16x16x32_bf16 v[64:67], v[76:79], v[32:35], v[64:67]
    v_lshlrev_b32 v104, 16, v52
    v_and_b32 v105, 0xffff0000, v52
    v_lshlrev_b32 v106, 16, v53
    v_and_b32 v107, 0xffff0000, v53
    v_mfma_f32_16x16x32_bf16 v[68:71], v[72:75], v[44:47], 0
    v_mfma_f32_16x16x32_bf16 v[68:71], v[76:79], v[36:39], v[68:71]
    v_lshlrev_b32 v108, 16, v54
    v_and_b32 v109, 0xffff0000, v54
    v_lshlrev_b32 v110, 16, v55
    v_and_b32 v111, 0xffff0000, v55
    v_mul_f32 v96, v56, v96
    v_mul_f32 v97, v57, v97
    v_mul_f32 v98, v58, v98
    v_mul_f32 v99, v59, v99
    v_mul_f32 v100, v60, v100
    v_mul_f32 v101, v61, v101
    v_mul_f32 v102, v62, v102
    v_mul_f32 v103, v63, v103
    v_mul_f32 v104, v64, v104
    v_mul_f32 v105, v65, v105
    v_mul_f32 v106, v66, v106
    v_mul_f32 v107, v67, v107
    v_mul_f32 v108, v68, v108
    v_mul_f32 v109, v69, v109
    v_mul_f32 v110, v70, v110
    v_mul_f32 v111, v71, v111
    v_cvt_pk_bf16_f32 v80, v108, v104
    v_cvt_pk_bf16_f32 v81, v100, v96
    v_cvt_pk_bf16_f32 v82, v109, v105
    v_cvt_pk_bf16_f32 v83, v101, v97
    v_cvt_pk_bf16_f32 v84, v110, v106
    v_cvt_pk_bf16_f32 v85, v102, v98
    v_cvt_pk_bf16_f32 v86, v111, v107
    v_cvt_pk_bf16_f32 v87, v103, v99
    v_cndmask_b32_dpp v88, v80, v82, vcc quad_perm:[1,0,3,2] row_mask:0xf bank_mask:0xf
    v_cndmask_b32_dpp v89, v81, v83, vcc quad_perm:[1,0,3,2] row_mask:0xf bank_mask:0xf
    v_cndmask_b32_dpp v92, v84, v86, vcc quad_perm:[1,0,3,2] row_mask:0xf bank_mask:0xf
    v_cndmask_b32_dpp v93, v85, v87, vcc quad_perm:[1,0,3,2] row_mask:0xf bank_mask:0xf
    s_not_b64 vcc, vcc
    v_cndmask_b32_dpp v90, v82, v80, vcc quad_perm:[1,0,3,2] row_mask:0xf bank_mask:0xf
    v_cndmask_b32_dpp v91, v83, v81, vcc quad_perm:[1,0,3,2] row_mask:0xf bank_mask:0xf
    buffer_store_dwordx4 v[88:91], v11, s[44:47], 0 offen sc1
    v_cndmask_b32_dpp v94, v86, v84, vcc quad_perm:[1,0,3,2] row_mask:0xf bank_mask:0xf
    v_cndmask_b32_dpp v95, v87, v85, vcc quad_perm:[1,0,3,2] row_mask:0xf bank_mask:0xf
    buffer_store_dwordx4 v[92:95], v11, s[44:47], s96 offen sc1
    s_cmp_eq_u32 s3, 0
    s_cbranch_scc1 L_gk
    v_mov_b32 v4, 1
    s_mov_b64 exec, 1
    ds_add_u32 v3, v4 offset:40
    s_mov_b64 exec, -1
    s_branch L_cs
L_gk:
    s_setprio 0
    s_mov_b32 s52, s40
    s_barrier
    s_cmp_lg_u32 s36, 3
    s_cbranch_scc1 Lq_11
    ds_read_b64 v[112:113], v166 offset:2048
    ds_read_b64 v[114:115], v166 offset:4096
    ds_read_b64 v[116:117], v166 offset:6144
    ds_read_b64 v[118:119], v166 offset:8192
    ds_read_b64 v[120:121], v166 offset:10240
    ds_read_b64 v[122:123], v166 offset:12288
    s_waitcnt lgkmcnt(0)
Lq_11:
    s_barrier
    s_cmp_lg_u32 s36, 4
    s_cbranch_scc1 Lq_12
    ds_read_b64 v[112:113], v166 offset:2048
    ds_read_b64 v[114:115], v166 offset:4096
    ds_read_b64 v[116:117], v166 offset:6144
    ds_read_b64 v[118:119], v166 offset:8192
    ds_read_b64 v[120:121], v166 offset:10240
    ds_read_b64 v[122:123], v166 offset:12288
    s_waitcnt lgkmcnt(0)
Lq_12:
    s_waitcnt vmcnt(0)
    s_atomic_swap s31, s[28:29], s64
    s_barrier
    s_cmp_lg_u32 s36, 5
    s_cbranch_scc1 Lq_13
    ds_read_b64 v[112:113], v166 offset:2048
    ds_read_b64 v[114:115], v166 offset:4096
    ds_read_b64 v[116:117], v166 offset:6144
    ds_read_b64 v[118:119], v166 offset:8192
    ds_read_b64 v[120:121], v166 offset:10240
    ds_read_b64 v[122:123], v166 offset:12288
    s_waitcnt lgkmcnt(0)
Lq_13:
    s_barrier
    s_cmp_lg_u32 s36, 6
    s_cbranch_scc1 Lq_14
    ds_read_b64 v[112:113], v166 offset:2048
    ds_read_b64 v[114:115], v166 offset:4096
    ds_read_b64 v[116:117], v166 offset:6144
    ds_read_b64 v[118:119], v166 offset:8192
    ds_read_b64 v[120:121], v166 offset:10240
    ds_read_b64 v[122:123], v166 offset:12288
    s_waitcnt lgkmcnt(0)
Lq_14:
    s_lshl_b32 s92, s2, 7
    s_and_b32 s92, s92, 0x1f80
    s_load_dwordx2 s[86:87], s[28:29], s92 offset:8192
    s_cmp_lg_u32 s52, 0
    s_cbranch_scc1 Lud_16
Lup_15:
    s_load_dwordx16 s[64:79], s[56:57], 0 glc
    s_load_dwordx16 s[4:19], s[56:57], 64 glc
Lud_16:
    s_barrier
    s_cmp_lg_u32 s36, 7
    s_cbranch_scc1 Lq_17
    ds_read_b64 v[112:113], v166 offset:2048
    ds_read_b64 v[114:115], v166 offset:4096
    ds_read_b64 v[116:117], v166 offset:6144
    ds_read_b64 v[118:119], v166 offset:8192
    ds_read_b64 v[120:121], v166 offset:10240
    ds_read_b64 v[122:123], v166 offset:12288
    s_waitcnt lgkmcnt(0)
Lq_17:
    s_cmp_lg_u32 s52, 0
    s_cbranch_scc1 Lud_19
Lup_18:
    s_waitcnt lgkmcnt(0)
    s_xor_b64 s[64:65], s[64:65], s[58:59]
    s_xor_b64 s[4:5], s[4:5], s[58:59]
    s_or_b64 s[64:65], s[64:65], s[4:5]
    s_xor_b64 s[66:67], s[66:67], s[58:59]
    s_xor_b64 s[6:7], s[6:7], s[58:59]
    s_or_b64 s[64:65], s[64:65], s[66:67]
    s_or_b64 s[64:65], s[64:65], s[6:7]
    s_xor_b64 s[68:69], s[68:69], s[58:59]
    s_xor_b64 s[8:9], s[8:9], s[58:59]
    s_or_b64 s[64:65], s[64:65], s[68:69]
    s_or_b64 s[64:65], s[64:65], s[8:9]
    s_xor_b64 s[70:71], s[70:71], s[58:59]
    s_xor_b64 s[10:11], s[10:11], s[58:59]
    s_or_b64 s[64:65], s[64:65], s[70:71]
    s_or_b64 s[64:65], s[64:65], s[10:11]
    s_xor_b64 s[72:73], s[72:73], s[58:59]
    s_xor_b64 s[12:13], s[12:13], s[58:59]
    s_or_b64 s[64:65], s[64:65], s[72:73]
    s_or_b64 s[64:65], s[64:65], s[12:13]
    s_xor_b64 s[74:75], s[74:75], s[58:59]
    s_xor_b64 s[14:15], s[14:15], s[58:59]
    s_or_b64 s[64:65], s[64:65], s[74:75]
    s_or_b64 s[64:65], s[64:65], s[14:15]
    s_xor_b64 s[76:77], s[76:77], s[58:59]
    s_xor_b64 s[16:17], s[16:17], s[58:59]
    s_or_b64 s[64:65], s[64:65], s[76:77]
    s_or_b64 s[64:65], s[64:65], s[16:17]
    s_xor_b64 s[78:79], s[78:79], s[58:59]
    s_xor_b64 s[18:19], s[18:19], s[58:59]
    s_or_b64 s[64:65], s[64:65], s[78:79]
    s_or_b64 s[64:65], s[64:65], s[18:19]
    s_cbranch_scc1 Lud_19
    s_mov_b32 s52, -1
Lud_19:
    s_cmp_lg_u32 s52, 0
    s_cbranch_scc1 Lud_21
Lup_20:
    s_load_dwordx16 s[64:79], s[56:57], 0 glc
    s_load_dwordx16 s[4:19], s[56:57], 64 glc
Lud_21:
    s_barrier
    s_cmp_lg_u32 s36, 8
    s_cbranch_scc1 Lq_22
    ds_read_b64 v[112:113], v166 offset:2048
    ds_read_b64 v[114:115], v166 offset:4096
    ds_read_b64 v[116:117], v166 offset:6144
    ds_read_b64 v[118:119], v166 offset:8192
    ds_read_b64 v[120:121], v166 offset:10240
    ds_read_b64 v[122:123], v166 offset:12288
    s_waitcnt lgkmcnt(0)
Lq_22:
    s_mov_b32 s100, 0
Lpo_23:
    s_waitcnt lgkmcnt(0)
    s_cmp_eq_u32 s86, s31
    s_cbranch_scc1 Lpd_24
    s_sleep 16
    s_load_dwordx2 s[86:87], s[28:29], s92 offset:8192 glc
    s_add_u32 s100, s100, 1
    s_cmp_lt_u32 s100, 1048576
    s_cbranch_scc1 Lpo_23
    s_waitcnt lgkmcnt(0)
Lpd_24:
    s_and_b32 s92, s87, 0x2000
    s_mov_b32 m0, s60
    s_sub_u32 s96, s61, 16
    s_bitcmp1_b32 s40, 0
    s_cselect_b32 s96, s96, 0x40000000
    buffer_load_dwordx4 v12, s[48:51], s61 offen lds
    buffer_load_dwordx4 v12, s[48:51], s61 offen offset:1024 lds
    s_sub_u32 m0, s60, 16
    s_mov_b64 exec, 1
    buffer_load_dwordx4 v12, s[48:51], s96 offen lds
    s_mov_b64 exec, -1
    s_cmp_lg_u32 s52, 0
    s_cbranch_scc1 Lud_26
Lup_25:
    s_waitcnt lgkmcnt(0)
    s_xor_b64 s[64:65], s[64:65], s[58:59]
    s_xor_b64 s[4:5], s[4:5], s[58:59]
    s_or_b64 s[64:65], s[64:65], s[4:5]
    s_xor_b64 s[66:67], s[66:67], s[58:59]
    s_xor_b64 s[6:7], s[6:7], s[58:59]
    s_or_b64 s[64:65], s[64:65], s[66:67]
    s_or_b64 s[64:65], s[64:65], s[6:7]
    s_xor_b64 s[68:69], s[68:69], s[58:59]
    s_xor_b64 s[8:9], s[8:9], s[58:59]
    s_or_b64 s[64:65], s[64:65], s[68:69]
    s_or_b64 s[64:65], s[64:65], s[8:9]
    s_xor_b64 s[70:71], s[70:71], s[58:59]
    s_xor_b64 s[10:11], s[10:11], s[58:59]
    s_or_b64 s[64:65], s[64:65], s[70:71]
    s_or_b64 s[64:65], s[64:65], s[10:11]
    s_xor_b64 s[72:73], s[72:73], s[58:59]
    s_xor_b64 s[12:13], s[12:13], s[58:59]
    s_or_b64 s[64:65], s[64:65], s[72:73]
    s_or_b64 s[64:65], s[64:65], s[12:13]
    s_xor_b64 s[74:75], s[74:75], s[58:59]
    s_xor_b64 s[14:15], s[14:15], s[58:59]
    s_or_b64 s[64:65], s[64:65], s[74:75]
    s_or_b64 s[64:65], s[64:65], s[14:15]
    s_xor_b64 s[76:77], s[76:77], s[58:59]
    s_xor_b64 s[16:17], s[16:17], s[58:59]
    s_or_b64 s[64:65], s[64:65], s[76:77]
    s_or_b64 s[64:65], s[64:65], s[16:17]
    s_xor_b64 s[78:79], s[78:79], s[58:59]
    s_xor_b64 s[18:19], s[18:19], s[58:59]
    s_or_b64 s[64:65], s[64:65], s[78:79]
    s_or_b64 s[64:65], s[64:65], s[18:19]
    s_cbranch_scc1 Lud_26
    s_mov_b32 s52, -1
Lud_26:
    s_cmp_lg_u32 s52, -1
    s_cbranch_scc1 Lui_27
    s_add_u32 m0, s41, 33536
    s_lshl_b32 s96, s43, 13
    s_add_u32 s96, s96, 2097152
    buffer_load_dwordx4 v12, s[44:47], s96 offen offset:0 sc1 lds
    buffer_load_dwordx4 v12, s[44:47], s96 offen offset:1024 sc1 lds
    buffer_load_dwordx4 v12, s[44:47], s96 offen offset:2048 sc1 lds
    buffer_load_dwordx4 v12, s[44:47], s96 offen offset:3072 sc1 lds
    s_add_u32 m0, m0, 4096
    s_add_u32 s96, s96, 4096
    buffer_load_dwordx4 v12, s[44:47], s96 offen offset:0 sc1 lds
    buffer_load_dwordx4 v12, s[44:47], s96 offen offset:1024 sc1 lds
    buffer_load_dwordx4 v12, s[44:47], s96 offen offset:2048 sc1 lds
    buffer_load_dwordx4 v12, s[44:47], s96 offen offset:3072 sc1 lds
    s_mov_b32 s52, 9
Lui_27:
    s_barrier
    s_cmp_lg_u32 s36, 9
    s_cbranch_scc1 Lq_28
    ds_read_b64 v[112:113], v166 offset:2048
    ds_read_b64 v[114:115], v166 offset:4096
    ds_read_b64 v[116:117], v166 offset:6144
    ds_read_b64 v[118:119], v166 offset:8192
    ds_read_b64 v[120:121], v166 offset:10240
    ds_read_b64 v[122:123], v166 offset:12288
    s_waitcnt lgkmcnt(0)
Lq_28:
    s_setprio 1
    v_mov_b32 v8, v112
    v_mov_b32 v9, v113
    v_mov_b32 v10, v114
    v_mov_b32 v11, v115
    v_mov_b32 v14, v116
    v_mov_b32 v15, v117
    v_mov_b32 v160, v118
    v_mov_b32 v161, v119
    v_mov_b32 v162, v120
    v_mov_b32 v163, v121
    v_mov_b32 v164, v122
    v_mov_b32 v165, v123
    s_waitcnt vmcnt(0)
    s_cmp_lg_u32 s52, 9
    s_cbranch_scc1 L_nul
    v_mov_b32 v4, 1
    ds_write_b32 v3, v4 offset:0
    s_mov_b32 s52, 1
L_nul:
    v_subrev_u32 v4, 4, v156
    ds_read_b32 v21, v4 offset:0
    ds_read_b128 v[22:25], v156 offset:0
    ds_read_b32 v29, v4 offset:1024
    ds_read_b128 v[30:33], v156 offset:1024
    s_waitcnt lgkmcnt(0)
    s_mov_b64 exec, 1
    v_lshlrev_b32 v26, 16, v22
    v_and_b32 v27, 0xffff0000, v22
    v_add_f32 v26, s53, v26
    v_cvt_pk_bf16_f32 v22, v26, v27
    ds_write_b32 v156, v22
    s_mov_b64 exec, -1
    v_alignbit_b32 v40, v22, v21, 16
    v_alignbit_b32 v41, v23, v22, 16
    v_alignbit_b32 v42, v24, v23, 16
    v_alignbit_b32 v43, v25, v24, 16
    ds_write_b128 v156, v[40:43] offset:4160
    v_alignbit_b32 v44, v30, v29, 16
    v_alignbit_b32 v45, v31, v30, 16
    v_alignbit_b32 v46, v32, v31, 16
    v_alignbit_b32 v47, v33, v32, 16
    ds_write_b128 v156, v[44:47] offset:5184
    s_waitcnt lgkmcnt(0)
    s_setprio 1
    s_barrier
    ds_read_b32 v5, v3 offset:0
    ds_read2_b32 v[48:49], v148 offset0:0 offset1:1
    ds_read2_b32 v[50:51], v148 offset0:2 offset1:3
    ds_read2_b32 v[52:53], v148 offset0:128 offset1:129
    ds_read2_b32 v[54:55], v148 offset0:130 offset1:131
    ds_read2_b32 v[56:57], v149 offset0:0 offset1:1
    ds_read2_b32 v[58:59], v149 offset0:2 offset1:3
    ds_read2_b32 v[60:61], v149 offset0:128 offset1:129
    ds_read2_b32 v[62:63], v149 offset0:130 offset1:131
    ds_read2_b32 v[64:65], v150 offset0:0 offset1:1
    ds_read2_b32 v[66:67], v150 offset0:2 offset1:3
    ds_read2_b32 v[68:69], v150 offset0:128 offset1:129
    ds_read2_b32 v[70:71], v150 offset0:130 offset1:131
    s_waitcnt lgkmcnt(6)
    ds_read2_b32 v[72:73], v151 offset0:0 offset1:1
    ds_read2_b32 v[74:75], v151 offset0:2 offset1:3
    ds_read2_b32 v[76:77], v151 offset0:128 offset1:129
    ds_read2_b32 v[78:79], v151 offset0:130 offset1:131
    v_readfirstlane_b32 s81, v5
    s_waitcnt lgkmcnt(6)
    ds_read_b128 v[108:111], v152 offset:0
    ds_read_b128 v[104:107], v152 offset:1024
    ds_read_b128 v[100:103], v152 offset:2048
    ds_read_b128 v[96:99], v152 offset:3072
    ds_read_b128 v[92:95], v152 offset:4096
    ds_read_b128 v[88:91], v152 offset:5120
    ds_read_b128 v[84:87], v152 offset:6144
    ds_read_b128 v[80:83], v152 offset:7168
    s_cmp_lg_u32 s81, 0
    s_cbranch_scc1 L_conv2
L_upoll:
    s_cmp_lg_u32 s52, 0
    s_cbranch_scc1 Lud_30
    s_mov_b32 s100, 0
Lup_29:
    s_load_dwordx16 s[64:79], s[56:57], 0 glc
    s_load_dwordx16 s[4:19], s[56:57], 64 glc
    s_waitcnt lgkmcnt(0)
    s_xor_b64 s[64:65], s[64:65], s[58:59]
    s_xor_b64 s[4:5], s[4:5], s[58:59]
    s_or_b64 s[64:65], s[64:65], s[4:5]
    s_xor_b64 s[66:67], s[66:67], s[58:59]
    s_xor_b64 s[6:7], s[6:7], s[58:59]
    s_or_b64 s[64:65], s[64:65], s[66:67]
    s_or_b64 s[64:65], s[64:65], s[6:7]
    s_xor_b64 s[68:69], s[68:69], s[58:59]
    s_xor_b64 s[8:9], s[8:9], s[58:59]
    s_or_b64 s[64:65], s[64:65], s[68:69]
    s_or_b64 s[64:65], s[64:65], s[8:9]
    s_xor_b64 s[70:71], s[70:71], s[58:59]
    s_xor_b64 s[10:11], s[10:11], s[58:59]
    s_or_b64 s[64:65], s[64:65], s[70:71]
    s_or_b64 s[64:65], s[64:65], s[10:11]
    s_xor_b64 s[72:73], s[72:73], s[58:59]
    s_xor_b64 s[12:13], s[12:13], s[58:59]
    s_or_b64 s[64:65], s[64:65], s[72:73]
    s_or_b64 s[64:65], s[64:65], s[12:13]
    s_xor_b64 s[74:75], s[74:75], s[58:59]
    s_xor_b64 s[14:15], s[14:15], s[58:59]
    s_or_b64 s[64:65], s[64:65], s[74:75]
    s_or_b64 s[64:65], s[64:65], s[14:15]
    s_xor_b64 s[76:77], s[76:77], s[58:59]
    s_xor_b64 s[16:17], s[16:17], s[58:59]
    s_or_b64 s[64:65], s[64:65], s[76:77]
    s_or_b64 s[64:65], s[64:65], s[16:17]
    s_xor_b64 s[78:79], s[78:79], s[58:59]
    s_xor_b64 s[18:19], s[18:19], s[58:59]
    s_or_b64 s[64:65], s[64:65], s[78:79]
    s_or_b64 s[64:65], s[64:65], s[18:19]
    s_cbranch_scc0 Lug_31
    s_add_u32 s100, s100, 1
    s_cmp_lt_u32 s100, 1048576
    s_cbranch_scc1 Lup_29
Lug_31:
    s_mov_b32 s52, -1
Lud_30:
    s_cmp_lg_u32 s52, -1
    s_cbranch_scc1 Lui_32
    s_add_u32 m0, s41, 33536
    s_lshl_b32 s96, s43, 13
    s_add_u32 s96, s96, 2097152
    buffer_load_dwordx4 v12, s[44:47], s96 offen offset:0 sc1 lds
    buffer_load_dwordx4 v12, s[44:47], s96 offen offset:1024 sc1 lds
    buffer_load_dwordx4 v12, s[44:47], s96 offen offset:2048 sc1 lds
    buffer_load_dwordx4 v12, s[44:47], s96 offen offset:3072 sc1 lds
    s_add_u32 m0, m0, 4096
    s_add_u32 s96, s96, 4096
    buffer_load_dwordx4 v12, s[44:47], s96 offen offset:0 sc1 lds
    buffer_load_dwordx4 v12, s[44:47], s96 offen offset:1024 sc1 lds
    buffer_load_dwordx4 v12, s[44:47], s96 offen offset:2048 sc1 lds
    buffer_load_dwordx4 v12, s[44:47], s96 offen offset:3072 sc1 lds
    s_mov_b32 s52, 9
Lui_32:
    s_cmp_lg_u32 s52, 9
    s_cbranch_scc1 L_uwait
    v_mov_b32 v4, 1
    s_mov_b64 exec, 1
    ds_add_u32 v3, v4 offset:40
    s_mov_b64 exec, -1
    s_waitcnt vmcnt(0)
    v_mov_b32 v4, 1
    ds_write_b32 v3, v4 offset:0
L_uwait:
    s_mov_b32 s100, 0
Lw_33:
    ds_read_b32 v4, v3 offset:0
    s_waitcnt lgkmcnt(0)
    v_readfirstlane_b32 s99, v4
    s_cmp_ge_u32 s99, 1
    s_cbranch_scc1 Lwd_34
    s_sleep 1
    s_add_u32 s100, s100, 1
    s_cmp_lt_u32 s100, 8388608
    s_cbranch_scc1 Lw_33
Lwd_34:
    s_cmp_eq_u32 s3, 0
    s_cbranch_scc1 L_conv
    s_branch L_touch
L_asig:
    s_waitcnt vmcnt(2)
    v_subrev_u32 v4, 4, v156
    ds_read_b32 v21, v4 offset:0
    ds_read_b128 v[22:25], v156 offset:0
    ds_read_b32 v29, v4 offset:1024
    ds_read_b128 v[30:33], v156 offset:1024
    s_waitcnt lgkmcnt(0)
    s_mov_b64 exec, 1
    v_lshlrev_b32 v26, 16, v22
    v_and_b32 v27, 0xffff0000, v22
    v_add_f32 v26, s53, v26
    v_cvt_pk_bf16_f32 v22, v26, v27
    ds_write_b32 v156, v22
    s_mov_b64 exec, -1
    v_alignbit_b32 v40, v22, v21, 16
    v_alignbit_b32 v41, v23, v22, 16
    v_alignbit_b32 v42, v24, v23, 16
    v_alignbit_b32 v43, v25, v24, 16
    ds_write_b128 v156, v[40:43] offset:4160
    v_alignbit_b32 v44, v30, v29, 16
    v_alignbit_b32 v45, v31, v30, 16
    v_alignbit_b32 v46, v32, v31, 16
    v_alignbit_b32 v47, v33, v32, 16
    ds_write_b128 v156, v[44:47] offset:5184
    s_waitcnt lgkmcnt(0)
    v_mov_b32 v4, 1
    s_mov_b64 exec, 1
    ds_add_u32 v3, v4 offset:32
    s_mov_b64 exec, -1
    v_lshl_add_u32 v6, v0, 7, s64
    v_mov_b32 v5, s31
    s_cmp_ge_u32 s55, 3
    s_cselect_b32 s97, 1, 0xff
    s_waitcnt vmcnt(0)
    s_mov_b32 exec_hi, 0
    s_mov_b32 exec_lo, s97
    global_atomic_swap v6, v5, s[28:29] sc1
    s_mov_b64 exec, -1
    s_mov_b32 s100, 0
Lw_35:
    ds_read_b32 v4, v3 offset:32
    s_waitcnt lgkmcnt(0)
    v_readfirstlane_b32 s99, v4
    s_cmp_ge_u32 s99, 4
    s_cbranch_scc1 Lwd_36
    s_sleep 1
    s_add_u32 s100, s100, 1
    s_cmp_lt_u32 s100, 8388608
    s_cbranch_scc1 Lw_35
Lwd_36:
    ds_read2_b32 v[48:49], v148 offset0:0 offset1:1
    ds_read2_b32 v[50:51], v148 offset0:2 offset1:3
    ds_read2_b32 v[52:53], v148 offset0:128 offset1:129
    ds_read2_b32 v[54:55], v148 offset0:130 offset1:131
    ds_read2_b32 v[56:57], v149 offset0:0 offset1:1
    ds_read2_b32 v[58:59], v149 offset0:2 offset1:3
    ds_read2_b32 v[60:61], v149 offset0:128 offset1:129
    ds_read2_b32 v[62:63], v149 offset0:130 offset1:131
    ds_read2_b32 v[64:65], v150 offset0:0 offset1:1
    ds_read2_b32 v[66:67], v150 offset0:2 offset1:3
    ds_read2_b32 v[68:69], v150 offset0:128 offset1:129
    ds_read2_b32 v[70:71], v150 offset0:130 offset1:131
    s_waitcnt lgkmcnt(6)
    ds_read2_b32 v[72:73], v151 offset0:0 offset1:1
    ds_read2_b32 v[74:75], v151 offset0:2 offset1:3
    ds_read2_b32 v[76:77], v151 offset0:128 offset1:129
    ds_read2_b32 v[78:79], v151 offset0:130 offset1:131
    s_mov_b32 s52, s40
    s_branch L_upoll
L_touch:
    s_cmp_lg_u32 s55, 1
    s_cbranch_scc1 L_conv
    s_lshl2_add_u32 s96, s63, s40
    s_mul_i32 s96, s96, 14336
    s_add_u32 s96, s96, 786432
    v_lshlrev_b32 v4, 7, v0
    s_add_u32 s97, s96, 8192
    buffer_load_dword v160, v4, s[48:51], s96 offen
    s_mov_b32 exec_hi, 0xffff
    buffer_load_dword v160, v4, s[48:51], s97 offen
    s_mov_b32 exec_hi, -1
L_conv:
    s_setprio 1
    ds_read_b128 v[108:111], v152 offset:0
    ds_read_b128 v[104:107], v152 offset:1024
    ds_read_b128 v[100:103], v152 offset:2048
    ds_read_b128 v[96:99], v152 offset:3072
    ds_read_b128 v[92:95], v152 offset:4096
    ds_read_b128 v[88:91], v152 offset:5120
    ds_read_b128 v[84:87], v152 offset:6144
    ds_read_b128 v[80:83], v152 offset:7168
L_conv2:

    s_waitcnt lgkmcnt(7)
    v_mfma_f32_16x16x32_bf16 v[44:47], v[48:51], v[108:111], 0
    s_waitcnt lgkmcnt(6)
    v_mfma_f32_16x16x32_bf16 v[40:43], v[48:51], v[104:107], 0
    ds_read_b128 v[140:143], v153 offset:0
    s_waitcnt lgkmcnt(6)
    v_mfma_f32_16x16x32_bf16 v[36:39], v[48:51], v[100:103], 0
    s_waitcnt lgkmcnt(5)
    v_mfma_f32_16x16x32_bf16 v[32:35], v[48:51], v[96:99], 0
    ds_read_b128 v[136:139], v153 offset:1024
    s_waitcnt lgkmcnt(5)
    v_mfma_f32_16x16x32_bf16 v[28:31], v[48:51], v[92:95], 0
    s_waitcnt lgkmcnt(4)
    v_mfma_f32_16x16x32_bf16 v[24:27], v[48:51], v[88:91], 0
    ds_read_b128 v[132:135], v153 offset:2048
    s_waitcnt lgkmcnt(4)
    v_mfma_f32_16x16x32_bf16 v[20:23], v[48:51], v[84:87], 0
    s_waitcnt lgkmcnt(3)
    v_mfma_f32_16x16x32_bf16 v[16:19], v[48:51], v[80:83], 0
    ds_read_b128 v[128:131], v153 offset:3072
    v_mfma_f32_16x16x32_bf16 v[44:47], v[52:55], v[104:107], v[44:47]
    v_mfma_f32_16x16x32_bf16 v[40:43], v[52:55], v[100:103], v[40:43]
    ds_read2_b32 v[48:49], v148 offset0:16 offset1:17
    v_mfma_f32_16x16x32_bf16 v[36:39], v[52:55], v[96:99], v[36:39]
    v_mfma_f32_16x16x32_bf16 v[32:35], v[52:55], v[92:95], v[32:35]
    ds_read2_b32 v[50:51], v148 offset0:18 offset1:19
    v_mfma_f32_16x16x32_bf16 v[28:31], v[52:55], v[88:91], v[28:31]
    v_mfma_f32_16x16x32_bf16 v[24:27], v[52:55], v[84:87], v[24:27]
    ds_read_b128 v[124:127], v153 offset:4096
    v_mfma_f32_16x16x32_bf16 v[20:23], v[52:55], v[80:83], v[20:23]
    v_mfma_f32_16x16x32_bf16 v[44:47], v[56:59], v[100:103], v[44:47]
    v_mfma_f32_16x16x32_bf16 v[40:43], v[56:59], v[96:99], v[40:43]
    ds_read2_b32 v[52:53], v148 offset0:144 offset1:145
    v_mfma_f32_16x16x32_bf16 v[36:39], v[56:59], v[92:95], v[36:39]
    v_mfma_f32_16x16x32_bf16 v[32:35], v[56:59], v[88:91], v[32:35]
    ds_read2_b32 v[54:55], v148 offset0:146 offset1:147
    v_mfma_f32_16x16x32_bf16 v[28:31], v[56:59], v[84:87], v[28:31]
    v_mfma_f32_16x16x32_bf16 v[24:27], v[56:59], v[80:83], v[24:27]
    ds_read_b128 v[120:123], v153 offset:5120
    v_mfma_f32_16x16x32_bf16 v[44:47], v[60:63], v[96:99], v[44:47]
    v_mfma_f32_16x16x32_bf16 v[40:43], v[60:63], v[92:95], v[40:43]
    ds_read2_b32 v[56:57], v149 offset0:16 offset1:17
    v_mfma_f32_16x16x32_bf16 v[36:39], v[60:63], v[88:91], v[36:39]
    v_mfma_f32_16x16x32_bf16 v[32:35], v[60:63], v[84:87], v[32:35]
    ds_read2_b32 v[58:59], v149 offset0:18 offset1:19
    v_mfma_f32_16x16x32_bf16 v[28:31], v[60:63], v[80:83], v[28:31]
    v_mfma_f32_16x16x32_bf16 v[44:47], v[64:67], v[92:95], v[44:47]
    ds_read2_b32 v[60:61], v149 offset0:144 offset1:145
    v_mfma_f32_16x16x32_bf16 v[40:43], v[64:67], v[88:91], v[40:43]
    ds_read2_b32 v[62:63], v149 offset0:146 offset1:147
    v_mfma_f32_16x16x32_bf16 v[36:39], v[64:67], v[84:87], v[36:39]
    ds_read_b128 v[116:119], v153 offset:6144
    v_mfma_f32_16x16x32_bf16 v[32:35], v[64:67], v[80:83], v[32:35]
    s_waitcnt lgkmcnt(13)
    ds_read_b128 v[112:115], v153 offset:7168
    v_mfma_f32_16x16x32_bf16 v[44:47], v[68:71], v[88:91], v[44:47]
    ds_read2_b32 v[64:65], v150 offset0:16 offset1:17
    v_mfma_f32_16x16x32_bf16 v[40:43], v[68:71], v[84:87], v[40:43]
    s_waitcnt lgkmcnt(13)
    ds_read2_b32 v[66:67], v150 offset0:18 offset1:19
    v_mfma_f32_16x16x32_bf16 v[36:39], v[68:71], v[80:83], v[36:39]
    v_mfma_f32_16x16x32_bf16 v[44:47], v[72:75], v[84:87], v[44:47]
    ds_read2_b32 v[68:69], v150 offset0:144 offset1:145
    v_mfma_f32_16x16x32_bf16 v[40:43], v[72:75], v[80:83], v[40:43]
    s_waitcnt lgkmcnt(13)
    ds_read2_b32 v[70:71], v150 offset0:146 offset1:147
    v_mfma_f32_16x16x32_bf16 v[44:47], v[76:79], v[80:83], v[44:47]
    ds_read2_b32 v[72:73], v151 offset0:16 offset1:17
    s_waitcnt lgkmcnt(13)
    ds_read2_b32 v[76:77], v151 offset0:144 offset1:145
    ds_read2_b32 v[78:79], v151 offset0:146 offset1:147
    s_waitcnt lgkmcnt(13)
    ds_read2_b32 v[74:75], v151 offset0:18 offset1:19
    v_mfma_f32_16x16x32_bf16 v[44:47], v[48:51], v[140:143], v[44:47]
    v_mfma_f32_16x16x32_bf16 v[40:43], v[48:51], v[136:139], v[40:43]
    ds_read_b128 v[108:111], v154 offset:256
    v_mfma_f32_16x16x32_bf16 v[36:39], v[48:51], v[132:135], v[36:39]
    v_mfma_f32_16x16x32_bf16 v[32:35], v[48:51], v[128:131], v[32:35]
    s_waitcnt lgkmcnt(13)
    ds_read_b128 v[104:107], v154 offset:1280
    v_mfma_f32_16x16x32_bf16 v[28:31], v[48:51], v[124:127], v[28:31]
    v_mfma_f32_16x16x32_bf16 v[24:27], v[48:51], v[120:123], v[24:27]
    ds_read_b128 v[100:103], v154 offset:2304
    s_waitcnt lgkmcnt(12)
    v_mfma_f32_16x16x32_bf16 v[20:23], v[48:51], v[116:119], v[20:23]
    s_waitcnt lgkmcnt(11)
    v_mfma_f32_16x16x32_bf16 v[16:19], v[48:51], v[112:115], v[16:19]
    ds_read_b128 v[96:99], v154 offset:3328
    v_mfma_f32_16x16x32_bf16 v[44:47], v[52:55], v[136:139], v[44:47]
    v_mfma_f32_16x16x32_bf16 v[40:43], v[52:55], v[132:135], v[40:43]
    ds_read2_b32 v[48:49], v148 offset0:32 offset1:33
    v_mfma_f32_16x16x32_bf16 v[36:39], v[52:55], v[128:131], v[36:39]
    v_mfma_f32_16x16x32_bf16 v[32:35], v[52:55], v[124:127], v[32:35]
    ds_read2_b32 v[50:51], v148 offset0:34 offset1:35
    v_mfma_f32_16x16x32_bf16 v[28:31], v[52:55], v[120:123], v[28:31]
    v_mfma_f32_16x16x32_bf16 v[24:27], v[52:55], v[116:119], v[24:27]
    ds_read_b128 v[92:95], v154 offset:4352
    v_mfma_f32_16x16x32_bf16 v[20:23], v[52:55], v[112:115], v[20:23]
    v_mfma_f32_16x16x32_bf16 v[44:47], v[56:59], v[132:135], v[44:47]
    v_mfma_f32_16x16x32_bf16 v[40:43], v[56:59], v[128:131], v[40:43]
    s_waitcnt lgkmcnt(13)
    ds_read2_b32 v[52:53], v148 offset0:160 offset1:161
    v_mfma_f32_16x16x32_bf16 v[36:39], v[56:59], v[124:127], v[36:39]
    v_mfma_f32_16x16x32_bf16 v[32:35], v[56:59], v[120:123], v[32:35]
    ds_read2_b32 v[54:55], v148 offset0:162 offset1:163
    v_mfma_f32_16x16x32_bf16 v[28:31], v[56:59], v[116:119], v[28:31]
    v_mfma_f32_16x16x32_bf16 v[24:27], v[56:59], v[112:115], v[24:27]
    s_waitcnt lgkmcnt(13)
    ds_read_b128 v[88:91], v154 offset:5376
    v_mfma_f32_16x16x32_bf16 v[44:47], v[60:63], v[128:131], v[44:47]
    v_mfma_f32_16x16x32_bf16 v[40:43], v[60:63], v[124:127], v[40:43]
    ds_read2_b32 v[56:57], v149 offset0:32 offset1:33
    v_mfma_f32_16x16x32_bf16 v[36:39], v[60:63], v[120:123], v[36:39]
    v_mfma_f32_16x16x32_bf16 v[32:35], v[60:63], v[116:119], v[32:35]
    s_waitcnt lgkmcnt(13)
    ds_read2_b32 v[58:59], v149 offset0:34 offset1:35
    v_mfma_f32_16x16x32_bf16 v[28:31], v[60:63], v[112:115], v[28:31]
    v_mfma_f32_16x16x32_bf16 v[44:47], v[64:67], v[124:127], v[44:47]
    ds_read2_b32 v[60:61], v149 offset0:160 offset1:161
    v_mfma_f32_16x16x32_bf16 v[40:43], v[64:67], v[120:123], v[40:43]
    s_waitcnt lgkmcnt(13)
    ds_read2_b32 v[62:63], v149 offset0:162 offset1:163
    v_mfma_f32_16x16x32_bf16 v[36:39], v[64:67], v[116:119], v[36:39]
    ds_read_b128 v[84:87], v154 offset:6400
    v_mfma_f32_16x16x32_bf16 v[32:35], v[64:67], v[112:115], v[32:35]
    s_waitcnt lgkmcnt(13)
    ds_read_b128 v[80:83], v154 offset:7424
    v_mfma_f32_16x16x32_bf16 v[44:47], v[68:71], v[120:123], v[44:47]
    ds_read2_b32 v[64:65], v150 offset0:32 offset1:33
    v_mfma_f32_16x16x32_bf16 v[40:43], v[68:71], v[116:119], v[40:43]
    s_waitcnt lgkmcnt(13)
    ds_read2_b32 v[66:67], v150 offset0:34 offset1:35
    v_mfma_f32_16x16x32_bf16 v[36:39], v[68:71], v[112:115], v[36:39]
    v_mfma_f32_16x16x32_bf16 v[44:47], v[72:75], v[116:119], v[44:47]
    ds_read2_b32 v[68:69], v150 offset0:160 offset1:161
    v_mfma_f32_16x16x32_bf16 v[40:43], v[72:75], v[112:115], v[40:43]
    s_waitcnt lgkmcnt(13)
    ds_read2_b32 v[70:71], v150 offset0:162 offset1:163
    v_mfma_f32_16x16x32_bf16 v[44:47], v[76:79], v[112:115], v[44:47]
    ds_read2_b32 v[72:73], v151 offset0:32 offset1:33
    s_waitcnt lgkmcnt(13)
    ds_read2_b32 v[76:77], v151 offset0:160 offset1:161
    ds_read2_b32 v[78:79], v151 offset0:162 offset1:163
    s_waitcnt lgkmcnt(13)
    ds_read2_b32 v[74:75], v151 offset0:34 offset1:35
    v_mfma_f32_16x16x32_bf16 v[44:47], v[48:51], v[108:111], v[44:47]
    v_mfma_f32_16x16x32_bf16 v[40:43], v[48:51], v[104:107], v[40:43]
    ds_read_b128 v[140:143], v155 offset:256
    v_mfma_f32_16x16x32_bf16 v[36:39], v[48:51], v[100:103], v[36:39]
    v_mfma_f32_16x16x32_bf16 v[32:35], v[48:51], v[96:99], v[32:35]
    s_waitcnt lgkmcnt(13)
    ds_read_b128 v[136:139], v155 offset:1280
    v_mfma_f32_16x16x32_bf16 v[28:31], v[48:51], v[92:95], v[28:31]
    v_mfma_f32_16x16x32_bf16 v[24:27], v[48:51], v[88:91], v[24:27]
    ds_read_b128 v[132:135], v155 offset:2304
    s_waitcnt lgkmcnt(12)
    v_mfma_f32_16x16x32_bf16 v[20:23], v[48:51], v[84:87], v[20:23]
    s_waitcnt lgkmcnt(11)
    v_mfma_f32_16x16x32_bf16 v[16:19], v[48:51], v[80:83], v[16:19]
    ds_read_b128 v[128:131], v155 offset:3328
    v_mfma_f32_16x16x32_bf16 v[44:47], v[52:55], v[104:107], v[44:47]
    v_mfma_f32_16x16x32_bf16 v[40:43], v[52:55], v[100:103], v[40:43]
    ds_read2_b32 v[48:49], v148 offset0:48 offset1:49
    v_mfma_f32_16x16x32_bf16 v[36:39], v[52:55], v[96:99], v[36:39]
    v_mfma_f32_16x16x32_bf16 v[32:35], v[52:55], v[92:95], v[32:35]
    ds_read2_b32 v[50:51], v148 offset0:50 offset1:51
    v_mfma_f32_16x16x32_bf16 v[28:31], v[52:55], v[88:91], v[28:31]
    v_mfma_f32_16x16x32_bf16 v[24:27], v[52:55], v[84:87], v[24:27]
    ds_read_b128 v[124:127], v155 offset:4352
    v_mfma_f32_16x16x32_bf16 v[20:23], v[52:55], v[80:83], v[20:23]
    v_mfma_f32_16x16x32_bf16 v[44:47], v[56:59], v[100:103], v[44:47]
    v_mfma_f32_16x16x32_bf16 v[40:43], v[56:59], v[96:99], v[40:43]
    s_waitcnt lgkmcnt(13)
    ds_read2_b32 v[52:53], v148 offset0:176 offset1:177
    v_mfma_f32_16x16x32_bf16 v[36:39], v[56:59], v[92:95], v[36:39]
    v_mfma_f32_16x16x32_bf16 v[32:35], v[56:59], v[88:91], v[32:35]
    ds_read2_b32 v[54:55], v148 offset0:178 offset1:179
    v_mfma_f32_16x16x32_bf16 v[28:31], v[56:59], v[84:87], v[28:31]
    v_mfma_f32_16x16x32_bf16 v[24:27], v[56:59], v[80:83], v[24:27]
    s_waitcnt lgkmcnt(13)
    ds_read_b128 v[120:123], v155 offset:5376
    s_lshl_b32 s96, s40, 2
    v_add_u32 v5, s96, v3
    v_mfma_f32_16x16x32_bf16 v[44:47], v[60:63], v[96:99], v[44:47]
    v_mfma_f32_16x16x32_bf16 v[40:43], v[60:63], v[92:95], v[40:43]
    ds_read2_b32 v[56:57], v149 offset0:48 offset1:49
    v_mfma_f32_16x16x32_bf16 v[36:39], v[60:63], v[88:91], v[36:39]
    v_mfma_f32_16x16x32_bf16 v[32:35], v[60:63], v[84:87], v[32:35]
    s_waitcnt lgkmcnt(13)
    ds_read2_b32 v[58:59], v149 offset0:50 offset1:51
    v_xor_b32 v6, 4, v5
    s_and_b32 s96, s34, 3
    v_mfma_f32_16x16x32_bf16 v[28:31], v[60:63], v[80:83], v[28:31]
    v_mfma_f32_16x16x32_bf16 v[44:47], v[64:67], v[92:95], v[44:47]
    ds_read2_b32 v[60:61], v149 offset0:176 offset1:177
    v_mfma_f32_16x16x32_bf16 v[40:43], v[64:67], v[88:91], v[40:43]
    s_waitcnt lgkmcnt(13)
    ds_read2_b32 v[62:63], v149 offset0:178 offset1:179
    v_mfma_f32_16x16x32_bf16 v[36:39], v[64:67], v[84:87], v[36:39]
    s_cselect_b32 s96, 4, 6
    s_cmp_eq_u32 s3, 0
    ds_read_b128 v[116:119], v155 offset:6400
    v_mfma_f32_16x16x32_bf16 v[32:35], v[64:67], v[80:83], v[32:35]
    s_waitcnt lgkmcnt(13)
    ds_read_b128 v[112:115], v155 offset:7424
    v_mfma_f32_16x16x32_bf16 v[44:47], v[68:71], v[88:91], v[44:47]
    ds_read2_b32 v[64:65], v150 offset0:48 offset1:49
    v_mfma_f32_16x16x32_bf16 v[40:43], v[68:71], v[84:87], v[40:43]
    s_cselect_b32 s81, s96, 0
    s_bitcmp1_b32 s40, 0
    s_waitcnt lgkmcnt(13)
    ds_read2_b32 v[66:67], v150 offset0:50 offset1:51
    v_mfma_f32_16x16x32_bf16 v[36:39], v[68:71], v[80:83], v[36:39]
    ds_read_b32 v4, v3 offset:64
    v_mfma_f32_16x16x32_bf16 v[44:47], v[72:75], v[84:87], v[44:47]
    s_waitcnt lgkmcnt(13)
    ds_read2_b32 v[68:69], v150 offset0:176 offset1:177
    v_mfma_f32_16x16x32_bf16 v[40:43], v[72:75], v[80:83], v[40:43]
    ds_read2_b32 v[70:71], v150 offset0:178 offset1:179
    v_mfma_f32_16x16x32_bf16 v[44:47], v[76:79], v[80:83], v[44:47]
    s_waitcnt lgkmcnt(13)
    ds_read2_b32 v[72:73], v151 offset0:48 offset1:49
    ds_read2_b32 v[76:77], v151 offset0:176 offset1:177
    s_waitcnt lgkmcnt(13)
    ds_read2_b32 v[78:79], v151 offset0:178 offset1:179
    ds_read2_b32 v[74:75], v151 offset0:50 offset1:51
    s_cbranch_scc1 L_mrg1

    s_waitcnt lgkmcnt(14)
    v_mfma_f32_16x16x32_bf16 v[36:39], v[48:51], v[132:135], v[36:39]
    v_mfma_f32_16x16x32_bf16 v[32:35], v[48:51], v[128:131], v[32:35]
    v_mfma_f32_16x16x32_bf16 v[28:31], v[48:51], v[124:127], v[28:31]
    v_mfma_f32_16x16x32_bf16 v[24:27], v[48:51], v[120:123], v[24:27]
    v_mfma_f32_16x16x32_bf16 v[36:39], v[52:55], v[128:131], v[36:39]
    v_mfma_f32_16x16x32_bf16 v[32:35], v[52:55], v[124:127], v[32:35]
    v_mfma_f32_16x16x32_bf16 v[28:31], v[52:55], v[120:123], v[28:31]
    s_waitcnt lgkmcnt(10)
    v_mfma_f32_16x16x32_bf16 v[24:27], v[52:55], v[116:119], v[24:27]
    v_mfma_f32_16x16x32_bf16 v[36:39], v[56:59], v[124:127], v[36:39]
    v_mfma_f32_16x16x32_bf16 v[32:35], v[56:59], v[120:123], v[32:35]
    v_mfma_f32_16x16x32_bf16 v[28:31], v[56:59], v[116:119], v[28:31]
    s_waitcnt lgkmcnt(9)
    v_mfma_f32_16x16x32_bf16 v[24:27], v[56:59], v[112:115], v[24:27]
    v_mfma_f32_16x16x32_bf16 v[36:39], v[60:63], v[120:123], v[36:39]
    v_mfma_f32_16x16x32_bf16 v[32:35], v[60:63], v[116:119], v[32:35]
    v_mfma_f32_16x16x32_bf16 v[28:31], v[60:63], v[112:115], v[28:31]
    s_waitcnt lgkmcnt(7)
    v_mfma_f32_16x16x32_bf16 v[36:39], v[64:67], v[116:119], v[36:39]
    v_mfma_f32_16x16x32_bf16 v[32:35], v[64:67], v[112:115], v[32:35]
    s_waitcnt lgkmcnt(4)
    v_mfma_f32_16x16x32_bf16 v[36:39], v[68:71], v[112:115], v[36:39]

    v_readfirstlane_b32 s99, v4
    s_cmp_lt_u32 s99, s81
    s_cbranch_scc1 L_mslow0
L_mgo0:
    v_mfma_f32_16x16x32_bf16 v[44:47], v[48:51], v[140:143], v[44:47]
    v_mfma_f32_16x16x32_bf16 v[40:43], v[48:51], v[136:139], v[40:43]
    v_mfma_f32_16x16x32_bf16 v[20:23], v[48:51], v[116:119], v[20:23]
    ds_write_b128 v158, v[24:27] offset:0
    v_mfma_f32_16x16x32_bf16 v[16:19], v[48:51], v[112:115], v[16:19]
    ds_write_b128 v158, v[28:31] offset:1024
    v_mfma_f32_16x16x32_bf16 v[44:47], v[52:55], v[136:139], v[44:47]
    ds_write_b128 v158, v[32:35] offset:2048
    v_mfma_f32_16x16x32_bf16 v[40:43], v[52:55], v[132:135], v[40:43]
    ds_write_b128 v158, v[36:39] offset:3072
    v_mfma_f32_16x16x32_bf16 v[20:23], v[52:55], v[112:115], v[20:23]
    ds_write_b32 v5, v5 offset:8
    v_mfma_f32_16x16x32_bf16 v[44:47], v[56:59], v[132:135], v[44:47]
    v_mfma_f32_16x16x32_bf16 v[40:43], v[56:59], v[128:131], v[40:43]
    v_mfma_f32_16x16x32_bf16 v[44:47], v[60:63], v[128:131], v[44:47]
    v_mfma_f32_16x16x32_bf16 v[40:43], v[60:63], v[124:127], v[40:43]
    v_mfma_f32_16x16x32_bf16 v[44:47], v[64:67], v[124:127], v[44:47]
    v_mfma_f32_16x16x32_bf16 v[40:43], v[64:67], v[120:123], v[40:43]
    v_mfma_f32_16x16x32_bf16 v[44:47], v[68:71], v[120:123], v[44:47]
    v_mfma_f32_16x16x32_bf16 v[40:43], v[68:71], v[116:119], v[40:43]
    s_waitcnt lgkmcnt(5)
    v_mfma_f32_16x16x32_bf16 v[44:47], v[72:75], v[116:119], v[44:47]
    v_mfma_f32_16x16x32_bf16 v[40:43], v[72:75], v[112:115], v[40:43]
    v_mfma_f32_16x16x32_bf16 v[44:47], v[76:79], v[112:115], v[44:47]
    s_setprio 3
    s_cmp_eq_u32 s3, 0
    s_cbranch_scc1 L_pk0
    s_lshl_b32 s92, s2, 7
    s_and_b32 s92, s92, 0x1f80
    s_load_dwordx2 s[86:87], s[28:29], s92 offset:8192
    s_mov_b32 s100, 0
Lpo_37:
    s_waitcnt lgkmcnt(0)
    s_cmp_eq_u32 s86, s31
    s_cbranch_scc1 Lpd_38
    s_sleep 16
    s_load_dwordx2 s[86:87], s[28:29], s92 offset:8192 glc
    s_add_u32 s100, s100, 1
    s_cmp_lt_u32 s100, 1048576
    s_cbranch_scc1 Lpo_37
    s_waitcnt lgkmcnt(0)
Lpd_38:
    s_and_b32 s92, s87, 0x2000
L_pk0:
    v_xor_b32 v157, s92, v157
    v_xor_b32 v7, 0x2000, v157
L_mb0:
    ds_read_b32 v4, v6 offset:8
    ds_read_b128 v[80:83], v159 offset:0
    ds_read_b128 v[84:87], v159 offset:1024
    ds_read_b128 v[88:91], v159 offset:2048
    ds_read_b128 v[92:95], v159 offset:3072
    s_waitcnt lgkmcnt(4)
    v_readfirstlane_b32 s99, v4
    s_cmp_eq_u32 s99, 0
    s_cbranch_scc1 L_mw0
    s_waitcnt lgkmcnt(2)
    v_add_f32 v16, v16, v80
    v_add_f32 v17, v17, v81
    v_add_f32 v18, v18, v82
    v_add_f32 v19, v19, v83
    v_add_f32 v20, v20, v84
    v_add_f32 v21, v21, v85
    v_add_f32 v22, v22, v86
    v_add_f32 v23, v23, v87
    v_cvt_pk_bf16_f32 v96, v16, v17
    v_cvt_pk_bf16_f32 v97, v18, v19
    v_cvt_pk_bf16_f32 v98, v20, v21
    v_cvt_pk_bf16_f32 v99, v22, v23
    s_nop 0
    v_permlane16_swap_b32 v96, v98
    v_permlane16_swap_b32 v97, v99
    buffer_store_dwordx4 v[96:99], v157, s[44:47], 0 offen offset:0 sc1
    s_waitcnt lgkmcnt(0)
    v_add_f32 v40, v40, v88
    v_add_f32 v41, v41, v89
    v_add_f32 v42, v42, v90
    v_add_f32 v43, v43, v91
    v_add_f32 v44, v44, v92
    v_add_f32 v45, v45, v93
    v_add_f32 v46, v46, v94
    v_add_f32 v47, v47, v95
    v_cvt_pk_bf16_f32 v100, v40, v41
    v_cvt_pk_bf16_f32 v101, v42, v43
    v_cvt_pk_bf16_f32 v102, v44, v45
    v_cvt_pk_bf16_f32 v103, v46, v47
    s_nop 0
    v_permlane16_swap_b32 v100, v102
    v_permlane16_swap_b32 v101, v103
    buffer_store_dwordx4 v[100:103], v7, s[44:47], 0 offen offset:3072 sc1
    s_branch L_mrgd
L_mw0:
    s_mov_b32 s100, 0
Lw_39:
    ds_read_b32 v4, v6 offset:8
    s_waitcnt lgkmcnt(0)
    v_readfirstlane_b32 s99, v4
    s_cmp_ge_u32 s99, 1
    s_cbranch_scc1 Lwd_40
    s_add_u32 s100, s100, 1
    s_cmp_lt_u32 s100, 8388608
    s_cbranch_scc1 Lw_39
Lwd_40:
    s_branch L_mb0
L_mslow0:
    s_mov_b32 s100, 0
Lw_41:
    ds_read_b32 v4, v3 offset:64
    s_waitcnt lgkmcnt(0)
    v_readfirstlane_b32 s99, v4
    s_cmp_ge_u32 s99, s81
    s_cbranch_scc1 Lwd_42
    s_add_u32 s100, s100, 1
    s_cmp_lt_u32 s100, 8388608
    s_cbranch_scc1 Lw_41
Lwd_42:
    s_branch L_mgo0
L_mrg1:

    s_waitcnt lgkmcnt(14)
    v_mfma_f32_16x16x32_bf16 v[44:47], v[48:51], v[140:143], v[44:47]
    v_mfma_f32_16x16x32_bf16 v[40:43], v[48:51], v[136:139], v[40:43]
    s_waitcnt lgkmcnt(10)
    v_mfma_f32_16x16x32_bf16 v[20:23], v[48:51], v[116:119], v[20:23]
    s_waitcnt lgkmcnt(9)
    v_mfma_f32_16x16x32_bf16 v[16:19], v[48:51], v[112:115], v[16:19]
    v_mfma_f32_16x16x32_bf16 v[44:47], v[52:55], v[136:139], v[44:47]
    v_mfma_f32_16x16x32_bf16 v[40:43], v[52:55], v[132:135], v[40:43]
    v_mfma_f32_16x16x32_bf16 v[20:23], v[52:55], v[112:115], v[20:23]
    v_mfma_f32_16x16x32_bf16 v[44:47], v[56:59], v[132:135], v[44:47]
    v_mfma_f32_16x16x32_bf16 v[40:43], v[56:59], v[128:131], v[40:43]
    v_mfma_f32_16x16x32_bf16 v[44:47], v[60:63], v[128:131], v[44:47]
    v_mfma_f32_16x16x32_bf16 v[40:43], v[60:63], v[124:127], v[40:43]
    s_waitcnt lgkmcnt(7)
    v_mfma_f32_16x16x32_bf16 v[44:47], v[64:67], v[124:127], v[44:47]
    v_mfma_f32_16x16x32_bf16 v[40:43], v[64:67], v[120:123], v[40:43]
    s_waitcnt lgkmcnt(4)
    v_mfma_f32_16x16x32_bf16 v[44:47], v[68:71], v[120:123], v[44:47]
    v_mfma_f32_16x16x32_bf16 v[40:43], v[68:71], v[116:119], v[40:43]
    s_waitcnt lgkmcnt(0)
    v_mfma_f32_16x16x32_bf16 v[44:47], v[72:75], v[116:119], v[44:47]
    v_mfma_f32_16x16x32_bf16 v[40:43], v[72:75], v[112:115], v[40:43]
    v_mfma_f32_16x16x32_bf16 v[44:47], v[76:79], v[112:115], v[44:47]

    v_readfirstlane_b32 s99, v4
    s_cmp_lt_u32 s99, s81
    s_cbranch_scc1 L_mslow1
L_mgo1:
    v_mfma_f32_16x16x32_bf16 v[36:39], v[48:51], v[132:135], v[36:39]
    v_mfma_f32_16x16x32_bf16 v[32:35], v[48:51], v[128:131], v[32:35]
    v_mfma_f32_16x16x32_bf16 v[28:31], v[48:51], v[124:127], v[28:31]
    ds_write_b128 v158, v[16:19] offset:0
    v_mfma_f32_16x16x32_bf16 v[24:27], v[48:51], v[120:123], v[24:27]
    ds_write_b128 v158, v[20:23] offset:1024
    v_mfma_f32_16x16x32_bf16 v[36:39], v[52:55], v[128:131], v[36:39]
    ds_write_b128 v158, v[40:43] offset:2048
    v_mfma_f32_16x16x32_bf16 v[32:35], v[52:55], v[124:127], v[32:35]
    ds_write_b128 v158, v[44:47] offset:3072
    v_mfma_f32_16x16x32_bf16 v[28:31], v[52:55], v[120:123], v[28:31]
    ds_write_b32 v5, v5 offset:8
    v_mfma_f32_16x16x32_bf16 v[24:27], v[52:55], v[116:119], v[24:27]
    v_mfma_f32_16x16x32_bf16 v[36:39], v[56:59], v[124:127], v[36:39]
    v_mfma_f32_16x16x32_bf16 v[32:35], v[56:59], v[120:123], v[32:35]
    v_mfma_f32_16x16x32_bf16 v[28:31], v[56:59], v[116:119], v[28:31]
    v_mfma_f32_16x16x32_bf16 v[24:27], v[56:59], v[112:115], v[24:27]
    v_mfma_f32_16x16x32_bf16 v[36:39], v[60:63], v[120:123], v[36:39]
    v_mfma_f32_16x16x32_bf16 v[32:35], v[60:63], v[116:119], v[32:35]
    v_mfma_f32_16x16x32_bf16 v[28:31], v[60:63], v[112:115], v[28:31]
    v_mfma_f32_16x16x32_bf16 v[36:39], v[64:67], v[116:119], v[36:39]
    v_mfma_f32_16x16x32_bf16 v[32:35], v[64:67], v[112:115], v[32:35]
    v_mfma_f32_16x16x32_bf16 v[36:39], v[68:71], v[112:115], v[36:39]
    s_setprio 3
    s_cmp_eq_u32 s3, 0
    s_cbranch_scc1 L_pk1
    s_lshl_b32 s92, s2, 7
    s_and_b32 s92, s92, 0x1f80
    s_load_dwordx2 s[86:87], s[28:29], s92 offset:8192
    s_mov_b32 s100, 0
Lpo_43:
    s_waitcnt lgkmcnt(0)
    s_cmp_eq_u32 s86, s31
    s_cbranch_scc1 Lpd_44
    s_sleep 16
    s_load_dwordx2 s[86:87], s[28:29], s92 offset:8192 glc
    s_add_u32 s100, s100, 1
    s_cmp_lt_u32 s100, 1048576
    s_cbranch_scc1 Lpo_43
    s_waitcnt lgkmcnt(0)
Lpd_44:
    s_and_b32 s92, s87, 0x2000
L_pk1:
    v_xor_b32 v157, s92, v157
    v_xor_b32 v7, 0x2000, v157
L_mb1:
    ds_read_b32 v4, v6 offset:8
    ds_read_b128 v[80:83], v159 offset:0
    ds_read_b128 v[84:87], v159 offset:1024
    ds_read_b128 v[88:91], v159 offset:2048
    ds_read_b128 v[92:95], v159 offset:3072
    s_waitcnt lgkmcnt(4)
    v_readfirstlane_b32 s99, v4
    s_cmp_eq_u32 s99, 0
    s_cbranch_scc1 L_mw1
    s_waitcnt lgkmcnt(2)
    v_add_f32 v24, v24, v80
    v_add_f32 v25, v25, v81
    v_add_f32 v26, v26, v82
    v_add_f32 v27, v27, v83
    v_add_f32 v28, v28, v84
    v_add_f32 v29, v29, v85
    v_add_f32 v30, v30, v86
    v_add_f32 v31, v31, v87
    v_cvt_pk_bf16_f32 v96, v24, v25
    v_cvt_pk_bf16_f32 v97, v26, v27
    v_cvt_pk_bf16_f32 v98, v28, v29
    v_cvt_pk_bf16_f32 v99, v30, v31
    s_nop 0
    v_permlane16_swap_b32 v96, v98
    v_permlane16_swap_b32 v97, v99
    buffer_store_dwordx4 v[96:99], v157, s[44:47], 0 offen offset:1024 sc1
    s_waitcnt lgkmcnt(0)
    v_add_f32 v32, v32, v88
    v_add_f32 v33, v33, v89
    v_add_f32 v34, v34, v90
    v_add_f32 v35, v35, v91
    v_add_f32 v36, v36, v92
    v_add_f32 v37, v37, v93
    v_add_f32 v38, v38, v94
    v_add_f32 v39, v39, v95
    v_cvt_pk_bf16_f32 v100, v32, v33
    v_cvt_pk_bf16_f32 v101, v34, v35
    v_cvt_pk_bf16_f32 v102, v36, v37
    v_cvt_pk_bf16_f32 v103, v38, v39
    s_nop 0
    v_permlane16_swap_b32 v100, v102
    v_permlane16_swap_b32 v101, v103
    buffer_store_dwordx4 v[100:103], v7, s[44:47], 0 offen offset:2048 sc1
    s_mov_b32 exec_lo, 15
    s_mov_b32 exec_hi, 15
    buffer_store_dwordx4 v[100:103], v157, s[44:47], 0 offen offset:2048 sc1
    s_mov_b64 exec, -1
    s_branch L_mrgd
L_mw1:
    s_mov_b32 s100, 0
Lw_45:
    ds_read_b32 v4, v6 offset:8
    s_waitcnt lgkmcnt(0)
    v_readfirstlane_b32 s99, v4
    s_cmp_ge_u32 s99, 1
    s_cbranch_scc1 Lwd_46
    s_add_u32 s100, s100, 1
    s_cmp_lt_u32 s100, 8388608
    s_cbranch_scc1 Lw_45
Lwd_46:
    s_branch L_mb1
L_mslow1:
    s_mov_b32 s100, 0
Lw_47:
    ds_read_b32 v4, v3 offset:64
    s_waitcnt lgkmcnt(0)
    v_readfirstlane_b32 s99, v4
    s_cmp_ge_u32 s99, s81
    s_cbranch_scc1 Lwd_48
    s_add_u32 s100, s100, 1
    s_cmp_lt_u32 s100, 8388608
    s_cbranch_scc1 Lw_47
Lwd_48:
    s_branch L_mgo1
L_mrgd:
    s_cmp_lg_u32 s3, 0
    s_cbranch_scc1 L_nogq
    s_setprio 3
    ds_read_b32 v4, v3 offset:76
    v_lshlrev_b32 v20, 2, v1
    v_add_u32 v20, 161088, v20
L_gqr:
    ds_read2_b32 v[32:33], v20 offset0:0 offset1:16
    ds_read2_b32 v[34:35], v20 offset0:32 offset1:48
    ds_read2_b32 v[36:37], v20 offset0:64 offset1:80
    v_lshlrev_b32 v40, 16, v8
    v_and_b32 v41, 0xffff0000, v8
    v_lshlrev_b32 v42, 16, v9
    v_and_b32 v43, 0xffff0000, v9
    v_lshlrev_b32 v44, 16, v10
    v_and_b32 v45, 0xffff0000, v10
    v_lshlrev_b32 v46, 16, v11
    v_and_b32 v47, 0xffff0000, v11
    v_lshlrev_b32 v48, 16, v14
    v_and_b32 v49, 0xffff0000, v14
    v_lshlrev_b32 v50, 16, v15
    v_and_b32 v51, 0xffff0000, v15
    v_lshlrev_b32 v52, 16, v160
    v_and_b32 v53, 0xffff0000, v160
    v_lshlrev_b32 v54, 16, v161
    v_and_b32 v55, 0xffff0000, v161
    v_lshlrev_b32 v56, 16, v162
    v_and_b32 v57, 0xffff0000, v162
    v_lshlrev_b32 v58, 16, v163
    v_and_b32 v59, 0xffff0000, v163
    v_lshlrev_b32 v60, 16, v164
    v_and_b32 v61, 0xffff0000, v164
    v_lshlrev_b32 v62, 16, v165
    v_and_b32 v63, 0xffff0000, v165
    s_waitcnt lgkmcnt(0)
    v_readfirstlane_b32 s67, v4
    v_mul_f32 v40, v32, v40
    v_mul_f32 v41, v32, v41
    v_mul_f32 v42, v32, v42
    v_mul_f32 v43, v32, v43
    v_mul_f32 v44, v33, v44
    v_mul_f32 v45, v33, v45
    v_mul_f32 v46, v33, v46
    v_mul_f32 v47, v33, v47
    v_mul_f32 v48, v34, v48
    v_mul_f32 v49, v34, v49
    v_mul_f32 v50, v34, v50
    v_mul_f32 v51, v34, v51
    v_mul_f32 v52, v35, v52
    v_mul_f32 v53, v35, v53
    v_mul_f32 v54, v35, v54
    v_mul_f32 v55, v35, v55
    v_mul_f32 v56, v36, v56
    v_mul_f32 v57, v36, v57
    v_mul_f32 v58, v36, v58
    v_mul_f32 v59, v36, v59
    v_mul_f32 v60, v37, v60
    v_mul_f32 v61, v37, v61
    v_mul_f32 v62, v37, v62
    v_mul_f32 v63, v37, v63
    s_cmp_eq_u32 s67, 2
    s_cbranch_scc1 L_gqd
    s_lshl_b32 s96, s40, 10
    s_add_u32 s96, s96, 133632
    v_add_u32 v21, s96, v12
    s_lshr_b32 s96, s40, 1
    s_lshl_b32 s96, s96, 2
    v_add_u32 v22, s96, v3
    s_mul_i32 s96, s32, 164096
    s_cmp_ge_u32 s32, 11
    s_cselect_b32 s100, 1796864, 0
    s_sub_u32 s96, s96, s100
    s_mul_i32 s100, s33, 16640
    s_add_u32 s96, s96, s100
    s_add_u32 s96, s96, 262144
    s_xor_b32 s96, s96, s92
    s_lshl_b32 s97, s40, 7
    s_add_u32 s96, s96, s97
    s_add_u32 s56, s28, s96
    s_addc_u32 s57, s29, 0
    s_xor_b32 s96, s40, 1
    s_lshl_b32 s96, s96, 12
    s_add_u32 m0, s96, 116736
    s_lshl2_add_u32 s66, s33, s40
    s_lshl_b32 s66, s66, 17
    s_mul_i32 s96, s32, 192
    s_add_u32 s66, s66, s96
    s_add_u32 s66, s66, 4718592
    s_cmp_ge_u32 s32, 11
    s_cselect_b32 s96, 0x2000, 0
    s_add_u32 s66, s66, s96
    s_lshr_b32 s100, s66, 8
    s_and_b32 s100, s100, 8192
    s_xor_b32 s66, s66, s100
    s_xor_b32 s66, s66, s92
    s_setprio 3
L_nogq:
    v_mul_u32_u24 v5, 164096, v0
    v_add_u32 v5, s82, v5
    v_mov_b32 v6, s31
    s_mov_b64 exec, 0xfffff800
    v_subrev_u32 v5, 1796864, v5
    s_mov_b64 exec, -1
    v_xor_b32 v5, s92, v5
    s_waitcnt vmcnt(0)
    v_mov_b32 v4, 1
    s_mov_b64 exec, 1
    ds_add_rtn_u32 v4, v3, v4 offset:28
    s_waitcnt lgkmcnt(0)
    v_readfirstlane_b32 s98, v4
    s_mov_b64 exec, -1
    s_cmp_lg_u32 s98, 3
    s_cbranch_scc1 L_ynosig
    s_mov_b64 exec, 0x3fffff
    global_atomic_swap v5, v6, s[28:29] sc1
    s_mov_b64 exec, -1
L_ynosig:
    s_and_b32 s96, s63, 7
    s_or_b32 s96, s96, s40
    s_cbranch_scc1 L_noep
    s_mov_b32 s96, 1
    s_atomic_add s96, s[26:27], 0 glc
    s_waitcnt lgkmcnt(0)
    s_cmp_lg_u32 s96, 39
    s_cbranch_scc1 Lep_49
    s_atomic_swap s31, s[28:29], 0
Lep_49:
L_noep:
    s_cmp_lg_u32 s3, 0
    s_cbranch_scc1 L_cexit
    s_mov_b32 s100, 0
L_yp:
    s_add_u32 s100, s100, 1
    s_cmp_ge_u32 s100, 1048576
    s_cbranch_scc1 L_ypd
    s_sleep 1
    s_load_dwordx16 s[4:19], s[56:57], 0 glc
    s_waitcnt lgkmcnt(0)
    s_cmp_lg_u32 s4, s31
    s_cbranch_scc1 L_yp
    s_cmp_lg_u32 s6, s31
    s_cbranch_scc1 L_yp
    s_cmp_lg_u32 s8, s31
    s_cbranch_scc1 L_yp
    s_cmp_lg_u32 s10, s31
    s_cbranch_scc1 L_yp
    s_cmp_lg_u32 s12, s31
    s_cbranch_scc1 L_yp
    s_cmp_lg_u32 s14, s31
    s_cbranch_scc1 L_yp
    s_cmp_lg_u32 s16, s31
    s_cbranch_scc1 L_yp
    s_cmp_lg_u32 s18, s31
    s_cbranch_scc1 L_yp
L_ypd:
    buffer_load_dwordx4 v144, s[44:47], s66 offen sc1 lds
    s_add_u32 m0, m0, 1024
    s_nop 0
    buffer_load_dwordx4 v145, s[44:47], s66 offen sc1 lds
    s_add_u32 m0, m0, 1024
    s_nop 0
    buffer_load_dwordx4 v146, s[44:47], s66 offen sc1 lds
    s_mov_b32 s100, 0
Lw_50:
    ds_read_b32 v4, v3 offset:28
    s_waitcnt lgkmcnt(0)
    v_readfirstlane_b32 s99, v4
    s_cmp_ge_u32 s99, 4
    s_cbranch_scc1 Lwd_51
    s_add_u32 s100, s100, 1
    s_cmp_lt_u32 s100, 8388608
    s_cbranch_scc1 Lw_50
Lwd_51:
    s_cmp_lg_u32 s67, 0
    s_cbranch_scc1 L_gqd
    s_mov_b32 s100, 0
Lw_52:
    ds_read_b32 v4, v3 offset:76
    s_waitcnt lgkmcnt(0)
    v_readfirstlane_b32 s99, v4
    s_cmp_ge_u32 s99, 1
    s_cbranch_scc1 Lwd_53
    s_sleep 1
    s_add_u32 s100, s100, 1
    s_cmp_lt_u32 s100, 8388608
    s_cbranch_scc1 Lw_52
Lwd_53:
    v_mov_b32 v4, 2
    s_branch L_gqr
L_gqd:
    v_mov_b32 v4, 1
    s_waitcnt vmcnt(0)
    ds_read_b64_tr_b16 v[64:65], v147 offset:0
    ds_read_b64_tr_b16 v[66:67], v147 offset:32
    ds_read_b64_tr_b16 v[68:69], v147 offset:64
    ds_read_b64_tr_b16 v[70:71], v147 offset:96
    ds_read_b64_tr_b16 v[72:73], v147 offset:128
    ds_read_b64_tr_b16 v[74:75], v147 offset:160
    s_waitcnt lgkmcnt(5)
    v_lshlrev_b32 v80, 16, v64
    v_and_b32 v81, 0xffff0000, v64
    v_lshlrev_b32 v82, 16, v65
    v_and_b32 v83, 0xffff0000, v65
    v_mul_f32 v40, v40, v80
    v_mul_f32 v41, v41, v81
    v_mul_f32 v42, v42, v82
    v_mul_f32 v43, v43, v83
    ds_write_b128 v21, v[40:43] offset:0
    s_waitcnt lgkmcnt(5)
    v_lshlrev_b32 v84, 16, v66
    v_and_b32 v85, 0xffff0000, v66
    v_lshlrev_b32 v86, 16, v67
    v_and_b32 v87, 0xffff0000, v67
    v_mul_f32 v44, v44, v84
    v_mul_f32 v45, v45, v85
    v_mul_f32 v46, v46, v86
    v_mul_f32 v47, v47, v87
    ds_write_b128 v21, v[44:47] offset:4096
    s_waitcnt lgkmcnt(5)
    v_lshlrev_b32 v88, 16, v68
    v_and_b32 v89, 0xffff0000, v68
    v_lshlrev_b32 v90, 16, v69
    v_and_b32 v91, 0xffff0000, v69
    v_mul_f32 v48, v48, v88
    v_mul_f32 v49, v49, v89
    v_mul_f32 v50, v50, v90
    v_mul_f32 v51, v51, v91
    ds_write_b128 v21, v[48:51] offset:8192
    s_waitcnt lgkmcnt(5)
    v_lshlrev_b32 v92, 16, v70
    v_and_b32 v93, 0xffff0000, v70
    v_lshlrev_b32 v94, 16, v71
    v_and_b32 v95, 0xffff0000, v71
    v_mul_f32 v52, v52, v92
    v_mul_f32 v53, v53, v93
    v_mul_f32 v54, v54, v94
    v_mul_f32 v55, v55, v95
    ds_write_b128 v21, v[52:55] offset:12288
    s_waitcnt lgkmcnt(5)
    v_lshlrev_b32 v96, 16, v72
    v_and_b32 v97, 0xffff0000, v72
    v_lshlrev_b32 v98, 16, v73
    v_and_b32 v99, 0xffff0000, v73
    v_mul_f32 v56, v56, v96
    v_mul_f32 v57, v57, v97
    v_mul_f32 v58, v58, v98
    v_mul_f32 v59, v59, v99
    ds_write_b128 v21, v[56:59] offset:16384
    s_waitcnt lgkmcnt(5)
    v_lshlrev_b32 v100, 16, v74
    v_and_b32 v101, 0xffff0000, v74
    v_lshlrev_b32 v102, 16, v75
    v_and_b32 v103, 0xffff0000, v75
    v_mul_f32 v60, v60, v100
    v_mul_f32 v61, v61, v101
    v_mul_f32 v62, v62, v102
    v_mul_f32 v63, v63, v103
    ds_write_b128 v21, v[60:63] offset:20480
    s_mov_b64 exec, 1
    ds_add_u32 v22, v4 offset:112
L_cexit:
    s_endpgm
L_idle:
    s_cmp_lg_u32 s43, 348
    s_cbranch_scc1 L_idl1
    s_cmp_lg_u32 s30, 4
    s_cbranch_scc1 L_idl1
    s_load_dword s31, s[28:29], 0
    s_load_dword s60, s[28:29], 196608 glc
    s_load_dword s61, s[28:29], 204800 glc
    v_lshlrev_b32 v8, 7, v0
    v_add_u32 v8, 8192, v8
    global_load_dword v9, v8, s[28:29] sc0 sc1
    s_barrier
    s_mov_b32 s62, 0
    s_mov_b64 s[68:69], -1
    s_waitcnt lgkmcnt(0)
    s_memtime s[70:71]
    s_waitcnt lgkmcnt(0)
L_ms:
    s_load_dword s60, s[28:29], 196608 glc
    s_waitcnt lgkmcnt(0)
    s_memtime s[72:73]
    s_waitcnt lgkmcnt(0)
    s_sub_u32 s60, s72, s70
    s_min_u32 s68, s68, s60
    s_add_u32 s62, s62, 1
    s_cmp_lt_u32 s62, 4
    s_cbranch_scc1 L_m1
L_m1:
    s_load_dword s60, s[28:29], 204800 glc
    s_waitcnt lgkmcnt(0)
    s_memtime s[70:71]
    s_waitcnt lgkmcnt(0)
    s_sub_u32 s60, s70, s72
    s_min_u32 s69, s69, s60
    s_add_u32 s62, s62, 1
    s_cmp_lt_u32 s62, 4
    s_cbranch_scc1 L_ms
    s_mul_i32 s31, s31, 1664525
    s_add_u32 s31, s31, 1013904223
    s_cmp_gt_u32 s68, s69
    s_cselect_b32 s65, 0x2000, 0
    s_mov_b32 s64, s31
    v_mov_b32 v10, s64
    v_mov_b32 v11, s65
    global_atomic_swap_x2 v8, v[10:11], s[28:29] sc1
    s_branch L_idl0
L_idl1:
    s_barrier
L_idl0:
    s_and_b32 s97, s35, 3
    s_lshl3_add_u32 s96, s97, s30
    s_sub_u32 s96, s96, 4
    v_lshlrev_b32 v4, 7, v0
    v_lshlrev_b32 v5, 10, v0
    s_waitcnt lgkmcnt(0)
    s_mov_b32 s44, s28
    s_and_b32 s45, s29, 0xffff
    s_mov_b32 s46, 2097152
    s_mov_b32 s47, 0x00020000
    s_cmp_lg_u32 s96, 31
    s_cbranch_scc1 L_idl2
    s_mov_b32 s98, 77824
    s_mov_b64 exec, 0xfffffff
    buffer_load_dword v8, v5, s[44:47], s98 offen sc1
    s_mov_b64 exec, -1
L_idl2:
    s_cmp_gt_u32 s96, 1
    s_cbranch_scc1 L_idl3
    s_lshl_b32 s98, s96, 13
    s_add_u32 s98, s98, 65536
    buffer_load_dword v8, v4, s[44:47], s98 offen sc1
L_idl3:
    v_lshrrev_b32 v5, 1, v2
    v_mul_u32_u24 v5, 147712, v5
    v_lshl_add_u32 v5, v2, 13, v5
    v_lshl_add_u32 v5, v1, 7, v5
    s_mov_b32 exec_lo, 0xff1fff1f
    s_mov_b32 exec_hi, 0xff1fff1f
    s_mul_i32 s98, s96, 43
    s_lshr_b32 s98, s98, 8
    s_mul_i32 s99, s98, 4293014784
    s_mul_i32 s98, s96, 328192
    s_add_u32 s98, s98, s99
    s_add_u32 s98, s98, 262144
    buffer_load_dword v9, v5, s[44:47], s98 offen sc1
    s_add_u32 s96, s96, 32
    s_min_u32 s96, s96, 59
    s_mul_i32 s98, s96, 43
    s_lshr_b32 s98, s98, 8
    s_mul_i32 s99, s98, 4293014784
    s_mul_i32 s98, s96, 328192
    s_add_u32 s98, s98, s99
    s_add_u32 s98, s98, 262144
    buffer_load_dword v10, v5, s[44:47], s98 offen sc1
    s_add_u32 s96, s96, 32
    s_min_u32 s96, s96, 59
    s_branch L_cexit
L_hg:
    v_mov_b32 v3, 160960
    s_mov_b32 s101, 0
    s_waitcnt lgkmcnt(0)
    s_cmp_ge_u32 s30, 4
    s_cbranch_scc1 L_ps
    v_mov_b32 v6, 0
    v_and_b32 v5, 31, v0
    v_lshl_add_u32 v5, v5, 2, v3
    ds_write_b32 v5, v6
    v_lshrrev_b32 v5, 1, v1
    v_xor_b32 v5, v5, v2
    v_lshlrev_b32 v5, 4, v5
    v_lshl_add_u32 v5, v1, 7, v5
    s_add_u32 s96, s33, 1
    s_min_u32 s96, s96, 6
    s_lshl_b32 s96, s96, 11
    v_add_u32 v15, s96, v5
    v_lshlrev_b32 v16, 4, v2
    v_add_u32 v16, 159488, v16
    v_mov_b32 v20, 0
    v_mov_b32 v21, 0
    v_mov_b32 v22, 0
    v_mov_b32 v23, 0
    v_lshlrev_b32 v17, 4, v0
    s_waitcnt lgkmcnt(0)
    s_mov_b32 s40, s22
    s_and_b32 s41, s23, 0xffff
    s_mov_b32 s42, 1280
    s_mov_b32 s43, 0x00020000
    s_mov_b32 m0, 159488
    s_nop 0
    buffer_load_dwordx4 v17, s[40:43], 0 offen lds
    s_mov_b64 exec, 0xffff
    buffer_load_dwordx4 v17, s[40:43], 0 offen offset:1024 lds
    s_mov_b64 exec, -1
    v_lshrrev_b32 v4, 3, v0
    v_and_b32 v5, 7, v0
    v_mul_u32_u24 v4, 1280, v4
    v_lshlrev_b32 v6, 1, v2
    v_xor_b32 v5, v5, v6
    v_lshl_add_u32 v4, v5, 4, v4
    s_lshl_b32 s96, s33, 7
    v_add_u32 v8, s96, v4
    v_lshrrev_b32 v4, 5, v0
    v_mul_u32_u24 v5, 20480, v4
    v_add_u32 v9, v8, v5
    v_mul_u32_u24 v5, 71680, v4
    v_add_u32 v10, v8, v5
    v_mul_u32_u24 v5, 327680, v4
    v_add_u32 v11, v8, v5
    s_mov_b32 s40, s20
    s_and_b32 s41, s21, 0xffff
    s_mov_b32 s42, 819200
    s_mov_b32 s43, 0x00020000
    s_mov_b32 s44, s28
    s_and_b32 s45, s29, 0xffff
    s_mov_b32 s46, 16777216
    s_mov_b32 s47, 0x00020000
    s_load_dword s31, s[28:29], 0
    s_mov_b32 s51, 0
    s_mov_b32 s52, 0
    s_and_b32 s53, s38, 15
    s_lshr_b64 s[38:39], s[38:39], 4
    s_lshl_b32 s53, s53, 7
    s_barrier
    s_waitcnt vmcnt(0)
L_hl:
    s_cmp_gt_u32 s33, 5
    s_cbranch_scc1 L_hng
    v_add_u32 v12, s52, v15
    v_add_u32 v14, s53, v16
    v_xor_b32 v13, 64, v12
    ds_read_b128 v[24:27], v12
    ds_read_b128 v[32:35], v14 offset:0
    ds_read_b128 v[28:31], v13
    ds_read_b128 v[36:39], v14 offset:64
    s_waitcnt lgkmcnt(0)
    v_mfma_f32_16x16x32_bf16 v[20:23], v[32:35], v[24:27], v[20:23]
    v_mfma_f32_16x16x32_bf16 v[20:23], v[36:39], v[28:31], v[20:23]
L_hng:
    s_waitcnt lgkmcnt(0)
    s_add_u32 s52, s52, 38912
    s_cmp_eq_u32 s52, 116736
    s_cselect_b32 s52, 0, s52
    s_and_b32 s53, s38, 15
    s_lshr_b64 s[38:39], s[38:39], 4
    s_lshl_b32 s53, s53, 7
    s_cmp_lg_u32 s51, 9
    s_cbranch_scc1 L_hnw
    s_lshr_b32 s96, s2, 3
    s_mul_i32 s96, s96, 30720
    s_and_b32 s97, s2, 1
    s_mul_i32 s97, s97, 640
    s_add_u32 s96, s96, s97
    v_mul_u32_u24 v5, 13108, v0
    v_lshrrev_b32 v5, 16, v5
    v_mul_u32_u24 v5, 640, v5
    v_lshl_add_u32 v5, v0, 7, v5
    s_add_u32 s97, s96, 15360
    s_mov_b32 exec_hi, 0xfffffff
    buffer_load_dword v40, v5, s[40:43], s96 offen
    buffer_load_dword v41, v5, s[40:43], s97 offen
    s_mov_b64 exec, -1
L_hnw:
    s_add_u32 s51, s51, 1
    s_cmp_ge_u32 s51, 10
    s_cbranch_scc1 L_hld
    s_barrier
    s_branch L_hl
L_hld:
    s_mul_i32 s31, s31, 1664525
    s_add_u32 s31, s31, 1013904223
    v_mov_b32 v24, s31
    s_mul_i32 s54, s32, 768
    s_add_u32 s54, s54, 131072
    v_lshlrev_b32 v26, 3, v0
    s_cmp_gt_u32 s33, 5
    s_cbranch_scc1 L_hgd
    v_cvt_pk_bf16_f32 v25, v20, v20
    v_and_b32 v25, 0xffff0000, v25
    v_mul_f32 v25, 0xbfb8aa3b, v25
    v_exp_f32 v25, v25
    s_nop 0
    v_add_f32 v25, 1.0, v25
    v_rcp_f32 v25, v25
    s_nop 0
    v_cvt_pk_bf16_f32 v25, v25, v25
    v_and_b32 v25, 0xffff0000, v25
    s_lshl_b32 s96, s33, 7
    s_add_u32 s96, s96, s54
    s_mov_b64 exec, 0xffff
    buffer_store_dwordx2 v[24:25], v26, s[44:47], s96 offen sc1
    s_mov_b64 exec, -1
L_hgd:
    s_setprio 1
    s_barrier
    s_sub_u32 s96, 0, s34
    s_cselect_b32 s97, 5, 0
    s_add_u32 s96, s96, s97
    s_lshl_b32 m0, s96, 12
    s_mov_b32 s96, 0
    buffer_load_dwordx4 v8, s[40:43], s96 offen offset:0 lds
    s_mov_b32 s96, 24576
    buffer_load_dwordx4 v8, s[40:43], s96 offen offset:1024 lds
    s_mov_b32 s96, 8192
    buffer_load_dwordx4 v8, s[40:43], s96 offen offset:2048 lds
    s_mov_b32 s96, 32768
    buffer_load_dwordx4 v8, s[40:43], s96 offen offset:3072 lds
    s_sub_u32 s96, 1, s34
    s_cselect_b32 s97, 5, 0
    s_add_u32 s96, s96, s97
    s_lshl_b32 m0, s96, 12
    s_mov_b32 s96, 102400
    buffer_load_dwordx4 v8, s[40:43], s96 offen offset:0 lds
    s_mov_b32 s96, 126976
    buffer_load_dwordx4 v8, s[40:43], s96 offen offset:1024 lds
    s_mov_b32 s96, 110592
    buffer_load_dwordx4 v8, s[40:43], s96 offen offset:2048 lds
    s_mov_b32 s96, 135168
    buffer_load_dwordx4 v8, s[40:43], s96 offen offset:3072 lds
    s_sub_u32 s96, 2, s34
    s_cselect_b32 s97, 5, 0
    s_add_u32 s96, s96, s97
    s_lshl_b32 m0, s96, 12
    s_mov_b32 s96, 179200
    buffer_load_dwordx4 v8, s[40:43], s96 offen offset:0 lds
    s_mov_b32 s96, 203776
    buffer_load_dwordx4 v8, s[40:43], s96 offen offset:1024 lds
    s_mov_b32 s96, 187392
    buffer_load_dwordx4 v8, s[40:43], s96 offen offset:2048 lds
    s_mov_b32 s96, 211968
    buffer_load_dwordx4 v8, s[40:43], s96 offen offset:3072 lds
    s_sub_u32 s96, 3, s34
    s_cselect_b32 s97, 5, 0
    s_add_u32 s96, s96, s97
    s_lshl_b32 m0, s96, 12
    s_mov_b32 s96, 256000
    buffer_load_dwordx4 v8, s[40:43], s96 offen offset:0 lds
    s_mov_b32 s96, 280576
    buffer_load_dwordx4 v8, s[40:43], s96 offen offset:1024 lds
    s_mov_b32 s96, 264192
    buffer_load_dwordx4 v8, s[40:43], s96 offen offset:2048 lds
    s_mov_b32 s96, 288768
    buffer_load_dwordx4 v8, s[40:43], s96 offen offset:3072 lds
    s_sub_u32 s96, 4, s34
    s_cselect_b32 s97, 5, 0
    s_add_u32 s96, s96, s97
    s_lshl_b32 m0, s96, 12
    s_mov_b32 s96, 332800
    buffer_load_dwordx4 v8, s[40:43], s96 offen offset:0 lds
    s_mov_b32 s96, 357376
    buffer_load_dwordx4 v8, s[40:43], s96 offen offset:1024 lds
    s_mov_b32 s96, 340992
    buffer_load_dwordx4 v8, s[40:43], s96 offen offset:2048 lds
    s_mov_b32 s96, 365568
    buffer_load_dwordx4 v8, s[40:43], s96 offen offset:3072 lds
    s_mov_b32 m0, 20480
    s_mov_b32 s96, 20480
    buffer_load_dwordx4 v9, s[40:43], s96 offen offset:0 lds
    s_mov_b32 s96, 121856
    buffer_load_dwordx4 v9, s[40:43], s96 offen offset:1024 lds
    s_mov_b32 s96, 197632
    buffer_load_dwordx4 v9, s[40:43], s96 offen offset:2048 lds
    s_mov_b32 s96, 273408
    buffer_load_dwordx4 v9, s[40:43], s96 offen offset:3072 lds
    s_mov_b32 m0, 61440
    s_mov_b32 s96, 430080
    buffer_load_dwordx4 v9, s[40:43], s96 offen offset:0 lds
    s_mov_b32 s96, 531456
    buffer_load_dwordx4 v9, s[40:43], s96 offen offset:1024 lds
    s_mov_b32 s96, 607232
    buffer_load_dwordx4 v9, s[40:43], s96 offen offset:2048 lds
    s_mov_b32 s96, 683008
    buffer_load_dwordx4 v9, s[40:43], s96 offen offset:3072 lds
    s_mov_b32 m0, 24576
    s_mov_b32 s96, 51200
    buffer_load_dwordx4 v8, s[40:43], s96 offen offset:0 lds
    s_mov_b32 s96, 382976
    buffer_load_dwordx4 v8, s[40:43], s96 offen offset:1024 lds
    s_mov_b32 s96, 59392
    buffer_load_dwordx4 v8, s[40:43], s96 offen offset:2048 lds
    s_mov_b32 s96, 391168
    buffer_load_dwordx4 v8, s[40:43], s96 offen offset:3072 lds
    s_mov_b32 m0, 65536
    s_mov_b32 s96, 460800
    buffer_load_dwordx4 v8, s[40:43], s96 offen offset:0 lds
    s_mov_b32 s96, 792576
    buffer_load_dwordx4 v8, s[40:43], s96 offen offset:1024 lds
    s_mov_b32 s96, 468992
    buffer_load_dwordx4 v8, s[40:43], s96 offen offset:2048 lds
    s_mov_b32 s96, 800768
    buffer_load_dwordx4 v8, s[40:43], s96 offen offset:3072 lds
    s_mov_b32 m0, 28672
    s_mov_b32 s96, 76800
    buffer_load_dwordx4 v8, s[40:43], s96 offen offset:0 lds
    s_mov_b32 s96, 152576
    buffer_load_dwordx4 v8, s[40:43], s96 offen offset:1024 lds
    s_mov_b32 s96, 84992
    buffer_load_dwordx4 v8, s[40:43], s96 offen offset:2048 lds
    s_mov_b32 s96, 160768
    buffer_load_dwordx4 v8, s[40:43], s96 offen offset:3072 lds
    s_mov_b32 m0, 69632
    s_mov_b32 s96, 486400
    buffer_load_dwordx4 v8, s[40:43], s96 offen offset:0 lds
    s_mov_b32 s96, 562176
    buffer_load_dwordx4 v8, s[40:43], s96 offen offset:1024 lds
    s_mov_b32 s96, 494592
    buffer_load_dwordx4 v8, s[40:43], s96 offen offset:2048 lds
    s_mov_b32 s96, 570368
    buffer_load_dwordx4 v8, s[40:43], s96 offen offset:3072 lds
    s_mov_b32 m0, 32768
    s_mov_b32 s96, 230400
    buffer_load_dwordx4 v8, s[40:43], s96 offen offset:0 lds
    s_mov_b32 s96, 306176
    buffer_load_dwordx4 v8, s[40:43], s96 offen offset:1024 lds
    s_mov_b32 s96, 238592
    buffer_load_dwordx4 v8, s[40:43], s96 offen offset:2048 lds
    s_mov_b32 s96, 314368
    buffer_load_dwordx4 v8, s[40:43], s96 offen offset:3072 lds
    s_mov_b32 m0, 73728
    s_mov_b32 s96, 640000
    buffer_load_dwordx4 v8, s[40:43], s96 offen offset:0 lds
    s_mov_b32 s96, 715776
    buffer_load_dwordx4 v8, s[40:43], s96 offen offset:1024 lds
    s_mov_b32 s96, 648192
    buffer_load_dwordx4 v8, s[40:43], s96 offen offset:2048 lds
    s_mov_b32 s96, 723968
    buffer_load_dwordx4 v8, s[40:43], s96 offen offset:3072 lds
    s_mov_b32 m0, 36864
    s_mov_b32 s96, 353280
    buffer_load_dwordx4 v9, s[40:43], s96 offen offset:0 lds
    s_mov_b32 s96, 70656
    buffer_load_dwordx4 v11, s[40:43], s96 offen offset:1024 lds
    s_mov_b32 s96, 95232
    buffer_load_dwordx4 v10, s[40:43], s96 offen offset:2048 lds
    s_mov_b32 s96, 247808
    buffer_load_dwordx4 v10, s[40:43], s96 offen offset:3072 lds
    s_mov_b32 m0, 77824
    s_mov_b32 s96, 762880
    buffer_load_dwordx4 v9, s[40:43], s96 offen offset:0 lds
    s_mov_b32 s96, 480256
    buffer_load_dwordx4 v11, s[40:43], s96 offen offset:1024 lds
    s_mov_b32 s96, 504832
    buffer_load_dwordx4 v10, s[40:43], s96 offen offset:2048 lds
    s_mov_b32 s96, 657408
    buffer_load_dwordx4 v10, s[40:43], s96 offen offset:3072 lds
    v_lshlrev_b32 v27, 2, v0
    v_add_u32 v27, 161088, v27
    s_waitcnt vmcnt(0)
    v_mov_b32 v4, 1
    s_mov_b64 exec, 1
    ds_add_u32 v3, v4 offset:4
    s_mov_b64 exec, -1
    s_mov_b32 s100, 0
    v_mov_b32 v30, s31
L_gp:
    buffer_load_dwordx2 v[28:29], v26, s[44:47], s54 offen sc1
    s_mov_b32 exec_hi, 0
    buffer_load_dwordx2 v[30:31], v26, s[44:47], s54 offen offset:512 sc1
    s_mov_b32 exec_hi, -1
    s_waitcnt vmcnt(0)
    v_cmp_ne_u32 vcc, s31, v28
    v_cmp_ne_u32 s[56:57], s31, v30
    s_or_b64 vcc, vcc, s[56:57]
    s_cbranch_scc0 L_gpd
    s_sleep 8
    s_add_u32 s100, s100, 1
    s_cmp_lt_u32 s100, 1048576
    s_cbranch_scc1 L_gp
L_gpd:
    ds_write_b32 v27, v29
    s_mov_b32 exec_hi, 0
    ds_write_b32 v27, v31 offset:256
    s_mov_b32 exec_hi, -1
    v_mov_b32 v4, 1
    ds_write_b32 v3, v4 offset:12
    s_lshl_b32 s92, s2, 7
    s_and_b32 s92, s92, 0x1f80
    s_load_dwordx2 s[86:87], s[28:29], s92 offset:8192
    s_mov_b32 s100, 0
Lpo_54:
    s_waitcnt lgkmcnt(0)
    s_cmp_eq_u32 s86, s31
    s_cbranch_scc1 Lpd_55
    s_sleep 16
    s_load_dwordx2 s[86:87], s[28:29], s92 offset:8192 glc
    s_add_u32 s100, s100, 1
    s_cmp_lt_u32 s100, 1048576
    s_cbranch_scc1 Lpo_54
    s_waitcnt lgkmcnt(0)
Lpd_55:
    s_and_b32 s92, s87, 0x2000
    s_mul_i32 s96, s32, 164096
    s_cmp_ge_u32 s32, 11
    s_cselect_b32 s100, 1796864, 0
    s_sub_u32 s96, s96, s100
    s_mul_i32 s100, s33, 16640
    s_add_u32 s96, s96, s100
    s_add_u32 s96, s96, 263808
    s_xor_b32 s96, s96, s92
    s_add_u32 s48, s28, s96
    s_addc_u32 s49, s29, 0
    s_mov_b32 s50, 0
    s_mov_b32 s100, 0
    v_mov_b32 v5, 1
    s_min_u32 s51, s34, 1
    s_lshl_b32 s51, s51, 1
    s_mov_b32 s100, 0
Lw_56:
    ds_read_b32 v4, v3 offset:16
    s_waitcnt lgkmcnt(0)
    v_readfirstlane_b32 s99, v4
    s_cmp_ge_u32 s99, s51
    s_cbranch_scc1 Lwd_57
    s_sleep 2
    s_add_u32 s100, s100, 1
    s_cmp_lt_u32 s100, 8388608
    s_cbranch_scc1 Lw_56
Lwd_57:
    s_mov_b32 s100, 0
Lrl_58:
    s_load_dwordx8 s[4:11], s[48:49], 0 glc
    s_load_dwordx8 s[12:19], s[48:49], 256 glc
    s_waitcnt lgkmcnt(0)
    s_cmp_lg_u32 s4, s31
    s_cbranch_scc1 Lrn_60
    s_cmp_lg_u32 s6, s31
    s_cbranch_scc1 Lrn_60
    s_cmp_lg_u32 s8, s31
    s_cbranch_scc1 Lrn_60
    s_cmp_lg_u32 s10, s31
    s_cbranch_scc1 Lrn_60
    s_bitcmp1_b32 s50, 0
    s_cbranch_scc1 Lrn_60
    ds_write_b32 v3, v5 offset:88
    s_bitset1_b32 s50, 0
Lrn_60:
    s_cmp_lg_u32 s12, s31
    s_cbranch_scc1 Lrn_61
    s_cmp_lg_u32 s14, s31
    s_cbranch_scc1 Lrn_61
    s_cmp_lg_u32 s16, s31
    s_cbranch_scc1 Lrn_61
    s_cmp_lg_u32 s18, s31
    s_cbranch_scc1 Lrn_61
    s_bitcmp1_b32 s50, 1
    s_cbranch_scc1 Lrn_61
    ds_write_b32 v3, v5 offset:92
    s_bitset1_b32 s50, 1
Lrn_61:
    s_cmp_eq_u32 s50, 3
    s_cbranch_scc1 Lrd_59
    s_add_u32 s100, s100, 1
    s_cmp_lt_u32 s100, 1048576
    s_cbranch_scc1 Lrl_58
Lrd_59:
    s_endpgm
L_s0:
    s_mul_i32 s31, s31, 1664525
    s_add_u32 s31, s31, 1013904223
    s_mov_b32 s100, 0
Lpo_62:
    s_waitcnt lgkmcnt(0)
    s_cmp_eq_u32 s86, s31
    s_cbranch_scc1 Lpd_63
    s_sleep 16
    s_load_dwordx2 s[86:87], s[28:29], s92 offset:8192 glc
    s_add_u32 s100, s100, 1
    s_cmp_lt_u32 s100, 1048576
    s_cbranch_scc1 Lpo_62
    s_waitcnt lgkmcnt(0)
Lpd_63:
    s_and_b32 s92, s87, 0x2000
    s_mov_b32 s44, s28
    s_and_b32 s45, s29, 0xffff
    s_mov_b32 s46, 16777216
    s_mov_b32 s47, 0x00020000
    v_lshrrev_b32 v4, 3, v0
    v_and_b32 v5, 7, v0
    v_mul_u32_u24 v4, 1280, v4
    v_lshlrev_b32 v6, 1, v2
    v_xor_b32 v5, v5, v6
    v_lshl_add_u32 v4, v5, 4, v4
    s_lshl_b32 s96, s33, 7
    v_add_u32 v8, s96, v4
    v_lshrrev_b32 v4, 5, v0
    v_mul_u32_u24 v5, 20480, v4
    v_add_u32 v9, v8, v5
    v_mul_u32_u24 v5, 71680, v4
    v_add_u32 v10, v8, v5
    v_mul_u32_u24 v5, 327680, v4
    v_add_u32 v11, v8, v5
    s_mov_b32 s40, s20
    s_and_b32 s41, s21, 0xffff
    s_mov_b32 s42, 819200
    s_mov_b32 s43, 0x00020000
    v_lshlrev_b32 v17, 4, v0
    s_waitcnt vmcnt(0)
    s_barrier
    s_mul_i32 s96, s32, 164096
    s_cmp_ge_u32 s32, 11
    s_cselect_b32 s100, 1796864, 0
    s_sub_u32 s96, s96, s100
    s_mul_i32 s100, s33, 16640
    s_add_u32 s96, s96, s100
    s_add_u32 s96, s96, 262656
    s_xor_b32 s96, s96, s92
    s_add_u32 s48, s28, s96
    s_addc_u32 s49, s29, 0
    s_mul_i32 s52, s32, 327680
    s_cmp_ge_u32 s32, 11
    s_cselect_b32 s100, 3596288, 0
    s_sub_u32 s52, s52, s100
    s_lshl_b32 s100, s33, 15
    s_add_u32 s52, s52, s100
    s_add_u32 s52, s52, 12812288
    s_lshr_b32 s100, s52, 8
    s_and_b32 s100, s100, 8192
    s_xor_b32 s52, s52, s100
    s_xor_b32 s52, s52, s92
    s_setprio 3
    s_barrier
    s_sub_u32 s96, 0, s34
    s_cselect_b32 s97, 15, 10
    s_add_u32 s96, s96, s97
    s_lshl_b32 m0, s96, 12
    s_mov_b32 s96, 409600
    buffer_load_dwordx4 v8, s[40:43], s96 offen offset:0 lds
    s_mov_b32 s96, 434176
    buffer_load_dwordx4 v8, s[40:43], s96 offen offset:1024 lds
    s_mov_b32 s96, 417792
    buffer_load_dwordx4 v8, s[40:43], s96 offen offset:2048 lds
    s_mov_b32 s96, 442368
    buffer_load_dwordx4 v8, s[40:43], s96 offen offset:3072 lds
    s_sub_u32 s96, 1, s34
    s_cselect_b32 s97, 15, 10
    s_add_u32 s96, s96, s97
    s_lshl_b32 m0, s96, 12
    s_mov_b32 s96, 512000
    buffer_load_dwordx4 v8, s[40:43], s96 offen offset:0 lds
    s_mov_b32 s96, 536576
    buffer_load_dwordx4 v8, s[40:43], s96 offen offset:1024 lds
    s_mov_b32 s96, 520192
    buffer_load_dwordx4 v8, s[40:43], s96 offen offset:2048 lds
    s_mov_b32 s96, 544768
    buffer_load_dwordx4 v8, s[40:43], s96 offen offset:3072 lds
    s_sub_u32 s96, 2, s34
    s_cselect_b32 s97, 15, 10
    s_add_u32 s96, s96, s97
    s_lshl_b32 m0, s96, 12
    s_mov_b32 s96, 588800
    buffer_load_dwordx4 v8, s[40:43], s96 offen offset:0 lds
    s_mov_b32 s96, 613376
    buffer_load_dwordx4 v8, s[40:43], s96 offen offset:1024 lds
    s_mov_b32 s96, 596992
    buffer_load_dwordx4 v8, s[40:43], s96 offen offset:2048 lds
    s_mov_b32 s96, 621568
    buffer_load_dwordx4 v8, s[40:43], s96 offen offset:3072 lds
    s_sub_u32 s96, 3, s34
    s_cselect_b32 s97, 15, 10
    s_add_u32 s96, s96, s97
    s_lshl_b32 m0, s96, 12
    s_mov_b32 s96, 665600
    buffer_load_dwordx4 v8, s[40:43], s96 offen offset:0 lds
    s_mov_b32 s96, 690176
    buffer_load_dwordx4 v8, s[40:43], s96 offen offset:1024 lds
    s_mov_b32 s96, 673792
    buffer_load_dwordx4 v8, s[40:43], s96 offen offset:2048 lds
    s_mov_b32 s96, 698368
    buffer_load_dwordx4 v8, s[40:43], s96 offen offset:3072 lds
    s_sub_u32 s96, 4, s34
    s_cselect_b32 s97, 15, 10
    s_add_u32 s96, s96, s97
    s_lshl_b32 m0, s96, 12
    s_mov_b32 s96, 742400
    buffer_load_dwordx4 v8, s[40:43], s96 offen offset:0 lds
    s_mov_b32 s96, 766976
    buffer_load_dwordx4 v8, s[40:43], s96 offen offset:1024 lds
    s_mov_b32 s96, 750592
    buffer_load_dwordx4 v8, s[40:43], s96 offen offset:2048 lds
    s_mov_b32 s96, 775168
    buffer_load_dwordx4 v8, s[40:43], s96 offen offset:3072 lds
    s_cmp_eq_u32 s34, 0
    s_cbranch_scc1 L_s0n
    s_mov_b32 s100, 0
L_xp:
    s_add_u32 s100, s100, 1
    s_cmp_ge_u32 s100, 1048576
    s_cbranch_scc1 L_xpd
    s_load_dwordx2 s[4:5], s[48:49], 0 glc
    s_waitcnt lgkmcnt(0)
    s_cmp_lg_u32 s4, s31
    s_cbranch_scc1 L_xp
L_xpd:
    s_mov_b32 m0, 81920
    s_nop 0
    buffer_load_dwordx4 v17, s[44:47], s52 offen offset:0 sc1 lds
    buffer_load_dwordx4 v17, s[44:47], s52 offen offset:1024 sc1 lds
    buffer_load_dwordx4 v17, s[44:47], s52 offen offset:2048 sc1 lds
    buffer_load_dwordx4 v17, s[44:47], s52 offen offset:3072 sc1 lds
    s_add_u32 m0, m0, 4096
    s_add_u32 s52, s52, 4096
    buffer_load_dwordx4 v17, s[44:47], s52 offen offset:0 sc1 lds
    buffer_load_dwordx4 v17, s[44:47], s52 offen offset:1024 sc1 lds
    buffer_load_dwordx4 v17, s[44:47], s52 offen offset:2048 sc1 lds
    buffer_load_dwordx4 v17, s[44:47], s52 offen offset:3072 sc1 lds
    s_add_u32 m0, m0, 4096
    s_add_u32 s52, s52, 12288
    buffer_load_dwordx4 v17, s[44:47], s52 offen offset:0 sc1 lds
    buffer_load_dwordx4 v17, s[44:47], s52 offen offset:1024 sc1 lds
L_s0n:
    s_waitcnt vmcnt(0)
    v_mov_b32 v4, 1
    ds_write_b32 v3, v4 offset:8
    v_mov_b32 v4, 1
    s_mov_b64 exec, 1
    ds_add_u32 v3, v4 offset:4
    s_mov_b64 exec, -1
    s_mul_i32 s96, s32, 164096
    s_cmp_ge_u32 s32, 11
    s_cselect_b32 s100, 1796864, 0
    s_sub_u32 s96, s96, s100
    s_mul_i32 s100, s33, 16640
    s_add_u32 s96, s96, s100
    s_add_u32 s96, s96, 263296
    s_xor_b32 s96, s96, s92
    s_add_u32 s48, s28, s96
    s_addc_u32 s49, s29, 0
    s_mov_b32 s50, 0
    s_mov_b32 s100, 0
    v_mov_b32 v5, 1
    s_min_u32 s51, s34, 1
    s_lshl_b32 s51, s51, 1
    s_mov_b32 s100, 0
Lw_64:
    ds_read_b32 v4, v3 offset:16
    s_waitcnt lgkmcnt(0)
    v_readfirstlane_b32 s99, v4
    s_cmp_ge_u32 s99, s51
    s_cbranch_scc1 Lwd_65
    s_sleep 2
    s_add_u32 s100, s100, 1
    s_cmp_lt_u32 s100, 8388608
    s_cbranch_scc1 Lw_64
Lwd_65:
    s_mov_b32 s100, 0
Lrl_66:
    s_load_dwordx8 s[4:11], s[48:49], 0 glc
    s_load_dwordx8 s[12:19], s[48:49], 256 glc
    s_waitcnt lgkmcnt(0)
    s_cmp_lg_u32 s4, s31
    s_cbranch_scc1 Lrn_68
    s_cmp_lg_u32 s6, s31
    s_cbranch_scc1 Lrn_68
    s_cmp_lg_u32 s8, s31
    s_cbranch_scc1 Lrn_68
    s_cmp_lg_u32 s10, s31
    s_cbranch_scc1 Lrn_68
    s_bitcmp1_b32 s50, 0
    s_cbranch_scc1 Lrn_68
    ds_write_b32 v3, v5 offset:80
    s_bitset1_b32 s50, 0
Lrn_68:
    s_cmp_lg_u32 s12, s31
    s_cbranch_scc1 Lrn_69
    s_cmp_lg_u32 s14, s31
    s_cbranch_scc1 Lrn_69
    s_cmp_lg_u32 s16, s31
    s_cbranch_scc1 Lrn_69
    s_cmp_lg_u32 s18, s31
    s_cbranch_scc1 Lrn_69
    s_bitcmp1_b32 s50, 1
    s_cbranch_scc1 Lrn_69
    ds_write_b32 v3, v5 offset:84
    s_bitset1_b32 s50, 1
Lrn_69:
    s_cmp_eq_u32 s50, 3
    s_cbranch_scc1 Lrd_67
    s_add_u32 s100, s100, 1
    s_cmp_lt_u32 s100, 1048576
    s_cbranch_scc1 Lrl_66
Lrd_67:
    s_endpgm
L_ps:
    s_cmp_ge_u32 s30, 4
    s_cselect_b32 s96, -4, 3
    s_add_u32 s60, s30, s96
    s_and_b32 s61, s60, 1
    s_and_b32 s96, s34, 3
    s_cselect_b32 s96, 4, 6
    s_cmp_ge_u32 s60, s96
    s_cselect_b32 s62, 1, 0
    v_mov_b32 v7, 0xf149f2ca
    v_lshlrev_b32 v4, 2, v2
    v_sub_u32 v4, v1, v4
    v_subrev_u32 v5, 0, v4
    v_and_b32 v5, 0x80000001, v5
    v_cmp_eq_u32 vcc, 0, v5
    s_nop 1
    v_cndmask_b32 v146, v7, 0, vcc
    v_cmp_eq_u32 vcc, 0x80000000, v5
    s_nop 1
    v_cndmask_b32 v150, v7, 0, vcc
    v_subrev_u32 v5, 1, v4
    v_and_b32 v5, 0x80000001, v5
    v_cmp_eq_u32 vcc, 0, v5
    s_nop 1
    v_cndmask_b32 v147, v7, 0, vcc
    v_cmp_eq_u32 vcc, 0x80000000, v5
    s_nop 1
    v_cndmask_b32 v151, v7, 0, vcc
    v_subrev_u32 v5, 2, v4
    v_and_b32 v5, 0x80000001, v5
    v_cmp_eq_u32 vcc, 0, v5
    s_nop 1
    v_cndmask_b32 v148, v7, 0, vcc
    v_cmp_eq_u32 vcc, 0x80000000, v5
    s_nop 1
    v_cndmask_b32 v152, v7, 0, vcc
    v_subrev_u32 v5, 3, v4
    v_and_b32 v5, 0x80000001, v5
    v_cmp_eq_u32 vcc, 0, v5
    s_nop 1
    v_cndmask_b32 v149, v7, 0, vcc
    v_cmp_eq_u32 vcc, 0x80000000, v5
    s_nop 1
    v_cndmask_b32 v153, v7, 0, vcc
    v_and_b32 v5, 1, v1
    v_lshlrev_b32 v6, 4, v5
    v_sub_u32 v5, v4, v5
    v_mov_b32 v4, 0x0c0c0c0c
    v_mov_b32 v7, 0xc0c0100
    v_alignbit_b32 v7, v7, v7, v6
    v_cmp_le_i32 vcc, 0, v5
    s_nop 1
    v_cndmask_b32 v154, v4, v7, vcc
    v_cndmask_b32 v156, v7, v4, vcc
    v_mov_b32 v7, 0xc0c0302
    v_alignbit_b32 v7, v7, v7, v6
    v_cmp_le_i32 vcc, 2, v5
    s_nop 1
    v_cndmask_b32 v155, v4, v7, vcc
    v_cndmask_b32 v157, v7, v4, vcc
    v_cmp_eq_u32 vcc, 0, v2
    s_nop 1
    v_cndmask_b32 v159, 0, -1, vcc
    s_mov_b32 s66, 0x3ea52b5c
    s_or_b32 s96, s32, s61
    s_cselect_b32 s67, 0, 0xf149f2ca
    s_mul_i32 s64, s61, 6128
    s_add_u32 s64, s64, 3080
    s_mul_i32 s65, s61, 3064
    s_add_u32 s65, s65, 6152
    s_mul_i32 s68, s32, 262144
    s_cmp_ge_u32 s32, 11
    s_cselect_b32 s100, 2875392, 0
    s_sub_u32 s68, s68, s100
    s_lshl_b32 s96, s61, 17
    s_add_u32 s68, s68, s96
    s_add_u32 s68, s68, 9961472
    s_lshr_b32 s100, s68, 8
    s_and_b32 s100, s100, 8192
    s_xor_b32 s68, s68, s100
    s_mov_b32 s69, 0
    s_cmp_lg_u32 s101, 1
    s_cbranch_scc1 L_us
    s_waitcnt vmcnt(0)
    s_barrier
L_us:
    s_min_u32 s96, s34, 1
    s_lshr_b32 s97, s60, 1
    s_add_u32 s96, s96, s97
    s_lshl1_add_u32 s99, s34, s97
    s_lshr_b32 s98, s34, 2
    s_add_u32 s98, s98, 10
    s_cmp_ge_u32 s60, 4
    s_cselect_b32 s63, s98, s99
    s_add_u32 s98, s34, 11
    s_cmp_lg_u32 s62, 0
    s_cselect_b32 s63, s98, s63
    s_cselect_b32 s96, 0, s96
    s_add_u32 s98, s34, 10
    v_sub_u32 v4, s98, v1
    v_mul_u32_u24 v5, 52, v4
    v_lshrrev_b32 v5, 8, v5
    v_mul_u32_u24 v5, 5, v5
    v_sub_u32 v4, v4, v5
    s_sub_u32 s99, s63, 5
    s_mul_i32 s98, s62, 9
    s_add_u32 s99, s99, s98
    s_cmp_lt_u32 s60, 4
    s_cbranch_scc1 L_ufs
    v_mov_b32 v4, s99
L_ufs:
    s_and_b32 s98, s2, 1
    s_lshl1_add_u32 s98, s98, s61
    s_lshl_b32 s98, s98, 8
    s_mul_i32 s99, s32, 164096
    s_cmp_ge_u32 s32, 11
    s_cselect_b32 s100, 1796864, 0
    s_sub_u32 s99, s99, s100
    s_add_u32 s98, s98, s99
    s_add_u32 s98, s98, 263168
    v_lshl_add_u32 v4, v4, 3, s98
    v_mul_u32_u24 v164, 16640, v1
    v_add_u32 v164, v164, v4
    s_mul_i32 s96, s96, 5
    s_add_u32 s96, s96, 4
    s_sub_u32 s96, s96, s34
    s_lshl3_add_u32 s97, s61, 81920
    v_add_u32 v4, s96, v2
    v_lshrrev_b32 v5, 2, v4
    v_mul_u32_u24 v5, 9216, v5
    v_lshl_add_u32 v5, v4, 8, v5
    v_lshl_add_u32 v6, v1, 4, s97
    v_add_u32 v158, v5, v6
    s_lshl_b32 s96, s96, 2
    v_lshl_add_u32 v6, v2, 8, s97
    v_add_u32 v4, s96, v1
    v_lshrrev_b32 v5, 4, v4
    v_mul_u32_u24 v5, 9984, v5
    v_lshl_add_u32 v5, v4, 4, v5
    v_add_u32 v160, v5, v6
    s_lshr_b32 s98, s96, 4
    s_mul_i32 s98, s98, 9984
    s_lshl4_add_u32 s98, s96, s98
    s_add_u32 s98, s98, 10240
    v_and_b32 v4, 3, v1
    v_lshl_add_u32 v4, v4, 4, s98
    v_add_u32 v161, v4, v6
    s_and_b32 s97, s2, 1
    s_lshl_b32 s97, s97, 16
    s_lshl_b32 s96, s63, 9
    s_add_u32 s96, s96, s97
    v_lshrrev_b32 v4, 5, v0
    v_mul_u32_u24 v4, 15872, v4
    v_lshl_add_u32 v4, v0, 4, v4
    v_add_u32 v162, s96, v4
    s_lshl_b32 s96, s63, 7
    s_add_u32 s96, s96, s97
    s_add_u32 s96, s96, 49152
    v_lshlrev_b32 v4, 11, v2
    v_lshl_add_u32 v4, v1, 3, v4
    v_add_u32 v163, s96, v4
    s_cmp_eq_u32 s101, 1
    s_cbranch_scc1 L_pb10
    s_cmp_eq_u32 s101, 2
    s_cbranch_scc1 L_upre
    s_setprio 2
    v_lshrrev_b32 v5, 1, v1
    v_xor_b32 v5, v5, v2
    v_lshlrev_b32 v5, 4, v5
    v_lshl_add_u32 v140, v1, 7, v5
    v_bfe_u32 v4, v0, 2, 2
    v_lshl_add_u32 v5, v2, 3, v4
    v_lshlrev_b32 v5, 7, v5
    v_bfe_u32 v6, v0, 3, 2
    v_xor_b32 v6, s60, v6
    v_lshl_add_u32 v5, v6, 5, v5
    v_and_b32 v6, 3, v0
    v_lshl_add_u32 v5, v6, 3, v5
    v_add_u32 v141, 14336, v5
    v_mov_b32 v8, 0
    v_mov_b32 v9, 0
    v_mov_b32 v10, 0
    v_mov_b32 v11, 0
    v_mov_b32 v12, 0
    v_mov_b32 v13, 0
    v_mov_b32 v14, 0
    v_mov_b32 v15, 0
    v_mov_b32 v16, 0
    v_mov_b32 v17, 0
    v_mov_b32 v18, 0
    v_mov_b32 v19, 0
    v_mov_b32 v20, 0
    v_mov_b32 v21, 0
    v_mov_b32 v22, 0
    v_mov_b32 v23, 0
    v_mov_b32 v24, 0
    v_mov_b32 v25, 0
    v_mov_b32 v26, 0
    v_mov_b32 v27, 0
    v_mov_b32 v28, 0
    v_mov_b32 v29, 0
    v_mov_b32 v30, 0
    v_mov_b32 v31, 0
    v_mov_b32 v32, 0
    v_mov_b32 v33, 0
    v_mov_b32 v34, 0
    v_mov_b32 v35, 0
    v_mov_b32 v36, 0
    v_mov_b32 v37, 0
    v_mov_b32 v38, 0
    v_mov_b32 v39, 0
    v_mov_b32 v40, 0
    v_mov_b32 v41, 0
    v_mov_b32 v42, 0
    v_mov_b32 v43, 0
    v_mov_b32 v44, 0
    v_mov_b32 v45, 0
    v_mov_b32 v46, 0
    v_mov_b32 v47, 0
    v_mov_b32 v48, 0
    v_mov_b32 v49, 0
    v_mov_b32 v50, 0
    v_mov_b32 v51, 0
    v_mov_b32 v52, 0
    v_mov_b32 v53, 0
    v_mov_b32 v54, 0
    v_mov_b32 v55, 0
    v_mov_b32 v56, 0
    v_mov_b32 v57, 0
    v_mov_b32 v58, 0
    v_mov_b32 v59, 0
    v_mov_b32 v60, 0
    v_mov_b32 v61, 0
    v_mov_b32 v62, 0
    v_mov_b32 v63, 0
    v_mov_b32 v64, 0
    v_mov_b32 v65, 0
    v_mov_b32 v66, 0
    v_mov_b32 v67, 0
    v_mov_b32 v68, 0
    v_mov_b32 v69, 0
    v_mov_b32 v70, 0
    v_mov_b32 v71, 0
    v_mov_b32 v72, 0
    v_mov_b32 v73, 0
    v_mov_b32 v74, 0
    v_mov_b32 v75, 0
    v_mov_b32 v76, 0
    v_mov_b32 v77, 0
    v_mov_b32 v78, 0
    v_mov_b32 v79, 0
    v_mov_b32 v80, 0
    v_mov_b32 v81, 0
    v_mov_b32 v82, 0
    v_mov_b32 v83, 0
    v_mov_b32 v84, 0
    v_mov_b32 v85, 0
    v_mov_b32 v86, 0
    v_mov_b32 v87, 0
    s_mov_b32 s41, 0
    s_mov_b32 s42, 0
    v_mov_b32 v142, v140
    v_xor_b32 v143, 64, v140
    v_mov_b32 v144, v141
    s_add_u32 s96, s60, 1
    s_mul_i32 s96, s96, 10240
    s_add_u32 s96, s96, 81920
    v_lshl_add_u32 v145, v0, 4, s96
    v_lshlrev_b32 v7, 4, v0
    s_waitcnt lgkmcnt(0)
    s_mov_b32 s44, s28
    s_and_b32 s45, s29, 0xffff
    s_mov_b32 s46, 16777216
    s_mov_b32 s47, 0x00020000
    s_mul_i32 s70, s32, 327680
    s_cmp_ge_u32 s32, 11
    s_cselect_b32 s100, 3596288, 0
    s_sub_u32 s70, s70, s100
    s_lshl_b32 s100, s33, 15
    s_add_u32 s70, s70, s100
    s_add_u32 s70, s70, 12845056
    s_lshr_b32 s100, s70, 8
    s_and_b32 s100, s100, 8192
    s_xor_b32 s70, s70, s100
    s_mul_i32 s97, s32, 164096
    s_cmp_ge_u32 s32, 11
    s_cselect_b32 s100, 1796864, 0
    s_sub_u32 s97, s97, s100
    s_mul_i32 s100, s33, 16640
    s_add_u32 s97, s97, s100
    s_add_u32 s97, s97, 279296
    s_cmp_eq_u32 s30, 7
    s_cselect_b32 s69, s97, 0
    s_cmp_eq_u32 s34, 4
    s_cselect_b32 s69, 0, s69
    s_load_dword s31, s[28:29], 0
    s_barrier
    ds_read_b64_tr_b16 v[120:121], v144 offset:4096
    ds_read_b64_tr_b16 v[122:123], v144 offset:4608
    ds_read_b128 v[88:91], v142 offset:0
    ds_read_b64_tr_b16 v[124:125], v144 offset:8192
    ds_read_b64_tr_b16 v[126:127], v144 offset:8704
    ds_read_b128 v[92:95], v142 offset:2048
    ds_read_b64_tr_b16 v[116:117], v144 offset:0
    ds_read_b64_tr_b16 v[118:119], v144 offset:512
    ds_read_b128 v[96:99], v142 offset:4096
    ds_read_b128 v[100:103], v142 offset:6144
    ds_read_b128 v[104:107], v142 offset:8192
    ds_read_b128 v[108:111], v142 offset:10240
    ds_read_b128 v[112:115], v142 offset:12288
    s_waitcnt lgkmcnt(0)
    s_mul_i32 s31, s31, 1664525
    s_add_u32 s31, s31, 1013904223
L_gl:
    s_waitcnt lgkmcnt(10)
    v_mfma_f32_16x16x32_bf16 v[32:35], v[120:123], v[88:91], v[32:35]
    ds_read_b64_tr_b16 v[132:133], v144 offset:16384
    s_waitcnt lgkmcnt(9)
    v_mfma_f32_16x16x32_bf16 v[60:63], v[88:91], v[124:127], v[60:63]
    ds_read_b64_tr_b16 v[134:135], v144 offset:16896
    s_waitcnt lgkmcnt(9)
    v_mfma_f32_16x16x32_bf16 v[36:39], v[120:123], v[92:95], v[36:39]
    ds_read_b128 v[88:91], v143 offset:0
    v_mfma_f32_16x16x32_bf16 v[64:67], v[92:95], v[124:127], v[64:67]
    ds_read_b64_tr_b16 v[136:137], v144 offset:20480
    s_waitcnt lgkmcnt(9)
    v_mfma_f32_16x16x32_bf16 v[8:11], v[116:119], v[92:95], v[8:11]
    ds_read_b64_tr_b16 v[138:139], v144 offset:20992
    s_waitcnt lgkmcnt(9)
    v_mfma_f32_16x16x32_bf16 v[40:43], v[120:123], v[96:99], v[40:43]
    ds_read_b128 v[92:95], v143 offset:2048
    v_mfma_f32_16x16x32_bf16 v[68:71], v[96:99], v[124:127], v[68:71]
    ds_read_b64_tr_b16 v[128:129], v144 offset:12288
    v_mfma_f32_16x16x32_bf16 v[12:15], v[116:119], v[96:99], v[12:15]
    ds_read_b64_tr_b16 v[130:131], v144 offset:12800
    s_waitcnt lgkmcnt(11)
    v_mfma_f32_16x16x32_bf16 v[44:47], v[120:123], v[100:103], v[44:47]
    ds_read_b128 v[96:99], v143 offset:4096
    v_mfma_f32_16x16x32_bf16 v[72:75], v[100:103], v[124:127], v[72:75]
    s_cmp_lg_u32 s42, 8
    s_cbranch_scc1 L_gnp
    s_lshl_b32 s92, s2, 7
    s_and_b32 s92, s92, 0x1f80
    s_load_dwordx2 s[86:87], s[28:29], s92 offset:8192
L_gnp:
    v_mfma_f32_16x16x32_bf16 v[16:19], v[116:119], v[100:103], v[16:19]
    ds_read_b128 v[100:103], v143 offset:6144
    s_waitcnt lgkmcnt(12)
    v_mfma_f32_16x16x32_bf16 v[48:51], v[120:123], v[104:107], v[48:51]
    v_mfma_f32_16x16x32_bf16 v[76:79], v[104:107], v[124:127], v[76:79]
    s_add_u32 s41, s41, 38912
    v_mfma_f32_16x16x32_bf16 v[20:23], v[116:119], v[104:107], v[20:23]
    ds_read_b128 v[104:107], v143 offset:8192
    s_waitcnt lgkmcnt(12)
    v_mfma_f32_16x16x32_bf16 v[52:55], v[120:123], v[108:111], v[52:55]
    s_cmp_eq_u32 s41, 116736
    s_cselect_b32 s41, 0, s41
    v_mfma_f32_16x16x32_bf16 v[80:83], v[108:111], v[124:127], v[80:83]
    v_add_u32 v144, s41, v141
    v_mfma_f32_16x16x32_bf16 v[24:27], v[116:119], v[108:111], v[24:27]
    ds_read_b128 v[108:111], v143 offset:10240
    s_waitcnt lgkmcnt(12)
    v_mfma_f32_16x16x32_bf16 v[56:59], v[120:123], v[112:115], v[56:59]
    v_add_u32 v142, s41, v140
    v_mfma_f32_16x16x32_bf16 v[84:87], v[112:115], v[124:127], v[84:87]
    v_mfma_f32_16x16x32_bf16 v[28:31], v[116:119], v[112:115], v[28:31]
    ds_read_b128 v[112:115], v143 offset:12288
    s_waitcnt lgkmcnt(10)
    v_mfma_f32_16x16x32_bf16 v[32:35], v[132:135], v[88:91], v[32:35]
    s_waitcnt lgkmcnt(8)
    v_mfma_f32_16x16x32_bf16 v[60:63], v[88:91], v[136:139], v[60:63]
    v_xor_b32 v143, 64, v142
    s_waitcnt lgkmcnt(7)
    v_mfma_f32_16x16x32_bf16 v[36:39], v[132:135], v[92:95], v[36:39]
    s_add_u32 s42, s42, 1
    v_mfma_f32_16x16x32_bf16 v[64:67], v[92:95], v[136:139], v[64:67]
    s_waitcnt lgkmcnt(5)
    v_mfma_f32_16x16x32_bf16 v[8:11], v[128:131], v[92:95], v[8:11]
    s_waitcnt lgkmcnt(0)

    v_mfma_f32_16x16x32_bf16 v[40:43], v[132:135], v[96:99], v[40:43]
    v_mfma_f32_16x16x32_bf16 v[68:71], v[96:99], v[136:139], v[68:71]
    s_barrier
    v_mfma_f32_16x16x32_bf16 v[12:15], v[128:131], v[96:99], v[12:15]
    ds_read_b64_tr_b16 v[120:121], v144 offset:4096
    v_mfma_f32_16x16x32_bf16 v[44:47], v[132:135], v[100:103], v[44:47]
    ds_read_b64_tr_b16 v[122:123], v144 offset:4608
    v_mfma_f32_16x16x32_bf16 v[72:75], v[100:103], v[136:139], v[72:75]
    ds_read_b128 v[88:91], v142 offset:0
    v_mfma_f32_16x16x32_bf16 v[16:19], v[128:131], v[100:103], v[16:19]
    ds_read_b64_tr_b16 v[124:125], v144 offset:8192
    v_mfma_f32_16x16x32_bf16 v[48:51], v[132:135], v[104:107], v[48:51]
    ds_read_b64_tr_b16 v[126:127], v144 offset:8704
    v_mfma_f32_16x16x32_bf16 v[76:79], v[104:107], v[136:139], v[76:79]
    ds_read_b128 v[92:95], v142 offset:2048
    v_mfma_f32_16x16x32_bf16 v[20:23], v[128:131], v[104:107], v[20:23]
    ds_read_b64_tr_b16 v[116:117], v144 offset:0
    v_mfma_f32_16x16x32_bf16 v[52:55], v[132:135], v[108:111], v[52:55]
    ds_read_b64_tr_b16 v[118:119], v144 offset:512
    v_mfma_f32_16x16x32_bf16 v[80:83], v[108:111], v[136:139], v[80:83]
    ds_read_b128 v[96:99], v142 offset:4096
    v_mfma_f32_16x16x32_bf16 v[24:27], v[128:131], v[108:111], v[24:27]
    ds_read_b128 v[100:103], v142 offset:6144
    v_mfma_f32_16x16x32_bf16 v[56:59], v[132:135], v[112:115], v[56:59]
    ds_read_b128 v[104:107], v142 offset:8192
    v_mfma_f32_16x16x32_bf16 v[84:87], v[112:115], v[136:139], v[84:87]
    ds_read_b128 v[108:111], v142 offset:10240
    s_cmp_lt_u32 s42, 9
    v_mfma_f32_16x16x32_bf16 v[28:31], v[128:131], v[112:115], v[28:31]
    ds_read_b128 v[112:115], v142 offset:12288
    s_cbranch_scc1 L_gl
    s_cmp_lg_u32 s86, s31
    s_cbranch_scc1 L_gpslow
    s_and_b32 s92, s87, 0x2000
L_gpok:
    s_cmp_lg_u32 s69, 0
    s_cbranch_scc1 L_lsend

    s_waitcnt lgkmcnt(10)
    v_mfma_f32_16x16x32_bf16 v[32:35], v[120:123], v[88:91], v[32:35]
    ds_read_b64_tr_b16 v[132:133], v144 offset:16384
    s_waitcnt lgkmcnt(9)
    v_mfma_f32_16x16x32_bf16 v[60:63], v[88:91], v[124:127], v[60:63]
    ds_read_b128 v[88:91], v143 offset:0
    s_waitcnt lgkmcnt(5)
    v_mfma_f32_16x16x32_bf16 v[44:47], v[120:123], v[100:103], v[44:47]
    ds_read_b64_tr_b16 v[134:135], v144 offset:16896
    v_mfma_f32_16x16x32_bf16 v[72:75], v[100:103], v[124:127], v[72:75]
    ds_read_b64_tr_b16 v[136:137], v144 offset:20480
    v_mfma_f32_16x16x32_bf16 v[16:19], v[116:119], v[100:103], v[16:19]
    ds_read_b128 v[100:103], v143 offset:6144
    v_mfma_f32_16x16x32_bf16 v[36:39], v[120:123], v[92:95], v[36:39]
    ds_read_b64_tr_b16 v[138:139], v144 offset:20992
    v_mfma_f32_16x16x32_bf16 v[64:67], v[92:95], v[124:127], v[64:67]
    ds_read_b64_tr_b16 v[128:129], v144 offset:12288
    v_mfma_f32_16x16x32_bf16 v[8:11], v[116:119], v[92:95], v[8:11]
    ds_read_b128 v[92:95], v143 offset:2048
    s_waitcnt lgkmcnt(8)
    v_mfma_f32_16x16x32_bf16 v[56:59], v[120:123], v[112:115], v[56:59]
    ds_read_b64_tr_b16 v[130:131], v144 offset:12800
    v_mfma_f32_16x16x32_bf16 v[84:87], v[112:115], v[124:127], v[84:87]
    v_mfma_f32_16x16x32_bf16 v[28:31], v[116:119], v[112:115], v[28:31]
    ds_read_b128 v[112:115], v143 offset:12288
    s_waitcnt lgkmcnt(7)
    v_mfma_f32_16x16x32_bf16 v[32:35], v[132:135], v[88:91], v[32:35]
    s_waitcnt lgkmcnt(4)
    v_mfma_f32_16x16x32_bf16 v[60:63], v[88:91], v[136:139], v[60:63]
    v_mfma_f32_16x16x32_bf16 v[44:47], v[132:135], v[100:103], v[44:47]
    v_mfma_f32_16x16x32_bf16 v[72:75], v[100:103], v[136:139], v[72:75]
    s_waitcnt lgkmcnt(1)
    v_mfma_f32_16x16x32_bf16 v[16:19], v[128:131], v[100:103], v[16:19]
    s_nop 1
    v_cvt_pk_bf16_f32 v32, v32, v33
    v_cvt_pk_bf16_f32 v33, v34, v35
    v_mfma_f32_16x16x32_bf16 v[48:51], v[120:123], v[104:107], v[48:51]
    v_cvt_pk_bf16_f32 v60, v60, v61
    v_cvt_pk_bf16_f32 v61, v62, v63
    v_mfma_f32_16x16x32_bf16 v[76:79], v[104:107], v[124:127], v[76:79]
    v_cvt_pk_bf16_f32 v34, v44, v45
    v_cvt_pk_bf16_f32 v35, v46, v47
    v_mfma_f32_16x16x32_bf16 v[20:23], v[116:119], v[104:107], v[20:23]
    ds_read_b128 v[104:107], v143 offset:8192
    ds_write_b128 v145, v[32:35] offset:3072
    s_waitcnt lgkmcnt(2)
    v_mfma_f32_16x16x32_bf16 v[56:59], v[132:135], v[112:115], v[56:59]
    v_cvt_pk_bf16_f32 v62, v72, v73
    v_cvt_pk_bf16_f32 v63, v74, v75
    v_mfma_f32_16x16x32_bf16 v[84:87], v[112:115], v[136:139], v[84:87]
    ds_write_b128 v145, v[60:63] offset:6144
    v_cvt_pk_bf16_f32 v16, v16, v17
    v_mfma_f32_16x16x32_bf16 v[28:31], v[128:131], v[112:115], v[28:31]
    v_cvt_pk_bf16_f32 v17, v18, v19
    v_mfma_f32_16x16x32_bf16 v[40:43], v[120:123], v[96:99], v[40:43]
    v_mfma_f32_16x16x32_bf16 v[68:71], v[96:99], v[124:127], v[68:71]
    v_cvt_pk_bf16_f32 v56, v56, v57
    v_cvt_pk_bf16_f32 v57, v58, v59
    v_mfma_f32_16x16x32_bf16 v[12:15], v[116:119], v[96:99], v[12:15]
    ds_read_b128 v[96:99], v143 offset:4096
    v_cvt_pk_bf16_f32 v58, v84, v85
    v_mfma_f32_16x16x32_bf16 v[36:39], v[132:135], v[92:95], v[36:39]
    v_cvt_pk_bf16_f32 v59, v86, v87
    ds_write_b128 v145, v[56:59] offset:9216
    v_mfma_f32_16x16x32_bf16 v[64:67], v[92:95], v[136:139], v[64:67]
    v_cvt_pk_bf16_f32 v18, v28, v29
    v_cvt_pk_bf16_f32 v19, v30, v31
    v_mfma_f32_16x16x32_bf16 v[8:11], v[128:131], v[92:95], v[8:11]
    ds_write_b128 v145, v[16:19] offset:2048
    v_mfma_f32_16x16x32_bf16 v[52:55], v[120:123], v[108:111], v[52:55]
    v_mfma_f32_16x16x32_bf16 v[80:83], v[108:111], v[124:127], v[80:83]
    v_cvt_pk_bf16_f32 v36, v36, v37
    v_cvt_pk_bf16_f32 v37, v38, v39
    v_mfma_f32_16x16x32_bf16 v[24:27], v[116:119], v[108:111], v[24:27]
    ds_read_b128 v[108:111], v143 offset:10240
    v_cvt_pk_bf16_f32 v64, v64, v65
    s_waitcnt lgkmcnt(6)
    v_mfma_f32_16x16x32_bf16 v[48:51], v[132:135], v[104:107], v[48:51]
    v_cvt_pk_bf16_f32 v65, v66, v67
    v_cvt_pk_bf16_f32 v8, v8, v9
    v_mfma_f32_16x16x32_bf16 v[76:79], v[104:107], v[136:139], v[76:79]
    v_cvt_pk_bf16_f32 v9, v10, v11
    v_mfma_f32_16x16x32_bf16 v[20:23], v[128:131], v[104:107], v[20:23]
    s_waitcnt lgkmcnt(3)
    v_mfma_f32_16x16x32_bf16 v[40:43], v[132:135], v[96:99], v[40:43]
    v_mfma_f32_16x16x32_bf16 v[68:71], v[96:99], v[136:139], v[68:71]
    v_cvt_pk_bf16_f32 v38, v48, v49
    v_cvt_pk_bf16_f32 v39, v50, v51
    v_mfma_f32_16x16x32_bf16 v[12:15], v[128:131], v[96:99], v[12:15]
    ds_write_b128 v145, v[36:39] offset:4096
    v_cvt_pk_bf16_f32 v66, v76, v77
    s_waitcnt lgkmcnt(1)
    v_mfma_f32_16x16x32_bf16 v[52:55], v[132:135], v[108:111], v[52:55]
    v_cvt_pk_bf16_f32 v67, v78, v79
    ds_write_b128 v145, v[64:67] offset:7168
    v_mfma_f32_16x16x32_bf16 v[80:83], v[108:111], v[136:139], v[80:83]
    v_cvt_pk_bf16_f32 v10, v20, v21
    v_cvt_pk_bf16_f32 v11, v22, v23
    v_mfma_f32_16x16x32_bf16 v[24:27], v[128:131], v[108:111], v[24:27]
    ds_write_b128 v145, v[8:11] offset:0
    v_cvt_pk_bf16_f32 v40, v40, v41
    v_cvt_pk_bf16_f32 v41, v42, v43
    v_cvt_pk_bf16_f32 v68, v68, v69
    v_cvt_pk_bf16_f32 v69, v70, v71
    v_cvt_pk_bf16_f32 v12, v12, v13
    v_cvt_pk_bf16_f32 v13, v14, v15
    v_cvt_pk_bf16_f32 v42, v52, v53
    v_cvt_pk_bf16_f32 v43, v54, v55
    ds_write_b128 v145, v[40:43] offset:5120
    v_cvt_pk_bf16_f32 v70, v80, v81
    v_cvt_pk_bf16_f32 v71, v82, v83
    ds_write_b128 v145, v[68:71] offset:8192
    v_cvt_pk_bf16_f32 v14, v24, v25
    v_cvt_pk_bf16_f32 v15, v26, v27
    ds_write_b128 v145, v[12:15] offset:1024
    s_branch L_pb10b
L_lsend:
    s_xor_b32 s70, s70, s92
    s_xor_b32 s69, s69, s92
    s_add_u32 s71, s70, 4096
    s_add_u32 s72, s70, 16384

    s_waitcnt lgkmcnt(10)
    v_mfma_f32_16x16x32_bf16 v[32:35], v[120:123], v[88:91], v[32:35]
    ds_read_b64_tr_b16 v[132:133], v144 offset:16384
    s_waitcnt lgkmcnt(9)
    v_mfma_f32_16x16x32_bf16 v[60:63], v[88:91], v[124:127], v[60:63]
    ds_read_b128 v[88:91], v143 offset:0
    s_waitcnt lgkmcnt(5)
    v_mfma_f32_16x16x32_bf16 v[44:47], v[120:123], v[100:103], v[44:47]
    ds_read_b64_tr_b16 v[134:135], v144 offset:16896
    v_mfma_f32_16x16x32_bf16 v[72:75], v[100:103], v[124:127], v[72:75]
    ds_read_b64_tr_b16 v[136:137], v144 offset:20480
    v_mfma_f32_16x16x32_bf16 v[16:19], v[116:119], v[100:103], v[16:19]
    ds_read_b128 v[100:103], v143 offset:6144
    v_mfma_f32_16x16x32_bf16 v[36:39], v[120:123], v[92:95], v[36:39]
    ds_read_b64_tr_b16 v[138:139], v144 offset:20992
    v_mfma_f32_16x16x32_bf16 v[64:67], v[92:95], v[124:127], v[64:67]
    ds_read_b64_tr_b16 v[128:129], v144 offset:12288
    v_mfma_f32_16x16x32_bf16 v[8:11], v[116:119], v[92:95], v[8:11]
    ds_read_b128 v[92:95], v143 offset:2048
    s_waitcnt lgkmcnt(8)
    v_mfma_f32_16x16x32_bf16 v[56:59], v[120:123], v[112:115], v[56:59]
    ds_read_b64_tr_b16 v[130:131], v144 offset:12800
    v_mfma_f32_16x16x32_bf16 v[84:87], v[112:115], v[124:127], v[84:87]
    v_mfma_f32_16x16x32_bf16 v[28:31], v[116:119], v[112:115], v[28:31]
    ds_read_b128 v[112:115], v143 offset:12288
    s_waitcnt lgkmcnt(7)
    v_mfma_f32_16x16x32_bf16 v[32:35], v[132:135], v[88:91], v[32:35]
    s_waitcnt lgkmcnt(4)
    v_mfma_f32_16x16x32_bf16 v[60:63], v[88:91], v[136:139], v[60:63]
    v_mfma_f32_16x16x32_bf16 v[44:47], v[132:135], v[100:103], v[44:47]
    v_mfma_f32_16x16x32_bf16 v[72:75], v[100:103], v[136:139], v[72:75]
    s_waitcnt lgkmcnt(1)
    v_mfma_f32_16x16x32_bf16 v[16:19], v[128:131], v[100:103], v[16:19]
    s_nop 1
    v_cvt_pk_bf16_f32 v32, v32, v33
    v_cvt_pk_bf16_f32 v33, v34, v35
    v_mfma_f32_16x16x32_bf16 v[48:51], v[120:123], v[104:107], v[48:51]
    v_cvt_pk_bf16_f32 v60, v60, v61
    v_cvt_pk_bf16_f32 v61, v62, v63
    v_mfma_f32_16x16x32_bf16 v[76:79], v[104:107], v[124:127], v[76:79]
    v_cvt_pk_bf16_f32 v34, v44, v45
    v_cvt_pk_bf16_f32 v35, v46, v47
    v_mfma_f32_16x16x32_bf16 v[20:23], v[116:119], v[104:107], v[20:23]
    ds_read_b128 v[104:107], v143 offset:8192
    buffer_store_dwordx4 v[32:35], v7, s[44:47], s70 offen offset:3072 sc1
    s_waitcnt lgkmcnt(1)
    v_mfma_f32_16x16x32_bf16 v[56:59], v[132:135], v[112:115], v[56:59]
    ds_write_b128 v145, v[32:35] offset:3072
    v_cvt_pk_bf16_f32 v62, v72, v73
    v_mfma_f32_16x16x32_bf16 v[84:87], v[112:115], v[136:139], v[84:87]
    v_cvt_pk_bf16_f32 v63, v74, v75
    buffer_store_dwordx4 v[60:63], v7, s[44:47], s71 offen offset:2048 sc1
    v_mfma_f32_16x16x32_bf16 v[28:31], v[128:131], v[112:115], v[28:31]
    ds_write_b128 v145, v[60:63] offset:6144
    v_cvt_pk_bf16_f32 v16, v16, v17
    v_mfma_f32_16x16x32_bf16 v[40:43], v[120:123], v[96:99], v[40:43]
    v_cvt_pk_bf16_f32 v17, v18, v19
    v_mfma_f32_16x16x32_bf16 v[68:71], v[96:99], v[124:127], v[68:71]
    v_cvt_pk_bf16_f32 v56, v56, v57
    v_cvt_pk_bf16_f32 v57, v58, v59
    v_mfma_f32_16x16x32_bf16 v[12:15], v[116:119], v[96:99], v[12:15]
    ds_read_b128 v[96:99], v143 offset:4096
    v_cvt_pk_bf16_f32 v58, v84, v85
    v_mfma_f32_16x16x32_bf16 v[36:39], v[132:135], v[92:95], v[36:39]
    v_cvt_pk_bf16_f32 v59, v86, v87
    buffer_store_dwordx4 v[56:59], v7, s[44:47], s72 offen offset:1024 sc1
    v_mfma_f32_16x16x32_bf16 v[64:67], v[92:95], v[136:139], v[64:67]
    ds_write_b128 v145, v[56:59] offset:9216
    v_cvt_pk_bf16_f32 v18, v28, v29
    v_mfma_f32_16x16x32_bf16 v[8:11], v[128:131], v[92:95], v[8:11]
    v_cvt_pk_bf16_f32 v19, v30, v31
    buffer_store_dwordx4 v[16:19], v7, s[44:47], s70 offen offset:2048 sc1
    v_mfma_f32_16x16x32_bf16 v[52:55], v[120:123], v[108:111], v[52:55]
    ds_write_b128 v145, v[16:19] offset:2048
    v_mfma_f32_16x16x32_bf16 v[80:83], v[108:111], v[124:127], v[80:83]
    v_cvt_pk_bf16_f32 v36, v36, v37
    v_cvt_pk_bf16_f32 v37, v38, v39
    v_mfma_f32_16x16x32_bf16 v[24:27], v[116:119], v[108:111], v[24:27]
    ds_read_b128 v[108:111], v143 offset:10240
    v_cvt_pk_bf16_f32 v64, v64, v65
    s_waitcnt lgkmcnt(6)
    v_mfma_f32_16x16x32_bf16 v[48:51], v[132:135], v[104:107], v[48:51]
    v_cvt_pk_bf16_f32 v65, v66, v67
    v_cvt_pk_bf16_f32 v8, v8, v9
    v_mfma_f32_16x16x32_bf16 v[76:79], v[104:107], v[136:139], v[76:79]
    v_cvt_pk_bf16_f32 v9, v10, v11
    v_mfma_f32_16x16x32_bf16 v[20:23], v[128:131], v[104:107], v[20:23]
    s_waitcnt lgkmcnt(3)
    v_mfma_f32_16x16x32_bf16 v[40:43], v[132:135], v[96:99], v[40:43]
    v_mfma_f32_16x16x32_bf16 v[68:71], v[96:99], v[136:139], v[68:71]
    v_cvt_pk_bf16_f32 v38, v48, v49
    v_cvt_pk_bf16_f32 v39, v50, v51
    v_mfma_f32_16x16x32_bf16 v[12:15], v[128:131], v[96:99], v[12:15]
    buffer_store_dwordx4 v[36:39], v7, s[44:47], s71 offen offset:0 sc1
    ds_write_b128 v145, v[36:39] offset:4096
    s_waitcnt lgkmcnt(1)
    v_mfma_f32_16x16x32_bf16 v[52:55], v[132:135], v[108:111], v[52:55]
    v_cvt_pk_bf16_f32 v66, v76, v77
    v_cvt_pk_bf16_f32 v67, v78, v79
    v_mfma_f32_16x16x32_bf16 v[80:83], v[108:111], v[136:139], v[80:83]
    buffer_store_dwordx4 v[64:67], v7, s[44:47], s71 offen offset:3072 sc1
    ds_write_b128 v145, v[64:67] offset:7168
    v_mfma_f32_16x16x32_bf16 v[24:27], v[128:131], v[108:111], v[24:27]
    v_cvt_pk_bf16_f32 v10, v20, v21
    v_cvt_pk_bf16_f32 v11, v22, v23
    buffer_store_dwordx4 v[8:11], v7, s[44:47], s70 offen offset:0 sc1
    ds_write_b128 v145, v[8:11] offset:0
    v_cvt_pk_bf16_f32 v40, v40, v41
    v_cvt_pk_bf16_f32 v41, v42, v43
    v_cvt_pk_bf16_f32 v68, v68, v69
    v_cvt_pk_bf16_f32 v69, v70, v71
    v_cvt_pk_bf16_f32 v12, v12, v13
    v_cvt_pk_bf16_f32 v13, v14, v15
    v_cvt_pk_bf16_f32 v42, v52, v53
    v_cvt_pk_bf16_f32 v43, v54, v55
    buffer_store_dwordx4 v[40:43], v7, s[44:47], s71 offen offset:1024 sc1
    ds_write_b128 v145, v[40:43] offset:5120
    v_cvt_pk_bf16_f32 v70, v80, v81
    v_cvt_pk_bf16_f32 v71, v82, v83
    buffer_store_dwordx4 v[68:71], v7, s[44:47], s72 offen offset:0 sc1
    ds_write_b128 v145, v[68:71] offset:8192
    v_cvt_pk_bf16_f32 v14, v24, v25
    v_cvt_pk_bf16_f32 v15, v26, v27
    buffer_store_dwordx4 v[12:15], v7, s[44:47], s70 offen offset:1024 sc1
    ds_write_b128 v145, v[12:15] offset:1024
    s_branch L_pb10b
L_pb10:
    s_mov_b32 s44, s28
    s_and_b32 s45, s29, 0xffff
    s_mov_b32 s46, 16777216
    s_mov_b32 s47, 0x00020000
    s_mul_i32 s31, s31, 1664525
    s_add_u32 s31, s31, 1013904223
    s_mov_b32 s100, 0
Lpo_70:
    s_waitcnt lgkmcnt(0)
    s_cmp_eq_u32 s86, s31
    s_cbranch_scc1 Lpd_71
    s_sleep 16
    s_load_dwordx2 s[86:87], s[28:29], s92 offset:8192 glc
    s_add_u32 s100, s100, 1
    s_cmp_lt_u32 s100, 1048576
    s_cbranch_scc1 Lpo_70
    s_waitcnt lgkmcnt(0)
Lpd_71:
    s_and_b32 s92, s87, 0x2000
    s_setprio 2
L_pb10b:
    v_mov_b32 v165, s31
    s_xor_b32 s68, s68, s92
L_upre:
    v_xor_b32 v164, s92, v164
    v_add_u32 v132, s64, v158
    v_add_u32 v133, s65, v160
    v_add_u32 v134, s65, v161
    s_cmp_eq_u32 s101, 2
    s_cbranch_scc1 L_unit
    v_add_f32 v136, s67, v150
    v_add_f32 v137, s67, v151
    v_add_f32 v138, s67, v152
    v_add_f32 v139, s67, v153
    s_waitcnt lgkmcnt(0)
    s_barrier
L_unit:
    s_cmp_eq_u32 s62, 0
    s_cbranch_scc1 L_ugo
    s_mov_b32 s100, 0
Lw_72:
    ds_read_b32 v4, v3 offset:8
    s_waitcnt lgkmcnt(0)
    v_readfirstlane_b32 s99, v4
    s_cmp_ge_u32 s99, 1
    s_cbranch_scc1 Lwd_73
    s_sleep 1
    s_add_u32 s100, s100, 1
    s_cmp_lt_u32 s100, 8388608
    s_cbranch_scc1 Lw_72
Lwd_73:
    s_setprio 3
L_ugo:
    ds_read_b64 v[104:105], v158 offset:0
    ds_read_b64 v[106:107], v158 offset:10240
    ds_read_b64 v[88:89], v158 offset:3072
    ds_read_b64 v[90:91], v158 offset:13312
    ds_read_b64 v[92:93], v158 offset:4096
    ds_read_b64 v[94:95], v158 offset:14336
    ds_read_b64 v[108:109], v158 offset:1024
    ds_read_b64 v[110:111], v158 offset:11264
    ds_read_b64 v[96:97], v158 offset:5120
    ds_read_b64 v[98:99], v158 offset:15360
    ds_read_b64 v[112:113], v158 offset:2048
    ds_read_b64 v[114:115], v158 offset:12288
    ds_read_b64 v[100:101], v132 offset:0
    ds_read_b64 v[102:103], v132 offset:10240
    s_waitcnt lgkmcnt(12)
    v_and_b32 v106, v106, v159
    v_and_b32 v107, v107, v159
    s_waitcnt lgkmcnt(8)
    s_nop 0
    v_mfma_f32_16x16x32_bf16 v[20:23], v[88:91], v[104:107], v[136:139]
    v_mfma_f32_16x16x32_bf16 v[8:11], v[92:95], v[104:107], v[146:149]
    s_waitcnt lgkmcnt(6)
    v_and_b32 v110, v110, v159
    v_and_b32 v111, v111, v159
    s_waitcnt lgkmcnt(4)
    s_nop 0
    v_mfma_f32_16x16x32_bf16 v[24:27], v[92:95], v[108:111], v[150:153]
    v_mfma_f32_16x16x32_bf16 v[12:15], v[96:99], v[108:111], v[146:149]
    s_waitcnt lgkmcnt(2)
    v_and_b32 v114, v114, v159
    v_and_b32 v115, v115, v159
    s_waitcnt lgkmcnt(0)
    s_nop 0
    v_mfma_f32_16x16x32_bf16 v[28:31], v[96:99], v[112:115], v[150:153]
    v_mfma_f32_16x16x32_bf16 v[16:19], v[100:103], v[112:115], v[146:149]
    ds_read_b64 v[120:121], v160 offset:7168
    ds_read_b64 v[122:123], v160 offset:6144
    ds_read_b64 v[118:119], v160 offset:8192
    ds_read_b64 v[116:117], v133 offset:0
    ds_read_b64 v[128:129], v161 offset:7168
    ds_read_b64 v[130:131], v161 offset:6144
    ds_read_b64 v[126:127], v161 offset:8192
    ds_read_b64 v[124:125], v134 offset:0
    v_max3_f32 v32, v20, v21, v8
    v_max3_f32 v36, v22, v23, v10
    v_max_f32 v32, v32, v9
    v_max_f32 v36, v36, v11
    v_max_f32 v40, v32, v36
    v_max3_f32 v33, v24, v25, v12
    v_max3_f32 v37, v26, v27, v14
    v_max_f32 v33, v33, v13
    v_max_f32 v37, v37, v15
    v_max_f32 v41, v33, v37
    v_max3_f32 v34, v28, v29, v16
    v_max3_f32 v38, v30, v31, v18
    v_max_f32 v34, v34, v17
    v_max_f32 v38, v38, v19
    v_permlane32_swap_b32 v40, v41
    v_max_f32 v42, v34, v38
    v_max_f32 v40, v40, v41
    s_add_u32 s96, s68, 32768
    v_permlane32_swap_b32 v42, v43
    v_max_f32 v42, v42, v43
    s_nop 1
    v_permlane16_swap_b32 v40, v42
    v_max_f32 v40, v40, v42
    v_mul_f32 v42, s66, v40
    v_mul_f32 v40, s66, v40
    s_nop 1
    v_permlane16_swap_b32 v40, v42
    v_mov_b32 v41, v40
    v_mov_b32 v43, v42
    s_waitcnt lgkmcnt(0)
    v_permlane32_swap_b32 v40, v41
    v_permlane32_swap_b32 v42, v43
    s_cmp_eq_u32 s69, 0
    s_cbranch_scc1 Lxs_74
    s_waitcnt vmcnt(0)
    s_atomic_swap s31, s[28:29], s69
Lxs_74:
    v_fma_f32 v32, v32, s66, -v40
    v_fma_f32 v36, v36, s66, -v40
    v_fma_f32 v33, v33, s66, -v41
    v_fma_f32 v37, v37, s66, -v41
    v_fma_f32 v34, v34, s66, -v42
    v_fma_f32 v38, v38, s66, -v42
    v_exp_f32 v32, v32
    v_exp_f32 v36, v36
    v_exp_f32 v33, v33
    v_exp_f32 v37, v37
    v_exp_f32 v34, v34
    v_exp_f32 v38, v38
    v_add_f32 v40, v32, v36
    v_add_f32 v41, v33, v37
    v_add_f32 v42, v34, v38
    s_nop 0
    v_permlane32_swap_b32 v40, v41
    v_permlane32_swap_b32 v42, v43
    v_add_f32 v40, v40, v41
    v_add_f32 v42, v42, v43
    s_nop 1
    v_permlane16_swap_b32 v40, v42
    v_add_f32 v40, v40, v42
    v_rcp_f32 v42, v40
    v_rcp_f32 v40, v40
    s_nop 1
    v_permlane16_swap_b32 v40, v42
    v_mov_b32 v41, v40
    v_mov_b32 v43, v42
    s_nop 0
    v_permlane32_swap_b32 v40, v41
    v_permlane32_swap_b32 v42, v43
    v_mul_f32 v32, v32, v40
    v_mul_f32 v36, v36, v40
    v_cvt_pk_bf16_f32 v32, v32, v36
    v_perm_b32 v44, v32, v32, v154
    v_perm_b32 v45, v32, v32, v155
    v_perm_b32 v46, v32, v32, v156
    v_perm_b32 v47, v32, v32, v157
    v_mul_f32 v33, v33, v41
    v_mul_f32 v37, v37, v41
    v_cvt_pk_bf16_f32 v33, v33, v37
    v_perm_b32 v48, v33, v33, v154
    v_perm_b32 v49, v33, v33, v155
    v_perm_b32 v50, v33, v33, v156
    v_perm_b32 v51, v33, v33, v157
    v_mfma_f32_16x16x32_bf16 v[8:11], v[120:123], v[44:47], 0
    v_mfma_f32_16x16x32_bf16 v[20:23], v[128:131], v[44:47], 0
    v_mul_f32 v34, v34, v42
    v_mul_f32 v38, v38, v42
    v_cvt_pk_bf16_f32 v34, v34, v38
    v_perm_b32 v52, v34, v34, v154
    v_perm_b32 v53, v34, v34, v155
    v_perm_b32 v54, v34, v34, v156
    v_perm_b32 v55, v34, v34, v157
    v_mfma_f32_16x16x32_bf16 v[12:15], v[118:121], v[48:51], 0
    v_mfma_f32_16x16x32_bf16 v[24:27], v[126:129], v[48:51], 0
    v_mfma_f32_16x16x32_bf16 v[16:19], v[116:119], v[52:55], 0
    v_mfma_f32_16x16x32_bf16 v[28:31], v[124:127], v[52:55], 0
    v_cvt_pk_bf16_f32 v60, v8, v9
    v_cvt_pk_bf16_f32 v61, v10, v11
    v_cvt_pk_bf16_f32 v68, v20, v21
    v_cvt_pk_bf16_f32 v69, v22, v23
    s_nop 0
    v_cvt_pk_bf16_f32 v62, v12, v13
    v_cvt_pk_bf16_f32 v63, v14, v15
    s_nop 0
    v_permlane32_swap_b32 v60, v62
    v_permlane32_swap_b32 v61, v63
    buffer_store_dwordx4 v[60:63], v162, s[44:47], s68 offen sc1
    v_cvt_pk_bf16_f32 v64, v16, v17
    v_cvt_pk_bf16_f32 v65, v18, v19
    s_nop 0
    v_permlane32_swap_b32 v64, v66
    v_permlane32_swap_b32 v65, v67
    s_mov_b32 exec_lo, 0
    v_cvt_pk_bf16_f32 v68, v28, v29
    v_cvt_pk_bf16_f32 v69, v30, v31
    s_mov_b64 exec, 0xffff0000
    v_cvt_pk_bf16_f32 v68, v24, v25
    v_cvt_pk_bf16_f32 v69, v26, v27
    s_mov_b32 exec_lo, -1
    buffer_store_dwordx4 v[64:67], v162, s[44:47], s96 offen sc1
    s_mov_b32 exec_hi, 0xffff
    buffer_store_dwordx2 v[68:69], v163, s[44:47], s68 offen sc1
    s_mov_b64 exec, -1
    s_cmp_lg_u32 s101, 0
    s_cbranch_scc1 L_nops
    s_lshr_b32 s75, s60, 1
    s_lshl_b32 s96, s75, 16
    s_add_u32 s72, s68, s96
    s_add_u32 s73, s72, 16384
    s_add_u32 s74, s72, 32768
    s_add_u32 s83, s72, 49152
    s_add_u32 s87, s72, 53248
    s_mul_i32 s96, s32, 164096
    s_cmp_ge_u32 s32, 11
    s_cselect_b32 s100, 1796864, 0
    s_sub_u32 s96, s96, s100
    s_mul_i32 s100, s33, 16640
    s_add_u32 s96, s96, s100
    s_add_u32 s96, s96, 263168
    s_xor_b32 s96, s96, s92
    s_lshl_b32 s97, s60, 8
    s_add_u32 s96, s96, s97
    s_add_u32 s76, s28, s96
    s_addc_u32 s77, s29, 0
    s_mul_i32 s80, s60, 6144
    s_add_u32 s80, s80, 81920
    s_xor_b32 s96, s60, 2
    s_mul_i32 s81, s96, 6144
    s_add_u32 s81, s81, 81920
    s_mul_i32 s82, s61, 12288
    s_lshl_b32 s96, s75, 11
    s_add_u32 s82, s82, s96
    s_add_u32 s82, s82, 133632
    s_lshl1_add_u32 s96, s32, s61
    s_mul_i32 s79, s96, 61440
    s_lshl1_add_u32 s96, s33, s75
    s_lshl_b32 s96, s96, 6
    s_add_u32 s79, s79, s96
    s_mov_b32 s48, s24
    s_and_b32 s49, s25, 0xffff
    s_mov_b32 s50, 2621440
    s_mov_b32 s51, 0x00020000
    v_lshrrev_b32 v58, 2, v0
    v_and_b32 v59, 3, v0
    v_bfe_u32 v57, v0, 3, 2
    v_lshlrev_b32 v7, 3, v0
    s_mul_i32 s96, s75, 40960
    v_lshl_add_u32 v5, v58, 7, s96
    v_lshl_add_u32 v5, v59, 3, v5
    s_lshl_b32 s96, s75, 1
    v_xor_b32 v6, s96, v57
    v_lshl_add_u32 v160, v6, 5, v5
    v_xor_b32 v161, 32, v160
    v_xor_b32 v162, 64, v160
    v_xor_b32 v163, 96, v160
    v_lshlrev_b32 v5, 4, v0
    v_add_u32 v6, 4096, v5
    v_xor_b32 v59, v59, v57
    v_mul_u32_u24 v58, 1280, v58
    v_lshl_add_u32 v58, v59, 4, v58
    s_mul_i32 s96, s61, 192
    s_add_u32 s96, s96, 161088
    v_lshl_add_u32 v57, v1, 2, s96
    v_bfe_u32 v59, v1, 1, 2
    v_lshl_add_u32 v1, v1, 6, s81
    v_lshlrev_b32 v59, 1, v59
    v_xor_b32 v59, v59, v2
    v_lshl_add_u32 v1, v59, 3, v1
    v_mov_b32 v2, v58
L_nops:
    s_lshl_b32 s96, s62, 4
    v_add_u32 v56, s96, v3
    v_mov_b32 v4, 1
    s_mov_b64 exec, 1
    ds_add_u32 v56, v4 offset:0
    s_mov_b64 exec, -1
    s_cmp_lg_u32 s101, 0
    s_cbranch_scc1 L_lsig
    s_lshl_b32 s96, s61, 3
    v_add_u32 v56, s96, v3
    s_waitcnt vmcnt(0)
    v_mov_b32 v4, 1
    s_mov_b64 exec, 1
    ds_add_rtn_u32 v4, v56, v4 offset:24
    s_waitcnt lgkmcnt(0)
    v_readfirstlane_b32 s97, v4
    s_mov_b64 exec, -1
    s_cmp_lg_u32 s97, 1
    s_cbranch_scc1 L_nosig
L_lsig:
    s_waitcnt vmcnt(0)
    s_mov_b64 exec, 0x3ff
    global_atomic_swap v164, v165, s[28:29] sc1
    s_mov_b64 exec, -1
L_nosig:
    s_cmp_eq_u32 s101, 0
    s_cbranch_scc1 L_op
    s_lshr_b32 s97, s34, 2
    s_andn2_b32 s96, s97, s62
    s_cbranch_scc0 L_pexit
    s_mov_b32 s62, 1
    s_mov_b32 s101, 2
    s_branch L_us
L_op:
    s_setprio 0
    s_lshl_b32 s85, s34, 10
    s_mov_b32 s100, 0
    v_mov_b32 v116, v57
    s_lshl_b32 s96, s60, 2
    v_add_u32 v164, s96, v3
    s_load_dwordx16 s[4:19], s[76:77], 0 glc
    s_mov_b32 s100, 0
Lw_75:
    ds_read_b32 v4, v3 offset:4
    s_waitcnt lgkmcnt(0)
    v_readfirstlane_b32 s99, v4
    s_cmp_ge_u32 s99, 2
    s_cbranch_scc1 Lwd_76
    s_add_u32 s100, s100, 1
    s_cmp_lt_u32 s100, 8388608
    s_cbranch_scc1 Lw_75
Lwd_76:
    s_mov_b32 s100, 0
    ds_read_b64_tr_b16 v[140:141], v160 offset:0
    ds_read_b64_tr_b16 v[142:143], v160 offset:2048
    ds_read_b64_tr_b16 v[144:145], v161 offset:0
    ds_read_b64_tr_b16 v[146:147], v161 offset:2048
    ds_read_b64_tr_b16 v[148:149], v162 offset:0
    ds_read_b64_tr_b16 v[150:151], v162 offset:2048
    ds_read_b64_tr_b16 v[152:153], v163 offset:0
    ds_read_b64_tr_b16 v[154:155], v163 offset:2048
    ds_read_b64_tr_b16 v[156:157], v160 offset:4096
    ds_read_b64_tr_b16 v[158:159], v160 offset:6144
L_nb0:
    s_cmp_lg_u32 s4, s31
    s_cbranch_scc1 L_ns0
L_ng0:
    s_add_u32 s96, s72, s85
    buffer_load_dwordx4 v[56:59], v5, s[44:47], s96 offen sc1
    s_add_u32 s96, s73, s85
    buffer_load_dwordx4 v[60:63], v5, s[44:47], s96 offen sc1
    s_add_u32 s96, s74, s85
    buffer_load_dwordx4 v[64:67], v5, s[44:47], s96 offen sc1
    s_add_u32 s85, s85, 1024
    s_cmp_eq_u32 s85, 5120
    s_cselect_b32 s85, 0, s85
L_nb1:
    s_cmp_lg_u32 s6, s31
    s_cbranch_scc1 L_ns1
L_ng1:
    s_add_u32 s96, s72, s85
    buffer_load_dwordx4 v[68:71], v5, s[44:47], s96 offen sc1
    s_add_u32 s96, s73, s85
    buffer_load_dwordx4 v[72:75], v5, s[44:47], s96 offen sc1
    s_add_u32 s96, s74, s85
    buffer_load_dwordx4 v[76:79], v5, s[44:47], s96 offen sc1
    s_add_u32 s85, s85, 1024
    s_cmp_eq_u32 s85, 5120
    s_cselect_b32 s85, 0, s85
L_nb2:
    s_cmp_lg_u32 s8, s31
    s_cbranch_scc1 L_ns2
L_ng2:
    s_add_u32 s96, s72, s85
    buffer_load_dwordx4 v[80:83], v5, s[44:47], s96 offen sc1
    s_add_u32 s96, s73, s85
    buffer_load_dwordx4 v[84:87], v5, s[44:47], s96 offen sc1
    s_add_u32 s96, s74, s85
    buffer_load_dwordx4 v[88:91], v5, s[44:47], s96 offen sc1
    s_add_u32 s85, s85, 1024
    s_cmp_eq_u32 s85, 5120
    s_cselect_b32 s85, 0, s85
L_nb3:
    s_cmp_lg_u32 s10, s31
    s_cbranch_scc1 L_ns3
L_ng3:
    s_add_u32 s96, s72, s85
    buffer_load_dwordx4 v[92:95], v5, s[44:47], s96 offen sc1
    s_add_u32 s96, s73, s85
    buffer_load_dwordx4 v[96:99], v5, s[44:47], s96 offen sc1
    s_add_u32 s96, s74, s85
    buffer_load_dwordx4 v[100:103], v5, s[44:47], s96 offen sc1
    s_add_u32 s85, s85, 1024
    s_cmp_eq_u32 s85, 5120
    s_cselect_b32 s85, 0, s85
L_nb4:
    s_cmp_lg_u32 s12, s31
    s_cbranch_scc1 L_ns4
L_ng4:
    s_add_u32 s96, s72, s85
    buffer_load_dwordx4 v[104:107], v5, s[44:47], s96 offen sc1
    s_add_u32 s96, s73, s85
    buffer_load_dwordx4 v[108:111], v5, s[44:47], s96 offen sc1
    s_add_u32 s96, s74, s85
    buffer_load_dwordx4 v[112:115], v5, s[44:47], s96 offen sc1

    s_waitcnt vmcnt(14)
    s_waitcnt lgkmcnt(8)
    v_mfma_f32_16x16x32_bf16 v[8:11], v[140:143], v[56:59], 0
    s_waitcnt vmcnt(13)
    v_mfma_f32_16x16x32_bf16 v[24:27], v[140:143], v[60:63], 0
    s_waitcnt vmcnt(12)
    v_mfma_f32_16x16x32_bf16 v[40:43], v[140:143], v[64:67], 0
    s_waitcnt lgkmcnt(6)
    v_mfma_f32_16x16x32_bf16 v[12:15], v[144:147], v[56:59], 0
    ds_read_b64_tr_b16 v[140:141], v161 offset:4096
    v_mfma_f32_16x16x32_bf16 v[28:31], v[144:147], v[60:63], 0
    ds_read_b64_tr_b16 v[142:143], v161 offset:6144
    v_mfma_f32_16x16x32_bf16 v[44:47], v[144:147], v[64:67], 0
    s_waitcnt lgkmcnt(6)
    v_mfma_f32_16x16x32_bf16 v[16:19], v[148:151], v[56:59], 0
    ds_read_b64_tr_b16 v[144:145], v162 offset:4096
    v_mfma_f32_16x16x32_bf16 v[32:35], v[148:151], v[60:63], 0
    ds_read_b64_tr_b16 v[146:147], v162 offset:6144
    v_mfma_f32_16x16x32_bf16 v[48:51], v[148:151], v[64:67], 0
    s_waitcnt lgkmcnt(6)
    v_mfma_f32_16x16x32_bf16 v[20:23], v[152:155], v[56:59], 0
    ds_read_b64_tr_b16 v[148:149], v163 offset:4096
    v_mfma_f32_16x16x32_bf16 v[36:39], v[152:155], v[60:63], 0
    ds_read_b64_tr_b16 v[150:151], v163 offset:6144
    v_mfma_f32_16x16x32_bf16 v[52:55], v[152:155], v[64:67], 0
    s_waitcnt vmcnt(11)
    s_waitcnt lgkmcnt(6)
    v_mfma_f32_16x16x32_bf16 v[8:11], v[156:159], v[68:71], v[8:11]
    ds_read_b64_tr_b16 v[152:153], v160 offset:8192
    buffer_load_dwordx2 v[56:57], v7, s[44:47], s83 offen offset:0 sc1
    s_waitcnt vmcnt(11)
    v_mfma_f32_16x16x32_bf16 v[24:27], v[156:159], v[72:75], v[24:27]
    ds_read_b64_tr_b16 v[154:155], v160 offset:10240
    buffer_load_dwordx2 v[58:59], v7, s[44:47], s83 offen offset:512 sc1
    s_waitcnt vmcnt(11)
    v_mfma_f32_16x16x32_bf16 v[40:43], v[156:159], v[76:79], v[40:43]
    buffer_load_dwordx2 v[60:61], v7, s[44:47], s83 offen offset:2048 sc1
    s_waitcnt lgkmcnt(6)
    v_mfma_f32_16x16x32_bf16 v[12:15], v[140:143], v[68:71], v[12:15]
    ds_read_b64_tr_b16 v[156:157], v161 offset:8192
    v_mfma_f32_16x16x32_bf16 v[28:31], v[140:143], v[72:75], v[28:31]
    ds_read_b64_tr_b16 v[158:159], v161 offset:10240
    v_mfma_f32_16x16x32_bf16 v[44:47], v[140:143], v[76:79], v[44:47]
    buffer_load_dwordx2 v[62:63], v7, s[44:47], s83 offen offset:2560 sc1
    s_waitcnt lgkmcnt(6)
    v_mfma_f32_16x16x32_bf16 v[16:19], v[144:147], v[68:71], v[16:19]
    ds_read_b64_tr_b16 v[140:141], v162 offset:8192
    v_mfma_f32_16x16x32_bf16 v[32:35], v[144:147], v[72:75], v[32:35]
    ds_read_b64_tr_b16 v[142:143], v162 offset:10240
    v_mfma_f32_16x16x32_bf16 v[48:51], v[144:147], v[76:79], v[48:51]
    buffer_load_dwordx2 v[64:65], v7, s[44:47], s87 offen offset:0 sc1
    s_waitcnt lgkmcnt(6)
    v_mfma_f32_16x16x32_bf16 v[20:23], v[148:151], v[68:71], v[20:23]
    ds_read_b64_tr_b16 v[144:145], v163 offset:8192
    v_mfma_f32_16x16x32_bf16 v[36:39], v[148:151], v[72:75], v[36:39]
    ds_read_b64_tr_b16 v[146:147], v163 offset:10240
    v_mfma_f32_16x16x32_bf16 v[52:55], v[148:151], v[76:79], v[52:55]
    buffer_load_dwordx2 v[66:67], v7, s[44:47], s87 offen offset:512 sc1
L_nb6:
    s_cmp_lg_u32 s14, s31
    s_cbranch_scc1 L_ns6
    s_cmp_lg_u32 s16, s31
    s_cbranch_scc1 L_ns6
L_ng6:
    s_waitcnt vmcnt(14)
    s_waitcnt lgkmcnt(6)
    v_mfma_f32_16x16x32_bf16 v[8:11], v[152:155], v[80:83], v[8:11]
    ds_read_b64_tr_b16 v[148:149], v160 offset:12288
    s_waitcnt vmcnt(13)
    v_mfma_f32_16x16x32_bf16 v[24:27], v[152:155], v[84:87], v[24:27]
    ds_read_b64_tr_b16 v[150:151], v160 offset:14336
    s_waitcnt vmcnt(12)
    v_mfma_f32_16x16x32_bf16 v[40:43], v[152:155], v[88:91], v[40:43]
    buffer_load_dwordx4 v[68:71], v6, s[44:47], s72 offen offset:1024 sc1
    s_waitcnt lgkmcnt(6)
    v_mfma_f32_16x16x32_bf16 v[12:15], v[156:159], v[80:83], v[12:15]
    ds_read_b64_tr_b16 v[152:153], v161 offset:12288
    v_mfma_f32_16x16x32_bf16 v[28:31], v[156:159], v[84:87], v[28:31]
    ds_read_b64_tr_b16 v[154:155], v161 offset:14336
    v_mfma_f32_16x16x32_bf16 v[44:47], v[156:159], v[88:91], v[44:47]
    buffer_load_dwordx4 v[72:75], v6, s[44:47], s73 offen offset:1024 sc1
    s_waitcnt lgkmcnt(6)
    v_mfma_f32_16x16x32_bf16 v[16:19], v[140:143], v[80:83], v[16:19]
    ds_read_b64_tr_b16 v[156:157], v162 offset:12288
    v_mfma_f32_16x16x32_bf16 v[32:35], v[140:143], v[84:87], v[32:35]
    ds_read_b64_tr_b16 v[158:159], v162 offset:14336
    v_mfma_f32_16x16x32_bf16 v[48:51], v[140:143], v[88:91], v[48:51]
    buffer_load_dwordx4 v[76:79], v6, s[44:47], s74 offen offset:1024 sc1
    s_waitcnt lgkmcnt(6)
    v_mfma_f32_16x16x32_bf16 v[20:23], v[144:147], v[80:83], v[20:23]
    ds_read_b64_tr_b16 v[140:141], v163 offset:12288
    v_mfma_f32_16x16x32_bf16 v[36:39], v[144:147], v[84:87], v[36:39]
    ds_read_b64_tr_b16 v[142:143], v163 offset:14336
    v_mfma_f32_16x16x32_bf16 v[52:55], v[144:147], v[88:91], v[52:55]
    s_waitcnt vmcnt(14)
    s_waitcnt lgkmcnt(6)
    v_mfma_f32_16x16x32_bf16 v[8:11], v[148:151], v[92:95], v[8:11]
    ds_read_b64_tr_b16 v[144:145], v160 offset:16384
    s_waitcnt vmcnt(13)
    v_mfma_f32_16x16x32_bf16 v[24:27], v[148:151], v[96:99], v[24:27]
    ds_read_b64_tr_b16 v[146:147], v160 offset:18432
    s_waitcnt vmcnt(12)
    v_mfma_f32_16x16x32_bf16 v[40:43], v[148:151], v[100:103], v[40:43]
    s_waitcnt lgkmcnt(6)
    v_mfma_f32_16x16x32_bf16 v[12:15], v[152:155], v[92:95], v[12:15]
    ds_read_b64_tr_b16 v[148:149], v161 offset:16384
    v_mfma_f32_16x16x32_bf16 v[28:31], v[152:155], v[96:99], v[28:31]
    ds_read_b64_tr_b16 v[150:151], v161 offset:18432
    v_mfma_f32_16x16x32_bf16 v[44:47], v[152:155], v[100:103], v[44:47]
    s_waitcnt lgkmcnt(6)
    v_mfma_f32_16x16x32_bf16 v[16:19], v[156:159], v[92:95], v[16:19]
    ds_read_b64_tr_b16 v[152:153], v162 offset:16384
    v_mfma_f32_16x16x32_bf16 v[32:35], v[156:159], v[96:99], v[32:35]
    ds_read_b64_tr_b16 v[154:155], v162 offset:18432
    v_mfma_f32_16x16x32_bf16 v[48:51], v[156:159], v[100:103], v[48:51]
    s_waitcnt lgkmcnt(6)
    v_mfma_f32_16x16x32_bf16 v[20:23], v[140:143], v[92:95], v[20:23]
    ds_read_b64_tr_b16 v[156:157], v163 offset:16384
    v_mfma_f32_16x16x32_bf16 v[36:39], v[140:143], v[96:99], v[36:39]
    ds_read_b64_tr_b16 v[158:159], v163 offset:18432
    v_mfma_f32_16x16x32_bf16 v[52:55], v[140:143], v[100:103], v[52:55]
    s_waitcnt vmcnt(11)
    s_waitcnt lgkmcnt(6)
    v_mfma_f32_16x16x32_bf16 v[8:11], v[144:147], v[104:107], v[8:11]
    ds_read_b64_tr_b16 v[140:141], v160 offset:20480
    s_waitcnt vmcnt(10)
    v_mfma_f32_16x16x32_bf16 v[24:27], v[144:147], v[108:111], v[24:27]
    ds_read_b64_tr_b16 v[142:143], v160 offset:22528
    s_waitcnt vmcnt(9)
    v_mfma_f32_16x16x32_bf16 v[40:43], v[144:147], v[112:115], v[40:43]
    s_waitcnt lgkmcnt(6)
    v_mfma_f32_16x16x32_bf16 v[12:15], v[148:151], v[104:107], v[12:15]
    ds_read_b64_tr_b16 v[144:145], v161 offset:20480
    v_mfma_f32_16x16x32_bf16 v[28:31], v[148:151], v[108:111], v[28:31]
    ds_read_b64_tr_b16 v[146:147], v161 offset:22528
    v_mfma_f32_16x16x32_bf16 v[44:47], v[148:151], v[112:115], v[44:47]
    s_waitcnt lgkmcnt(6)
    v_mfma_f32_16x16x32_bf16 v[16:19], v[152:155], v[104:107], v[16:19]
    ds_read_b64_tr_b16 v[148:149], v162 offset:20480
    v_mfma_f32_16x16x32_bf16 v[32:35], v[152:155], v[108:111], v[32:35]
    ds_read_b64_tr_b16 v[150:151], v162 offset:22528
    v_mfma_f32_16x16x32_bf16 v[48:51], v[152:155], v[112:115], v[48:51]
    ds_read_b32 v122, v164 offset:80
    s_waitcnt lgkmcnt(7)
    v_mfma_f32_16x16x32_bf16 v[20:23], v[156:159], v[104:107], v[20:23]
    ds_read_b64_tr_b16 v[152:153], v163 offset:20480
    v_mfma_f32_16x16x32_bf16 v[36:39], v[156:159], v[108:111], v[36:39]
    ds_read_b64_tr_b16 v[154:155], v163 offset:22528
    v_mfma_f32_16x16x32_bf16 v[52:55], v[156:159], v[112:115], v[52:55]
    s_waitcnt lgkmcnt(2)
    v_readfirstlane_b32 s97, v122
    s_cmp_eq_u32 s97, 0
    s_cbranch_scc1 L_lts
L_ltg:
    buffer_load_dwordx4 v[80:83], v6, s[44:47], s72 offen offset:2048 sc1
    buffer_load_dwordx4 v[84:87], v6, s[44:47], s73 offen offset:2048 sc1
    buffer_load_dwordx4 v[88:91], v6, s[44:47], s74 offen offset:2048 sc1
    s_waitcnt vmcnt(10)
    v_mfma_f32_16x16x32_bf16 v[8:11], v[140:143], v[56:59], v[8:11]
    ds_read_b64_tr_b16 v[156:157], v160 offset:24576
    buffer_load_dwordx4 v[92:95], v6, s[44:47], s72 offen offset:3072 sc1
    s_waitcnt vmcnt(9)
    v_mfma_f32_16x16x32_bf16 v[24:27], v[140:143], v[60:63], v[24:27]
    ds_read_b64_tr_b16 v[158:159], v160 offset:26624
    buffer_load_dwordx4 v[96:99], v6, s[44:47], s73 offen offset:3072 sc1
    s_waitcnt vmcnt(8)
    v_mfma_f32_16x16x32_bf16 v[40:43], v[140:143], v[64:67], v[40:43]
    buffer_load_dwordx4 v[100:103], v6, s[44:47], s74 offen offset:3072 sc1
    v_mfma_f32_16x16x32_bf16 v[12:15], v[144:147], v[56:59], v[12:15]
    ds_read_b64_tr_b16 v[140:141], v161 offset:24576
    buffer_load_dwordx2 v[104:105], v7, s[44:47], s83 offen offset:1024 sc1
    v_mfma_f32_16x16x32_bf16 v[28:31], v[144:147], v[60:63], v[28:31]
    ds_read_b64_tr_b16 v[142:143], v161 offset:26624
    buffer_load_dwordx2 v[106:107], v7, s[44:47], s83 offen offset:1536 sc1
    v_mfma_f32_16x16x32_bf16 v[44:47], v[144:147], v[64:67], v[44:47]
    buffer_load_dwordx2 v[108:109], v7, s[44:47], s83 offen offset:3072 sc1
    v_mfma_f32_16x16x32_bf16 v[16:19], v[148:151], v[56:59], v[16:19]
    ds_read_b64_tr_b16 v[144:145], v162 offset:24576
    buffer_load_dwordx2 v[110:111], v7, s[44:47], s83 offen offset:3584 sc1
    v_mfma_f32_16x16x32_bf16 v[32:35], v[148:151], v[60:63], v[32:35]
    ds_read_b64_tr_b16 v[146:147], v162 offset:26624
    v_mfma_f32_16x16x32_bf16 v[48:51], v[148:151], v[64:67], v[48:51]
    buffer_load_dwordx2 v[112:113], v7, s[44:47], s87 offen offset:1024 sc1
    s_waitcnt lgkmcnt(6)
    v_mfma_f32_16x16x32_bf16 v[20:23], v[152:155], v[56:59], v[20:23]
    ds_read_b64_tr_b16 v[148:149], v163 offset:24576
    v_mfma_f32_16x16x32_bf16 v[36:39], v[152:155], v[60:63], v[36:39]
    ds_read_b64_tr_b16 v[150:151], v163 offset:26624
    v_mfma_f32_16x16x32_bf16 v[52:55], v[152:155], v[64:67], v[52:55]
    buffer_load_dwordx2 v[114:115], v7, s[44:47], s87 offen offset:1536 sc1
    s_waitcnt vmcnt(14)
    s_waitcnt lgkmcnt(6)
    v_mfma_f32_16x16x32_bf16 v[8:11], v[156:159], v[68:71], v[8:11]
    ds_read_b64_tr_b16 v[152:153], v162 offset:28672
    s_waitcnt vmcnt(13)
    v_mfma_f32_16x16x32_bf16 v[24:27], v[156:159], v[72:75], v[24:27]
    ds_read_b64_tr_b16 v[154:155], v162 offset:30720
    s_waitcnt vmcnt(12)
    v_mfma_f32_16x16x32_bf16 v[40:43], v[156:159], v[76:79], v[40:43]
    s_waitcnt lgkmcnt(6)
    v_mfma_f32_16x16x32_bf16 v[12:15], v[140:143], v[68:71], v[12:15]
    ds_read_b64_tr_b16 v[156:157], v163 offset:28672
    v_mfma_f32_16x16x32_bf16 v[28:31], v[140:143], v[72:75], v[28:31]
    ds_read_b64_tr_b16 v[158:159], v163 offset:30720
    v_mfma_f32_16x16x32_bf16 v[44:47], v[140:143], v[76:79], v[44:47]
    s_waitcnt lgkmcnt(6)
    v_mfma_f32_16x16x32_bf16 v[16:19], v[144:147], v[68:71], v[16:19]
    ds_read_b64_tr_b16 v[140:141], v162 offset:32768
    v_mfma_f32_16x16x32_bf16 v[32:35], v[144:147], v[72:75], v[32:35]
    ds_read_b64_tr_b16 v[142:143], v162 offset:34816
    v_mfma_f32_16x16x32_bf16 v[48:51], v[144:147], v[76:79], v[48:51]
    s_waitcnt lgkmcnt(6)
    v_mfma_f32_16x16x32_bf16 v[20:23], v[148:151], v[68:71], v[20:23]
    ds_read_b64_tr_b16 v[144:145], v163 offset:32768
    v_mfma_f32_16x16x32_bf16 v[36:39], v[148:151], v[72:75], v[36:39]
    ds_read_b64_tr_b16 v[146:147], v163 offset:34816
    v_mfma_f32_16x16x32_bf16 v[52:55], v[148:151], v[76:79], v[52:55]
    s_waitcnt vmcnt(11)
    s_waitcnt lgkmcnt(6)
    v_mfma_f32_16x16x32_bf16 v[16:19], v[152:155], v[80:83], v[16:19]
    ds_read_b64_tr_b16 v[148:149], v162 offset:36864
    s_waitcnt vmcnt(10)
    v_mfma_f32_16x16x32_bf16 v[32:35], v[152:155], v[84:87], v[32:35]
    ds_read_b64_tr_b16 v[150:151], v162 offset:38912
    s_waitcnt vmcnt(9)
    v_mfma_f32_16x16x32_bf16 v[48:51], v[152:155], v[88:91], v[48:51]
    s_waitcnt lgkmcnt(6)
    v_mfma_f32_16x16x32_bf16 v[20:23], v[156:159], v[80:83], v[20:23]
    ds_read_b64_tr_b16 v[152:153], v163 offset:36864
    v_mfma_f32_16x16x32_bf16 v[36:39], v[156:159], v[84:87], v[36:39]
    ds_read_b64_tr_b16 v[154:155], v163 offset:38912
    v_mfma_f32_16x16x32_bf16 v[52:55], v[156:159], v[88:91], v[52:55]
    s_waitcnt vmcnt(8)
    s_waitcnt lgkmcnt(6)
    v_mfma_f32_16x16x32_bf16 v[16:19], v[140:143], v[92:95], v[16:19]
    ds_read_b64_tr_b16 v[156:157], v160 offset:28672
    s_waitcnt vmcnt(7)
    v_mfma_f32_16x16x32_bf16 v[32:35], v[140:143], v[96:99], v[32:35]
    ds_read_b64_tr_b16 v[158:159], v160 offset:30720
    s_waitcnt vmcnt(6)
    v_mfma_f32_16x16x32_bf16 v[48:51], v[140:143], v[100:103], v[48:51]
    ds_read2_b32 v[120:121], v3 offset0:0 offset1:4
    v_add_u32 v6, s80, v5
    v_add_u32 v7, s82, v5
    v_add_u32 v5, s81, v5
    s_waitcnt lgkmcnt(7)
    v_mfma_f32_16x16x32_bf16 v[20:23], v[144:147], v[92:95], v[20:23]
    ds_read_b64_tr_b16 v[140:141], v161 offset:28672
    v_mfma_f32_16x16x32_bf16 v[36:39], v[144:147], v[96:99], v[36:39]
    ds_read_b64_tr_b16 v[142:143], v161 offset:30720
    v_mfma_f32_16x16x32_bf16 v[52:55], v[144:147], v[100:103], v[52:55]
    v_xor_b32 v165, 8, v164
    s_lshl_b32 s96, s75, 2
    v_add_u32 v166, s96, v3
    s_waitcnt vmcnt(4)
    s_waitcnt lgkmcnt(7)
    v_mfma_f32_16x16x32_bf16 v[16:19], v[148:151], v[104:107], v[16:19]
    ds_read_b64_tr_b16 v[144:145], v160 offset:32768
    s_waitcnt vmcnt(2)
    v_mfma_f32_16x16x32_bf16 v[32:35], v[148:151], v[108:111], v[32:35]
    ds_read_b64_tr_b16 v[146:147], v160 offset:34816
    s_waitcnt vmcnt(0)
    v_mfma_f32_16x16x32_bf16 v[48:51], v[148:151], v[112:115], v[48:51]
    s_waitcnt lgkmcnt(4)
    v_add_u32 v120, v120, v121
    s_lshr_b32 s96, s34, 2
    v_readfirstlane_b32 s97, v120
    s_lshl1_add_u32 s84, s96, 6
    v_mfma_f32_16x16x32_bf16 v[20:23], v[152:155], v[104:107], v[20:23]
    ds_read_b64_tr_b16 v[148:149], v161 offset:32768
    v_mfma_f32_16x16x32_bf16 v[36:39], v[152:155], v[108:111], v[36:39]
    ds_read_b64_tr_b16 v[150:151], v161 offset:34816
    v_mfma_f32_16x16x32_bf16 v[52:55], v[152:155], v[112:115], v[52:55]
    s_cmp_lt_u32 s97, s84
    s_cbranch_scc1 L_fslow
L_fgo:
    v_mfma_f32_16x16x32_bf16 v[8:11], v[156:159], v[80:83], v[8:11]
    ds_read_b64_tr_b16 v[152:153], v160 offset:36864
    v_mfma_f32_16x16x32_bf16 v[24:27], v[156:159], v[84:87], v[24:27]
    ds_read_b64_tr_b16 v[154:155], v160 offset:38912
    ds_write_b128 v6, v[16:19] offset:0
    v_mfma_f32_16x16x32_bf16 v[40:43], v[156:159], v[88:91], v[40:43]
    ds_write_b128 v6, v[32:35] offset:2048
    s_waitcnt lgkmcnt(8)
    v_mfma_f32_16x16x32_bf16 v[12:15], v[140:143], v[80:83], v[12:15]
    ds_read_b64_tr_b16 v[156:157], v161 offset:36864
    ds_write_b128 v6, v[48:51] offset:4096
    v_mfma_f32_16x16x32_bf16 v[28:31], v[140:143], v[84:87], v[28:31]
    ds_read_b64_tr_b16 v[158:159], v161 offset:38912
    ds_write_b128 v6, v[20:23] offset:1024
    v_mfma_f32_16x16x32_bf16 v[44:47], v[140:143], v[88:91], v[44:47]
    ds_write_b128 v6, v[36:39] offset:3072
    s_waitcnt lgkmcnt(11)
    v_mfma_f32_16x16x32_bf16 v[8:11], v[144:147], v[92:95], v[8:11]
    ds_write_b128 v6, v[52:55] offset:5120
    v_mfma_f32_16x16x32_bf16 v[24:27], v[144:147], v[96:99], v[24:27]
    ds_write_b32 v164, v164 offset:64
    v_mfma_f32_16x16x32_bf16 v[40:43], v[144:147], v[100:103], v[40:43]
    v_mov_b32 v162, v116
    v_xor_b32 v6, 32, v1
    s_waitcnt lgkmcnt(11)
    v_mfma_f32_16x16x32_bf16 v[12:15], v[148:151], v[92:95], v[12:15]
    ds_read_b32 v21, v166 offset:48
    v_mfma_f32_16x16x32_bf16 v[28:31], v[148:151], v[96:99], v[28:31]
    ds_read2_b32 v[16:17], v162 offset0:0 offset1:16
    v_mfma_f32_16x16x32_bf16 v[44:47], v[148:151], v[100:103], v[44:47]
    ds_read_b32 v20, v162 offset:128
    s_waitcnt lgkmcnt(12)
    v_mfma_f32_16x16x32_bf16 v[8:11], v[152:155], v[104:107], v[8:11]
    ds_read_b128 v[116:119], v7 offset:0
    v_mfma_f32_16x16x32_bf16 v[24:27], v[152:155], v[108:111], v[24:27]
    ds_read_b128 v[120:123], v7 offset:1024
    v_mfma_f32_16x16x32_bf16 v[40:43], v[152:155], v[112:115], v[40:43]
    ds_read_b128 v[124:127], v7 offset:4096
    s_waitcnt lgkmcnt(10)
    v_mfma_f32_16x16x32_bf16 v[12:15], v[156:159], v[104:107], v[12:15]
    ds_read_b128 v[128:131], v7 offset:5120
    v_mfma_f32_16x16x32_bf16 v[28:31], v[156:159], v[108:111], v[28:31]
    ds_read_b128 v[132:135], v7 offset:8192
    v_mfma_f32_16x16x32_bf16 v[44:47], v[156:159], v[112:115], v[44:47]
    ds_read_b128 v[136:139], v7 offset:9216
    s_waitcnt lgkmcnt(8)
L_fb:
    ds_read_b32 v140, v165 offset:64
    ds_read_b128 v[56:59], v5 offset:0
    ds_read_b128 v[60:63], v5 offset:1024
    ds_read_b128 v[64:67], v5 offset:2048
    ds_read_b128 v[68:71], v5 offset:3072
    ds_read_b128 v[72:75], v5 offset:4096
    ds_read_b128 v[76:79], v5 offset:5120
    s_waitcnt lgkmcnt(6)
    v_readfirstlane_b32 s96, v140
    v_readfirstlane_b32 s97, v21
    s_cmp_eq_u32 s96, 0
    s_cbranch_scc1 L_fxw
    s_cmp_lt_u32 s97, 2
    s_cbranch_scc1 L_fyw
L_yok:
    v_sub_f32 v18, 1.0, v17
    v_sub_f32 v16, 1.0, v16
    v_sub_f32 v20, 1.0, v20
    s_waitcnt lgkmcnt(5)
    v_pk_add_f32 v[56:57], v[56:57], v[8:9]
    v_pk_add_f32 v[58:59], v[58:59], v[10:11]
    v_pk_fma_f32 v[116:117], v[56:57], v[16:17], v[116:117] op_sel_hi:[1,0,1]
    v_pk_fma_f32 v[118:119], v[58:59], v[16:17], v[118:119] op_sel_hi:[1,0,1]
    v_cvt_pk_bf16_f32 v80, v116, v117
    v_cvt_pk_bf16_f32 v81, v118, v119
    ds_write_b64 v1, v[80:81] offset:0
    s_waitcnt lgkmcnt(5)
    v_pk_add_f32 v[60:61], v[60:61], v[12:13]
    v_pk_add_f32 v[62:63], v[62:63], v[14:15]
    v_pk_fma_f32 v[120:121], v[60:61], v[16:17], v[120:121] op_sel_hi:[1,0,1]
    v_pk_fma_f32 v[122:123], v[62:63], v[16:17], v[122:123] op_sel_hi:[1,0,1]
    v_cvt_pk_bf16_f32 v82, v120, v121
    v_cvt_pk_bf16_f32 v83, v122, v123
    ds_write_b64 v6, v[82:83] offset:0
    ds_read_b128 v[92:95], v5 offset:0
    s_waitcnt lgkmcnt(6)
    v_pk_add_f32 v[64:65], v[64:65], v[24:25]
    v_pk_add_f32 v[66:67], v[66:67], v[26:27]
    v_pk_fma_f32 v[124:125], v[64:65], v[18:19], v[124:125] op_sel_hi:[1,0,1]
    v_pk_fma_f32 v[126:127], v[66:67], v[18:19], v[126:127] op_sel_hi:[1,0,1]
    v_cvt_pk_bf16_f32 v84, v124, v125
    v_cvt_pk_bf16_f32 v85, v126, v127
    ds_write_b64 v1, v[84:85] offset:1024
    s_waitcnt lgkmcnt(6)
    v_pk_add_f32 v[68:69], v[68:69], v[28:29]
    v_pk_add_f32 v[70:71], v[70:71], v[30:31]
    v_pk_fma_f32 v[128:129], v[68:69], v[18:19], v[128:129] op_sel_hi:[1,0,1]
    v_pk_fma_f32 v[130:131], v[70:71], v[18:19], v[130:131] op_sel_hi:[1,0,1]
    v_cvt_pk_bf16_f32 v86, v128, v129
    v_cvt_pk_bf16_f32 v87, v130, v131
    ds_write_b64 v6, v[86:87] offset:1024
    ds_read_b128 v[96:99], v5 offset:1024
    s_waitcnt lgkmcnt(7)
    v_pk_add_f32 v[72:73], v[72:73], v[40:41]
    v_pk_add_f32 v[74:75], v[74:75], v[42:43]
    v_pk_fma_f32 v[132:133], v[72:73], v[20:21], v[132:133] op_sel_hi:[1,0,1]
    v_pk_fma_f32 v[134:135], v[74:75], v[20:21], v[134:135] op_sel_hi:[1,0,1]
    v_cvt_pk_bf16_f32 v88, v132, v133
    v_cvt_pk_bf16_f32 v89, v134, v135
    ds_write_b64 v1, v[88:89] offset:2048
    s_waitcnt lgkmcnt(7)
    v_pk_add_f32 v[76:77], v[76:77], v[44:45]
    v_pk_add_f32 v[78:79], v[78:79], v[46:47]
    v_pk_fma_f32 v[136:137], v[76:77], v[20:21], v[136:137] op_sel_hi:[1,0,1]
    v_pk_fma_f32 v[138:139], v[78:79], v[20:21], v[138:139] op_sel_hi:[1,0,1]
    v_cvt_pk_bf16_f32 v90, v136, v137
    v_cvt_pk_bf16_f32 v91, v138, v139
    ds_write_b64 v6, v[90:91] offset:2048
    ds_read_b128 v[100:103], v5 offset:2048
    s_waitcnt lgkmcnt(6)
    buffer_store_dwordx4 v[92:95], v2, s[48:51], s79 offen
    s_add_u32 s79, s79, 20480
    s_waitcnt lgkmcnt(3)
    buffer_store_dwordx4 v[96:99], v2, s[48:51], s79 offen
    s_add_u32 s79, s79, 20480
    s_waitcnt lgkmcnt(0)
    buffer_store_dwordx4 v[100:103], v2, s[48:51], s79 offen
L_pexit:
    s_endpgm
L_lts:
    s_mov_b32 s100, 0
Lw_77:
    ds_read_b32 v4, v164 offset:80
    s_waitcnt lgkmcnt(0)
    v_readfirstlane_b32 s99, v4
    s_cmp_ge_u32 s99, 1
    s_cbranch_scc1 Lwd_78
    s_add_u32 s100, s100, 1
    s_cmp_lt_u32 s100, 8388608
    s_cbranch_scc1 Lw_77
Lwd_78:
    s_branch L_ltg
L_gpslow:
    s_mov_b32 s100, 0
Lpo_79:
    s_waitcnt lgkmcnt(0)
    s_cmp_eq_u32 s86, s31
    s_cbranch_scc1 Lpd_80
    s_sleep 16
    s_load_dwordx2 s[86:87], s[28:29], s92 offset:8192 glc
    s_add_u32 s100, s100, 1
    s_cmp_lt_u32 s100, 1048576
    s_cbranch_scc1 Lpo_79
    s_waitcnt lgkmcnt(0)
Lpd_80:
    s_and_b32 s92, s87, 0x2000
    s_branch L_gpok
L_fxw:
    s_mov_b32 s100, 0
Lw_81:
    ds_read_b32 v4, v165 offset:64
    s_waitcnt lgkmcnt(0)
    v_readfirstlane_b32 s99, v4
    s_cmp_ge_u32 s99, 1
    s_cbranch_scc1 Lwd_82
    s_add_u32 s100, s100, 1
    s_cmp_lt_u32 s100, 8388608
    s_cbranch_scc1 Lw_81
Lwd_82:
    ds_read_b32 v21, v166 offset:48
    ds_read2_b32 v[16:17], v162 offset0:0 offset1:16
    ds_read_b32 v20, v162 offset:128
    ds_read_b128 v[116:119], v7 offset:0
    ds_read_b128 v[120:123], v7 offset:1024
    ds_read_b128 v[124:127], v7 offset:4096
    ds_read_b128 v[128:131], v7 offset:5120
    ds_read_b128 v[132:135], v7 offset:8192
    ds_read_b128 v[136:139], v7 offset:9216
    s_waitcnt lgkmcnt(8)
    s_branch L_fb
L_fyw:
    s_mov_b32 s100, 0
Lw_83:
    ds_read_b32 v4, v166 offset:48
    s_waitcnt lgkmcnt(0)
    v_readfirstlane_b32 s99, v4
    s_cmp_ge_u32 s99, 2
    s_cbranch_scc1 Lwd_84
    s_add_u32 s100, s100, 1
    s_cmp_lt_u32 s100, 8388608
    s_cbranch_scc1 Lw_83
Lwd_84:
    ds_read2_b32 v[16:17], v162 offset0:0 offset1:16
    ds_read_b32 v20, v162 offset:128
    ds_read_b128 v[116:119], v7 offset:0
    ds_read_b128 v[120:123], v7 offset:1024
    ds_read_b128 v[124:127], v7 offset:4096
    ds_read_b128 v[128:131], v7 offset:5120
    ds_read_b128 v[132:135], v7 offset:8192
    ds_read_b128 v[136:139], v7 offset:9216
    s_waitcnt lgkmcnt(0)
    s_branch L_yok
L_fslow:
    s_mov_b32 s100, 0
L_fs2:
    ds_read2_b32 v[120:121], v3 offset0:0 offset1:4
    s_waitcnt lgkmcnt(0)
    v_add_u32 v120, v120, v121
    s_nop 0
    v_readfirstlane_b32 s97, v120
    s_cmp_ge_u32 s97, s84
    s_cbranch_scc1 L_fgo
    s_add_u32 s100, s100, 1
    s_cmp_lt_u32 s100, 8388608
    s_cbranch_scc1 L_fs2
    s_branch L_fgo
L_ns0:
    s_load_dwordx16 s[4:19], s[76:77], 0 glc
    s_waitcnt lgkmcnt(0)
    s_add_u32 s100, s100, 1
    s_cmp_lt_u32 s100, 1048576
    s_cbranch_scc1 L_nb0
    s_branch L_ng0
L_ns1:
    s_load_dwordx16 s[4:19], s[76:77], 0 glc
    s_waitcnt lgkmcnt(0)
    s_add_u32 s100, s100, 1
    s_cmp_lt_u32 s100, 1048576
    s_cbranch_scc1 L_nb1
    s_branch L_ng1
L_ns2:
    s_load_dwordx16 s[4:19], s[76:77], 0 glc
    s_waitcnt lgkmcnt(0)
    s_add_u32 s100, s100, 1
    s_cmp_lt_u32 s100, 1048576
    s_cbranch_scc1 L_nb2
    s_branch L_ng2
L_ns3:
    s_load_dwordx16 s[4:19], s[76:77], 0 glc
    s_waitcnt lgkmcnt(0)
    s_add_u32 s100, s100, 1
    s_cmp_lt_u32 s100, 1048576
    s_cbranch_scc1 L_nb3
    s_branch L_ng3
L_ns4:
    s_load_dwordx16 s[4:19], s[76:77], 0 glc
    s_waitcnt lgkmcnt(0)
    s_add_u32 s100, s100, 1
    s_cmp_lt_u32 s100, 1048576
    s_cbranch_scc1 L_nb4
    s_branch L_ng4
L_ns6:
    s_load_dwordx16 s[4:19], s[76:77], 0 glc
    s_waitcnt lgkmcnt(0)
    s_add_u32 s100, s100, 1
    s_cmp_lt_u32 s100, 1048576
    s_cbranch_scc1 L_nb6
    s_branch L_ng6
L_end:
    s_endpgm
L_codeend:
.section .rodata,"a"
.p2align 6
.amdhsa_kernel gated_mix__ssm_conv_h3__sliding_local_dilated__prompt_kernel
  .amdhsa_next_free_vgpr 168
  .amdhsa_next_free_sgpr 102
  .amdhsa_accum_offset 168
  .amdhsa_group_segment_fixed_size 0
  .amdhsa_kernarg_size 104
  .amdhsa_user_sgpr_count 2
  .amdhsa_user_sgpr_kernarg_segment_ptr 1
  .amdhsa_system_sgpr_workgroup_id_x 1
.end_amdhsa_kernel
.p2align 7
wg_table:
  .long 0, 0, 0, 96, 0, 0, 1985229328, 152
  .long 0, 5, 0, 206, 0, 0, 554272613, 67
  .long 5, 3, 3, 124, 0, 614400, 158762307, 33
  .long 5, 8, 3, 234, 0, 614400, 1411461272, 118
  .long 11, 0, 0, 151, 3, 1351680, 328730199, 66
  .long 11, 5, 0, 261, 3, 1351680, 1749242114, 151
  .long 21, 3, 3, 179, 4, 2580480, 1175660928, 117
  .long 21, 8, 3, 289, 4, 2580480, 2439541813, 32
  .long 0, 1, 1, 97, 0, 0, 2268413985, 150
  .long 0, 6, 1, 207, 0, 0, 847287670, 65
  .long 5, 4, 4, 125, 2, 614400, 2441569333, 32
  .long 5, 9, 4, 235, 2, 614400, 1177688448, 117
  .long 11, 1, 1, 152, 6, 1351680, 554272613, 67
  .long 11, 6, 1, 262, 6, 1351680, 1985229328, 152
  .long 21, 4, 4, 180, 8, 2580480, 1696675849, 116
  .long 21, 9, 4, 290, 8, 2580480, 276202324, 41
  .long 0, 2, 2, 98, 0, 0, 1749242114, 151
  .long 0, 7, 2, 208, 0, 0, 328730199, 66
  .long 6, 0, 0, 126, 7, 737280, 159868227, 33
  .long 6, 5, 0, 236, 7, 737280, 1412567192, 118
  .long 11, 2, 2, 153, 6, 1351680, 847287670, 65
  .long 11, 7, 2, 263, 6, 1351680, 2268413985, 150
  .long 17, 0, 0, 181, 0, 2088960, 1176582528, 117
  .long 17, 5, 0, 291, 0, 2088960, 2440463413, 32
  .long 0, 3, 3, 99, 3, 0, 1985229328, 152
  .long 0, 8, 3, 209, 3, 0, 554272613, 67
  .long 6, 1, 1, 127, 7, 737280, 275280724, 41
  .long 6, 6, 1, 237, 7, 737280, 1695754249, 116
  .long 11, 3, 3, 154, 6, 1351680, 328730199, 66
  .long 11, 8, 3, 264, 6, 1351680, 1749242114, 151
  .long 17, 1, 1, 182, 3, 2088960, 1412567192, 118
  .long 17, 6, 1, 292, 3, 2088960, 159868227, 33
  .long 0, 4, 4, 100, 3, 0, 2268413985, 150
  .long 0, 9, 4, 210, 3, 0, 847287670, 65
  .long 6, 2, 2, 128, 9, 737280, 2440463413, 32
  .long 6, 7, 2, 238, 9, 737280, 1176582528, 117
  .long 11, 4, 4, 155, 9, 1351680, 554272613, 67
  .long 11, 9, 4, 265, 9, 1351680, 1985229328, 152
  .long 17, 2, 2, 183, 3, 2088960, 1695754249, 116
  .long 17, 7, 2, 293, 3, 2088960, 275280724, 41
  .long 1, 0, 0, 101, 2, 122880, 2268413985, 150
  .long 1, 5, 0, 211, 2, 122880, 847287670, 65
  .long 6, 3, 3, 129, 0, 737280, 159868227, 33
  .long 6, 8, 3, 239, 0, 737280, 1412567192, 118
  .long 12, 0, 0, 156, 5, 1474560, 554272613, 67
  .long 12, 5, 0, 266, 5, 1474560, 1985229328, 152
  .long 17, 3, 3, 184, 3, 2088960, 1176582528, 117
  .long 17, 8, 3, 294, 3, 2088960, 2440463413, 32
  .long 1, 1, 1, 102, 2, 122880, 1749242114, 151
  .long 1, 6, 1, 212, 2, 122880, 328730199, 66
  .long 6, 4, 4, 130, 0, 737280, 275280724, 41
  .long 6, 9, 4, 240, 0, 737280, 1695754249, 116
  .long 12, 1, 1, 157, 8, 1474560, 847287670, 65
  .long 12, 6, 1, 267, 8, 1474560, 2268413985, 150
  .long 17, 4, 4, 185, 6, 2088960, 1412567192, 118
  .long 17, 9, 4, 295, 6, 2088960, 159868227, 33
  .long 1, 2, 2, 103, 2, 122880, 1985229328, 152
  .long 1, 7, 2, 213, 2, 122880, 554272613, 67
  .long 7, 0, 0, 131, 6, 860160, 275280724, 41
  .long 7, 5, 0, 241, 6, 860160, 1695754249, 116
  .long 12, 2, 2, 158, 8, 1474560, 328730199, 66
  .long 12, 7, 2, 268, 8, 1474560, 1749242114, 151
  .long 18, 0, 0, 186, 2, 2211840, 1412567192, 118
  .long 18, 5, 0, 296, 2, 2211840, 159868227, 33
  .long 1, 3, 3, 104, 5, 122880, 2268413985, 150
  .long 1, 8, 3, 214, 5, 122880, 847287670, 65
  .long 7, 1, 1, 132, 6, 860160, 2440463413, 32
  .long 7, 6, 1, 242, 6, 860160, 1176582528, 117
  .long 12, 3, 3, 159, 8, 1474560, 554272613, 67
  .long 12, 8, 3, 269, 8, 1474560, 1985229328, 152
  .long 18, 1, 1, 187, 5, 2211840, 1695754249, 116
  .long 18, 6, 1, 297, 5, 2211840, 275280724, 41
  .long 1, 4, 4, 105, 5, 122880, 1749242114, 151
  .long 1, 9, 4, 215, 5, 122880, 328730199, 66
  .long 7, 2, 2, 133, 9, 860160, 159868227, 33
  .long 7, 7, 2, 243, 9, 860160, 1412567192, 118
  .long 12, 4, 4, 160, 9, 1474560, 847287670, 65
  .long 12, 9, 4, 270, 9, 1474560, 2268413985, 150
  .long 18, 2, 2, 188, 5, 2211840, 1176582528, 117
  .long 18, 7, 2, 298, 5, 2211840, 2440463413, 32
  .long 2, 0, 0, 106, 1, 245760, 1749242114, 151
  .long 2, 5, 0, 216, 1, 245760, 328730199, 66
  .long 7, 3, 3, 134, 2, 860160, 275280724, 41
  .long 7, 8, 3, 244, 2, 860160, 1695754249, 116
  .long 13, 0, 0, 161, 4, 1597440, 847287670, 65
  .long 13, 5, 0, 271, 4, 1597440, 2268413985, 150
  .long 18, 3, 3, 189, 5, 2211840, 1412567192, 118
  .long 18, 8, 3, 299, 5, 2211840, 159868227, 33
  .long 2, 1, 1, 107, 1, 245760, 1985229328, 152
  .long 2, 6, 1, 217, 1, 245760, 554272613, 67
  .long 7, 4, 4, 135, 2, 860160, 2440463413, 32
  .long 7, 9, 4, 245, 2, 860160, 1176582528, 117
  .long 13, 1, 1, 162, 7, 1597440, 328730199, 66
  .long 13, 6, 1, 272, 7, 1597440, 1749242114, 151
  .long 18, 4, 4, 190, 8, 2211840, 1695754249, 116
  .long 18, 9, 4, 300, 8, 2211840, 275280724, 41
  .long 2, 2, 2, 108, 1, 245760, 2268413985, 150
  .long 2, 7, 2, 218, 1, 245760, 847287670, 65
  .long 8, 0, 0, 136, 8, 983040, 2440463413, 32
  .long 8, 5, 0, 246, 8, 983040, 1176582528, 117
  .long 13, 2, 2, 163, 7, 1597440, 554272613, 67
  .long 13, 7, 2, 273, 7, 1597440, 1985229328, 152
  .long 19, 0, 0, 191, 1, 2334720, 1695754249, 116
  .long 19, 5, 0, 301, 1, 2334720, 275280724, 41
  .long 2, 3, 3, 109, 4, 245760, 1749242114, 151
  .long 2, 8, 3, 219, 4, 245760, 328730199, 66
  .long 8, 1, 1, 137, 8, 983040, 159868227, 33
  .long 8, 6, 1, 247, 8, 983040, 1412567192, 118
  .long 13, 3, 3, 164, 7, 1597440, 847287670, 65
  .long 13, 8, 3, 274, 7, 1597440, 2268413985, 150
  .long 19, 1, 1, 192, 4, 2334720, 1176582528, 117
  .long 19, 6, 1, 302, 4, 2334720, 2440463413, 32
  .long 2, 4, 4, 110, 4, 245760, 1985229328, 152
  .long 2, 9, 4, 220, 4, 245760, 554272613, 67
  .long 8, 2, 2, 138, 9, 983040, 275280724, 41
  .long 8, 7, 2, 248, 9, 983040, 1695754249, 116
  .long 13, 4, 4, 165, 9, 1597440, 328730199, 66
  .long 13, 9, 4, 275, 9, 1597440, 1749242114, 151
  .long 19, 2, 2, 193, 4, 2334720, 1412567192, 118
  .long 19, 7, 2, 303, 4, 2334720, 159868227, 33
  .long 3, 0, 0, 111, 0, 368640, 1985229328, 152
  .long 3, 5, 0, 221, 0, 368640, 554272613, 67
  .long 8, 3, 3, 139, 1, 983040, 2440463413, 32
  .long 8, 8, 3, 249, 1, 983040, 1176582528, 117
  .long 14, 0, 0, 166, 3, 1720320, 328730199, 66
  .long 14, 5, 0, 276, 3, 1720320, 1749242114, 151
  .long 19, 3, 3, 194, 4, 2334720, 1695754249, 116
  .long 19, 8, 3, 304, 4, 2334720, 275280724, 41
  .long 3, 1, 1, 112, 0, 368640, 2268413985, 150
  .long 3, 6, 1, 222, 0, 368640, 847287670, 65
  .long 8, 4, 4, 140, 1, 983040, 159868227, 33
  .long 8, 9, 4, 250, 1, 983040, 1412567192, 118
  .long 14, 1, 1, 167, 6, 1720320, 554272613, 67
  .long 14, 6, 1, 277, 6, 1720320, 1985229328, 152
  .long 19, 4, 4, 195, 7, 2334720, 1176582528, 117
  .long 19, 9, 4, 305, 7, 2334720, 2440463413, 32
  .long 3, 2, 2, 113, 0, 368640, 1749242114, 151
  .long 3, 7, 2, 223, 0, 368640, 328730199, 66
  .long 9, 0, 0, 141, 7, 1105920, 159868227, 33
  .long 9, 5, 0, 251, 7, 1105920, 1412567192, 118
  .long 14, 2, 2, 168, 6, 1720320, 847287670, 65
  .long 14, 7, 2, 278, 6, 1720320, 2268413985, 150
  .long 20, 0, 0, 196, 0, 2457600, 1176582528, 117
  .long 20, 5, 0, 306, 0, 2457600, 2440463413, 32
  .long 3, 3, 3, 114, 3, 368640, 1985229328, 152
  .long 3, 8, 3, 224, 3, 368640, 554272613, 67
  .long 9, 1, 1, 142, 7, 1105920, 275280724, 41
  .long 9, 6, 1, 252, 7, 1105920, 1695754249, 116
  .long 14, 3, 3, 169, 6, 1720320, 328730199, 66
  .long 14, 8, 3, 279, 6, 1720320, 1749242114, 151
  .long 20, 1, 1, 197, 3, 2457600, 1412567192, 118
  .long 20, 6, 1, 307, 3, 2457600, 159868227, 33
  .long 3, 4, 4, 115, 3, 368640, 2268413985, 150
  .long 3, 9, 4, 225, 3, 368640, 847287670, 65
  .long 9, 2, 2, 143, 9, 1105920, 2440463413, 32
  .long 9, 7, 2, 253, 9, 1105920, 1176582528, 117
  .long 14, 4, 4, 170, 9, 1720320, 554272613, 67
  .long 14, 9, 4, 280, 9, 1720320, 1985229328, 152
  .long 20, 2, 2, 198, 3, 2457600, 1695754249, 116
  .long 20, 7, 2, 308, 3, 2457600, 275280724, 41
  .long 4, 0, 0, 116, 2, 491520, 2268413985, 150
  .long 4, 5, 0, 226, 2, 491520, 847287670, 65
  .long 9, 3, 3, 144, 0, 1105920, 159868227, 33
  .long 9, 8, 3, 254, 0, 1105920, 1412567192, 118
  .long 15, 0, 0, 171, 5, 1843200, 554272613, 67
  .long 15, 5, 0, 281, 5, 1843200, 1985229328, 152
  .long 20, 3, 3, 199, 3, 2457600, 1176582528, 117
  .long 20, 8, 3, 309, 3, 2457600, 2440463413, 32
  .long 4, 1, 1, 117, 2, 491520, 1749242114, 151
  .long 4, 6, 1, 227, 2, 491520, 328730199, 66
  .long 9, 4, 4, 145, 0, 1105920, 275280724, 41
  .long 9, 9, 4, 255, 0, 1105920, 1695754249, 116
  .long 15, 1, 1, 172, 8, 1843200, 847287670, 65
  .long 15, 6, 1, 282, 8, 1843200, 2268413985, 150
  .long 20, 4, 4, 200, 6, 2457600, 1412567192, 118
  .long 20, 9, 4, 310, 6, 2457600, 159868227, 33
  .long 4, 2, 2, 118, 2, 491520, 1985229328, 152
  .long 4, 7, 2, 228, 2, 491520, 554272613, 67
  .long 10, 0, 0, 146, 6, 1228800, 275280724, 41
  .long 10, 5, 0, 256, 6, 1228800, 1695754249, 116
  .long 15, 2, 2, 173, 8, 1843200, 328730199, 66
  .long 15, 7, 2, 283, 8, 1843200, 1749242114, 151
  .long 16, 0, 0, 201, 2, 1966080, 1412567192, 118
  .long 16, 5, 0, 311, 2, 1966080, 159868227, 33
  .long 4, 3, 3, 119, 5, 491520, 2268413985, 150
  .long 4, 8, 3, 229, 5, 491520, 847287670, 65
  .long 10, 1, 1, 147, 6, 1228800, 2440463413, 32
  .long 10, 6, 1, 257, 6, 1228800, 1176582528, 117
  .long 15, 3, 3, 174, 8, 1843200, 554272613, 67
  .long 15, 8, 3, 284, 8, 1843200, 1985229328, 152
  .long 16, 1, 1, 202, 5, 1966080, 1695754249, 116
  .long 16, 6, 1, 312, 5, 1966080, 275280724, 41
  .long 4, 4, 4, 120, 5, 491520, 1749242114, 151
  .long 4, 9, 4, 230, 5, 491520, 328730199, 66
  .long 10, 2, 2, 148, 9, 1228800, 159868227, 33
  .long 10, 7, 2, 258, 9, 1228800, 1412567192, 118
  .long 15, 4, 4, 175, 9, 1843200, 847287670, 65
  .long 15, 9, 4, 285, 9, 1843200, 2268413985, 150
  .long 16, 2, 2, 203, 5, 1966080, 1176582528, 117
  .long 16, 7, 2, 313, 5, 1966080, 2440463413, 32
  .long 5, 0, 0, 121, 1, 614400, 1749242114, 151
  .long 5, 5, 0, 231, 1, 614400, 328730199, 66
  .long 10, 3, 3, 149, 2, 1228800, 275280724, 41
  .long 10, 8, 3, 259, 2, 1228800, 1695754249, 116
  .long 21, 0, 0, 176, 4, 2580480, 847287670, 65
  .long 21, 5, 0, 286, 4, 2580480, 2268413985, 150
  .long 16, 3, 3, 204, 5, 1966080, 1412567192, 118
  .long 16, 8, 3, 314, 5, 1966080, 159868227, 33
  .long 5, 1, 1, 122, 1, 614400, 1985229328, 152
  .long 5, 6, 1, 232, 1, 614400, 554272613, 67
  .long 10, 4, 4, 150, 2, 1228800, 2440463413, 32
  .long 10, 9, 4, 260, 2, 1228800, 1176582528, 117
  .long 21, 1, 1, 177, 7, 2580480, 328730199, 66
  .long 21, 6, 1, 287, 7, 2580480, 1749242114, 151
  .long 16, 4, 4, 205, 8, 1966080, 1695754249, 116
  .long 16, 9, 4, 315, 8, 1966080, 275280724, 41
  .long 5, 2, 2, 123, 1, 614400, 2268413985, 150
  .long 5, 7, 2, 233, 1, 614400, 847287670, 65
  .long 0, 0, 0, 0, 0, 0, 0, 0
  .long 0, 1, 0, 1, 0, 0, 0, 0
  .long 21, 2, 2, 178, 7, 2580480, 554272613, 67
  .long 21, 7, 2, 288, 7, 2580480, 1985229328, 152
  .long 0, 0, 0, 2, 0, 0, 0, 0
  .long 0, 1, 0, 3, 0, 0, 0, 0
  .long 0, 0, 0, 4, 0, 0, 0, 0
  .long 0, 1, 0, 5, 0, 0, 0, 0
  .long 0, 0, 0, 6, 0, 0, 0, 0
  .long 0, 1, 0, 7, 0, 0, 0, 0
  .long 0, 0, 0, 8, 0, 0, 0, 0
  .long 0, 1, 0, 9, 0, 0, 0, 0
  .long 0, 0, 0, 10, 0, 0, 0, 0
  .long 0, 1, 0, 11, 0, 0, 0, 0
  .long 0, 0, 0, 12, 0, 0, 0, 0
  .long 0, 1, 0, 13, 0, 0, 0, 0
  .long 0, 0, 0, 14, 0, 0, 0, 0
  .long 0, 1, 0, 15, 0, 0, 0, 0
  .long 0, 0, 0, 16, 0, 0, 0, 0
  .long 0, 1, 0, 17, 0, 0, 0, 0
  .long 0, 0, 0, 18, 0, 0, 0, 0
  .long 0, 1, 0, 19, 0, 0, 0, 0
  .long 0, 0, 0, 20, 0, 0, 0, 0
  .long 0, 1, 0, 21, 0, 0, 0, 0
  .long 0, 0, 0, 22, 0, 0, 0, 0
  .long 0, 1, 0, 23, 0, 0, 0, 0
  .long 0, 0, 0, 24, 0, 0, 0, 0
  .long 0, 1, 0, 25, 0, 0, 0, 0
  .long 0, 0, 0, 26, 0, 0, 0, 0
  .long 0, 1, 0, 27, 0, 0, 0, 0
  .long 0, 0, 0, 316, 0, 0, 0, 0
  .long 0, 1, 0, 317, 0, 0, 0, 0
  .long 0, 0, 0, 318, 0, 0, 0, 0
  .long 0, 1, 0, 319, 0, 0, 0, 0
  .long 0, 0, 0, 28, 0, 0, 0, 0
  .long 0, 1, 0, 29, 0, 0, 0, 0
  .long 0, 0, 0, 30, 0, 0, 0, 0
  .long 0, 1, 0, 31, 0, 0, 0, 0
```

```asm
; @launch grid=(256,1,1) block=(768,1,1) lds=163840
.amdgcn_target "amdgcn-amd-amdhsa--gfx950"
.text
.globl gated_mix__ssm_conv_h3__sliding_local_dilated__prompt_kernel
.p2align 8
.type gated_mix__ssm_conv_h3__sliding_local_dilated__prompt_kernel,@function
gated_mix__ssm_conv_h3__sliding_local_dilated__prompt_kernel:
    s_load_dwordx16 s[4:19], s[0:1], 0
    s_getpc_b64 s[46:47]
L_pc:
    s_add_u32 s44, s46, wg_table@rel32@lo+4
    s_addc_u32 s45, s47, wg_table@rel32@hi+12
    s_and_b32 s97, s2, 255
    s_lshl_b32 s97, s97, 5
    s_load_dwordx8 s[32:39], s[44:45], s97
    s_lshr_b32 s96, s2, 3
    s_lshl_b32 s97, s96, 7
    v_lshl_add_u32 v5, v0, 12, s97
    v_cmp_gt_u32 vcc, L_codeend-L_pc-4, v5
    s_and_saveexec_b64 s[50:51], vcc
    s_cbranch_execz L_nopf
    global_load_dword v166, v5, s[46:47]
L_nopf:
    s_mov_b64 exec, -1
    s_load_dwordx8 s[20:27], s[0:1], 64
    s_load_dwordx2 s[28:29], s[0:1], 96
    v_lshrrev_b32 v4, 6, v0
    v_and_b32 v0, 63, v0
    v_readfirstlane_b32 s30, v4
    s_cmp_ge_u32 s96, 32
    s_cbranch_scc1 L_end
    v_lshrrev_b32 v2, 4, v0
    v_and_b32 v1, 15, v0
    v_lshrrev_b32 v4, 3, v0
    v_and_b32 v5, 7, v0
    s_lshl_b32 s99, s2, 2
    s_lshr_b32 s99, 0x55445544, s99
    s_and_b32 s99, s99, 15
    s_add_u32 s99, s99, s96
    s_lshr_b32 s3, s99, 5
    s_cbranch_scc1 L_a
    s_cmp_ge_u32 s30, 3
    s_cbranch_scc1 L_notld
    s_setprio 3
    s_mov_b32 s51, 0
    s_mul_i32 s52, s30, 12288
    s_addk_i32 s52, 2048
    s_min_u32 s98, s30, 1
    s_lshr_b32 s54, s30, 1
    s_mul_i32 s54, s54, 122880
    v_lshlrev_b32 v6, s98, v2
    v_and_b32 v6, 3, v6
    v_xor_b32 v5, v5, v6
    s_mulk_i32 s98, 2560
    s_addk_i32 s98, 1280
    v_mul_u32_u24 v4, s98, v4
    v_lshl_add_u32 v8, v5, 4, v4
    v_xor_b32 v9, 64, v8
    s_lshl_b32 s56, s98, 3
    s_addk_i32 s56, -1024
    s_mov_b32 s43, 0x00020000
    s_cmp_eq_u32 s30, 0
    s_movk_i32 s57, 13312
    s_cselect_b32 s57, s57, 4294879488
    s_movk_i32 s58, 128
    s_cselect_b32 s58, s58, 245760
    s_mov_b32 s42, 2621440
    s_cselect_b32 s42, s42, 2457600
    s_waitcnt lgkmcnt(0)
    s_cselect_b64 s[40:41], s[4:5], s[18:19]
    s_mul_i32 s96, s33, 128
    s_cselect_b32 s96, s37, s96
    s_add_u32 s54, s54, s96
    s_and_b32 s53, s38, 15
    s_lshr_b64 s[38:39], s[38:39], 4
    s_mov_b32 m0, s52
    s_mul_i32 s96, s53, s58
    s_add_u32 s50, s96, s54
    s_branch L_ld
L_ldb:
    s_barrier
L_ld2:
L_ld:
    buffer_load_dwordx4 v8, s[40:43], s50 offen offset:0 lds
    s_add_u32 s50, s50, s56
    buffer_load_dwordx4 v9, s[40:43], s50 offen offset:1024 lds
    s_add_u32 s50, s50, s56
    s_add_u32 s51, s51, 1
    s_cmp_lg_u32 s51, 3
    s_cbranch_scc1 L_ldt
    s_load_dword s31, s[28:29], 0
L_ldt:
    buffer_load_dwordx4 v8, s[40:43], s50 offen offset:2048 lds
    s_add_u32 s50, s50, s56
    s_and_b32 s53, s38, 15
    s_lshr_b64 s[38:39], s[38:39], 4
    s_mul_i32 s55, s53, s58
    s_add_u32 s55, s55, s54
    buffer_load_dwordx4 v9, s[40:43], s50 offen offset:3072 lds
    s_add_u32 s50, s50, s57
    s_add_u32 m0, m0, 4096
    s_add_u32 s52, s52, 38912
    s_cmp_ge_u32 s52, 116736
    s_cselect_b32 s96, 116736, 0
    s_sub_u32 s52, s52, s96
    buffer_load_dwordx4 v8, s[40:43], s50 offen offset:0 lds
    s_add_u32 s50, s50, s56
    s_cmp_lg_u32 s51, 10
    s_cbranch_scc1 L_ldp
    s_lshl_b32 s92, s2, 7
    s_and_b32 s92, s92, 0x1f80
    s_load_dwordx2 s[86:87], s[28:29], s92 offset:8192
L_ldp:
    buffer_load_dwordx4 v9, s[40:43], s50 offen offset:1024 lds
    s_add_u32 s50, s50, s56
    buffer_load_dwordx4 v8, s[40:43], s50 offen offset:2048 lds
    s_add_u32 s50, s50, s56
    buffer_load_dwordx4 v9, s[40:43], s50 offen offset:3072 lds
    s_add_u32 s50, s50, s57
    s_add_u32 m0, m0, 4096
    s_nop 0
    buffer_load_dwordx4 v8, s[40:43], s50 offen offset:0 lds
    s_add_u32 s50, s50, s56
    buffer_load_dwordx4 v9, s[40:43], s50 offen offset:1024 lds
    s_add_u32 s50, s50, s56
    buffer_load_dwordx4 v8, s[40:43], s50 offen offset:2048 lds
    s_add_u32 s50, s50, s56
    buffer_load_dwordx4 v9, s[40:43], s50 offen offset:3072 lds
    s_mov_b32 m0, s52
    s_mov_b32 s50, s55
    s_cmp_lt_u32 s51, 2
    s_cbranch_scc1 L_ld2
    s_cmp_lt_u32 s51, 10
    s_waitcnt vmcnt(12) lgkmcnt(0)
    s_cbranch_scc1 L_ldb
    s_barrier
    s_setprio 0
    s_waitcnt vmcnt(0)
    s_barrier
    v_mov_b32 v3, 160960
    s_mov_b32 s101, 1
    s_cmp_lg_u32 s30, 0
    s_cbranch_scc1 L_ps
    s_branch L_s0
L_a:
    s_lshr_b32 s96, s30, 2
    s_lshl_b32 s98, s96, 5
    s_mul_i32 s41, s96, 42752
    s_add_u32 s41, s41, 1024
    s_mov_b32 s54, s41
    s_branch L_c
L_notld:
    s_cmp_lt_u32 s30, 8
    s_cbranch_scc1 L_hg
    s_mov_b32 s98, 0
    s_mov_b32 s41, 116736
    s_mov_b32 s54, 116736
L_c:
    s_and_b32 s40, s30, 3
    v_mul_u32_u24 v4, 1280, v4
    v_lshrrev_b32 v6, 1, v2
    v_xor_b32 v5, v5, v6
    s_lshl_b32 s96, s40, 2
    s_and_b32 s96, s96, 4
    v_xor_b32 v5, s96, v5
    v_lshl_add_u32 v22, v5, 4, v4
    v_xor_b32 v23, 32, v22
    s_waitcnt lgkmcnt(0)
    s_add_u32 s43, s35, s98
    s_cmp_ge_u32 s43, 320
    s_cbranch_scc1 L_idle
    s_lshr_b32 s55, s43, 5
    s_and_b32 s63, s43, 31
    s_lshl2_add_u32 s96, s55, s40
    s_lshl_b32 s96, s96, 7
    v_lshl_add_u32 v21, v1, 3, s96
    v_lshlrev_b32 v12, 4, v0
    s_lshr_b32 s96, s40, 1
    s_lshl1_add_u32 s42, s43, s96
    s_mul_i32 s96, s96, 8320
    s_add_u32 s96, s96, s41
    s_add_u32 s62, s96, 16960
    s_and_b32 s97, s40, 1
    s_lshl_b32 s98, s97, 11
    s_add_u32 s60, s98, s62
    s_lshl_b32 s96, s42, 12
    s_add_u32 s61, s96, s98
    s_mov_b32 s46, 2621440
    s_mov_b32 s47, 0x00020000
    s_mov_b64 s[50:51], s[46:47]
    s_setprio 1
    s_cmp_ge_u32 s30, 4
    s_cbranch_scc1 L_c2
    s_lshl2_add_u32 s96, s63, s40
    s_mul_i32 s96, s96, 20480
    s_lshl_b32 s97, s55, 7
    s_add_u32 s96, s96, s97
    s_lshl_b32 s97, s40, 11
    s_add_u32 s97, s97, s41
    s_add_u32 m0, s97, 8704
    s_add_u32 s98, s96, 9216
    s_waitcnt lgkmcnt(0)
    s_mov_b64 s[48:49], s[8:9]
    buffer_load_dwordx4 v22, s[48:51], s96 offen lds
    buffer_load_dwordx4 v23, s[48:51], s98 offen offset:1024 lds
    s_sub_u32 m0, m0, 8192
    s_mov_b64 s[44:45], s[6:7]
    buffer_load_dwordx4 v22, s[44:47], s96 offen lds
    buffer_load_dwordx4 v23, s[44:47], s98 offen offset:1024 lds
    global_load_dwordx2 v[14:15], v21, s[10:11]
    s_cmp_lg_u32 s40, 3
    s_cbranch_scc1 Lkv_1
    s_sub_u32 s96, s96, 71680
    s_cselect_b32 s96, 0x40000000, s96
    s_sub_u32 m0, s41, 512
    s_mov_b32 exec_lo, 0
    buffer_load_dwordx4 v23, s[44:47], s96 offen lds
    s_mov_b32 exec_lo, -1
Lkv_1:
    s_mov_b64 s[48:49], s[12:13]
    s_mov_b32 m0, s60
    s_sub_u32 s96, s61, 16
    s_bitcmp1_b32 s40, 0
    s_cselect_b32 s96, s96, 0x40000000
    buffer_load_dwordx4 v12, s[48:51], s61 offen lds
    buffer_load_dwordx4 v12, s[48:51], s61 offen offset:1024 lds
    s_sub_u32 m0, s60, 16
    s_mov_b64 exec, 1
    buffer_load_dwordx4 v12, s[48:51], s96 offen lds
    s_mov_b64 exec, -1
L_c2:
    s_lshr_b32 s96, s30, 2
    s_lshl_b32 s96, s96, 6
    s_add_u32 s96, s96, 160768
    v_mov_b32 v3, s96
    v_mov_b32 v6, 0
    s_lshl_b32 s96, s40, 8
    s_add_u32 s96, s96, s41
    v_lshl_add_u32 v5, v0, 2, s96
    ds_write_b32 v5, v6 offset:41728
    s_mul_i32 s96, s40, 4160
    s_add_u32 s96, s96, s41
    v_lshl_add_u32 v5, v1, 2, s96
    ds_write_b32 v5, v6 offset:16896
    v_lshl_add_u32 v5, v1, 2, v3
    ds_write_b32 v5, v6
    v_and_b32 v4, 1, v2
    v_lshrrev_b32 v5, 1, v2
    v_lshlrev_b32 v6, 2, v1
    v_sub_u32 v6, v6, v4
    s_add_u32 s96, s41, 256
    v_lshl_add_u32 v6, v6, 7, s96
    s_lshl_b32 s97, s40, 1
    v_or_b32 v7, s97, v5
    v_sub_u32 v9, v1, v4
    v_subrev_u32 v10, 1, v1
    v_xor_b32 v8, v1, v7
    v_and_b32 v8, 7, v8
    v_lshl_add_u32 v8, v8, 4, v6
    v_xor_b32 v9, v9, v7
    v_and_b32 v9, 7, v9
    v_lshl_add_u32 v9, v9, 4, v6
    v_xor_b32 v10, v10, v7
    v_and_b32 v10, 7, v10
    v_lshl_add_u32 v10, v10, 4, v6
    v_mul_u32_u24 v7, 136, v4
    v_add_u32 v13, v8, v7
    v_and_b32 v6, 1, v1
    v_xor_b32 v16, v4, v6
    v_lshlrev_b32 v16, 4, v16
    v_lshlrev_b32 v6, 4, v6
    v_mov_b32 v7, 0xffff
    v_lshlrev_b32 v6, v6, v7
    v_lshrrev_b32 v7, 1, v1
    v_lshlrev_b32 v5, 2, v5
    v_sub_u32 v7, v7, v5
    v_cmp_eq_u32 vcc, 0, v7
    s_nop 1
    v_cndmask_b32 v17, 0, v6, vcc
    v_cmp_eq_u32 vcc, 1, v7
    s_nop 1
    v_cndmask_b32 v18, 0, v6, vcc
    v_cmp_eq_u32 vcc, 2, v7
    s_nop 1
    v_cndmask_b32 v19, 0, v6, vcc
    v_cmp_eq_u32 vcc, 3, v7
    s_nop 1
    v_cndmask_b32 v20, 0, v6, vcc
    v_not_b32 v4, v0
    v_bfe_u32 v5, v4, 1, 2
    v_lshlrev_b32 v5, 4, v5
    v_bfe_u32 v6, v4, 3, 1
    v_lshl_add_u32 v5, v6, 7, v5
    v_xor_b32 v6, s63, v4
    v_and_b32 v6, 1, v6
    v_lshl_add_u32 v5, v6, 6, v5
    v_lshl_add_u32 v5, v2, 14, v5
    s_lshl2_add_u32 s96, s55, s40
    s_lshl_b32 s97, s96, 16
    s_lshl_b32 s98, s63, 8
    s_sub_u32 s97, s97, s98
    s_add_u32 s97, s97, 2105088
    v_add_u32 v11, s97, v5
    s_lshl_b32 s97, s96, 10
    s_lshl2_add_u32 s97, s63, s97
    s_add_u32 s64, s97, 65536
    s_and_b32 s96, s43, -8
    s_cmp_ge_u32 s55, 3
    s_cselect_b32 s96, s96, s43
    s_lshl_b32 s96, s96, 7
    s_add_u32 s65, s96, 65536
    s_waitcnt lgkmcnt(0)
    s_load_dword s31, s[28:29], 0
    s_lshl_b32 s96, s43, 2
    s_load_dword s53, s[14:15], s96
    s_cmp_lg_u32 s3, 0
    s_cbranch_scc1 L_akv
    s_mul_i32 s96, s36, 43
    s_lshr_b32 s96, s96, 7
    s_mul_i32 s96, s96, 3
    s_sub_u32 s96, s36, s96
    s_mul_i32 s97, s96, 38912
    v_lshrrev_b32 v4, 1, v1
    v_lshrrev_b32 v5, 1, v2
    v_xor_b32 v4, v4, v5
    s_lshl_b32 s96, s40, 1
    v_xor_b32 v4, s96, v4
    v_lshlrev_b32 v4, 4, v4
    v_lshl_add_u32 v4, v1, 7, v4
    v_and_b32 v5, 1, v2
    v_lshl_add_u32 v4, v5, 3, v4
    v_add_u32 v166, s97, v4
    s_barrier
    s_cmp_lg_u32 s36, 0
    s_cbranch_scc1 Lq_2
    ds_read_b64 v[112:113], v166 offset:2048
    ds_read_b64 v[114:115], v166 offset:4096
    ds_read_b64 v[116:117], v166 offset:6144
    ds_read_b64 v[118:119], v166 offset:8192
    ds_read_b64 v[120:121], v166 offset:10240
    ds_read_b64 v[122:123], v166 offset:12288
    s_waitcnt lgkmcnt(0)
Lq_2:
    s_setprio 0
    s_cmp_eq_u32 s32, 21
    s_cselect_b32 s97, 0xc0, 0
    v_add_u32 v4, 0, v0
    v_mul_u32_u24 v5, 5462, v4
    v_lshrrev_b32 v5, 16, v5
    v_lshrrev_b32 v6, 1, v5
    v_mul_u32_u24 v5, 3904, v5
    v_lshl_add_u32 v5, v6, 13, v5
    v_lshl_add_u32 v144, v4, 4, v5
    v_and_b32 v5, s97, v144
    v_lshl_add_u32 v144, v5, 22, v144
    v_add_u32 v4, 64, v0
    v_mul_u32_u24 v5, 5462, v4
    v_lshrrev_b32 v5, 16, v5
    v_lshrrev_b32 v6, 1, v5
    v_mul_u32_u24 v5, 3904, v5
    v_lshl_add_u32 v5, v6, 13, v5
    v_lshl_add_u32 v145, v4, 4, v5
    v_and_b32 v5, s97, v145
    v_lshl_add_u32 v145, v5, 22, v145
    v_add_u32 v4, 128, v0
    v_mul_u32_u24 v5, 5462, v4
    v_lshrrev_b32 v5, 16, v5
    v_lshrrev_b32 v6, 1, v5
    v_mul_u32_u24 v5, 3904, v5
    v_lshl_add_u32 v5, v6, 13, v5
    v_lshl_add_u32 v146, v4, 4, v5
    v_and_b32 v5, s97, v146
    v_lshl_add_u32 v146, v5, 22, v146
    s_xor_b32 s96, s40, 1
    s_lshl_b32 s96, s96, 12
    s_add_u32 s96, s96, 116736
    v_lshrrev_b32 v4, 2, v0
    v_mul_u32_u24 v4, 192, v4
    v_and_b32 v5, 3, v0
    v_lshl_add_u32 v4, v5, 3, v4
    v_add_u32 v147, s96, v4
L_cs:
    s_and_b32 s97, s40, 1
    v_add_u32 v156, s60, v12
    s_lshl_b32 s98, s97, 8
    s_add_u32 s96, s62, s98
    s_add_u32 s96, s96, 4132
    v_lshrrev_b32 v4, 1, v1
    v_lshl_add_u32 v4, v2, 2, v4
    v_lshl_add_u32 v4, v4, 2, s96
    v_and_b32 v5, 1, v1
    v_mul_u32_u24 v5, 4160, v5
    v_sub_u32 v148, v4, v5
    v_add_u32 v149, 1024, v148
    v_add_u32 v150, 2048, v148
    v_add_u32 v151, 3072, v148
    v_lshlrev_b32 v4, 1, v1
    v_sub_u32 v4, v2, v4
    s_lshl_b32 s98, s97, 4
    s_add_u32 s98, s98, 30
    v_add_u32 v4, s98, v4
    s_lshr_b32 s98, s40, 1
    s_add_u32 s96, s41, 33536
    v_and_b32 v5, 3, v4
    v_lshl_add_u32 v5, v5, 4, s96
    v_lshrrev_b32 v6, 2, v4
    v_lshl_add_u32 v5, v6, 7, v5
    v_bfe_u32 v6, v4, 3, 1
    v_xor_b32 v6, s98, v6
    v_lshl_add_u32 v152, v6, 6, v5
    v_xor_b32 v154, 64, v152
    v_add_u32 v4, 4, v4
    v_and_b32 v5, 3, v4
    v_lshl_add_u32 v5, v5, 4, s96
    v_lshrrev_b32 v6, 2, v4
    v_lshl_add_u32 v5, v6, 7, v5
    v_bfe_u32 v6, v4, 3, 1
    v_xor_b32 v6, s98, v6
    v_lshl_add_u32 v153, v6, 6, v5
    v_xor_b32 v155, 64, v153
    v_and_b32 v5, 1, v2
    v_lshlrev_b32 v5, 9, v5
    v_lshl_add_u32 v5, v1, 5, v5
    v_lshrrev_b32 v6, 1, v2
    v_lshl_add_u32 v5, v6, 4, v5
    s_lshl_b32 s96, s43, 14
    s_lshl_b32 s97, s40, 11
    s_and_b32 s97, s97, 4096
    s_add_u32 s96, s96, s97
    s_add_u32 s96, s96, 4718592
    s_lshr_b32 s100, s96, 8
    s_and_b32 s100, s100, 8192
    s_xor_b32 s96, s96, s100
    v_add_u32 v157, s96, v5
    s_mul_i32 s97, s55, 16640
    s_lshr_b32 s96, s63, 3
    s_lshl_b32 s96, s96, 7
    s_add_u32 s97, s97, s96
    s_and_b32 s96, s63, 7
    s_lshl3_add_u32 s97, s96, s97
    s_add_u32 s82, s97, 262144
    s_lshl_b32 s96, s40, 12
    s_add_u32 s96, s96, s54
    v_add_u32 v158, s96, v12
    s_xor_b32 s96, s40, 1
    s_lshl_b32 s96, s96, 12
    s_add_u32 s96, s96, s54
    v_add_u32 v159, s96, v12
    s_waitcnt lgkmcnt(0)
    s_mul_i32 s31, s31, 1664525
    s_add_u32 s31, s31, 1013904223
    s_mov_b32 s58, s31
    s_mov_b32 s59, s31
    s_add_u32 s56, s28, s65
    s_addc_u32 s57, s29, 0
    s_bitcmp1_b32 s40, 1
    s_cselect_b32 s96, 0, 16
    s_lshl_b32 s53, s53, s96
    s_and_b32 s53, s53, 0xffff0000
    s_bitcmp1_b32 s40, 0
    s_cselect_b32 s53, 0, s53
    s_cmp_lg_u32 s3, 0
    s_cbranch_scc1 L_asig
    s_setprio 1
    s_lshl2_add_u32 s96, s63, s40
    s_mul_i32 s96, s96, 20480
    s_lshl_b32 s97, s55, 7
    s_add_u32 s96, s96, s97
    s_lshl_b32 s97, s40, 11
    s_add_u32 s97, s97, s41
    s_add_u32 m0, s97, 8704
    s_add_u32 s98, s96, 9216
    s_waitcnt lgkmcnt(0)
    s_mov_b64 s[48:49], s[8:9]
    buffer_load_dwordx4 v22, s[48:51], s96 offen lds
    buffer_load_dwordx4 v23, s[48:51], s98 offen offset:1024 lds
    s_sub_u32 m0, m0, 8192
    s_mov_b64 s[44:45], s[6:7]
    buffer_load_dwordx4 v22, s[44:47], s96 offen lds
    buffer_load_dwordx4 v23, s[44:47], s98 offen offset:1024 lds
    global_load_dwordx2 v[14:15], v21, s[10:11]
    s_cmp_lg_u32 s40, 3
    s_cbranch_scc1 Lkv_3
    s_sub_u32 s96, s96, 71680
    s_cselect_b32 s96, 0x40000000, s96
    s_sub_u32 m0, s41, 512
    s_mov_b32 exec_lo, 0
    buffer_load_dwordx4 v23, s[44:47], s96 offen lds
    s_mov_b32 exec_lo, -1
Lkv_3:
    s_barrier
    s_cmp_lg_u32 s36, 1
    s_cbranch_scc1 Lq_4
    ds_read_b64 v[112:113], v166 offset:2048
    ds_read_b64 v[114:115], v166 offset:4096
    ds_read_b64 v[116:117], v166 offset:6144
    ds_read_b64 v[118:119], v166 offset:8192
    ds_read_b64 v[120:121], v166 offset:10240
    ds_read_b64 v[122:123], v166 offset:12288
    s_waitcnt lgkmcnt(0)
Lq_4:
    s_waitcnt vmcnt(0)
    s_mov_b64 s[48:49], s[12:13]
    s_barrier
    s_cmp_lg_u32 s36, 2
    s_cbranch_scc1 Lq_5
    ds_read_b64 v[112:113], v166 offset:2048
    ds_read_b64 v[114:115], v166 offset:4096
    ds_read_b64 v[116:117], v166 offset:6144
    ds_read_b64 v[118:119], v166 offset:8192
    ds_read_b64 v[120:121], v166 offset:10240
    ds_read_b64 v[122:123], v166 offset:12288
    s_waitcnt lgkmcnt(0)
Lq_5:
    s_branch L_kvc
L_akv:
    v_mov_b32 v144, 0
    v_mov_b32 v145, 0
    v_mov_b32 v146, 0
    s_barrier
    s_cmp_lt_u32 s30, 4
    s_cbranch_scc1 L_akw
    v_mov_b32 v5, 160768
    s_cmp_lt_u32 s30, 8
    s_cbranch_scc1 L_ak1
    s_mov_b32 s100, 0
Lw_6:
    ds_read_b32 v4, v5 offset:104
    s_waitcnt lgkmcnt(0)
    v_readfirstlane_b32 s99, v4
    s_cmp_ge_u32 s99, 4
    s_cbranch_scc1 Lwd_7
    s_sleep 2
    s_add_u32 s100, s100, 1
    s_cmp_lt_u32 s100, 8388608
    s_cbranch_scc1 Lw_6
Lwd_7:
L_ak1:
    s_lshl2_add_u32 s96, s63, s40
    s_mul_i32 s96, s96, 20480
    s_lshl_b32 s97, s55, 7
    s_add_u32 s96, s96, s97
    s_lshl_b32 s97, s40, 11
    s_add_u32 s97, s97, s41
    s_add_u32 m0, s97, 8704
    s_add_u32 s98, s96, 9216
    s_waitcnt lgkmcnt(0)
    s_mov_b64 s[48:49], s[8:9]
    buffer_load_dwordx4 v22, s[48:51], s96 offen lds
    buffer_load_dwordx4 v23, s[48:51], s98 offen offset:1024 lds
    s_sub_u32 m0, m0, 8192
    s_mov_b64 s[44:45], s[6:7]
    buffer_load_dwordx4 v22, s[44:47], s96 offen lds
    buffer_load_dwordx4 v23, s[44:47], s98 offen offset:1024 lds
    global_load_dwordx2 v[14:15], v21, s[10:11]
    s_cmp_lg_u32 s40, 3
    s_cbranch_scc1 Lkv_8
    s_sub_u32 s96, s96, 71680
    s_cselect_b32 s96, 0x40000000, s96
    s_sub_u32 m0, s41, 512
    s_mov_b32 exec_lo, 0
    buffer_load_dwordx4 v23, s[44:47], s96 offen lds
    s_mov_b32 exec_lo, -1
Lkv_8:
    s_mov_b64 s[48:49], s[12:13]
    s_mov_b32 m0, s60
    s_sub_u32 s96, s61, 16
    s_bitcmp1_b32 s40, 0
    s_cselect_b32 s96, s96, 0x40000000
    buffer_load_dwordx4 v12, s[48:51], s61 offen lds
    buffer_load_dwordx4 v12, s[48:51], s61 offen offset:1024 lds
    s_sub_u32 m0, s60, 16
    s_mov_b64 exec, 1
    buffer_load_dwordx4 v12, s[48:51], s96 offen lds
    s_mov_b64 exec, -1
L_akw:
    s_mov_b64 s[48:49], s[12:13]
    s_waitcnt vmcnt(3)
    v_mov_b32 v4, 1
    s_mov_b64 exec, 1
    ds_add_u32 v3, v4 offset:36
    s_mov_b64 exec, -1
    s_mov_b32 s100, 0
Lw_9:
    ds_read_b32 v4, v3 offset:36
    s_waitcnt lgkmcnt(0)
    v_readfirstlane_b32 s99, v4
    s_cmp_ge_u32 s99, 4
    s_cbranch_scc1 Lwd_10
    s_add_u32 s100, s100, 1
    s_cmp_lt_u32 s100, 8388608
    s_cbranch_scc1 Lw_9
Lwd_10:
L_kvc:
    ds_read_b128 v[32:35], v9 offset:256
    ds_read_b128 v[24:27], v10 offset:0
    ds_read_b128 v[36:39], v8 offset:384
    ds_read_b128 v[28:31], v10 offset:128
    ds_read_b128 v[40:43], v8 offset:512
    ds_read_b128 v[44:47], v8 offset:640
    ds_read_b64 v[48:49], v13 offset:8448
    ds_read_b64 v[50:51], v13 offset:8576
    ds_read_b64 v[52:53], v13 offset:8704
    ds_read_b64 v[54:55], v13 offset:8832
    v_alignbit_b32 v14, v14, v14, v16
    v_alignbit_b32 v15, v15, v15, v16
    v_and_b32 v72, v14, v17
    v_and_b32 v73, v14, v18
    v_and_b32 v74, v14, v19
    v_and_b32 v75, v14, v20
    v_and_b32 v76, v15, v17
    v_and_b32 v77, v15, v18
    v_and_b32 v78, v15, v19
    v_and_b32 v79, v15, v20
    s_mov_b32 s44, s28
    s_and_b32 s45, s29, 0xffff
    s_mov_b32 s46, 16777216
    s_mov_b32 s47, 0x00020000
    s_mov_b32 vcc_lo, 0xaaaaaaaa
    s_mov_b32 vcc_hi, 0xaaaaaaaa
    s_movk_i32 s96, 8192
    s_waitcnt lgkmcnt(0)
    v_mfma_f32_16x16x32_bf16 v[56:59], v[72:75], v[32:35], 0
    v_mfma_f32_16x16x32_bf16 v[56:59], v[76:79], v[24:27], v[56:59]
    v_lshlrev_b32 v96, 16, v48
    v_and_b32 v97, 0xffff0000, v48
    v_lshlrev_b32 v98, 16, v49
    v_and_b32 v99, 0xffff0000, v49
    v_mfma_f32_16x16x32_bf16 v[60:63], v[72:75], v[36:39], 0
    v_mfma_f32_16x16x32_bf16 v[60:63], v[76:79], v[28:31], v[60:63]
    v_lshlrev_b32 v100, 16, v50
    v_and_b32 v101, 0xffff0000, v50
    v_lshlrev_b32 v102, 16, v51
    v_and_b32 v103, 0xffff0000, v51
    v_mfma_f32_16x16x32_bf16 v[64:67], v[72:75], v[40:43], 0
    v_mfma_f32_16x16x32_bf16 v[64:67], v[76:79], v[32:35], v[64:67]
    v_lshlrev_b32 v104, 16, v52
    v_and_b32 v105, 0xffff0000, v52
    v_lshlrev_b32 v106, 16, v53
    v_and_b32 v107, 0xffff0000, v53
    v_mfma_f32_16x16x32_bf16 v[68:71], v[72:75], v[44:47], 0
    v_mfma_f32_16x16x32_bf16 v[68:71], v[76:79], v[36:39], v[68:71]
    v_lshlrev_b32 v108, 16, v54
    v_and_b32 v109, 0xffff0000, v54
    v_lshlrev_b32 v110, 16, v55
    v_and_b32 v111, 0xffff0000, v55
    v_mul_f32 v96, v56, v96
    v_mul_f32 v97, v57, v97
    v_mul_f32 v98, v58, v98
    v_mul_f32 v99, v59, v99
    v_mul_f32 v100, v60, v100
    v_mul_f32 v101, v61, v101
    v_mul_f32 v102, v62, v102
    v_mul_f32 v103, v63, v103
    v_mul_f32 v104, v64, v104
    v_mul_f32 v105, v65, v105
    v_mul_f32 v106, v66, v106
    v_mul_f32 v107, v67, v107
    v_mul_f32 v108, v68, v108
    v_mul_f32 v109, v69, v109
    v_mul_f32 v110, v70, v110
    v_mul_f32 v111, v71, v111
    v_cvt_pk_bf16_f32 v80, v108, v104
    v_cvt_pk_bf16_f32 v81, v100, v96
    v_cvt_pk_bf16_f32 v82, v109, v105
    v_cvt_pk_bf16_f32 v83, v101, v97
    v_cvt_pk_bf16_f32 v84, v110, v106
    v_cvt_pk_bf16_f32 v85, v102, v98
    v_cvt_pk_bf16_f32 v86, v111, v107
    v_cvt_pk_bf16_f32 v87, v103, v99
    v_cndmask_b32_dpp v88, v80, v82, vcc quad_perm:[1,0,3,2] row_mask:0xf bank_mask:0xf
    v_cndmask_b32_dpp v89, v81, v83, vcc quad_perm:[1,0,3,2] row_mask:0xf bank_mask:0xf
    v_cndmask_b32_dpp v92, v84, v86, vcc quad_perm:[1,0,3,2] row_mask:0xf bank_mask:0xf
    v_cndmask_b32_dpp v93, v85, v87, vcc quad_perm:[1,0,3,2] row_mask:0xf bank_mask:0xf
    s_not_b64 vcc, vcc
    v_cndmask_b32_dpp v90, v82, v80, vcc quad_perm:[1,0,3,2] row_mask:0xf bank_mask:0xf
    v_cndmask_b32_dpp v91, v83, v81, vcc quad_perm:[1,0,3,2] row_mask:0xf bank_mask:0xf
    buffer_store_dwordx4 v[88:91], v11, s[44:47], 0 offen sc1
    v_cndmask_b32_dpp v94, v86, v84, vcc quad_perm:[1,0,3,2] row_mask:0xf bank_mask:0xf
    v_cndmask_b32_dpp v95, v87, v85, vcc quad_perm:[1,0,3,2] row_mask:0xf bank_mask:0xf
    buffer_store_dwordx4 v[92:95], v11, s[44:47], s96 offen sc1
    s_cmp_eq_u32 s3, 0
    s_cbranch_scc1 L_gk
    v_mov_b32 v4, 1
    s_mov_b64 exec, 1
    ds_add_u32 v3, v4 offset:40
    s_mov_b64 exec, -1
    s_branch L_cs
L_gk:
    s_setprio 0
    s_mov_b32 s52, s40
    s_barrier
    s_cmp_lg_u32 s36, 3
    s_cbranch_scc1 Lq_11
    ds_read_b64 v[112:113], v166 offset:2048
    ds_read_b64 v[114:115], v166 offset:4096
    ds_read_b64 v[116:117], v166 offset:6144
    ds_read_b64 v[118:119], v166 offset:8192
    ds_read_b64 v[120:121], v166 offset:10240
    ds_read_b64 v[122:123], v166 offset:12288
    s_waitcnt lgkmcnt(0)
Lq_11:
    s_barrier
    s_cmp_lg_u32 s36, 4
    s_cbranch_scc1 Lq_12
    ds_read_b64 v[112:113], v166 offset:2048
    ds_read_b64 v[114:115], v166 offset:4096
    ds_read_b64 v[116:117], v166 offset:6144
    ds_read_b64 v[118:119], v166 offset:8192
    ds_read_b64 v[120:121], v166 offset:10240
    ds_read_b64 v[122:123], v166 offset:12288
    s_waitcnt lgkmcnt(0)
Lq_12:
    s_waitcnt vmcnt(0)
    s_atomic_swap s31, s[28:29], s64
    s_barrier
    s_cmp_lg_u32 s36, 5
    s_cbranch_scc1 Lq_13
    ds_read_b64 v[112:113], v166 offset:2048
    ds_read_b64 v[114:115], v166 offset:4096
    ds_read_b64 v[116:117], v166 offset:6144
    ds_read_b64 v[118:119], v166 offset:8192
    ds_read_b64 v[120:121], v166 offset:10240
    ds_read_b64 v[122:123], v166 offset:12288
    s_waitcnt lgkmcnt(0)
Lq_13:
    s_barrier
    s_cmp_lg_u32 s36, 6
    s_cbranch_scc1 Lq_14
    ds_read_b64 v[112:113], v166 offset:2048
    ds_read_b64 v[114:115], v166 offset:4096
    ds_read_b64 v[116:117], v166 offset:6144
    ds_read_b64 v[118:119], v166 offset:8192
    ds_read_b64 v[120:121], v166 offset:10240
    ds_read_b64 v[122:123], v166 offset:12288
    s_waitcnt lgkmcnt(0)
Lq_14:
    s_lshl_b32 s92, s2, 7
    s_and_b32 s92, s92, 0x1f80
    s_load_dwordx2 s[86:87], s[28:29], s92 offset:8192
    s_cmp_lg_u32 s52, 0
    s_cbranch_scc1 Lud_16
Lup_15:
    s_load_dwordx16 s[64:79], s[56:57], 0 glc
    s_load_dwordx16 s[4:19], s[56:57], 64 glc
Lud_16:
    s_barrier
    s_cmp_lg_u32 s36, 7
    s_cbranch_scc1 Lq_17
    ds_read_b64 v[112:113], v166 offset:2048
    ds_read_b64 v[114:115], v166 offset:4096
    ds_read_b64 v[116:117], v166 offset:6144
    ds_read_b64 v[118:119], v166 offset:8192
    ds_read_b64 v[120:121], v166 offset:10240
    ds_read_b64 v[122:123], v166 offset:12288
    s_waitcnt lgkmcnt(0)
Lq_17:
    s_cmp_lg_u32 s52, 0
    s_cbranch_scc1 Lud_19
Lup_18:
    s_waitcnt lgkmcnt(0)
    s_xor_b64 s[64:65], s[64:65], s[58:59]
    s_xor_b64 s[4:5], s[4:5], s[58:59]
    s_or_b64 s[64:65], s[64:65], s[4:5]
    s_xor_b64 s[66:67], s[66:67], s[58:59]
    s_xor_b64 s[6:7], s[6:7], s[58:59]
    s_or_b64 s[64:65], s[64:65], s[66:67]
    s_or_b64 s[64:65], s[64:65], s[6:7]
    s_xor_b64 s[68:69], s[68:69], s[58:59]
    s_xor_b64 s[8:9], s[8:9], s[58:59]
    s_or_b64 s[64:65], s[64:65], s[68:69]
    s_or_b64 s[64:65], s[64:65], s[8:9]
    s_xor_b64 s[70:71], s[70:71], s[58:59]
    s_xor_b64 s[10:11], s[10:11], s[58:59]
    s_or_b64 s[64:65], s[64:65], s[70:71]
    s_or_b64 s[64:65], s[64:65], s[10:11]
    s_xor_b64 s[72:73], s[72:73], s[58:59]
    s_xor_b64 s[12:13], s[12:13], s[58:59]
    s_or_b64 s[64:65], s[64:65], s[72:73]
    s_or_b64 s[64:65], s[64:65], s[12:13]
    s_xor_b64 s[74:75], s[74:75], s[58:59]
    s_xor_b64 s[14:15], s[14:15], s[58:59]
    s_or_b64 s[64:65], s[64:65], s[74:75]
    s_or_b64 s[64:65], s[64:65], s[14:15]
    s_xor_b64 s[76:77], s[76:77], s[58:59]
    s_xor_b64 s[16:17], s[16:17], s[58:59]
    s_or_b64 s[64:65], s[64:65], s[76:77]
    s_or_b64 s[64:65], s[64:65], s[16:17]
    s_xor_b64 s[78:79], s[78:79], s[58:59]
    s_xor_b64 s[18:19], s[18:19], s[58:59]
    s_or_b64 s[64:65], s[64:65], s[78:79]
    s_or_b64 s[64:65], s[64:65], s[18:19]
    s_cbranch_scc1 Lud_19
    s_mov_b32 s52, -1
Lud_19:
    s_cmp_lg_u32 s52, 0
    s_cbranch_scc1 Lud_21
Lup_20:
    s_load_dwordx16 s[64:79], s[56:57], 0 glc
    s_load_dwordx16 s[4:19], s[56:57], 64 glc
Lud_21:
    s_barrier
    s_cmp_lg_u32 s36, 8
    s_cbranch_scc1 Lq_22
    ds_read_b64 v[112:113], v166 offset:2048
    ds_read_b64 v[114:115], v166 offset:4096
    ds_read_b64 v[116:117], v166 offset:6144
    ds_read_b64 v[118:119], v166 offset:8192
    ds_read_b64 v[120:121], v166 offset:10240
    ds_read_b64 v[122:123], v166 offset:12288
    s_waitcnt lgkmcnt(0)
Lq_22:
    s_mov_b32 s100, 0
Lpo_23:
    s_waitcnt lgkmcnt(0)
    s_cmp_eq_u32 s86, s31
    s_cbranch_scc1 Lpd_24
    s_sleep 16
    s_load_dwordx2 s[86:87], s[28:29], s92 offset:8192 glc
    s_add_u32 s100, s100, 1
    s_cmp_lt_u32 s100, 1048576
    s_cbranch_scc1 Lpo_23
    s_waitcnt lgkmcnt(0)
Lpd_24:
    s_and_b32 s92, s87, 0x2000
    s_mov_b32 m0, s60
    s_sub_u32 s96, s61, 16
    s_bitcmp1_b32 s40, 0
    s_cselect_b32 s96, s96, 0x40000000
    buffer_load_dwordx4 v12, s[48:51], s61 offen lds
    buffer_load_dwordx4 v12, s[48:51], s61 offen offset:1024 lds
    s_sub_u32 m0, s60, 16
    s_mov_b64 exec, 1
    buffer_load_dwordx4 v12, s[48:51], s96 offen lds
    s_mov_b64 exec, -1
    s_cmp_lg_u32 s52, 0
    s_cbranch_scc1 Lud_26
Lup_25:
    s_waitcnt lgkmcnt(0)
    s_xor_b64 s[64:65], s[64:65], s[58:59]
    s_xor_b64 s[4:5], s[4:5], s[58:59]
    s_or_b64 s[64:65], s[64:65], s[4:5]
    s_xor_b64 s[66:67], s[66:67], s[58:59]
    s_xor_b64 s[6:7], s[6:7], s[58:59]
    s_or_b64 s[64:65], s[64:65], s[66:67]
    s_or_b64 s[64:65], s[64:65], s[6:7]
    s_xor_b64 s[68:69], s[68:69], s[58:59]
    s_xor_b64 s[8:9], s[8:9], s[58:59]
    s_or_b64 s[64:65], s[64:65], s[68:69]
    s_or_b64 s[64:65], s[64:65], s[8:9]
    s_xor_b64 s[70:71], s[70:71], s[58:59]
    s_xor_b64 s[10:11], s[10:11], s[58:59]
    s_or_b64 s[64:65], s[64:65], s[70:71]
    s_or_b64 s[64:65], s[64:65], s[10:11]
    s_xor_b64 s[72:73], s[72:73], s[58:59]
    s_xor_b64 s[12:13], s[12:13], s[58:59]
    s_or_b64 s[64:65], s[64:65], s[72:73]
    s_or_b64 s[64:65], s[64:65], s[12:13]
    s_xor_b64 s[74:75], s[74:75], s[58:59]
    s_xor_b64 s[14:15], s[14:15], s[58:59]
    s_or_b64 s[64:65], s[64:65], s[74:75]
    s_or_b64 s[64:65], s[64:65], s[14:15]
    s_xor_b64 s[76:77], s[76:77], s[58:59]
    s_xor_b64 s[16:17], s[16:17], s[58:59]
    s_or_b64 s[64:65], s[64:65], s[76:77]
    s_or_b64 s[64:65], s[64:65], s[16:17]
    s_xor_b64 s[78:79], s[78:79], s[58:59]
    s_xor_b64 s[18:19], s[18:19], s[58:59]
    s_or_b64 s[64:65], s[64:65], s[78:79]
    s_or_b64 s[64:65], s[64:65], s[18:19]
    s_cbranch_scc1 Lud_26
    s_mov_b32 s52, -1
Lud_26:
    s_cmp_lg_u32 s52, -1
    s_cbranch_scc1 Lui_27
    s_add_u32 m0, s41, 33536
    s_lshl_b32 s96, s43, 13
    s_add_u32 s96, s96, 2097152
    buffer_load_dwordx4 v12, s[44:47], s96 offen offset:0 sc1 lds
    buffer_load_dwordx4 v12, s[44:47], s96 offen offset:1024 sc1 lds
    buffer_load_dwordx4 v12, s[44:47], s96 offen offset:2048 sc1 lds
    buffer_load_dwordx4 v12, s[44:47], s96 offen offset:3072 sc1 lds
    s_add_u32 m0, m0, 4096
    s_add_u32 s96, s96, 4096
    buffer_load_dwordx4 v12, s[44:47], s96 offen offset:0 sc1 lds
    buffer_load_dwordx4 v12, s[44:47], s96 offen offset:1024 sc1 lds
    buffer_load_dwordx4 v12, s[44:47], s96 offen offset:2048 sc1 lds
    buffer_load_dwordx4 v12, s[44:47], s96 offen offset:3072 sc1 lds
    s_mov_b32 s52, 9
Lui_27:
    s_barrier
    s_cmp_lg_u32 s36, 9
    s_cbranch_scc1 Lq_28
    ds_read_b64 v[112:113], v166 offset:2048
    ds_read_b64 v[114:115], v166 offset:4096
    ds_read_b64 v[116:117], v166 offset:6144
    ds_read_b64 v[118:119], v166 offset:8192
    ds_read_b64 v[120:121], v166 offset:10240
    ds_read_b64 v[122:123], v166 offset:12288
    s_waitcnt lgkmcnt(0)
Lq_28:
    s_setprio 1
    v_mov_b32 v8, v112
    v_mov_b32 v9, v113
    v_mov_b32 v10, v114
    v_mov_b32 v11, v115
    v_mov_b32 v14, v116
    v_mov_b32 v15, v117
    v_mov_b32 v160, v118
    v_mov_b32 v161, v119
    v_mov_b32 v162, v120
    v_mov_b32 v163, v121
    v_mov_b32 v164, v122
    v_mov_b32 v165, v123
    s_waitcnt vmcnt(0)
    s_cmp_lg_u32 s52, 9
    s_cbranch_scc1 L_nul
    v_mov_b32 v4, 1
    ds_write_b32 v3, v4 offset:0
    s_mov_b32 s52, 1
L_nul:
    v_subrev_u32 v4, 4, v156
    ds_read_b32 v21, v4 offset:0
    ds_read_b128 v[22:25], v156 offset:0
    ds_read_b32 v29, v4 offset:1024
    ds_read_b128 v[30:33], v156 offset:1024
    s_waitcnt lgkmcnt(0)
    s_mov_b64 exec, 1
    v_lshlrev_b32 v26, 16, v22
    v_and_b32 v27, 0xffff0000, v22
    v_add_f32 v26, s53, v26
    v_cvt_pk_bf16_f32 v22, v26, v27
    ds_write_b32 v156, v22
    s_mov_b64 exec, -1
    v_alignbit_b32 v40, v22, v21, 16
    v_alignbit_b32 v41, v23, v22, 16
    v_alignbit_b32 v42, v24, v23, 16
    v_alignbit_b32 v43, v25, v24, 16
    ds_write_b128 v156, v[40:43] offset:4160
    v_alignbit_b32 v44, v30, v29, 16
    v_alignbit_b32 v45, v31, v30, 16
    v_alignbit_b32 v46, v32, v31, 16
    v_alignbit_b32 v47, v33, v32, 16
    ds_write_b128 v156, v[44:47] offset:5184
    s_waitcnt lgkmcnt(0)
    s_setprio 1
    s_barrier
    ds_read_b32 v5, v3 offset:0
    ds_read2_b32 v[48:49], v148 offset0:0 offset1:1
    ds_read2_b32 v[50:51], v148 offset0:2 offset1:3
    ds_read2_b32 v[52:53], v148 offset0:128 offset1:129
    ds_read2_b32 v[54:55], v148 offset0:130 offset1:131
    ds_read2_b32 v[56:57], v149 offset0:0 offset1:1
    ds_read2_b32 v[58:59], v149 offset0:2 offset1:3
    ds_read2_b32 v[60:61], v149 offset0:128 offset1:129
    ds_read2_b32 v[62:63], v149 offset0:130 offset1:131
    ds_read2_b32 v[64:65], v150 offset0:0 offset1:1
    ds_read2_b32 v[66:67], v150 offset0:2 offset1:3
    ds_read2_b32 v[68:69], v150 offset0:128 offset1:129
    ds_read2_b32 v[70:71], v150 offset0:130 offset1:131
    s_waitcnt lgkmcnt(6)
    ds_read2_b32 v[72:73], v151 offset0:0 offset1:1
    ds_read2_b32 v[74:75], v151 offset0:2 offset1:3
    ds_read2_b32 v[76:77], v151 offset0:128 offset1:129
    ds_read2_b32 v[78:79], v151 offset0:130 offset1:131
    v_readfirstlane_b32 s81, v5
    s_waitcnt lgkmcnt(6)
    ds_read_b128 v[108:111], v152 offset:0
    ds_read_b128 v[104:107], v152 offset:1024
    ds_read_b128 v[100:103], v152 offset:2048
    ds_read_b128 v[96:99], v152 offset:3072
    ds_read_b128 v[92:95], v152 offset:4096
    ds_read_b128 v[88:91], v152 offset:5120
    ds_read_b128 v[84:87], v152 offset:6144
    ds_read_b128 v[80:83], v152 offset:7168
    s_cmp_lg_u32 s81, 0
    s_cbranch_scc1 L_conv2
L_upoll:
    s_cmp_lg_u32 s52, 0
    s_cbranch_scc1 Lud_30
    s_mov_b32 s100, 0
Lup_29:
    s_load_dwordx16 s[64:79], s[56:57], 0 glc
    s_load_dwordx16 s[4:19], s[56:57], 64 glc
    s_waitcnt lgkmcnt(0)
    s_xor_b64 s[64:65], s[64:65], s[58:59]
    s_xor_b64 s[4:5], s[4:5], s[58:59]
    s_or_b64 s[64:65], s[64:65], s[4:5]
    s_xor_b64 s[66:67], s[66:67], s[58:59]
    s_xor_b64 s[6:7], s[6:7], s[58:59]
    s_or_b64 s[64:65], s[64:65], s[66:67]
    s_or_b64 s[64:65], s[64:65], s[6:7]
    s_xor_b64 s[68:69], s[68:69], s[58:59]
    s_xor_b64 s[8:9], s[8:9], s[58:59]
    s_or_b64 s[64:65], s[64:65], s[68:69]
    s_or_b64 s[64:65], s[64:65], s[8:9]
    s_xor_b64 s[70:71], s[70:71], s[58:59]
    s_xor_b64 s[10:11], s[10:11], s[58:59]
    s_or_b64 s[64:65], s[64:65], s[70:71]
    s_or_b64 s[64:65], s[64:65], s[10:11]
    s_xor_b64 s[72:73], s[72:73], s[58:59]
    s_xor_b64 s[12:13], s[12:13], s[58:59]
    s_or_b64 s[64:65], s[64:65], s[72:73]
    s_or_b64 s[64:65], s[64:65], s[12:13]
    s_xor_b64 s[74:75], s[74:75], s[58:59]
    s_xor_b64 s[14:15], s[14:15], s[58:59]
    s_or_b64 s[64:65], s[64:65], s[74:75]
    s_or_b64 s[64:65], s[64:65], s[14:15]
    s_xor_b64 s[76:77], s[76:77], s[58:59]
    s_xor_b64 s[16:17], s[16:17], s[58:59]
    s_or_b64 s[64:65], s[64:65], s[76:77]
    s_or_b64 s[64:65], s[64:65], s[16:17]
    s_xor_b64 s[78:79], s[78:79], s[58:59]
    s_xor_b64 s[18:19], s[18:19], s[58:59]
    s_or_b64 s[64:65], s[64:65], s[78:79]
    s_or_b64 s[64:65], s[64:65], s[18:19]
    s_cbranch_scc0 Lug_31
    s_add_u32 s100, s100, 1
    s_cmp_lt_u32 s100, 1048576
    s_cbranch_scc1 Lup_29
Lug_31:
    s_mov_b32 s52, -1
Lud_30:
    s_cmp_lg_u32 s52, -1
    s_cbranch_scc1 Lui_32
    s_add_u32 m0, s41, 33536
    s_lshl_b32 s96, s43, 13
    s_add_u32 s96, s96, 2097152
    buffer_load_dwordx4 v12, s[44:47], s96 offen offset:0 sc1 lds
    buffer_load_dwordx4 v12, s[44:47], s96 offen offset:1024 sc1 lds
    buffer_load_dwordx4 v12, s[44:47], s96 offen offset:2048 sc1 lds
    buffer_load_dwordx4 v12, s[44:47], s96 offen offset:3072 sc1 lds
    s_add_u32 m0, m0, 4096
    s_add_u32 s96, s96, 4096
    buffer_load_dwordx4 v12, s[44:47], s96 offen offset:0 sc1 lds
    buffer_load_dwordx4 v12, s[44:47], s96 offen offset:1024 sc1 lds
    buffer_load_dwordx4 v12, s[44:47], s96 offen offset:2048 sc1 lds
    buffer_load_dwordx4 v12, s[44:47], s96 offen offset:3072 sc1 lds
    s_mov_b32 s52, 9
Lui_32:
    s_cmp_lg_u32 s52, 9
    s_cbranch_scc1 L_uwait
    s_waitcnt vmcnt(0)
    v_mov_b32 v4, 1
    ds_write_b32 v3, v4 offset:0
L_uwait:
    s_mov_b32 s100, 0
Lw_33:
    ds_read_b32 v4, v3 offset:0
    s_waitcnt lgkmcnt(0)
    v_readfirstlane_b32 s99, v4
    s_cmp_ge_u32 s99, 1
    s_cbranch_scc1 Lwd_34
    s_sleep 1
    s_add_u32 s100, s100, 1
    s_cmp_lt_u32 s100, 8388608
    s_cbranch_scc1 Lw_33
Lwd_34:
    s_cmp_eq_u32 s3, 0
    s_cbranch_scc1 L_conv
    s_branch L_touch
L_asig:
    s_waitcnt vmcnt(2)
    v_subrev_u32 v4, 4, v156
    ds_read_b32 v21, v4 offset:0
    ds_read_b128 v[22:25], v156 offset:0
    ds_read_b32 v29, v4 offset:1024
    ds_read_b128 v[30:33], v156 offset:1024
    s_waitcnt lgkmcnt(0)
    s_mov_b64 exec, 1
    v_lshlrev_b32 v26, 16, v22
    v_and_b32 v27, 0xffff0000, v22
    v_add_f32 v26, s53, v26
    v_cvt_pk_bf16_f32 v22, v26, v27
    ds_write_b32 v156, v22
    s_mov_b64 exec, -1
    v_alignbit_b32 v40, v22, v21, 16
    v_alignbit_b32 v41, v23, v22, 16
    v_alignbit_b32 v42, v24, v23, 16
    v_alignbit_b32 v43, v25, v24, 16
    ds_write_b128 v156, v[40:43] offset:4160
    v_alignbit_b32 v44, v30, v29, 16
    v_alignbit_b32 v45, v31, v30, 16
    v_alignbit_b32 v46, v32, v31, 16
    v_alignbit_b32 v47, v33, v32, 16
    ds_write_b128 v156, v[44:47] offset:5184
    s_waitcnt lgkmcnt(0)
    v_mov_b32 v4, 1
    s_mov_b64 exec, 1
    ds_add_u32 v3, v4 offset:32
    s_mov_b64 exec, -1
    v_lshl_add_u32 v6, v0, 7, s64
    v_mov_b32 v5, s31
    s_cmp_ge_u32 s55, 3
    s_cselect_b32 s97, 1, 0xff
    s_waitcnt vmcnt(0)
    s_mov_b32 exec_hi, 0
    s_mov_b32 exec_lo, s97
    global_atomic_swap v6, v5, s[28:29] sc1
    s_mov_b64 exec, -1
    s_mov_b32 s100, 0
Lw_35:
    ds_read_b32 v4, v3 offset:32
    s_waitcnt lgkmcnt(0)
    v_readfirstlane_b32 s99, v4
    s_cmp_ge_u32 s99, 4
    s_cbranch_scc1 Lwd_36
    s_sleep 1
    s_add_u32 s100, s100, 1
    s_cmp_lt_u32 s100, 8388608
    s_cbranch_scc1 Lw_35
Lwd_36:
    ds_read2_b32 v[48:49], v148 offset0:0 offset1:1
    ds_read2_b32 v[50:51], v148 offset0:2 offset1:3
    ds_read2_b32 v[52:53], v148 offset0:128 offset1:129
    ds_read2_b32 v[54:55], v148 offset0:130 offset1:131
    ds_read2_b32 v[56:57], v149 offset0:0 offset1:1
    ds_read2_b32 v[58:59], v149 offset0:2 offset1:3
    ds_read2_b32 v[60:61], v149 offset0:128 offset1:129
    ds_read2_b32 v[62:63], v149 offset0:130 offset1:131
    ds_read2_b32 v[64:65], v150 offset0:0 offset1:1
    ds_read2_b32 v[66:67], v150 offset0:2 offset1:3
    ds_read2_b32 v[68:69], v150 offset0:128 offset1:129
    ds_read2_b32 v[70:71], v150 offset0:130 offset1:131
    s_waitcnt lgkmcnt(6)
    ds_read2_b32 v[72:73], v151 offset0:0 offset1:1
    ds_read2_b32 v[74:75], v151 offset0:2 offset1:3
    ds_read2_b32 v[76:77], v151 offset0:128 offset1:129
    ds_read2_b32 v[78:79], v151 offset0:130 offset1:131
    s_mov_b32 s52, s40
    s_branch L_upoll
L_touch:
    s_cmp_lg_u32 s55, 1
    s_cbranch_scc1 L_conv
    s_lshl2_add_u32 s96, s63, s40
    s_mul_i32 s96, s96, 14336
    s_add_u32 s96, s96, 786432
    v_lshlrev_b32 v4, 7, v0
    s_add_u32 s97, s96, 8192
    buffer_load_dword v160, v4, s[48:51], s96 offen
    s_mov_b32 exec_hi, 0xffff
    buffer_load_dword v160, v4, s[48:51], s97 offen
    s_mov_b32 exec_hi, -1
L_conv:
    s_setprio 1
    ds_read_b128 v[108:111], v152 offset:0
    ds_read_b128 v[104:107], v152 offset:1024
    ds_read_b128 v[100:103], v152 offset:2048
    ds_read_b128 v[96:99], v152 offset:3072
    ds_read_b128 v[92:95], v152 offset:4096
    ds_read_b128 v[88:91], v152 offset:5120
    ds_read_b128 v[84:87], v152 offset:6144
    ds_read_b128 v[80:83], v152 offset:7168
L_conv2:

    s_waitcnt lgkmcnt(7)
    v_mfma_f32_16x16x32_bf16 v[44:47], v[48:51], v[108:111], 0
    s_waitcnt lgkmcnt(6)
    v_mfma_f32_16x16x32_bf16 v[40:43], v[48:51], v[104:107], 0
    ds_read_b128 v[140:143], v153 offset:0
    s_waitcnt lgkmcnt(6)
    v_mfma_f32_16x16x32_bf16 v[36:39], v[48:51], v[100:103], 0
    s_waitcnt lgkmcnt(5)
    v_mfma_f32_16x16x32_bf16 v[32:35], v[48:51], v[96:99], 0
    ds_read_b128 v[136:139], v153 offset:1024
    s_waitcnt lgkmcnt(5)
    v_mfma_f32_16x16x32_bf16 v[28:31], v[48:51], v[92:95], 0
    s_waitcnt lgkmcnt(4)
    v_mfma_f32_16x16x32_bf16 v[24:27], v[48:51], v[88:91], 0
    ds_read_b128 v[132:135], v153 offset:2048
    s_waitcnt lgkmcnt(4)
    v_mfma_f32_16x16x32_bf16 v[20:23], v[48:51], v[84:87], 0
    s_waitcnt lgkmcnt(3)
    v_mfma_f32_16x16x32_bf16 v[16:19], v[48:51], v[80:83], 0
    ds_read_b128 v[128:131], v153 offset:3072
    v_mfma_f32_16x16x32_bf16 v[44:47], v[52:55], v[104:107], v[44:47]
    v_mfma_f32_16x16x32_bf16 v[40:43], v[52:55], v[100:103], v[40:43]
    ds_read2_b32 v[48:49], v148 offset0:16 offset1:17
    v_mfma_f32_16x16x32_bf16 v[36:39], v[52:55], v[96:99], v[36:39]
    v_mfma_f32_16x16x32_bf16 v[32:35], v[52:55], v[92:95], v[32:35]
    ds_read2_b32 v[50:51], v148 offset0:18 offset1:19
    v_mfma_f32_16x16x32_bf16 v[28:31], v[52:55], v[88:91], v[28:31]
    v_mfma_f32_16x16x32_bf16 v[24:27], v[52:55], v[84:87], v[24:27]
    ds_read_b128 v[124:127], v153 offset:4096
    v_mfma_f32_16x16x32_bf16 v[20:23], v[52:55], v[80:83], v[20:23]
    v_mfma_f32_16x16x32_bf16 v[44:47], v[56:59], v[100:103], v[44:47]
    v_mfma_f32_16x16x32_bf16 v[40:43], v[56:59], v[96:99], v[40:43]
    ds_read2_b32 v[52:53], v148 offset0:144 offset1:145
    v_mfma_f32_16x16x32_bf16 v[36:39], v[56:59], v[92:95], v[36:39]
    v_mfma_f32_16x16x32_bf16 v[32:35], v[56:59], v[88:91], v[32:35]
    ds_read2_b32 v[54:55], v148 offset0:146 offset1:147
    v_mfma_f32_16x16x32_bf16 v[28:31], v[56:59], v[84:87], v[28:31]
    v_mfma_f32_16x16x32_bf16 v[24:27], v[56:59], v[80:83], v[24:27]
    ds_read_b128 v[120:123], v153 offset:5120
    v_mfma_f32_16x16x32_bf16 v[44:47], v[60:63], v[96:99], v[44:47]
    v_mfma_f32_16x16x32_bf16 v[40:43], v[60:63], v[92:95], v[40:43]
    ds_read2_b32 v[56:57], v149 offset0:16 offset1:17
    v_mfma_f32_16x16x32_bf16 v[36:39], v[60:63], v[88:91], v[36:39]
    v_mfma_f32_16x16x32_bf16 v[32:35], v[60:63], v[84:87], v[32:35]
    ds_read2_b32 v[58:59], v149 offset0:18 offset1:19
    v_mfma_f32_16x16x32_bf16 v[28:31], v[60:63], v[80:83], v[28:31]
    v_mfma_f32_16x16x32_bf16 v[44:47], v[64:67], v[92:95], v[44:47]
    ds_read2_b32 v[60:61], v149 offset0:144 offset1:145
    v_mfma_f32_16x16x32_bf16 v[40:43], v[64:67], v[88:91], v[40:43]
    ds_read2_b32 v[62:63], v149 offset0:146 offset1:147
    v_mfma_f32_16x16x32_bf16 v[36:39], v[64:67], v[84:87], v[36:39]
    ds_read_b128 v[116:119], v153 offset:6144
    v_mfma_f32_16x16x32_bf16 v[32:35], v[64:67], v[80:83], v[32:35]
    s_waitcnt lgkmcnt(13)
    ds_read_b128 v[112:115], v153 offset:7168
    v_mfma_f32_16x16x32_bf16 v[44:47], v[68:71], v[88:91], v[44:47]
    ds_read2_b32 v[64:65], v150 offset0:16 offset1:17
    v_mfma_f32_16x16x32_bf16 v[40:43], v[68:71], v[84:87], v[40:43]
    s_waitcnt lgkmcnt(13)
    ds_read2_b32 v[66:67], v150 offset0:18 offset1:19
    v_mfma_f32_16x16x32_bf16 v[36:39], v[68:71], v[80:83], v[36:39]
    v_mfma_f32_16x16x32_bf16 v[44:47], v[72:75], v[84:87], v[44:47]
    ds_read2_b32 v[68:69], v150 offset0:144 offset1:145
    v_mfma_f32_16x16x32_bf16 v[40:43], v[72:75], v[80:83], v[40:43]
    s_waitcnt lgkmcnt(13)
    ds_read2_b32 v[70:71], v150 offset0:146 offset1:147
    v_mfma_f32_16x16x32_bf16 v[44:47], v[76:79], v[80:83], v[44:47]
    ds_read2_b32 v[72:73], v151 offset0:16 offset1:17
    s_waitcnt lgkmcnt(13)
    ds_read2_b32 v[76:77], v151 offset0:144 offset1:145
    ds_read2_b32 v[78:79], v151 offset0:146 offset1:147
    s_waitcnt lgkmcnt(13)
    ds_read2_b32 v[74:75], v151 offset0:18 offset1:19
    v_mfma_f32_16x16x32_bf16 v[44:47], v[48:51], v[140:143], v[44:47]
    v_mfma_f32_16x16x32_bf16 v[40:43], v[48:51], v[136:139], v[40:43]
    ds_read_b128 v[108:111], v154 offset:256
    v_mfma_f32_16x16x32_bf16 v[36:39], v[48:51], v[132:135], v[36:39]
    v_mfma_f32_16x16x32_bf16 v[32:35], v[48:51], v[128:131], v[32:35]
    s_waitcnt lgkmcnt(13)
    ds_read_b128 v[104:107], v154 offset:1280
    v_mfma_f32_16x16x32_bf16 v[28:31], v[48:51], v[124:127], v[28:31]
    v_mfma_f32_16x16x32_bf16 v[24:27], v[48:51], v[120:123], v[24:27]
    ds_read_b128 v[100:103], v154 offset:2304
    s_waitcnt lgkmcnt(12)
    v_mfma_f32_16x16x32_bf16 v[20:23], v[48:51], v[116:119], v[20:23]
    s_waitcnt lgkmcnt(11)
    v_mfma_f32_16x16x32_bf16 v[16:19], v[48:51], v[112:115], v[16:19]
    ds_read_b128 v[96:99], v154 offset:3328
    v_mfma_f32_16x16x32_bf16 v[44:47], v[52:55], v[136:139], v[44:47]
    v_mfma_f32_16x16x32_bf16 v[40:43], v[52:55], v[132:135], v[40:43]
    ds_read2_b32 v[48:49], v148 offset0:32 offset1:33
    v_mfma_f32_16x16x32_bf16 v[36:39], v[52:55], v[128:131], v[36:39]
    v_mfma_f32_16x16x32_bf16 v[32:35], v[52:55], v[124:127], v[32:35]
    ds_read2_b32 v[50:51], v148 offset0:34 offset1:35
    v_mfma_f32_16x16x32_bf16 v[28:31], v[52:55], v[120:123], v[28:31]
    v_mfma_f32_16x16x32_bf16 v[24:27], v[52:55], v[116:119], v[24:27]
    ds_read_b128 v[92:95], v154 offset:4352
    v_mfma_f32_16x16x32_bf16 v[20:23], v[52:55], v[112:115], v[20:23]
    v_mfma_f32_16x16x32_bf16 v[44:47], v[56:59], v[132:135], v[44:47]
    v_mfma_f32_16x16x32_bf16 v[40:43], v[56:59], v[128:131], v[40:43]
    s_waitcnt lgkmcnt(13)
    ds_read2_b32 v[52:53], v148 offset0:160 offset1:161
    v_mfma_f32_16x16x32_bf16 v[36:39], v[56:59], v[124:127], v[36:39]
    v_mfma_f32_16x16x32_bf16 v[32:35], v[56:59], v[120:123], v[32:35]
    ds_read2_b32 v[54:55], v148 offset0:162 offset1:163
    v_mfma_f32_16x16x32_bf16 v[28:31], v[56:59], v[116:119], v[28:31]
    v_mfma_f32_16x16x32_bf16 v[24:27], v[56:59], v[112:115], v[24:27]
    s_waitcnt lgkmcnt(13)
    ds_read_b128 v[88:91], v154 offset:5376
    v_mfma_f32_16x16x32_bf16 v[44:47], v[60:63], v[128:131], v[44:47]
    v_mfma_f32_16x16x32_bf16 v[40:43], v[60:63], v[124:127], v[40:43]
    ds_read2_b32 v[56:57], v149 offset0:32 offset1:33
    v_mfma_f32_16x16x32_bf16 v[36:39], v[60:63], v[120:123], v[36:39]
    v_mfma_f32_16x16x32_bf16 v[32:35], v[60:63], v[116:119], v[32:35]
    s_waitcnt lgkmcnt(13)
    ds_read2_b32 v[58:59], v149 offset0:34 offset1:35
    v_mfma_f32_16x16x32_bf16 v[28:31], v[60:63], v[112:115], v[28:31]
    v_mfma_f32_16x16x32_bf16 v[44:47], v[64:67], v[124:127], v[44:47]
    ds_read2_b32 v[60:61], v149 offset0:160 offset1:161
    v_mfma_f32_16x16x32_bf16 v[40:43], v[64:67], v[120:123], v[40:43]
    s_waitcnt lgkmcnt(13)
    ds_read2_b32 v[62:63], v149 offset0:162 offset1:163
    v_mfma_f32_16x16x32_bf16 v[36:39], v[64:67], v[116:119], v[36:39]
    ds_read_b128 v[84:87], v154 offset:6400
    v_mfma_f32_16x16x32_bf16 v[32:35], v[64:67], v[112:115], v[32:35]
    s_waitcnt lgkmcnt(13)
    ds_read_b128 v[80:83], v154 offset:7424
    v_mfma_f32_16x16x32_bf16 v[44:47], v[68:71], v[120:123], v[44:47]
    ds_read2_b32 v[64:65], v150 offset0:32 offset1:33
    v_mfma_f32_16x16x32_bf16 v[40:43], v[68:71], v[116:119], v[40:43]
    s_waitcnt lgkmcnt(13)
    ds_read2_b32 v[66:67], v150 offset0:34 offset1:35
    v_mfma_f32_16x16x32_bf16 v[36:39], v[68:71], v[112:115], v[36:39]
    v_mfma_f32_16x16x32_bf16 v[44:47], v[72:75], v[116:119], v[44:47]
    ds_read2_b32 v[68:69], v150 offset0:160 offset1:161
    v_mfma_f32_16x16x32_bf16 v[40:43], v[72:75], v[112:115], v[40:43]
    s_waitcnt lgkmcnt(13)
    ds_read2_b32 v[70:71], v150 offset0:162 offset1:163
    v_mfma_f32_16x16x32_bf16 v[44:47], v[76:79], v[112:115], v[44:47]
    ds_read2_b32 v[72:73], v151 offset0:32 offset1:33
    s_waitcnt lgkmcnt(13)
    ds_read2_b32 v[76:77], v151 offset0:160 offset1:161
    ds_read2_b32 v[78:79], v151 offset0:162 offset1:163
    s_waitcnt lgkmcnt(13)
    ds_read2_b32 v[74:75], v151 offset0:34 offset1:35
    v_mfma_f32_16x16x32_bf16 v[44:47], v[48:51], v[108:111], v[44:47]
    v_mfma_f32_16x16x32_bf16 v[40:43], v[48:51], v[104:107], v[40:43]
    ds_read_b128 v[140:143], v155 offset:256
    v_mfma_f32_16x16x32_bf16 v[36:39], v[48:51], v[100:103], v[36:39]
    v_mfma_f32_16x16x32_bf16 v[32:35], v[48:51], v[96:99], v[32:35]
    s_waitcnt lgkmcnt(13)
    ds_read_b128 v[136:139], v155 offset:1280
    v_mfma_f32_16x16x32_bf16 v[28:31], v[48:51], v[92:95], v[28:31]
    v_mfma_f32_16x16x32_bf16 v[24:27], v[48:51], v[88:91], v[24:27]
    ds_read_b128 v[132:135], v155 offset:2304
    s_waitcnt lgkmcnt(12)
    v_mfma_f32_16x16x32_bf16 v[20:23], v[48:51], v[84:87], v[20:23]
    s_waitcnt lgkmcnt(11)
    v_mfma_f32_16x16x32_bf16 v[16:19], v[48:51], v[80:83], v[16:19]
    ds_read_b128 v[128:131], v155 offset:3328
    v_mfma_f32_16x16x32_bf16 v[44:47], v[52:55], v[104:107], v[44:47]
    v_mfma_f32_16x16x32_bf16 v[40:43], v[52:55], v[100:103], v[40:43]
    ds_read2_b32 v[48:49], v148 offset0:48 offset1:49
    v_mfma_f32_16x16x32_bf16 v[36:39], v[52:55], v[96:99], v[36:39]
    v_mfma_f32_16x16x32_bf16 v[32:35], v[52:55], v[92:95], v[32:35]
    ds_read2_b32 v[50:51], v148 offset0:50 offset1:51
    v_mfma_f32_16x16x32_bf16 v[28:31], v[52:55], v[88:91], v[28:31]
    v_mfma_f32_16x16x32_bf16 v[24:27], v[52:55], v[84:87], v[24:27]
    ds_read_b128 v[124:127], v155 offset:4352
    v_mfma_f32_16x16x32_bf16 v[20:23], v[52:55], v[80:83], v[20:23]
    v_mfma_f32_16x16x32_bf16 v[44:47], v[56:59], v[100:103], v[44:47]
    v_mfma_f32_16x16x32_bf16 v[40:43], v[56:59], v[96:99], v[40:43]
    s_waitcnt lgkmcnt(13)
    ds_read2_b32 v[52:53], v148 offset0:176 offset1:177
    v_mfma_f32_16x16x32_bf16 v[36:39], v[56:59], v[92:95], v[36:39]
    v_mfma_f32_16x16x32_bf16 v[32:35], v[56:59], v[88:91], v[32:35]
    ds_read2_b32 v[54:55], v148 offset0:178 offset1:179
    v_mfma_f32_16x16x32_bf16 v[28:31], v[56:59], v[84:87], v[28:31]
    v_mfma_f32_16x16x32_bf16 v[24:27], v[56:59], v[80:83], v[24:27]
    s_waitcnt lgkmcnt(13)
    ds_read_b128 v[120:123], v155 offset:5376
    s_lshl_b32 s96, s40, 2
    v_add_u32 v5, s96, v3
    v_mfma_f32_16x16x32_bf16 v[44:47], v[60:63], v[96:99], v[44:47]
    v_mfma_f32_16x16x32_bf16 v[40:43], v[60:63], v[92:95], v[40:43]
    ds_read2_b32 v[56:57], v149 offset0:48 offset1:49
    v_mfma_f32_16x16x32_bf16 v[36:39], v[60:63], v[88:91], v[36:39]
    v_mfma_f32_16x16x32_bf16 v[32:35], v[60:63], v[84:87], v[32:35]
    s_waitcnt lgkmcnt(13)
    ds_read2_b32 v[58:59], v149 offset0:50 offset1:51
    v_xor_b32 v6, 4, v5
    s_and_b32 s96, s34, 3
    v_mfma_f32_16x16x32_bf16 v[28:31], v[60:63], v[80:83], v[28:31]
    v_mfma_f32_16x16x32_bf16 v[44:47], v[64:67], v[92:95], v[44:47]
    ds_read2_b32 v[60:61], v149 offset0:176 offset1:177
    v_mfma_f32_16x16x32_bf16 v[40:43], v[64:67], v[88:91], v[40:43]
    s_waitcnt lgkmcnt(13)
    ds_read2_b32 v[62:63], v149 offset0:178 offset1:179
    v_mfma_f32_16x16x32_bf16 v[36:39], v[64:67], v[84:87], v[36:39]
    s_cselect_b32 s96, 4, 6
    s_cmp_eq_u32 s3, 0
    ds_read_b128 v[116:119], v155 offset:6400
    v_mfma_f32_16x16x32_bf16 v[32:35], v[64:67], v[80:83], v[32:35]
    s_waitcnt lgkmcnt(13)
    ds_read_b128 v[112:115], v155 offset:7424
    v_mfma_f32_16x16x32_bf16 v[44:47], v[68:71], v[88:91], v[44:47]
    ds_read2_b32 v[64:65], v150 offset0:48 offset1:49
    v_mfma_f32_16x16x32_bf16 v[40:43], v[68:71], v[84:87], v[40:43]
    s_cselect_b32 s81, s96, 0
    s_bitcmp1_b32 s40, 0
    s_waitcnt lgkmcnt(13)
    ds_read2_b32 v[66:67], v150 offset0:50 offset1:51
    v_mfma_f32_16x16x32_bf16 v[36:39], v[68:71], v[80:83], v[36:39]
    ds_read_b32 v4, v3 offset:64
    v_mfma_f32_16x16x32_bf16 v[44:47], v[72:75], v[84:87], v[44:47]
    s_waitcnt lgkmcnt(13)
    ds_read2_b32 v[68:69], v150 offset0:176 offset1:177
    v_mfma_f32_16x16x32_bf16 v[40:43], v[72:75], v[80:83], v[40:43]
    ds_read2_b32 v[70:71], v150 offset0:178 offset1:179
    v_mfma_f32_16x16x32_bf16 v[44:47], v[76:79], v[80:83], v[44:47]
    s_waitcnt lgkmcnt(13)
    ds_read2_b32 v[72:73], v151 offset0:48 offset1:49
    ds_read2_b32 v[76:77], v151 offset0:176 offset1:177
    s_waitcnt lgkmcnt(13)
    ds_read2_b32 v[78:79], v151 offset0:178 offset1:179
    ds_read2_b32 v[74:75], v151 offset0:50 offset1:51
    s_cbranch_scc1 L_mrg1

    s_waitcnt lgkmcnt(14)
    v_mfma_f32_16x16x32_bf16 v[36:39], v[48:51], v[132:135], v[36:39]
    v_mfma_f32_16x16x32_bf16 v[32:35], v[48:51], v[128:131], v[32:35]
    v_mfma_f32_16x16x32_bf16 v[28:31], v[48:51], v[124:127], v[28:31]
    v_mfma_f32_16x16x32_bf16 v[24:27], v[48:51], v[120:123], v[24:27]
    v_mfma_f32_16x16x32_bf16 v[36:39], v[52:55], v[128:131], v[36:39]
    v_mfma_f32_16x16x32_bf16 v[32:35], v[52:55], v[124:127], v[32:35]
    v_mfma_f32_16x16x32_bf16 v[28:31], v[52:55], v[120:123], v[28:31]
    s_waitcnt lgkmcnt(10)
    v_mfma_f32_16x16x32_bf16 v[24:27], v[52:55], v[116:119], v[24:27]
    v_mfma_f32_16x16x32_bf16 v[36:39], v[56:59], v[124:127], v[36:39]
    v_mfma_f32_16x16x32_bf16 v[32:35], v[56:59], v[120:123], v[32:35]
    v_mfma_f32_16x16x32_bf16 v[28:31], v[56:59], v[116:119], v[28:31]
    s_waitcnt lgkmcnt(9)
    v_mfma_f32_16x16x32_bf16 v[24:27], v[56:59], v[112:115], v[24:27]
    v_mfma_f32_16x16x32_bf16 v[36:39], v[60:63], v[120:123], v[36:39]
    v_mfma_f32_16x16x32_bf16 v[32:35], v[60:63], v[116:119], v[32:35]
    v_mfma_f32_16x16x32_bf16 v[28:31], v[60:63], v[112:115], v[28:31]
    s_waitcnt lgkmcnt(7)
    v_mfma_f32_16x16x32_bf16 v[36:39], v[64:67], v[116:119], v[36:39]
    v_mfma_f32_16x16x32_bf16 v[32:35], v[64:67], v[112:115], v[32:35]
    s_waitcnt lgkmcnt(4)
    v_mfma_f32_16x16x32_bf16 v[36:39], v[68:71], v[112:115], v[36:39]

    v_readfirstlane_b32 s99, v4
    s_cmp_lt_u32 s99, s81
    s_cbranch_scc1 L_mslow0
L_mgo0:
    v_mfma_f32_16x16x32_bf16 v[44:47], v[48:51], v[140:143], v[44:47]
    v_mfma_f32_16x16x32_bf16 v[40:43], v[48:51], v[136:139], v[40:43]
    v_mfma_f32_16x16x32_bf16 v[20:23], v[48:51], v[116:119], v[20:23]
    ds_write_b128 v158, v[24:27] offset:0
    v_mfma_f32_16x16x32_bf16 v[16:19], v[48:51], v[112:115], v[16:19]
    ds_write_b128 v158, v[28:31] offset:1024
    v_mfma_f32_16x16x32_bf16 v[44:47], v[52:55], v[136:139], v[44:47]
    ds_write_b128 v158, v[32:35] offset:2048
    v_mfma_f32_16x16x32_bf16 v[40:43], v[52:55], v[132:135], v[40:43]
    ds_write_b128 v158, v[36:39] offset:3072
    v_mfma_f32_16x16x32_bf16 v[20:23], v[52:55], v[112:115], v[20:23]
    ds_write_b32 v5, v5 offset:8
    v_mfma_f32_16x16x32_bf16 v[44:47], v[56:59], v[132:135], v[44:47]
    v_mfma_f32_16x16x32_bf16 v[40:43], v[56:59], v[128:131], v[40:43]
    v_mfma_f32_16x16x32_bf16 v[44:47], v[60:63], v[128:131], v[44:47]
    v_mfma_f32_16x16x32_bf16 v[40:43], v[60:63], v[124:127], v[40:43]
    v_mfma_f32_16x16x32_bf16 v[44:47], v[64:67], v[124:127], v[44:47]
    v_mfma_f32_16x16x32_bf16 v[40:43], v[64:67], v[120:123], v[40:43]
    v_mfma_f32_16x16x32_bf16 v[44:47], v[68:71], v[120:123], v[44:47]
    v_mfma_f32_16x16x32_bf16 v[40:43], v[68:71], v[116:119], v[40:43]
    s_waitcnt lgkmcnt(5)
    v_mfma_f32_16x16x32_bf16 v[44:47], v[72:75], v[116:119], v[44:47]
    v_mfma_f32_16x16x32_bf16 v[40:43], v[72:75], v[112:115], v[40:43]
    v_mfma_f32_16x16x32_bf16 v[44:47], v[76:79], v[112:115], v[44:47]
    s_setprio 3
    s_cmp_eq_u32 s3, 0
    s_cbranch_scc1 L_pk0
    s_lshl_b32 s92, s2, 7
    s_and_b32 s92, s92, 0x1f80
    s_load_dwordx2 s[86:87], s[28:29], s92 offset:8192
    s_mov_b32 s100, 0
Lpo_37:
    s_waitcnt lgkmcnt(0)
    s_cmp_eq_u32 s86, s31
    s_cbranch_scc1 Lpd_38
    s_sleep 16
    s_load_dwordx2 s[86:87], s[28:29], s92 offset:8192 glc
    s_add_u32 s100, s100, 1
    s_cmp_lt_u32 s100, 1048576
    s_cbranch_scc1 Lpo_37
    s_waitcnt lgkmcnt(0)
Lpd_38:
    s_and_b32 s92, s87, 0x2000
L_pk0:
    v_xor_b32 v157, s92, v157
    v_xor_b32 v7, 0x2000, v157
L_mb0:
    ds_read_b32 v4, v6 offset:8
    ds_read_b128 v[80:83], v159 offset:0
    ds_read_b128 v[84:87], v159 offset:1024
    ds_read_b128 v[88:91], v159 offset:2048
    ds_read_b128 v[92:95], v159 offset:3072
    s_waitcnt lgkmcnt(4)
    v_readfirstlane_b32 s99, v4
    s_cmp_eq_u32 s99, 0
    s_cbranch_scc1 L_mw0
    s_waitcnt lgkmcnt(2)
    v_add_f32 v16, v16, v80
    v_add_f32 v17, v17, v81
    v_add_f32 v18, v18, v82
    v_add_f32 v19, v19, v83
    v_add_f32 v20, v20, v84
    v_add_f32 v21, v21, v85
    v_add_f32 v22, v22, v86
    v_add_f32 v23, v23, v87
    v_cvt_pk_bf16_f32 v96, v16, v17
    v_cvt_pk_bf16_f32 v97, v18, v19
    v_cvt_pk_bf16_f32 v98, v20, v21
    v_cvt_pk_bf16_f32 v99, v22, v23
    s_nop 0
    v_permlane16_swap_b32 v96, v98
    v_permlane16_swap_b32 v97, v99
    buffer_store_dwordx4 v[96:99], v157, s[44:47], 0 offen offset:0 sc1
    s_waitcnt lgkmcnt(0)
    v_add_f32 v40, v40, v88
    v_add_f32 v41, v41, v89
    v_add_f32 v42, v42, v90
    v_add_f32 v43, v43, v91
    v_add_f32 v44, v44, v92
    v_add_f32 v45, v45, v93
    v_add_f32 v46, v46, v94
    v_add_f32 v47, v47, v95
    v_cvt_pk_bf16_f32 v100, v40, v41
    v_cvt_pk_bf16_f32 v101, v42, v43
    v_cvt_pk_bf16_f32 v102, v44, v45
    v_cvt_pk_bf16_f32 v103, v46, v47
    s_nop 0
    v_permlane16_swap_b32 v100, v102
    v_permlane16_swap_b32 v101, v103
    buffer_store_dwordx4 v[100:103], v7, s[44:47], 0 offen offset:3072 sc1
    s_branch L_mrgd
L_mw0:
    s_mov_b32 s100, 0
Lw_39:
    ds_read_b32 v4, v6 offset:8
    s_waitcnt lgkmcnt(0)
    v_readfirstlane_b32 s99, v4
    s_cmp_ge_u32 s99, 1
    s_cbranch_scc1 Lwd_40
    s_add_u32 s100, s100, 1
    s_cmp_lt_u32 s100, 8388608
    s_cbranch_scc1 Lw_39
Lwd_40:
    s_branch L_mb0
L_mslow0:
    s_mov_b32 s100, 0
Lw_41:
    ds_read_b32 v4, v3 offset:64
    s_waitcnt lgkmcnt(0)
    v_readfirstlane_b32 s99, v4
    s_cmp_ge_u32 s99, s81
    s_cbranch_scc1 Lwd_42
    s_add_u32 s100, s100, 1
    s_cmp_lt_u32 s100, 8388608
    s_cbranch_scc1 Lw_41
Lwd_42:
    s_branch L_mgo0
L_mrg1:

    s_waitcnt lgkmcnt(14)
    v_mfma_f32_16x16x32_bf16 v[44:47], v[48:51], v[140:143], v[44:47]
    v_mfma_f32_16x16x32_bf16 v[40:43], v[48:51], v[136:139], v[40:43]
    s_waitcnt lgkmcnt(10)
    v_mfma_f32_16x16x32_bf16 v[20:23], v[48:51], v[116:119], v[20:23]
    s_waitcnt lgkmcnt(9)
    v_mfma_f32_16x16x32_bf16 v[16:19], v[48:51], v[112:115], v[16:19]
    v_mfma_f32_16x16x32_bf16 v[44:47], v[52:55], v[136:139], v[44:47]
    v_mfma_f32_16x16x32_bf16 v[40:43], v[52:55], v[132:135], v[40:43]
    v_mfma_f32_16x16x32_bf16 v[20:23], v[52:55], v[112:115], v[20:23]
    v_mfma_f32_16x16x32_bf16 v[44:47], v[56:59], v[132:135], v[44:47]
    v_mfma_f32_16x16x32_bf16 v[40:43], v[56:59], v[128:131], v[40:43]
    v_mfma_f32_16x16x32_bf16 v[44:47], v[60:63], v[128:131], v[44:47]
    v_mfma_f32_16x16x32_bf16 v[40:43], v[60:63], v[124:127], v[40:43]
    s_waitcnt lgkmcnt(7)
    v_mfma_f32_16x16x32_bf16 v[44:47], v[64:67], v[124:127], v[44:47]
    v_mfma_f32_16x16x32_bf16 v[40:43], v[64:67], v[120:123], v[40:43]
    s_waitcnt lgkmcnt(4)
    v_mfma_f32_16x16x32_bf16 v[44:47], v[68:71], v[120:123], v[44:47]
    v_mfma_f32_16x16x32_bf16 v[40:43], v[68:71], v[116:119], v[40:43]
    s_waitcnt lgkmcnt(0)
    v_mfma_f32_16x16x32_bf16 v[44:47], v[72:75], v[116:119], v[44:47]
    v_mfma_f32_16x16x32_bf16 v[40:43], v[72:75], v[112:115], v[40:43]
    v_mfma_f32_16x16x32_bf16 v[44:47], v[76:79], v[112:115], v[44:47]

    v_readfirstlane_b32 s99, v4
    s_cmp_lt_u32 s99, s81
    s_cbranch_scc1 L_mslow1
L_mgo1:
    v_mfma_f32_16x16x32_bf16 v[36:39], v[48:51], v[132:135], v[36:39]
    v_mfma_f32_16x16x32_bf16 v[32:35], v[48:51], v[128:131], v[32:35]
    v_mfma_f32_16x16x32_bf16 v[28:31], v[48:51], v[124:127], v[28:31]
    ds_write_b128 v158, v[16:19] offset:0
    v_mfma_f32_16x16x32_bf16 v[24:27], v[48:51], v[120:123], v[24:27]
    ds_write_b128 v158, v[20:23] offset:1024
    v_mfma_f32_16x16x32_bf16 v[36:39], v[52:55], v[128:131], v[36:39]
    ds_write_b128 v158, v[40:43] offset:2048
    v_mfma_f32_16x16x32_bf16 v[32:35], v[52:55], v[124:127], v[32:35]
    ds_write_b128 v158, v[44:47] offset:3072
    v_mfma_f32_16x16x32_bf16 v[28:31], v[52:55], v[120:123], v[28:31]
    ds_write_b32 v5, v5 offset:8
    v_mfma_f32_16x16x32_bf16 v[24:27], v[52:55], v[116:119], v[24:27]
    v_mfma_f32_16x16x32_bf16 v[36:39], v[56:59], v[124:127], v[36:39]
    v_mfma_f32_16x16x32_bf16 v[32:35], v[56:59], v[120:123], v[32:35]
    v_mfma_f32_16x16x32_bf16 v[28:31], v[56:59], v[116:119], v[28:31]
    v_mfma_f32_16x16x32_bf16 v[24:27], v[56:59], v[112:115], v[24:27]
    v_mfma_f32_16x16x32_bf16 v[36:39], v[60:63], v[120:123], v[36:39]
    v_mfma_f32_16x16x32_bf16 v[32:35], v[60:63], v[116:119], v[32:35]
    v_mfma_f32_16x16x32_bf16 v[28:31], v[60:63], v[112:115], v[28:31]
    v_mfma_f32_16x16x32_bf16 v[36:39], v[64:67], v[116:119], v[36:39]
    v_mfma_f32_16x16x32_bf16 v[32:35], v[64:67], v[112:115], v[32:35]
    v_mfma_f32_16x16x32_bf16 v[36:39], v[68:71], v[112:115], v[36:39]
    s_setprio 3
    s_cmp_eq_u32 s3, 0
    s_cbranch_scc1 L_pk1
    s_lshl_b32 s92, s2, 7
    s_and_b32 s92, s92, 0x1f80
    s_load_dwordx2 s[86:87], s[28:29], s92 offset:8192
    s_mov_b32 s100, 0
Lpo_43:
    s_waitcnt lgkmcnt(0)
    s_cmp_eq_u32 s86, s31
    s_cbranch_scc1 Lpd_44
    s_sleep 16
    s_load_dwordx2 s[86:87], s[28:29], s92 offset:8192 glc
    s_add_u32 s100, s100, 1
    s_cmp_lt_u32 s100, 1048576
    s_cbranch_scc1 Lpo_43
    s_waitcnt lgkmcnt(0)
Lpd_44:
    s_and_b32 s92, s87, 0x2000
L_pk1:
    v_xor_b32 v157, s92, v157
    v_xor_b32 v7, 0x2000, v157
L_mb1:
    ds_read_b32 v4, v6 offset:8
    ds_read_b128 v[80:83], v159 offset:0
    ds_read_b128 v[84:87], v159 offset:1024
    ds_read_b128 v[88:91], v159 offset:2048
    ds_read_b128 v[92:95], v159 offset:3072
    s_waitcnt lgkmcnt(4)
    v_readfirstlane_b32 s99, v4
    s_cmp_eq_u32 s99, 0
    s_cbranch_scc1 L_mw1
    s_waitcnt lgkmcnt(2)
    v_add_f32 v24, v24, v80
    v_add_f32 v25, v25, v81
    v_add_f32 v26, v26, v82
    v_add_f32 v27, v27, v83
    v_add_f32 v28, v28, v84
    v_add_f32 v29, v29, v85
    v_add_f32 v30, v30, v86
    v_add_f32 v31, v31, v87
    v_cvt_pk_bf16_f32 v96, v24, v25
    v_cvt_pk_bf16_f32 v97, v26, v27
    v_cvt_pk_bf16_f32 v98, v28, v29
    v_cvt_pk_bf16_f32 v99, v30, v31
    s_nop 0
    v_permlane16_swap_b32 v96, v98
    v_permlane16_swap_b32 v97, v99
    buffer_store_dwordx4 v[96:99], v157, s[44:47], 0 offen offset:1024 sc1
    s_waitcnt lgkmcnt(0)
    v_add_f32 v32, v32, v88
    v_add_f32 v33, v33, v89
    v_add_f32 v34, v34, v90
    v_add_f32 v35, v35, v91
    v_add_f32 v36, v36, v92
    v_add_f32 v37, v37, v93
    v_add_f32 v38, v38, v94
    v_add_f32 v39, v39, v95
    v_cvt_pk_bf16_f32 v100, v32, v33
    v_cvt_pk_bf16_f32 v101, v34, v35
    v_cvt_pk_bf16_f32 v102, v36, v37
    v_cvt_pk_bf16_f32 v103, v38, v39
    s_nop 0
    v_permlane16_swap_b32 v100, v102
    v_permlane16_swap_b32 v101, v103
    buffer_store_dwordx4 v[100:103], v7, s[44:47], 0 offen offset:2048 sc1
    s_mov_b32 exec_lo, 15
    s_mov_b32 exec_hi, 15
    buffer_store_dwordx4 v[100:103], v157, s[44:47], 0 offen offset:2048 sc1
    s_mov_b64 exec, -1
    s_branch L_mrgd
L_mw1:
    s_mov_b32 s100, 0
Lw_45:
    ds_read_b32 v4, v6 offset:8
    s_waitcnt lgkmcnt(0)
    v_readfirstlane_b32 s99, v4
    s_cmp_ge_u32 s99, 1
    s_cbranch_scc1 Lwd_46
    s_add_u32 s100, s100, 1
    s_cmp_lt_u32 s100, 8388608
    s_cbranch_scc1 Lw_45
Lwd_46:
    s_branch L_mb1
L_mslow1:
    s_mov_b32 s100, 0
Lw_47:
    ds_read_b32 v4, v3 offset:64
    s_waitcnt lgkmcnt(0)
    v_readfirstlane_b32 s99, v4
    s_cmp_ge_u32 s99, s81
    s_cbranch_scc1 Lwd_48
    s_add_u32 s100, s100, 1
    s_cmp_lt_u32 s100, 8388608
    s_cbranch_scc1 Lw_47
Lwd_48:
    s_branch L_mgo1
L_mrgd:
    s_cmp_lg_u32 s3, 0
    s_cbranch_scc1 L_nogq
    s_setprio 3
    ds_read_b32 v4, v3 offset:76
    v_lshlrev_b32 v20, 2, v1
    v_add_u32 v20, 161088, v20
L_gqr:
    ds_read2_b32 v[32:33], v20 offset0:0 offset1:16
    ds_read2_b32 v[34:35], v20 offset0:32 offset1:48
    ds_read2_b32 v[36:37], v20 offset0:64 offset1:80
    v_lshlrev_b32 v40, 16, v8
    v_and_b32 v41, 0xffff0000, v8
    v_lshlrev_b32 v42, 16, v9
    v_and_b32 v43, 0xffff0000, v9
    v_lshlrev_b32 v44, 16, v10
    v_and_b32 v45, 0xffff0000, v10
    v_lshlrev_b32 v46, 16, v11
    v_and_b32 v47, 0xffff0000, v11
    v_lshlrev_b32 v48, 16, v14
    v_and_b32 v49, 0xffff0000, v14
    v_lshlrev_b32 v50, 16, v15
    v_and_b32 v51, 0xffff0000, v15
    v_lshlrev_b32 v52, 16, v160
    v_and_b32 v53, 0xffff0000, v160
    v_lshlrev_b32 v54, 16, v161
    v_and_b32 v55, 0xffff0000, v161
    v_lshlrev_b32 v56, 16, v162
    v_and_b32 v57, 0xffff0000, v162
    v_lshlrev_b32 v58, 16, v163
    v_and_b32 v59, 0xffff0000, v163
    v_lshlrev_b32 v60, 16, v164
    v_and_b32 v61, 0xffff0000, v164
    v_lshlrev_b32 v62, 16, v165
    v_and_b32 v63, 0xffff0000, v165
    s_waitcnt lgkmcnt(0)
    v_readfirstlane_b32 s67, v4
    v_mul_f32 v40, v32, v40
    v_mul_f32 v41, v32, v41
    v_mul_f32 v42, v32, v42
    v_mul_f32 v43, v32, v43
    v_mul_f32 v44, v33, v44
    v_mul_f32 v45, v33, v45
    v_mul_f32 v46, v33, v46
    v_mul_f32 v47, v33, v47
    v_mul_f32 v48, v34, v48
    v_mul_f32 v49, v34, v49
    v_mul_f32 v50, v34, v50
    v_mul_f32 v51, v34, v51
    v_mul_f32 v52, v35, v52
    v_mul_f32 v53, v35, v53
    v_mul_f32 v54, v35, v54
    v_mul_f32 v55, v35, v55
    v_mul_f32 v56, v36, v56
    v_mul_f32 v57, v36, v57
    v_mul_f32 v58, v36, v58
    v_mul_f32 v59, v36, v59
    v_mul_f32 v60, v37, v60
    v_mul_f32 v61, v37, v61
    v_mul_f32 v62, v37, v62
    v_mul_f32 v63, v37, v63
    s_cmp_eq_u32 s67, 2
    s_cbranch_scc1 L_gqd
    s_lshl_b32 s96, s40, 10
    s_add_u32 s96, s96, 133632
    v_add_u32 v21, s96, v12
    s_lshr_b32 s96, s40, 1
    s_lshl_b32 s96, s96, 2
    v_add_u32 v22, s96, v3
    s_mul_i32 s96, s32, 164096
    s_cmp_ge_u32 s32, 11
    s_cselect_b32 s100, 1796864, 0
    s_sub_u32 s96, s96, s100
    s_mul_i32 s100, s33, 16640
    s_add_u32 s96, s96, s100
    s_add_u32 s96, s96, 262144
    s_xor_b32 s96, s96, s92
    s_lshl_b32 s97, s40, 7
    s_add_u32 s96, s96, s97
    s_add_u32 s56, s28, s96
    s_addc_u32 s57, s29, 0
    s_xor_b32 s96, s40, 1
    s_lshl_b32 s96, s96, 12
    s_add_u32 m0, s96, 116736
    s_lshl2_add_u32 s66, s33, s40
    s_lshl_b32 s66, s66, 17
    s_mul_i32 s96, s32, 192
    s_add_u32 s66, s66, s96
    s_add_u32 s66, s66, 4718592
    s_cmp_ge_u32 s32, 11
    s_cselect_b32 s96, 0x2000, 0
    s_add_u32 s66, s66, s96
    s_lshr_b32 s100, s66, 8
    s_and_b32 s100, s100, 8192
    s_xor_b32 s66, s66, s100
    s_xor_b32 s66, s66, s92
    s_setprio 3
L_nogq:
    v_mul_u32_u24 v5, 164096, v0
    v_add_u32 v5, s82, v5
    v_mov_b32 v6, s31
    s_mov_b64 exec, 0xfffff800
    v_subrev_u32 v5, 1796864, v5
    s_mov_b64 exec, -1
    v_xor_b32 v5, s92, v5
    s_waitcnt vmcnt(0)
    v_mov_b32 v4, 1
    s_mov_b64 exec, 1
    ds_add_rtn_u32 v4, v3, v4 offset:28
    s_waitcnt lgkmcnt(0)
    v_readfirstlane_b32 s98, v4
    s_mov_b64 exec, -1
    s_cmp_lg_u32 s98, 3
    s_cbranch_scc1 L_ynosig
    s_mov_b64 exec, 0x3fffff
    global_atomic_swap v5, v6, s[28:29] sc1
    s_mov_b64 exec, -1
L_ynosig:
    s_and_b32 s96, s63, 7
    s_or_b32 s96, s96, s40
    s_cbranch_scc1 L_noep
    s_mov_b32 s96, 1
    s_atomic_add s96, s[26:27], 0 glc
    s_waitcnt lgkmcnt(0)
    s_cmp_lg_u32 s96, 39
    s_cbranch_scc1 Lep_49
    s_atomic_swap s31, s[28:29], 0
Lep_49:
L_noep:
    s_cmp_lg_u32 s3, 0
    s_cbranch_scc1 L_cexit
    s_mov_b32 s100, 0
L_yp:
    s_add_u32 s100, s100, 1
    s_cmp_ge_u32 s100, 1048576
    s_cbranch_scc1 L_ypd
    s_sleep 1
    s_load_dwordx16 s[4:19], s[56:57], 0 glc
    s_waitcnt lgkmcnt(0)
    s_cmp_lg_u32 s4, s31
    s_cbranch_scc1 L_yp
    s_cmp_lg_u32 s6, s31
    s_cbranch_scc1 L_yp
    s_cmp_lg_u32 s8, s31
    s_cbranch_scc1 L_yp
    s_cmp_lg_u32 s10, s31
    s_cbranch_scc1 L_yp
    s_cmp_lg_u32 s12, s31
    s_cbranch_scc1 L_yp
    s_cmp_lg_u32 s14, s31
    s_cbranch_scc1 L_yp
    s_cmp_lg_u32 s16, s31
    s_cbranch_scc1 L_yp
    s_cmp_lg_u32 s18, s31
    s_cbranch_scc1 L_yp
L_ypd:
    buffer_load_dwordx4 v144, s[44:47], s66 offen sc1 lds
    s_add_u32 m0, m0, 1024
    s_nop 0
    buffer_load_dwordx4 v145, s[44:47], s66 offen sc1 lds
    s_add_u32 m0, m0, 1024
    s_nop 0
    buffer_load_dwordx4 v146, s[44:47], s66 offen sc1 lds
    s_mov_b32 s100, 0
Lw_50:
    ds_read_b32 v4, v3 offset:28
    s_waitcnt lgkmcnt(0)
    v_readfirstlane_b32 s99, v4
    s_cmp_ge_u32 s99, 4
    s_cbranch_scc1 Lwd_51
    s_add_u32 s100, s100, 1
    s_cmp_lt_u32 s100, 8388608
    s_cbranch_scc1 Lw_50
Lwd_51:
    s_cmp_lg_u32 s67, 0
    s_cbranch_scc1 L_gqd
    s_mov_b32 s100, 0
Lw_52:
    ds_read_b32 v4, v3 offset:76
    s_waitcnt lgkmcnt(0)
    v_readfirstlane_b32 s99, v4
    s_cmp_ge_u32 s99, 1
    s_cbranch_scc1 Lwd_53
    s_sleep 1
    s_add_u32 s100, s100, 1
    s_cmp_lt_u32 s100, 8388608
    s_cbranch_scc1 Lw_52
Lwd_53:
    v_mov_b32 v4, 2
    s_branch L_gqr
L_gqd:
    v_mov_b32 v4, 1
    s_waitcnt vmcnt(0)
    ds_read_b64_tr_b16 v[64:65], v147 offset:0
    ds_read_b64_tr_b16 v[66:67], v147 offset:32
    ds_read_b64_tr_b16 v[68:69], v147 offset:64
    ds_read_b64_tr_b16 v[70:71], v147 offset:96
    ds_read_b64_tr_b16 v[72:73], v147 offset:128
    ds_read_b64_tr_b16 v[74:75], v147 offset:160
    s_waitcnt lgkmcnt(5)
    v_lshlrev_b32 v80, 16, v64
    v_and_b32 v81, 0xffff0000, v64
    v_lshlrev_b32 v82, 16, v65
    v_and_b32 v83, 0xffff0000, v65
    v_mul_f32 v40, v40, v80
    v_mul_f32 v41, v41, v81
    v_mul_f32 v42, v42, v82
    v_mul_f32 v43, v43, v83
    ds_write_b128 v21, v[40:43] offset:0
    s_waitcnt lgkmcnt(5)
    v_lshlrev_b32 v84, 16, v66
    v_and_b32 v85, 0xffff0000, v66
    v_lshlrev_b32 v86, 16, v67
    v_and_b32 v87, 0xffff0000, v67
    v_mul_f32 v44, v44, v84
    v_mul_f32 v45, v45, v85
    v_mul_f32 v46, v46, v86
    v_mul_f32 v47, v47, v87
    ds_write_b128 v21, v[44:47] offset:4096
    s_waitcnt lgkmcnt(5)
    v_lshlrev_b32 v88, 16, v68
    v_and_b32 v89, 0xffff0000, v68
    v_lshlrev_b32 v90, 16, v69
    v_and_b32 v91, 0xffff0000, v69
    v_mul_f32 v48, v48, v88
    v_mul_f32 v49, v49, v89
    v_mul_f32 v50, v50, v90
    v_mul_f32 v51, v51, v91
    ds_write_b128 v21, v[48:51] offset:8192
    s_waitcnt lgkmcnt(5)
    v_lshlrev_b32 v92, 16, v70
    v_and_b32 v93, 0xffff0000, v70
    v_lshlrev_b32 v94, 16, v71
    v_and_b32 v95, 0xffff0000, v71
    v_mul_f32 v52, v52, v92
    v_mul_f32 v53, v53, v93
    v_mul_f32 v54, v54, v94
    v_mul_f32 v55, v55, v95
    ds_write_b128 v21, v[52:55] offset:12288
    s_waitcnt lgkmcnt(5)
    v_lshlrev_b32 v96, 16, v72
    v_and_b32 v97, 0xffff0000, v72
    v_lshlrev_b32 v98, 16, v73
    v_and_b32 v99, 0xffff0000, v73
    v_mul_f32 v56, v56, v96
    v_mul_f32 v57, v57, v97
    v_mul_f32 v58, v58, v98
    v_mul_f32 v59, v59, v99
    ds_write_b128 v21, v[56:59] offset:16384
    s_waitcnt lgkmcnt(5)
    v_lshlrev_b32 v100, 16, v74
    v_and_b32 v101, 0xffff0000, v74
    v_lshlrev_b32 v102, 16, v75
    v_and_b32 v103, 0xffff0000, v75
    v_mul_f32 v60, v60, v100
    v_mul_f32 v61, v61, v101
    v_mul_f32 v62, v62, v102
    v_mul_f32 v63, v63, v103
    ds_write_b128 v21, v[60:63] offset:20480
    s_mov_b64 exec, 1
    ds_add_u32 v22, v4 offset:112
L_cexit:
    s_endpgm
L_idle:
    s_cmp_lg_u32 s43, 348
    s_cbranch_scc1 L_idl1
    s_cmp_lg_u32 s30, 4
    s_cbranch_scc1 L_idl1
    s_load_dword s31, s[28:29], 0
    s_load_dword s60, s[28:29], 196608 glc
    s_load_dword s61, s[28:29], 204800 glc
    v_lshlrev_b32 v8, 7, v0
    v_add_u32 v8, 8192, v8
    global_load_dword v9, v8, s[28:29] sc0 sc1
    s_barrier
    s_mov_b32 s62, 0
    s_mov_b64 s[68:69], -1
    s_waitcnt lgkmcnt(0)
    s_memtime s[70:71]
    s_waitcnt lgkmcnt(0)
L_ms:
    s_load_dword s60, s[28:29], 196608 glc
    s_waitcnt lgkmcnt(0)
    s_memtime s[72:73]
    s_waitcnt lgkmcnt(0)
    s_sub_u32 s60, s72, s70
    s_min_u32 s68, s68, s60
    s_add_u32 s62, s62, 1
    s_cmp_lt_u32 s62, 4
    s_cbranch_scc1 L_m1
L_m1:
    s_load_dword s60, s[28:29], 204800 glc
    s_waitcnt lgkmcnt(0)
    s_memtime s[70:71]
    s_waitcnt lgkmcnt(0)
    s_sub_u32 s60, s70, s72
    s_min_u32 s69, s69, s60
    s_add_u32 s62, s62, 1
    s_cmp_lt_u32 s62, 4
    s_cbranch_scc1 L_ms
    s_mul_i32 s31, s31, 1664525
    s_add_u32 s31, s31, 1013904223
    s_cmp_gt_u32 s68, s69
    s_cselect_b32 s65, 0x2000, 0
    s_mov_b32 s64, s31
    v_mov_b32 v10, s64
    v_mov_b32 v11, s65
    global_atomic_swap_x2 v8, v[10:11], s[28:29] sc1
    s_branch L_idl0
L_idl1:
    s_barrier
L_idl0:
    s_and_b32 s97, s35, 3
    s_lshl3_add_u32 s96, s97, s30
    s_sub_u32 s96, s96, 4
    v_lshlrev_b32 v4, 7, v0
    v_lshlrev_b32 v5, 10, v0
    s_waitcnt lgkmcnt(0)
    s_mov_b32 s44, s28
    s_and_b32 s45, s29, 0xffff
    s_mov_b32 s46, 2097152
    s_mov_b32 s47, 0x00020000
    s_cmp_lg_u32 s96, 31
    s_cbranch_scc1 L_idl2
    s_mov_b32 s98, 77824
    s_mov_b64 exec, 0xfffffff
    buffer_load_dword v8, v5, s[44:47], s98 offen sc1
    s_mov_b64 exec, -1
L_idl2:
    s_cmp_gt_u32 s96, 1
    s_cbranch_scc1 L_idl3
    s_lshl_b32 s98, s96, 13
    s_add_u32 s98, s98, 65536
    buffer_load_dword v8, v4, s[44:47], s98 offen sc1
L_idl3:
    v_lshrrev_b32 v5, 1, v2
    v_mul_u32_u24 v5, 147712, v5
    v_lshl_add_u32 v5, v2, 13, v5
    v_lshl_add_u32 v5, v1, 7, v5
    s_mov_b32 exec_lo, 0xff1fff1f
    s_mov_b32 exec_hi, 0xff1fff1f
    s_mul_i32 s98, s96, 43
    s_lshr_b32 s98, s98, 8
    s_mul_i32 s99, s98, 4293014784
    s_mul_i32 s98, s96, 328192
    s_add_u32 s98, s98, s99
    s_add_u32 s98, s98, 262144
    buffer_load_dword v9, v5, s[44:47], s98 offen sc1
    s_add_u32 s96, s96, 32
    s_min_u32 s96, s96, 59
    s_mul_i32 s98, s96, 43
    s_lshr_b32 s98, s98, 8
    s_mul_i32 s99, s98, 4293014784
    s_mul_i32 s98, s96, 328192
    s_add_u32 s98, s98, s99
    s_add_u32 s98, s98, 262144
    buffer_load_dword v10, v5, s[44:47], s98 offen sc1
    s_add_u32 s96, s96, 32
    s_min_u32 s96, s96, 59
    s_branch L_cexit
L_hg:
    v_mov_b32 v3, 160960
    s_mov_b32 s101, 0
    s_waitcnt lgkmcnt(0)
    s_cmp_ge_u32 s30, 4
    s_cbranch_scc1 L_ps
    s_setprio 3
    v_mul_u32_u24 v4, 1280, v4
    v_xor_b32 v5, v5, v2
    v_lshl_add_u32 v18, v5, 4, v4
    v_xor_b32 v19, 64, v18
    v_add_u32 v19, 9216, v19
    s_mov_b32 s60, s4
    s_and_b32 s61, s5, 0xffff
    s_mov_b32 s62, 2621440
    s_mov_b32 s63, 0x00020000
    s_sub_u32 s66, s37, 20480
    s_cselect_b32 s66, 0x40000000, s66
    s_mov_b64 s[64:65], s[38:39]
    s_mov_b32 s67, 0
    s_and_b32 s96, s64, 15
    s_mov_b32 m0, s67
    s_lshl_b32 s96, s96, 7
    s_add_u32 s96, s96, s66
    buffer_load_dwordx4 v18, s[60:63], s96 offen lds
    buffer_load_dwordx4 v19, s[60:63], s96 offen offset:1024 lds
    s_lshr_b64 s[64:65], s[64:65], 4
    s_add_u32 s67, s67, 38912
    s_cmp_eq_u32 s67, 116736
    s_cselect_b32 s67, 0, s67
    v_mov_b32 v6, 0
    v_and_b32 v5, 31, v0
    v_lshl_add_u32 v5, v5, 2, v3
    ds_write_b32 v5, v6
    v_lshrrev_b32 v5, 1, v1
    v_xor_b32 v5, v5, v2
    v_lshlrev_b32 v5, 4, v5
    v_lshl_add_u32 v5, v1, 7, v5
    s_add_u32 s96, s33, 1
    s_min_u32 s96, s96, 6
    s_lshl_b32 s96, s96, 11
    v_add_u32 v15, s96, v5
    v_lshlrev_b32 v16, 4, v2
    v_add_u32 v16, 159488, v16
    v_mov_b32 v20, 0
    v_mov_b32 v21, 0
    v_mov_b32 v22, 0
    v_mov_b32 v23, 0
    v_lshlrev_b32 v17, 4, v0
    s_waitcnt lgkmcnt(0)
    s_mov_b32 s40, s22
    s_and_b32 s41, s23, 0xffff
    s_mov_b32 s42, 1280
    s_mov_b32 s43, 0x00020000
    s_mov_b32 m0, 159488
    s_nop 0
    buffer_load_dwordx4 v17, s[40:43], 0 offen lds
    s_mov_b64 exec, 0xffff
    buffer_load_dwordx4 v17, s[40:43], 0 offen offset:1024 lds
    s_mov_b64 exec, -1
    s_and_b32 s96, s64, 15
    s_mov_b32 m0, s67
    s_lshl_b32 s96, s96, 7
    s_add_u32 s96, s96, s66
    buffer_load_dwordx4 v18, s[60:63], s96 offen lds
    buffer_load_dwordx4 v19, s[60:63], s96 offen offset:1024 lds
    s_lshr_b64 s[64:65], s[64:65], 4
    s_add_u32 s67, s67, 38912
    s_cmp_eq_u32 s67, 116736
    s_cselect_b32 s67, 0, s67
    v_lshrrev_b32 v4, 3, v0
    v_and_b32 v5, 7, v0
    v_mul_u32_u24 v4, 1280, v4
    v_lshlrev_b32 v6, 1, v2
    v_xor_b32 v5, v5, v6
    v_lshl_add_u32 v4, v5, 4, v4
    s_lshl_b32 s96, s33, 7
    v_add_u32 v8, s96, v4
    v_lshrrev_b32 v4, 5, v0
    v_mul_u32_u24 v5, 20480, v4
    v_add_u32 v9, v8, v5
    v_mul_u32_u24 v5, 71680, v4
    v_add_u32 v10, v8, v5
    v_mul_u32_u24 v5, 327680, v4
    v_add_u32 v11, v8, v5
    s_mov_b32 s40, s20
    s_and_b32 s41, s21, 0xffff
    s_mov_b32 s42, 819200
    s_mov_b32 s43, 0x00020000
    s_mov_b32 s44, s28
    s_and_b32 s45, s29, 0xffff
    s_mov_b32 s46, 16777216
    s_mov_b32 s47, 0x00020000
    s_load_dword s31, s[28:29], 0
    s_mov_b32 s51, 0
    s_mov_b32 s52, 0
    s_and_b32 s53, s38, 15
    s_lshr_b64 s[38:39], s[38:39], 4
    s_lshl_b32 s53, s53, 7
    s_waitcnt vmcnt(2)
    s_barrier
L_hl:
    s_cmp_ge_u32 s51, 8
    s_cbranch_scc1 L_hnh
    s_setprio 3
    s_and_b32 s96, s64, 15
    s_mov_b32 m0, s67
    s_lshl_b32 s96, s96, 7
    s_add_u32 s96, s96, s66
    buffer_load_dwordx4 v18, s[60:63], s96 offen lds
    buffer_load_dwordx4 v19, s[60:63], s96 offen offset:1024 lds
    s_lshr_b64 s[64:65], s[64:65], 4
    s_add_u32 s67, s67, 38912
    s_cmp_eq_u32 s67, 116736
    s_cselect_b32 s67, 0, s67
L_hnh:
    s_setprio 0
    s_cmp_gt_u32 s33, 5
    s_cbranch_scc1 L_hng
    v_add_u32 v12, s52, v15
    v_add_u32 v14, s53, v16
    v_xor_b32 v13, 64, v12
    ds_read_b128 v[24:27], v12
    ds_read_b128 v[32:35], v14 offset:0
    ds_read_b128 v[28:31], v13
    ds_read_b128 v[36:39], v14 offset:64
    s_waitcnt lgkmcnt(0)
    v_mfma_f32_16x16x32_bf16 v[20:23], v[32:35], v[24:27], v[20:23]
    v_mfma_f32_16x16x32_bf16 v[20:23], v[36:39], v[28:31], v[20:23]
L_hng:
    s_waitcnt lgkmcnt(0)
    s_add_u32 s52, s52, 38912
    s_cmp_eq_u32 s52, 116736
    s_cselect_b32 s52, 0, s52
    s_and_b32 s53, s38, 15
    s_lshr_b64 s[38:39], s[38:39], 4
    s_lshl_b32 s53, s53, 7
    s_cmp_lg_u32 s51, 9
    s_cbranch_scc1 L_hnw
    s_lshr_b32 s96, s2, 3
    s_mul_i32 s96, s96, 30720
    s_and_b32 s97, s2, 1
    s_mul_i32 s97, s97, 640
    s_add_u32 s96, s96, s97
    v_mul_u32_u24 v5, 13108, v0
    v_lshrrev_b32 v5, 16, v5
    v_mul_u32_u24 v5, 640, v5
    v_lshl_add_u32 v5, v0, 7, v5
    s_add_u32 s97, s96, 15360
    s_mov_b32 exec_hi, 0xfffffff
    buffer_load_dword v40, v5, s[40:43], s96 offen
    buffer_load_dword v41, v5, s[40:43], s97 offen
    s_mov_b64 exec, -1
L_hnw:
    s_add_u32 s51, s51, 1
    s_cmp_ge_u32 s51, 10
    s_cbranch_scc1 L_hld
    s_waitcnt vmcnt(2)
    s_cmp_lt_u32 s51, 9
    s_cbranch_scc1 L_hb
    s_waitcnt vmcnt(0)
L_hb:
    s_barrier
    s_branch L_hl
L_hld:
    s_mul_i32 s31, s31, 1664525
    s_add_u32 s31, s31, 1013904223
    v_mov_b32 v24, s31
    s_mul_i32 s54, s32, 768
    s_add_u32 s54, s54, 131072
    v_lshlrev_b32 v26, 3, v0
    s_cmp_gt_u32 s33, 5
    s_cbranch_scc1 L_hgd
    v_cvt_pk_bf16_f32 v25, v20, v20
    v_and_b32 v25, 0xffff0000, v25
    v_mul_f32 v25, 0xbfb8aa3b, v25
    v_exp_f32 v25, v25
    s_nop 0
    v_add_f32 v25, 1.0, v25
    v_rcp_f32 v25, v25
    s_nop 0
    v_cvt_pk_bf16_f32 v25, v25, v25
    v_and_b32 v25, 0xffff0000, v25
    s_lshl_b32 s96, s33, 7
    s_add_u32 s96, s96, s54
    s_mov_b64 exec, 0xffff
    buffer_store_dwordx2 v[24:25], v26, s[44:47], s96 offen sc1
    s_mov_b64 exec, -1
L_hgd:
    s_setprio 1
    s_barrier
    s_sub_u32 s96, 0, s34
    s_cselect_b32 s97, 5, 0
    s_add_u32 s96, s96, s97
    s_lshl_b32 m0, s96, 12
    s_mov_b32 s96, 0
    buffer_load_dwordx4 v8, s[40:43], s96 offen offset:0 lds
    s_mov_b32 s96, 24576
    buffer_load_dwordx4 v8, s[40:43], s96 offen offset:1024 lds
    s_mov_b32 s96, 8192
    buffer_load_dwordx4 v8, s[40:43], s96 offen offset:2048 lds
    s_mov_b32 s96, 32768
    buffer_load_dwordx4 v8, s[40:43], s96 offen offset:3072 lds
    s_sub_u32 s96, 1, s34
    s_cselect_b32 s97, 5, 0
    s_add_u32 s96, s96, s97
    s_lshl_b32 m0, s96, 12
    s_mov_b32 s96, 102400
    buffer_load_dwordx4 v8, s[40:43], s96 offen offset:0 lds
    s_mov_b32 s96, 126976
    buffer_load_dwordx4 v8, s[40:43], s96 offen offset:1024 lds
    s_mov_b32 s96, 110592
    buffer_load_dwordx4 v8, s[40:43], s96 offen offset:2048 lds
    s_mov_b32 s96, 135168
    buffer_load_dwordx4 v8, s[40:43], s96 offen offset:3072 lds
    s_sub_u32 s96, 2, s34
    s_cselect_b32 s97, 5, 0
    s_add_u32 s96, s96, s97
    s_lshl_b32 m0, s96, 12
    s_mov_b32 s96, 179200
    buffer_load_dwordx4 v8, s[40:43], s96 offen offset:0 lds
    s_mov_b32 s96, 203776
    buffer_load_dwordx4 v8, s[40:43], s96 offen offset:1024 lds
    s_mov_b32 s96, 187392
    buffer_load_dwordx4 v8, s[40:43], s96 offen offset:2048 lds
    s_mov_b32 s96, 211968
    buffer_load_dwordx4 v8, s[40:43], s96 offen offset:3072 lds
    s_sub_u32 s96, 3, s34
    s_cselect_b32 s97, 5, 0
    s_add_u32 s96, s96, s97
    s_lshl_b32 m0, s96, 12
    s_mov_b32 s96, 256000
    buffer_load_dwordx4 v8, s[40:43], s96 offen offset:0 lds
    s_mov_b32 s96, 280576
    buffer_load_dwordx4 v8, s[40:43], s96 offen offset:1024 lds
    s_mov_b32 s96, 264192
    buffer_load_dwordx4 v8, s[40:43], s96 offen offset:2048 lds
    s_mov_b32 s96, 288768
    buffer_load_dwordx4 v8, s[40:43], s96 offen offset:3072 lds
    s_sub_u32 s96, 4, s34
    s_cselect_b32 s97, 5, 0
    s_add_u32 s96, s96, s97
    s_lshl_b32 m0, s96, 12
    s_mov_b32 s96, 332800
    buffer_load_dwordx4 v8, s[40:43], s96 offen offset:0 lds
    s_mov_b32 s96, 357376
    buffer_load_dwordx4 v8, s[40:43], s96 offen offset:1024 lds
    s_mov_b32 s96, 340992
    buffer_load_dwordx4 v8, s[40:43], s96 offen offset:2048 lds
    s_mov_b32 s96, 365568
    buffer_load_dwordx4 v8, s[40:43], s96 offen offset:3072 lds
    s_mov_b32 m0, 20480
    s_mov_b32 s96, 20480
    buffer_load_dwordx4 v9, s[40:43], s96 offen offset:0 lds
    s_mov_b32 s96, 121856
    buffer_load_dwordx4 v9, s[40:43], s96 offen offset:1024 lds
    s_mov_b32 s96, 197632
    buffer_load_dwordx4 v9, s[40:43], s96 offen offset:2048 lds
    s_mov_b32 s96, 273408
    buffer_load_dwordx4 v9, s[40:43], s96 offen offset:3072 lds
    s_mov_b32 m0, 61440
    s_mov_b32 s96, 430080
    buffer_load_dwordx4 v9, s[40:43], s96 offen offset:0 lds
    s_mov_b32 s96, 531456
    buffer_load_dwordx4 v9, s[40:43], s96 offen offset:1024 lds
    s_mov_b32 s96, 607232
    buffer_load_dwordx4 v9, s[40:43], s96 offen offset:2048 lds
    s_mov_b32 s96, 683008
    buffer_load_dwordx4 v9, s[40:43], s96 offen offset:3072 lds
    s_mov_b32 m0, 24576
    s_mov_b32 s96, 51200
    buffer_load_dwordx4 v8, s[40:43], s96 offen offset:0 lds
    s_mov_b32 s96, 382976
    buffer_load_dwordx4 v8, s[40:43], s96 offen offset:1024 lds
    s_mov_b32 s96, 59392
    buffer_load_dwordx4 v8, s[40:43], s96 offen offset:2048 lds
    s_mov_b32 s96, 391168
    buffer_load_dwordx4 v8, s[40:43], s96 offen offset:3072 lds
    s_mov_b32 m0, 65536
    s_mov_b32 s96, 460800
    buffer_load_dwordx4 v8, s[40:43], s96 offen offset:0 lds
    s_mov_b32 s96, 792576
    buffer_load_dwordx4 v8, s[40:43], s96 offen offset:1024 lds
    s_mov_b32 s96, 468992
    buffer_load_dwordx4 v8, s[40:43], s96 offen offset:2048 lds
    s_mov_b32 s96, 800768
    buffer_load_dwordx4 v8, s[40:43], s96 offen offset:3072 lds
    s_mov_b32 m0, 28672
    s_mov_b32 s96, 76800
    buffer_load_dwordx4 v8, s[40:43], s96 offen offset:0 lds
    s_mov_b32 s96, 152576
    buffer_load_dwordx4 v8, s[40:43], s96 offen offset:1024 lds
    s_mov_b32 s96, 84992
    buffer_load_dwordx4 v8, s[40:43], s96 offen offset:2048 lds
    s_mov_b32 s96, 160768
    buffer_load_dwordx4 v8, s[40:43], s96 offen offset:3072 lds
    s_mov_b32 m0, 69632
    s_mov_b32 s96, 486400
    buffer_load_dwordx4 v8, s[40:43], s96 offen offset:0 lds
    s_mov_b32 s96, 562176
    buffer_load_dwordx4 v8, s[40:43], s96 offen offset:1024 lds
    s_mov_b32 s96, 494592
    buffer_load_dwordx4 v8, s[40:43], s96 offen offset:2048 lds
    s_mov_b32 s96, 570368
    buffer_load_dwordx4 v8, s[40:43], s96 offen offset:3072 lds
    s_mov_b32 m0, 32768
    s_mov_b32 s96, 230400
    buffer_load_dwordx4 v8, s[40:43], s96 offen offset:0 lds
    s_mov_b32 s96, 306176
    buffer_load_dwordx4 v8, s[40:43], s96 offen offset:1024 lds
    s_mov_b32 s96, 238592
    buffer_load_dwordx4 v8, s[40:43], s96 offen offset:2048 lds
    s_mov_b32 s96, 314368
    buffer_load_dwordx4 v8, s[40:43], s96 offen offset:3072 lds
    s_mov_b32 m0, 73728
    s_mov_b32 s96, 640000
    buffer_load_dwordx4 v8, s[40:43], s96 offen offset:0 lds
    s_mov_b32 s96, 715776
    buffer_load_dwordx4 v8, s[40:43], s96 offen offset:1024 lds
    s_mov_b32 s96, 648192
    buffer_load_dwordx4 v8, s[40:43], s96 offen offset:2048 lds
    s_mov_b32 s96, 723968
    buffer_load_dwordx4 v8, s[40:43], s96 offen offset:3072 lds
    s_mov_b32 m0, 36864
    s_mov_b32 s96, 353280
    buffer_load_dwordx4 v9, s[40:43], s96 offen offset:0 lds
    s_mov_b32 s96, 70656
    buffer_load_dwordx4 v11, s[40:43], s96 offen offset:1024 lds
    s_mov_b32 s96, 95232
    buffer_load_dwordx4 v10, s[40:43], s96 offen offset:2048 lds
    s_mov_b32 s96, 247808
    buffer_load_dwordx4 v10, s[40:43], s96 offen offset:3072 lds
    s_mov_b32 m0, 77824
    s_mov_b32 s96, 762880
    buffer_load_dwordx4 v9, s[40:43], s96 offen offset:0 lds
    s_mov_b32 s96, 480256
    buffer_load_dwordx4 v11, s[40:43], s96 offen offset:1024 lds
    s_mov_b32 s96, 504832
    buffer_load_dwordx4 v10, s[40:43], s96 offen offset:2048 lds
    s_mov_b32 s96, 657408
    buffer_load_dwordx4 v10, s[40:43], s96 offen offset:3072 lds
    v_lshlrev_b32 v27, 2, v0
    v_add_u32 v27, 161088, v27
    s_waitcnt vmcnt(0)
    v_mov_b32 v4, 1
    s_mov_b64 exec, 1
    ds_add_u32 v3, v4 offset:4
    s_mov_b64 exec, -1
    s_mov_b32 s100, 0
    v_mov_b32 v30, s31
L_gp:
    buffer_load_dwordx2 v[28:29], v26, s[44:47], s54 offen sc1
    s_mov_b32 exec_hi, 0
    buffer_load_dwordx2 v[30:31], v26, s[44:47], s54 offen offset:512 sc1
    s_mov_b32 exec_hi, -1
    s_waitcnt vmcnt(0)
    v_cmp_ne_u32 vcc, s31, v28
    v_cmp_ne_u32 s[56:57], s31, v30
    s_or_b64 vcc, vcc, s[56:57]
    s_cbranch_scc0 L_gpd
    s_sleep 8
    s_add_u32 s100, s100, 1
    s_cmp_lt_u32 s100, 1048576
    s_cbranch_scc1 L_gp
L_gpd:
    ds_write_b32 v27, v29
    s_mov_b32 exec_hi, 0
    ds_write_b32 v27, v31 offset:256
    s_mov_b32 exec_hi, -1
    v_mov_b32 v4, 1
    ds_write_b32 v3, v4 offset:12
    s_lshl_b32 s92, s2, 7
    s_and_b32 s92, s92, 0x1f80
    s_load_dwordx2 s[86:87], s[28:29], s92 offset:8192
    s_mov_b32 s100, 0
Lpo_54:
    s_waitcnt lgkmcnt(0)
    s_cmp_eq_u32 s86, s31
    s_cbranch_scc1 Lpd_55
    s_sleep 16
    s_load_dwordx2 s[86:87], s[28:29], s92 offset:8192 glc
    s_add_u32 s100, s100, 1
    s_cmp_lt_u32 s100, 1048576
    s_cbranch_scc1 Lpo_54
    s_waitcnt lgkmcnt(0)
Lpd_55:
    s_and_b32 s92, s87, 0x2000
    s_mul_i32 s96, s32, 164096
    s_cmp_ge_u32 s32, 11
    s_cselect_b32 s100, 1796864, 0
    s_sub_u32 s96, s96, s100
    s_mul_i32 s100, s33, 16640
    s_add_u32 s96, s96, s100
    s_add_u32 s96, s96, 263808
    s_xor_b32 s96, s96, s92
    s_add_u32 s48, s28, s96
    s_addc_u32 s49, s29, 0
    s_mov_b32 s50, 0
    s_mov_b32 s100, 0
    v_mov_b32 v5, 1
    s_min_u32 s51, s34, 1
    s_lshl_b32 s51, s51, 1
    s_mov_b32 s100, 0
Lw_56:
    ds_read_b32 v4, v3 offset:16
    s_waitcnt lgkmcnt(0)
    v_readfirstlane_b32 s99, v4
    s_cmp_ge_u32 s99, s51
    s_cbranch_scc1 Lwd_57
    s_sleep 2
    s_add_u32 s100, s100, 1
    s_cmp_lt_u32 s100, 8388608
    s_cbranch_scc1 Lw_56
Lwd_57:
    s_mov_b32 s100, 0
Lrl_58:
    s_load_dwordx8 s[4:11], s[48:49], 0 glc
    s_load_dwordx8 s[12:19], s[48:49], 256 glc
    s_waitcnt lgkmcnt(0)
    s_cmp_lg_u32 s4, s31
    s_cbranch_scc1 Lrn_60
    s_cmp_lg_u32 s6, s31
    s_cbranch_scc1 Lrn_60
    s_cmp_lg_u32 s8, s31
    s_cbranch_scc1 Lrn_60
    s_cmp_lg_u32 s10, s31
    s_cbranch_scc1 Lrn_60
    s_bitcmp1_b32 s50, 0
    s_cbranch_scc1 Lrn_60
    ds_write_b32 v3, v5 offset:88
    s_bitset1_b32 s50, 0
Lrn_60:
    s_cmp_lg_u32 s12, s31
    s_cbranch_scc1 Lrn_61
    s_cmp_lg_u32 s14, s31
    s_cbranch_scc1 Lrn_61
    s_cmp_lg_u32 s16, s31
    s_cbranch_scc1 Lrn_61
    s_cmp_lg_u32 s18, s31
    s_cbranch_scc1 Lrn_61
    s_bitcmp1_b32 s50, 1
    s_cbranch_scc1 Lrn_61
    ds_write_b32 v3, v5 offset:92
    s_bitset1_b32 s50, 1
Lrn_61:
    s_cmp_eq_u32 s50, 3
    s_cbranch_scc1 Lrd_59
    s_add_u32 s100, s100, 1
    s_cmp_lt_u32 s100, 1048576
    s_cbranch_scc1 Lrl_58
Lrd_59:
    s_endpgm
L_s0:
    s_mul_i32 s31, s31, 1664525
    s_add_u32 s31, s31, 1013904223
    s_mov_b32 s100, 0
Lpo_62:
    s_waitcnt lgkmcnt(0)
    s_cmp_eq_u32 s86, s31
    s_cbranch_scc1 Lpd_63
    s_sleep 16
    s_load_dwordx2 s[86:87], s[28:29], s92 offset:8192 glc
    s_add_u32 s100, s100, 1
    s_cmp_lt_u32 s100, 1048576
    s_cbranch_scc1 Lpo_62
    s_waitcnt lgkmcnt(0)
Lpd_63:
    s_and_b32 s92, s87, 0x2000
    s_mov_b32 s44, s28
    s_and_b32 s45, s29, 0xffff
    s_mov_b32 s46, 16777216
    s_mov_b32 s47, 0x00020000
    v_lshrrev_b32 v4, 3, v0
    v_and_b32 v5, 7, v0
    v_mul_u32_u24 v4, 1280, v4
    v_lshlrev_b32 v6, 1, v2
    v_xor_b32 v5, v5, v6
    v_lshl_add_u32 v4, v5, 4, v4
    s_lshl_b32 s96, s33, 7
    v_add_u32 v8, s96, v4
    v_lshrrev_b32 v4, 5, v0
    v_mul_u32_u24 v5, 20480, v4
    v_add_u32 v9, v8, v5
    v_mul_u32_u24 v5, 71680, v4
    v_add_u32 v10, v8, v5
    v_mul_u32_u24 v5, 327680, v4
    v_add_u32 v11, v8, v5
    s_mov_b32 s40, s20
    s_and_b32 s41, s21, 0xffff
    s_mov_b32 s42, 819200
    s_mov_b32 s43, 0x00020000
    v_lshlrev_b32 v17, 4, v0
    s_mul_i32 s96, s32, 164096
    s_cmp_ge_u32 s32, 11
    s_cselect_b32 s100, 1796864, 0
    s_sub_u32 s96, s96, s100
    s_mul_i32 s100, s33, 16640
    s_add_u32 s96, s96, s100
    s_add_u32 s96, s96, 262656
    s_xor_b32 s96, s96, s92
    s_add_u32 s48, s28, s96
    s_addc_u32 s49, s29, 0
    s_mul_i32 s52, s32, 327680
    s_cmp_ge_u32 s32, 11
    s_cselect_b32 s100, 3596288, 0
    s_sub_u32 s52, s52, s100
    s_lshl_b32 s100, s33, 15
    s_add_u32 s52, s52, s100
    s_add_u32 s52, s52, 12812288
    s_lshr_b32 s100, s52, 8
    s_and_b32 s100, s100, 8192
    s_xor_b32 s52, s52, s100
    s_xor_b32 s52, s52, s92
    s_setprio 3
    s_barrier
    s_sub_u32 s96, 0, s34
    s_cselect_b32 s97, 15, 10
    s_add_u32 s96, s96, s97
    s_lshl_b32 m0, s96, 12
    s_mov_b32 s96, 409600
    buffer_load_dwordx4 v8, s[40:43], s96 offen offset:0 lds
    s_mov_b32 s96, 434176
    buffer_load_dwordx4 v8, s[40:43], s96 offen offset:1024 lds
    s_mov_b32 s96, 417792
    buffer_load_dwordx4 v8, s[40:43], s96 offen offset:2048 lds
    s_mov_b32 s96, 442368
    buffer_load_dwordx4 v8, s[40:43], s96 offen offset:3072 lds
    s_sub_u32 s96, 1, s34
    s_cselect_b32 s97, 15, 10
    s_add_u32 s96, s96, s97
    s_lshl_b32 m0, s96, 12
    s_mov_b32 s96, 512000
    buffer_load_dwordx4 v8, s[40:43], s96 offen offset:0 lds
    s_mov_b32 s96, 536576
    buffer_load_dwordx4 v8, s[40:43], s96 offen offset:1024 lds
    s_mov_b32 s96, 520192
    buffer_load_dwordx4 v8, s[40:43], s96 offen offset:2048 lds
    s_mov_b32 s96, 544768
    buffer_load_dwordx4 v8, s[40:43], s96 offen offset:3072 lds
    s_sub_u32 s96, 2, s34
    s_cselect_b32 s97, 15, 10
    s_add_u32 s96, s96, s97
    s_lshl_b32 m0, s96, 12
    s_mov_b32 s96, 588800
    buffer_load_dwordx4 v8, s[40:43], s96 offen offset:0 lds
    s_mov_b32 s96, 613376
    buffer_load_dwordx4 v8, s[40:43], s96 offen offset:1024 lds
    s_mov_b32 s96, 596992
    buffer_load_dwordx4 v8, s[40:43], s96 offen offset:2048 lds
    s_mov_b32 s96, 621568
    buffer_load_dwordx4 v8, s[40:43], s96 offen offset:3072 lds
    s_sub_u32 s96, 3, s34
    s_cselect_b32 s97, 15, 10
    s_add_u32 s96, s96, s97
    s_lshl_b32 m0, s96, 12
    s_mov_b32 s96, 665600
    buffer_load_dwordx4 v8, s[40:43], s96 offen offset:0 lds
    s_mov_b32 s96, 690176
    buffer_load_dwordx4 v8, s[40:43], s96 offen offset:1024 lds
    s_mov_b32 s96, 673792
    buffer_load_dwordx4 v8, s[40:43], s96 offen offset:2048 lds
    s_mov_b32 s96, 698368
    buffer_load_dwordx4 v8, s[40:43], s96 offen offset:3072 lds
    s_sub_u32 s96, 4, s34
    s_cselect_b32 s97, 15, 10
    s_add_u32 s96, s96, s97
    s_lshl_b32 m0, s96, 12
    s_mov_b32 s96, 742400
    buffer_load_dwordx4 v8, s[40:43], s96 offen offset:0 lds
    s_mov_b32 s96, 766976
    buffer_load_dwordx4 v8, s[40:43], s96 offen offset:1024 lds
    s_mov_b32 s96, 750592
    buffer_load_dwordx4 v8, s[40:43], s96 offen offset:2048 lds
    s_mov_b32 s96, 775168
    buffer_load_dwordx4 v8, s[40:43], s96 offen offset:3072 lds
    s_cmp_eq_u32 s34, 0
    s_cbranch_scc1 L_s0n
    s_mov_b32 s100, 0
L_xp:
    s_add_u32 s100, s100, 1
    s_cmp_ge_u32 s100, 1048576
    s_cbranch_scc1 L_xpd
    s_load_dwordx2 s[4:5], s[48:49], 0 glc
    s_waitcnt lgkmcnt(0)
    s_cmp_lg_u32 s4, s31
    s_cbranch_scc1 L_xp
L_xpd:
    s_mov_b32 m0, 81920
    s_nop 0
    buffer_load_dwordx4 v17, s[44:47], s52 offen offset:0 sc1 lds
    buffer_load_dwordx4 v17, s[44:47], s52 offen offset:1024 sc1 lds
    buffer_load_dwordx4 v17, s[44:47], s52 offen offset:2048 sc1 lds
    buffer_load_dwordx4 v17, s[44:47], s52 offen offset:3072 sc1 lds
    s_add_u32 m0, m0, 4096
    s_xor_b32 s52, s52, 4096
    buffer_load_dwordx4 v17, s[44:47], s52 offen offset:0 sc1 lds
    buffer_load_dwordx4 v17, s[44:47], s52 offen offset:1024 sc1 lds
    buffer_load_dwordx4 v17, s[44:47], s52 offen offset:2048 sc1 lds
    buffer_load_dwordx4 v17, s[44:47], s52 offen offset:3072 sc1 lds
    s_add_u32 m0, m0, 4096
    s_xor_b32 s52, s52, 20480
    buffer_load_dwordx4 v17, s[44:47], s52 offen offset:0 sc1 lds
    buffer_load_dwordx4 v17, s[44:47], s52 offen offset:1024 sc1 lds
L_s0n:
    s_waitcnt vmcnt(0)
    v_mov_b32 v4, 1
    ds_write_b32 v3, v4 offset:8
    v_mov_b32 v4, 1
    s_mov_b64 exec, 1
    ds_add_u32 v3, v4 offset:4
    s_mov_b64 exec, -1
    s_mul_i32 s96, s32, 164096
    s_cmp_ge_u32 s32, 11
    s_cselect_b32 s100, 1796864, 0
    s_sub_u32 s96, s96, s100
    s_mul_i32 s100, s33, 16640
    s_add_u32 s96, s96, s100
    s_add_u32 s96, s96, 263296
    s_xor_b32 s96, s96, s92
    s_add_u32 s48, s28, s96
    s_addc_u32 s49, s29, 0
    s_mov_b32 s50, 0
    s_mov_b32 s100, 0
    v_mov_b32 v5, 1
    s_min_u32 s51, s34, 1
    s_lshl_b32 s51, s51, 1
    s_mov_b32 s100, 0
Lw_64:
    ds_read_b32 v4, v3 offset:16
    s_waitcnt lgkmcnt(0)
    v_readfirstlane_b32 s99, v4
    s_cmp_ge_u32 s99, s51
    s_cbranch_scc1 Lwd_65
    s_sleep 2
    s_add_u32 s100, s100, 1
    s_cmp_lt_u32 s100, 8388608
    s_cbranch_scc1 Lw_64
Lwd_65:
    s_mov_b32 s100, 0
Lrl_66:
    s_load_dwordx8 s[4:11], s[48:49], 0 glc
    s_load_dwordx8 s[12:19], s[48:49], 256 glc
    s_waitcnt lgkmcnt(0)
    s_cmp_lg_u32 s4, s31
    s_cbranch_scc1 Lrn_68
    s_cmp_lg_u32 s6, s31
    s_cbranch_scc1 Lrn_68
    s_cmp_lg_u32 s8, s31
    s_cbranch_scc1 Lrn_68
    s_cmp_lg_u32 s10, s31
    s_cbranch_scc1 Lrn_68
    s_bitcmp1_b32 s50, 0
    s_cbranch_scc1 Lrn_68
    ds_write_b32 v3, v5 offset:80
    s_bitset1_b32 s50, 0
Lrn_68:
    s_cmp_lg_u32 s12, s31
    s_cbranch_scc1 Lrn_69
    s_cmp_lg_u32 s14, s31
    s_cbranch_scc1 Lrn_69
    s_cmp_lg_u32 s16, s31
    s_cbranch_scc1 Lrn_69
    s_cmp_lg_u32 s18, s31
    s_cbranch_scc1 Lrn_69
    s_bitcmp1_b32 s50, 1
    s_cbranch_scc1 Lrn_69
    ds_write_b32 v3, v5 offset:84
    s_bitset1_b32 s50, 1
Lrn_69:
    s_cmp_eq_u32 s50, 3
    s_cbranch_scc1 Lrd_67
    s_add_u32 s100, s100, 1
    s_cmp_lt_u32 s100, 1048576
    s_cbranch_scc1 Lrl_66
Lrd_67:
    s_endpgm
L_ps:
    s_cmp_ge_u32 s30, 4
    s_cselect_b32 s96, -4, 3
    s_add_u32 s60, s30, s96
    s_and_b32 s61, s60, 1
    s_and_b32 s96, s34, 3
    s_cselect_b32 s96, 4, 6
    s_cmp_ge_u32 s60, s96
    s_cselect_b32 s62, 1, 0
    v_mov_b32 v7, 0xf149f2ca
    v_lshlrev_b32 v4, 2, v2
    v_sub_u32 v4, v1, v4
    v_subrev_u32 v5, 0, v4
    v_and_b32 v5, 0x80000001, v5
    v_cmp_eq_u32 vcc, 0, v5
    s_nop 1
    v_cndmask_b32 v146, v7, 0, vcc
    v_cmp_eq_u32 vcc, 0x80000000, v5
    s_nop 1
    v_cndmask_b32 v150, v7, 0, vcc
    v_subrev_u32 v5, 1, v4
    v_and_b32 v5, 0x80000001, v5
    v_cmp_eq_u32 vcc, 0, v5
    s_nop 1
    v_cndmask_b32 v147, v7, 0, vcc
    v_cmp_eq_u32 vcc, 0x80000000, v5
    s_nop 1
    v_cndmask_b32 v151, v7, 0, vcc
    v_subrev_u32 v5, 2, v4
    v_and_b32 v5, 0x80000001, v5
    v_cmp_eq_u32 vcc, 0, v5
    s_nop 1
    v_cndmask_b32 v148, v7, 0, vcc
    v_cmp_eq_u32 vcc, 0x80000000, v5
    s_nop 1
    v_cndmask_b32 v152, v7, 0, vcc
    v_subrev_u32 v5, 3, v4
    v_and_b32 v5, 0x80000001, v5
    v_cmp_eq_u32 vcc, 0, v5
    s_nop 1
    v_cndmask_b32 v149, v7, 0, vcc
    v_cmp_eq_u32 vcc, 0x80000000, v5
    s_nop 1
    v_cndmask_b32 v153, v7, 0, vcc
    v_and_b32 v5, 1, v1
    v_lshlrev_b32 v6, 4, v5
    v_sub_u32 v5, v4, v5
    v_mov_b32 v4, 0x0c0c0c0c
    v_mov_b32 v7, 0xc0c0100
    v_alignbit_b32 v7, v7, v7, v6
    v_cmp_le_i32 vcc, 0, v5
    s_nop 1
    v_cndmask_b32 v154, v4, v7, vcc
    v_cndmask_b32 v156, v7, v4, vcc
    v_mov_b32 v7, 0xc0c0302
    v_alignbit_b32 v7, v7, v7, v6
    v_cmp_le_i32 vcc, 2, v5
    s_nop 1
    v_cndmask_b32 v155, v4, v7, vcc
    v_cndmask_b32 v157, v7, v4, vcc
    v_cmp_eq_u32 vcc, 0, v2
    s_nop 1
    v_cndmask_b32 v159, 0, -1, vcc
    s_mov_b32 s66, 0x3ea52b5c
    s_or_b32 s96, s32, s61
    s_cselect_b32 s67, 0, 0xf149f2ca
    s_mul_i32 s64, s61, 6128
    s_add_u32 s64, s64, 3080
    s_mul_i32 s65, s61, 3064
    s_add_u32 s65, s65, 6152
    s_mul_i32 s68, s32, 262144
    s_cmp_ge_u32 s32, 11
    s_cselect_b32 s100, 2875392, 0
    s_sub_u32 s68, s68, s100
    s_lshl_b32 s96, s61, 17
    s_add_u32 s68, s68, s96
    s_add_u32 s68, s68, 9961472
    s_lshr_b32 s100, s68, 8
    s_and_b32 s100, s100, 8192
    s_xor_b32 s68, s68, s100
    s_mov_b32 s69, 0
L_us:
    s_min_u32 s96, s34, 1
    s_lshr_b32 s97, s60, 1
    s_add_u32 s96, s96, s97
    s_lshl1_add_u32 s99, s34, s97
    s_lshr_b32 s98, s34, 2
    s_add_u32 s98, s98, 10
    s_cmp_ge_u32 s60, 4
    s_cselect_b32 s63, s98, s99
    s_add_u32 s98, s34, 11
    s_cmp_lg_u32 s62, 0
    s_cselect_b32 s63, s98, s63
    s_cselect_b32 s96, 0, s96
    s_add_u32 s98, s34, 10
    v_sub_u32 v4, s98, v1
    v_mul_u32_u24 v5, 52, v4
    v_lshrrev_b32 v5, 8, v5
    v_mul_u32_u24 v5, 5, v5
    v_sub_u32 v4, v4, v5
    s_sub_u32 s99, s63, 5
    s_mul_i32 s98, s62, 9
    s_add_u32 s99, s99, s98
    s_cmp_lt_u32 s60, 4
    s_cbranch_scc1 L_ufs
    v_mov_b32 v4, s99
L_ufs:
    s_and_b32 s98, s2, 1
    s_lshl1_add_u32 s98, s98, s61
    s_lshl_b32 s98, s98, 8
    s_mul_i32 s99, s32, 164096
    s_cmp_ge_u32 s32, 11
    s_cselect_b32 s100, 1796864, 0
    s_sub_u32 s99, s99, s100
    s_add_u32 s98, s98, s99
    s_add_u32 s98, s98, 263168
    v_lshl_add_u32 v4, v4, 3, s98
    v_mul_u32_u24 v164, 16640, v1
    v_add_u32 v164, v164, v4
    s_mul_i32 s96, s96, 5
    s_add_u32 s96, s96, 4
    s_sub_u32 s96, s96, s34
    s_lshl3_add_u32 s97, s61, 81920
    v_add_u32 v4, s96, v2
    v_lshrrev_b32 v5, 2, v4
    v_mul_u32_u24 v5, 9216, v5
    v_lshl_add_u32 v5, v4, 8, v5
    v_lshl_add_u32 v6, v1, 4, s97
    v_add_u32 v158, v5, v6
    s_lshl_b32 s96, s96, 2
    v_lshl_add_u32 v6, v2, 8, s97
    v_add_u32 v4, s96, v1
    v_lshrrev_b32 v5, 4, v4
    v_mul_u32_u24 v5, 9984, v5
    v_lshl_add_u32 v5, v4, 4, v5
    v_add_u32 v160, v5, v6
    s_lshr_b32 s98, s96, 4
    s_mul_i32 s98, s98, 9984
    s_lshl4_add_u32 s98, s96, s98
    s_add_u32 s98, s98, 10240
    v_and_b32 v4, 3, v1
    v_lshl_add_u32 v4, v4, 4, s98
    v_add_u32 v161, v4, v6
    s_and_b32 s97, s2, 1
    s_lshl_b32 s97, s97, 16
    s_lshl_b32 s96, s63, 9
    s_add_u32 s96, s96, s97
    v_lshrrev_b32 v4, 5, v0
    v_mul_u32_u24 v4, 15872, v4
    v_lshl_add_u32 v4, v0, 4, v4
    v_add_u32 v162, s96, v4
    s_lshl_b32 s96, s63, 7
    s_add_u32 s96, s96, s97
    s_add_u32 s96, s96, 49152
    v_lshlrev_b32 v4, 11, v2
    v_lshl_add_u32 v4, v1, 3, v4
    v_add_u32 v163, s96, v4
    s_cmp_eq_u32 s101, 1
    s_cbranch_scc1 L_pb10
    s_cmp_eq_u32 s101, 2
    s_cbranch_scc1 L_upre
    s_setprio 2
    v_lshrrev_b32 v5, 1, v1
    v_xor_b32 v5, v5, v2
    v_lshlrev_b32 v5, 4, v5
    v_lshl_add_u32 v140, v1, 7, v5
    v_bfe_u32 v4, v0, 2, 2
    v_lshl_add_u32 v5, v2, 3, v4
    v_lshlrev_b32 v5, 7, v5
    v_bfe_u32 v6, v0, 3, 2
    v_xor_b32 v6, s60, v6
    v_lshl_add_u32 v5, v6, 5, v5
    v_and_b32 v6, 3, v0
    v_lshl_add_u32 v5, v6, 3, v5
    v_add_u32 v141, 14336, v5
    v_mov_b32 v8, 0
    v_mov_b32 v9, 0
    v_mov_b32 v10, 0
    v_mov_b32 v11, 0
    v_mov_b32 v12, 0
    v_mov_b32 v13, 0
    v_mov_b32 v14, 0
    v_mov_b32 v15, 0
    v_mov_b32 v16, 0
    v_mov_b32 v17, 0
    v_mov_b32 v18, 0
    v_mov_b32 v19, 0
    v_mov_b32 v20, 0
    v_mov_b32 v21, 0
    v_mov_b32 v22, 0
    v_mov_b32 v23, 0
    v_mov_b32 v24, 0
    v_mov_b32 v25, 0
    v_mov_b32 v26, 0
    v_mov_b32 v27, 0
    v_mov_b32 v28, 0
    v_mov_b32 v29, 0
    v_mov_b32 v30, 0
    v_mov_b32 v31, 0
    v_mov_b32 v32, 0
    v_mov_b32 v33, 0
    v_mov_b32 v34, 0
    v_mov_b32 v35, 0
    v_mov_b32 v36, 0
    v_mov_b32 v37, 0
    v_mov_b32 v38, 0
    v_mov_b32 v39, 0
    v_mov_b32 v40, 0
    v_mov_b32 v41, 0
    v_mov_b32 v42, 0
    v_mov_b32 v43, 0
    v_mov_b32 v44, 0
    v_mov_b32 v45, 0
    v_mov_b32 v46, 0
    v_mov_b32 v47, 0
    v_mov_b32 v48, 0
    v_mov_b32 v49, 0
    v_mov_b32 v50, 0
    v_mov_b32 v51, 0
    v_mov_b32 v52, 0
    v_mov_b32 v53, 0
    v_mov_b32 v54, 0
    v_mov_b32 v55, 0
    v_mov_b32 v56, 0
    v_mov_b32 v57, 0
    v_mov_b32 v58, 0
    v_mov_b32 v59, 0
    v_mov_b32 v60, 0
    v_mov_b32 v61, 0
    v_mov_b32 v62, 0
    v_mov_b32 v63, 0
    v_mov_b32 v64, 0
    v_mov_b32 v65, 0
    v_mov_b32 v66, 0
    v_mov_b32 v67, 0
    v_mov_b32 v68, 0
    v_mov_b32 v69, 0
    v_mov_b32 v70, 0
    v_mov_b32 v71, 0
    v_mov_b32 v72, 0
    v_mov_b32 v73, 0
    v_mov_b32 v74, 0
    v_mov_b32 v75, 0
    v_mov_b32 v76, 0
    v_mov_b32 v77, 0
    v_mov_b32 v78, 0
    v_mov_b32 v79, 0
    v_mov_b32 v80, 0
    v_mov_b32 v81, 0
    v_mov_b32 v82, 0
    v_mov_b32 v83, 0
    v_mov_b32 v84, 0
    v_mov_b32 v85, 0
    v_mov_b32 v86, 0
    v_mov_b32 v87, 0
    s_mov_b32 s41, 0
    s_mov_b32 s42, 0
    v_mov_b32 v142, v140
    v_xor_b32 v143, 64, v140
    v_mov_b32 v144, v141
    s_add_u32 s96, s60, 1
    s_mul_i32 s96, s96, 10240
    s_add_u32 s96, s96, 81920
    v_lshl_add_u32 v145, v0, 4, s96
    v_lshlrev_b32 v7, 4, v0
    s_waitcnt lgkmcnt(0)
    s_mov_b32 s44, s28
    s_and_b32 s45, s29, 0xffff
    s_mov_b32 s46, 16777216
    s_mov_b32 s47, 0x00020000
    s_mul_i32 s70, s32, 327680
    s_cmp_ge_u32 s32, 11
    s_cselect_b32 s100, 3596288, 0
    s_sub_u32 s70, s70, s100
    s_lshl_b32 s100, s33, 15
    s_add_u32 s70, s70, s100
    s_add_u32 s70, s70, 12845056
    s_lshr_b32 s100, s70, 8
    s_and_b32 s100, s100, 8192
    s_xor_b32 s70, s70, s100
    s_mul_i32 s97, s32, 164096
    s_cmp_ge_u32 s32, 11
    s_cselect_b32 s100, 1796864, 0
    s_sub_u32 s97, s97, s100
    s_mul_i32 s100, s33, 16640
    s_add_u32 s97, s97, s100
    s_add_u32 s97, s97, 279296
    s_cmp_eq_u32 s30, 7
    s_cselect_b32 s69, s97, 0
    s_cmp_eq_u32 s34, 4
    s_cselect_b32 s69, 0, s69
    s_load_dword s31, s[28:29], 0
    s_barrier
    ds_read_b64_tr_b16 v[120:121], v144 offset:4096
    ds_read_b64_tr_b16 v[122:123], v144 offset:4608
    ds_read_b128 v[88:91], v142 offset:0
    ds_read_b64_tr_b16 v[124:125], v144 offset:8192
    ds_read_b64_tr_b16 v[126:127], v144 offset:8704
    ds_read_b128 v[92:95], v142 offset:2048
    ds_read_b64_tr_b16 v[116:117], v144 offset:0
    ds_read_b64_tr_b16 v[118:119], v144 offset:512
    ds_read_b128 v[96:99], v142 offset:4096
    ds_read_b128 v[100:103], v142 offset:6144
    ds_read_b128 v[104:107], v142 offset:8192
    ds_read_b128 v[108:111], v142 offset:10240
    ds_read_b128 v[112:115], v142 offset:12288
    s_waitcnt lgkmcnt(0)
    s_mul_i32 s31, s31, 1664525
    s_add_u32 s31, s31, 1013904223
L_gl:
    s_waitcnt lgkmcnt(10)
    v_mfma_f32_16x16x32_bf16 v[32:35], v[120:123], v[88:91], v[32:35]
    ds_read_b64_tr_b16 v[132:133], v144 offset:16384
    s_waitcnt lgkmcnt(9)
    v_mfma_f32_16x16x32_bf16 v[60:63], v[88:91], v[124:127], v[60:63]
    ds_read_b64_tr_b16 v[134:135], v144 offset:16896
    s_waitcnt lgkmcnt(9)
    v_mfma_f32_16x16x32_bf16 v[36:39], v[120:123], v[92:95], v[36:39]
    ds_read_b128 v[88:91], v143 offset:0
    v_mfma_f32_16x16x32_bf16 v[64:67], v[92:95], v[124:127], v[64:67]
    ds_read_b64_tr_b16 v[136:137], v144 offset:20480
    s_waitcnt lgkmcnt(9)
    v_mfma_f32_16x16x32_bf16 v[8:11], v[116:119], v[92:95], v[8:11]
    ds_read_b64_tr_b16 v[138:139], v144 offset:20992
    s_waitcnt lgkmcnt(9)
    v_mfma_f32_16x16x32_bf16 v[40:43], v[120:123], v[96:99], v[40:43]
    ds_read_b128 v[92:95], v143 offset:2048
    v_mfma_f32_16x16x32_bf16 v[68:71], v[96:99], v[124:127], v[68:71]
    ds_read_b64_tr_b16 v[128:129], v144 offset:12288
    v_mfma_f32_16x16x32_bf16 v[12:15], v[116:119], v[96:99], v[12:15]
    ds_read_b64_tr_b16 v[130:131], v144 offset:12800
    s_waitcnt lgkmcnt(11)
    v_mfma_f32_16x16x32_bf16 v[44:47], v[120:123], v[100:103], v[44:47]
    ds_read_b128 v[96:99], v143 offset:4096
    v_mfma_f32_16x16x32_bf16 v[72:75], v[100:103], v[124:127], v[72:75]
    s_cmp_lg_u32 s42, 8
    s_cbranch_scc1 L_gnp
    s_lshl_b32 s92, s2, 7
    s_and_b32 s92, s92, 0x1f80
    s_load_dwordx2 s[86:87], s[28:29], s92 offset:8192
L_gnp:
    v_mfma_f32_16x16x32_bf16 v[16:19], v[116:119], v[100:103], v[16:19]
    ds_read_b128 v[100:103], v143 offset:6144
    s_waitcnt lgkmcnt(12)
    v_mfma_f32_16x16x32_bf16 v[48:51], v[120:123], v[104:107], v[48:51]
    v_mfma_f32_16x16x32_bf16 v[76:79], v[104:107], v[124:127], v[76:79]
    s_add_u32 s41, s41, 38912
    v_mfma_f32_16x16x32_bf16 v[20:23], v[116:119], v[104:107], v[20:23]
    ds_read_b128 v[104:107], v143 offset:8192
    s_waitcnt lgkmcnt(12)
    v_mfma_f32_16x16x32_bf16 v[52:55], v[120:123], v[108:111], v[52:55]
    s_cmp_eq_u32 s41, 116736
    s_cselect_b32 s41, 0, s41
    v_mfma_f32_16x16x32_bf16 v[80:83], v[108:111], v[124:127], v[80:83]
    v_add_u32 v144, s41, v141
    v_mfma_f32_16x16x32_bf16 v[24:27], v[116:119], v[108:111], v[24:27]
    ds_read_b128 v[108:111], v143 offset:10240
    s_waitcnt lgkmcnt(12)
    v_mfma_f32_16x16x32_bf16 v[56:59], v[120:123], v[112:115], v[56:59]
    v_add_u32 v142, s41, v140
    v_mfma_f32_16x16x32_bf16 v[84:87], v[112:115], v[124:127], v[84:87]
    v_mfma_f32_16x16x32_bf16 v[28:31], v[116:119], v[112:115], v[28:31]
    ds_read_b128 v[112:115], v143 offset:12288
    s_waitcnt lgkmcnt(10)
    v_mfma_f32_16x16x32_bf16 v[32:35], v[132:135], v[88:91], v[32:35]
    s_waitcnt lgkmcnt(8)
    v_mfma_f32_16x16x32_bf16 v[60:63], v[88:91], v[136:139], v[60:63]
    v_xor_b32 v143, 64, v142
    s_waitcnt lgkmcnt(7)
    v_mfma_f32_16x16x32_bf16 v[36:39], v[132:135], v[92:95], v[36:39]
    s_add_u32 s42, s42, 1
    v_mfma_f32_16x16x32_bf16 v[64:67], v[92:95], v[136:139], v[64:67]
    s_waitcnt lgkmcnt(5)
    v_mfma_f32_16x16x32_bf16 v[8:11], v[128:131], v[92:95], v[8:11]
    s_waitcnt lgkmcnt(0)

    v_mfma_f32_16x16x32_bf16 v[40:43], v[132:135], v[96:99], v[40:43]
    v_mfma_f32_16x16x32_bf16 v[68:71], v[96:99], v[136:139], v[68:71]
    s_barrier
    v_mfma_f32_16x16x32_bf16 v[12:15], v[128:131], v[96:99], v[12:15]
    ds_read_b64_tr_b16 v[120:121], v144 offset:4096
    v_mfma_f32_16x16x32_bf16 v[44:47], v[132:135], v[100:103], v[44:47]
    ds_read_b64_tr_b16 v[122:123], v144 offset:4608
    v_mfma_f32_16x16x32_bf16 v[72:75], v[100:103], v[136:139], v[72:75]
    ds_read_b128 v[88:91], v142 offset:0
    v_mfma_f32_16x16x32_bf16 v[16:19], v[128:131], v[100:103], v[16:19]
    ds_read_b64_tr_b16 v[124:125], v144 offset:8192
    v_mfma_f32_16x16x32_bf16 v[48:51], v[132:135], v[104:107], v[48:51]
    ds_read_b64_tr_b16 v[126:127], v144 offset:8704
    v_mfma_f32_16x16x32_bf16 v[76:79], v[104:107], v[136:139], v[76:79]
    ds_read_b128 v[92:95], v142 offset:2048
    v_mfma_f32_16x16x32_bf16 v[20:23], v[128:131], v[104:107], v[20:23]
    ds_read_b64_tr_b16 v[116:117], v144 offset:0
    v_mfma_f32_16x16x32_bf16 v[52:55], v[132:135], v[108:111], v[52:55]
    ds_read_b64_tr_b16 v[118:119], v144 offset:512
    v_mfma_f32_16x16x32_bf16 v[80:83], v[108:111], v[136:139], v[80:83]
    ds_read_b128 v[96:99], v142 offset:4096
    v_mfma_f32_16x16x32_bf16 v[24:27], v[128:131], v[108:111], v[24:27]
    ds_read_b128 v[100:103], v142 offset:6144
    v_mfma_f32_16x16x32_bf16 v[56:59], v[132:135], v[112:115], v[56:59]
    ds_read_b128 v[104:107], v142 offset:8192
    v_mfma_f32_16x16x32_bf16 v[84:87], v[112:115], v[136:139], v[84:87]
    ds_read_b128 v[108:111], v142 offset:10240
    s_cmp_lt_u32 s42, 9
    v_mfma_f32_16x16x32_bf16 v[28:31], v[128:131], v[112:115], v[28:31]
    ds_read_b128 v[112:115], v142 offset:12288
    s_cbranch_scc1 L_gl
    s_cmp_lg_u32 s86, s31
    s_cbranch_scc1 L_gpslow
    s_and_b32 s92, s87, 0x2000
L_gpok:
    s_cmp_lg_u32 s69, 0
    s_cbranch_scc1 L_lsend

    s_waitcnt lgkmcnt(10)
    v_mfma_f32_16x16x32_bf16 v[32:35], v[120:123], v[88:91], v[32:35]
    ds_read_b64_tr_b16 v[132:133], v144 offset:16384
    s_waitcnt lgkmcnt(9)
    v_mfma_f32_16x16x32_bf16 v[60:63], v[88:91], v[124:127], v[60:63]
    ds_read_b128 v[88:91], v143 offset:0
    s_waitcnt lgkmcnt(5)
    v_mfma_f32_16x16x32_bf16 v[44:47], v[120:123], v[100:103], v[44:47]
    ds_read_b64_tr_b16 v[134:135], v144 offset:16896
    v_mfma_f32_16x16x32_bf16 v[72:75], v[100:103], v[124:127], v[72:75]
    ds_read_b64_tr_b16 v[136:137], v144 offset:20480
    v_mfma_f32_16x16x32_bf16 v[16:19], v[116:119], v[100:103], v[16:19]
    ds_read_b128 v[100:103], v143 offset:6144
    v_mfma_f32_16x16x32_bf16 v[36:39], v[120:123], v[92:95], v[36:39]
    ds_read_b64_tr_b16 v[138:139], v144 offset:20992
    v_mfma_f32_16x16x32_bf16 v[64:67], v[92:95], v[124:127], v[64:67]
    ds_read_b64_tr_b16 v[128:129], v144 offset:12288
    v_mfma_f32_16x16x32_bf16 v[8:11], v[116:119], v[92:95], v[8:11]
    ds_read_b128 v[92:95], v143 offset:2048
    s_waitcnt lgkmcnt(8)
    v_mfma_f32_16x16x32_bf16 v[56:59], v[120:123], v[112:115], v[56:59]
    ds_read_b64_tr_b16 v[130:131], v144 offset:12800
    v_mfma_f32_16x16x32_bf16 v[84:87], v[112:115], v[124:127], v[84:87]
    v_mfma_f32_16x16x32_bf16 v[28:31], v[116:119], v[112:115], v[28:31]
    ds_read_b128 v[112:115], v143 offset:12288
    s_waitcnt lgkmcnt(7)
    v_mfma_f32_16x16x32_bf16 v[32:35], v[132:135], v[88:91], v[32:35]
    s_waitcnt lgkmcnt(4)
    v_mfma_f32_16x16x32_bf16 v[60:63], v[88:91], v[136:139], v[60:63]
    v_mfma_f32_16x16x32_bf16 v[44:47], v[132:135], v[100:103], v[44:47]
    v_mfma_f32_16x16x32_bf16 v[72:75], v[100:103], v[136:139], v[72:75]
    s_waitcnt lgkmcnt(1)
    v_mfma_f32_16x16x32_bf16 v[16:19], v[128:131], v[100:103], v[16:19]
    s_nop 1
    v_cvt_pk_bf16_f32 v32, v32, v33
    v_cvt_pk_bf16_f32 v33, v34, v35
    v_mfma_f32_16x16x32_bf16 v[48:51], v[120:123], v[104:107], v[48:51]
    v_cvt_pk_bf16_f32 v60, v60, v61
    v_cvt_pk_bf16_f32 v61, v62, v63
    v_mfma_f32_16x16x32_bf16 v[76:79], v[104:107], v[124:127], v[76:79]
    v_cvt_pk_bf16_f32 v34, v44, v45
    v_cvt_pk_bf16_f32 v35, v46, v47
    v_mfma_f32_16x16x32_bf16 v[20:23], v[116:119], v[104:107], v[20:23]
    ds_read_b128 v[104:107], v143 offset:8192
    ds_write_b128 v145, v[32:35] offset:3072
    s_waitcnt lgkmcnt(2)
    v_mfma_f32_16x16x32_bf16 v[56:59], v[132:135], v[112:115], v[56:59]
    v_cvt_pk_bf16_f32 v62, v72, v73
    v_cvt_pk_bf16_f32 v63, v74, v75
    v_mfma_f32_16x16x32_bf16 v[84:87], v[112:115], v[136:139], v[84:87]
    ds_write_b128 v145, v[60:63] offset:6144
    v_cvt_pk_bf16_f32 v16, v16, v17
    v_mfma_f32_16x16x32_bf16 v[28:31], v[128:131], v[112:115], v[28:31]
    v_cvt_pk_bf16_f32 v17, v18, v19
    v_mfma_f32_16x16x32_bf16 v[40:43], v[120:123], v[96:99], v[40:43]
    v_mfma_f32_16x16x32_bf16 v[68:71], v[96:99], v[124:127], v[68:71]
    v_cvt_pk_bf16_f32 v56, v56, v57
    v_cvt_pk_bf16_f32 v57, v58, v59
    v_mfma_f32_16x16x32_bf16 v[12:15], v[116:119], v[96:99], v[12:15]
    ds_read_b128 v[96:99], v143 offset:4096
    v_cvt_pk_bf16_f32 v58, v84, v85
    v_mfma_f32_16x16x32_bf16 v[36:39], v[132:135], v[92:95], v[36:39]
    v_cvt_pk_bf16_f32 v59, v86, v87
    ds_write_b128 v145, v[56:59] offset:9216
    v_mfma_f32_16x16x32_bf16 v[64:67], v[92:95], v[136:139], v[64:67]
    v_cvt_pk_bf16_f32 v18, v28, v29
    v_cvt_pk_bf16_f32 v19, v30, v31
    v_mfma_f32_16x16x32_bf16 v[8:11], v[128:131], v[92:95], v[8:11]
    ds_write_b128 v145, v[16:19] offset:2048
    v_mfma_f32_16x16x32_bf16 v[52:55], v[120:123], v[108:111], v[52:55]
    v_mfma_f32_16x16x32_bf16 v[80:83], v[108:111], v[124:127], v[80:83]
    v_cvt_pk_bf16_f32 v36, v36, v37
    v_cvt_pk_bf16_f32 v37, v38, v39
    v_mfma_f32_16x16x32_bf16 v[24:27], v[116:119], v[108:111], v[24:27]
    ds_read_b128 v[108:111], v143 offset:10240
    v_cvt_pk_bf16_f32 v64, v64, v65
    s_waitcnt lgkmcnt(6)
    v_mfma_f32_16x16x32_bf16 v[48:51], v[132:135], v[104:107], v[48:51]
    v_cvt_pk_bf16_f32 v65, v66, v67
    v_cvt_pk_bf16_f32 v8, v8, v9
    v_mfma_f32_16x16x32_bf16 v[76:79], v[104:107], v[136:139], v[76:79]
    v_cvt_pk_bf16_f32 v9, v10, v11
    v_mfma_f32_16x16x32_bf16 v[20:23], v[128:131], v[104:107], v[20:23]
    s_waitcnt lgkmcnt(3)
    v_mfma_f32_16x16x32_bf16 v[40:43], v[132:135], v[96:99], v[40:43]
    v_mfma_f32_16x16x32_bf16 v[68:71], v[96:99], v[136:139], v[68:71]
    v_cvt_pk_bf16_f32 v38, v48, v49
    v_cvt_pk_bf16_f32 v39, v50, v51
    v_mfma_f32_16x16x32_bf16 v[12:15], v[128:131], v[96:99], v[12:15]
    ds_write_b128 v145, v[36:39] offset:4096
    v_cvt_pk_bf16_f32 v66, v76, v77
    s_waitcnt lgkmcnt(1)
    v_mfma_f32_16x16x32_bf16 v[52:55], v[132:135], v[108:111], v[52:55]
    v_cvt_pk_bf16_f32 v67, v78, v79
    ds_write_b128 v145, v[64:67] offset:7168
    v_mfma_f32_16x16x32_bf16 v[80:83], v[108:111], v[136:139], v[80:83]
    v_cvt_pk_bf16_f32 v10, v20, v21
    v_cvt_pk_bf16_f32 v11, v22, v23
    v_mfma_f32_16x16x32_bf16 v[24:27], v[128:131], v[108:111], v[24:27]
    ds_write_b128 v145, v[8:11] offset:0
    v_cvt_pk_bf16_f32 v40, v40, v41
    v_cvt_pk_bf16_f32 v41, v42, v43
    v_cvt_pk_bf16_f32 v68, v68, v69
    v_cvt_pk_bf16_f32 v69, v70, v71
    v_cvt_pk_bf16_f32 v12, v12, v13
    v_cvt_pk_bf16_f32 v13, v14, v15
    v_cvt_pk_bf16_f32 v42, v52, v53
    v_cvt_pk_bf16_f32 v43, v54, v55
    ds_write_b128 v145, v[40:43] offset:5120
    v_cvt_pk_bf16_f32 v70, v80, v81
    v_cvt_pk_bf16_f32 v71, v82, v83
    ds_write_b128 v145, v[68:71] offset:8192
    v_cvt_pk_bf16_f32 v14, v24, v25
    v_cvt_pk_bf16_f32 v15, v26, v27
    ds_write_b128 v145, v[12:15] offset:1024
    s_branch L_pb10b
L_lsend:
    s_xor_b32 s70, s70, s92
    s_xor_b32 s69, s69, s92
    s_xor_b32 s71, s70, 4096
    s_xor_b32 s72, s70, 16384

    s_waitcnt lgkmcnt(10)
    v_mfma_f32_16x16x32_bf16 v[32:35], v[120:123], v[88:91], v[32:35]
    ds_read_b64_tr_b16 v[132:133], v144 offset:16384
    s_waitcnt lgkmcnt(9)
    v_mfma_f32_16x16x32_bf16 v[60:63], v[88:91], v[124:127], v[60:63]
    ds_read_b128 v[88:91], v143 offset:0
    s_waitcnt lgkmcnt(5)
    v_mfma_f32_16x16x32_bf16 v[44:47], v[120:123], v[100:103], v[44:47]
    ds_read_b64_tr_b16 v[134:135], v144 offset:16896
    v_mfma_f32_16x16x32_bf16 v[72:75], v[100:103], v[124:127], v[72:75]
    ds_read_b64_tr_b16 v[136:137], v144 offset:20480
    v_mfma_f32_16x16x32_bf16 v[16:19], v[116:119], v[100:103], v[16:19]
    ds_read_b128 v[100:103], v143 offset:6144
    v_mfma_f32_16x16x32_bf16 v[36:39], v[120:123], v[92:95], v[36:39]
    ds_read_b64_tr_b16 v[138:139], v144 offset:20992
    v_mfma_f32_16x16x32_bf16 v[64:67], v[92:95], v[124:127], v[64:67]
    ds_read_b64_tr_b16 v[128:129], v144 offset:12288
    v_mfma_f32_16x16x32_bf16 v[8:11], v[116:119], v[92:95], v[8:11]
    ds_read_b128 v[92:95], v143 offset:2048
    s_waitcnt lgkmcnt(8)
    v_mfma_f32_16x16x32_bf16 v[56:59], v[120:123], v[112:115], v[56:59]
    ds_read_b64_tr_b16 v[130:131], v144 offset:12800
    v_mfma_f32_16x16x32_bf16 v[84:87], v[112:115], v[124:127], v[84:87]
    v_mfma_f32_16x16x32_bf16 v[28:31], v[116:119], v[112:115], v[28:31]
    ds_read_b128 v[112:115], v143 offset:12288
    s_waitcnt lgkmcnt(7)
    v_mfma_f32_16x16x32_bf16 v[32:35], v[132:135], v[88:91], v[32:35]
    s_waitcnt lgkmcnt(4)
    v_mfma_f32_16x16x32_bf16 v[60:63], v[88:91], v[136:139], v[60:63]
    v_mfma_f32_16x16x32_bf16 v[44:47], v[132:135], v[100:103], v[44:47]
    v_mfma_f32_16x16x32_bf16 v[72:75], v[100:103], v[136:139], v[72:75]
    s_waitcnt lgkmcnt(1)
    v_mfma_f32_16x16x32_bf16 v[16:19], v[128:131], v[100:103], v[16:19]
    s_nop 1
    v_cvt_pk_bf16_f32 v32, v32, v33
    v_cvt_pk_bf16_f32 v33, v34, v35
    v_mfma_f32_16x16x32_bf16 v[48:51], v[120:123], v[104:107], v[48:51]
    v_cvt_pk_bf16_f32 v60, v60, v61
    v_cvt_pk_bf16_f32 v61, v62, v63
    v_mfma_f32_16x16x32_bf16 v[76:79], v[104:107], v[124:127], v[76:79]
    v_cvt_pk_bf16_f32 v34, v44, v45
    v_cvt_pk_bf16_f32 v35, v46, v47
    v_mfma_f32_16x16x32_bf16 v[20:23], v[116:119], v[104:107], v[20:23]
    ds_read_b128 v[104:107], v143 offset:8192
    buffer_store_dwordx4 v[32:35], v7, s[44:47], s70 offen offset:3072 sc1
    s_waitcnt lgkmcnt(1)
    v_mfma_f32_16x16x32_bf16 v[56:59], v[132:135], v[112:115], v[56:59]
    ds_write_b128 v145, v[32:35] offset:3072
    v_cvt_pk_bf16_f32 v62, v72, v73
    v_mfma_f32_16x16x32_bf16 v[84:87], v[112:115], v[136:139], v[84:87]
    v_cvt_pk_bf16_f32 v63, v74, v75
    buffer_store_dwordx4 v[60:63], v7, s[44:47], s71 offen offset:2048 sc1
    v_mfma_f32_16x16x32_bf16 v[28:31], v[128:131], v[112:115], v[28:31]
    ds_write_b128 v145, v[60:63] offset:6144
    v_cvt_pk_bf16_f32 v16, v16, v17
    v_mfma_f32_16x16x32_bf16 v[40:43], v[120:123], v[96:99], v[40:43]
    v_cvt_pk_bf16_f32 v17, v18, v19
    v_mfma_f32_16x16x32_bf16 v[68:71], v[96:99], v[124:127], v[68:71]
    v_cvt_pk_bf16_f32 v56, v56, v57
    v_cvt_pk_bf16_f32 v57, v58, v59
    v_mfma_f32_16x16x32_bf16 v[12:15], v[116:119], v[96:99], v[12:15]
    ds_read_b128 v[96:99], v143 offset:4096
    v_cvt_pk_bf16_f32 v58, v84, v85
    v_mfma_f32_16x16x32_bf16 v[36:39], v[132:135], v[92:95], v[36:39]
    v_cvt_pk_bf16_f32 v59, v86, v87
    buffer_store_dwordx4 v[56:59], v7, s[44:47], s72 offen offset:1024 sc1
    v_mfma_f32_16x16x32_bf16 v[64:67], v[92:95], v[136:139], v[64:67]
    ds_write_b128 v145, v[56:59] offset:9216
    v_cvt_pk_bf16_f32 v18, v28, v29
    v_mfma_f32_16x16x32_bf16 v[8:11], v[128:131], v[92:95], v[8:11]
    v_cvt_pk_bf16_f32 v19, v30, v31
    buffer_store_dwordx4 v[16:19], v7, s[44:47], s70 offen offset:2048 sc1
    v_mfma_f32_16x16x32_bf16 v[52:55], v[120:123], v[108:111], v[52:55]
    ds_write_b128 v145, v[16:19] offset:2048
    v_mfma_f32_16x16x32_bf16 v[80:83], v[108:111], v[124:127], v[80:83]
    v_cvt_pk_bf16_f32 v36, v36, v37
    v_cvt_pk_bf16_f32 v37, v38, v39
    v_mfma_f32_16x16x32_bf16 v[24:27], v[116:119], v[108:111], v[24:27]
    ds_read_b128 v[108:111], v143 offset:10240
    v_cvt_pk_bf16_f32 v64, v64, v65
    s_waitcnt lgkmcnt(6)
    v_mfma_f32_16x16x32_bf16 v[48:51], v[132:135], v[104:107], v[48:51]
    v_cvt_pk_bf16_f32 v65, v66, v67
    v_cvt_pk_bf16_f32 v8, v8, v9
    v_mfma_f32_16x16x32_bf16 v[76:79], v[104:107], v[136:139], v[76:79]
    v_cvt_pk_bf16_f32 v9, v10, v11
    v_mfma_f32_16x16x32_bf16 v[20:23], v[128:131], v[104:107], v[20:23]
    s_waitcnt lgkmcnt(3)
    v_mfma_f32_16x16x32_bf16 v[40:43], v[132:135], v[96:99], v[40:43]
    v_mfma_f32_16x16x32_bf16 v[68:71], v[96:99], v[136:139], v[68:71]
    v_cvt_pk_bf16_f32 v38, v48, v49
    v_cvt_pk_bf16_f32 v39, v50, v51
    v_mfma_f32_16x16x32_bf16 v[12:15], v[128:131], v[96:99], v[12:15]
    buffer_store_dwordx4 v[36:39], v7, s[44:47], s71 offen offset:0 sc1
    ds_write_b128 v145, v[36:39] offset:4096
    s_waitcnt lgkmcnt(1)
    v_mfma_f32_16x16x32_bf16 v[52:55], v[132:135], v[108:111], v[52:55]
    v_cvt_pk_bf16_f32 v66, v76, v77
    v_cvt_pk_bf16_f32 v67, v78, v79
    v_mfma_f32_16x16x32_bf16 v[80:83], v[108:111], v[136:139], v[80:83]
    buffer_store_dwordx4 v[64:67], v7, s[44:47], s71 offen offset:3072 sc1
    ds_write_b128 v145, v[64:67] offset:7168
    v_mfma_f32_16x16x32_bf16 v[24:27], v[128:131], v[108:111], v[24:27]
    v_cvt_pk_bf16_f32 v10, v20, v21
    v_cvt_pk_bf16_f32 v11, v22, v23
    buffer_store_dwordx4 v[8:11], v7, s[44:47], s70 offen offset:0 sc1
    ds_write_b128 v145, v[8:11] offset:0
    v_cvt_pk_bf16_f32 v40, v40, v41
    v_cvt_pk_bf16_f32 v41, v42, v43
    v_cvt_pk_bf16_f32 v68, v68, v69
    v_cvt_pk_bf16_f32 v69, v70, v71
    v_cvt_pk_bf16_f32 v12, v12, v13
    v_cvt_pk_bf16_f32 v13, v14, v15
    v_cvt_pk_bf16_f32 v42, v52, v53
    v_cvt_pk_bf16_f32 v43, v54, v55
    buffer_store_dwordx4 v[40:43], v7, s[44:47], s71 offen offset:1024 sc1
    ds_write_b128 v145, v[40:43] offset:5120
    v_cvt_pk_bf16_f32 v70, v80, v81
    v_cvt_pk_bf16_f32 v71, v82, v83
    buffer_store_dwordx4 v[68:71], v7, s[44:47], s72 offen offset:0 sc1
    ds_write_b128 v145, v[68:71] offset:8192
    v_cvt_pk_bf16_f32 v14, v24, v25
    v_cvt_pk_bf16_f32 v15, v26, v27
    buffer_store_dwordx4 v[12:15], v7, s[44:47], s70 offen offset:1024 sc1
    ds_write_b128 v145, v[12:15] offset:1024
    s_branch L_pb10b
L_pb10:
    s_mov_b32 s44, s28
    s_and_b32 s45, s29, 0xffff
    s_mov_b32 s46, 16777216
    s_mov_b32 s47, 0x00020000
    s_mul_i32 s31, s31, 1664525
    s_add_u32 s31, s31, 1013904223
    s_mov_b32 s100, 0
Lpo_70:
    s_waitcnt lgkmcnt(0)
    s_cmp_eq_u32 s86, s31
    s_cbranch_scc1 Lpd_71
    s_sleep 16
    s_load_dwordx2 s[86:87], s[28:29], s92 offset:8192 glc
    s_add_u32 s100, s100, 1
    s_cmp_lt_u32 s100, 1048576
    s_cbranch_scc1 Lpo_70
    s_waitcnt lgkmcnt(0)
Lpd_71:
    s_and_b32 s92, s87, 0x2000
    s_setprio 2
L_pb10b:
    v_mov_b32 v165, s31
    s_xor_b32 s68, s68, s92
L_upre:
    v_xor_b32 v164, s92, v164
    v_add_u32 v132, s64, v158
    v_add_u32 v133, s65, v160
    v_add_u32 v134, s65, v161
    s_cmp_eq_u32 s101, 2
    s_cbranch_scc1 L_unit
    v_add_f32 v136, s67, v150
    v_add_f32 v137, s67, v151
    v_add_f32 v138, s67, v152
    v_add_f32 v139, s67, v153
    v_mov_b32 v106, 0
    v_mov_b32 v107, 0
    v_mov_b32 v110, 0
    v_mov_b32 v111, 0
    v_mov_b32 v114, 0
    v_mov_b32 v115, 0
    s_waitcnt lgkmcnt(0)
    s_barrier
L_unit:
    s_cmp_eq_u32 s62, 0
    s_cbranch_scc1 L_ugo
    s_mov_b32 s100, 0
Lw_72:
    ds_read_b32 v4, v3 offset:8
    s_waitcnt lgkmcnt(0)
    v_readfirstlane_b32 s99, v4
    s_cmp_ge_u32 s99, 1
    s_cbranch_scc1 Lwd_73
    s_sleep 1
    s_add_u32 s100, s100, 1
    s_cmp_lt_u32 s100, 8388608
    s_cbranch_scc1 Lw_72
Lwd_73:
    s_setprio 3
L_ugo:
    s_mov_b64 exec, 0xffff
    ds_read_b64 v[106:107], v158 offset:10240
    ds_read_b64 v[110:111], v158 offset:11264
    ds_read_b64 v[114:115], v158 offset:12288
    s_mov_b64 exec, -1
    ds_read_b64 v[104:105], v158 offset:0
    ds_read_b64 v[88:89], v158 offset:3072
    ds_read_b64 v[90:91], v158 offset:13312
    ds_read_b64 v[92:93], v158 offset:4096
    ds_read_b64 v[94:95], v158 offset:14336
    ds_read_b64 v[108:109], v158 offset:1024
    ds_read_b64 v[96:97], v158 offset:5120
    ds_read_b64 v[98:99], v158 offset:15360
    ds_read_b64 v[112:113], v158 offset:2048
    ds_read_b64 v[100:101], v132 offset:0
    ds_read_b64 v[102:103], v132 offset:10240
    s_waitcnt lgkmcnt(6)
    v_mfma_f32_16x16x32_bf16 v[20:23], v[88:91], v[104:107], v[136:139]
    v_mfma_f32_16x16x32_bf16 v[8:11], v[92:95], v[104:107], v[146:149]
    s_waitcnt lgkmcnt(3)
    v_mfma_f32_16x16x32_bf16 v[24:27], v[92:95], v[108:111], v[150:153]
    v_mfma_f32_16x16x32_bf16 v[12:15], v[96:99], v[108:111], v[146:149]
    s_waitcnt lgkmcnt(0)
    v_mfma_f32_16x16x32_bf16 v[28:31], v[96:99], v[112:115], v[150:153]
    v_mfma_f32_16x16x32_bf16 v[16:19], v[100:103], v[112:115], v[146:149]
    ds_read_b64 v[120:121], v160 offset:7168
    ds_read_b64 v[122:123], v160 offset:6144
    ds_read_b64 v[118:119], v160 offset:8192
    ds_read_b64 v[116:117], v133 offset:0
    ds_read_b64 v[128:129], v161 offset:7168
    ds_read_b64 v[130:131], v161 offset:6144
    ds_read_b64 v[126:127], v161 offset:8192
    ds_read_b64 v[124:125], v134 offset:0
    v_max3_f32 v32, v20, v21, v8
    v_max3_f32 v36, v22, v23, v10
    v_max_f32 v32, v32, v9
    v_max_f32 v36, v36, v11
    v_max_f32 v40, v32, v36
    v_max3_f32 v33, v24, v25, v12
    v_max3_f32 v37, v26, v27, v14
    v_max_f32 v33, v33, v13
    v_max_f32 v37, v37, v15
    v_max_f32 v41, v33, v37
    v_max3_f32 v34, v28, v29, v16
    v_max3_f32 v38, v30, v31, v18
    v_max_f32 v34, v34, v17
    v_max_f32 v38, v38, v19
    v_permlane32_swap_b32 v40, v41
    v_max_f32 v42, v34, v38
    v_max_f32 v40, v40, v41
    s_add_u32 s96, s68, 32768
    v_permlane32_swap_b32 v42, v43
    v_max_f32 v42, v42, v43
    s_nop 1
    v_permlane16_swap_b32 v40, v42
    v_max_f32 v40, v40, v42
    v_mul_f32 v42, s66, v40
    v_mul_f32 v40, s66, v40
    s_nop 1
    v_permlane16_swap_b32 v40, v42
    v_mov_b32 v41, v40
    v_mov_b32 v43, v42
    s_waitcnt lgkmcnt(0)
    v_permlane32_swap_b32 v40, v41
    v_permlane32_swap_b32 v42, v43
    s_cmp_eq_u32 s69, 0
    s_cbranch_scc1 Lxs_74
    s_waitcnt vmcnt(0)
    s_atomic_swap s31, s[28:29], s69
Lxs_74:
    v_fma_f32 v32, v32, s66, -v40
    v_fma_f32 v36, v36, s66, -v40
    v_fma_f32 v33, v33, s66, -v41
    v_fma_f32 v37, v37, s66, -v41
    v_fma_f32 v34, v34, s66, -v42
    v_fma_f32 v38, v38, s66, -v42
    v_exp_f32 v32, v32
    v_exp_f32 v36, v36
    v_exp_f32 v33, v33
    v_exp_f32 v37, v37
    v_exp_f32 v34, v34
    v_exp_f32 v38, v38
    v_add_f32 v40, v32, v36
    v_add_f32 v41, v33, v37
    v_add_f32 v42, v34, v38
    s_nop 0
    v_permlane32_swap_b32 v40, v41
    v_permlane32_swap_b32 v42, v43
    v_add_f32 v40, v40, v41
    v_add_f32 v42, v42, v43
    s_nop 1
    v_permlane16_swap_b32 v40, v42
    v_add_f32 v40, v40, v42
    v_rcp_f32 v42, v40
    v_rcp_f32 v40, v40
    s_nop 1
    v_permlane16_swap_b32 v40, v42
    v_mov_b32 v41, v40
    v_mov_b32 v43, v42
    s_nop 0
    v_permlane32_swap_b32 v40, v41
    v_permlane32_swap_b32 v42, v43
    v_mul_f32 v32, v32, v40
    v_mul_f32 v36, v36, v40
    v_cvt_pk_bf16_f32 v32, v32, v36
    v_perm_b32 v44, v32, v32, v154
    v_perm_b32 v45, v32, v32, v155
    v_perm_b32 v46, v32, v32, v156
    v_perm_b32 v47, v32, v32, v157
    v_mul_f32 v33, v33, v41
    v_mul_f32 v37, v37, v41
    v_cvt_pk_bf16_f32 v33, v33, v37
    v_perm_b32 v48, v33, v33, v154
    v_perm_b32 v49, v33, v33, v155
    v_perm_b32 v50, v33, v33, v156
    v_perm_b32 v51, v33, v33, v157
    v_mfma_f32_16x16x32_bf16 v[8:11], v[120:123], v[44:47], 0
    v_mfma_f32_16x16x32_bf16 v[20:23], v[128:131], v[44:47], 0
    v_mul_f32 v34, v34, v42
    v_mul_f32 v38, v38, v42
    v_cvt_pk_bf16_f32 v34, v34, v38
    v_perm_b32 v52, v34, v34, v154
    v_perm_b32 v53, v34, v34, v155
    v_perm_b32 v54, v34, v34, v156
    v_perm_b32 v55, v34, v34, v157
    v_mfma_f32_16x16x32_bf16 v[12:15], v[118:121], v[48:51], 0
    v_mfma_f32_16x16x32_bf16 v[24:27], v[126:129], v[48:51], 0
    v_mfma_f32_16x16x32_bf16 v[16:19], v[116:119], v[52:55], 0
    v_mfma_f32_16x16x32_bf16 v[28:31], v[124:127], v[52:55], 0
    v_cvt_pk_bf16_f32 v60, v8, v9
    v_cvt_pk_bf16_f32 v61, v10, v11
    v_cvt_pk_bf16_f32 v68, v20, v21
    v_cvt_pk_bf16_f32 v69, v22, v23
    s_nop 0
    v_cvt_pk_bf16_f32 v62, v12, v13
    v_cvt_pk_bf16_f32 v63, v14, v15
    s_nop 0
    v_permlane32_swap_b32 v60, v62
    v_permlane32_swap_b32 v61, v63
    buffer_store_dwordx4 v[60:63], v162, s[44:47], s68 offen sc1
    v_cvt_pk_bf16_f32 v64, v16, v17
    v_cvt_pk_bf16_f32 v65, v18, v19
    s_nop 0
    v_permlane32_swap_b32 v64, v66
    v_permlane32_swap_b32 v65, v67
    s_mov_b32 exec_lo, 0
    v_cvt_pk_bf16_f32 v68, v28, v29
    v_cvt_pk_bf16_f32 v69, v30, v31
    s_mov_b64 exec, 0xffff0000
    v_cvt_pk_bf16_f32 v68, v24, v25
    v_cvt_pk_bf16_f32 v69, v26, v27
    s_mov_b32 exec_lo, -1
    buffer_store_dwordx4 v[64:67], v162, s[44:47], s96 offen sc1
    s_mov_b32 exec_hi, 0xffff
    buffer_store_dwordx2 v[68:69], v163, s[44:47], s68 offen sc1
    s_mov_b64 exec, -1
    s_cmp_lg_u32 s101, 0
    s_cbranch_scc1 L_nops
    s_lshr_b32 s75, s60, 1
    s_lshl_b32 s96, s75, 16
    s_add_u32 s72, s68, s96
    s_add_u32 s73, s72, 16384
    s_add_u32 s74, s72, 32768
    s_lshl1_add_u32 s70, s61, s32
    s_lshl2_add_u32 s70, s75, s70
    s_and_b32 s70, s70, 7
    s_lshl_b32 s70, s70, 10
    s_add_u32 s83, s72, 49152
    s_add_u32 s87, s72, 53248
    s_mul_i32 s96, s32, 164096
    s_cmp_ge_u32 s32, 11
    s_cselect_b32 s100, 1796864, 0
    s_sub_u32 s96, s96, s100
    s_mul_i32 s100, s33, 16640
    s_add_u32 s96, s96, s100
    s_add_u32 s96, s96, 263168
    s_xor_b32 s96, s96, s92
    s_lshl_b32 s97, s60, 8
    s_add_u32 s96, s96, s97
    s_add_u32 s76, s28, s96
    s_addc_u32 s77, s29, 0
    s_mul_i32 s80, s60, 6144
    s_add_u32 s80, s80, 81920
    s_xor_b32 s96, s60, 2
    s_mul_i32 s81, s96, 6144
    s_add_u32 s81, s81, 81920
    s_mul_i32 s82, s61, 12288
    s_lshl_b32 s96, s75, 11
    s_add_u32 s82, s82, s96
    s_add_u32 s82, s82, 133632
    s_lshl1_add_u32 s96, s32, s61
    s_mul_i32 s79, s96, 61440
    s_lshl1_add_u32 s96, s33, s75
    s_lshl_b32 s96, s96, 6
    s_add_u32 s79, s79, s96
    s_mov_b32 s48, s24
    s_and_b32 s49, s25, 0xffff
    s_mov_b32 s50, 2621440
    s_mov_b32 s51, 0x00020000
    v_lshrrev_b32 v58, 2, v0
    v_and_b32 v59, 3, v0
    v_bfe_u32 v57, v0, 3, 2
    v_lshlrev_b32 v7, 3, v0
    s_mul_i32 s96, s75, 40960
    v_lshl_add_u32 v5, v58, 7, s96
    v_lshl_add_u32 v5, v59, 3, v5
    s_lshl_b32 s96, s75, 1
    v_xor_b32 v6, s96, v57
    v_lshl_add_u32 v160, v6, 5, v5
    v_xor_b32 v161, 32, v160
    v_xor_b32 v162, 64, v160
    v_xor_b32 v163, 96, v160
    v_lshlrev_b32 v5, 4, v0
    v_add_u32 v6, 4096, v5
    v_xor_b32 v59, v59, v57
    v_mul_u32_u24 v58, 1280, v58
    v_lshl_add_u32 v58, v59, 4, v58
    s_mul_i32 s96, s61, 192
    s_add_u32 s96, s96, 161088
    v_lshl_add_u32 v57, v1, 2, s96
    v_bfe_u32 v59, v1, 1, 2
    v_lshl_add_u32 v1, v1, 6, s81
    v_lshlrev_b32 v59, 1, v59
    v_xor_b32 v59, v59, v2
    v_lshl_add_u32 v1, v59, 3, v1
    v_mov_b32 v2, v58
L_nops:
    s_lshl_b32 s96, s62, 4
    v_add_u32 v56, s96, v3
    v_mov_b32 v4, 1
    s_mov_b64 exec, 1
    ds_add_u32 v56, v4 offset:0
    s_mov_b64 exec, -1
    s_cmp_lg_u32 s101, 0
    s_cbranch_scc1 L_lsig
    s_lshl_b32 s96, s61, 3
    v_add_u32 v56, s96, v3
    s_waitcnt vmcnt(0)
    v_mov_b32 v4, 1
    s_mov_b64 exec, 1
    ds_add_rtn_u32 v4, v56, v4 offset:24
    s_waitcnt lgkmcnt(0)
    v_readfirstlane_b32 s97, v4
    s_mov_b64 exec, -1
    s_cmp_lg_u32 s97, 1
    s_cbranch_scc1 L_nosig
L_lsig:
    s_waitcnt vmcnt(0)
    s_mov_b64 exec, 0x3ff
    global_atomic_swap v164, v165, s[28:29] sc1
    s_mov_b64 exec, -1
L_nosig:
    s_cmp_eq_u32 s101, 0
    s_cbranch_scc1 L_op
    s_lshr_b32 s97, s34, 2
    s_andn2_b32 s96, s97, s62
    s_cbranch_scc0 L_pexit
    s_mov_b32 s62, 1
    s_mov_b32 s101, 2
    s_branch L_us
L_op:
    s_setprio 0
    s_lshl_b32 s85, s34, 10
    s_mov_b32 s100, 0
    v_mov_b32 v116, v57
    s_lshl_b32 s96, s60, 2
    v_add_u32 v164, s96, v3
    s_load_dwordx16 s[4:19], s[76:77], 0 glc
    s_mov_b32 s100, 0
Lw_75:
    ds_read_b32 v4, v3 offset:4
    s_waitcnt lgkmcnt(0)
    v_readfirstlane_b32 s99, v4
    s_cmp_ge_u32 s99, 2
    s_cbranch_scc1 Lwd_76
    s_add_u32 s100, s100, 1
    s_cmp_lt_u32 s100, 8388608
    s_cbranch_scc1 Lw_75
Lwd_76:
    s_mov_b32 s100, 0
    ds_read_b64_tr_b16 v[140:141], v160 offset:0
    ds_read_b64_tr_b16 v[142:143], v160 offset:2048
    ds_read_b64_tr_b16 v[144:145], v161 offset:0
    ds_read_b64_tr_b16 v[146:147], v161 offset:2048
    ds_read_b64_tr_b16 v[148:149], v162 offset:0
    ds_read_b64_tr_b16 v[150:151], v162 offset:2048
    ds_read_b64_tr_b16 v[152:153], v163 offset:0
    ds_read_b64_tr_b16 v[154:155], v163 offset:2048
    ds_read_b64_tr_b16 v[156:157], v160 offset:4096
    ds_read_b64_tr_b16 v[158:159], v160 offset:6144
L_nb0:
    s_cmp_lg_u32 s4, s31
    s_cbranch_scc1 L_ns0
L_ng0:
    s_add_u32 s96, s72, s85
    buffer_load_dwordx4 v[56:59], v5, s[44:47], s96 offen sc1
    s_add_u32 s96, s73, s85
    buffer_load_dwordx4 v[60:63], v5, s[44:47], s96 offen sc1
    s_add_u32 s96, s74, s85
    buffer_load_dwordx4 v[64:67], v5, s[44:47], s96 offen sc1
    s_add_u32 s85, s85, 1024
    s_cmp_eq_u32 s85, 5120
    s_cselect_b32 s85, 0, s85
L_nb1:
    s_cmp_lg_u32 s6, s31
    s_cbranch_scc1 L_ns1
L_ng1:
    s_add_u32 s96, s72, s85
    buffer_load_dwordx4 v[68:71], v5, s[44:47], s96 offen sc1
    s_add_u32 s96, s73, s85
    buffer_load_dwordx4 v[72:75], v5, s[44:47], s96 offen sc1
    s_add_u32 s96, s74, s85
    buffer_load_dwordx4 v[76:79], v5, s[44:47], s96 offen sc1
    s_add_u32 s85, s85, 1024
    s_cmp_eq_u32 s85, 5120
    s_cselect_b32 s85, 0, s85
L_nb2:
    s_cmp_lg_u32 s8, s31
    s_cbranch_scc1 L_ns2
L_ng2:
    s_add_u32 s96, s72, s85
    buffer_load_dwordx4 v[80:83], v5, s[44:47], s96 offen sc1
    s_add_u32 s96, s73, s85
    buffer_load_dwordx4 v[84:87], v5, s[44:47], s96 offen sc1
    s_add_u32 s96, s74, s85
    buffer_load_dwordx4 v[88:91], v5, s[44:47], s96 offen sc1
    s_add_u32 s85, s85, 1024
    s_cmp_eq_u32 s85, 5120
    s_cselect_b32 s85, 0, s85
L_nb3:
    s_cmp_lg_u32 s10, s31
    s_cbranch_scc1 L_ns3
L_ng3:
    s_add_u32 s96, s72, s85
    buffer_load_dwordx4 v[92:95], v5, s[44:47], s96 offen sc1
    s_add_u32 s96, s73, s85
    buffer_load_dwordx4 v[96:99], v5, s[44:47], s96 offen sc1
    s_add_u32 s96, s74, s85
    buffer_load_dwordx4 v[100:103], v5, s[44:47], s96 offen sc1
    s_add_u32 s85, s85, 1024
    s_cmp_eq_u32 s85, 5120
    s_cselect_b32 s85, 0, s85
L_nb4:
    s_cmp_lg_u32 s12, s31
    s_cbranch_scc1 L_ns4
L_ng4:
    s_add_u32 s96, s72, s85
    buffer_load_dwordx4 v[104:107], v5, s[44:47], s96 offen sc1
    s_add_u32 s96, s73, s85
    buffer_load_dwordx4 v[108:111], v5, s[44:47], s96 offen sc1
    s_add_u32 s96, s74, s85
    buffer_load_dwordx4 v[112:115], v5, s[44:47], s96 offen sc1

    s_waitcnt vmcnt(14)
    s_waitcnt lgkmcnt(8)
    v_mfma_f32_16x16x32_bf16 v[8:11], v[140:143], v[56:59], 0
    s_waitcnt vmcnt(13)
    v_mfma_f32_16x16x32_bf16 v[24:27], v[140:143], v[60:63], 0
    s_waitcnt vmcnt(12)
    v_mfma_f32_16x16x32_bf16 v[40:43], v[140:143], v[64:67], 0
    s_waitcnt lgkmcnt(6)
    v_mfma_f32_16x16x32_bf16 v[12:15], v[144:147], v[56:59], 0
    ds_read_b64_tr_b16 v[140:141], v161 offset:4096
    v_mfma_f32_16x16x32_bf16 v[28:31], v[144:147], v[60:63], 0
    ds_read_b64_tr_b16 v[142:143], v161 offset:6144
    v_mfma_f32_16x16x32_bf16 v[44:47], v[144:147], v[64:67], 0
    s_waitcnt lgkmcnt(6)
    v_mfma_f32_16x16x32_bf16 v[16:19], v[148:151], v[56:59], 0
    ds_read_b64_tr_b16 v[144:145], v162 offset:4096
    v_mfma_f32_16x16x32_bf16 v[32:35], v[148:151], v[60:63], 0
    ds_read_b64_tr_b16 v[146:147], v162 offset:6144
    v_mfma_f32_16x16x32_bf16 v[48:51], v[148:151], v[64:67], 0
    s_waitcnt lgkmcnt(6)
    v_mfma_f32_16x16x32_bf16 v[20:23], v[152:155], v[56:59], 0
    ds_read_b64_tr_b16 v[148:149], v163 offset:4096
    v_mfma_f32_16x16x32_bf16 v[36:39], v[152:155], v[60:63], 0
    ds_read_b64_tr_b16 v[150:151], v163 offset:6144
    v_mfma_f32_16x16x32_bf16 v[52:55], v[152:155], v[64:67], 0
    s_waitcnt vmcnt(11)
    s_waitcnt lgkmcnt(6)
    v_mfma_f32_16x16x32_bf16 v[8:11], v[156:159], v[68:71], v[8:11]
    ds_read_b64_tr_b16 v[152:153], v160 offset:8192
    buffer_load_dwordx2 v[56:57], v7, s[44:47], s83 offen offset:0 sc1
    s_waitcnt vmcnt(11)
    v_mfma_f32_16x16x32_bf16 v[24:27], v[156:159], v[72:75], v[24:27]
    ds_read_b64_tr_b16 v[154:155], v160 offset:10240
    buffer_load_dwordx2 v[58:59], v7, s[44:47], s83 offen offset:512 sc1
    s_waitcnt vmcnt(11)
    v_mfma_f32_16x16x32_bf16 v[40:43], v[156:159], v[76:79], v[40:43]
    buffer_load_dwordx2 v[60:61], v7, s[44:47], s83 offen offset:2048 sc1
    s_waitcnt lgkmcnt(6)
    v_mfma_f32_16x16x32_bf16 v[12:15], v[140:143], v[68:71], v[12:15]
    ds_read_b64_tr_b16 v[156:157], v161 offset:8192
    v_mfma_f32_16x16x32_bf16 v[28:31], v[140:143], v[72:75], v[28:31]
    ds_read_b64_tr_b16 v[158:159], v161 offset:10240
    v_mfma_f32_16x16x32_bf16 v[44:47], v[140:143], v[76:79], v[44:47]
    buffer_load_dwordx2 v[62:63], v7, s[44:47], s83 offen offset:2560 sc1
    s_waitcnt lgkmcnt(6)
    v_mfma_f32_16x16x32_bf16 v[16:19], v[144:147], v[68:71], v[16:19]
    ds_read_b64_tr_b16 v[140:141], v162 offset:8192
    v_mfma_f32_16x16x32_bf16 v[32:35], v[144:147], v[72:75], v[32:35]
    ds_read_b64_tr_b16 v[142:143], v162 offset:10240
    v_mfma_f32_16x16x32_bf16 v[48:51], v[144:147], v[76:79], v[48:51]
    buffer_load_dwordx2 v[64:65], v7, s[44:47], s87 offen offset:0 sc1
    s_waitcnt lgkmcnt(6)
    v_mfma_f32_16x16x32_bf16 v[20:23], v[148:151], v[68:71], v[20:23]
    ds_read_b64_tr_b16 v[144:145], v163 offset:8192
    v_mfma_f32_16x16x32_bf16 v[36:39], v[148:151], v[72:75], v[36:39]
    ds_read_b64_tr_b16 v[146:147], v163 offset:10240
    v_mfma_f32_16x16x32_bf16 v[52:55], v[148:151], v[76:79], v[52:55]
    buffer_load_dwordx2 v[66:67], v7, s[44:47], s87 offen offset:512 sc1
L_nb6:
    s_cmp_lg_u32 s14, s31
    s_cbranch_scc1 L_ns6
    s_cmp_lg_u32 s16, s31
    s_cbranch_scc1 L_ns6
L_ng6:
    s_waitcnt vmcnt(14)
    s_waitcnt lgkmcnt(6)
    v_mfma_f32_16x16x32_bf16 v[8:11], v[152:155], v[80:83], v[8:11]
    ds_read_b64_tr_b16 v[148:149], v160 offset:12288
    s_waitcnt vmcnt(13)
    v_mfma_f32_16x16x32_bf16 v[24:27], v[152:155], v[84:87], v[24:27]
    ds_read_b64_tr_b16 v[150:151], v160 offset:14336
    s_waitcnt vmcnt(12)
    v_mfma_f32_16x16x32_bf16 v[40:43], v[152:155], v[88:91], v[40:43]
    buffer_load_dwordx4 v[68:71], v6, s[44:47], s72 offen offset:1024 sc1
    s_waitcnt lgkmcnt(6)
    v_mfma_f32_16x16x32_bf16 v[12:15], v[156:159], v[80:83], v[12:15]
    ds_read_b64_tr_b16 v[152:153], v161 offset:12288
    v_mfma_f32_16x16x32_bf16 v[28:31], v[156:159], v[84:87], v[28:31]
    ds_read_b64_tr_b16 v[154:155], v161 offset:14336
    v_mfma_f32_16x16x32_bf16 v[44:47], v[156:159], v[88:91], v[44:47]
    buffer_load_dwordx4 v[72:75], v6, s[44:47], s73 offen offset:1024 sc1
    s_waitcnt lgkmcnt(6)
    v_mfma_f32_16x16x32_bf16 v[16:19], v[140:143], v[80:83], v[16:19]
    ds_read_b64_tr_b16 v[156:157], v162 offset:12288
    v_mfma_f32_16x16x32_bf16 v[32:35], v[140:143], v[84:87], v[32:35]
    ds_read_b64_tr_b16 v[158:159], v162 offset:14336
    v_mfma_f32_16x16x32_bf16 v[48:51], v[140:143], v[88:91], v[48:51]
    buffer_load_dwordx4 v[76:79], v6, s[44:47], s74 offen offset:1024 sc1
    s_waitcnt lgkmcnt(6)
    v_mfma_f32_16x16x32_bf16 v[20:23], v[144:147], v[80:83], v[20:23]
    ds_read_b64_tr_b16 v[140:141], v163 offset:12288
    v_mfma_f32_16x16x32_bf16 v[36:39], v[144:147], v[84:87], v[36:39]
    ds_read_b64_tr_b16 v[142:143], v163 offset:14336
    v_mfma_f32_16x16x32_bf16 v[52:55], v[144:147], v[88:91], v[52:55]
    s_waitcnt vmcnt(14)
    s_waitcnt lgkmcnt(6)
    v_mfma_f32_16x16x32_bf16 v[8:11], v[148:151], v[92:95], v[8:11]
    ds_read_b64_tr_b16 v[144:145], v160 offset:16384
    s_waitcnt vmcnt(13)
    v_mfma_f32_16x16x32_bf16 v[24:27], v[148:151], v[96:99], v[24:27]
    ds_read_b64_tr_b16 v[146:147], v160 offset:18432
    s_waitcnt vmcnt(12)
    v_mfma_f32_16x16x32_bf16 v[40:43], v[148:151], v[100:103], v[40:43]
    s_waitcnt lgkmcnt(6)
    v_mfma_f32_16x16x32_bf16 v[12:15], v[152:155], v[92:95], v[12:15]
    ds_read_b64_tr_b16 v[148:149], v161 offset:16384
    v_mfma_f32_16x16x32_bf16 v[28:31], v[152:155], v[96:99], v[28:31]
    ds_read_b64_tr_b16 v[150:151], v161 offset:18432
    v_mfma_f32_16x16x32_bf16 v[44:47], v[152:155], v[100:103], v[44:47]
    s_waitcnt lgkmcnt(6)
    v_mfma_f32_16x16x32_bf16 v[16:19], v[156:159], v[92:95], v[16:19]
    ds_read_b64_tr_b16 v[152:153], v162 offset:16384
    v_mfma_f32_16x16x32_bf16 v[32:35], v[156:159], v[96:99], v[32:35]
    ds_read_b64_tr_b16 v[154:155], v162 offset:18432
    v_mfma_f32_16x16x32_bf16 v[48:51], v[156:159], v[100:103], v[48:51]
    s_waitcnt lgkmcnt(6)
    v_mfma_f32_16x16x32_bf16 v[20:23], v[140:143], v[92:95], v[20:23]
    ds_read_b64_tr_b16 v[156:157], v163 offset:16384
    v_mfma_f32_16x16x32_bf16 v[36:39], v[140:143], v[96:99], v[36:39]
    ds_read_b64_tr_b16 v[158:159], v163 offset:18432
    v_mfma_f32_16x16x32_bf16 v[52:55], v[140:143], v[100:103], v[52:55]
    s_waitcnt vmcnt(11)
    s_waitcnt lgkmcnt(6)
    v_mfma_f32_16x16x32_bf16 v[8:11], v[144:147], v[104:107], v[8:11]
    ds_read_b64_tr_b16 v[140:141], v160 offset:20480
    s_waitcnt vmcnt(10)
    v_mfma_f32_16x16x32_bf16 v[24:27], v[144:147], v[108:111], v[24:27]
    ds_read_b64_tr_b16 v[142:143], v160 offset:22528
    s_waitcnt vmcnt(9)
    v_mfma_f32_16x16x32_bf16 v[40:43], v[144:147], v[112:115], v[40:43]
    s_waitcnt lgkmcnt(6)
    v_mfma_f32_16x16x32_bf16 v[12:15], v[148:151], v[104:107], v[12:15]
    ds_read_b64_tr_b16 v[144:145], v161 offset:20480
    v_mfma_f32_16x16x32_bf16 v[28:31], v[148:151], v[108:111], v[28:31]
    ds_read_b64_tr_b16 v[146:147], v161 offset:22528
    v_mfma_f32_16x16x32_bf16 v[44:47], v[148:151], v[112:115], v[44:47]
    s_waitcnt lgkmcnt(6)
    v_mfma_f32_16x16x32_bf16 v[16:19], v[152:155], v[104:107], v[16:19]
    ds_read_b64_tr_b16 v[148:149], v162 offset:20480
    v_mfma_f32_16x16x32_bf16 v[32:35], v[152:155], v[108:111], v[32:35]
    ds_read_b64_tr_b16 v[150:151], v162 offset:22528
    v_mfma_f32_16x16x32_bf16 v[48:51], v[152:155], v[112:115], v[48:51]
    ds_read_b32 v122, v164 offset:80
    s_waitcnt lgkmcnt(7)
    v_mfma_f32_16x16x32_bf16 v[20:23], v[156:159], v[104:107], v[20:23]
    ds_read_b64_tr_b16 v[152:153], v163 offset:20480
    v_mfma_f32_16x16x32_bf16 v[36:39], v[156:159], v[108:111], v[36:39]
    ds_read_b64_tr_b16 v[154:155], v163 offset:22528
    v_mfma_f32_16x16x32_bf16 v[52:55], v[156:159], v[112:115], v[52:55]
    s_waitcnt lgkmcnt(2)
    v_readfirstlane_b32 s97, v122
    s_cmp_eq_u32 s97, 0
    s_cbranch_scc1 L_lts
L_ltg:
    buffer_load_dwordx4 v[80:83], v6, s[44:47], s72 offen offset:2048 sc1
    buffer_load_dwordx4 v[84:87], v6, s[44:47], s73 offen offset:2048 sc1
    buffer_load_dwordx4 v[88:91], v6, s[44:47], s74 offen offset:2048 sc1
    s_waitcnt vmcnt(10)
    v_mfma_f32_16x16x32_bf16 v[8:11], v[140:143], v[56:59], v[8:11]
    ds_read_b64_tr_b16 v[156:157], v160 offset:24576
    buffer_load_dwordx4 v[92:95], v6, s[44:47], s72 offen offset:3072 sc1
    s_waitcnt vmcnt(9)
    v_mfma_f32_16x16x32_bf16 v[24:27], v[140:143], v[60:63], v[24:27]
    ds_read_b64_tr_b16 v[158:159], v160 offset:26624
    buffer_load_dwordx4 v[96:99], v6, s[44:47], s73 offen offset:3072 sc1
    s_waitcnt vmcnt(8)
    v_mfma_f32_16x16x32_bf16 v[40:43], v[140:143], v[64:67], v[40:43]
    buffer_load_dwordx4 v[100:103], v6, s[44:47], s74 offen offset:3072 sc1
    v_mfma_f32_16x16x32_bf16 v[12:15], v[144:147], v[56:59], v[12:15]
    ds_read_b64_tr_b16 v[140:141], v161 offset:24576
    buffer_load_dwordx2 v[104:105], v7, s[44:47], s83 offen offset:1024 sc1
    v_mfma_f32_16x16x32_bf16 v[28:31], v[144:147], v[60:63], v[28:31]
    ds_read_b64_tr_b16 v[142:143], v161 offset:26624
    buffer_load_dwordx2 v[106:107], v7, s[44:47], s83 offen offset:1536 sc1
    v_mfma_f32_16x16x32_bf16 v[44:47], v[144:147], v[64:67], v[44:47]
    buffer_load_dwordx2 v[108:109], v7, s[44:47], s83 offen offset:3072 sc1
    v_mfma_f32_16x16x32_bf16 v[16:19], v[148:151], v[56:59], v[16:19]
    ds_read_b64_tr_b16 v[144:145], v162 offset:24576
    buffer_load_dwordx2 v[110:111], v7, s[44:47], s83 offen offset:3584 sc1
    v_mfma_f32_16x16x32_bf16 v[32:35], v[148:151], v[60:63], v[32:35]
    ds_read_b64_tr_b16 v[146:147], v162 offset:26624
    v_mfma_f32_16x16x32_bf16 v[48:51], v[148:151], v[64:67], v[48:51]
    buffer_load_dwordx2 v[112:113], v7, s[44:47], s87 offen offset:1024 sc1
    s_waitcnt lgkmcnt(6)
    v_mfma_f32_16x16x32_bf16 v[20:23], v[152:155], v[56:59], v[20:23]
    ds_read_b64_tr_b16 v[148:149], v163 offset:24576
    v_mfma_f32_16x16x32_bf16 v[36:39], v[152:155], v[60:63], v[36:39]
    ds_read_b64_tr_b16 v[150:151], v163 offset:26624
    v_mfma_f32_16x16x32_bf16 v[52:55], v[152:155], v[64:67], v[52:55]
    buffer_load_dwordx2 v[114:115], v7, s[44:47], s87 offen offset:1536 sc1
    s_waitcnt vmcnt(14)
    s_waitcnt lgkmcnt(6)
    v_mfma_f32_16x16x32_bf16 v[8:11], v[156:159], v[68:71], v[8:11]
    ds_read_b64_tr_b16 v[152:153], v162 offset:28672
    s_waitcnt vmcnt(13)
    v_mfma_f32_16x16x32_bf16 v[24:27], v[156:159], v[72:75], v[24:27]
    ds_read_b64_tr_b16 v[154:155], v162 offset:30720
    s_waitcnt vmcnt(12)
    v_mfma_f32_16x16x32_bf16 v[40:43], v[156:159], v[76:79], v[40:43]
    s_waitcnt lgkmcnt(6)
    v_mfma_f32_16x16x32_bf16 v[12:15], v[140:143], v[68:71], v[12:15]
    ds_read_b64_tr_b16 v[156:157], v163 offset:28672
    v_mfma_f32_16x16x32_bf16 v[28:31], v[140:143], v[72:75], v[28:31]
    ds_read_b64_tr_b16 v[158:159], v163 offset:30720
    v_mfma_f32_16x16x32_bf16 v[44:47], v[140:143], v[76:79], v[44:47]
    s_waitcnt lgkmcnt(6)
    v_mfma_f32_16x16x32_bf16 v[16:19], v[144:147], v[68:71], v[16:19]
    ds_read_b64_tr_b16 v[140:141], v162 offset:32768
    v_mfma_f32_16x16x32_bf16 v[32:35], v[144:147], v[72:75], v[32:35]
    ds_read_b64_tr_b16 v[142:143], v162 offset:34816
    v_mfma_f32_16x16x32_bf16 v[48:51], v[144:147], v[76:79], v[48:51]
    s_waitcnt lgkmcnt(6)
    v_mfma_f32_16x16x32_bf16 v[20:23], v[148:151], v[68:71], v[20:23]
    ds_read_b64_tr_b16 v[144:145], v163 offset:32768
    v_mfma_f32_16x16x32_bf16 v[36:39], v[148:151], v[72:75], v[36:39]
    ds_read_b64_tr_b16 v[146:147], v163 offset:34816
    v_mfma_f32_16x16x32_bf16 v[52:55], v[148:151], v[76:79], v[52:55]
    s_waitcnt vmcnt(11)
    s_waitcnt lgkmcnt(6)
    v_mfma_f32_16x16x32_bf16 v[16:19], v[152:155], v[80:83], v[16:19]
    ds_read_b64_tr_b16 v[148:149], v162 offset:36864
    s_waitcnt vmcnt(10)
    v_mfma_f32_16x16x32_bf16 v[32:35], v[152:155], v[84:87], v[32:35]
    ds_read_b64_tr_b16 v[150:151], v162 offset:38912
    s_waitcnt vmcnt(9)
    v_mfma_f32_16x16x32_bf16 v[48:51], v[152:155], v[88:91], v[48:51]
    s_waitcnt lgkmcnt(6)
    v_mfma_f32_16x16x32_bf16 v[20:23], v[156:159], v[80:83], v[20:23]
    ds_read_b64_tr_b16 v[152:153], v163 offset:36864
    v_mfma_f32_16x16x32_bf16 v[36:39], v[156:159], v[84:87], v[36:39]
    ds_read_b64_tr_b16 v[154:155], v163 offset:38912
    v_mfma_f32_16x16x32_bf16 v[52:55], v[156:159], v[88:91], v[52:55]
    s_waitcnt vmcnt(8)
    s_waitcnt lgkmcnt(6)
    v_mfma_f32_16x16x32_bf16 v[16:19], v[140:143], v[92:95], v[16:19]
    ds_read_b64_tr_b16 v[156:157], v160 offset:28672
    s_waitcnt vmcnt(7)
    v_mfma_f32_16x16x32_bf16 v[32:35], v[140:143], v[96:99], v[32:35]
    ds_read_b64_tr_b16 v[158:159], v160 offset:30720
    s_waitcnt vmcnt(6)
    v_mfma_f32_16x16x32_bf16 v[48:51], v[140:143], v[100:103], v[48:51]
    ds_read2_b32 v[120:121], v3 offset0:0 offset1:4
    v_add_u32 v6, s80, v5
    v_add_u32 v7, s82, v5
    v_add_u32 v5, s81, v5
    s_waitcnt lgkmcnt(7)
    v_mfma_f32_16x16x32_bf16 v[20:23], v[144:147], v[92:95], v[20:23]
    ds_read_b64_tr_b16 v[140:141], v161 offset:28672
    v_mfma_f32_16x16x32_bf16 v[36:39], v[144:147], v[96:99], v[36:39]
    ds_read_b64_tr_b16 v[142:143], v161 offset:30720
    v_mfma_f32_16x16x32_bf16 v[52:55], v[144:147], v[100:103], v[52:55]
    v_xor_b32 v165, 8, v164
    s_lshl_b32 s96, s75, 2
    v_add_u32 v166, s96, v3
    s_waitcnt vmcnt(4)
    s_waitcnt lgkmcnt(7)
    v_mfma_f32_16x16x32_bf16 v[16:19], v[148:151], v[104:107], v[16:19]
    ds_read_b64_tr_b16 v[144:145], v160 offset:32768
    s_waitcnt vmcnt(2)
    v_mfma_f32_16x16x32_bf16 v[32:35], v[148:151], v[108:111], v[32:35]
    ds_read_b64_tr_b16 v[146:147], v160 offset:34816
    s_waitcnt vmcnt(0)
    v_mfma_f32_16x16x32_bf16 v[48:51], v[148:151], v[112:115], v[48:51]
    s_waitcnt lgkmcnt(4)
    v_add_u32 v120, v120, v121
    s_lshr_b32 s96, s34, 2
    v_readfirstlane_b32 s97, v120
    s_lshl1_add_u32 s84, s96, 6
    v_mfma_f32_16x16x32_bf16 v[20:23], v[152:155], v[104:107], v[20:23]
    ds_read_b64_tr_b16 v[148:149], v161 offset:32768
    v_mfma_f32_16x16x32_bf16 v[36:39], v[152:155], v[108:111], v[36:39]
    ds_read_b64_tr_b16 v[150:151], v161 offset:34816
    v_mfma_f32_16x16x32_bf16 v[52:55], v[152:155], v[112:115], v[52:55]
    s_cmp_lt_u32 s97, s84
    s_cbranch_scc1 L_fslow
L_fgo:
    v_mfma_f32_16x16x32_bf16 v[8:11], v[156:159], v[80:83], v[8:11]
    ds_read_b64_tr_b16 v[152:153], v160 offset:36864
    v_mfma_f32_16x16x32_bf16 v[24:27], v[156:159], v[84:87], v[24:27]
    ds_read_b64_tr_b16 v[154:155], v160 offset:38912
    ds_write_b128 v6, v[16:19] offset:0
    v_mfma_f32_16x16x32_bf16 v[40:43], v[156:159], v[88:91], v[40:43]
    ds_write_b128 v6, v[32:35] offset:2048
    s_waitcnt lgkmcnt(8)
    v_mfma_f32_16x16x32_bf16 v[12:15], v[140:143], v[80:83], v[12:15]
    ds_read_b64_tr_b16 v[156:157], v161 offset:36864
    ds_write_b128 v6, v[48:51] offset:4096
    v_mfma_f32_16x16x32_bf16 v[28:31], v[140:143], v[84:87], v[28:31]
    ds_read_b64_tr_b16 v[158:159], v161 offset:38912
    ds_write_b128 v6, v[20:23] offset:1024
    v_mfma_f32_16x16x32_bf16 v[44:47], v[140:143], v[88:91], v[44:47]
    ds_write_b128 v6, v[36:39] offset:3072
    s_waitcnt lgkmcnt(11)
    v_mfma_f32_16x16x32_bf16 v[8:11], v[144:147], v[92:95], v[8:11]
    ds_write_b128 v6, v[52:55] offset:5120
    v_mfma_f32_16x16x32_bf16 v[24:27], v[144:147], v[96:99], v[24:27]
    ds_write_b32 v164, v164 offset:64
    v_mfma_f32_16x16x32_bf16 v[40:43], v[144:147], v[100:103], v[40:43]
    v_mov_b32 v162, v116
    v_xor_b32 v6, 32, v1
    s_waitcnt lgkmcnt(11)
    v_mfma_f32_16x16x32_bf16 v[12:15], v[148:151], v[92:95], v[12:15]
    ds_read_b32 v21, v166 offset:48
    v_mfma_f32_16x16x32_bf16 v[28:31], v[148:151], v[96:99], v[28:31]
    ds_read2_b32 v[16:17], v162 offset0:0 offset1:16
    v_mfma_f32_16x16x32_bf16 v[44:47], v[148:151], v[100:103], v[44:47]
    ds_read_b32 v20, v162 offset:128
    s_waitcnt lgkmcnt(12)
    v_mfma_f32_16x16x32_bf16 v[8:11], v[152:155], v[104:107], v[8:11]
    ds_read_b128 v[116:119], v7 offset:0
    v_mfma_f32_16x16x32_bf16 v[24:27], v[152:155], v[108:111], v[24:27]
    ds_read_b128 v[120:123], v7 offset:1024
    v_mfma_f32_16x16x32_bf16 v[40:43], v[152:155], v[112:115], v[40:43]
    ds_read_b128 v[124:127], v7 offset:4096
    s_waitcnt lgkmcnt(10)
    v_mfma_f32_16x16x32_bf16 v[12:15], v[156:159], v[104:107], v[12:15]
    ds_read_b128 v[128:131], v7 offset:5120
    v_mfma_f32_16x16x32_bf16 v[28:31], v[156:159], v[108:111], v[28:31]
    ds_read_b128 v[132:135], v7 offset:8192
    v_mfma_f32_16x16x32_bf16 v[44:47], v[156:159], v[112:115], v[44:47]
    ds_read_b128 v[136:139], v7 offset:9216
    s_waitcnt lgkmcnt(8)
L_fb:
    ds_read_b32 v140, v165 offset:64
    ds_read_b128 v[56:59], v5 offset:0
    ds_read_b128 v[60:63], v5 offset:1024
    ds_read_b128 v[64:67], v5 offset:2048
    ds_read_b128 v[68:71], v5 offset:3072
    ds_read_b128 v[72:75], v5 offset:4096
    ds_read_b128 v[76:79], v5 offset:5120
    s_waitcnt lgkmcnt(6)
    v_readfirstlane_b32 s96, v140
    v_readfirstlane_b32 s97, v21
    s_cmp_eq_u32 s96, 0
    s_cbranch_scc1 L_fxw
    s_cmp_lt_u32 s97, 2
    s_cbranch_scc1 L_fyw
L_yok:
    v_sub_f32 v18, 1.0, v17
    v_sub_f32 v16, 1.0, v16
    v_sub_f32 v20, 1.0, v20
    s_waitcnt lgkmcnt(5)
    v_pk_add_f32 v[56:57], v[56:57], v[8:9]
    v_pk_add_f32 v[58:59], v[58:59], v[10:11]
    v_pk_fma_f32 v[116:117], v[56:57], v[16:17], v[116:117] op_sel_hi:[1,0,1]
    v_pk_fma_f32 v[118:119], v[58:59], v[16:17], v[118:119] op_sel_hi:[1,0,1]
    v_cvt_pk_bf16_f32 v80, v116, v117
    v_cvt_pk_bf16_f32 v81, v118, v119
    ds_write_b64 v1, v[80:81] offset:0
    s_waitcnt lgkmcnt(5)
    v_pk_add_f32 v[60:61], v[60:61], v[12:13]
    v_pk_add_f32 v[62:63], v[62:63], v[14:15]
    v_pk_fma_f32 v[120:121], v[60:61], v[16:17], v[120:121] op_sel_hi:[1,0,1]
    v_pk_fma_f32 v[122:123], v[62:63], v[16:17], v[122:123] op_sel_hi:[1,0,1]
    v_cvt_pk_bf16_f32 v82, v120, v121
    v_cvt_pk_bf16_f32 v83, v122, v123
    ds_write_b64 v6, v[82:83] offset:0
    ds_read_b128 v[92:95], v5 offset:0
    s_waitcnt lgkmcnt(6)
    v_pk_add_f32 v[64:65], v[64:65], v[24:25]
    v_pk_add_f32 v[66:67], v[66:67], v[26:27]
    v_pk_fma_f32 v[124:125], v[64:65], v[18:19], v[124:125] op_sel_hi:[1,0,1]
    v_pk_fma_f32 v[126:127], v[66:67], v[18:19], v[126:127] op_sel_hi:[1,0,1]
    v_cvt_pk_bf16_f32 v84, v124, v125
    v_cvt_pk_bf16_f32 v85, v126, v127
    ds_write_b64 v1, v[84:85] offset:1024
    s_waitcnt lgkmcnt(6)
    v_pk_add_f32 v[68:69], v[68:69], v[28:29]
    v_pk_add_f32 v[70:71], v[70:71], v[30:31]
    v_pk_fma_f32 v[128:129], v[68:69], v[18:19], v[128:129] op_sel_hi:[1,0,1]
    v_pk_fma_f32 v[130:131], v[70:71], v[18:19], v[130:131] op_sel_hi:[1,0,1]
    v_cvt_pk_bf16_f32 v86, v128, v129
    v_cvt_pk_bf16_f32 v87, v130, v131
    ds_write_b64 v6, v[86:87] offset:1024
    ds_read_b128 v[96:99], v5 offset:1024
    s_waitcnt lgkmcnt(7)
    v_pk_add_f32 v[72:73], v[72:73], v[40:41]
    v_pk_add_f32 v[74:75], v[74:75], v[42:43]
    v_pk_fma_f32 v[132:133], v[72:73], v[20:21], v[132:133] op_sel_hi:[1,0,1]
    v_pk_fma_f32 v[134:135], v[74:75], v[20:21], v[134:135] op_sel_hi:[1,0,1]
    v_cvt_pk_bf16_f32 v88, v132, v133
    v_cvt_pk_bf16_f32 v89, v134, v135
    ds_write_b64 v1, v[88:89] offset:2048
    s_waitcnt lgkmcnt(7)
    v_pk_add_f32 v[76:77], v[76:77], v[44:45]
    v_pk_add_f32 v[78:79], v[78:79], v[46:47]
    v_pk_fma_f32 v[136:137], v[76:77], v[20:21], v[136:137] op_sel_hi:[1,0,1]
    v_pk_fma_f32 v[138:139], v[78:79], v[20:21], v[138:139] op_sel_hi:[1,0,1]
    v_cvt_pk_bf16_f32 v90, v136, v137
    v_cvt_pk_bf16_f32 v91, v138, v139
    ds_write_b64 v6, v[90:91] offset:2048
    ds_read_b128 v[100:103], v5 offset:2048
    s_waitcnt lgkmcnt(6)
    buffer_store_dwordx4 v[92:95], v2, s[48:51], s79 offen
    s_add_u32 s79, s79, 20480
    s_waitcnt lgkmcnt(3)
    buffer_store_dwordx4 v[96:99], v2, s[48:51], s79 offen
    s_add_u32 s79, s79, 20480
    s_waitcnt lgkmcnt(0)
    buffer_store_dwordx4 v[100:103], v2, s[48:51], s79 offen
L_pexit:
    s_endpgm
L_lts:
    s_mov_b32 s100, 0
Lw_77:
    ds_read_b32 v4, v164 offset:80
    s_waitcnt lgkmcnt(0)
    v_readfirstlane_b32 s99, v4
    s_cmp_ge_u32 s99, 1
    s_cbranch_scc1 Lwd_78
    s_add_u32 s100, s100, 1
    s_cmp_lt_u32 s100, 8388608
    s_cbranch_scc1 Lw_77
Lwd_78:
    s_branch L_ltg
L_gpslow:
    s_mov_b32 s100, 0
Lpo_79:
    s_waitcnt lgkmcnt(0)
    s_cmp_eq_u32 s86, s31
    s_cbranch_scc1 Lpd_80
    s_sleep 16
    s_load_dwordx2 s[86:87], s[28:29], s92 offset:8192 glc
    s_add_u32 s100, s100, 1
    s_cmp_lt_u32 s100, 1048576
    s_cbranch_scc1 Lpo_79
    s_waitcnt lgkmcnt(0)
Lpd_80:
    s_and_b32 s92, s87, 0x2000
    s_branch L_gpok
L_fxw:
    s_mov_b32 s100, 0
Lw_81:
    ds_read_b32 v4, v165 offset:64
    s_waitcnt lgkmcnt(0)
    v_readfirstlane_b32 s99, v4
    s_cmp_ge_u32 s99, 1
    s_cbranch_scc1 Lwd_82
    s_add_u32 s100, s100, 1
    s_cmp_lt_u32 s100, 8388608
    s_cbranch_scc1 Lw_81
Lwd_82:
    ds_read_b32 v21, v166 offset:48
    ds_read2_b32 v[16:17], v162 offset0:0 offset1:16
    ds_read_b32 v20, v162 offset:128
    ds_read_b128 v[116:119], v7 offset:0
    ds_read_b128 v[120:123], v7 offset:1024
    ds_read_b128 v[124:127], v7 offset:4096
    ds_read_b128 v[128:131], v7 offset:5120
    ds_read_b128 v[132:135], v7 offset:8192
    ds_read_b128 v[136:139], v7 offset:9216
    s_waitcnt lgkmcnt(8)
    s_branch L_fb
L_fyw:
    s_mov_b32 s100, 0
Lw_83:
    ds_read_b32 v4, v166 offset:48
    s_waitcnt lgkmcnt(0)
    v_readfirstlane_b32 s99, v4
    s_cmp_ge_u32 s99, 2
    s_cbranch_scc1 Lwd_84
    s_add_u32 s100, s100, 1
    s_cmp_lt_u32 s100, 8388608
    s_cbranch_scc1 Lw_83
Lwd_84:
    ds_read2_b32 v[16:17], v162 offset0:0 offset1:16
    ds_read_b32 v20, v162 offset:128
    ds_read_b128 v[116:119], v7 offset:0
    ds_read_b128 v[120:123], v7 offset:1024
    ds_read_b128 v[124:127], v7 offset:4096
    ds_read_b128 v[128:131], v7 offset:5120
    ds_read_b128 v[132:135], v7 offset:8192
    ds_read_b128 v[136:139], v7 offset:9216
    s_waitcnt lgkmcnt(0)
    s_branch L_yok
L_fslow:
    s_mov_b32 s100, 0
L_fs2:
    ds_read2_b32 v[120:121], v3 offset0:0 offset1:4
    s_waitcnt lgkmcnt(0)
    v_add_u32 v120, v120, v121
    s_nop 0
    v_readfirstlane_b32 s97, v120
    s_cmp_ge_u32 s97, s84
    s_cbranch_scc1 L_fgo
    s_add_u32 s100, s100, 1
    s_cmp_lt_u32 s100, 8388608
    s_cbranch_scc1 L_fs2
    s_branch L_fgo
L_ns0:
    s_load_dwordx16 s[4:19], s[76:77], 0 glc
    s_waitcnt lgkmcnt(0)
    s_add_u32 s100, s100, 1
    s_cmp_lt_u32 s100, 1048576
    s_cbranch_scc1 L_nb0
    s_branch L_ng0
L_ns1:
    s_load_dwordx16 s[4:19], s[76:77], 0 glc
    s_waitcnt lgkmcnt(0)
    s_add_u32 s100, s100, 1
    s_cmp_lt_u32 s100, 1048576
    s_cbranch_scc1 L_nb1
    s_branch L_ng1
L_ns2:
    s_load_dwordx16 s[4:19], s[76:77], 0 glc
    s_waitcnt lgkmcnt(0)
    s_add_u32 s100, s100, 1
    s_cmp_lt_u32 s100, 1048576
    s_cbranch_scc1 L_nb2
    s_branch L_ng2
L_ns3:
    s_load_dwordx16 s[4:19], s[76:77], 0 glc
    s_waitcnt lgkmcnt(0)
    s_add_u32 s100, s100, 1
    s_cmp_lt_u32 s100, 1048576
    s_cbranch_scc1 L_nb3
    s_branch L_ng3
L_ns4:
    s_load_dwordx16 s[4:19], s[76:77], 0 glc
    s_waitcnt lgkmcnt(0)
    s_add_u32 s100, s100, 1
    s_cmp_lt_u32 s100, 1048576
    s_cbranch_scc1 L_nb4
    s_branch L_ng4
L_ns6:
    s_load_dwordx16 s[4:19], s[76:77], 0 glc
    s_waitcnt lgkmcnt(0)
    s_add_u32 s100, s100, 1
    s_cmp_lt_u32 s100, 1048576
    s_cbranch_scc1 L_nb6
    s_branch L_ng6
L_end:
    s_endpgm
L_codeend:
.section .rodata,"a"
.p2align 6
.amdhsa_kernel gated_mix__ssm_conv_h3__sliding_local_dilated__prompt_kernel
  .amdhsa_next_free_vgpr 168
  .amdhsa_next_free_sgpr 102
  .amdhsa_accum_offset 168
  .amdhsa_group_segment_fixed_size 0
  .amdhsa_kernarg_size 104
  .amdhsa_user_sgpr_count 2
  .amdhsa_user_sgpr_kernarg_segment_ptr 1
  .amdhsa_system_sgpr_workgroup_id_x 1
.end_amdhsa_kernel
.p2align 7
wg_table:
  .long 0, 0, 0, 96, 0, 0, 1985229328, 152
  .long 0, 5, 0, 206, 0, 0, 554272613, 67
  .long 5, 3, 3, 124, 0, 614400, 158762307, 33
  .long 5, 8, 3, 234, 0, 614400, 1411461272, 118
  .long 11, 0, 0, 151, 3, 1351680, 328730199, 66
  .long 11, 5, 0, 261, 3, 1351680, 1749242114, 151
  .long 21, 3, 3, 179, 4, 2580480, 1175660928, 117
  .long 21, 8, 3, 289, 4, 2580480, 2439541813, 32
  .long 0, 1, 1, 97, 0, 0, 2268413985, 150
  .long 0, 6, 1, 207, 0, 0, 847287670, 65
  .long 5, 4, 4, 125, 2, 614400, 2441569333, 32
  .long 5, 9, 4, 235, 2, 614400, 1177688448, 117
  .long 11, 1, 1, 152, 6, 1351680, 554272613, 67
  .long 11, 6, 1, 262, 6, 1351680, 1985229328, 152
  .long 21, 4, 4, 180, 8, 2580480, 1696675849, 116
  .long 21, 9, 4, 290, 8, 2580480, 276202324, 41
  .long 0, 2, 2, 98, 0, 0, 1749242114, 151
  .long 0, 7, 2, 208, 0, 0, 328730199, 66
  .long 6, 0, 0, 126, 7, 737280, 159868227, 33
  .long 6, 5, 0, 236, 7, 737280, 1412567192, 118
  .long 11, 2, 2, 153, 6, 1351680, 847287670, 65
  .long 11, 7, 2, 263, 6, 1351680, 2268413985, 150
  .long 17, 0, 0, 181, 0, 2088960, 1176582528, 117
  .long 17, 5, 0, 291, 0, 2088960, 2440463413, 32
  .long 0, 3, 3, 99, 3, 0, 1985229328, 152
  .long 0, 8, 3, 209, 3, 0, 554272613, 67
  .long 6, 1, 1, 127, 7, 737280, 275280724, 41
  .long 6, 6, 1, 237, 7, 737280, 1695754249, 116
  .long 11, 3, 3, 154, 6, 1351680, 328730199, 66
  .long 11, 8, 3, 264, 6, 1351680, 1749242114, 151
  .long 17, 1, 1, 182, 3, 2088960, 1412567192, 118
  .long 17, 6, 1, 292, 3, 2088960, 159868227, 33
  .long 0, 4, 4, 100, 3, 0, 2268413985, 150
  .long 0, 9, 4, 210, 3, 0, 847287670, 65
  .long 6, 2, 2, 128, 9, 737280, 2440463413, 32
  .long 6, 7, 2, 238, 9, 737280, 1176582528, 117
  .long 11, 4, 4, 155, 9, 1351680, 554272613, 67
  .long 11, 9, 4, 265, 9, 1351680, 1985229328, 152
  .long 17, 2, 2, 183, 3, 2088960, 1695754249, 116
  .long 17, 7, 2, 293, 3, 2088960, 275280724, 41
  .long 1, 0, 0, 101, 2, 122880, 2268413985, 150
  .long 1, 5, 0, 211, 2, 122880, 847287670, 65
  .long 6, 3, 3, 129, 0, 737280, 159868227, 33
  .long 6, 8, 3, 239, 0, 737280, 1412567192, 118
  .long 12, 0, 0, 156, 5, 1474560, 554272613, 67
  .long 12, 5, 0, 266, 5, 1474560, 1985229328, 152
  .long 17, 3, 3, 184, 3, 2088960, 1176582528, 117
  .long 17, 8, 3, 294, 3, 2088960, 2440463413, 32
  .long 1, 1, 1, 102, 2, 122880, 1749242114, 151
  .long 1, 6, 1, 212, 2, 122880, 328730199, 66
  .long 6, 4, 4, 130, 0, 737280, 275280724, 41
  .long 6, 9, 4, 240, 0, 737280, 1695754249, 116
  .long 12, 1, 1, 157, 8, 1474560, 847287670, 65
  .long 12, 6, 1, 267, 8, 1474560, 2268413985, 150
  .long 17, 4, 4, 185, 6, 2088960, 1412567192, 118
  .long 17, 9, 4, 295, 6, 2088960, 159868227, 33
  .long 1, 2, 2, 103, 2, 122880, 1985229328, 152
  .long 1, 7, 2, 213, 2, 122880, 554272613, 67
  .long 7, 0, 0, 131, 6, 860160, 275280724, 41
  .long 7, 5, 0, 241, 6, 860160, 1695754249, 116
  .long 12, 2, 2, 158, 8, 1474560, 328730199, 66
  .long 12, 7, 2, 268, 8, 1474560, 1749242114, 151
  .long 18, 0, 0, 186, 2, 2211840, 1412567192, 118
  .long 18, 5, 0, 296, 2, 2211840, 159868227, 33
  .long 1, 3, 3, 104, 5, 122880, 2268413985, 150
  .long 1, 8, 3, 214, 5, 122880, 847287670, 65
  .long 7, 1, 1, 132, 6, 860160, 2440463413, 32
  .long 7, 6, 1, 242, 6, 860160, 1176582528, 117
  .long 12, 3, 3, 159, 8, 1474560, 554272613, 67
  .long 12, 8, 3, 269, 8, 1474560, 1985229328, 152
  .long 18, 1, 1, 187, 5, 2211840, 1695754249, 116
  .long 18, 6, 1, 297, 5, 2211840, 275280724, 41
  .long 1, 4, 4, 105, 5, 122880, 1749242114, 151
  .long 1, 9, 4, 215, 5, 122880, 328730199, 66
  .long 7, 2, 2, 133, 9, 860160, 159868227, 33
  .long 7, 7, 2, 243, 9, 860160, 1412567192, 118
  .long 12, 4, 4, 160, 9, 1474560, 847287670, 65
  .long 12, 9, 4, 270, 9, 1474560, 2268413985, 150
  .long 18, 2, 2, 188, 5, 2211840, 1176582528, 117
  .long 18, 7, 2, 298, 5, 2211840, 2440463413, 32
  .long 2, 0, 0, 106, 1, 245760, 1749242114, 151
  .long 2, 5, 0, 216, 1, 245760, 328730199, 66
  .long 7, 3, 3, 134, 2, 860160, 275280724, 41
  .long 7, 8, 3, 244, 2, 860160, 1695754249, 116
  .long 13, 0, 0, 161, 4, 1597440, 847287670, 65
  .long 13, 5, 0, 271, 4, 1597440, 2268413985, 150
  .long 18, 3, 3, 189, 5, 2211840, 1412567192, 118
  .long 18, 8, 3, 299, 5, 2211840, 159868227, 33
  .long 2, 1, 1, 107, 1, 245760, 1985229328, 152
  .long 2, 6, 1, 217, 1, 245760, 554272613, 67
  .long 7, 4, 4, 135, 2, 860160, 2440463413, 32
  .long 7, 9, 4, 245, 2, 860160, 1176582528, 117
  .long 13, 1, 1, 162, 7, 1597440, 328730199, 66
  .long 13, 6, 1, 272, 7, 1597440, 1749242114, 151
  .long 18, 4, 4, 190, 8, 2211840, 1695754249, 116
  .long 18, 9, 4, 300, 8, 2211840, 275280724, 41
  .long 2, 2, 2, 108, 1, 245760, 2268413985, 150
  .long 2, 7, 2, 218, 1, 245760, 847287670, 65
  .long 8, 0, 0, 136, 8, 983040, 2440463413, 32
  .long 8, 5, 0, 246, 8, 983040, 1176582528, 117
  .long 13, 2, 2, 163, 7, 1597440, 554272613, 67
  .long 13, 7, 2, 273, 7, 1597440, 1985229328, 152
  .long 19, 0, 0, 191, 1, 2334720, 1695754249, 116
  .long 19, 5, 0, 301, 1, 2334720, 275280724, 41
  .long 2, 3, 3, 109, 4, 245760, 1749242114, 151
  .long 2, 8, 3, 219, 4, 245760, 328730199, 66
  .long 8, 1, 1, 137, 8, 983040, 159868227, 33
  .long 8, 6, 1, 247, 8, 983040, 1412567192, 118
  .long 13, 3, 3, 164, 7, 1597440, 847287670, 65
  .long 13, 8, 3, 274, 7, 1597440, 2268413985, 150
  .long 19, 1, 1, 192, 4, 2334720, 1176582528, 117
  .long 19, 6, 1, 302, 4, 2334720, 2440463413, 32
  .long 2, 4, 4, 110, 4, 245760, 1985229328, 152
  .long 2, 9, 4, 220, 4, 245760, 554272613, 67
  .long 8, 2, 2, 138, 9, 983040, 275280724, 41
  .long 8, 7, 2, 248, 9, 983040, 1695754249, 116
  .long 13, 4, 4, 165, 9, 1597440, 328730199, 66
  .long 13, 9, 4, 275, 9, 1597440, 1749242114, 151
  .long 19, 2, 2, 193, 4, 2334720, 1412567192, 118
  .long 19, 7, 2, 303, 4, 2334720, 159868227, 33
  .long 3, 0, 0, 111, 0, 368640, 1985229328, 152
  .long 3, 5, 0, 221, 0, 368640, 554272613, 67
  .long 8, 3, 3, 139, 1, 983040, 2440463413, 32
  .long 8, 8, 3, 249, 1, 983040, 1176582528, 117
  .long 14, 0, 0, 166, 3, 1720320, 328730199, 66
  .long 14, 5, 0, 276, 3, 1720320, 1749242114, 151
  .long 19, 3, 3, 194, 4, 2334720, 1695754249, 116
  .long 19, 8, 3, 304, 4, 2334720, 275280724, 41
  .long 3, 1, 1, 112, 0, 368640, 2268413985, 150
  .long 3, 6, 1, 222, 0, 368640, 847287670, 65
  .long 8, 4, 4, 140, 1, 983040, 159868227, 33
  .long 8, 9, 4, 250, 1, 983040, 1412567192, 118
  .long 14, 1, 1, 167, 6, 1720320, 554272613, 67
  .long 14, 6, 1, 277, 6, 1720320, 1985229328, 152
  .long 19, 4, 4, 195, 7, 2334720, 1176582528, 117
  .long 19, 9, 4, 305, 7, 2334720, 2440463413, 32
  .long 3, 2, 2, 113, 0, 368640, 1749242114, 151
  .long 3, 7, 2, 223, 0, 368640, 328730199, 66
  .long 9, 0, 0, 141, 7, 1105920, 159868227, 33
  .long 9, 5, 0, 251, 7, 1105920, 1412567192, 118
  .long 14, 2, 2, 168, 6, 1720320, 847287670, 65
  .long 14, 7, 2, 278, 6, 1720320, 2268413985, 150
  .long 20, 0, 0, 196, 0, 2457600, 1176582528, 117
  .long 20, 5, 0, 306, 0, 2457600, 2440463413, 32
  .long 3, 3, 3, 114, 3, 368640, 1985229328, 152
  .long 3, 8, 3, 224, 3, 368640, 554272613, 67
  .long 9, 1, 1, 142, 7, 1105920, 275280724, 41
  .long 9, 6, 1, 252, 7, 1105920, 1695754249, 116
  .long 14, 3, 3, 169, 6, 1720320, 328730199, 66
  .long 14, 8, 3, 279, 6, 1720320, 1749242114, 151
  .long 20, 1, 1, 197, 3, 2457600, 1412567192, 118
  .long 20, 6, 1, 307, 3, 2457600, 159868227, 33
  .long 3, 4, 4, 115, 3, 368640, 2268413985, 150
  .long 3, 9, 4, 225, 3, 368640, 847287670, 65
  .long 9, 2, 2, 143, 9, 1105920, 2440463413, 32
  .long 9, 7, 2, 253, 9, 1105920, 1176582528, 117
  .long 14, 4, 4, 170, 9, 1720320, 554272613, 67
  .long 14, 9, 4, 280, 9, 1720320, 1985229328, 152
  .long 20, 2, 2, 198, 3, 2457600, 1695754249, 116
  .long 20, 7, 2, 308, 3, 2457600, 275280724, 41
  .long 4, 0, 0, 116, 2, 491520, 2268413985, 150
  .long 4, 5, 0, 226, 2, 491520, 847287670, 65
  .long 9, 3, 3, 144, 0, 1105920, 159868227, 33
  .long 9, 8, 3, 254, 0, 1105920, 1412567192, 118
  .long 15, 0, 0, 171, 5, 1843200, 554272613, 67
  .long 15, 5, 0, 281, 5, 1843200, 1985229328, 152
  .long 20, 3, 3, 199, 3, 2457600, 1176582528, 117
  .long 20, 8, 3, 309, 3, 2457600, 2440463413, 32
  .long 4, 1, 1, 117, 2, 491520, 1749242114, 151
  .long 4, 6, 1, 227, 2, 491520, 328730199, 66
  .long 9, 4, 4, 145, 0, 1105920, 275280724, 41
  .long 9, 9, 4, 255, 0, 1105920, 1695754249, 116
  .long 15, 1, 1, 172, 8, 1843200, 847287670, 65
  .long 15, 6, 1, 282, 8, 1843200, 2268413985, 150
  .long 20, 4, 4, 200, 6, 2457600, 1412567192, 118
  .long 20, 9, 4, 310, 6, 2457600, 159868227, 33
  .long 4, 2, 2, 118, 2, 491520, 1985229328, 152
  .long 4, 7, 2, 228, 2, 491520, 554272613, 67
  .long 10, 0, 0, 146, 6, 1228800, 275280724, 41
  .long 10, 5, 0, 256, 6, 1228800, 1695754249, 116
  .long 15, 2, 2, 173, 8, 1843200, 328730199, 66
  .long 15, 7, 2, 283, 8, 1843200, 1749242114, 151
  .long 16, 0, 0, 201, 2, 1966080, 1412567192, 118
  .long 16, 5, 0, 311, 2, 1966080, 159868227, 33
  .long 4, 3, 3, 119, 5, 491520, 2268413985, 150
  .long 4, 8, 3, 229, 5, 491520, 847287670, 65
  .long 10, 1, 1, 147, 6, 1228800, 2440463413, 32
  .long 10, 6, 1, 257, 6, 1228800, 1176582528, 117
  .long 15, 3, 3, 174, 8, 1843200, 554272613, 67
  .long 15, 8, 3, 284, 8, 1843200, 1985229328, 152
  .long 16, 1, 1, 202, 5, 1966080, 1695754249, 116
  .long 16, 6, 1, 312, 5, 1966080, 275280724, 41
  .long 4, 4, 4, 120, 5, 491520, 1749242114, 151
  .long 4, 9, 4, 230, 5, 491520, 328730199, 66
  .long 10, 2, 2, 148, 9, 1228800, 159868227, 33
  .long 10, 7, 2, 258, 9, 1228800, 1412567192, 118
  .long 15, 4, 4, 175, 9, 1843200, 847287670, 65
  .long 15, 9, 4, 285, 9, 1843200, 2268413985, 150
  .long 16, 2, 2, 203, 5, 1966080, 1176582528, 117
  .long 16, 7, 2, 313, 5, 1966080, 2440463413, 32
  .long 5, 0, 0, 121, 1, 614400, 1749242114, 151
  .long 5, 5, 0, 231, 1, 614400, 328730199, 66
  .long 10, 3, 3, 149, 2, 1228800, 275280724, 41
  .long 10, 8, 3, 259, 2, 1228800, 1695754249, 116
  .long 21, 0, 0, 176, 4, 2580480, 847287670, 65
  .long 21, 5, 0, 286, 4, 2580480, 2268413985, 150
  .long 16, 3, 3, 204, 5, 1966080, 1412567192, 118
  .long 16, 8, 3, 314, 5, 1966080, 159868227, 33
  .long 5, 1, 1, 122, 1, 614400, 1985229328, 152
  .long 5, 6, 1, 232, 1, 614400, 554272613, 67
  .long 10, 4, 4, 150, 2, 1228800, 2440463413, 32
  .long 10, 9, 4, 260, 2, 1228800, 1176582528, 117
  .long 21, 1, 1, 177, 7, 2580480, 328730199, 66
  .long 21, 6, 1, 287, 7, 2580480, 1749242114, 151
  .long 16, 4, 4, 205, 8, 1966080, 1695754249, 116
  .long 16, 9, 4, 315, 8, 1966080, 275280724, 41
  .long 5, 2, 2, 123, 1, 614400, 2268413985, 150
  .long 5, 7, 2, 233, 1, 614400, 847287670, 65
  .long 0, 0, 0, 0, 0, 0, 0, 0
  .long 0, 1, 0, 1, 0, 0, 0, 0
  .long 21, 2, 2, 178, 7, 2580480, 554272613, 67
  .long 21, 7, 2, 288, 7, 2580480, 1985229328, 152
  .long 0, 0, 0, 2, 0, 0, 0, 0
  .long 0, 1, 0, 3, 0, 0, 0, 0
  .long 0, 0, 0, 4, 0, 0, 0, 0
  .long 0, 1, 0, 5, 0, 0, 0, 0
  .long 0, 0, 0, 6, 0, 0, 0, 0
  .long 0, 1, 0, 7, 0, 0, 0, 0
  .long 0, 0, 0, 8, 0, 0, 0, 0
  .long 0, 1, 0, 9, 0, 0, 0, 0
  .long 0, 0, 0, 10, 0, 0, 0, 0
  .long 0, 1, 0, 11, 0, 0, 0, 0
  .long 0, 0, 0, 12, 0, 0, 0, 0
  .long 0, 1, 0, 13, 0, 0, 0, 0
  .long 0, 0, 0, 14, 0, 0, 0, 0
  .long 0, 1, 0, 15, 0, 0, 0, 0
  .long 0, 0, 0, 16, 0, 0, 0, 0
  .long 0, 1, 0, 17, 0, 0, 0, 0
  .long 0, 0, 0, 18, 0, 0, 0, 0
  .long 0, 1, 0, 19, 0, 0, 0, 0
  .long 0, 0, 0, 20, 0, 0, 0, 0
  .long 0, 1, 0, 21, 0, 0, 0, 0
  .long 0, 0, 0, 22, 0, 0, 0, 0
  .long 0, 1, 0, 23, 0, 0, 0, 0
  .long 0, 0, 0, 24, 0, 0, 0, 0
  .long 0, 1, 0, 25, 0, 0, 0, 0
  .long 0, 0, 0, 26, 0, 0, 0, 0
  .long 0, 1, 0, 27, 0, 0, 0, 0
  .long 0, 0, 0, 316, 0, 0, 0, 0
  .long 0, 1, 0, 317, 0, 0, 0, 0
  .long 0, 0, 0, 318, 0, 0, 0, 0
  .long 0, 1, 0, 319, 0, 0, 0, 0
  .long 0, 0, 0, 28, 0, 0, 0, 0
  .long 0, 1, 0, 29, 0, 0, 0, 0
  .long 0, 0, 0, 30, 0, 0, 0, 0
  .long 0, 1, 0, 31, 0, 0, 0, 0
```

```asm
; @launch grid=(256,1,1) block=(768,1,1) lds=163840
.amdgcn_target "amdgcn-amd-amdhsa--gfx950"
.text
.globl gated_mix__ssm_conv_h3__sliding_local_dilated__prompt_kernel
.p2align 8
.type gated_mix__ssm_conv_h3__sliding_local_dilated__prompt_kernel,@function
gated_mix__ssm_conv_h3__sliding_local_dilated__prompt_kernel:
    s_load_dwordx16 s[4:19], s[0:1], 0
    s_getpc_b64 s[46:47]
L_pc:
    s_add_u32 s44, s46, wg_table@rel32@lo+4
    s_addc_u32 s45, s47, wg_table@rel32@hi+12
    s_and_b32 s97, s2, 255
    s_lshl_b32 s97, s97, 5
    s_load_dwordx8 s[32:39], s[44:45], s97
    s_lshr_b32 s96, s2, 3
    s_lshl_b32 s97, s96, 7
    v_lshl_add_u32 v5, v0, 12, s97
    v_cmp_gt_u32 vcc, L_codeend-L_pc-4, v5
    s_and_saveexec_b64 s[50:51], vcc
    s_cbranch_execz L_nopf
    global_load_dword v166, v5, s[46:47]
L_nopf:
    s_mov_b64 exec, -1
    s_load_dwordx8 s[20:27], s[0:1], 64
    s_load_dwordx2 s[28:29], s[0:1], 96
    v_lshrrev_b32 v4, 6, v0
    v_and_b32 v0, 63, v0
    v_readfirstlane_b32 s30, v4
    s_cmp_ge_u32 s96, 32
    s_cbranch_scc1 L_end
    v_lshrrev_b32 v2, 4, v0
    v_and_b32 v1, 15, v0
    v_lshrrev_b32 v4, 3, v0
    v_and_b32 v5, 7, v0
    s_lshl_b32 s99, s2, 2
    s_lshr_b32 s99, 0x55445544, s99
    s_and_b32 s99, s99, 15
    s_add_u32 s99, s99, s96
    s_lshr_b32 s3, s99, 5
    s_cbranch_scc1 L_a
    s_cmp_ge_u32 s30, 3
    s_cbranch_scc1 L_notld
    s_setprio 3
    s_mov_b32 s51, 0
    s_mul_i32 s52, s30, 12288
    s_addk_i32 s52, 2048
    s_min_u32 s98, s30, 1
    s_lshr_b32 s54, s30, 1
    s_mul_i32 s54, s54, 122880
    v_lshlrev_b32 v6, s98, v2
    v_and_b32 v6, 3, v6
    v_xor_b32 v5, v5, v6
    s_mulk_i32 s98, 2560
    s_addk_i32 s98, 1280
    v_mul_u32_u24 v4, s98, v4
    v_lshl_add_u32 v8, v5, 4, v4
    v_xor_b32 v9, 64, v8
    s_lshl_b32 s56, s98, 3
    s_addk_i32 s56, -1024
    s_mov_b32 s43, 0x00020000
    s_cmp_eq_u32 s30, 0
    s_movk_i32 s57, 13312
    s_cselect_b32 s57, s57, 4294879488
    s_movk_i32 s58, 128
    s_cselect_b32 s58, s58, 245760
    s_mov_b32 s42, 2621440
    s_cselect_b32 s42, s42, 2457600
    s_waitcnt lgkmcnt(0)
    s_cselect_b64 s[40:41], s[4:5], s[18:19]
    s_mul_i32 s96, s33, 128
    s_cselect_b32 s96, s37, s96
    s_add_u32 s54, s54, s96
    s_and_b32 s53, s38, 15
    s_lshr_b64 s[38:39], s[38:39], 4
    s_mov_b32 m0, s52
    s_mul_i32 s96, s53, s58
    s_add_u32 s50, s96, s54
    s_branch L_ld
L_ldb:
    s_barrier
L_ld2:
L_ld:
    buffer_load_dwordx4 v8, s[40:43], s50 offen offset:0 lds
    s_add_u32 s50, s50, s56
    buffer_load_dwordx4 v9, s[40:43], s50 offen offset:1024 lds
    s_add_u32 s50, s50, s56
    s_add_u32 s51, s51, 1
    s_cmp_lg_u32 s51, 3
    s_cbranch_scc1 L_ldt
    s_load_dword s31, s[28:29], 0
L_ldt:
    buffer_load_dwordx4 v8, s[40:43], s50 offen offset:2048 lds
    s_add_u32 s50, s50, s56
    s_and_b32 s53, s38, 15
    s_lshr_b64 s[38:39], s[38:39], 4
    s_mul_i32 s55, s53, s58
    s_add_u32 s55, s55, s54
    buffer_load_dwordx4 v9, s[40:43], s50 offen offset:3072 lds
    s_add_u32 s50, s50, s57
    s_add_u32 m0, m0, 4096
    s_add_u32 s52, s52, 38912
    s_cmp_ge_u32 s52, 116736
    s_cselect_b32 s96, 116736, 0
    s_sub_u32 s52, s52, s96
    buffer_load_dwordx4 v8, s[40:43], s50 offen offset:0 lds
    s_add_u32 s50, s50, s56
    s_cmp_lg_u32 s51, 10
    s_cbranch_scc1 L_ldp
    s_lshl_b32 s92, s2, 7
    s_and_b32 s92, s92, 0x1f80
    s_load_dwordx2 s[86:87], s[28:29], s92 offset:8192
L_ldp:
    buffer_load_dwordx4 v9, s[40:43], s50 offen offset:1024 lds
    s_add_u32 s50, s50, s56
    buffer_load_dwordx4 v8, s[40:43], s50 offen offset:2048 lds
    s_add_u32 s50, s50, s56
    buffer_load_dwordx4 v9, s[40:43], s50 offen offset:3072 lds
    s_add_u32 s50, s50, s57
    s_add_u32 m0, m0, 4096
    s_nop 0
    buffer_load_dwordx4 v8, s[40:43], s50 offen offset:0 lds
    s_add_u32 s50, s50, s56
    buffer_load_dwordx4 v9, s[40:43], s50 offen offset:1024 lds
    s_add_u32 s50, s50, s56
    buffer_load_dwordx4 v8, s[40:43], s50 offen offset:2048 lds
    s_add_u32 s50, s50, s56
    buffer_load_dwordx4 v9, s[40:43], s50 offen offset:3072 lds
    s_mov_b32 m0, s52
    s_mov_b32 s50, s55
    s_cmp_lt_u32 s51, 2
    s_cbranch_scc1 L_ld2
    s_cmp_lt_u32 s51, 10
    s_waitcnt vmcnt(12) lgkmcnt(0)
    s_cbranch_scc1 L_ldb
    s_barrier
    s_setprio 0
    s_waitcnt vmcnt(0)
    s_barrier
    v_mov_b32 v3, 160960
    s_mov_b32 s101, 1
    s_cmp_lg_u32 s30, 0
    s_cbranch_scc1 L_ps
    s_branch L_s0
L_a:
    s_lshr_b32 s96, s30, 2
    s_lshl_b32 s98, s96, 5
    s_mul_i32 s41, s96, 42752
    s_add_u32 s41, s41, 1024
    s_mov_b32 s54, s41
    s_branch L_c
L_notld:
    s_cmp_lt_u32 s30, 8
    s_cbranch_scc1 L_hg
    s_mov_b32 s98, 0
    s_mov_b32 s41, 116736
    s_mov_b32 s54, 116736
L_c:
    s_and_b32 s40, s30, 3
    v_mul_u32_u24 v4, 1280, v4
    v_lshrrev_b32 v6, 1, v2
    v_xor_b32 v5, v5, v6
    s_lshl_b32 s96, s40, 2
    s_and_b32 s96, s96, 4
    v_xor_b32 v5, s96, v5
    v_lshl_add_u32 v22, v5, 4, v4
    v_xor_b32 v23, 32, v22
    s_waitcnt lgkmcnt(0)
    s_add_u32 s43, s35, s98
    s_cmp_ge_u32 s43, 320
    s_cbranch_scc1 L_idle
    s_lshr_b32 s55, s43, 5
    s_and_b32 s63, s43, 31
    s_lshl2_add_u32 s96, s55, s40
    s_lshl_b32 s96, s96, 7
    v_lshl_add_u32 v21, v1, 3, s96
    v_lshlrev_b32 v12, 4, v0
    s_lshr_b32 s96, s40, 1
    s_lshl1_add_u32 s42, s43, s96
    s_mul_i32 s96, s96, 8320
    s_add_u32 s96, s96, s41
    s_add_u32 s62, s96, 16960
    s_and_b32 s97, s40, 1
    s_lshl_b32 s98, s97, 11
    s_add_u32 s60, s98, s62
    s_lshl_b32 s96, s42, 12
    s_add_u32 s61, s96, s98
    s_mov_b32 s46, 2621440
    s_mov_b32 s47, 0x00020000
    s_mov_b64 s[50:51], s[46:47]
    s_setprio 1
    s_cmp_ge_u32 s30, 4
    s_cbranch_scc1 L_c2
    s_lshl2_add_u32 s96, s63, s40
    s_mul_i32 s96, s96, 20480
    s_lshl_b32 s97, s55, 7
    s_add_u32 s96, s96, s97
    s_lshl_b32 s97, s40, 11
    s_add_u32 s97, s97, s41
    s_add_u32 m0, s97, 8704
    s_add_u32 s98, s96, 9216
    s_waitcnt lgkmcnt(0)
    s_mov_b64 s[48:49], s[8:9]
    buffer_load_dwordx4 v22, s[48:51], s96 offen lds
    buffer_load_dwordx4 v23, s[48:51], s98 offen offset:1024 lds
    s_sub_u32 m0, m0, 8192
    s_mov_b64 s[44:45], s[6:7]
    buffer_load_dwordx4 v22, s[44:47], s96 offen lds
    buffer_load_dwordx4 v23, s[44:47], s98 offen offset:1024 lds
    global_load_dwordx2 v[14:15], v21, s[10:11]
    s_cmp_lg_u32 s40, 3
    s_cbranch_scc1 Lkv_1
    s_sub_u32 s96, s96, 71680
    s_cselect_b32 s96, 0x40000000, s96
    s_sub_u32 m0, s41, 512
    s_mov_b32 exec_lo, 0
    buffer_load_dwordx4 v23, s[44:47], s96 offen lds
    s_mov_b32 exec_lo, -1
Lkv_1:
    s_mov_b64 s[48:49], s[12:13]
    s_mov_b32 m0, s60
    s_sub_u32 s96, s61, 16
    s_bitcmp1_b32 s40, 0
    s_cselect_b32 s96, s96, 0x40000000
    buffer_load_dwordx4 v12, s[48:51], s61 offen lds
    buffer_load_dwordx4 v12, s[48:51], s61 offen offset:1024 lds
    s_sub_u32 m0, s60, 16
    s_mov_b64 exec, 1
    buffer_load_dwordx4 v12, s[48:51], s96 offen lds
    s_mov_b64 exec, -1
L_c2:
    s_lshr_b32 s96, s30, 2
    s_lshl_b32 s96, s96, 6
    s_add_u32 s96, s96, 160768
    v_mov_b32 v3, s96
    v_mov_b32 v6, 0
    s_lshl_b32 s96, s40, 8
    s_add_u32 s96, s96, s41
    v_lshl_add_u32 v5, v0, 2, s96
    ds_write_b32 v5, v6 offset:41728
    s_mul_i32 s96, s40, 4160
    s_add_u32 s96, s96, s41
    v_lshl_add_u32 v5, v1, 2, s96
    ds_write_b32 v5, v6 offset:16896
    v_lshl_add_u32 v5, v1, 2, v3
    ds_write_b32 v5, v6
    v_and_b32 v4, 1, v2
    v_lshrrev_b32 v5, 1, v2
    v_lshlrev_b32 v6, 2, v1
    v_sub_u32 v6, v6, v4
    s_add_u32 s96, s41, 256
    v_lshl_add_u32 v6, v6, 7, s96
    s_lshl_b32 s97, s40, 1
    v_or_b32 v7, s97, v5
    v_sub_u32 v9, v1, v4
    v_subrev_u32 v10, 1, v1
    v_xor_b32 v8, v1, v7
    v_and_b32 v8, 7, v8
    v_lshl_add_u32 v8, v8, 4, v6
    v_xor_b32 v9, v9, v7
    v_and_b32 v9, 7, v9
    v_lshl_add_u32 v9, v9, 4, v6
    v_xor_b32 v10, v10, v7
    v_and_b32 v10, 7, v10
    v_lshl_add_u32 v10, v10, 4, v6
    v_mul_u32_u24 v7, 136, v4
    v_add_u32 v13, v8, v7
    v_and_b32 v6, 1, v1
    v_xor_b32 v16, v4, v6
    v_lshlrev_b32 v16, 4, v16
    v_lshlrev_b32 v6, 4, v6
    v_mov_b32 v7, 0xffff
    v_lshlrev_b32 v6, v6, v7
    v_lshrrev_b32 v7, 1, v1
    v_lshlrev_b32 v5, 2, v5
    v_sub_u32 v7, v7, v5
    v_cmp_eq_u32 vcc, 0, v7
    s_nop 1
    v_cndmask_b32 v17, 0, v6, vcc
    v_cmp_eq_u32 vcc, 1, v7
    s_nop 1
    v_cndmask_b32 v18, 0, v6, vcc
    v_cmp_eq_u32 vcc, 2, v7
    s_nop 1
    v_cndmask_b32 v19, 0, v6, vcc
    v_cmp_eq_u32 vcc, 3, v7
    s_nop 1
    v_cndmask_b32 v20, 0, v6, vcc
    v_not_b32 v4, v0
    v_bfe_u32 v5, v4, 1, 2
    v_lshlrev_b32 v5, 4, v5
    v_bfe_u32 v6, v4, 3, 1
    v_lshl_add_u32 v5, v6, 7, v5
    v_xor_b32 v6, s63, v4
    v_and_b32 v6, 1, v6
    v_lshl_add_u32 v5, v6, 6, v5
    v_lshl_add_u32 v5, v2, 14, v5
    s_lshl2_add_u32 s96, s55, s40
    s_lshl_b32 s97, s96, 16
    s_lshl_b32 s98, s63, 8
    s_sub_u32 s97, s97, s98
    s_add_u32 s97, s97, 2105088
    v_add_u32 v11, s97, v5
    s_lshl_b32 s97, s96, 10
    s_lshl2_add_u32 s97, s63, s97
    s_add_u32 s64, s97, 65536
    s_and_b32 s96, s43, -8
    s_cmp_ge_u32 s55, 3
    s_cselect_b32 s96, s96, s43
    s_lshl_b32 s96, s96, 7
    s_add_u32 s65, s96, 65536
    s_waitcnt lgkmcnt(0)
    s_load_dword s31, s[28:29], 0
    s_lshl_b32 s96, s43, 2
    s_load_dword s53, s[14:15], s96
    s_cmp_lg_u32 s3, 0
    s_cbranch_scc1 L_akv
    s_mul_i32 s96, s36, 43
    s_lshr_b32 s96, s96, 7
    s_mul_i32 s96, s96, 3
    s_sub_u32 s96, s36, s96
    s_mul_i32 s97, s96, 38912
    v_lshrrev_b32 v4, 1, v1
    v_lshrrev_b32 v5, 1, v2
    v_xor_b32 v4, v4, v5
    s_lshl_b32 s96, s40, 1
    v_xor_b32 v4, s96, v4
    v_lshlrev_b32 v4, 4, v4
    v_lshl_add_u32 v4, v1, 7, v4
    v_and_b32 v5, 1, v2
    v_lshl_add_u32 v4, v5, 3, v4
    v_add_u32 v166, s97, v4
    s_barrier
    s_cmp_lg_u32 s36, 0
    s_cbranch_scc1 Lq_2
    ds_read_b64 v[112:113], v166 offset:2048
    ds_read_b64 v[114:115], v166 offset:4096
    ds_read_b64 v[116:117], v166 offset:6144
    ds_read_b64 v[118:119], v166 offset:8192
    ds_read_b64 v[120:121], v166 offset:10240
    ds_read_b64 v[122:123], v166 offset:12288
    s_waitcnt lgkmcnt(0)
Lq_2:
    s_setprio 0
    s_cmp_eq_u32 s32, 21
    s_cselect_b32 s97, 0xc0, 0
    v_add_u32 v4, 0, v0
    v_mul_u32_u24 v5, 5462, v4
    v_lshrrev_b32 v5, 16, v5
    v_lshrrev_b32 v6, 1, v5
    v_mul_u32_u24 v5, 3904, v5
    v_lshl_add_u32 v5, v6, 13, v5
    v_lshl_add_u32 v144, v4, 4, v5
    v_and_b32 v5, s97, v144
    v_lshl_add_u32 v144, v5, 22, v144
    v_add_u32 v4, 64, v0
    v_mul_u32_u24 v5, 5462, v4
    v_lshrrev_b32 v5, 16, v5
    v_lshrrev_b32 v6, 1, v5
    v_mul_u32_u24 v5, 3904, v5
    v_lshl_add_u32 v5, v6, 13, v5
    v_lshl_add_u32 v145, v4, 4, v5
    v_and_b32 v5, s97, v145
    v_lshl_add_u32 v145, v5, 22, v145
    v_add_u32 v4, 128, v0
    v_mul_u32_u24 v5, 5462, v4
    v_lshrrev_b32 v5, 16, v5
    v_lshrrev_b32 v6, 1, v5
    v_mul_u32_u24 v5, 3904, v5
    v_lshl_add_u32 v5, v6, 13, v5
    v_lshl_add_u32 v146, v4, 4, v5
    v_and_b32 v5, s97, v146
    v_lshl_add_u32 v146, v5, 22, v146
    s_xor_b32 s96, s40, 1
    s_lshl_b32 s96, s96, 12
    s_add_u32 s96, s96, 116736
    v_lshrrev_b32 v4, 2, v0
    v_mul_u32_u24 v4, 192, v4
    v_and_b32 v5, 3, v0
    v_lshl_add_u32 v4, v5, 3, v4
    v_add_u32 v147, s96, v4
L_cs:
    s_and_b32 s97, s40, 1
    v_add_u32 v156, s60, v12
    s_lshl_b32 s98, s97, 8
    s_add_u32 s96, s62, s98
    s_add_u32 s96, s96, 4132
    v_lshrrev_b32 v4, 1, v1
    v_lshl_add_u32 v4, v2, 2, v4
    v_lshl_add_u32 v4, v4, 2, s96
    v_and_b32 v5, 1, v1
    v_mul_u32_u24 v5, 4160, v5
    v_sub_u32 v148, v4, v5
    v_add_u32 v149, 1024, v148
    v_add_u32 v150, 2048, v148
    v_add_u32 v151, 3072, v148
    v_lshlrev_b32 v4, 1, v1
    v_sub_u32 v4, v2, v4
    s_lshl_b32 s98, s97, 4
    s_add_u32 s98, s98, 30
    v_add_u32 v4, s98, v4
    s_lshr_b32 s98, s40, 1
    s_add_u32 s96, s41, 33536
    v_and_b32 v5, 3, v4
    v_lshl_add_u32 v5, v5, 4, s96
    v_lshrrev_b32 v6, 2, v4
    v_lshl_add_u32 v5, v6, 7, v5
    v_bfe_u32 v6, v4, 3, 1
    v_xor_b32 v6, s98, v6
    v_lshl_add_u32 v152, v6, 6, v5
    v_xor_b32 v154, 64, v152
    v_add_u32 v4, 4, v4
    v_and_b32 v5, 3, v4
    v_lshl_add_u32 v5, v5, 4, s96
    v_lshrrev_b32 v6, 2, v4
    v_lshl_add_u32 v5, v6, 7, v5
    v_bfe_u32 v6, v4, 3, 1
    v_xor_b32 v6, s98, v6
    v_lshl_add_u32 v153, v6, 6, v5
    v_xor_b32 v155, 64, v153
    v_and_b32 v5, 1, v2
    v_lshlrev_b32 v5, 9, v5
    v_lshl_add_u32 v5, v1, 5, v5
    v_lshrrev_b32 v6, 1, v2
    v_lshl_add_u32 v5, v6, 4, v5
    s_lshl_b32 s96, s43, 14
    s_lshl_b32 s97, s40, 11
    s_and_b32 s97, s97, 4096
    s_add_u32 s96, s96, s97
    s_add_u32 s96, s96, 4718592
    s_lshr_b32 s100, s96, 8
    s_and_b32 s100, s100, 8192
    s_xor_b32 s96, s96, s100
    v_add_u32 v157, s96, v5
    s_mul_i32 s97, s55, 16640
    s_lshr_b32 s96, s63, 3
    s_lshl_b32 s96, s96, 7
    s_add_u32 s97, s97, s96
    s_and_b32 s96, s63, 7
    s_lshl3_add_u32 s97, s96, s97
    s_add_u32 s82, s97, 262144
    s_lshl_b32 s96, s40, 12
    s_add_u32 s96, s96, s54
    v_add_u32 v158, s96, v12
    s_xor_b32 s96, s40, 1
    s_lshl_b32 s96, s96, 12
    s_add_u32 s96, s96, s54
    v_add_u32 v159, s96, v12
    s_waitcnt lgkmcnt(0)
    s_mul_i32 s31, s31, 1664525
    s_add_u32 s31, s31, 1013904223
    s_mov_b32 s58, s31
    s_mov_b32 s59, s31
    s_add_u32 s56, s28, s65
    s_addc_u32 s57, s29, 0
    s_bitcmp1_b32 s40, 1
    s_cselect_b32 s96, 0, 16
    s_lshl_b32 s53, s53, s96
    s_and_b32 s53, s53, 0xffff0000
    s_bitcmp1_b32 s40, 0
    s_cselect_b32 s53, 0, s53
    s_cmp_lg_u32 s3, 0
    s_cbranch_scc1 L_asig
    s_setprio 1
    s_lshl2_add_u32 s96, s63, s40
    s_mul_i32 s96, s96, 20480
    s_lshl_b32 s97, s55, 7
    s_add_u32 s96, s96, s97
    s_lshl_b32 s97, s40, 11
    s_add_u32 s97, s97, s41
    s_add_u32 m0, s97, 8704
    s_add_u32 s98, s96, 9216
    s_waitcnt lgkmcnt(0)
    s_mov_b64 s[48:49], s[8:9]
    buffer_load_dwordx4 v22, s[48:51], s96 offen lds
    buffer_load_dwordx4 v23, s[48:51], s98 offen offset:1024 lds
    s_sub_u32 m0, m0, 8192
    s_mov_b64 s[44:45], s[6:7]
    buffer_load_dwordx4 v22, s[44:47], s96 offen lds
    buffer_load_dwordx4 v23, s[44:47], s98 offen offset:1024 lds
    global_load_dwordx2 v[14:15], v21, s[10:11]
    s_cmp_lg_u32 s40, 3
    s_cbranch_scc1 Lkv_3
    s_sub_u32 s96, s96, 71680
    s_cselect_b32 s96, 0x40000000, s96
    s_sub_u32 m0, s41, 512
    s_mov_b32 exec_lo, 0
    buffer_load_dwordx4 v23, s[44:47], s96 offen lds
    s_mov_b32 exec_lo, -1
Lkv_3:
    s_barrier
    s_cmp_lg_u32 s36, 1
    s_cbranch_scc1 Lq_4
    ds_read_b64 v[112:113], v166 offset:2048
    ds_read_b64 v[114:115], v166 offset:4096
    ds_read_b64 v[116:117], v166 offset:6144
    ds_read_b64 v[118:119], v166 offset:8192
    ds_read_b64 v[120:121], v166 offset:10240
    ds_read_b64 v[122:123], v166 offset:12288
    s_waitcnt lgkmcnt(0)
Lq_4:
    s_waitcnt vmcnt(0)
    s_mov_b64 s[48:49], s[12:13]
    s_barrier
    s_cmp_lg_u32 s36, 2
    s_cbranch_scc1 Lq_5
    ds_read_b64 v[112:113], v166 offset:2048
    ds_read_b64 v[114:115], v166 offset:4096
    ds_read_b64 v[116:117], v166 offset:6144
    ds_read_b64 v[118:119], v166 offset:8192
    ds_read_b64 v[120:121], v166 offset:10240
    ds_read_b64 v[122:123], v166 offset:12288
    s_waitcnt lgkmcnt(0)
Lq_5:
    s_branch L_kvc
L_akv:
    v_mov_b32 v144, 0
    v_mov_b32 v145, 0
    v_mov_b32 v146, 0
    s_barrier
    s_cmp_lt_u32 s30, 4
    s_cbranch_scc1 L_akw
    v_mov_b32 v5, 160768
    s_cmp_lt_u32 s30, 8
    s_cbranch_scc1 L_ak1
    s_mov_b32 s100, 0
Lw_6:
    ds_read_b32 v4, v5 offset:104
    s_waitcnt lgkmcnt(0)
    v_readfirstlane_b32 s99, v4
    s_cmp_ge_u32 s99, 4
    s_cbranch_scc1 Lwd_7
    s_sleep 2
    s_add_u32 s100, s100, 1
    s_cmp_lt_u32 s100, 8388608
    s_cbranch_scc1 Lw_6
Lwd_7:
L_ak1:
    s_lshl2_add_u32 s96, s63, s40
    s_mul_i32 s96, s96, 20480
    s_lshl_b32 s97, s55, 7
    s_add_u32 s96, s96, s97
    s_lshl_b32 s97, s40, 11
    s_add_u32 s97, s97, s41
    s_add_u32 m0, s97, 8704
    s_add_u32 s98, s96, 9216
    s_waitcnt lgkmcnt(0)
    s_mov_b64 s[48:49], s[8:9]
    buffer_load_dwordx4 v22, s[48:51], s96 offen lds
    buffer_load_dwordx4 v23, s[48:51], s98 offen offset:1024 lds
    s_sub_u32 m0, m0, 8192
    s_mov_b64 s[44:45], s[6:7]
    buffer_load_dwordx4 v22, s[44:47], s96 offen lds
    buffer_load_dwordx4 v23, s[44:47], s98 offen offset:1024 lds
    global_load_dwordx2 v[14:15], v21, s[10:11]
    s_cmp_lg_u32 s40, 3
    s_cbranch_scc1 Lkv_8
    s_sub_u32 s96, s96, 71680
    s_cselect_b32 s96, 0x40000000, s96
    s_sub_u32 m0, s41, 512
    s_mov_b32 exec_lo, 0
    buffer_load_dwordx4 v23, s[44:47], s96 offen lds
    s_mov_b32 exec_lo, -1
Lkv_8:
    s_mov_b64 s[48:49], s[12:13]
    s_mov_b32 m0, s60
    s_sub_u32 s96, s61, 16
    s_bitcmp1_b32 s40, 0
    s_cselect_b32 s96, s96, 0x40000000
    buffer_load_dwordx4 v12, s[48:51], s61 offen lds
    buffer_load_dwordx4 v12, s[48:51], s61 offen offset:1024 lds
    s_sub_u32 m0, s60, 16
    s_mov_b64 exec, 1
    buffer_load_dwordx4 v12, s[48:51], s96 offen lds
    s_mov_b64 exec, -1
L_akw:
    s_mov_b64 s[48:49], s[12:13]
    s_waitcnt vmcnt(3)
    v_mov_b32 v4, 1
    s_mov_b64 exec, 1
    ds_add_u32 v3, v4 offset:36
    s_mov_b64 exec, -1
    s_mov_b32 s100, 0
Lw_9:
    ds_read_b32 v4, v3 offset:36
    s_waitcnt lgkmcnt(0)
    v_readfirstlane_b32 s99, v4
    s_cmp_ge_u32 s99, 4
    s_cbranch_scc1 Lwd_10
    s_add_u32 s100, s100, 1
    s_cmp_lt_u32 s100, 8388608
    s_cbranch_scc1 Lw_9
Lwd_10:
L_kvc:
    ds_read_b128 v[32:35], v9 offset:256
    ds_read_b128 v[24:27], v10 offset:0
    ds_read_b128 v[36:39], v8 offset:384
    ds_read_b128 v[28:31], v10 offset:128
    ds_read_b128 v[40:43], v8 offset:512
    ds_read_b128 v[44:47], v8 offset:640
    ds_read_b64 v[48:49], v13 offset:8448
    ds_read_b64 v[50:51], v13 offset:8576
    ds_read_b64 v[52:53], v13 offset:8704
    ds_read_b64 v[54:55], v13 offset:8832
    v_alignbit_b32 v14, v14, v14, v16
    v_alignbit_b32 v15, v15, v15, v16
    v_and_b32 v72, v14, v17
    v_and_b32 v73, v14, v18
    v_and_b32 v74, v14, v19
    v_and_b32 v75, v14, v20
    v_and_b32 v76, v15, v17
    v_and_b32 v77, v15, v18
    v_and_b32 v78, v15, v19
    v_and_b32 v79, v15, v20
    s_mov_b32 s44, s28
    s_and_b32 s45, s29, 0xffff
    s_mov_b32 s46, 16777216
    s_mov_b32 s47, 0x00020000
    s_mov_b32 vcc_lo, 0xaaaaaaaa
    s_mov_b32 vcc_hi, 0xaaaaaaaa
    s_movk_i32 s96, 8192
    s_waitcnt lgkmcnt(0)
    v_mfma_f32_16x16x32_bf16 v[56:59], v[72:75], v[32:35], 0
    v_mfma_f32_16x16x32_bf16 v[56:59], v[76:79], v[24:27], v[56:59]
    v_lshlrev_b32 v96, 16, v48
    v_and_b32 v97, 0xffff0000, v48
    v_lshlrev_b32 v98, 16, v49
    v_and_b32 v99, 0xffff0000, v49
    v_mfma_f32_16x16x32_bf16 v[60:63], v[72:75], v[36:39], 0
    v_mfma_f32_16x16x32_bf16 v[60:63], v[76:79], v[28:31], v[60:63]
    v_lshlrev_b32 v100, 16, v50
    v_and_b32 v101, 0xffff0000, v50
    v_lshlrev_b32 v102, 16, v51
    v_and_b32 v103, 0xffff0000, v51
    v_mfma_f32_16x16x32_bf16 v[64:67], v[72:75], v[40:43], 0
    v_mfma_f32_16x16x32_bf16 v[64:67], v[76:79], v[32:35], v[64:67]
    v_lshlrev_b32 v104, 16, v52
    v_and_b32 v105, 0xffff0000, v52
    v_lshlrev_b32 v106, 16, v53
    v_and_b32 v107, 0xffff0000, v53
    v_mfma_f32_16x16x32_bf16 v[68:71], v[72:75], v[44:47], 0
    v_mfma_f32_16x16x32_bf16 v[68:71], v[76:79], v[36:39], v[68:71]
    v_lshlrev_b32 v108, 16, v54
    v_and_b32 v109, 0xffff0000, v54
    v_lshlrev_b32 v110, 16, v55
    v_and_b32 v111, 0xffff0000, v55
    v_mul_f32 v96, v56, v96
    v_mul_f32 v97, v57, v97
    v_mul_f32 v98, v58, v98
    v_mul_f32 v99, v59, v99
    v_mul_f32 v100, v60, v100
    v_mul_f32 v101, v61, v101
    v_mul_f32 v102, v62, v102
    v_mul_f32 v103, v63, v103
    v_mul_f32 v104, v64, v104
    v_mul_f32 v105, v65, v105
    v_mul_f32 v106, v66, v106
    v_mul_f32 v107, v67, v107
    v_mul_f32 v108, v68, v108
    v_mul_f32 v109, v69, v109
    v_mul_f32 v110, v70, v110
    v_mul_f32 v111, v71, v111
    v_cvt_pk_bf16_f32 v80, v108, v104
    v_cvt_pk_bf16_f32 v81, v100, v96
    v_cvt_pk_bf16_f32 v82, v109, v105
    v_cvt_pk_bf16_f32 v83, v101, v97
    v_cvt_pk_bf16_f32 v84, v110, v106
    v_cvt_pk_bf16_f32 v85, v102, v98
    v_cvt_pk_bf16_f32 v86, v111, v107
    v_cvt_pk_bf16_f32 v87, v103, v99
    v_cndmask_b32_dpp v88, v80, v82, vcc quad_perm:[1,0,3,2] row_mask:0xf bank_mask:0xf
    v_cndmask_b32_dpp v89, v81, v83, vcc quad_perm:[1,0,3,2] row_mask:0xf bank_mask:0xf
    v_cndmask_b32_dpp v92, v84, v86, vcc quad_perm:[1,0,3,2] row_mask:0xf bank_mask:0xf
    v_cndmask_b32_dpp v93, v85, v87, vcc quad_perm:[1,0,3,2] row_mask:0xf bank_mask:0xf
    s_not_b64 vcc, vcc
    v_cndmask_b32_dpp v90, v82, v80, vcc quad_perm:[1,0,3,2] row_mask:0xf bank_mask:0xf
    v_cndmask_b32_dpp v91, v83, v81, vcc quad_perm:[1,0,3,2] row_mask:0xf bank_mask:0xf
    buffer_store_dwordx4 v[88:91], v11, s[44:47], 0 offen sc1
    v_cndmask_b32_dpp v94, v86, v84, vcc quad_perm:[1,0,3,2] row_mask:0xf bank_mask:0xf
    v_cndmask_b32_dpp v95, v87, v85, vcc quad_perm:[1,0,3,2] row_mask:0xf bank_mask:0xf
    buffer_store_dwordx4 v[92:95], v11, s[44:47], s96 offen sc1
    s_cmp_eq_u32 s3, 0
    s_cbranch_scc1 L_gk
    v_mov_b32 v4, 1
    s_mov_b64 exec, 1
    ds_add_u32 v3, v4 offset:40
    s_mov_b64 exec, -1
    s_branch L_cs
L_gk:
    s_setprio 0
    s_mov_b32 s52, s40
    s_barrier
    s_cmp_lg_u32 s36, 3
    s_cbranch_scc1 Lq_11
    ds_read_b64 v[112:113], v166 offset:2048
    ds_read_b64 v[114:115], v166 offset:4096
    ds_read_b64 v[116:117], v166 offset:6144
    ds_read_b64 v[118:119], v166 offset:8192
    ds_read_b64 v[120:121], v166 offset:10240
    ds_read_b64 v[122:123], v166 offset:12288
    s_waitcnt lgkmcnt(0)
Lq_11:
    s_barrier
    s_cmp_lg_u32 s36, 4
    s_cbranch_scc1 Lq_12
    ds_read_b64 v[112:113], v166 offset:2048
    ds_read_b64 v[114:115], v166 offset:4096
    ds_read_b64 v[116:117], v166 offset:6144
    ds_read_b64 v[118:119], v166 offset:8192
    ds_read_b64 v[120:121], v166 offset:10240
    ds_read_b64 v[122:123], v166 offset:12288
    s_waitcnt lgkmcnt(0)
Lq_12:
    s_waitcnt vmcnt(0)
    s_atomic_swap s31, s[28:29], s64
    s_barrier
    s_cmp_lg_u32 s36, 5
    s_cbranch_scc1 Lq_13
    ds_read_b64 v[112:113], v166 offset:2048
    ds_read_b64 v[114:115], v166 offset:4096
    ds_read_b64 v[116:117], v166 offset:6144
    ds_read_b64 v[118:119], v166 offset:8192
    ds_read_b64 v[120:121], v166 offset:10240
    ds_read_b64 v[122:123], v166 offset:12288
    s_waitcnt lgkmcnt(0)
Lq_13:
    s_barrier
    s_cmp_lg_u32 s36, 6
    s_cbranch_scc1 Lq_14
    ds_read_b64 v[112:113], v166 offset:2048
    ds_read_b64 v[114:115], v166 offset:4096
    ds_read_b64 v[116:117], v166 offset:6144
    ds_read_b64 v[118:119], v166 offset:8192
    ds_read_b64 v[120:121], v166 offset:10240
    ds_read_b64 v[122:123], v166 offset:12288
    s_waitcnt lgkmcnt(0)
Lq_14:
    s_lshl_b32 s92, s2, 7
    s_and_b32 s92, s92, 0x1f80
    s_load_dwordx2 s[86:87], s[28:29], s92 offset:8192
    s_cmp_lg_u32 s52, 0
    s_cbranch_scc1 Lud_16
Lup_15:
    s_load_dwordx16 s[64:79], s[56:57], 0 glc
    s_load_dwordx16 s[4:19], s[56:57], 64 glc
Lud_16:
    s_barrier
    s_cmp_lg_u32 s36, 7
    s_cbranch_scc1 Lq_17
    ds_read_b64 v[112:113], v166 offset:2048
    ds_read_b64 v[114:115], v166 offset:4096
    ds_read_b64 v[116:117], v166 offset:6144
    ds_read_b64 v[118:119], v166 offset:8192
    ds_read_b64 v[120:121], v166 offset:10240
    ds_read_b64 v[122:123], v166 offset:12288
    s_waitcnt lgkmcnt(0)
Lq_17:
    s_cmp_lg_u32 s52, 0
    s_cbranch_scc1 Lud_19
Lup_18:
    s_waitcnt lgkmcnt(0)
    s_xor_b64 s[64:65], s[64:65], s[58:59]
    s_xor_b64 s[4:5], s[4:5], s[58:59]
    s_or_b64 s[64:65], s[64:65], s[4:5]
    s_xor_b64 s[66:67], s[66:67], s[58:59]
    s_xor_b64 s[6:7], s[6:7], s[58:59]
    s_or_b64 s[64:65], s[64:65], s[66:67]
    s_or_b64 s[64:65], s[64:65], s[6:7]
    s_xor_b64 s[68:69], s[68:69], s[58:59]
    s_xor_b64 s[8:9], s[8:9], s[58:59]
    s_or_b64 s[64:65], s[64:65], s[68:69]
    s_or_b64 s[64:65], s[64:65], s[8:9]
    s_xor_b64 s[70:71], s[70:71], s[58:59]
    s_xor_b64 s[10:11], s[10:11], s[58:59]
    s_or_b64 s[64:65], s[64:65], s[70:71]
    s_or_b64 s[64:65], s[64:65], s[10:11]
    s_xor_b64 s[72:73], s[72:73], s[58:59]
    s_xor_b64 s[12:13], s[12:13], s[58:59]
    s_or_b64 s[64:65], s[64:65], s[72:73]
    s_or_b64 s[64:65], s[64:65], s[12:13]
    s_xor_b64 s[74:75], s[74:75], s[58:59]
    s_xor_b64 s[14:15], s[14:15], s[58:59]
    s_or_b64 s[64:65], s[64:65], s[74:75]
    s_or_b64 s[64:65], s[64:65], s[14:15]
    s_xor_b64 s[76:77], s[76:77], s[58:59]
    s_xor_b64 s[16:17], s[16:17], s[58:59]
    s_or_b64 s[64:65], s[64:65], s[76:77]
    s_or_b64 s[64:65], s[64:65], s[16:17]
    s_xor_b64 s[78:79], s[78:79], s[58:59]
    s_xor_b64 s[18:19], s[18:19], s[58:59]
    s_or_b64 s[64:65], s[64:65], s[78:79]
    s_or_b64 s[64:65], s[64:65], s[18:19]
    s_cbranch_scc1 Lud_19
    s_mov_b32 s52, -1
Lud_19:
    s_cmp_lg_u32 s52, 0
    s_cbranch_scc1 Lud_21
Lup_20:
    s_load_dwordx16 s[64:79], s[56:57], 0 glc
    s_load_dwordx16 s[4:19], s[56:57], 64 glc
Lud_21:
    s_barrier
    s_cmp_lg_u32 s36, 8
    s_cbranch_scc1 Lq_22
    ds_read_b64 v[112:113], v166 offset:2048
    ds_read_b64 v[114:115], v166 offset:4096
    ds_read_b64 v[116:117], v166 offset:6144
    ds_read_b64 v[118:119], v166 offset:8192
    ds_read_b64 v[120:121], v166 offset:10240
    ds_read_b64 v[122:123], v166 offset:12288
    s_waitcnt lgkmcnt(0)
Lq_22:
    s_mov_b32 s100, 0
Lpo_23:
    s_waitcnt lgkmcnt(0)
    s_cmp_eq_u32 s86, s31
    s_cbranch_scc1 Lpd_24
    s_sleep 16
    s_load_dwordx2 s[86:87], s[28:29], s92 offset:8192 glc
    s_add_u32 s100, s100, 1
    s_cmp_lt_u32 s100, 1048576
    s_cbranch_scc1 Lpo_23
    s_waitcnt lgkmcnt(0)
Lpd_24:
    s_and_b32 s92, s87, 0x2000
    s_mov_b32 m0, s60
    s_sub_u32 s96, s61, 16
    s_bitcmp1_b32 s40, 0
    s_cselect_b32 s96, s96, 0x40000000
    buffer_load_dwordx4 v12, s[48:51], s61 offen lds
    buffer_load_dwordx4 v12, s[48:51], s61 offen offset:1024 lds
    s_sub_u32 m0, s60, 16
    s_mov_b64 exec, 1
    buffer_load_dwordx4 v12, s[48:51], s96 offen lds
    s_mov_b64 exec, -1
    s_cmp_lg_u32 s52, 0
    s_cbranch_scc1 Lud_26
Lup_25:
    s_waitcnt lgkmcnt(0)
    s_xor_b64 s[64:65], s[64:65], s[58:59]
    s_xor_b64 s[4:5], s[4:5], s[58:59]
    s_or_b64 s[64:65], s[64:65], s[4:5]
    s_xor_b64 s[66:67], s[66:67], s[58:59]
    s_xor_b64 s[6:7], s[6:7], s[58:59]
    s_or_b64 s[64:65], s[64:65], s[66:67]
    s_or_b64 s[64:65], s[64:65], s[6:7]
    s_xor_b64 s[68:69], s[68:69], s[58:59]
    s_xor_b64 s[8:9], s[8:9], s[58:59]
    s_or_b64 s[64:65], s[64:65], s[68:69]
    s_or_b64 s[64:65], s[64:65], s[8:9]
    s_xor_b64 s[70:71], s[70:71], s[58:59]
    s_xor_b64 s[10:11], s[10:11], s[58:59]
    s_or_b64 s[64:65], s[64:65], s[70:71]
    s_or_b64 s[64:65], s[64:65], s[10:11]
    s_xor_b64 s[72:73], s[72:73], s[58:59]
    s_xor_b64 s[12:13], s[12:13], s[58:59]
    s_or_b64 s[64:65], s[64:65], s[72:73]
    s_or_b64 s[64:65], s[64:65], s[12:13]
    s_xor_b64 s[74:75], s[74:75], s[58:59]
    s_xor_b64 s[14:15], s[14:15], s[58:59]
    s_or_b64 s[64:65], s[64:65], s[74:75]
    s_or_b64 s[64:65], s[64:65], s[14:15]
    s_xor_b64 s[76:77], s[76:77], s[58:59]
    s_xor_b64 s[16:17], s[16:17], s[58:59]
    s_or_b64 s[64:65], s[64:65], s[76:77]
    s_or_b64 s[64:65], s[64:65], s[16:17]
    s_xor_b64 s[78:79], s[78:79], s[58:59]
    s_xor_b64 s[18:19], s[18:19], s[58:59]
    s_or_b64 s[64:65], s[64:65], s[78:79]
    s_or_b64 s[64:65], s[64:65], s[18:19]
    s_cbranch_scc1 Lud_26
    s_mov_b32 s52, -1
Lud_26:
    s_cmp_lg_u32 s52, -1
    s_cbranch_scc1 Lui_27
    s_add_u32 m0, s41, 33536
    s_lshl_b32 s96, s43, 13
    s_add_u32 s96, s96, 2097152
    buffer_load_dwordx4 v12, s[44:47], s96 offen offset:0 sc1 lds
    buffer_load_dwordx4 v12, s[44:47], s96 offen offset:1024 sc1 lds
    buffer_load_dwordx4 v12, s[44:47], s96 offen offset:2048 sc1 lds
    buffer_load_dwordx4 v12, s[44:47], s96 offen offset:3072 sc1 lds
    s_add_u32 m0, m0, 4096
    s_add_u32 s96, s96, 4096
    buffer_load_dwordx4 v12, s[44:47], s96 offen offset:0 sc1 lds
    buffer_load_dwordx4 v12, s[44:47], s96 offen offset:1024 sc1 lds
    buffer_load_dwordx4 v12, s[44:47], s96 offen offset:2048 sc1 lds
    buffer_load_dwordx4 v12, s[44:47], s96 offen offset:3072 sc1 lds
    s_mov_b32 s52, 9
Lui_27:
    s_barrier
    s_cmp_lg_u32 s36, 9
    s_cbranch_scc1 Lq_28
    ds_read_b64 v[112:113], v166 offset:2048
    ds_read_b64 v[114:115], v166 offset:4096
    ds_read_b64 v[116:117], v166 offset:6144
    ds_read_b64 v[118:119], v166 offset:8192
    ds_read_b64 v[120:121], v166 offset:10240
    ds_read_b64 v[122:123], v166 offset:12288
    s_waitcnt lgkmcnt(0)
Lq_28:
    s_setprio 1
    v_mov_b32 v8, v112
    v_mov_b32 v9, v113
    v_mov_b32 v10, v114
    v_mov_b32 v11, v115
    v_mov_b32 v14, v116
    v_mov_b32 v15, v117
    v_mov_b32 v160, v118
    v_mov_b32 v161, v119
    v_mov_b32 v162, v120
    v_mov_b32 v163, v121
    v_mov_b32 v164, v122
    v_mov_b32 v165, v123
    s_waitcnt vmcnt(0)
    s_cmp_lg_u32 s52, 9
    s_cbranch_scc1 L_nul
    v_mov_b32 v4, 1
    ds_write_b32 v3, v4 offset:0
    s_mov_b32 s52, 1
L_nul:
    v_subrev_u32 v4, 4, v156
    ds_read_b32 v21, v4 offset:0
    ds_read_b128 v[22:25], v156 offset:0
    ds_read_b32 v29, v4 offset:1024
    ds_read_b128 v[30:33], v156 offset:1024
    s_waitcnt lgkmcnt(0)
    s_mov_b64 exec, 1
    v_lshlrev_b32 v26, 16, v22
    v_and_b32 v27, 0xffff0000, v22
    v_add_f32 v26, s53, v26
    v_cvt_pk_bf16_f32 v22, v26, v27
    ds_write_b32 v156, v22
    s_mov_b64 exec, -1
    v_alignbit_b32 v40, v22, v21, 16
    v_alignbit_b32 v41, v23, v22, 16
    v_alignbit_b32 v42, v24, v23, 16
    v_alignbit_b32 v43, v25, v24, 16
    ds_write_b128 v156, v[40:43] offset:4160
    v_alignbit_b32 v44, v30, v29, 16
    v_alignbit_b32 v45, v31, v30, 16
    v_alignbit_b32 v46, v32, v31, 16
    v_alignbit_b32 v47, v33, v32, 16
    ds_write_b128 v156, v[44:47] offset:5184
    s_waitcnt lgkmcnt(0)
    s_setprio 1
    s_barrier
    ds_read_b32 v5, v3 offset:0
    ds_read2_b32 v[48:49], v148 offset0:0 offset1:1
    ds_read2_b32 v[50:51], v148 offset0:2 offset1:3
    ds_read2_b32 v[52:53], v148 offset0:128 offset1:129
    ds_read2_b32 v[54:55], v148 offset0:130 offset1:131
    ds_read2_b32 v[56:57], v149 offset0:0 offset1:1
    ds_read2_b32 v[58:59], v149 offset0:2 offset1:3
    ds_read2_b32 v[60:61], v149 offset0:128 offset1:129
    ds_read2_b32 v[62:63], v149 offset0:130 offset1:131
    ds_read2_b32 v[64:65], v150 offset0:0 offset1:1
    ds_read2_b32 v[66:67], v150 offset0:2 offset1:3
    ds_read2_b32 v[68:69], v150 offset0:128 offset1:129
    ds_read2_b32 v[70:71], v150 offset0:130 offset1:131
    s_waitcnt lgkmcnt(6)
    ds_read2_b32 v[72:73], v151 offset0:0 offset1:1
    ds_read2_b32 v[74:75], v151 offset0:2 offset1:3
    ds_read2_b32 v[76:77], v151 offset0:128 offset1:129
    ds_read2_b32 v[78:79], v151 offset0:130 offset1:131
    v_readfirstlane_b32 s81, v5
    s_waitcnt lgkmcnt(6)
    ds_read_b128 v[108:111], v152 offset:0
    ds_read_b128 v[104:107], v152 offset:1024
    ds_read_b128 v[100:103], v152 offset:2048
    ds_read_b128 v[96:99], v152 offset:3072
    ds_read_b128 v[92:95], v152 offset:4096
    ds_read_b128 v[88:91], v152 offset:5120
    ds_read_b128 v[84:87], v152 offset:6144
    ds_read_b128 v[80:83], v152 offset:7168
    s_cmp_lg_u32 s81, 0
    s_cbranch_scc1 L_conv2
L_upoll:
    s_cmp_lg_u32 s52, 0
    s_cbranch_scc1 Lud_30
    s_mov_b32 s100, 0
Lup_29:
    s_load_dwordx16 s[64:79], s[56:57], 0 glc
    s_load_dwordx16 s[4:19], s[56:57], 64 glc
    s_waitcnt lgkmcnt(0)
    s_xor_b64 s[64:65], s[64:65], s[58:59]
    s_xor_b64 s[4:5], s[4:5], s[58:59]
    s_or_b64 s[64:65], s[64:65], s[4:5]
    s_xor_b64 s[66:67], s[66:67], s[58:59]
    s_xor_b64 s[6:7], s[6:7], s[58:59]
    s_or_b64 s[64:65], s[64:65], s[66:67]
    s_or_b64 s[64:65], s[64:65], s[6:7]
    s_xor_b64 s[68:69], s[68:69], s[58:59]
    s_xor_b64 s[8:9], s[8:9], s[58:59]
    s_or_b64 s[64:65], s[64:65], s[68:69]
    s_or_b64 s[64:65], s[64:65], s[8:9]
    s_xor_b64 s[70:71], s[70:71], s[58:59]
    s_xor_b64 s[10:11], s[10:11], s[58:59]
    s_or_b64 s[64:65], s[64:65], s[70:71]
    s_or_b64 s[64:65], s[64:65], s[10:11]
    s_xor_b64 s[72:73], s[72:73], s[58:59]
    s_xor_b64 s[12:13], s[12:13], s[58:59]
    s_or_b64 s[64:65], s[64:65], s[72:73]
    s_or_b64 s[64:65], s[64:65], s[12:13]
    s_xor_b64 s[74:75], s[74:75], s[58:59]
    s_xor_b64 s[14:15], s[14:15], s[58:59]
    s_or_b64 s[64:65], s[64:65], s[74:75]
    s_or_b64 s[64:65], s[64:65], s[14:15]
    s_xor_b64 s[76:77], s[76:77], s[58:59]
    s_xor_b64 s[16:17], s[16:17], s[58:59]
    s_or_b64 s[64:65], s[64:65], s[76:77]
    s_or_b64 s[64:65], s[64:65], s[16:17]
    s_xor_b64 s[78:79], s[78:79], s[58:59]
    s_xor_b64 s[18:19], s[18:19], s[58:59]
    s_or_b64 s[64:65], s[64:65], s[78:79]
    s_or_b64 s[64:65], s[64:65], s[18:19]
    s_cbranch_scc0 Lug_31
    s_add_u32 s100, s100, 1
    s_cmp_lt_u32 s100, 1048576
    s_cbranch_scc1 Lup_29
Lug_31:
    s_mov_b32 s52, -1
Lud_30:
    s_cmp_lg_u32 s52, -1
    s_cbranch_scc1 Lui_32
    s_add_u32 m0, s41, 33536
    s_lshl_b32 s96, s43, 13
    s_add_u32 s96, s96, 2097152
    buffer_load_dwordx4 v12, s[44:47], s96 offen offset:0 sc1 lds
    buffer_load_dwordx4 v12, s[44:47], s96 offen offset:1024 sc1 lds
    buffer_load_dwordx4 v12, s[44:47], s96 offen offset:2048 sc1 lds
    buffer_load_dwordx4 v12, s[44:47], s96 offen offset:3072 sc1 lds
    s_add_u32 m0, m0, 4096
    s_add_u32 s96, s96, 4096
    buffer_load_dwordx4 v12, s[44:47], s96 offen offset:0 sc1 lds
    buffer_load_dwordx4 v12, s[44:47], s96 offen offset:1024 sc1 lds
    buffer_load_dwordx4 v12, s[44:47], s96 offen offset:2048 sc1 lds
    buffer_load_dwordx4 v12, s[44:47], s96 offen offset:3072 sc1 lds
    s_mov_b32 s52, 9
Lui_32:
    s_cmp_lg_u32 s52, 9
    s_cbranch_scc1 L_uwait
    s_waitcnt vmcnt(0)
    v_mov_b32 v4, 1
    ds_write_b32 v3, v4 offset:0
L_uwait:
    s_mov_b32 s100, 0
Lw_33:
    ds_read_b32 v4, v3 offset:0
    s_waitcnt lgkmcnt(0)
    v_readfirstlane_b32 s99, v4
    s_cmp_ge_u32 s99, 1
    s_cbranch_scc1 Lwd_34
    s_sleep 1
    s_add_u32 s100, s100, 1
    s_cmp_lt_u32 s100, 8388608
    s_cbranch_scc1 Lw_33
Lwd_34:
    s_cmp_eq_u32 s3, 0
    s_cbranch_scc1 L_conv
    s_branch L_touch
L_asig:
    s_waitcnt vmcnt(2)
    v_subrev_u32 v4, 4, v156
    ds_read_b32 v21, v4 offset:0
    ds_read_b128 v[22:25], v156 offset:0
    ds_read_b32 v29, v4 offset:1024
    ds_read_b128 v[30:33], v156 offset:1024
    s_waitcnt lgkmcnt(0)
    s_mov_b64 exec, 1
    v_lshlrev_b32 v26, 16, v22
    v_and_b32 v27, 0xffff0000, v22
    v_add_f32 v26, s53, v26
    v_cvt_pk_bf16_f32 v22, v26, v27
    ds_write_b32 v156, v22
    s_mov_b64 exec, -1
    v_alignbit_b32 v40, v22, v21, 16
    v_alignbit_b32 v41, v23, v22, 16
    v_alignbit_b32 v42, v24, v23, 16
    v_alignbit_b32 v43, v25, v24, 16
    ds_write_b128 v156, v[40:43] offset:4160
    v_alignbit_b32 v44, v30, v29, 16
    v_alignbit_b32 v45, v31, v30, 16
    v_alignbit_b32 v46, v32, v31, 16
    v_alignbit_b32 v47, v33, v32, 16
    ds_write_b128 v156, v[44:47] offset:5184
    s_waitcnt lgkmcnt(0)
    v_mov_b32 v4, 1
    s_mov_b64 exec, 1
    ds_add_u32 v3, v4 offset:32
    s_mov_b64 exec, -1
    v_lshl_add_u32 v6, v0, 7, s64
    v_mov_b32 v5, s31
    s_cmp_ge_u32 s55, 3
    s_cselect_b32 s97, 1, 0xff
    s_waitcnt vmcnt(0)
    s_mov_b32 exec_hi, 0
    s_mov_b32 exec_lo, s97
    global_atomic_swap v6, v5, s[28:29] sc1
    s_mov_b64 exec, -1
    s_mov_b32 s100, 0
Lw_35:
    ds_read_b32 v4, v3 offset:32
    s_waitcnt lgkmcnt(0)
    v_readfirstlane_b32 s99, v4
    s_cmp_ge_u32 s99, 4
    s_cbranch_scc1 Lwd_36
    s_sleep 1
    s_add_u32 s100, s100, 1
    s_cmp_lt_u32 s100, 8388608
    s_cbranch_scc1 Lw_35
Lwd_36:
    ds_read2_b32 v[48:49], v148 offset0:0 offset1:1
    ds_read2_b32 v[50:51], v148 offset0:2 offset1:3
    ds_read2_b32 v[52:53], v148 offset0:128 offset1:129
    ds_read2_b32 v[54:55], v148 offset0:130 offset1:131
    ds_read2_b32 v[56:57], v149 offset0:0 offset1:1
    ds_read2_b32 v[58:59], v149 offset0:2 offset1:3
    ds_read2_b32 v[60:61], v149 offset0:128 offset1:129
    ds_read2_b32 v[62:63], v149 offset0:130 offset1:131
    ds_read2_b32 v[64:65], v150 offset0:0 offset1:1
    ds_read2_b32 v[66:67], v150 offset0:2 offset1:3
    ds_read2_b32 v[68:69], v150 offset0:128 offset1:129
    ds_read2_b32 v[70:71], v150 offset0:130 offset1:131
    s_waitcnt lgkmcnt(6)
    ds_read2_b32 v[72:73], v151 offset0:0 offset1:1
    ds_read2_b32 v[74:75], v151 offset0:2 offset1:3
    ds_read2_b32 v[76:77], v151 offset0:128 offset1:129
    ds_read2_b32 v[78:79], v151 offset0:130 offset1:131
    s_mov_b32 s52, s40
    s_branch L_upoll
L_touch:
    s_cmp_lg_u32 s55, 1
    s_cbranch_scc1 L_conv
    s_lshl2_add_u32 s96, s63, s40
    s_mul_i32 s96, s96, 14336
    s_add_u32 s96, s96, 786432
    v_lshlrev_b32 v4, 7, v0
    s_add_u32 s97, s96, 8192
    buffer_load_dword v160, v4, s[48:51], s96 offen
    s_mov_b32 exec_hi, 0xffff
    buffer_load_dword v160, v4, s[48:51], s97 offen
    s_mov_b32 exec_hi, -1
L_conv:
    s_setprio 1
    ds_read_b128 v[108:111], v152 offset:0
    ds_read_b128 v[104:107], v152 offset:1024
    ds_read_b128 v[100:103], v152 offset:2048
    ds_read_b128 v[96:99], v152 offset:3072
    ds_read_b128 v[92:95], v152 offset:4096
    ds_read_b128 v[88:91], v152 offset:5120
    ds_read_b128 v[84:87], v152 offset:6144
    ds_read_b128 v[80:83], v152 offset:7168
L_conv2:

    s_waitcnt lgkmcnt(7)
    v_mfma_f32_16x16x32_bf16 v[44:47], v[48:51], v[108:111], 0
    s_waitcnt lgkmcnt(6)
    v_mfma_f32_16x16x32_bf16 v[40:43], v[48:51], v[104:107], 0
    ds_read_b128 v[140:143], v153 offset:0
    s_waitcnt lgkmcnt(6)
    v_mfma_f32_16x16x32_bf16 v[36:39], v[48:51], v[100:103], 0
    s_waitcnt lgkmcnt(5)
    v_mfma_f32_16x16x32_bf16 v[32:35], v[48:51], v[96:99], 0
    ds_read_b128 v[136:139], v153 offset:1024
    s_waitcnt lgkmcnt(5)
    v_mfma_f32_16x16x32_bf16 v[28:31], v[48:51], v[92:95], 0
    s_waitcnt lgkmcnt(4)
    v_mfma_f32_16x16x32_bf16 v[24:27], v[48:51], v[88:91], 0
    ds_read_b128 v[132:135], v153 offset:2048
    s_waitcnt lgkmcnt(4)
    v_mfma_f32_16x16x32_bf16 v[20:23], v[48:51], v[84:87], 0
    s_waitcnt lgkmcnt(3)
    v_mfma_f32_16x16x32_bf16 v[16:19], v[48:51], v[80:83], 0
    ds_read_b128 v[128:131], v153 offset:3072
    v_mfma_f32_16x16x32_bf16 v[44:47], v[52:55], v[104:107], v[44:47]
    v_mfma_f32_16x16x32_bf16 v[40:43], v[52:55], v[100:103], v[40:43]
    ds_read2_b32 v[48:49], v148 offset0:16 offset1:17
    v_mfma_f32_16x16x32_bf16 v[36:39], v[52:55], v[96:99], v[36:39]
    v_mfma_f32_16x16x32_bf16 v[32:35], v[52:55], v[92:95], v[32:35]
    ds_read2_b32 v[50:51], v148 offset0:18 offset1:19
    v_mfma_f32_16x16x32_bf16 v[28:31], v[52:55], v[88:91], v[28:31]
    v_mfma_f32_16x16x32_bf16 v[24:27], v[52:55], v[84:87], v[24:27]
    ds_read_b128 v[124:127], v153 offset:4096
    v_mfma_f32_16x16x32_bf16 v[20:23], v[52:55], v[80:83], v[20:23]
    v_mfma_f32_16x16x32_bf16 v[44:47], v[56:59], v[100:103], v[44:47]
    v_mfma_f32_16x16x32_bf16 v[40:43], v[56:59], v[96:99], v[40:43]
    ds_read2_b32 v[52:53], v148 offset0:144 offset1:145
    v_mfma_f32_16x16x32_bf16 v[36:39], v[56:59], v[92:95], v[36:39]
    v_mfma_f32_16x16x32_bf16 v[32:35], v[56:59], v[88:91], v[32:35]
    ds_read2_b32 v[54:55], v148 offset0:146 offset1:147
    v_mfma_f32_16x16x32_bf16 v[28:31], v[56:59], v[84:87], v[28:31]
    v_mfma_f32_16x16x32_bf16 v[24:27], v[56:59], v[80:83], v[24:27]
    ds_read_b128 v[120:123], v153 offset:5120
    v_mfma_f32_16x16x32_bf16 v[44:47], v[60:63], v[96:99], v[44:47]
    v_mfma_f32_16x16x32_bf16 v[40:43], v[60:63], v[92:95], v[40:43]
    ds_read2_b32 v[56:57], v149 offset0:16 offset1:17
    v_mfma_f32_16x16x32_bf16 v[36:39], v[60:63], v[88:91], v[36:39]
    v_mfma_f32_16x16x32_bf16 v[32:35], v[60:63], v[84:87], v[32:35]
    ds_read2_b32 v[58:59], v149 offset0:18 offset1:19
    v_mfma_f32_16x16x32_bf16 v[28:31], v[60:63], v[80:83], v[28:31]
    v_mfma_f32_16x16x32_bf16 v[44:47], v[64:67], v[92:95], v[44:47]
    ds_read2_b32 v[60:61], v149 offset0:144 offset1:145
    v_mfma_f32_16x16x32_bf16 v[40:43], v[64:67], v[88:91], v[40:43]
    ds_read2_b32 v[62:63], v149 offset0:146 offset1:147
    v_mfma_f32_16x16x32_bf16 v[36:39], v[64:67], v[84:87], v[36:39]
    ds_read_b128 v[116:119], v153 offset:6144
    v_mfma_f32_16x16x32_bf16 v[32:35], v[64:67], v[80:83], v[32:35]
    s_waitcnt lgkmcnt(13)
    ds_read_b128 v[112:115], v153 offset:7168
    v_mfma_f32_16x16x32_bf16 v[44:47], v[68:71], v[88:91], v[44:47]
    ds_read2_b32 v[64:65], v150 offset0:16 offset1:17
    v_mfma_f32_16x16x32_bf16 v[40:43], v[68:71], v[84:87], v[40:43]
    s_waitcnt lgkmcnt(13)
    ds_read2_b32 v[66:67], v150 offset0:18 offset1:19
    v_mfma_f32_16x16x32_bf16 v[36:39], v[68:71], v[80:83], v[36:39]
    v_mfma_f32_16x16x32_bf16 v[44:47], v[72:75], v[84:87], v[44:47]
    ds_read2_b32 v[68:69], v150 offset0:144 offset1:145
    v_mfma_f32_16x16x32_bf16 v[40:43], v[72:75], v[80:83], v[40:43]
    s_waitcnt lgkmcnt(13)
    ds_read2_b32 v[70:71], v150 offset0:146 offset1:147
    v_mfma_f32_16x16x32_bf16 v[44:47], v[76:79], v[80:83], v[44:47]
    ds_read2_b32 v[72:73], v151 offset0:16 offset1:17
    s_waitcnt lgkmcnt(13)
    ds_read2_b32 v[76:77], v151 offset0:144 offset1:145
    ds_read2_b32 v[78:79], v151 offset0:146 offset1:147
    s_waitcnt lgkmcnt(13)
    ds_read2_b32 v[74:75], v151 offset0:18 offset1:19
    v_mfma_f32_16x16x32_bf16 v[44:47], v[48:51], v[140:143], v[44:47]
    v_mfma_f32_16x16x32_bf16 v[40:43], v[48:51], v[136:139], v[40:43]
    ds_read_b128 v[108:111], v154 offset:256
    v_mfma_f32_16x16x32_bf16 v[36:39], v[48:51], v[132:135], v[36:39]
    v_mfma_f32_16x16x32_bf16 v[32:35], v[48:51], v[128:131], v[32:35]
    s_waitcnt lgkmcnt(13)
    ds_read_b128 v[104:107], v154 offset:1280
    v_mfma_f32_16x16x32_bf16 v[28:31], v[48:51], v[124:127], v[28:31]
    v_mfma_f32_16x16x32_bf16 v[24:27], v[48:51], v[120:123], v[24:27]
    ds_read_b128 v[100:103], v154 offset:2304
    s_waitcnt lgkmcnt(12)
    v_mfma_f32_16x16x32_bf16 v[20:23], v[48:51], v[116:119], v[20:23]
    s_waitcnt lgkmcnt(11)
    v_mfma_f32_16x16x32_bf16 v[16:19], v[48:51], v[112:115], v[16:19]
    ds_read_b128 v[96:99], v154 offset:3328
    v_mfma_f32_16x16x32_bf16 v[44:47], v[52:55], v[136:139], v[44:47]
    v_mfma_f32_16x16x32_bf16 v[40:43], v[52:55], v[132:135], v[40:43]
    ds_read2_b32 v[48:49], v148 offset0:32 offset1:33
    v_mfma_f32_16x16x32_bf16 v[36:39], v[52:55], v[128:131], v[36:39]
    v_mfma_f32_16x16x32_bf16 v[32:35], v[52:55], v[124:127], v[32:35]
    ds_read2_b32 v[50:51], v148 offset0:34 offset1:35
    v_mfma_f32_16x16x32_bf16 v[28:31], v[52:55], v[120:123], v[28:31]
    v_mfma_f32_16x16x32_bf16 v[24:27], v[52:55], v[116:119], v[24:27]
    ds_read_b128 v[92:95], v154 offset:4352
    v_mfma_f32_16x16x32_bf16 v[20:23], v[52:55], v[112:115], v[20:23]
    v_mfma_f32_16x16x32_bf16 v[44:47], v[56:59], v[132:135], v[44:47]
    v_mfma_f32_16x16x32_bf16 v[40:43], v[56:59], v[128:131], v[40:43]
    s_waitcnt lgkmcnt(13)
    ds_read2_b32 v[52:53], v148 offset0:160 offset1:161
    v_mfma_f32_16x16x32_bf16 v[36:39], v[56:59], v[124:127], v[36:39]
    v_mfma_f32_16x16x32_bf16 v[32:35], v[56:59], v[120:123], v[32:35]
    ds_read2_b32 v[54:55], v148 offset0:162 offset1:163
    v_mfma_f32_16x16x32_bf16 v[28:31], v[56:59], v[116:119], v[28:31]
    v_mfma_f32_16x16x32_bf16 v[24:27], v[56:59], v[112:115], v[24:27]
    s_waitcnt lgkmcnt(13)
    ds_read_b128 v[88:91], v154 offset:5376
    v_mfma_f32_16x16x32_bf16 v[44:47], v[60:63], v[128:131], v[44:47]
    v_mfma_f32_16x16x32_bf16 v[40:43], v[60:63], v[124:127], v[40:43]
    ds_read2_b32 v[56:57], v149 offset0:32 offset1:33
    v_mfma_f32_16x16x32_bf16 v[36:39], v[60:63], v[120:123], v[36:39]
    v_mfma_f32_16x16x32_bf16 v[32:35], v[60:63], v[116:119], v[32:35]
    s_waitcnt lgkmcnt(13)
    ds_read2_b32 v[58:59], v149 offset0:34 offset1:35
    v_mfma_f32_16x16x32_bf16 v[28:31], v[60:63], v[112:115], v[28:31]
    v_mfma_f32_16x16x32_bf16 v[44:47], v[64:67], v[124:127], v[44:47]
    ds_read2_b32 v[60:61], v149 offset0:160 offset1:161
    v_mfma_f32_16x16x32_bf16 v[40:43], v[64:67], v[120:123], v[40:43]
    s_waitcnt lgkmcnt(13)
    ds_read2_b32 v[62:63], v149 offset0:162 offset1:163
    v_mfma_f32_16x16x32_bf16 v[36:39], v[64:67], v[116:119], v[36:39]
    ds_read_b128 v[84:87], v154 offset:6400
    v_mfma_f32_16x16x32_bf16 v[32:35], v[64:67], v[112:115], v[32:35]
    s_waitcnt lgkmcnt(13)
    ds_read_b128 v[80:83], v154 offset:7424
    v_mfma_f32_16x16x32_bf16 v[44:47], v[68:71], v[120:123], v[44:47]
    ds_read2_b32 v[64:65], v150 offset0:32 offset1:33
    v_mfma_f32_16x16x32_bf16 v[40:43], v[68:71], v[116:119], v[40:43]
    s_waitcnt lgkmcnt(13)
    ds_read2_b32 v[66:67], v150 offset0:34 offset1:35
    v_mfma_f32_16x16x32_bf16 v[36:39], v[68:71], v[112:115], v[36:39]
    v_mfma_f32_16x16x32_bf16 v[44:47], v[72:75], v[116:119], v[44:47]
    ds_read2_b32 v[68:69], v150 offset0:160 offset1:161
    v_mfma_f32_16x16x32_bf16 v[40:43], v[72:75], v[112:115], v[40:43]
    s_waitcnt lgkmcnt(13)
    ds_read2_b32 v[70:71], v150 offset0:162 offset1:163
    v_mfma_f32_16x16x32_bf16 v[44:47], v[76:79], v[112:115], v[44:47]
    ds_read2_b32 v[72:73], v151 offset0:32 offset1:33
    s_waitcnt lgkmcnt(13)
    ds_read2_b32 v[76:77], v151 offset0:160 offset1:161
    ds_read2_b32 v[78:79], v151 offset0:162 offset1:163
    s_waitcnt lgkmcnt(13)
    ds_read2_b32 v[74:75], v151 offset0:34 offset1:35
    v_mfma_f32_16x16x32_bf16 v[44:47], v[48:51], v[108:111], v[44:47]
    v_mfma_f32_16x16x32_bf16 v[40:43], v[48:51], v[104:107], v[40:43]
    ds_read_b128 v[140:143], v155 offset:256
    v_mfma_f32_16x16x32_bf16 v[36:39], v[48:51], v[100:103], v[36:39]
    v_mfma_f32_16x16x32_bf16 v[32:35], v[48:51], v[96:99], v[32:35]
    s_waitcnt lgkmcnt(13)
    ds_read_b128 v[136:139], v155 offset:1280
    v_mfma_f32_16x16x32_bf16 v[28:31], v[48:51], v[92:95], v[28:31]
    v_mfma_f32_16x16x32_bf16 v[24:27], v[48:51], v[88:91], v[24:27]
    ds_read_b128 v[132:135], v155 offset:2304
    s_waitcnt lgkmcnt(12)
    v_mfma_f32_16x16x32_bf16 v[20:23], v[48:51], v[84:87], v[20:23]
    s_waitcnt lgkmcnt(11)
    v_mfma_f32_16x16x32_bf16 v[16:19], v[48:51], v[80:83], v[16:19]
    ds_read_b128 v[128:131], v155 offset:3328
    v_mfma_f32_16x16x32_bf16 v[44:47], v[52:55], v[104:107], v[44:47]
    v_mfma_f32_16x16x32_bf16 v[40:43], v[52:55], v[100:103], v[40:43]
    ds_read2_b32 v[48:49], v148 offset0:48 offset1:49
    v_mfma_f32_16x16x32_bf16 v[36:39], v[52:55], v[96:99], v[36:39]
    v_mfma_f32_16x16x32_bf16 v[32:35], v[52:55], v[92:95], v[32:35]
    ds_read2_b32 v[50:51], v148 offset0:50 offset1:51
    v_mfma_f32_16x16x32_bf16 v[28:31], v[52:55], v[88:91], v[28:31]
    v_mfma_f32_16x16x32_bf16 v[24:27], v[52:55], v[84:87], v[24:27]
    ds_read_b128 v[124:127], v155 offset:4352
    v_mfma_f32_16x16x32_bf16 v[20:23], v[52:55], v[80:83], v[20:23]
    v_mfma_f32_16x16x32_bf16 v[44:47], v[56:59], v[100:103], v[44:47]
    v_mfma_f32_16x16x32_bf16 v[40:43], v[56:59], v[96:99], v[40:43]
    s_waitcnt lgkmcnt(13)
    ds_read2_b32 v[52:53], v148 offset0:176 offset1:177
    v_mfma_f32_16x16x32_bf16 v[36:39], v[56:59], v[92:95], v[36:39]
    v_mfma_f32_16x16x32_bf16 v[32:35], v[56:59], v[88:91], v[32:35]
    ds_read2_b32 v[54:55], v148 offset0:178 offset1:179
    v_mfma_f32_16x16x32_bf16 v[28:31], v[56:59], v[84:87], v[28:31]
    v_mfma_f32_16x16x32_bf16 v[24:27], v[56:59], v[80:83], v[24:27]
    s_waitcnt lgkmcnt(13)
    ds_read_b128 v[120:123], v155 offset:5376
    s_lshl_b32 s96, s40, 2
    v_add_u32 v5, s96, v3
    v_mfma_f32_16x16x32_bf16 v[44:47], v[60:63], v[96:99], v[44:47]
    v_mfma_f32_16x16x32_bf16 v[40:43], v[60:63], v[92:95], v[40:43]
    ds_read2_b32 v[56:57], v149 offset0:48 offset1:49
    v_mfma_f32_16x16x32_bf16 v[36:39], v[60:63], v[88:91], v[36:39]
    v_mfma_f32_16x16x32_bf16 v[32:35], v[60:63], v[84:87], v[32:35]
    s_waitcnt lgkmcnt(13)
    ds_read2_b32 v[58:59], v149 offset0:50 offset1:51
    v_xor_b32 v6, 4, v5
    s_and_b32 s96, s34, 3
    v_mfma_f32_16x16x32_bf16 v[28:31], v[60:63], v[80:83], v[28:31]
    v_mfma_f32_16x16x32_bf16 v[44:47], v[64:67], v[92:95], v[44:47]
    ds_read2_b32 v[60:61], v149 offset0:176 offset1:177
    v_mfma_f32_16x16x32_bf16 v[40:43], v[64:67], v[88:91], v[40:43]
    s_waitcnt lgkmcnt(13)
    ds_read2_b32 v[62:63], v149 offset0:178 offset1:179
    v_mfma_f32_16x16x32_bf16 v[36:39], v[64:67], v[84:87], v[36:39]
    s_cselect_b32 s96, 4, 6
    s_cmp_eq_u32 s3, 0
    ds_read_b128 v[116:119], v155 offset:6400
    v_mfma_f32_16x16x32_bf16 v[32:35], v[64:67], v[80:83], v[32:35]
    s_waitcnt lgkmcnt(13)
    ds_read_b128 v[112:115], v155 offset:7424
    v_mfma_f32_16x16x32_bf16 v[44:47], v[68:71], v[88:91], v[44:47]
    ds_read2_b32 v[64:65], v150 offset0:48 offset1:49
    v_mfma_f32_16x16x32_bf16 v[40:43], v[68:71], v[84:87], v[40:43]
    s_cselect_b32 s81, s96, 0
    s_bitcmp1_b32 s40, 0
    s_waitcnt lgkmcnt(13)
    ds_read2_b32 v[66:67], v150 offset0:50 offset1:51
    v_mfma_f32_16x16x32_bf16 v[36:39], v[68:71], v[80:83], v[36:39]
    ds_read_b32 v4, v3 offset:64
    v_mfma_f32_16x16x32_bf16 v[44:47], v[72:75], v[84:87], v[44:47]
    s_waitcnt lgkmcnt(13)
    ds_read2_b32 v[68:69], v150 offset0:176 offset1:177
    v_mfma_f32_16x16x32_bf16 v[40:43], v[72:75], v[80:83], v[40:43]
    ds_read2_b32 v[70:71], v150 offset0:178 offset1:179
    v_mfma_f32_16x16x32_bf16 v[44:47], v[76:79], v[80:83], v[44:47]
    s_waitcnt lgkmcnt(13)
    ds_read2_b32 v[72:73], v151 offset0:48 offset1:49
    ds_read2_b32 v[76:77], v151 offset0:176 offset1:177
    s_waitcnt lgkmcnt(13)
    ds_read2_b32 v[78:79], v151 offset0:178 offset1:179
    ds_read2_b32 v[74:75], v151 offset0:50 offset1:51
    s_cbranch_scc1 L_mrg1

    s_waitcnt lgkmcnt(14)
    v_mfma_f32_16x16x32_bf16 v[36:39], v[48:51], v[132:135], v[36:39]
    v_mfma_f32_16x16x32_bf16 v[32:35], v[48:51], v[128:131], v[32:35]
    v_mfma_f32_16x16x32_bf16 v[28:31], v[48:51], v[124:127], v[28:31]
    v_mfma_f32_16x16x32_bf16 v[24:27], v[48:51], v[120:123], v[24:27]
    v_mfma_f32_16x16x32_bf16 v[36:39], v[52:55], v[128:131], v[36:39]
    v_mfma_f32_16x16x32_bf16 v[32:35], v[52:55], v[124:127], v[32:35]
    v_mfma_f32_16x16x32_bf16 v[28:31], v[52:55], v[120:123], v[28:31]
    s_waitcnt lgkmcnt(10)
    v_mfma_f32_16x16x32_bf16 v[24:27], v[52:55], v[116:119], v[24:27]
    v_mfma_f32_16x16x32_bf16 v[36:39], v[56:59], v[124:127], v[36:39]
    v_mfma_f32_16x16x32_bf16 v[32:35], v[56:59], v[120:123], v[32:35]
    v_mfma_f32_16x16x32_bf16 v[28:31], v[56:59], v[116:119], v[28:31]
    s_waitcnt lgkmcnt(9)
    v_mfma_f32_16x16x32_bf16 v[24:27], v[56:59], v[112:115], v[24:27]
    v_mfma_f32_16x16x32_bf16 v[36:39], v[60:63], v[120:123], v[36:39]
    v_mfma_f32_16x16x32_bf16 v[32:35], v[60:63], v[116:119], v[32:35]
    v_mfma_f32_16x16x32_bf16 v[28:31], v[60:63], v[112:115], v[28:31]
    s_waitcnt lgkmcnt(7)
    v_mfma_f32_16x16x32_bf16 v[36:39], v[64:67], v[116:119], v[36:39]
    v_mfma_f32_16x16x32_bf16 v[32:35], v[64:67], v[112:115], v[32:35]
    s_waitcnt lgkmcnt(4)
    v_mfma_f32_16x16x32_bf16 v[36:39], v[68:71], v[112:115], v[36:39]

    v_readfirstlane_b32 s99, v4
    s_cmp_lt_u32 s99, s81
    s_cbranch_scc1 L_mslow0
L_mgo0:
    v_mfma_f32_16x16x32_bf16 v[44:47], v[48:51], v[140:143], v[44:47]
    v_mfma_f32_16x16x32_bf16 v[40:43], v[48:51], v[136:139], v[40:43]
    v_mfma_f32_16x16x32_bf16 v[20:23], v[48:51], v[116:119], v[20:23]
    ds_write_b128 v158, v[24:27] offset:0
    v_mfma_f32_16x16x32_bf16 v[16:19], v[48:51], v[112:115], v[16:19]
    ds_write_b128 v158, v[28:31] offset:1024
    v_mfma_f32_16x16x32_bf16 v[44:47], v[52:55], v[136:139], v[44:47]
    ds_write_b128 v158, v[32:35] offset:2048
    v_mfma_f32_16x16x32_bf16 v[40:43], v[52:55], v[132:135], v[40:43]
    ds_write_b128 v158, v[36:39] offset:3072
    v_mfma_f32_16x16x32_bf16 v[20:23], v[52:55], v[112:115], v[20:23]
    ds_write_b32 v5, v5 offset:8
    v_mfma_f32_16x16x32_bf16 v[44:47], v[56:59], v[132:135], v[44:47]
    v_mfma_f32_16x16x32_bf16 v[40:43], v[56:59], v[128:131], v[40:43]
    v_mfma_f32_16x16x32_bf16 v[44:47], v[60:63], v[128:131], v[44:47]
    v_mfma_f32_16x16x32_bf16 v[40:43], v[60:63], v[124:127], v[40:43]
    v_mfma_f32_16x16x32_bf16 v[44:47], v[64:67], v[124:127], v[44:47]
    v_mfma_f32_16x16x32_bf16 v[40:43], v[64:67], v[120:123], v[40:43]
    v_mfma_f32_16x16x32_bf16 v[44:47], v[68:71], v[120:123], v[44:47]
    v_mfma_f32_16x16x32_bf16 v[40:43], v[68:71], v[116:119], v[40:43]
    s_waitcnt lgkmcnt(5)
    v_mfma_f32_16x16x32_bf16 v[44:47], v[72:75], v[116:119], v[44:47]
    v_mfma_f32_16x16x32_bf16 v[40:43], v[72:75], v[112:115], v[40:43]
    v_mfma_f32_16x16x32_bf16 v[44:47], v[76:79], v[112:115], v[44:47]
    s_setprio 3
    s_cmp_eq_u32 s3, 0
    s_cbranch_scc1 L_pk0
    s_lshl_b32 s92, s2, 7
    s_and_b32 s92, s92, 0x1f80
    s_load_dwordx2 s[86:87], s[28:29], s92 offset:8192
    s_mov_b32 s100, 0
Lpo_37:
    s_waitcnt lgkmcnt(0)
    s_cmp_eq_u32 s86, s31
    s_cbranch_scc1 Lpd_38
    s_sleep 16
    s_load_dwordx2 s[86:87], s[28:29], s92 offset:8192 glc
    s_add_u32 s100, s100, 1
    s_cmp_lt_u32 s100, 1048576
    s_cbranch_scc1 Lpo_37
    s_waitcnt lgkmcnt(0)
Lpd_38:
    s_and_b32 s92, s87, 0x2000
L_pk0:
    v_xor_b32 v157, s92, v157
    v_xor_b32 v7, 0x2000, v157
L_mb0:
    ds_read_b32 v4, v6 offset:8
    ds_read_b128 v[80:83], v159 offset:0
    ds_read_b128 v[84:87], v159 offset:1024
    ds_read_b128 v[88:91], v159 offset:2048
    ds_read_b128 v[92:95], v159 offset:3072
    s_waitcnt lgkmcnt(4)
    v_readfirstlane_b32 s99, v4
    s_cmp_eq_u32 s99, 0
    s_cbranch_scc1 L_mw0
    s_waitcnt lgkmcnt(2)
    v_add_f32 v16, v16, v80
    v_add_f32 v17, v17, v81
    v_add_f32 v18, v18, v82
    v_add_f32 v19, v19, v83
    v_add_f32 v20, v20, v84
    v_add_f32 v21, v21, v85
    v_add_f32 v22, v22, v86
    v_add_f32 v23, v23, v87
    v_cvt_pk_bf16_f32 v96, v16, v17
    v_cvt_pk_bf16_f32 v97, v18, v19
    v_cvt_pk_bf16_f32 v98, v20, v21
    v_cvt_pk_bf16_f32 v99, v22, v23
    s_nop 0
    v_permlane16_swap_b32 v96, v98
    v_permlane16_swap_b32 v97, v99
    buffer_store_dwordx4 v[96:99], v157, s[44:47], 0 offen offset:0 sc1
    s_waitcnt lgkmcnt(0)
    v_add_f32 v40, v40, v88
    v_add_f32 v41, v41, v89
    v_add_f32 v42, v42, v90
    v_add_f32 v43, v43, v91
    v_add_f32 v44, v44, v92
    v_add_f32 v45, v45, v93
    v_add_f32 v46, v46, v94
    v_add_f32 v47, v47, v95
    v_cvt_pk_bf16_f32 v100, v40, v41
    v_cvt_pk_bf16_f32 v101, v42, v43
    v_cvt_pk_bf16_f32 v102, v44, v45
    v_cvt_pk_bf16_f32 v103, v46, v47
    s_nop 0
    v_permlane16_swap_b32 v100, v102
    v_permlane16_swap_b32 v101, v103
    buffer_store_dwordx4 v[100:103], v7, s[44:47], 0 offen offset:3072 sc1
    s_branch L_mrgd
L_mw0:
    s_mov_b32 s100, 0
Lw_39:
    ds_read_b32 v4, v6 offset:8
    s_waitcnt lgkmcnt(0)
    v_readfirstlane_b32 s99, v4
    s_cmp_ge_u32 s99, 1
    s_cbranch_scc1 Lwd_40
    s_add_u32 s100, s100, 1
    s_cmp_lt_u32 s100, 8388608
    s_cbranch_scc1 Lw_39
Lwd_40:
    s_branch L_mb0
L_mslow0:
    s_mov_b32 s100, 0
Lw_41:
    ds_read_b32 v4, v3 offset:64
    s_waitcnt lgkmcnt(0)
    v_readfirstlane_b32 s99, v4
    s_cmp_ge_u32 s99, s81
    s_cbranch_scc1 Lwd_42
    s_add_u32 s100, s100, 1
    s_cmp_lt_u32 s100, 8388608
    s_cbranch_scc1 Lw_41
Lwd_42:
    s_branch L_mgo0
L_mrg1:

    s_waitcnt lgkmcnt(14)
    v_mfma_f32_16x16x32_bf16 v[44:47], v[48:51], v[140:143], v[44:47]
    v_mfma_f32_16x16x32_bf16 v[40:43], v[48:51], v[136:139], v[40:43]
    s_waitcnt lgkmcnt(10)
    v_mfma_f32_16x16x32_bf16 v[20:23], v[48:51], v[116:119], v[20:23]
    s_waitcnt lgkmcnt(9)
    v_mfma_f32_16x16x32_bf16 v[16:19], v[48:51], v[112:115], v[16:19]
    v_mfma_f32_16x16x32_bf16 v[44:47], v[52:55], v[136:139], v[44:47]
    v_mfma_f32_16x16x32_bf16 v[40:43], v[52:55], v[132:135], v[40:43]
    v_mfma_f32_16x16x32_bf16 v[20:23], v[52:55], v[112:115], v[20:23]
    v_mfma_f32_16x16x32_bf16 v[44:47], v[56:59], v[132:135], v[44:47]
    v_mfma_f32_16x16x32_bf16 v[40:43], v[56:59], v[128:131], v[40:43]
    v_mfma_f32_16x16x32_bf16 v[44:47], v[60:63], v[128:131], v[44:47]
    v_mfma_f32_16x16x32_bf16 v[40:43], v[60:63], v[124:127], v[40:43]
    s_waitcnt lgkmcnt(7)
    v_mfma_f32_16x16x32_bf16 v[44:47], v[64:67], v[124:127], v[44:47]
    v_mfma_f32_16x16x32_bf16 v[40:43], v[64:67], v[120:123], v[40:43]
    s_waitcnt lgkmcnt(4)
    v_mfma_f32_16x16x32_bf16 v[44:47], v[68:71], v[120:123], v[44:47]
    v_mfma_f32_16x16x32_bf16 v[40:43], v[68:71], v[116:119], v[40:43]
    s_waitcnt lgkmcnt(0)
    v_mfma_f32_16x16x32_bf16 v[44:47], v[72:75], v[116:119], v[44:47]
    v_mfma_f32_16x16x32_bf16 v[40:43], v[72:75], v[112:115], v[40:43]
    v_mfma_f32_16x16x32_bf16 v[44:47], v[76:79], v[112:115], v[44:47]

    v_readfirstlane_b32 s99, v4
    s_cmp_lt_u32 s99, s81
    s_cbranch_scc1 L_mslow1
L_mgo1:
    v_mfma_f32_16x16x32_bf16 v[36:39], v[48:51], v[132:135], v[36:39]
    v_mfma_f32_16x16x32_bf16 v[32:35], v[48:51], v[128:131], v[32:35]
    v_mfma_f32_16x16x32_bf16 v[28:31], v[48:51], v[124:127], v[28:31]
    ds_write_b128 v158, v[16:19] offset:0
    v_mfma_f32_16x16x32_bf16 v[24:27], v[48:51], v[120:123], v[24:27]
    ds_write_b128 v158, v[20:23] offset:1024
    v_mfma_f32_16x16x32_bf16 v[36:39], v[52:55], v[128:131], v[36:39]
    ds_write_b128 v158, v[40:43] offset:2048
    v_mfma_f32_16x16x32_bf16 v[32:35], v[52:55], v[124:127], v[32:35]
    ds_write_b128 v158, v[44:47] offset:3072
    v_mfma_f32_16x16x32_bf16 v[28:31], v[52:55], v[120:123], v[28:31]
    ds_write_b32 v5, v5 offset:8
    v_mfma_f32_16x16x32_bf16 v[24:27], v[52:55], v[116:119], v[24:27]
    v_mfma_f32_16x16x32_bf16 v[36:39], v[56:59], v[124:127], v[36:39]
    v_mfma_f32_16x16x32_bf16 v[32:35], v[56:59], v[120:123], v[32:35]
    v_mfma_f32_16x16x32_bf16 v[28:31], v[56:59], v[116:119], v[28:31]
    v_mfma_f32_16x16x32_bf16 v[24:27], v[56:59], v[112:115], v[24:27]
    v_mfma_f32_16x16x32_bf16 v[36:39], v[60:63], v[120:123], v[36:39]
    v_mfma_f32_16x16x32_bf16 v[32:35], v[60:63], v[116:119], v[32:35]
    v_mfma_f32_16x16x32_bf16 v[28:31], v[60:63], v[112:115], v[28:31]
    v_mfma_f32_16x16x32_bf16 v[36:39], v[64:67], v[116:119], v[36:39]
    v_mfma_f32_16x16x32_bf16 v[32:35], v[64:67], v[112:115], v[32:35]
    v_mfma_f32_16x16x32_bf16 v[36:39], v[68:71], v[112:115], v[36:39]
    s_setprio 3
    s_cmp_eq_u32 s3, 0
    s_cbranch_scc1 L_pk1
    s_lshl_b32 s92, s2, 7
    s_and_b32 s92, s92, 0x1f80
    s_load_dwordx2 s[86:87], s[28:29], s92 offset:8192
    s_mov_b32 s100, 0
Lpo_43:
    s_waitcnt lgkmcnt(0)
    s_cmp_eq_u32 s86, s31
    s_cbranch_scc1 Lpd_44
    s_sleep 16
    s_load_dwordx2 s[86:87], s[28:29], s92 offset:8192 glc
    s_add_u32 s100, s100, 1
    s_cmp_lt_u32 s100, 1048576
    s_cbranch_scc1 Lpo_43
    s_waitcnt lgkmcnt(0)
Lpd_44:
    s_and_b32 s92, s87, 0x2000
L_pk1:
    v_xor_b32 v157, s92, v157
    v_xor_b32 v7, 0x2000, v157
L_mb1:
    ds_read_b32 v4, v6 offset:8
    ds_read_b128 v[80:83], v159 offset:0
    ds_read_b128 v[84:87], v159 offset:1024
    ds_read_b128 v[88:91], v159 offset:2048
    ds_read_b128 v[92:95], v159 offset:3072
    s_waitcnt lgkmcnt(4)
    v_readfirstlane_b32 s99, v4
    s_cmp_eq_u32 s99, 0
    s_cbranch_scc1 L_mw1
    s_waitcnt lgkmcnt(2)
    v_add_f32 v24, v24, v80
    v_add_f32 v25, v25, v81
    v_add_f32 v26, v26, v82
    v_add_f32 v27, v27, v83
    v_add_f32 v28, v28, v84
    v_add_f32 v29, v29, v85
    v_add_f32 v30, v30, v86
    v_add_f32 v31, v31, v87
    v_cvt_pk_bf16_f32 v96, v24, v25
    v_cvt_pk_bf16_f32 v97, v26, v27
    v_cvt_pk_bf16_f32 v98, v28, v29
    v_cvt_pk_bf16_f32 v99, v30, v31
    s_nop 0
    v_permlane16_swap_b32 v96, v98
    v_permlane16_swap_b32 v97, v99
    buffer_store_dwordx4 v[96:99], v157, s[44:47], 0 offen offset:1024 sc1
    s_waitcnt lgkmcnt(0)
    v_add_f32 v32, v32, v88
    v_add_f32 v33, v33, v89
    v_add_f32 v34, v34, v90
    v_add_f32 v35, v35, v91
    v_add_f32 v36, v36, v92
    v_add_f32 v37, v37, v93
    v_add_f32 v38, v38, v94
    v_add_f32 v39, v39, v95
    v_cvt_pk_bf16_f32 v100, v32, v33
    v_cvt_pk_bf16_f32 v101, v34, v35
    v_cvt_pk_bf16_f32 v102, v36, v37
    v_cvt_pk_bf16_f32 v103, v38, v39
    s_nop 0
    v_permlane16_swap_b32 v100, v102
    v_permlane16_swap_b32 v101, v103
    buffer_store_dwordx4 v[100:103], v7, s[44:47], 0 offen offset:2048 sc1
    s_mov_b32 exec_lo, 15
    s_mov_b32 exec_hi, 15
    buffer_store_dwordx4 v[100:103], v157, s[44:47], 0 offen offset:2048 sc1
    s_mov_b64 exec, -1
    s_branch L_mrgd
L_mw1:
    s_mov_b32 s100, 0
Lw_45:
    ds_read_b32 v4, v6 offset:8
    s_waitcnt lgkmcnt(0)
    v_readfirstlane_b32 s99, v4
    s_cmp_ge_u32 s99, 1
    s_cbranch_scc1 Lwd_46
    s_add_u32 s100, s100, 1
    s_cmp_lt_u32 s100, 8388608
    s_cbranch_scc1 Lw_45
Lwd_46:
    s_branch L_mb1
L_mslow1:
    s_mov_b32 s100, 0
Lw_47:
    ds_read_b32 v4, v3 offset:64
    s_waitcnt lgkmcnt(0)
    v_readfirstlane_b32 s99, v4
    s_cmp_ge_u32 s99, s81
    s_cbranch_scc1 Lwd_48
    s_add_u32 s100, s100, 1
    s_cmp_lt_u32 s100, 8388608
    s_cbranch_scc1 Lw_47
Lwd_48:
    s_branch L_mgo1
L_mrgd:
    s_cmp_lg_u32 s3, 0
    s_cbranch_scc1 L_nogq
    s_setprio 3
    ds_read_b32 v4, v3 offset:76
    v_lshlrev_b32 v20, 2, v1
    v_add_u32 v20, 161088, v20
L_gqr:
    ds_read2_b32 v[32:33], v20 offset0:0 offset1:16
    ds_read2_b32 v[34:35], v20 offset0:32 offset1:48
    ds_read2_b32 v[36:37], v20 offset0:64 offset1:80
    v_lshlrev_b32 v40, 16, v8
    v_and_b32 v41, 0xffff0000, v8
    v_lshlrev_b32 v42, 16, v9
    v_and_b32 v43, 0xffff0000, v9
    v_lshlrev_b32 v44, 16, v10
    v_and_b32 v45, 0xffff0000, v10
    v_lshlrev_b32 v46, 16, v11
    v_and_b32 v47, 0xffff0000, v11
    v_lshlrev_b32 v48, 16, v14
    v_and_b32 v49, 0xffff0000, v14
    v_lshlrev_b32 v50, 16, v15
    v_and_b32 v51, 0xffff0000, v15
    v_lshlrev_b32 v52, 16, v160
    v_and_b32 v53, 0xffff0000, v160
    v_lshlrev_b32 v54, 16, v161
    v_and_b32 v55, 0xffff0000, v161
    v_lshlrev_b32 v56, 16, v162
    v_and_b32 v57, 0xffff0000, v162
    v_lshlrev_b32 v58, 16, v163
    v_and_b32 v59, 0xffff0000, v163
    v_lshlrev_b32 v60, 16, v164
    v_and_b32 v61, 0xffff0000, v164
    v_lshlrev_b32 v62, 16, v165
    v_and_b32 v63, 0xffff0000, v165
    s_waitcnt lgkmcnt(0)
    v_readfirstlane_b32 s67, v4
    v_mul_f32 v40, v32, v40
    v_mul_f32 v41, v32, v41
    v_mul_f32 v42, v32, v42
    v_mul_f32 v43, v32, v43
    v_mul_f32 v44, v33, v44
    v_mul_f32 v45, v33, v45
    v_mul_f32 v46, v33, v46
    v_mul_f32 v47, v33, v47
    v_mul_f32 v48, v34, v48
    v_mul_f32 v49, v34, v49
    v_mul_f32 v50, v34, v50
    v_mul_f32 v51, v34, v51
    v_mul_f32 v52, v35, v52
    v_mul_f32 v53, v35, v53
    v_mul_f32 v54, v35, v54
    v_mul_f32 v55, v35, v55
    v_mul_f32 v56, v36, v56
    v_mul_f32 v57, v36, v57
    v_mul_f32 v58, v36, v58
    v_mul_f32 v59, v36, v59
    v_mul_f32 v60, v37, v60
    v_mul_f32 v61, v37, v61
    v_mul_f32 v62, v37, v62
    v_mul_f32 v63, v37, v63
    s_cmp_eq_u32 s67, 2
    s_cbranch_scc1 L_gqd
    s_lshl_b32 s96, s40, 10
    s_add_u32 s96, s96, 133632
    v_add_u32 v21, s96, v12
    s_lshr_b32 s96, s40, 1
    s_lshl_b32 s96, s96, 2
    v_add_u32 v22, s96, v3
    s_mul_i32 s96, s32, 164096
    s_cmp_ge_u32 s32, 11
    s_cselect_b32 s100, 1796864, 0
    s_sub_u32 s96, s96, s100
    s_mul_i32 s100, s33, 16640
    s_add_u32 s96, s96, s100
    s_add_u32 s96, s96, 262144
    s_xor_b32 s96, s96, s92
    s_lshl_b32 s97, s40, 7
    s_add_u32 s96, s96, s97
    s_add_u32 s56, s28, s96
    s_addc_u32 s57, s29, 0
    s_xor_b32 s96, s40, 1
    s_lshl_b32 s96, s96, 12
    s_add_u32 m0, s96, 116736
    s_lshl2_add_u32 s66, s33, s40
    s_lshl_b32 s66, s66, 17
    s_mul_i32 s96, s32, 192
    s_add_u32 s66, s66, s96
    s_add_u32 s66, s66, 4718592
    s_cmp_ge_u32 s32, 11
    s_cselect_b32 s96, 0x2000, 0
    s_add_u32 s66, s66, s96
    s_lshr_b32 s100, s66, 8
    s_and_b32 s100, s100, 8192
    s_xor_b32 s66, s66, s100
    s_xor_b32 s66, s66, s92
    s_setprio 3
L_nogq:
    v_mul_u32_u24 v5, 164096, v0
    v_add_u32 v5, s82, v5
    v_mov_b32 v6, s31
    s_mov_b64 exec, 0xfffff800
    v_subrev_u32 v5, 1796864, v5
    s_mov_b64 exec, -1
    v_xor_b32 v5, s92, v5
    s_waitcnt vmcnt(0)
    v_mov_b32 v4, 1
    s_mov_b64 exec, 1
    ds_add_rtn_u32 v4, v3, v4 offset:28
    s_waitcnt lgkmcnt(0)
    v_readfirstlane_b32 s98, v4
    s_mov_b64 exec, -1
    s_cmp_lg_u32 s98, 3
    s_cbranch_scc1 L_ynosig
    s_mov_b64 exec, 0x3fffff
    global_atomic_swap v5, v6, s[28:29] sc1
    s_mov_b64 exec, -1
L_ynosig:
    s_and_b32 s96, s63, 7
    s_or_b32 s96, s96, s40
    s_cbranch_scc1 L_noep
    s_mov_b32 s96, 1
    s_atomic_add s96, s[26:27], 0 glc
    s_waitcnt lgkmcnt(0)
    s_cmp_lg_u32 s96, 39
    s_cbranch_scc1 Lep_49
    s_atomic_swap s31, s[28:29], 0
Lep_49:
L_noep:
    s_cmp_lg_u32 s3, 0
    s_cbranch_scc1 L_cexit
    s_mov_b32 s100, 0
L_yp:
    s_add_u32 s100, s100, 1
    s_cmp_ge_u32 s100, 1048576
    s_cbranch_scc1 L_ypd
    s_load_dwordx16 s[4:19], s[56:57], 0 glc
    s_waitcnt lgkmcnt(0)
    s_cmp_lg_u32 s4, s31
    s_cbranch_scc1 L_yp
    s_cmp_lg_u32 s6, s31
    s_cbranch_scc1 L_yp
    s_cmp_lg_u32 s8, s31
    s_cbranch_scc1 L_yp
    s_cmp_lg_u32 s10, s31
    s_cbranch_scc1 L_yp
    s_cmp_lg_u32 s12, s31
    s_cbranch_scc1 L_yp
    s_cmp_lg_u32 s14, s31
    s_cbranch_scc1 L_yp
    s_cmp_lg_u32 s16, s31
    s_cbranch_scc1 L_yp
    s_cmp_lg_u32 s18, s31
    s_cbranch_scc1 L_yp
L_ypd:
    buffer_load_dwordx4 v144, s[44:47], s66 offen sc1 lds
    s_add_u32 m0, m0, 1024
    s_nop 0
    buffer_load_dwordx4 v145, s[44:47], s66 offen sc1 lds
    s_add_u32 m0, m0, 1024
    s_nop 0
    buffer_load_dwordx4 v146, s[44:47], s66 offen sc1 lds
    s_mov_b32 s100, 0
Lw_50:
    ds_read_b32 v4, v3 offset:28
    s_waitcnt lgkmcnt(0)
    v_readfirstlane_b32 s99, v4
    s_cmp_ge_u32 s99, 4
    s_cbranch_scc1 Lwd_51
    s_add_u32 s100, s100, 1
    s_cmp_lt_u32 s100, 8388608
    s_cbranch_scc1 Lw_50
Lwd_51:
    s_cmp_lg_u32 s67, 0
    s_cbranch_scc1 L_gqd
    s_mov_b32 s100, 0
Lw_52:
    ds_read_b32 v4, v3 offset:76
    s_waitcnt lgkmcnt(0)
    v_readfirstlane_b32 s99, v4
    s_cmp_ge_u32 s99, 1
    s_cbranch_scc1 Lwd_53
    s_sleep 1
    s_add_u32 s100, s100, 1
    s_cmp_lt_u32 s100, 8388608
    s_cbranch_scc1 Lw_52
Lwd_53:
    v_mov_b32 v4, 2
    s_branch L_gqr
L_gqd:
    v_mov_b32 v4, 1
    s_waitcnt vmcnt(0)
    ds_read_b64_tr_b16 v[64:65], v147 offset:0
    ds_read_b64_tr_b16 v[66:67], v147 offset:32
    ds_read_b64_tr_b16 v[68:69], v147 offset:64
    ds_read_b64_tr_b16 v[70:71], v147 offset:96
    ds_read_b64_tr_b16 v[72:73], v147 offset:128
    ds_read_b64_tr_b16 v[74:75], v147 offset:160
    s_waitcnt lgkmcnt(5)
    v_lshlrev_b32 v80, 16, v64
    v_and_b32 v81, 0xffff0000, v64
    v_lshlrev_b32 v82, 16, v65
    v_and_b32 v83, 0xffff0000, v65
    v_mul_f32 v40, v40, v80
    v_mul_f32 v41, v41, v81
    v_mul_f32 v42, v42, v82
    v_mul_f32 v43, v43, v83
    ds_write_b128 v21, v[40:43] offset:0
    s_waitcnt lgkmcnt(5)
    v_lshlrev_b32 v84, 16, v66
    v_and_b32 v85, 0xffff0000, v66
    v_lshlrev_b32 v86, 16, v67
    v_and_b32 v87, 0xffff0000, v67
    v_mul_f32 v44, v44, v84
    v_mul_f32 v45, v45, v85
    v_mul_f32 v46, v46, v86
    v_mul_f32 v47, v47, v87
    ds_write_b128 v21, v[44:47] offset:4096
    s_waitcnt lgkmcnt(5)
    v_lshlrev_b32 v88, 16, v68
    v_and_b32 v89, 0xffff0000, v68
    v_lshlrev_b32 v90, 16, v69
    v_and_b32 v91, 0xffff0000, v69
    v_mul_f32 v48, v48, v88
    v_mul_f32 v49, v49, v89
    v_mul_f32 v50, v50, v90
    v_mul_f32 v51, v51, v91
    ds_write_b128 v21, v[48:51] offset:8192
    s_waitcnt lgkmcnt(5)
    v_lshlrev_b32 v92, 16, v70
    v_and_b32 v93, 0xffff0000, v70
    v_lshlrev_b32 v94, 16, v71
    v_and_b32 v95, 0xffff0000, v71
    v_mul_f32 v52, v52, v92
    v_mul_f32 v53, v53, v93
    v_mul_f32 v54, v54, v94
    v_mul_f32 v55, v55, v95
    ds_write_b128 v21, v[52:55] offset:12288
    s_waitcnt lgkmcnt(5)
    v_lshlrev_b32 v96, 16, v72
    v_and_b32 v97, 0xffff0000, v72
    v_lshlrev_b32 v98, 16, v73
    v_and_b32 v99, 0xffff0000, v73
    v_mul_f32 v56, v56, v96
    v_mul_f32 v57, v57, v97
    v_mul_f32 v58, v58, v98
    v_mul_f32 v59, v59, v99
    ds_write_b128 v21, v[56:59] offset:16384
    s_waitcnt lgkmcnt(5)
    v_lshlrev_b32 v100, 16, v74
    v_and_b32 v101, 0xffff0000, v74
    v_lshlrev_b32 v102, 16, v75
    v_and_b32 v103, 0xffff0000, v75
    v_mul_f32 v60, v60, v100
    v_mul_f32 v61, v61, v101
    v_mul_f32 v62, v62, v102
    v_mul_f32 v63, v63, v103
    ds_write_b128 v21, v[60:63] offset:20480
    s_mov_b64 exec, 1
    ds_add_u32 v22, v4 offset:112
L_cexit:
    s_endpgm
L_idle:
    s_cmp_lg_u32 s43, 348
    s_cbranch_scc1 L_idl1
    s_cmp_lg_u32 s30, 4
    s_cbranch_scc1 L_idl1
    s_load_dword s31, s[28:29], 0
    s_load_dword s60, s[28:29], 196608 glc
    s_load_dword s61, s[28:29], 204800 glc
    v_lshlrev_b32 v8, 7, v0
    v_add_u32 v8, 8192, v8
    global_load_dword v9, v8, s[28:29] sc0 sc1
    s_barrier
    s_mov_b32 s62, 0
    s_mov_b64 s[68:69], -1
    s_waitcnt lgkmcnt(0)
    s_memtime s[70:71]
    s_waitcnt lgkmcnt(0)
L_ms:
    s_load_dword s60, s[28:29], 196608 glc
    s_waitcnt lgkmcnt(0)
    s_memtime s[72:73]
    s_waitcnt lgkmcnt(0)
    s_sub_u32 s60, s72, s70
    s_min_u32 s68, s68, s60
    s_add_u32 s62, s62, 1
    s_cmp_lt_u32 s62, 4
    s_cbranch_scc1 L_m1
L_m1:
    s_load_dword s60, s[28:29], 204800 glc
    s_waitcnt lgkmcnt(0)
    s_memtime s[70:71]
    s_waitcnt lgkmcnt(0)
    s_sub_u32 s60, s70, s72
    s_min_u32 s69, s69, s60
    s_add_u32 s62, s62, 1
    s_cmp_lt_u32 s62, 4
    s_cbranch_scc1 L_ms
    s_mul_i32 s31, s31, 1664525
    s_add_u32 s31, s31, 1013904223
    s_cmp_gt_u32 s68, s69
    s_cselect_b32 s65, 0x2000, 0
    s_mov_b32 s64, s31
    v_mov_b32 v10, s64
    v_mov_b32 v11, s65
    global_atomic_swap_x2 v8, v[10:11], s[28:29] sc1
    s_branch L_idl0
L_idl1:
    s_barrier
L_idl0:
    s_and_b32 s97, s35, 3
    s_lshl3_add_u32 s96, s97, s30
    s_sub_u32 s96, s96, 4
    v_lshlrev_b32 v4, 7, v0
    v_lshlrev_b32 v5, 10, v0
    s_waitcnt lgkmcnt(0)
    s_mov_b32 s44, s28
    s_and_b32 s45, s29, 0xffff
    s_mov_b32 s46, 2097152
    s_mov_b32 s47, 0x00020000
    s_cmp_lg_u32 s96, 31
    s_cbranch_scc1 L_idl2
    s_mov_b32 s98, 77824
    s_mov_b64 exec, 0xfffffff
    buffer_load_dword v8, v5, s[44:47], s98 offen sc1
    s_mov_b64 exec, -1
L_idl2:
    s_cmp_gt_u32 s96, 1
    s_cbranch_scc1 L_idl3
    s_lshl_b32 s98, s96, 13
    s_add_u32 s98, s98, 65536
    buffer_load_dword v8, v4, s[44:47], s98 offen sc1
L_idl3:
    v_lshrrev_b32 v5, 1, v2
    v_mul_u32_u24 v5, 147712, v5
    v_lshl_add_u32 v5, v2, 13, v5
    v_lshl_add_u32 v5, v1, 7, v5
    s_mov_b32 exec_lo, 0xff1fff1f
    s_mov_b32 exec_hi, 0xff1fff1f
    s_mul_i32 s98, s96, 43
    s_lshr_b32 s98, s98, 8
    s_mul_i32 s99, s98, 4293014784
    s_mul_i32 s98, s96, 328192
    s_add_u32 s98, s98, s99
    s_add_u32 s98, s98, 262144
    buffer_load_dword v9, v5, s[44:47], s98 offen sc1
    s_add_u32 s96, s96, 32
    s_min_u32 s96, s96, 59
    s_mul_i32 s98, s96, 43
    s_lshr_b32 s98, s98, 8
    s_mul_i32 s99, s98, 4293014784
    s_mul_i32 s98, s96, 328192
    s_add_u32 s98, s98, s99
    s_add_u32 s98, s98, 262144
    buffer_load_dword v10, v5, s[44:47], s98 offen sc1
    s_add_u32 s96, s96, 32
    s_min_u32 s96, s96, 59
    s_branch L_cexit
L_hg:
    v_mov_b32 v3, 160960
    s_mov_b32 s101, 0
    s_waitcnt lgkmcnt(0)
    s_cmp_ge_u32 s30, 4
    s_cbranch_scc1 L_ps
    s_setprio 3
    v_mul_u32_u24 v4, 1280, v4
    v_xor_b32 v5, v5, v2
    v_lshl_add_u32 v18, v5, 4, v4
    v_xor_b32 v19, 64, v18
    v_add_u32 v19, 9216, v19
    s_mov_b32 s60, s4
    s_and_b32 s61, s5, 0xffff
    s_mov_b32 s62, 2621440
    s_mov_b32 s63, 0x00020000
    s_sub_u32 s66, s37, 20480
    s_cselect_b32 s66, 0x40000000, s66
    s_mov_b64 s[64:65], s[38:39]
    s_mov_b32 s67, 0
    s_and_b32 s96, s64, 15
    s_mov_b32 m0, s67
    s_lshl_b32 s96, s96, 7
    s_add_u32 s96, s96, s66
    buffer_load_dwordx4 v18, s[60:63], s96 offen lds
    buffer_load_dwordx4 v19, s[60:63], s96 offen offset:1024 lds
    s_lshr_b64 s[64:65], s[64:65], 4
    s_add_u32 s67, s67, 38912
    s_cmp_eq_u32 s67, 116736
    s_cselect_b32 s67, 0, s67
    v_mov_b32 v6, 0
    v_and_b32 v5, 31, v0
    v_lshl_add_u32 v5, v5, 2, v3
    ds_write_b32 v5, v6
    v_lshrrev_b32 v5, 1, v1
    v_xor_b32 v5, v5, v2
    v_lshlrev_b32 v5, 4, v5
    v_lshl_add_u32 v5, v1, 7, v5
    s_add_u32 s96, s33, 1
    s_min_u32 s96, s96, 6
    s_lshl_b32 s96, s96, 11
    v_add_u32 v15, s96, v5
    v_lshlrev_b32 v16, 4, v2
    v_add_u32 v16, 159488, v16
    v_mov_b32 v20, 0
    v_mov_b32 v21, 0
    v_mov_b32 v22, 0
    v_mov_b32 v23, 0
    v_lshlrev_b32 v17, 4, v0
    s_waitcnt lgkmcnt(0)
    s_mov_b32 s40, s22
    s_and_b32 s41, s23, 0xffff
    s_mov_b32 s42, 1280
    s_mov_b32 s43, 0x00020000
    s_mov_b32 m0, 159488
    s_nop 0
    buffer_load_dwordx4 v17, s[40:43], 0 offen lds
    s_mov_b64 exec, 0xffff
    buffer_load_dwordx4 v17, s[40:43], 0 offen offset:1024 lds
    s_mov_b64 exec, -1
    s_and_b32 s96, s64, 15
    s_mov_b32 m0, s67
    s_lshl_b32 s96, s96, 7
    s_add_u32 s96, s96, s66
    buffer_load_dwordx4 v18, s[60:63], s96 offen lds
    buffer_load_dwordx4 v19, s[60:63], s96 offen offset:1024 lds
    s_lshr_b64 s[64:65], s[64:65], 4
    s_add_u32 s67, s67, 38912
    s_cmp_eq_u32 s67, 116736
    s_cselect_b32 s67, 0, s67
    v_lshrrev_b32 v4, 3, v0
    v_and_b32 v5, 7, v0
    v_mul_u32_u24 v4, 1280, v4
    v_lshlrev_b32 v6, 1, v2
    v_xor_b32 v5, v5, v6
    v_lshl_add_u32 v4, v5, 4, v4
    s_lshl_b32 s96, s33, 7
    v_add_u32 v8, s96, v4
    v_lshrrev_b32 v4, 5, v0
    v_mul_u32_u24 v5, 20480, v4
    v_add_u32 v9, v8, v5
    v_mul_u32_u24 v5, 71680, v4
    v_add_u32 v10, v8, v5
    v_mul_u32_u24 v5, 327680, v4
    v_add_u32 v11, v8, v5
    s_mov_b32 s40, s20
    s_and_b32 s41, s21, 0xffff
    s_mov_b32 s42, 819200
    s_mov_b32 s43, 0x00020000
    s_mov_b32 s44, s28
    s_and_b32 s45, s29, 0xffff
    s_mov_b32 s46, 16777216
    s_mov_b32 s47, 0x00020000
    s_load_dword s31, s[28:29], 0
    s_mov_b32 s51, 0
    s_mov_b32 s52, 0
    s_and_b32 s53, s38, 15
    s_lshr_b64 s[38:39], s[38:39], 4
    s_lshl_b32 s53, s53, 7
    s_waitcnt vmcnt(2)
    s_barrier
L_hl:
    s_cmp_ge_u32 s51, 8
    s_cbranch_scc1 L_hnh
    s_setprio 3
    s_and_b32 s96, s64, 15
    s_mov_b32 m0, s67
    s_lshl_b32 s96, s96, 7
    s_add_u32 s96, s96, s66
    buffer_load_dwordx4 v18, s[60:63], s96 offen lds
    buffer_load_dwordx4 v19, s[60:63], s96 offen offset:1024 lds
    s_lshr_b64 s[64:65], s[64:65], 4
    s_add_u32 s67, s67, 38912
    s_cmp_eq_u32 s67, 116736
    s_cselect_b32 s67, 0, s67
L_hnh:
    s_setprio 0
    s_cmp_gt_u32 s33, 5
    s_cbranch_scc1 L_hng
    v_add_u32 v12, s52, v15
    v_add_u32 v14, s53, v16
    v_xor_b32 v13, 64, v12
    ds_read_b128 v[24:27], v12
    ds_read_b128 v[32:35], v14 offset:0
    ds_read_b128 v[28:31], v13
    ds_read_b128 v[36:39], v14 offset:64
    s_waitcnt lgkmcnt(0)
    v_mfma_f32_16x16x32_bf16 v[20:23], v[32:35], v[24:27], v[20:23]
    v_mfma_f32_16x16x32_bf16 v[20:23], v[36:39], v[28:31], v[20:23]
L_hng:
    s_waitcnt lgkmcnt(0)
    s_add_u32 s52, s52, 38912
    s_cmp_eq_u32 s52, 116736
    s_cselect_b32 s52, 0, s52
    s_and_b32 s53, s38, 15
    s_lshr_b64 s[38:39], s[38:39], 4
    s_lshl_b32 s53, s53, 7
    s_cmp_lg_u32 s51, 9
    s_cbranch_scc1 L_hnw
    s_lshr_b32 s96, s2, 3
    s_mul_i32 s96, s96, 30720
    s_and_b32 s97, s2, 1
    s_mul_i32 s97, s97, 640
    s_add_u32 s96, s96, s97
    v_mul_u32_u24 v5, 13108, v0
    v_lshrrev_b32 v5, 16, v5
    v_mul_u32_u24 v5, 640, v5
    v_lshl_add_u32 v5, v0, 7, v5
    s_add_u32 s97, s96, 15360
    s_mov_b32 exec_hi, 0xfffffff
    buffer_load_dword v40, v5, s[40:43], s96 offen
    buffer_load_dword v41, v5, s[40:43], s97 offen
    s_mov_b64 exec, -1
L_hnw:
    s_add_u32 s51, s51, 1
    s_cmp_ge_u32 s51, 10
    s_cbranch_scc1 L_hld
    s_waitcnt vmcnt(2)
    s_cmp_lt_u32 s51, 9
    s_cbranch_scc1 L_hb
    s_waitcnt vmcnt(0)
L_hb:
    s_barrier
    s_branch L_hl
L_hld:
    s_mul_i32 s31, s31, 1664525
    s_add_u32 s31, s31, 1013904223
    v_mov_b32 v24, s31
    s_mul_i32 s54, s32, 768
    s_add_u32 s54, s54, 131072
    v_lshlrev_b32 v26, 3, v0
    s_cmp_gt_u32 s33, 5
    s_cbranch_scc1 L_hgd
    v_cvt_pk_bf16_f32 v25, v20, v20
    v_and_b32 v25, 0xffff0000, v25
    v_mul_f32 v25, 0xbfb8aa3b, v25
    v_exp_f32 v25, v25
    s_nop 0
    v_add_f32 v25, 1.0, v25
    v_rcp_f32 v25, v25
    s_nop 0
    v_cvt_pk_bf16_f32 v25, v25, v25
    v_and_b32 v25, 0xffff0000, v25
    s_lshl_b32 s96, s33, 7
    s_add_u32 s96, s96, s54
    s_mov_b64 exec, 0xffff
    buffer_store_dwordx2 v[24:25], v26, s[44:47], s96 offen sc1
    s_mov_b64 exec, -1
L_hgd:
    s_setprio 1
    s_barrier
    s_sub_u32 s96, 0, s34
    s_cselect_b32 s97, 5, 0
    s_add_u32 s96, s96, s97
    s_lshl_b32 m0, s96, 12
    s_mov_b32 s96, 0
    buffer_load_dwordx4 v8, s[40:43], s96 offen offset:0 lds
    s_mov_b32 s96, 24576
    buffer_load_dwordx4 v8, s[40:43], s96 offen offset:1024 lds
    s_mov_b32 s96, 8192
    buffer_load_dwordx4 v8, s[40:43], s96 offen offset:2048 lds
    s_mov_b32 s96, 32768
    buffer_load_dwordx4 v8, s[40:43], s96 offen offset:3072 lds
    s_sub_u32 s96, 1, s34
    s_cselect_b32 s97, 5, 0
    s_add_u32 s96, s96, s97
    s_lshl_b32 m0, s96, 12
    s_mov_b32 s96, 102400
    buffer_load_dwordx4 v8, s[40:43], s96 offen offset:0 lds
    s_mov_b32 s96, 126976
    buffer_load_dwordx4 v8, s[40:43], s96 offen offset:1024 lds
    s_mov_b32 s96, 110592
    buffer_load_dwordx4 v8, s[40:43], s96 offen offset:2048 lds
    s_mov_b32 s96, 135168
    buffer_load_dwordx4 v8, s[40:43], s96 offen offset:3072 lds
    s_sub_u32 s96, 2, s34
    s_cselect_b32 s97, 5, 0
    s_add_u32 s96, s96, s97
    s_lshl_b32 m0, s96, 12
    s_mov_b32 s96, 179200
    buffer_load_dwordx4 v8, s[40:43], s96 offen offset:0 lds
    s_mov_b32 s96, 203776
    buffer_load_dwordx4 v8, s[40:43], s96 offen offset:1024 lds
    s_mov_b32 s96, 187392
    buffer_load_dwordx4 v8, s[40:43], s96 offen offset:2048 lds
    s_mov_b32 s96, 211968
    buffer_load_dwordx4 v8, s[40:43], s96 offen offset:3072 lds
    s_sub_u32 s96, 3, s34
    s_cselect_b32 s97, 5, 0
    s_add_u32 s96, s96, s97
    s_lshl_b32 m0, s96, 12
    s_mov_b32 s96, 256000
    buffer_load_dwordx4 v8, s[40:43], s96 offen offset:0 lds
    s_mov_b32 s96, 280576
    buffer_load_dwordx4 v8, s[40:43], s96 offen offset:1024 lds
    s_mov_b32 s96, 264192
    buffer_load_dwordx4 v8, s[40:43], s96 offen offset:2048 lds
    s_mov_b32 s96, 288768
    buffer_load_dwordx4 v8, s[40:43], s96 offen offset:3072 lds
    s_sub_u32 s96, 4, s34
    s_cselect_b32 s97, 5, 0
    s_add_u32 s96, s96, s97
    s_lshl_b32 m0, s96, 12
    s_mov_b32 s96, 332800
    buffer_load_dwordx4 v8, s[40:43], s96 offen offset:0 lds
    s_mov_b32 s96, 357376
    buffer_load_dwordx4 v8, s[40:43], s96 offen offset:1024 lds
    s_mov_b32 s96, 340992
    buffer_load_dwordx4 v8, s[40:43], s96 offen offset:2048 lds
    s_mov_b32 s96, 365568
    buffer_load_dwordx4 v8, s[40:43], s96 offen offset:3072 lds
    s_mov_b32 m0, 20480
    s_mov_b32 s96, 20480
    buffer_load_dwordx4 v9, s[40:43], s96 offen offset:0 lds
    s_mov_b32 s96, 121856
    buffer_load_dwordx4 v9, s[40:43], s96 offen offset:1024 lds
    s_mov_b32 s96, 197632
    buffer_load_dwordx4 v9, s[40:43], s96 offen offset:2048 lds
    s_mov_b32 s96, 273408
    buffer_load_dwordx4 v9, s[40:43], s96 offen offset:3072 lds
    s_mov_b32 m0, 61440
    s_mov_b32 s96, 430080
    buffer_load_dwordx4 v9, s[40:43], s96 offen offset:0 lds
    s_mov_b32 s96, 531456
    buffer_load_dwordx4 v9, s[40:43], s96 offen offset:1024 lds
    s_mov_b32 s96, 607232
    buffer_load_dwordx4 v9, s[40:43], s96 offen offset:2048 lds
    s_mov_b32 s96, 683008
    buffer_load_dwordx4 v9, s[40:43], s96 offen offset:3072 lds
    s_mov_b32 m0, 24576
    s_mov_b32 s96, 51200
    buffer_load_dwordx4 v8, s[40:43], s96 offen offset:0 lds
    s_mov_b32 s96, 382976
    buffer_load_dwordx4 v8, s[40:43], s96 offen offset:1024 lds
    s_mov_b32 s96, 59392
    buffer_load_dwordx4 v8, s[40:43], s96 offen offset:2048 lds
    s_mov_b32 s96, 391168
    buffer_load_dwordx4 v8, s[40:43], s96 offen offset:3072 lds
    s_mov_b32 m0, 65536
    s_mov_b32 s96, 460800
    buffer_load_dwordx4 v8, s[40:43], s96 offen offset:0 lds
    s_mov_b32 s96, 792576
    buffer_load_dwordx4 v8, s[40:43], s96 offen offset:1024 lds
    s_mov_b32 s96, 468992
    buffer_load_dwordx4 v8, s[40:43], s96 offen offset:2048 lds
    s_mov_b32 s96, 800768
    buffer_load_dwordx4 v8, s[40:43], s96 offen offset:3072 lds
    s_mov_b32 m0, 28672
    s_mov_b32 s96, 76800
    buffer_load_dwordx4 v8, s[40:43], s96 offen offset:0 lds
    s_mov_b32 s96, 152576
    buffer_load_dwordx4 v8, s[40:43], s96 offen offset:1024 lds
    s_mov_b32 s96, 84992
    buffer_load_dwordx4 v8, s[40:43], s96 offen offset:2048 lds
    s_mov_b32 s96, 160768
    buffer_load_dwordx4 v8, s[40:43], s96 offen offset:3072 lds
    s_mov_b32 m0, 69632
    s_mov_b32 s96, 486400
    buffer_load_dwordx4 v8, s[40:43], s96 offen offset:0 lds
    s_mov_b32 s96, 562176
    buffer_load_dwordx4 v8, s[40:43], s96 offen offset:1024 lds
    s_mov_b32 s96, 494592
    buffer_load_dwordx4 v8, s[40:43], s96 offen offset:2048 lds
    s_mov_b32 s96, 570368
    buffer_load_dwordx4 v8, s[40:43], s96 offen offset:3072 lds
    s_mov_b32 m0, 32768
    s_mov_b32 s96, 230400
    buffer_load_dwordx4 v8, s[40:43], s96 offen offset:0 lds
    s_mov_b32 s96, 306176
    buffer_load_dwordx4 v8, s[40:43], s96 offen offset:1024 lds
    s_mov_b32 s96, 238592
    buffer_load_dwordx4 v8, s[40:43], s96 offen offset:2048 lds
    s_mov_b32 s96, 314368
    buffer_load_dwordx4 v8, s[40:43], s96 offen offset:3072 lds
    s_mov_b32 m0, 73728
    s_mov_b32 s96, 640000
    buffer_load_dwordx4 v8, s[40:43], s96 offen offset:0 lds
    s_mov_b32 s96, 715776
    buffer_load_dwordx4 v8, s[40:43], s96 offen offset:1024 lds
    s_mov_b32 s96, 648192
    buffer_load_dwordx4 v8, s[40:43], s96 offen offset:2048 lds
    s_mov_b32 s96, 723968
    buffer_load_dwordx4 v8, s[40:43], s96 offen offset:3072 lds
    s_mov_b32 m0, 36864
    s_mov_b32 s96, 353280
    buffer_load_dwordx4 v9, s[40:43], s96 offen offset:0 lds
    s_mov_b32 s96, 70656
    buffer_load_dwordx4 v11, s[40:43], s96 offen offset:1024 lds
    s_mov_b32 s96, 95232
    buffer_load_dwordx4 v10, s[40:43], s96 offen offset:2048 lds
    s_mov_b32 s96, 247808
    buffer_load_dwordx4 v10, s[40:43], s96 offen offset:3072 lds
    s_mov_b32 m0, 77824
    s_mov_b32 s96, 762880
    buffer_load_dwordx4 v9, s[40:43], s96 offen offset:0 lds
    s_mov_b32 s96, 480256
    buffer_load_dwordx4 v11, s[40:43], s96 offen offset:1024 lds
    s_mov_b32 s96, 504832
    buffer_load_dwordx4 v10, s[40:43], s96 offen offset:2048 lds
    s_mov_b32 s96, 657408
    buffer_load_dwordx4 v10, s[40:43], s96 offen offset:3072 lds
    v_lshlrev_b32 v27, 2, v0
    v_add_u32 v27, 161088, v27
    s_waitcnt vmcnt(0)
    v_mov_b32 v4, 1
    s_mov_b64 exec, 1
    ds_add_u32 v3, v4 offset:4
    s_mov_b64 exec, -1
    s_mov_b32 s100, 0
    v_mov_b32 v30, s31
L_gp:
    buffer_load_dwordx2 v[28:29], v26, s[44:47], s54 offen sc1
    s_mov_b32 exec_hi, 0
    buffer_load_dwordx2 v[30:31], v26, s[44:47], s54 offen offset:512 sc1
    s_mov_b32 exec_hi, -1
    s_waitcnt vmcnt(0)
    v_cmp_ne_u32 vcc, s31, v28
    v_cmp_ne_u32 s[56:57], s31, v30
    s_or_b64 vcc, vcc, s[56:57]
    s_cbranch_scc0 L_gpd
    s_sleep 8
    s_add_u32 s100, s100, 1
    s_cmp_lt_u32 s100, 1048576
    s_cbranch_scc1 L_gp
L_gpd:
    ds_write_b32 v27, v29
    s_mov_b32 exec_hi, 0
    ds_write_b32 v27, v31 offset:256
    s_mov_b32 exec_hi, -1
    v_mov_b32 v4, 1
    ds_write_b32 v3, v4 offset:12
    s_lshl_b32 s92, s2, 7
    s_and_b32 s92, s92, 0x1f80
    s_load_dwordx2 s[86:87], s[28:29], s92 offset:8192
    s_mov_b32 s100, 0
Lpo_54:
    s_waitcnt lgkmcnt(0)
    s_cmp_eq_u32 s86, s31
    s_cbranch_scc1 Lpd_55
    s_sleep 16
    s_load_dwordx2 s[86:87], s[28:29], s92 offset:8192 glc
    s_add_u32 s100, s100, 1
    s_cmp_lt_u32 s100, 1048576
    s_cbranch_scc1 Lpo_54
    s_waitcnt lgkmcnt(0)
Lpd_55:
    s_and_b32 s92, s87, 0x2000
    s_mul_i32 s96, s32, 164096
    s_cmp_ge_u32 s32, 11
    s_cselect_b32 s100, 1796864, 0
    s_sub_u32 s96, s96, s100
    s_mul_i32 s100, s33, 16640
    s_add_u32 s96, s96, s100
    s_add_u32 s96, s96, 263808
    s_xor_b32 s96, s96, s92
    s_add_u32 s48, s28, s96
    s_addc_u32 s49, s29, 0
    s_mov_b32 s50, 0
    s_mov_b32 s100, 0
    v_mov_b32 v5, 1
    s_min_u32 s51, s34, 1
    s_lshl_b32 s51, s51, 1
    s_mov_b32 s100, 0
Lw_56:
    ds_read_b32 v4, v3 offset:16
    s_waitcnt lgkmcnt(0)
    v_readfirstlane_b32 s99, v4
    s_cmp_ge_u32 s99, s51
    s_cbranch_scc1 Lwd_57
    s_sleep 2
    s_add_u32 s100, s100, 1
    s_cmp_lt_u32 s100, 8388608
    s_cbranch_scc1 Lw_56
Lwd_57:
    s_mov_b32 s100, 0
Lrl_58:
    s_load_dwordx8 s[4:11], s[48:49], 0 glc
    s_load_dwordx8 s[12:19], s[48:49], 256 glc
    s_waitcnt lgkmcnt(0)
    s_cmp_lg_u32 s4, s31
    s_cbranch_scc1 Lrn_60
    s_cmp_lg_u32 s6, s31
    s_cbranch_scc1 Lrn_60
    s_cmp_lg_u32 s8, s31
    s_cbranch_scc1 Lrn_60
    s_cmp_lg_u32 s10, s31
    s_cbranch_scc1 Lrn_60
    s_bitcmp1_b32 s50, 0
    s_cbranch_scc1 Lrn_60
    ds_write_b32 v3, v5 offset:88
    s_bitset1_b32 s50, 0
Lrn_60:
    s_cmp_lg_u32 s12, s31
    s_cbranch_scc1 Lrn_61
    s_cmp_lg_u32 s14, s31
    s_cbranch_scc1 Lrn_61
    s_cmp_lg_u32 s16, s31
    s_cbranch_scc1 Lrn_61
    s_cmp_lg_u32 s18, s31
    s_cbranch_scc1 Lrn_61
    s_bitcmp1_b32 s50, 1
    s_cbranch_scc1 Lrn_61
    ds_write_b32 v3, v5 offset:92
    s_bitset1_b32 s50, 1
Lrn_61:
    s_cmp_eq_u32 s50, 3
    s_cbranch_scc1 Lrd_59
    s_add_u32 s100, s100, 1
    s_cmp_lt_u32 s100, 1048576
    s_cbranch_scc1 Lrl_58
Lrd_59:
    s_endpgm
L_s0:
    s_mul_i32 s31, s31, 1664525
    s_add_u32 s31, s31, 1013904223
    s_mov_b32 s100, 0
Lpo_62:
    s_waitcnt lgkmcnt(0)
    s_cmp_eq_u32 s86, s31
    s_cbranch_scc1 Lpd_63
    s_sleep 16
    s_load_dwordx2 s[86:87], s[28:29], s92 offset:8192 glc
    s_add_u32 s100, s100, 1
    s_cmp_lt_u32 s100, 1048576
    s_cbranch_scc1 Lpo_62
    s_waitcnt lgkmcnt(0)
Lpd_63:
    s_and_b32 s92, s87, 0x2000
    s_mov_b32 s44, s28
    s_and_b32 s45, s29, 0xffff
    s_mov_b32 s46, 16777216
    s_mov_b32 s47, 0x00020000
    v_lshrrev_b32 v4, 3, v0
    v_and_b32 v5, 7, v0
    v_mul_u32_u24 v4, 1280, v4
    v_lshlrev_b32 v6, 1, v2
    v_xor_b32 v5, v5, v6
    v_lshl_add_u32 v4, v5, 4, v4
    s_lshl_b32 s96, s33, 7
    v_add_u32 v8, s96, v4
    v_lshrrev_b32 v4, 5, v0
    v_mul_u32_u24 v5, 20480, v4
    v_add_u32 v9, v8, v5
    v_mul_u32_u24 v5, 71680, v4
    v_add_u32 v10, v8, v5
    v_mul_u32_u24 v5, 327680, v4
    v_add_u32 v11, v8, v5
    s_mov_b32 s40, s20
    s_and_b32 s41, s21, 0xffff
    s_mov_b32 s42, 819200
    s_mov_b32 s43, 0x00020000
    v_lshlrev_b32 v17, 4, v0
    s_mul_i32 s96, s32, 164096
    s_cmp_ge_u32 s32, 11
    s_cselect_b32 s100, 1796864, 0
    s_sub_u32 s96, s96, s100
    s_mul_i32 s100, s33, 16640
    s_add_u32 s96, s96, s100
    s_add_u32 s96, s96, 262656
    s_xor_b32 s96, s96, s92
    s_add_u32 s48, s28, s96
    s_addc_u32 s49, s29, 0
    s_mul_i32 s52, s32, 327680
    s_cmp_ge_u32 s32, 11
    s_cselect_b32 s100, 3596288, 0
    s_sub_u32 s52, s52, s100
    s_lshl_b32 s100, s33, 15
    s_add_u32 s52, s52, s100
    s_add_u32 s52, s52, 12812288
    s_lshr_b32 s100, s52, 8
    s_and_b32 s100, s100, 8192
    s_xor_b32 s52, s52, s100
    s_xor_b32 s52, s52, s92
    s_setprio 3
    s_barrier
    s_sub_u32 s96, 0, s34
    s_cselect_b32 s97, 15, 10
    s_add_u32 s96, s96, s97
    s_lshl_b32 m0, s96, 12
    s_mov_b32 s96, 409600
    buffer_load_dwordx4 v8, s[40:43], s96 offen offset:0 lds
    s_mov_b32 s96, 434176
    buffer_load_dwordx4 v8, s[40:43], s96 offen offset:1024 lds
    s_mov_b32 s96, 417792
    buffer_load_dwordx4 v8, s[40:43], s96 offen offset:2048 lds
    s_mov_b32 s96, 442368
    buffer_load_dwordx4 v8, s[40:43], s96 offen offset:3072 lds
    s_sub_u32 s96, 1, s34
    s_cselect_b32 s97, 15, 10
    s_add_u32 s96, s96, s97
    s_lshl_b32 m0, s96, 12
    s_mov_b32 s96, 512000
    buffer_load_dwordx4 v8, s[40:43], s96 offen offset:0 lds
    s_mov_b32 s96, 536576
    buffer_load_dwordx4 v8, s[40:43], s96 offen offset:1024 lds
    s_mov_b32 s96, 520192
    buffer_load_dwordx4 v8, s[40:43], s96 offen offset:2048 lds
    s_mov_b32 s96, 544768
    buffer_load_dwordx4 v8, s[40:43], s96 offen offset:3072 lds
    s_sub_u32 s96, 2, s34
    s_cselect_b32 s97, 15, 10
    s_add_u32 s96, s96, s97
    s_lshl_b32 m0, s96, 12
    s_mov_b32 s96, 588800
    buffer_load_dwordx4 v8, s[40:43], s96 offen offset:0 lds
    s_mov_b32 s96, 613376
    buffer_load_dwordx4 v8, s[40:43], s96 offen offset:1024 lds
    s_mov_b32 s96, 596992
    buffer_load_dwordx4 v8, s[40:43], s96 offen offset:2048 lds
    s_mov_b32 s96, 621568
    buffer_load_dwordx4 v8, s[40:43], s96 offen offset:3072 lds
    s_sub_u32 s96, 3, s34
    s_cselect_b32 s97, 15, 10
    s_add_u32 s96, s96, s97
    s_lshl_b32 m0, s96, 12
    s_mov_b32 s96, 665600
    buffer_load_dwordx4 v8, s[40:43], s96 offen offset:0 lds
    s_mov_b32 s96, 690176
    buffer_load_dwordx4 v8, s[40:43], s96 offen offset:1024 lds
    s_mov_b32 s96, 673792
    buffer_load_dwordx4 v8, s[40:43], s96 offen offset:2048 lds
    s_mov_b32 s96, 698368
    buffer_load_dwordx4 v8, s[40:43], s96 offen offset:3072 lds
    s_sub_u32 s96, 4, s34
    s_cselect_b32 s97, 15, 10
    s_add_u32 s96, s96, s97
    s_lshl_b32 m0, s96, 12
    s_mov_b32 s96, 742400
    buffer_load_dwordx4 v8, s[40:43], s96 offen offset:0 lds
    s_mov_b32 s96, 766976
    buffer_load_dwordx4 v8, s[40:43], s96 offen offset:1024 lds
    s_mov_b32 s96, 750592
    buffer_load_dwordx4 v8, s[40:43], s96 offen offset:2048 lds
    s_mov_b32 s96, 775168
    buffer_load_dwordx4 v8, s[40:43], s96 offen offset:3072 lds
    s_cmp_eq_u32 s34, 0
    s_cbranch_scc1 L_s0n
    s_mov_b32 s100, 0
L_xp:
    s_add_u32 s100, s100, 1
    s_cmp_ge_u32 s100, 1048576
    s_cbranch_scc1 L_xpd
    s_load_dwordx2 s[4:5], s[48:49], 0 glc
    s_waitcnt lgkmcnt(0)
    s_cmp_lg_u32 s4, s31
    s_cbranch_scc1 L_xp
L_xpd:
    s_mov_b32 m0, 81920
    s_nop 0
    buffer_load_dwordx4 v17, s[44:47], s52 offen offset:0 sc1 lds
    buffer_load_dwordx4 v17, s[44:47], s52 offen offset:1024 sc1 lds
    buffer_load_dwordx4 v17, s[44:47], s52 offen offset:2048 sc1 lds
    buffer_load_dwordx4 v17, s[44:47], s52 offen offset:3072 sc1 lds
    s_add_u32 m0, m0, 4096
    s_xor_b32 s52, s52, 4096
    buffer_load_dwordx4 v17, s[44:47], s52 offen offset:0 sc1 lds
    buffer_load_dwordx4 v17, s[44:47], s52 offen offset:1024 sc1 lds
    buffer_load_dwordx4 v17, s[44:47], s52 offen offset:2048 sc1 lds
    buffer_load_dwordx4 v17, s[44:47], s52 offen offset:3072 sc1 lds
    s_add_u32 m0, m0, 4096
    s_xor_b32 s52, s52, 20480
    buffer_load_dwordx4 v17, s[44:47], s52 offen offset:0 sc1 lds
    buffer_load_dwordx4 v17, s[44:47], s52 offen offset:1024 sc1 lds
L_s0n:
    s_waitcnt vmcnt(0)
    v_mov_b32 v4, 1
    ds_write_b32 v3, v4 offset:8
    v_mov_b32 v4, 1
    s_mov_b64 exec, 1
    ds_add_u32 v3, v4 offset:4
    s_mov_b64 exec, -1
    s_mul_i32 s96, s32, 164096
    s_cmp_ge_u32 s32, 11
    s_cselect_b32 s100, 1796864, 0
    s_sub_u32 s96, s96, s100
    s_mul_i32 s100, s33, 16640
    s_add_u32 s96, s96, s100
    s_add_u32 s96, s96, 263296
    s_xor_b32 s96, s96, s92
    s_add_u32 s48, s28, s96
    s_addc_u32 s49, s29, 0
    s_mov_b32 s50, 0
    s_mov_b32 s100, 0
    v_mov_b32 v5, 1
    s_min_u32 s51, s34, 1
    s_lshl_b32 s51, s51, 1
    s_mov_b32 s100, 0
Lw_64:
    ds_read_b32 v4, v3 offset:16
    s_waitcnt lgkmcnt(0)
    v_readfirstlane_b32 s99, v4
    s_cmp_ge_u32 s99, s51
    s_cbranch_scc1 Lwd_65
    s_sleep 2
    s_add_u32 s100, s100, 1
    s_cmp_lt_u32 s100, 8388608
    s_cbranch_scc1 Lw_64
Lwd_65:
    s_mov_b32 s100, 0
Lrl_66:
    s_load_dwordx8 s[4:11], s[48:49], 0 glc
    s_load_dwordx8 s[12:19], s[48:49], 256 glc
    s_waitcnt lgkmcnt(0)
    s_cmp_lg_u32 s4, s31
    s_cbranch_scc1 Lrn_68
    s_cmp_lg_u32 s6, s31
    s_cbranch_scc1 Lrn_68
    s_cmp_lg_u32 s8, s31
    s_cbranch_scc1 Lrn_68
    s_cmp_lg_u32 s10, s31
    s_cbranch_scc1 Lrn_68
    s_bitcmp1_b32 s50, 0
    s_cbranch_scc1 Lrn_68
    ds_write_b32 v3, v5 offset:80
    s_bitset1_b32 s50, 0
Lrn_68:
    s_cmp_lg_u32 s12, s31
    s_cbranch_scc1 Lrn_69
    s_cmp_lg_u32 s14, s31
    s_cbranch_scc1 Lrn_69
    s_cmp_lg_u32 s16, s31
    s_cbranch_scc1 Lrn_69
    s_cmp_lg_u32 s18, s31
    s_cbranch_scc1 Lrn_69
    s_bitcmp1_b32 s50, 1
    s_cbranch_scc1 Lrn_69
    ds_write_b32 v3, v5 offset:84
    s_bitset1_b32 s50, 1
Lrn_69:
    s_cmp_eq_u32 s50, 3
    s_cbranch_scc1 Lrd_67
    s_add_u32 s100, s100, 1
    s_cmp_lt_u32 s100, 1048576
    s_cbranch_scc1 Lrl_66
Lrd_67:
    s_endpgm
L_ps:
    s_cmp_ge_u32 s30, 4
    s_cselect_b32 s96, -4, 3
    s_add_u32 s60, s30, s96
    s_and_b32 s61, s60, 1
    s_and_b32 s96, s34, 3
    s_cselect_b32 s96, 4, 6
    s_cmp_ge_u32 s60, s96
    s_cselect_b32 s62, 1, 0
    v_mov_b32 v7, 0xf149f2ca
    v_lshlrev_b32 v4, 2, v2
    v_sub_u32 v4, v1, v4
    v_subrev_u32 v5, 0, v4
    v_and_b32 v5, 0x80000001, v5
    v_cmp_eq_u32 vcc, 0, v5
    s_nop 1
    v_cndmask_b32 v146, v7, 0, vcc
    v_cmp_eq_u32 vcc, 0x80000000, v5
    s_nop 1
    v_cndmask_b32 v150, v7, 0, vcc
    v_subrev_u32 v5, 1, v4
    v_and_b32 v5, 0x80000001, v5
    v_cmp_eq_u32 vcc, 0, v5
    s_nop 1
    v_cndmask_b32 v147, v7, 0, vcc
    v_cmp_eq_u32 vcc, 0x80000000, v5
    s_nop 1
    v_cndmask_b32 v151, v7, 0, vcc
    v_subrev_u32 v5, 2, v4
    v_and_b32 v5, 0x80000001, v5
    v_cmp_eq_u32 vcc, 0, v5
    s_nop 1
    v_cndmask_b32 v148, v7, 0, vcc
    v_cmp_eq_u32 vcc, 0x80000000, v5
    s_nop 1
    v_cndmask_b32 v152, v7, 0, vcc
    v_subrev_u32 v5, 3, v4
    v_and_b32 v5, 0x80000001, v5
    v_cmp_eq_u32 vcc, 0, v5
    s_nop 1
    v_cndmask_b32 v149, v7, 0, vcc
    v_cmp_eq_u32 vcc, 0x80000000, v5
    s_nop 1
    v_cndmask_b32 v153, v7, 0, vcc
    v_and_b32 v5, 1, v1
    v_lshlrev_b32 v6, 4, v5
    v_sub_u32 v5, v4, v5
    v_mov_b32 v4, 0x0c0c0c0c
    v_mov_b32 v7, 0xc0c0100
    v_alignbit_b32 v7, v7, v7, v6
    v_cmp_le_i32 vcc, 0, v5
    s_nop 1
    v_cndmask_b32 v154, v4, v7, vcc
    v_cndmask_b32 v156, v7, v4, vcc
    v_mov_b32 v7, 0xc0c0302
    v_alignbit_b32 v7, v7, v7, v6
    v_cmp_le_i32 vcc, 2, v5
    s_nop 1
    v_cndmask_b32 v155, v4, v7, vcc
    v_cndmask_b32 v157, v7, v4, vcc
    v_cmp_eq_u32 vcc, 0, v2
    s_nop 1
    v_cndmask_b32 v159, 0, -1, vcc
    s_mov_b32 s66, 0x3ea52b5c
    s_or_b32 s96, s32, s61
    s_cselect_b32 s67, 0, 0xf149f2ca
    s_mul_i32 s64, s61, 6128
    s_add_u32 s64, s64, 3080
    s_mul_i32 s65, s61, 3064
    s_add_u32 s65, s65, 6152
    s_mul_i32 s68, s32, 262144
    s_cmp_ge_u32 s32, 11
    s_cselect_b32 s100, 2875392, 0
    s_sub_u32 s68, s68, s100
    s_lshl_b32 s96, s61, 17
    s_add_u32 s68, s68, s96
    s_add_u32 s68, s68, 9961472
    s_lshr_b32 s100, s68, 8
    s_and_b32 s100, s100, 8192
    s_xor_b32 s68, s68, s100
    s_mov_b32 s69, 0
L_us:
    s_min_u32 s96, s34, 1
    s_lshr_b32 s97, s60, 1
    s_add_u32 s96, s96, s97
    s_lshl1_add_u32 s99, s34, s97
    s_lshr_b32 s98, s34, 2
    s_add_u32 s98, s98, 10
    s_cmp_ge_u32 s60, 4
    s_cselect_b32 s63, s98, s99
    s_add_u32 s98, s34, 11
    s_cmp_lg_u32 s62, 0
    s_cselect_b32 s63, s98, s63
    s_cselect_b32 s96, 0, s96
    s_add_u32 s98, s34, 10
    v_sub_u32 v4, s98, v1
    v_mul_u32_u24 v5, 52, v4
    v_lshrrev_b32 v5, 8, v5
    v_mul_u32_u24 v5, 5, v5
    v_sub_u32 v4, v4, v5
    s_sub_u32 s99, s63, 5
    s_mul_i32 s98, s62, 9
    s_add_u32 s99, s99, s98
    s_cmp_lt_u32 s60, 4
    s_cbranch_scc1 L_ufs
    v_mov_b32 v4, s99
L_ufs:
    s_and_b32 s98, s2, 1
    s_lshl1_add_u32 s98, s98, s61
    s_lshl_b32 s98, s98, 8
    s_mul_i32 s99, s32, 164096
    s_cmp_ge_u32 s32, 11
    s_cselect_b32 s100, 1796864, 0
    s_sub_u32 s99, s99, s100
    s_add_u32 s98, s98, s99
    s_add_u32 s98, s98, 263168
    v_lshl_add_u32 v4, v4, 3, s98
    v_mul_u32_u24 v164, 16640, v1
    v_add_u32 v164, v164, v4
    s_mul_i32 s96, s96, 5
    s_add_u32 s96, s96, 4
    s_sub_u32 s96, s96, s34
    s_lshl3_add_u32 s97, s61, 81920
    v_add_u32 v4, s96, v2
    v_lshrrev_b32 v5, 2, v4
    v_mul_u32_u24 v5, 9216, v5
    v_lshl_add_u32 v5, v4, 8, v5
    v_lshl_add_u32 v6, v1, 4, s97
    v_add_u32 v158, v5, v6
    s_lshl_b32 s96, s96, 2
    v_lshl_add_u32 v6, v2, 8, s97
    v_add_u32 v4, s96, v1
    v_lshrrev_b32 v5, 4, v4
    v_mul_u32_u24 v5, 9984, v5
    v_lshl_add_u32 v5, v4, 4, v5
    v_add_u32 v160, v5, v6
    s_lshr_b32 s98, s96, 4
    s_mul_i32 s98, s98, 9984
    s_lshl4_add_u32 s98, s96, s98
    s_add_u32 s98, s98, 10240
    v_and_b32 v4, 3, v1
    v_lshl_add_u32 v4, v4, 4, s98
    v_add_u32 v161, v4, v6
    s_and_b32 s97, s2, 1
    s_lshl_b32 s97, s97, 16
    s_lshl_b32 s96, s63, 9
    s_add_u32 s96, s96, s97
    v_lshrrev_b32 v4, 5, v0
    v_mul_u32_u24 v4, 15872, v4
    v_lshl_add_u32 v4, v0, 4, v4
    v_add_u32 v162, s96, v4
    s_lshl_b32 s96, s63, 7
    s_add_u32 s96, s96, s97
    s_add_u32 s96, s96, 49152
    v_lshlrev_b32 v4, 11, v2
    v_lshl_add_u32 v4, v1, 3, v4
    v_add_u32 v163, s96, v4
    s_cmp_eq_u32 s101, 1
    s_cbranch_scc1 L_pb10
    s_cmp_eq_u32 s101, 2
    s_cbranch_scc1 L_upre
    s_setprio 2
    v_lshrrev_b32 v5, 1, v1
    v_xor_b32 v5, v5, v2
    v_lshlrev_b32 v5, 4, v5
    v_lshl_add_u32 v140, v1, 7, v5
    v_bfe_u32 v4, v0, 2, 2
    v_lshl_add_u32 v5, v2, 3, v4
    v_lshlrev_b32 v5, 7, v5
    v_bfe_u32 v6, v0, 3, 2
    v_xor_b32 v6, s60, v6
    v_lshl_add_u32 v5, v6, 5, v5
    v_and_b32 v6, 3, v0
    v_lshl_add_u32 v5, v6, 3, v5
    v_add_u32 v141, 14336, v5
    v_mov_b32 v8, 0
    v_mov_b32 v9, 0
    v_mov_b32 v10, 0
    v_mov_b32 v11, 0
    v_mov_b32 v12, 0
    v_mov_b32 v13, 0
    v_mov_b32 v14, 0
    v_mov_b32 v15, 0
    v_mov_b32 v16, 0
    v_mov_b32 v17, 0
    v_mov_b32 v18, 0
    v_mov_b32 v19, 0
    v_mov_b32 v20, 0
    v_mov_b32 v21, 0
    v_mov_b32 v22, 0
    v_mov_b32 v23, 0
    v_mov_b32 v24, 0
    v_mov_b32 v25, 0
    v_mov_b32 v26, 0
    v_mov_b32 v27, 0
    v_mov_b32 v28, 0
    v_mov_b32 v29, 0
    v_mov_b32 v30, 0
    v_mov_b32 v31, 0
    v_mov_b32 v32, 0
    v_mov_b32 v33, 0
    v_mov_b32 v34, 0
    v_mov_b32 v35, 0
    v_mov_b32 v36, 0
    v_mov_b32 v37, 0
    v_mov_b32 v38, 0
    v_mov_b32 v39, 0
    v_mov_b32 v40, 0
    v_mov_b32 v41, 0
    v_mov_b32 v42, 0
    v_mov_b32 v43, 0
    v_mov_b32 v44, 0
    v_mov_b32 v45, 0
    v_mov_b32 v46, 0
    v_mov_b32 v47, 0
    v_mov_b32 v48, 0
    v_mov_b32 v49, 0
    v_mov_b32 v50, 0
    v_mov_b32 v51, 0
    v_mov_b32 v52, 0
    v_mov_b32 v53, 0
    v_mov_b32 v54, 0
    v_mov_b32 v55, 0
    v_mov_b32 v56, 0
    v_mov_b32 v57, 0
    v_mov_b32 v58, 0
    v_mov_b32 v59, 0
    v_mov_b32 v60, 0
    v_mov_b32 v61, 0
    v_mov_b32 v62, 0
    v_mov_b32 v63, 0
    v_mov_b32 v64, 0
    v_mov_b32 v65, 0
    v_mov_b32 v66, 0
    v_mov_b32 v67, 0
    v_mov_b32 v68, 0
    v_mov_b32 v69, 0
    v_mov_b32 v70, 0
    v_mov_b32 v71, 0
    v_mov_b32 v72, 0
    v_mov_b32 v73, 0
    v_mov_b32 v74, 0
    v_mov_b32 v75, 0
    v_mov_b32 v76, 0
    v_mov_b32 v77, 0
    v_mov_b32 v78, 0
    v_mov_b32 v79, 0
    v_mov_b32 v80, 0
    v_mov_b32 v81, 0
    v_mov_b32 v82, 0
    v_mov_b32 v83, 0
    v_mov_b32 v84, 0
    v_mov_b32 v85, 0
    v_mov_b32 v86, 0
    v_mov_b32 v87, 0
    s_mov_b32 s41, 0
    s_mov_b32 s42, 0
    v_mov_b32 v142, v140
    v_xor_b32 v143, 64, v140
    v_mov_b32 v144, v141
    s_add_u32 s96, s60, 1
    s_mul_i32 s96, s96, 10240
    s_add_u32 s96, s96, 81920
    v_lshl_add_u32 v145, v0, 4, s96
    v_lshlrev_b32 v7, 4, v0
    s_waitcnt lgkmcnt(0)
    s_mov_b32 s44, s28
    s_and_b32 s45, s29, 0xffff
    s_mov_b32 s46, 16777216
    s_mov_b32 s47, 0x00020000
    s_mul_i32 s70, s32, 327680
    s_cmp_ge_u32 s32, 11
    s_cselect_b32 s100, 3596288, 0
    s_sub_u32 s70, s70, s100
    s_lshl_b32 s100, s33, 15
    s_add_u32 s70, s70, s100
    s_add_u32 s70, s70, 12845056
    s_lshr_b32 s100, s70, 8
    s_and_b32 s100, s100, 8192
    s_xor_b32 s70, s70, s100
    s_mul_i32 s97, s32, 164096
    s_cmp_ge_u32 s32, 11
    s_cselect_b32 s100, 1796864, 0
    s_sub_u32 s97, s97, s100
    s_mul_i32 s100, s33, 16640
    s_add_u32 s97, s97, s100
    s_add_u32 s97, s97, 279296
    s_cmp_eq_u32 s30, 7
    s_cselect_b32 s69, s97, 0
    s_cmp_eq_u32 s34, 4
    s_cselect_b32 s69, 0, s69
    s_load_dword s31, s[28:29], 0
    s_barrier
    ds_read_b64_tr_b16 v[120:121], v144 offset:4096
    ds_read_b64_tr_b16 v[122:123], v144 offset:4608
    ds_read_b128 v[88:91], v142 offset:0
    ds_read_b64_tr_b16 v[124:125], v144 offset:8192
    ds_read_b64_tr_b16 v[126:127], v144 offset:8704
    ds_read_b128 v[92:95], v142 offset:2048
    ds_read_b64_tr_b16 v[116:117], v144 offset:0
    ds_read_b64_tr_b16 v[118:119], v144 offset:512
    ds_read_b128 v[96:99], v142 offset:4096
    ds_read_b128 v[100:103], v142 offset:6144
    ds_read_b128 v[104:107], v142 offset:8192
    ds_read_b128 v[108:111], v142 offset:10240
    ds_read_b128 v[112:115], v142 offset:12288
    s_waitcnt lgkmcnt(0)
    s_mul_i32 s31, s31, 1664525
    s_add_u32 s31, s31, 1013904223
L_gl:
    s_waitcnt lgkmcnt(10)
    v_mfma_f32_16x16x32_bf16 v[32:35], v[120:123], v[88:91], v[32:35]
    ds_read_b64_tr_b16 v[132:133], v144 offset:16384
    s_waitcnt lgkmcnt(9)
    v_mfma_f32_16x16x32_bf16 v[60:63], v[88:91], v[124:127], v[60:63]
    ds_read_b64_tr_b16 v[134:135], v144 offset:16896
    s_waitcnt lgkmcnt(9)
    v_mfma_f32_16x16x32_bf16 v[36:39], v[120:123], v[92:95], v[36:39]
    ds_read_b128 v[88:91], v143 offset:0
    v_mfma_f32_16x16x32_bf16 v[64:67], v[92:95], v[124:127], v[64:67]
    ds_read_b64_tr_b16 v[136:137], v144 offset:20480
    s_waitcnt lgkmcnt(9)
    v_mfma_f32_16x16x32_bf16 v[8:11], v[116:119], v[92:95], v[8:11]
    ds_read_b64_tr_b16 v[138:139], v144 offset:20992
    s_waitcnt lgkmcnt(9)
    v_mfma_f32_16x16x32_bf16 v[40:43], v[120:123], v[96:99], v[40:43]
    ds_read_b128 v[92:95], v143 offset:2048
    v_mfma_f32_16x16x32_bf16 v[68:71], v[96:99], v[124:127], v[68:71]
    ds_read_b64_tr_b16 v[128:129], v144 offset:12288
    v_mfma_f32_16x16x32_bf16 v[12:15], v[116:119], v[96:99], v[12:15]
    ds_read_b64_tr_b16 v[130:131], v144 offset:12800
    s_waitcnt lgkmcnt(11)
    v_mfma_f32_16x16x32_bf16 v[44:47], v[120:123], v[100:103], v[44:47]
    ds_read_b128 v[96:99], v143 offset:4096
    v_mfma_f32_16x16x32_bf16 v[72:75], v[100:103], v[124:127], v[72:75]
    s_cmp_lg_u32 s42, 8
    s_cbranch_scc1 L_gnp
    s_lshl_b32 s92, s2, 7
    s_and_b32 s92, s92, 0x1f80
    s_load_dwordx2 s[86:87], s[28:29], s92 offset:8192
L_gnp:
    v_mfma_f32_16x16x32_bf16 v[16:19], v[116:119], v[100:103], v[16:19]
    ds_read_b128 v[100:103], v143 offset:6144
    s_waitcnt lgkmcnt(12)
    v_mfma_f32_16x16x32_bf16 v[48:51], v[120:123], v[104:107], v[48:51]
    v_mfma_f32_16x16x32_bf16 v[76:79], v[104:107], v[124:127], v[76:79]
    s_add_u32 s41, s41, 38912
    v_mfma_f32_16x16x32_bf16 v[20:23], v[116:119], v[104:107], v[20:23]
    ds_read_b128 v[104:107], v143 offset:8192
    s_waitcnt lgkmcnt(12)
    v_mfma_f32_16x16x32_bf16 v[52:55], v[120:123], v[108:111], v[52:55]
    s_cmp_eq_u32 s41, 116736
    s_cselect_b32 s41, 0, s41
    v_mfma_f32_16x16x32_bf16 v[80:83], v[108:111], v[124:127], v[80:83]
    v_add_u32 v144, s41, v141
    v_mfma_f32_16x16x32_bf16 v[24:27], v[116:119], v[108:111], v[24:27]
    ds_read_b128 v[108:111], v143 offset:10240
    s_waitcnt lgkmcnt(12)
    v_mfma_f32_16x16x32_bf16 v[56:59], v[120:123], v[112:115], v[56:59]
    v_add_u32 v142, s41, v140
    v_mfma_f32_16x16x32_bf16 v[84:87], v[112:115], v[124:127], v[84:87]
    v_mfma_f32_16x16x32_bf16 v[28:31], v[116:119], v[112:115], v[28:31]
    ds_read_b128 v[112:115], v143 offset:12288
    s_waitcnt lgkmcnt(10)
    v_mfma_f32_16x16x32_bf16 v[32:35], v[132:135], v[88:91], v[32:35]
    s_waitcnt lgkmcnt(8)
    v_mfma_f32_16x16x32_bf16 v[60:63], v[88:91], v[136:139], v[60:63]
    v_xor_b32 v143, 64, v142
    s_waitcnt lgkmcnt(7)
    v_mfma_f32_16x16x32_bf16 v[36:39], v[132:135], v[92:95], v[36:39]
    s_add_u32 s42, s42, 1
    v_mfma_f32_16x16x32_bf16 v[64:67], v[92:95], v[136:139], v[64:67]
    s_waitcnt lgkmcnt(5)
    v_mfma_f32_16x16x32_bf16 v[8:11], v[128:131], v[92:95], v[8:11]
    s_waitcnt lgkmcnt(0)

    v_mfma_f32_16x16x32_bf16 v[40:43], v[132:135], v[96:99], v[40:43]
    v_mfma_f32_16x16x32_bf16 v[68:71], v[96:99], v[136:139], v[68:71]
    s_barrier
    v_mfma_f32_16x16x32_bf16 v[12:15], v[128:131], v[96:99], v[12:15]
    ds_read_b64_tr_b16 v[120:121], v144 offset:4096
    v_mfma_f32_16x16x32_bf16 v[44:47], v[132:135], v[100:103], v[44:47]
    ds_read_b64_tr_b16 v[122:123], v144 offset:4608
    v_mfma_f32_16x16x32_bf16 v[72:75], v[100:103], v[136:139], v[72:75]
    ds_read_b128 v[88:91], v142 offset:0
    v_mfma_f32_16x16x32_bf16 v[16:19], v[128:131], v[100:103], v[16:19]
    ds_read_b64_tr_b16 v[124:125], v144 offset:8192
    v_mfma_f32_16x16x32_bf16 v[48:51], v[132:135], v[104:107], v[48:51]
    ds_read_b64_tr_b16 v[126:127], v144 offset:8704
    v_mfma_f32_16x16x32_bf16 v[76:79], v[104:107], v[136:139], v[76:79]
    ds_read_b128 v[92:95], v142 offset:2048
    v_mfma_f32_16x16x32_bf16 v[20:23], v[128:131], v[104:107], v[20:23]
    ds_read_b64_tr_b16 v[116:117], v144 offset:0
    v_mfma_f32_16x16x32_bf16 v[52:55], v[132:135], v[108:111], v[52:55]
    ds_read_b64_tr_b16 v[118:119], v144 offset:512
    v_mfma_f32_16x16x32_bf16 v[80:83], v[108:111], v[136:139], v[80:83]
    ds_read_b128 v[96:99], v142 offset:4096
    v_mfma_f32_16x16x32_bf16 v[24:27], v[128:131], v[108:111], v[24:27]
    ds_read_b128 v[100:103], v142 offset:6144
    v_mfma_f32_16x16x32_bf16 v[56:59], v[132:135], v[112:115], v[56:59]
    ds_read_b128 v[104:107], v142 offset:8192
    v_mfma_f32_16x16x32_bf16 v[84:87], v[112:115], v[136:139], v[84:87]
    ds_read_b128 v[108:111], v142 offset:10240
    s_cmp_lt_u32 s42, 9
    v_mfma_f32_16x16x32_bf16 v[28:31], v[128:131], v[112:115], v[28:31]
    ds_read_b128 v[112:115], v142 offset:12288
    s_cbranch_scc1 L_gl
    s_cmp_lg_u32 s86, s31
    s_cbranch_scc1 L_gpslow
    s_and_b32 s92, s87, 0x2000
L_gpok:
    s_cmp_lg_u32 s69, 0
    s_cbranch_scc1 L_lsend

    s_waitcnt lgkmcnt(10)
    v_mfma_f32_16x16x32_bf16 v[32:35], v[120:123], v[88:91], v[32:35]
    ds_read_b64_tr_b16 v[132:133], v144 offset:16384
    s_waitcnt lgkmcnt(9)
    v_mfma_f32_16x16x32_bf16 v[60:63], v[88:91], v[124:127], v[60:63]
    ds_read_b128 v[88:91], v143 offset:0
    s_waitcnt lgkmcnt(5)
    v_mfma_f32_16x16x32_bf16 v[44:47], v[120:123], v[100:103], v[44:47]
    ds_read_b64_tr_b16 v[134:135], v144 offset:16896
    v_mfma_f32_16x16x32_bf16 v[72:75], v[100:103], v[124:127], v[72:75]
    ds_read_b64_tr_b16 v[136:137], v144 offset:20480
    v_mfma_f32_16x16x32_bf16 v[16:19], v[116:119], v[100:103], v[16:19]
    ds_read_b128 v[100:103], v143 offset:6144
    v_mfma_f32_16x16x32_bf16 v[36:39], v[120:123], v[92:95], v[36:39]
    ds_read_b64_tr_b16 v[138:139], v144 offset:20992
    v_mfma_f32_16x16x32_bf16 v[64:67], v[92:95], v[124:127], v[64:67]
    ds_read_b64_tr_b16 v[128:129], v144 offset:12288
    v_mfma_f32_16x16x32_bf16 v[8:11], v[116:119], v[92:95], v[8:11]
    ds_read_b128 v[92:95], v143 offset:2048
    s_waitcnt lgkmcnt(8)
    v_mfma_f32_16x16x32_bf16 v[56:59], v[120:123], v[112:115], v[56:59]
    ds_read_b64_tr_b16 v[130:131], v144 offset:12800
    v_mfma_f32_16x16x32_bf16 v[84:87], v[112:115], v[124:127], v[84:87]
    v_mfma_f32_16x16x32_bf16 v[28:31], v[116:119], v[112:115], v[28:31]
    ds_read_b128 v[112:115], v143 offset:12288
    s_waitcnt lgkmcnt(7)
    v_mfma_f32_16x16x32_bf16 v[32:35], v[132:135], v[88:91], v[32:35]
    s_waitcnt lgkmcnt(4)
    v_mfma_f32_16x16x32_bf16 v[60:63], v[88:91], v[136:139], v[60:63]
    v_mfma_f32_16x16x32_bf16 v[44:47], v[132:135], v[100:103], v[44:47]
    v_mfma_f32_16x16x32_bf16 v[72:75], v[100:103], v[136:139], v[72:75]
    s_waitcnt lgkmcnt(1)
    v_mfma_f32_16x16x32_bf16 v[16:19], v[128:131], v[100:103], v[16:19]
    s_nop 1
    v_cvt_pk_bf16_f32 v32, v32, v33
    v_cvt_pk_bf16_f32 v33, v34, v35
    v_mfma_f32_16x16x32_bf16 v[48:51], v[120:123], v[104:107], v[48:51]
    v_cvt_pk_bf16_f32 v60, v60, v61
    v_cvt_pk_bf16_f32 v61, v62, v63
    v_mfma_f32_16x16x32_bf16 v[76:79], v[104:107], v[124:127], v[76:79]
    v_cvt_pk_bf16_f32 v34, v44, v45
    v_cvt_pk_bf16_f32 v35, v46, v47
    v_mfma_f32_16x16x32_bf16 v[20:23], v[116:119], v[104:107], v[20:23]
    ds_read_b128 v[104:107], v143 offset:8192
    ds_write_b128 v145, v[32:35] offset:3072
    s_waitcnt lgkmcnt(2)
    v_mfma_f32_16x16x32_bf16 v[56:59], v[132:135], v[112:115], v[56:59]
    v_cvt_pk_bf16_f32 v62, v72, v73
    v_cvt_pk_bf16_f32 v63, v74, v75
    v_mfma_f32_16x16x32_bf16 v[84:87], v[112:115], v[136:139], v[84:87]
    ds_write_b128 v145, v[60:63] offset:6144
    v_cvt_pk_bf16_f32 v16, v16, v17
    v_mfma_f32_16x16x32_bf16 v[28:31], v[128:131], v[112:115], v[28:31]
    v_cvt_pk_bf16_f32 v17, v18, v19
    v_mfma_f32_16x16x32_bf16 v[40:43], v[120:123], v[96:99], v[40:43]
    v_mfma_f32_16x16x32_bf16 v[68:71], v[96:99], v[124:127], v[68:71]
    v_cvt_pk_bf16_f32 v56, v56, v57
    v_cvt_pk_bf16_f32 v57, v58, v59
    v_mfma_f32_16x16x32_bf16 v[12:15], v[116:119], v[96:99], v[12:15]
    ds_read_b128 v[96:99], v143 offset:4096
    v_cvt_pk_bf16_f32 v58, v84, v85
    v_mfma_f32_16x16x32_bf16 v[36:39], v[132:135], v[92:95], v[36:39]
    v_cvt_pk_bf16_f32 v59, v86, v87
    ds_write_b128 v145, v[56:59] offset:9216
    v_mfma_f32_16x16x32_bf16 v[64:67], v[92:95], v[136:139], v[64:67]
    v_cvt_pk_bf16_f32 v18, v28, v29
    v_cvt_pk_bf16_f32 v19, v30, v31
    v_mfma_f32_16x16x32_bf16 v[8:11], v[128:131], v[92:95], v[8:11]
    ds_write_b128 v145, v[16:19] offset:2048
    v_mfma_f32_16x16x32_bf16 v[52:55], v[120:123], v[108:111], v[52:55]
    v_mfma_f32_16x16x32_bf16 v[80:83], v[108:111], v[124:127], v[80:83]
    v_cvt_pk_bf16_f32 v36, v36, v37
    v_cvt_pk_bf16_f32 v37, v38, v39
    v_mfma_f32_16x16x32_bf16 v[24:27], v[116:119], v[108:111], v[24:27]
    ds_read_b128 v[108:111], v143 offset:10240
    v_cvt_pk_bf16_f32 v64, v64, v65
    s_waitcnt lgkmcnt(6)
    v_mfma_f32_16x16x32_bf16 v[48:51], v[132:135], v[104:107], v[48:51]
    v_cvt_pk_bf16_f32 v65, v66, v67
    v_cvt_pk_bf16_f32 v8, v8, v9
    v_mfma_f32_16x16x32_bf16 v[76:79], v[104:107], v[136:139], v[76:79]
    v_cvt_pk_bf16_f32 v9, v10, v11
    v_mfma_f32_16x16x32_bf16 v[20:23], v[128:131], v[104:107], v[20:23]
    s_waitcnt lgkmcnt(3)
    v_mfma_f32_16x16x32_bf16 v[40:43], v[132:135], v[96:99], v[40:43]
    v_mfma_f32_16x16x32_bf16 v[68:71], v[96:99], v[136:139], v[68:71]
    v_cvt_pk_bf16_f32 v38, v48, v49
    v_cvt_pk_bf16_f32 v39, v50, v51
    v_mfma_f32_16x16x32_bf16 v[12:15], v[128:131], v[96:99], v[12:15]
    ds_write_b128 v145, v[36:39] offset:4096
    v_cvt_pk_bf16_f32 v66, v76, v77
    s_waitcnt lgkmcnt(1)
    v_mfma_f32_16x16x32_bf16 v[52:55], v[132:135], v[108:111], v[52:55]
    v_cvt_pk_bf16_f32 v67, v78, v79
    ds_write_b128 v145, v[64:67] offset:7168
    v_mfma_f32_16x16x32_bf16 v[80:83], v[108:111], v[136:139], v[80:83]
    v_cvt_pk_bf16_f32 v10, v20, v21
    v_cvt_pk_bf16_f32 v11, v22, v23
    v_mfma_f32_16x16x32_bf16 v[24:27], v[128:131], v[108:111], v[24:27]
    ds_write_b128 v145, v[8:11] offset:0
    v_cvt_pk_bf16_f32 v40, v40, v41
    v_cvt_pk_bf16_f32 v41, v42, v43
    v_cvt_pk_bf16_f32 v68, v68, v69
    v_cvt_pk_bf16_f32 v69, v70, v71
    v_cvt_pk_bf16_f32 v12, v12, v13
    v_cvt_pk_bf16_f32 v13, v14, v15
    v_cvt_pk_bf16_f32 v42, v52, v53
    v_cvt_pk_bf16_f32 v43, v54, v55
    ds_write_b128 v145, v[40:43] offset:5120
    v_cvt_pk_bf16_f32 v70, v80, v81
    v_cvt_pk_bf16_f32 v71, v82, v83
    ds_write_b128 v145, v[68:71] offset:8192
    v_cvt_pk_bf16_f32 v14, v24, v25
    v_cvt_pk_bf16_f32 v15, v26, v27
    ds_write_b128 v145, v[12:15] offset:1024
    s_branch L_pb10b
L_lsend:
    s_xor_b32 s70, s70, s92
    s_xor_b32 s69, s69, s92
    s_xor_b32 s71, s70, 4096
    s_xor_b32 s72, s70, 16384

    s_waitcnt lgkmcnt(10)
    v_mfma_f32_16x16x32_bf16 v[32:35], v[120:123], v[88:91], v[32:35]
    ds_read_b64_tr_b16 v[132:133], v144 offset:16384
    s_waitcnt lgkmcnt(9)
    v_mfma_f32_16x16x32_bf16 v[60:63], v[88:91], v[124:127], v[60:63]
    ds_read_b128 v[88:91], v143 offset:0
    s_waitcnt lgkmcnt(5)
    v_mfma_f32_16x16x32_bf16 v[44:47], v[120:123], v[100:103], v[44:47]
    ds_read_b64_tr_b16 v[134:135], v144 offset:16896
    v_mfma_f32_16x16x32_bf16 v[72:75], v[100:103], v[124:127], v[72:75]
    ds_read_b64_tr_b16 v[136:137], v144 offset:20480
    v_mfma_f32_16x16x32_bf16 v[16:19], v[116:119], v[100:103], v[16:19]
    ds_read_b128 v[100:103], v143 offset:6144
    v_mfma_f32_16x16x32_bf16 v[36:39], v[120:123], v[92:95], v[36:39]
    ds_read_b64_tr_b16 v[138:139], v144 offset:20992
    v_mfma_f32_16x16x32_bf16 v[64:67], v[92:95], v[124:127], v[64:67]
    ds_read_b64_tr_b16 v[128:129], v144 offset:12288
    v_mfma_f32_16x16x32_bf16 v[8:11], v[116:119], v[92:95], v[8:11]
    ds_read_b128 v[92:95], v143 offset:2048
    s_waitcnt lgkmcnt(8)
    v_mfma_f32_16x16x32_bf16 v[56:59], v[120:123], v[112:115], v[56:59]
    ds_read_b64_tr_b16 v[130:131], v144 offset:12800
    v_mfma_f32_16x16x32_bf16 v[84:87], v[112:115], v[124:127], v[84:87]
    v_mfma_f32_16x16x32_bf16 v[28:31], v[116:119], v[112:115], v[28:31]
    ds_read_b128 v[112:115], v143 offset:12288
    s_waitcnt lgkmcnt(7)
    v_mfma_f32_16x16x32_bf16 v[32:35], v[132:135], v[88:91], v[32:35]
    s_waitcnt lgkmcnt(4)
    v_mfma_f32_16x16x32_bf16 v[60:63], v[88:91], v[136:139], v[60:63]
    v_mfma_f32_16x16x32_bf16 v[44:47], v[132:135], v[100:103], v[44:47]
    v_mfma_f32_16x16x32_bf16 v[72:75], v[100:103], v[136:139], v[72:75]
    s_waitcnt lgkmcnt(1)
    v_mfma_f32_16x16x32_bf16 v[16:19], v[128:131], v[100:103], v[16:19]
    s_nop 1
    v_cvt_pk_bf16_f32 v32, v32, v33
    v_cvt_pk_bf16_f32 v33, v34, v35
    v_mfma_f32_16x16x32_bf16 v[48:51], v[120:123], v[104:107], v[48:51]
    v_cvt_pk_bf16_f32 v60, v60, v61
    v_cvt_pk_bf16_f32 v61, v62, v63
    v_mfma_f32_16x16x32_bf16 v[76:79], v[104:107], v[124:127], v[76:79]
    v_cvt_pk_bf16_f32 v34, v44, v45
    v_cvt_pk_bf16_f32 v35, v46, v47
    v_mfma_f32_16x16x32_bf16 v[20:23], v[116:119], v[104:107], v[20:23]
    ds_read_b128 v[104:107], v143 offset:8192
    buffer_store_dwordx4 v[32:35], v7, s[44:47], s70 offen offset:3072 sc1
    s_waitcnt lgkmcnt(1)
    v_mfma_f32_16x16x32_bf16 v[56:59], v[132:135], v[112:115], v[56:59]
    ds_write_b128 v145, v[32:35] offset:3072
    v_cvt_pk_bf16_f32 v62, v72, v73
    v_mfma_f32_16x16x32_bf16 v[84:87], v[112:115], v[136:139], v[84:87]
    v_cvt_pk_bf16_f32 v63, v74, v75
    buffer_store_dwordx4 v[60:63], v7, s[44:47], s71 offen offset:2048 sc1
    v_mfma_f32_16x16x32_bf16 v[28:31], v[128:131], v[112:115], v[28:31]
    ds_write_b128 v145, v[60:63] offset:6144
    v_cvt_pk_bf16_f32 v16, v16, v17
    v_mfma_f32_16x16x32_bf16 v[40:43], v[120:123], v[96:99], v[40:43]
    v_cvt_pk_bf16_f32 v17, v18, v19
    v_mfma_f32_16x16x32_bf16 v[68:71], v[96:99], v[124:127], v[68:71]
    v_cvt_pk_bf16_f32 v56, v56, v57
    v_cvt_pk_bf16_f32 v57, v58, v59
    v_mfma_f32_16x16x32_bf16 v[12:15], v[116:119], v[96:99], v[12:15]
    ds_read_b128 v[96:99], v143 offset:4096
    v_cvt_pk_bf16_f32 v58, v84, v85
    v_mfma_f32_16x16x32_bf16 v[36:39], v[132:135], v[92:95], v[36:39]
    v_cvt_pk_bf16_f32 v59, v86, v87
    buffer_store_dwordx4 v[56:59], v7, s[44:47], s72 offen offset:1024 sc1
    v_mfma_f32_16x16x32_bf16 v[64:67], v[92:95], v[136:139], v[64:67]
    ds_write_b128 v145, v[56:59] offset:9216
    v_cvt_pk_bf16_f32 v18, v28, v29
    v_mfma_f32_16x16x32_bf16 v[8:11], v[128:131], v[92:95], v[8:11]
    v_cvt_pk_bf16_f32 v19, v30, v31
    buffer_store_dwordx4 v[16:19], v7, s[44:47], s70 offen offset:2048 sc1
    v_mfma_f32_16x16x32_bf16 v[52:55], v[120:123], v[108:111], v[52:55]
    ds_write_b128 v145, v[16:19] offset:2048
    v_mfma_f32_16x16x32_bf16 v[80:83], v[108:111], v[124:127], v[80:83]
    v_cvt_pk_bf16_f32 v36, v36, v37
    v_cvt_pk_bf16_f32 v37, v38, v39
    v_mfma_f32_16x16x32_bf16 v[24:27], v[116:119], v[108:111], v[24:27]
    ds_read_b128 v[108:111], v143 offset:10240
    v_cvt_pk_bf16_f32 v64, v64, v65
    s_waitcnt lgkmcnt(6)
    v_mfma_f32_16x16x32_bf16 v[48:51], v[132:135], v[104:107], v[48:51]
    v_cvt_pk_bf16_f32 v65, v66, v67
    v_cvt_pk_bf16_f32 v8, v8, v9
    v_mfma_f32_16x16x32_bf16 v[76:79], v[104:107], v[136:139], v[76:79]
    v_cvt_pk_bf16_f32 v9, v10, v11
    v_mfma_f32_16x16x32_bf16 v[20:23], v[128:131], v[104:107], v[20:23]
    s_waitcnt lgkmcnt(3)
    v_mfma_f32_16x16x32_bf16 v[40:43], v[132:135], v[96:99], v[40:43]
    v_mfma_f32_16x16x32_bf16 v[68:71], v[96:99], v[136:139], v[68:71]
    v_cvt_pk_bf16_f32 v38, v48, v49
    v_cvt_pk_bf16_f32 v39, v50, v51
    v_mfma_f32_16x16x32_bf16 v[12:15], v[128:131], v[96:99], v[12:15]
    buffer_store_dwordx4 v[36:39], v7, s[44:47], s71 offen offset:0 sc1
    ds_write_b128 v145, v[36:39] offset:4096
    s_waitcnt lgkmcnt(1)
    v_mfma_f32_16x16x32_bf16 v[52:55], v[132:135], v[108:111], v[52:55]
    v_cvt_pk_bf16_f32 v66, v76, v77
    v_cvt_pk_bf16_f32 v67, v78, v79
    v_mfma_f32_16x16x32_bf16 v[80:83], v[108:111], v[136:139], v[80:83]
    buffer_store_dwordx4 v[64:67], v7, s[44:47], s71 offen offset:3072 sc1
    ds_write_b128 v145, v[64:67] offset:7168
    v_mfma_f32_16x16x32_bf16 v[24:27], v[128:131], v[108:111], v[24:27]
    v_cvt_pk_bf16_f32 v10, v20, v21
    v_cvt_pk_bf16_f32 v11, v22, v23
    buffer_store_dwordx4 v[8:11], v7, s[44:47], s70 offen offset:0 sc1
    ds_write_b128 v145, v[8:11] offset:0
    v_cvt_pk_bf16_f32 v40, v40, v41
    v_cvt_pk_bf16_f32 v41, v42, v43
    v_cvt_pk_bf16_f32 v68, v68, v69
    v_cvt_pk_bf16_f32 v69, v70, v71
    v_cvt_pk_bf16_f32 v12, v12, v13
    v_cvt_pk_bf16_f32 v13, v14, v15
    v_cvt_pk_bf16_f32 v42, v52, v53
    v_cvt_pk_bf16_f32 v43, v54, v55
    buffer_store_dwordx4 v[40:43], v7, s[44:47], s71 offen offset:1024 sc1
    ds_write_b128 v145, v[40:43] offset:5120
    v_cvt_pk_bf16_f32 v70, v80, v81
    v_cvt_pk_bf16_f32 v71, v82, v83
    buffer_store_dwordx4 v[68:71], v7, s[44:47], s72 offen offset:0 sc1
    ds_write_b128 v145, v[68:71] offset:8192
    v_cvt_pk_bf16_f32 v14, v24, v25
    v_cvt_pk_bf16_f32 v15, v26, v27
    buffer_store_dwordx4 v[12:15], v7, s[44:47], s70 offen offset:1024 sc1
    ds_write_b128 v145, v[12:15] offset:1024
    s_branch L_pb10b
L_pb10:
    s_mov_b32 s44, s28
    s_and_b32 s45, s29, 0xffff
    s_mov_b32 s46, 16777216
    s_mov_b32 s47, 0x00020000
    s_mul_i32 s31, s31, 1664525
    s_add_u32 s31, s31, 1013904223
    s_mov_b32 s100, 0
Lpo_70:
    s_waitcnt lgkmcnt(0)
    s_cmp_eq_u32 s86, s31
    s_cbranch_scc1 Lpd_71
    s_sleep 16
    s_load_dwordx2 s[86:87], s[28:29], s92 offset:8192 glc
    s_add_u32 s100, s100, 1
    s_cmp_lt_u32 s100, 1048576
    s_cbranch_scc1 Lpo_70
    s_waitcnt lgkmcnt(0)
Lpd_71:
    s_and_b32 s92, s87, 0x2000
    s_setprio 2
L_pb10b:
    v_mov_b32 v165, s31
    s_xor_b32 s68, s68, s92
L_upre:
    v_xor_b32 v164, s92, v164
    v_add_u32 v132, s64, v158
    v_add_u32 v133, s65, v160
    v_add_u32 v134, s65, v161
    s_cmp_eq_u32 s101, 2
    s_cbranch_scc1 L_unit
    v_add_f32 v136, s67, v150
    v_add_f32 v137, s67, v151
    v_add_f32 v138, s67, v152
    v_add_f32 v139, s67, v153
    v_mov_b32 v106, 0
    v_mov_b32 v107, 0
    v_mov_b32 v110, 0
    v_mov_b32 v111, 0
    v_mov_b32 v114, 0
    v_mov_b32 v115, 0
    s_waitcnt lgkmcnt(0)
    s_barrier
L_unit:
    s_cmp_eq_u32 s62, 0
    s_cbranch_scc1 L_ugo
    s_mov_b32 s100, 0
Lw_72:
    ds_read_b32 v4, v3 offset:8
    s_waitcnt lgkmcnt(0)
    v_readfirstlane_b32 s99, v4
    s_cmp_ge_u32 s99, 1
    s_cbranch_scc1 Lwd_73
    s_sleep 1
    s_add_u32 s100, s100, 1
    s_cmp_lt_u32 s100, 8388608
    s_cbranch_scc1 Lw_72
Lwd_73:
    s_setprio 3
L_ugo:
    s_mov_b64 exec, 0xffff
    ds_read_b64 v[106:107], v158 offset:10240
    ds_read_b64 v[110:111], v158 offset:11264
    ds_read_b64 v[114:115], v158 offset:12288
    s_mov_b64 exec, -1
    ds_read_b64 v[104:105], v158 offset:0
    ds_read_b64 v[88:89], v158 offset:3072
    ds_read_b64 v[90:91], v158 offset:13312
    ds_read_b64 v[92:93], v158 offset:4096
    ds_read_b64 v[94:95], v158 offset:14336
    ds_read_b64 v[108:109], v158 offset:1024
    ds_read_b64 v[96:97], v158 offset:5120
    ds_read_b64 v[98:99], v158 offset:15360
    ds_read_b64 v[112:113], v158 offset:2048
    ds_read_b64 v[100:101], v132 offset:0
    ds_read_b64 v[102:103], v132 offset:10240
    s_waitcnt lgkmcnt(6)
    v_mfma_f32_16x16x32_bf16 v[20:23], v[88:91], v[104:107], v[136:139]
    v_mfma_f32_16x16x32_bf16 v[8:11], v[92:95], v[104:107], v[146:149]
    s_waitcnt lgkmcnt(3)
    v_mfma_f32_16x16x32_bf16 v[24:27], v[92:95], v[108:111], v[150:153]
    v_mfma_f32_16x16x32_bf16 v[12:15], v[96:99], v[108:111], v[146:149]
    s_waitcnt lgkmcnt(0)
    v_mfma_f32_16x16x32_bf16 v[28:31], v[96:99], v[112:115], v[150:153]
    v_mfma_f32_16x16x32_bf16 v[16:19], v[100:103], v[112:115], v[146:149]
    ds_read_b64 v[120:121], v160 offset:7168
    ds_read_b64 v[122:123], v160 offset:6144
    ds_read_b64 v[118:119], v160 offset:8192
    ds_read_b64 v[116:117], v133 offset:0
    ds_read_b64 v[128:129], v161 offset:7168
    ds_read_b64 v[130:131], v161 offset:6144
    ds_read_b64 v[126:127], v161 offset:8192
    ds_read_b64 v[124:125], v134 offset:0
    v_max3_f32 v32, v20, v21, v8
    v_max3_f32 v36, v22, v23, v10
    v_max_f32 v32, v32, v9
    v_max_f32 v36, v36, v11
    v_max_f32 v40, v32, v36
    v_max3_f32 v33, v24, v25, v12
    v_max3_f32 v37, v26, v27, v14
    v_max_f32 v33, v33, v13
    v_max_f32 v37, v37, v15
    v_max_f32 v41, v33, v37
    v_max3_f32 v34, v28, v29, v16
    v_max3_f32 v38, v30, v31, v18
    v_max_f32 v34, v34, v17
    v_max_f32 v38, v38, v19
    v_permlane32_swap_b32 v40, v41
    v_max_f32 v42, v34, v38
    v_max_f32 v40, v40, v41
    s_add_u32 s96, s68, 32768
    v_permlane32_swap_b32 v42, v43
    v_max_f32 v42, v42, v43
    s_nop 1
    v_permlane16_swap_b32 v40, v42
    v_max_f32 v40, v40, v42
    v_mul_f32 v42, s66, v40
    v_mul_f32 v40, s66, v40
    s_nop 1
    v_permlane16_swap_b32 v40, v42
    v_mov_b32 v41, v40
    v_mov_b32 v43, v42
    s_waitcnt lgkmcnt(0)
    v_permlane32_swap_b32 v40, v41
    v_permlane32_swap_b32 v42, v43
    s_cmp_eq_u32 s69, 0
    s_cbranch_scc1 Lxs_74
    s_waitcnt vmcnt(0)
    s_atomic_swap s31, s[28:29], s69
Lxs_74:
    v_fma_f32 v32, v32, s66, -v40
    v_fma_f32 v36, v36, s66, -v40
    v_fma_f32 v33, v33, s66, -v41
    v_fma_f32 v37, v37, s66, -v41
    v_fma_f32 v34, v34, s66, -v42
    v_fma_f32 v38, v38, s66, -v42
    v_exp_f32 v32, v32
    v_exp_f32 v36, v36
    v_exp_f32 v33, v33
    v_exp_f32 v37, v37
    v_exp_f32 v34, v34
    v_exp_f32 v38, v38
    v_add_f32 v40, v32, v36
    v_add_f32 v41, v33, v37
    v_add_f32 v42, v34, v38
    s_nop 0
    v_permlane32_swap_b32 v40, v41
    v_permlane32_swap_b32 v42, v43
    v_add_f32 v40, v40, v41
    v_add_f32 v42, v42, v43
    s_nop 1
    v_permlane16_swap_b32 v40, v42
    v_add_f32 v40, v40, v42
    v_rcp_f32 v42, v40
    v_rcp_f32 v40, v40
    s_nop 1
    v_permlane16_swap_b32 v40, v42
    v_mov_b32 v41, v40
    v_mov_b32 v43, v42
    s_nop 0
    v_permlane32_swap_b32 v40, v41
    v_permlane32_swap_b32 v42, v43
    v_mul_f32 v32, v32, v40
    v_mul_f32 v36, v36, v40
    v_cvt_pk_bf16_f32 v32, v32, v36
    v_perm_b32 v44, v32, v32, v154
    v_perm_b32 v45, v32, v32, v155
    v_perm_b32 v46, v32, v32, v156
    v_perm_b32 v47, v32, v32, v157
    v_mul_f32 v33, v33, v41
    v_mul_f32 v37, v37, v41
    v_cvt_pk_bf16_f32 v33, v33, v37
    v_perm_b32 v48, v33, v33, v154
    v_perm_b32 v49, v33, v33, v155
    v_perm_b32 v50, v33, v33, v156
    v_perm_b32 v51, v33, v33, v157
    v_mfma_f32_16x16x32_bf16 v[8:11], v[120:123], v[44:47], 0
    v_mfma_f32_16x16x32_bf16 v[20:23], v[128:131], v[44:47], 0
    v_mul_f32 v34, v34, v42
    v_mul_f32 v38, v38, v42
    v_cvt_pk_bf16_f32 v34, v34, v38
    v_perm_b32 v52, v34, v34, v154
    v_perm_b32 v53, v34, v34, v155
    v_perm_b32 v54, v34, v34, v156
    v_perm_b32 v55, v34, v34, v157
    v_mfma_f32_16x16x32_bf16 v[12:15], v[118:121], v[48:51], 0
    v_mfma_f32_16x16x32_bf16 v[24:27], v[126:129], v[48:51], 0
    v_mfma_f32_16x16x32_bf16 v[16:19], v[116:119], v[52:55], 0
    v_mfma_f32_16x16x32_bf16 v[28:31], v[124:127], v[52:55], 0
    v_cvt_pk_bf16_f32 v60, v8, v9
    v_cvt_pk_bf16_f32 v61, v10, v11
    v_cvt_pk_bf16_f32 v68, v20, v21
    v_cvt_pk_bf16_f32 v69, v22, v23
    s_nop 0
    v_cvt_pk_bf16_f32 v62, v12, v13
    v_cvt_pk_bf16_f32 v63, v14, v15
    s_nop 0
    v_permlane32_swap_b32 v60, v62
    v_permlane32_swap_b32 v61, v63
    buffer_store_dwordx4 v[60:63], v162, s[44:47], s68 offen sc1
    v_cvt_pk_bf16_f32 v64, v16, v17
    v_cvt_pk_bf16_f32 v65, v18, v19
    s_nop 0
    v_permlane32_swap_b32 v64, v66
    v_permlane32_swap_b32 v65, v67
    s_mov_b32 exec_lo, 0
    v_cvt_pk_bf16_f32 v68, v28, v29
    v_cvt_pk_bf16_f32 v69, v30, v31
    s_mov_b64 exec, 0xffff0000
    v_cvt_pk_bf16_f32 v68, v24, v25
    v_cvt_pk_bf16_f32 v69, v26, v27
    s_mov_b32 exec_lo, -1
    buffer_store_dwordx4 v[64:67], v162, s[44:47], s96 offen sc1
    s_mov_b32 exec_hi, 0xffff
    buffer_store_dwordx2 v[68:69], v163, s[44:47], s68 offen sc1
    s_mov_b64 exec, -1
    s_cmp_lg_u32 s101, 0
    s_cbranch_scc1 L_nops
    s_lshr_b32 s75, s60, 1
    s_lshl_b32 s96, s75, 16
    s_add_u32 s72, s68, s96
    s_add_u32 s73, s72, 16384
    s_add_u32 s74, s72, 32768
    s_lshl1_add_u32 s70, s61, s32
    s_lshl2_add_u32 s70, s75, s70
    s_and_b32 s70, s70, 7
    s_lshl_b32 s70, s70, 10
    s_add_u32 s83, s72, 49152
    s_add_u32 s87, s72, 53248
    s_mul_i32 s96, s32, 164096
    s_cmp_ge_u32 s32, 11
    s_cselect_b32 s100, 1796864, 0
    s_sub_u32 s96, s96, s100
    s_mul_i32 s100, s33, 16640
    s_add_u32 s96, s96, s100
    s_add_u32 s96, s96, 263168
    s_xor_b32 s96, s96, s92
    s_lshl_b32 s97, s60, 8
    s_add_u32 s96, s96, s97
    s_add_u32 s76, s28, s96
    s_addc_u32 s77, s29, 0
    s_mul_i32 s80, s60, 6144
    s_add_u32 s80, s80, 81920
    s_xor_b32 s96, s60, 2
    s_mul_i32 s81, s96, 6144
    s_add_u32 s81, s81, 81920
    s_mul_i32 s82, s61, 12288
    s_lshl_b32 s96, s75, 11
    s_add_u32 s82, s82, s96
    s_add_u32 s82, s82, 133632
    s_lshl1_add_u32 s96, s32, s61
    s_mul_i32 s79, s96, 61440
    s_lshl1_add_u32 s96, s33, s75
    s_lshl_b32 s96, s96, 6
    s_add_u32 s79, s79, s96
    s_mov_b32 s48, s24
    s_and_b32 s49, s25, 0xffff
    s_mov_b32 s50, 2621440
    s_mov_b32 s51, 0x00020000
    v_lshrrev_b32 v58, 2, v0
    v_and_b32 v59, 3, v0
    v_bfe_u32 v57, v0, 3, 2
    v_lshlrev_b32 v7, 3, v0
    s_mul_i32 s96, s75, 40960
    v_lshl_add_u32 v5, v58, 7, s96
    v_lshl_add_u32 v5, v59, 3, v5
    s_lshl_b32 s96, s75, 1
    v_xor_b32 v6, s96, v57
    v_lshl_add_u32 v160, v6, 5, v5
    v_xor_b32 v161, 32, v160
    v_xor_b32 v162, 64, v160
    v_xor_b32 v163, 96, v160
    v_lshlrev_b32 v5, 4, v0
    v_add_u32 v6, 4096, v5
    v_xor_b32 v59, v59, v57
    v_mul_u32_u24 v58, 1280, v58
    v_lshl_add_u32 v58, v59, 4, v58
    s_mul_i32 s96, s61, 192
    s_add_u32 s96, s96, 161088
    v_lshl_add_u32 v57, v1, 2, s96
    v_bfe_u32 v59, v1, 1, 2
    v_lshl_add_u32 v1, v1, 6, s81
    v_lshlrev_b32 v59, 1, v59
    v_xor_b32 v59, v59, v2
    v_lshl_add_u32 v1, v59, 3, v1
    v_mov_b32 v2, v58
L_nops:
    s_lshl_b32 s96, s62, 4
    v_add_u32 v56, s96, v3
    v_mov_b32 v4, 1
    s_mov_b64 exec, 1
    ds_add_u32 v56, v4 offset:0
    s_mov_b64 exec, -1
    s_cmp_lg_u32 s101, 0
    s_cbranch_scc1 L_lsig
    s_lshl_b32 s96, s61, 3
    v_add_u32 v56, s96, v3
    s_waitcnt vmcnt(0)
    v_mov_b32 v4, 1
    s_mov_b64 exec, 1
    ds_add_rtn_u32 v4, v56, v4 offset:24
    s_waitcnt lgkmcnt(0)
    v_readfirstlane_b32 s97, v4
    s_mov_b64 exec, -1
    s_cmp_lg_u32 s97, 1
    s_cbranch_scc1 L_nosig
L_lsig:
    s_waitcnt vmcnt(0)
    s_mov_b64 exec, 0x3ff
    global_atomic_swap v164, v165, s[28:29] sc1
    s_mov_b64 exec, -1
L_nosig:
    s_cmp_eq_u32 s101, 0
    s_cbranch_scc1 L_op
    s_lshr_b32 s97, s34, 2
    s_andn2_b32 s96, s97, s62
    s_cbranch_scc0 L_pexit
    s_mov_b32 s62, 1
    s_mov_b32 s101, 2
    s_branch L_us
L_op:
    s_setprio 0
    s_lshl_b32 s85, s34, 10
    s_mov_b32 s100, 0
    v_mov_b32 v116, v57
    s_lshl_b32 s96, s60, 2
    v_add_u32 v164, s96, v3
    s_load_dwordx16 s[4:19], s[76:77], 0 glc
    s_mov_b32 s100, 0
Lw_75:
    ds_read_b32 v4, v3 offset:4
    s_waitcnt lgkmcnt(0)
    v_readfirstlane_b32 s99, v4
    s_cmp_ge_u32 s99, 2
    s_cbranch_scc1 Lwd_76
    s_add_u32 s100, s100, 1
    s_cmp_lt_u32 s100, 8388608
    s_cbranch_scc1 Lw_75
Lwd_76:
    s_mov_b32 s100, 0
    ds_read_b64_tr_b16 v[140:141], v160 offset:0
    ds_read_b64_tr_b16 v[142:143], v160 offset:2048
    ds_read_b64_tr_b16 v[144:145], v161 offset:0
    ds_read_b64_tr_b16 v[146:147], v161 offset:2048
    ds_read_b64_tr_b16 v[148:149], v162 offset:0
    ds_read_b64_tr_b16 v[150:151], v162 offset:2048
    ds_read_b64_tr_b16 v[152:153], v163 offset:0
    ds_read_b64_tr_b16 v[154:155], v163 offset:2048
    ds_read_b64_tr_b16 v[156:157], v160 offset:4096
    ds_read_b64_tr_b16 v[158:159], v160 offset:6144
L_nb0:
    s_cmp_lg_u32 s4, s31
    s_cbranch_scc1 L_ns0
L_ng0:
    s_add_u32 s96, s72, s85
    buffer_load_dwordx4 v[56:59], v5, s[44:47], s96 offen sc1
    s_add_u32 s96, s73, s85
    buffer_load_dwordx4 v[60:63], v5, s[44:47], s96 offen sc1
    s_add_u32 s96, s74, s85
    buffer_load_dwordx4 v[64:67], v5, s[44:47], s96 offen sc1
    s_add_u32 s85, s85, 1024
    s_cmp_eq_u32 s85, 5120
    s_cselect_b32 s85, 0, s85
L_nb1:
    s_cmp_lg_u32 s6, s31
    s_cbranch_scc1 L_ns1
L_ng1:
    s_add_u32 s96, s72, s85
    buffer_load_dwordx4 v[68:71], v5, s[44:47], s96 offen sc1
    s_add_u32 s96, s73, s85
    buffer_load_dwordx4 v[72:75], v5, s[44:47], s96 offen sc1
    s_add_u32 s96, s74, s85
    buffer_load_dwordx4 v[76:79], v5, s[44:47], s96 offen sc1
    s_add_u32 s85, s85, 1024
    s_cmp_eq_u32 s85, 5120
    s_cselect_b32 s85, 0, s85
L_nb2:
    s_cmp_lg_u32 s8, s31
    s_cbranch_scc1 L_ns2
L_ng2:
    s_add_u32 s96, s72, s85
    buffer_load_dwordx4 v[80:83], v5, s[44:47], s96 offen sc1
    s_add_u32 s96, s73, s85
    buffer_load_dwordx4 v[84:87], v5, s[44:47], s96 offen sc1
    s_add_u32 s96, s74, s85
    buffer_load_dwordx4 v[88:91], v5, s[44:47], s96 offen sc1
    s_add_u32 s85, s85, 1024
    s_cmp_eq_u32 s85, 5120
    s_cselect_b32 s85, 0, s85
L_nb3:
    s_cmp_lg_u32 s10, s31
    s_cbranch_scc1 L_ns3
L_ng3:
    s_add_u32 s96, s72, s85
    buffer_load_dwordx4 v[92:95], v5, s[44:47], s96 offen sc1
    s_add_u32 s96, s73, s85
    buffer_load_dwordx4 v[96:99], v5, s[44:47], s96 offen sc1
    s_add_u32 s96, s74, s85
    buffer_load_dwordx4 v[100:103], v5, s[44:47], s96 offen sc1
    s_add_u32 s85, s85, 1024
    s_cmp_eq_u32 s85, 5120
    s_cselect_b32 s85, 0, s85
L_nb4:
    s_cmp_lg_u32 s12, s31
    s_cbranch_scc1 L_ns4
L_ng4:
    s_add_u32 s96, s72, s85
    buffer_load_dwordx4 v[104:107], v5, s[44:47], s96 offen sc1
    s_add_u32 s96, s73, s85
    buffer_load_dwordx4 v[108:111], v5, s[44:47], s96 offen sc1
    s_add_u32 s96, s74, s85
    buffer_load_dwordx4 v[112:115], v5, s[44:47], s96 offen sc1

    s_waitcnt vmcnt(14)
    s_waitcnt lgkmcnt(8)
    v_mfma_f32_16x16x32_bf16 v[8:11], v[140:143], v[56:59], 0
    s_waitcnt vmcnt(13)
    v_mfma_f32_16x16x32_bf16 v[24:27], v[140:143], v[60:63], 0
    s_waitcnt vmcnt(12)
    v_mfma_f32_16x16x32_bf16 v[40:43], v[140:143], v[64:67], 0
    s_waitcnt lgkmcnt(6)
    v_mfma_f32_16x16x32_bf16 v[12:15], v[144:147], v[56:59], 0
    ds_read_b64_tr_b16 v[140:141], v161 offset:4096
    v_mfma_f32_16x16x32_bf16 v[28:31], v[144:147], v[60:63], 0
    ds_read_b64_tr_b16 v[142:143], v161 offset:6144
    v_mfma_f32_16x16x32_bf16 v[44:47], v[144:147], v[64:67], 0
    s_waitcnt lgkmcnt(6)
    v_mfma_f32_16x16x32_bf16 v[16:19], v[148:151], v[56:59], 0
    ds_read_b64_tr_b16 v[144:145], v162 offset:4096
    v_mfma_f32_16x16x32_bf16 v[32:35], v[148:151], v[60:63], 0
    ds_read_b64_tr_b16 v[146:147], v162 offset:6144
    v_mfma_f32_16x16x32_bf16 v[48:51], v[148:151], v[64:67], 0
    s_waitcnt lgkmcnt(6)
    v_mfma_f32_16x16x32_bf16 v[20:23], v[152:155], v[56:59], 0
    ds_read_b64_tr_b16 v[148:149], v163 offset:4096
    v_mfma_f32_16x16x32_bf16 v[36:39], v[152:155], v[60:63], 0
    ds_read_b64_tr_b16 v[150:151], v163 offset:6144
    v_mfma_f32_16x16x32_bf16 v[52:55], v[152:155], v[64:67], 0
    s_waitcnt vmcnt(11)
    s_waitcnt lgkmcnt(6)
    v_mfma_f32_16x16x32_bf16 v[8:11], v[156:159], v[68:71], v[8:11]
    ds_read_b64_tr_b16 v[152:153], v160 offset:8192
    buffer_load_dwordx2 v[56:57], v7, s[44:47], s83 offen offset:0 sc1
    s_waitcnt vmcnt(11)
    v_mfma_f32_16x16x32_bf16 v[24:27], v[156:159], v[72:75], v[24:27]
    ds_read_b64_tr_b16 v[154:155], v160 offset:10240
    buffer_load_dwordx2 v[58:59], v7, s[44:47], s83 offen offset:512 sc1
    s_waitcnt vmcnt(11)
    v_mfma_f32_16x16x32_bf16 v[40:43], v[156:159], v[76:79], v[40:43]
    buffer_load_dwordx2 v[60:61], v7, s[44:47], s83 offen offset:2048 sc1
    s_waitcnt lgkmcnt(6)
    v_mfma_f32_16x16x32_bf16 v[12:15], v[140:143], v[68:71], v[12:15]
    ds_read_b64_tr_b16 v[156:157], v161 offset:8192
    v_mfma_f32_16x16x32_bf16 v[28:31], v[140:143], v[72:75], v[28:31]
    ds_read_b64_tr_b16 v[158:159], v161 offset:10240
    v_mfma_f32_16x16x32_bf16 v[44:47], v[140:143], v[76:79], v[44:47]
    buffer_load_dwordx2 v[62:63], v7, s[44:47], s83 offen offset:2560 sc1
    s_waitcnt lgkmcnt(6)
    v_mfma_f32_16x16x32_bf16 v[16:19], v[144:147], v[68:71], v[16:19]
    ds_read_b64_tr_b16 v[140:141], v162 offset:8192
    v_mfma_f32_16x16x32_bf16 v[32:35], v[144:147], v[72:75], v[32:35]
    ds_read_b64_tr_b16 v[142:143], v162 offset:10240
    v_mfma_f32_16x16x32_bf16 v[48:51], v[144:147], v[76:79], v[48:51]
    buffer_load_dwordx2 v[64:65], v7, s[44:47], s87 offen offset:0 sc1
    s_waitcnt lgkmcnt(6)
    v_mfma_f32_16x16x32_bf16 v[20:23], v[148:151], v[68:71], v[20:23]
    ds_read_b64_tr_b16 v[144:145], v163 offset:8192
    v_mfma_f32_16x16x32_bf16 v[36:39], v[148:151], v[72:75], v[36:39]
    ds_read_b64_tr_b16 v[146:147], v163 offset:10240
    v_mfma_f32_16x16x32_bf16 v[52:55], v[148:151], v[76:79], v[52:55]
    buffer_load_dwordx2 v[66:67], v7, s[44:47], s87 offen offset:512 sc1
L_nb6:
    s_cmp_lg_u32 s14, s31
    s_cbranch_scc1 L_ns6
    s_cmp_lg_u32 s16, s31
    s_cbranch_scc1 L_ns6
L_ng6:
    s_waitcnt vmcnt(14)
    s_waitcnt lgkmcnt(6)
    v_mfma_f32_16x16x32_bf16 v[8:11], v[152:155], v[80:83], v[8:11]
    ds_read_b64_tr_b16 v[148:149], v160 offset:12288
    s_waitcnt vmcnt(13)
    v_mfma_f32_16x16x32_bf16 v[24:27], v[152:155], v[84:87], v[24:27]
    ds_read_b64_tr_b16 v[150:151], v160 offset:14336
    s_waitcnt vmcnt(12)
    v_mfma_f32_16x16x32_bf16 v[40:43], v[152:155], v[88:91], v[40:43]
    buffer_load_dwordx4 v[68:71], v6, s[44:47], s72 offen offset:1024 sc1
    s_waitcnt lgkmcnt(6)
    v_mfma_f32_16x16x32_bf16 v[12:15], v[156:159], v[80:83], v[12:15]
    ds_read_b64_tr_b16 v[152:153], v161 offset:12288
    v_mfma_f32_16x16x32_bf16 v[28:31], v[156:159], v[84:87], v[28:31]
    ds_read_b64_tr_b16 v[154:155], v161 offset:14336
    v_mfma_f32_16x16x32_bf16 v[44:47], v[156:159], v[88:91], v[44:47]
    buffer_load_dwordx4 v[72:75], v6, s[44:47], s73 offen offset:1024 sc1
    s_waitcnt lgkmcnt(6)
    v_mfma_f32_16x16x32_bf16 v[16:19], v[140:143], v[80:83], v[16:19]
    ds_read_b64_tr_b16 v[156:157], v162 offset:12288
    v_mfma_f32_16x16x32_bf16 v[32:35], v[140:143], v[84:87], v[32:35]
    ds_read_b64_tr_b16 v[158:159], v162 offset:14336
    v_mfma_f32_16x16x32_bf16 v[48:51], v[140:143], v[88:91], v[48:51]
    buffer_load_dwordx4 v[76:79], v6, s[44:47], s74 offen offset:1024 sc1
    s_waitcnt lgkmcnt(6)
    v_mfma_f32_16x16x32_bf16 v[20:23], v[144:147], v[80:83], v[20:23]
    ds_read_b64_tr_b16 v[140:141], v163 offset:12288
    v_mfma_f32_16x16x32_bf16 v[36:39], v[144:147], v[84:87], v[36:39]
    ds_read_b64_tr_b16 v[142:143], v163 offset:14336
    v_mfma_f32_16x16x32_bf16 v[52:55], v[144:147], v[88:91], v[52:55]
    s_waitcnt vmcnt(14)
    s_waitcnt lgkmcnt(6)
    v_mfma_f32_16x16x32_bf16 v[8:11], v[148:151], v[92:95], v[8:11]
    ds_read_b64_tr_b16 v[144:145], v160 offset:16384
    s_waitcnt vmcnt(13)
    v_mfma_f32_16x16x32_bf16 v[24:27], v[148:151], v[96:99], v[24:27]
    ds_read_b64_tr_b16 v[146:147], v160 offset:18432
    s_waitcnt vmcnt(12)
    v_mfma_f32_16x16x32_bf16 v[40:43], v[148:151], v[100:103], v[40:43]
    s_waitcnt lgkmcnt(6)
    v_mfma_f32_16x16x32_bf16 v[12:15], v[152:155], v[92:95], v[12:15]
    ds_read_b64_tr_b16 v[148:149], v161 offset:16384
    v_mfma_f32_16x16x32_bf16 v[28:31], v[152:155], v[96:99], v[28:31]
    ds_read_b64_tr_b16 v[150:151], v161 offset:18432
    v_mfma_f32_16x16x32_bf16 v[44:47], v[152:155], v[100:103], v[44:47]
    s_waitcnt lgkmcnt(6)
    v_mfma_f32_16x16x32_bf16 v[16:19], v[156:159], v[92:95], v[16:19]
    ds_read_b64_tr_b16 v[152:153], v162 offset:16384
    v_mfma_f32_16x16x32_bf16 v[32:35], v[156:159], v[96:99], v[32:35]
    ds_read_b64_tr_b16 v[154:155], v162 offset:18432
    v_mfma_f32_16x16x32_bf16 v[48:51], v[156:159], v[100:103], v[48:51]
    s_waitcnt lgkmcnt(6)
    v_mfma_f32_16x16x32_bf16 v[20:23], v[140:143], v[92:95], v[20:23]
    ds_read_b64_tr_b16 v[156:157], v163 offset:16384
    v_mfma_f32_16x16x32_bf16 v[36:39], v[140:143], v[96:99], v[36:39]
    ds_read_b64_tr_b16 v[158:159], v163 offset:18432
    v_mfma_f32_16x16x32_bf16 v[52:55], v[140:143], v[100:103], v[52:55]
    s_waitcnt vmcnt(11)
    s_waitcnt lgkmcnt(6)
    v_mfma_f32_16x16x32_bf16 v[8:11], v[144:147], v[104:107], v[8:11]
    ds_read_b64_tr_b16 v[140:141], v160 offset:20480
    s_waitcnt vmcnt(10)
    v_mfma_f32_16x16x32_bf16 v[24:27], v[144:147], v[108:111], v[24:27]
    ds_read_b64_tr_b16 v[142:143], v160 offset:22528
    s_waitcnt vmcnt(9)
    v_mfma_f32_16x16x32_bf16 v[40:43], v[144:147], v[112:115], v[40:43]
    s_waitcnt lgkmcnt(6)
    v_mfma_f32_16x16x32_bf16 v[12:15], v[148:151], v[104:107], v[12:15]
    ds_read_b64_tr_b16 v[144:145], v161 offset:20480
    v_mfma_f32_16x16x32_bf16 v[28:31], v[148:151], v[108:111], v[28:31]
    ds_read_b64_tr_b16 v[146:147], v161 offset:22528
    v_mfma_f32_16x16x32_bf16 v[44:47], v[148:151], v[112:115], v[44:47]
    s_waitcnt lgkmcnt(6)
    v_mfma_f32_16x16x32_bf16 v[16:19], v[152:155], v[104:107], v[16:19]
    ds_read_b64_tr_b16 v[148:149], v162 offset:20480
    v_mfma_f32_16x16x32_bf16 v[32:35], v[152:155], v[108:111], v[32:35]
    ds_read_b64_tr_b16 v[150:151], v162 offset:22528
    v_mfma_f32_16x16x32_bf16 v[48:51], v[152:155], v[112:115], v[48:51]
    ds_read_b32 v122, v164 offset:80
    s_waitcnt lgkmcnt(7)
    v_mfma_f32_16x16x32_bf16 v[20:23], v[156:159], v[104:107], v[20:23]
    ds_read_b64_tr_b16 v[152:153], v163 offset:20480
    v_mfma_f32_16x16x32_bf16 v[36:39], v[156:159], v[108:111], v[36:39]
    ds_read_b64_tr_b16 v[154:155], v163 offset:22528
    v_mfma_f32_16x16x32_bf16 v[52:55], v[156:159], v[112:115], v[52:55]
    s_waitcnt lgkmcnt(2)
    v_readfirstlane_b32 s97, v122
    s_cmp_eq_u32 s97, 0
    s_cbranch_scc1 L_lts
L_ltg:
    buffer_load_dwordx4 v[80:83], v6, s[44:47], s72 offen offset:2048 sc1
    buffer_load_dwordx4 v[84:87], v6, s[44:47], s73 offen offset:2048 sc1
    buffer_load_dwordx4 v[88:91], v6, s[44:47], s74 offen offset:2048 sc1
    s_waitcnt vmcnt(10)
    v_mfma_f32_16x16x32_bf16 v[8:11], v[140:143], v[56:59], v[8:11]
    ds_read_b64_tr_b16 v[156:157], v160 offset:24576
    buffer_load_dwordx4 v[92:95], v6, s[44:47], s72 offen offset:3072 sc1
    s_waitcnt vmcnt(9)
    v_mfma_f32_16x16x32_bf16 v[24:27], v[140:143], v[60:63], v[24:27]
    ds_read_b64_tr_b16 v[158:159], v160 offset:26624
    buffer_load_dwordx4 v[96:99], v6, s[44:47], s73 offen offset:3072 sc1
    s_waitcnt vmcnt(8)
    v_mfma_f32_16x16x32_bf16 v[40:43], v[140:143], v[64:67], v[40:43]
    buffer_load_dwordx4 v[100:103], v6, s[44:47], s74 offen offset:3072 sc1
    v_mfma_f32_16x16x32_bf16 v[12:15], v[144:147], v[56:59], v[12:15]
    ds_read_b64_tr_b16 v[140:141], v161 offset:24576
    buffer_load_dwordx2 v[104:105], v7, s[44:47], s83 offen offset:1024 sc1
    v_mfma_f32_16x16x32_bf16 v[28:31], v[144:147], v[60:63], v[28:31]
    ds_read_b64_tr_b16 v[142:143], v161 offset:26624
    buffer_load_dwordx2 v[106:107], v7, s[44:47], s83 offen offset:1536 sc1
    v_mfma_f32_16x16x32_bf16 v[44:47], v[144:147], v[64:67], v[44:47]
    buffer_load_dwordx2 v[108:109], v7, s[44:47], s83 offen offset:3072 sc1
    v_mfma_f32_16x16x32_bf16 v[16:19], v[148:151], v[56:59], v[16:19]
    ds_read_b64_tr_b16 v[144:145], v162 offset:24576
    buffer_load_dwordx2 v[110:111], v7, s[44:47], s83 offen offset:3584 sc1
    v_mfma_f32_16x16x32_bf16 v[32:35], v[148:151], v[60:63], v[32:35]
    ds_read_b64_tr_b16 v[146:147], v162 offset:26624
    v_mfma_f32_16x16x32_bf16 v[48:51], v[148:151], v[64:67], v[48:51]
    buffer_load_dwordx2 v[112:113], v7, s[44:47], s87 offen offset:1024 sc1
    s_waitcnt lgkmcnt(6)
    v_mfma_f32_16x16x32_bf16 v[20:23], v[152:155], v[56:59], v[20:23]
    ds_read_b64_tr_b16 v[148:149], v163 offset:24576
    v_mfma_f32_16x16x32_bf16 v[36:39], v[152:155], v[60:63], v[36:39]
    ds_read_b64_tr_b16 v[150:151], v163 offset:26624
    v_mfma_f32_16x16x32_bf16 v[52:55], v[152:155], v[64:67], v[52:55]
    buffer_load_dwordx2 v[114:115], v7, s[44:47], s87 offen offset:1536 sc1
    s_waitcnt vmcnt(14)
    s_waitcnt lgkmcnt(6)
    v_mfma_f32_16x16x32_bf16 v[8:11], v[156:159], v[68:71], v[8:11]
    ds_read_b64_tr_b16 v[152:153], v162 offset:28672
    s_waitcnt vmcnt(13)
    v_mfma_f32_16x16x32_bf16 v[24:27], v[156:159], v[72:75], v[24:27]
    ds_read_b64_tr_b16 v[154:155], v162 offset:30720
    s_waitcnt vmcnt(12)
    v_mfma_f32_16x16x32_bf16 v[40:43], v[156:159], v[76:79], v[40:43]
    s_waitcnt lgkmcnt(6)
    v_mfma_f32_16x16x32_bf16 v[12:15], v[140:143], v[68:71], v[12:15]
    ds_read_b64_tr_b16 v[156:157], v163 offset:28672
    v_mfma_f32_16x16x32_bf16 v[28:31], v[140:143], v[72:75], v[28:31]
    ds_read_b64_tr_b16 v[158:159], v163 offset:30720
    v_mfma_f32_16x16x32_bf16 v[44:47], v[140:143], v[76:79], v[44:47]
    s_waitcnt lgkmcnt(6)
    v_mfma_f32_16x16x32_bf16 v[16:19], v[144:147], v[68:71], v[16:19]
    ds_read_b64_tr_b16 v[140:141], v162 offset:32768
    v_mfma_f32_16x16x32_bf16 v[32:35], v[144:147], v[72:75], v[32:35]
    ds_read_b64_tr_b16 v[142:143], v162 offset:34816
    v_mfma_f32_16x16x32_bf16 v[48:51], v[144:147], v[76:79], v[48:51]
    s_waitcnt lgkmcnt(6)
    v_mfma_f32_16x16x32_bf16 v[20:23], v[148:151], v[68:71], v[20:23]
    ds_read_b64_tr_b16 v[144:145], v163 offset:32768
    v_mfma_f32_16x16x32_bf16 v[36:39], v[148:151], v[72:75], v[36:39]
    ds_read_b64_tr_b16 v[146:147], v163 offset:34816
    v_mfma_f32_16x16x32_bf16 v[52:55], v[148:151], v[76:79], v[52:55]
    s_waitcnt vmcnt(11)
    s_waitcnt lgkmcnt(6)
    v_mfma_f32_16x16x32_bf16 v[16:19], v[152:155], v[80:83], v[16:19]
    ds_read_b64_tr_b16 v[148:149], v162 offset:36864
    s_waitcnt vmcnt(10)
    v_mfma_f32_16x16x32_bf16 v[32:35], v[152:155], v[84:87], v[32:35]
    ds_read_b64_tr_b16 v[150:151], v162 offset:38912
    s_waitcnt vmcnt(9)
    v_mfma_f32_16x16x32_bf16 v[48:51], v[152:155], v[88:91], v[48:51]
    s_waitcnt lgkmcnt(6)
    v_mfma_f32_16x16x32_bf16 v[20:23], v[156:159], v[80:83], v[20:23]
    ds_read_b64_tr_b16 v[152:153], v163 offset:36864
    v_mfma_f32_16x16x32_bf16 v[36:39], v[156:159], v[84:87], v[36:39]
    ds_read_b64_tr_b16 v[154:155], v163 offset:38912
    v_mfma_f32_16x16x32_bf16 v[52:55], v[156:159], v[88:91], v[52:55]
    s_waitcnt vmcnt(8)
    s_waitcnt lgkmcnt(6)
    v_mfma_f32_16x16x32_bf16 v[16:19], v[140:143], v[92:95], v[16:19]
    ds_read_b64_tr_b16 v[156:157], v160 offset:28672
    s_waitcnt vmcnt(7)
    v_mfma_f32_16x16x32_bf16 v[32:35], v[140:143], v[96:99], v[32:35]
    ds_read_b64_tr_b16 v[158:159], v160 offset:30720
    s_waitcnt vmcnt(6)
    v_mfma_f32_16x16x32_bf16 v[48:51], v[140:143], v[100:103], v[48:51]
    ds_read2_b32 v[120:121], v3 offset0:0 offset1:4
    v_add_u32 v6, s80, v5
    v_add_u32 v7, s82, v5
    v_add_u32 v5, s81, v5
    s_waitcnt lgkmcnt(7)
    v_mfma_f32_16x16x32_bf16 v[20:23], v[144:147], v[92:95], v[20:23]
    ds_read_b64_tr_b16 v[140:141], v161 offset:28672
    v_mfma_f32_16x16x32_bf16 v[36:39], v[144:147], v[96:99], v[36:39]
    ds_read_b64_tr_b16 v[142:143], v161 offset:30720
    v_mfma_f32_16x16x32_bf16 v[52:55], v[144:147], v[100:103], v[52:55]
    v_xor_b32 v165, 8, v164
    s_lshl_b32 s96, s75, 2
    v_add_u32 v166, s96, v3
    s_waitcnt vmcnt(4)
    s_waitcnt lgkmcnt(7)
    v_mfma_f32_16x16x32_bf16 v[16:19], v[148:151], v[104:107], v[16:19]
    ds_read_b64_tr_b16 v[144:145], v160 offset:32768
    s_waitcnt vmcnt(2)
    v_mfma_f32_16x16x32_bf16 v[32:35], v[148:151], v[108:111], v[32:35]
    ds_read_b64_tr_b16 v[146:147], v160 offset:34816
    s_waitcnt vmcnt(0)
    v_mfma_f32_16x16x32_bf16 v[48:51], v[148:151], v[112:115], v[48:51]
    s_waitcnt lgkmcnt(4)
    v_add_u32 v120, v120, v121
    s_lshr_b32 s96, s34, 2
    v_readfirstlane_b32 s97, v120
    s_lshl1_add_u32 s84, s96, 6
    v_mfma_f32_16x16x32_bf16 v[20:23], v[152:155], v[104:107], v[20:23]
    ds_read_b64_tr_b16 v[148:149], v161 offset:32768
    v_mfma_f32_16x16x32_bf16 v[36:39], v[152:155], v[108:111], v[36:39]
    ds_read_b64_tr_b16 v[150:151], v161 offset:34816
    v_mfma_f32_16x16x32_bf16 v[52:55], v[152:155], v[112:115], v[52:55]
    s_cmp_lt_u32 s97, s84
    s_cbranch_scc1 L_fslow
L_fgo:
    v_mfma_f32_16x16x32_bf16 v[8:11], v[156:159], v[80:83], v[8:11]
    ds_read_b64_tr_b16 v[152:153], v160 offset:36864
    v_mfma_f32_16x16x32_bf16 v[24:27], v[156:159], v[84:87], v[24:27]
    ds_read_b64_tr_b16 v[154:155], v160 offset:38912
    ds_write_b128 v6, v[16:19] offset:0
    v_mfma_f32_16x16x32_bf16 v[40:43], v[156:159], v[88:91], v[40:43]
    ds_write_b128 v6, v[32:35] offset:2048
    s_waitcnt lgkmcnt(8)
    v_mfma_f32_16x16x32_bf16 v[12:15], v[140:143], v[80:83], v[12:15]
    ds_read_b64_tr_b16 v[156:157], v161 offset:36864
    ds_write_b128 v6, v[48:51] offset:4096
    v_mfma_f32_16x16x32_bf16 v[28:31], v[140:143], v[84:87], v[28:31]
    ds_read_b64_tr_b16 v[158:159], v161 offset:38912
    ds_write_b128 v6, v[20:23] offset:1024
    v_mfma_f32_16x16x32_bf16 v[44:47], v[140:143], v[88:91], v[44:47]
    ds_write_b128 v6, v[36:39] offset:3072
    s_waitcnt lgkmcnt(11)
    v_mfma_f32_16x16x32_bf16 v[8:11], v[144:147], v[92:95], v[8:11]
    ds_write_b128 v6, v[52:55] offset:5120
    v_mfma_f32_16x16x32_bf16 v[24:27], v[144:147], v[96:99], v[24:27]
    ds_write_b32 v164, v164 offset:64
    v_mfma_f32_16x16x32_bf16 v[40:43], v[144:147], v[100:103], v[40:43]
    v_mov_b32 v162, v116
    v_xor_b32 v6, 32, v1
    s_waitcnt lgkmcnt(11)
    v_mfma_f32_16x16x32_bf16 v[12:15], v[148:151], v[92:95], v[12:15]
    ds_read_b32 v21, v166 offset:48
    v_mfma_f32_16x16x32_bf16 v[28:31], v[148:151], v[96:99], v[28:31]
    ds_read2_b32 v[16:17], v162 offset0:0 offset1:16
    v_mfma_f32_16x16x32_bf16 v[44:47], v[148:151], v[100:103], v[44:47]
    ds_read_b32 v20, v162 offset:128
    s_waitcnt lgkmcnt(12)
    v_mfma_f32_16x16x32_bf16 v[8:11], v[152:155], v[104:107], v[8:11]
    ds_read_b128 v[116:119], v7 offset:0
    v_mfma_f32_16x16x32_bf16 v[24:27], v[152:155], v[108:111], v[24:27]
    ds_read_b128 v[120:123], v7 offset:1024
    v_mfma_f32_16x16x32_bf16 v[40:43], v[152:155], v[112:115], v[40:43]
    ds_read_b128 v[124:127], v7 offset:4096
    s_waitcnt lgkmcnt(10)
    v_mfma_f32_16x16x32_bf16 v[12:15], v[156:159], v[104:107], v[12:15]
    ds_read_b128 v[128:131], v7 offset:5120
    v_mfma_f32_16x16x32_bf16 v[28:31], v[156:159], v[108:111], v[28:31]
    ds_read_b128 v[132:135], v7 offset:8192
    v_mfma_f32_16x16x32_bf16 v[44:47], v[156:159], v[112:115], v[44:47]
    ds_read_b128 v[136:139], v7 offset:9216
    s_waitcnt lgkmcnt(8)
L_fb:
    ds_read_b32 v140, v165 offset:64
    ds_read_b128 v[56:59], v5 offset:0
    ds_read_b128 v[60:63], v5 offset:1024
    ds_read_b128 v[64:67], v5 offset:2048
    ds_read_b128 v[68:71], v5 offset:3072
    ds_read_b128 v[72:75], v5 offset:4096
    ds_read_b128 v[76:79], v5 offset:5120
    s_waitcnt lgkmcnt(6)
    v_readfirstlane_b32 s96, v140
    v_readfirstlane_b32 s97, v21
    s_cmp_eq_u32 s96, 0
    s_cbranch_scc1 L_fxw
    s_cmp_lt_u32 s97, 2
    s_cbranch_scc1 L_fyw
L_yok:
    v_sub_f32 v18, 1.0, v17
    v_sub_f32 v16, 1.0, v16
    v_sub_f32 v20, 1.0, v20
    s_waitcnt lgkmcnt(5)
    v_pk_add_f32 v[56:57], v[56:57], v[8:9]
    v_pk_add_f32 v[58:59], v[58:59], v[10:11]
    v_pk_fma_f32 v[116:117], v[56:57], v[16:17], v[116:117] op_sel_hi:[1,0,1]
    v_pk_fma_f32 v[118:119], v[58:59], v[16:17], v[118:119] op_sel_hi:[1,0,1]
    v_cvt_pk_bf16_f32 v80, v116, v117
    v_cvt_pk_bf16_f32 v81, v118, v119
    ds_write_b64 v1, v[80:81] offset:0
    s_waitcnt lgkmcnt(5)
    v_pk_add_f32 v[60:61], v[60:61], v[12:13]
    v_pk_add_f32 v[62:63], v[62:63], v[14:15]
    v_pk_fma_f32 v[120:121], v[60:61], v[16:17], v[120:121] op_sel_hi:[1,0,1]
    v_pk_fma_f32 v[122:123], v[62:63], v[16:17], v[122:123] op_sel_hi:[1,0,1]
    v_cvt_pk_bf16_f32 v82, v120, v121
    v_cvt_pk_bf16_f32 v83, v122, v123
    ds_write_b64 v6, v[82:83] offset:0
    ds_read_b128 v[92:95], v5 offset:0
    s_waitcnt lgkmcnt(6)
    v_pk_add_f32 v[64:65], v[64:65], v[24:25]
    v_pk_add_f32 v[66:67], v[66:67], v[26:27]
    v_pk_fma_f32 v[124:125], v[64:65], v[18:19], v[124:125] op_sel_hi:[1,0,1]
    v_pk_fma_f32 v[126:127], v[66:67], v[18:19], v[126:127] op_sel_hi:[1,0,1]
    v_cvt_pk_bf16_f32 v84, v124, v125
    v_cvt_pk_bf16_f32 v85, v126, v127
    ds_write_b64 v1, v[84:85] offset:1024
    s_waitcnt lgkmcnt(6)
    v_pk_add_f32 v[68:69], v[68:69], v[28:29]
    v_pk_add_f32 v[70:71], v[70:71], v[30:31]
    v_pk_fma_f32 v[128:129], v[68:69], v[18:19], v[128:129] op_sel_hi:[1,0,1]
    v_pk_fma_f32 v[130:131], v[70:71], v[18:19], v[130:131] op_sel_hi:[1,0,1]
    v_cvt_pk_bf16_f32 v86, v128, v129
    v_cvt_pk_bf16_f32 v87, v130, v131
    ds_write_b64 v6, v[86:87] offset:1024
    ds_read_b128 v[96:99], v5 offset:1024
    s_waitcnt lgkmcnt(7)
    v_pk_add_f32 v[72:73], v[72:73], v[40:41]
    v_pk_add_f32 v[74:75], v[74:75], v[42:43]
    v_pk_fma_f32 v[132:133], v[72:73], v[20:21], v[132:133] op_sel_hi:[1,0,1]
    v_pk_fma_f32 v[134:135], v[74:75], v[20:21], v[134:135] op_sel_hi:[1,0,1]
    v_cvt_pk_bf16_f32 v88, v132, v133
    v_cvt_pk_bf16_f32 v89, v134, v135
    ds_write_b64 v1, v[88:89] offset:2048
    s_waitcnt lgkmcnt(7)
    v_pk_add_f32 v[76:77], v[76:77], v[44:45]
    v_pk_add_f32 v[78:79], v[78:79], v[46:47]
    v_pk_fma_f32 v[136:137], v[76:77], v[20:21], v[136:137] op_sel_hi:[1,0,1]
    v_pk_fma_f32 v[138:139], v[78:79], v[20:21], v[138:139] op_sel_hi:[1,0,1]
    v_cvt_pk_bf16_f32 v90, v136, v137
    v_cvt_pk_bf16_f32 v91, v138, v139
    ds_write_b64 v6, v[90:91] offset:2048
    ds_read_b128 v[100:103], v5 offset:2048
    s_waitcnt lgkmcnt(6)
    buffer_store_dwordx4 v[92:95], v2, s[48:51], s79 offen
    s_add_u32 s79, s79, 20480
    s_waitcnt lgkmcnt(3)
    buffer_store_dwordx4 v[96:99], v2, s[48:51], s79 offen
    s_add_u32 s79, s79, 20480
    s_waitcnt lgkmcnt(0)
    buffer_store_dwordx4 v[100:103], v2, s[48:51], s79 offen
L_pexit:
    s_endpgm
L_lts:
    s_mov_b32 s100, 0
Lw_77:
    ds_read_b32 v4, v164 offset:80
    s_waitcnt lgkmcnt(0)
    v_readfirstlane_b32 s99, v4
    s_cmp_ge_u32 s99, 1
    s_cbranch_scc1 Lwd_78
    s_add_u32 s100, s100, 1
    s_cmp_lt_u32 s100, 8388608
    s_cbranch_scc1 Lw_77
Lwd_78:
    s_branch L_ltg
L_gpslow:
    s_mov_b32 s100, 0
Lpo_79:
    s_waitcnt lgkmcnt(0)
    s_cmp_eq_u32 s86, s31
    s_cbranch_scc1 Lpd_80
    s_sleep 16
    s_load_dwordx2 s[86:87], s[28:29], s92 offset:8192 glc
    s_add_u32 s100, s100, 1
    s_cmp_lt_u32 s100, 1048576
    s_cbranch_scc1 Lpo_79
    s_waitcnt lgkmcnt(0)
Lpd_80:
    s_and_b32 s92, s87, 0x2000
    s_branch L_gpok
L_fxw:
    s_mov_b32 s100, 0
Lw_81:
    ds_read_b32 v4, v165 offset:64
    s_waitcnt lgkmcnt(0)
    v_readfirstlane_b32 s99, v4
    s_cmp_ge_u32 s99, 1
    s_cbranch_scc1 Lwd_82
    s_add_u32 s100, s100, 1
    s_cmp_lt_u32 s100, 8388608
    s_cbranch_scc1 Lw_81
Lwd_82:
    ds_read_b32 v21, v166 offset:48
    ds_read2_b32 v[16:17], v162 offset0:0 offset1:16
    ds_read_b32 v20, v162 offset:128
    ds_read_b128 v[116:119], v7 offset:0
    ds_read_b128 v[120:123], v7 offset:1024
    ds_read_b128 v[124:127], v7 offset:4096
    ds_read_b128 v[128:131], v7 offset:5120
    ds_read_b128 v[132:135], v7 offset:8192
    ds_read_b128 v[136:139], v7 offset:9216
    s_waitcnt lgkmcnt(8)
    s_branch L_fb
L_fyw:
    s_mov_b32 s100, 0
Lw_83:
    ds_read_b32 v4, v166 offset:48
    s_waitcnt lgkmcnt(0)
    v_readfirstlane_b32 s99, v4
    s_cmp_ge_u32 s99, 2
    s_cbranch_scc1 Lwd_84
    s_add_u32 s100, s100, 1
    s_cmp_lt_u32 s100, 8388608
    s_cbranch_scc1 Lw_83
Lwd_84:
    ds_read2_b32 v[16:17], v162 offset0:0 offset1:16
    ds_read_b32 v20, v162 offset:128
    ds_read_b128 v[116:119], v7 offset:0
    ds_read_b128 v[120:123], v7 offset:1024
    ds_read_b128 v[124:127], v7 offset:4096
    ds_read_b128 v[128:131], v7 offset:5120
    ds_read_b128 v[132:135], v7 offset:8192
    ds_read_b128 v[136:139], v7 offset:9216
    s_waitcnt lgkmcnt(0)
    s_branch L_yok
L_fslow:
    s_mov_b32 s100, 0
L_fs2:
    ds_read2_b32 v[120:121], v3 offset0:0 offset1:4
    s_waitcnt lgkmcnt(0)
    v_add_u32 v120, v120, v121
    s_nop 0
    v_readfirstlane_b32 s97, v120
    s_cmp_ge_u32 s97, s84
    s_cbranch_scc1 L_fgo
    s_add_u32 s100, s100, 1
    s_cmp_lt_u32 s100, 8388608
    s_cbranch_scc1 L_fs2
    s_branch L_fgo
L_ns0:
    s_load_dwordx16 s[4:19], s[76:77], 0 glc
    s_waitcnt lgkmcnt(0)
    s_add_u32 s100, s100, 1
    s_cmp_lt_u32 s100, 1048576
    s_cbranch_scc1 L_nb0
    s_branch L_ng0
L_ns1:
    s_load_dwordx16 s[4:19], s[76:77], 0 glc
    s_waitcnt lgkmcnt(0)
    s_add_u32 s100, s100, 1
    s_cmp_lt_u32 s100, 1048576
    s_cbranch_scc1 L_nb1
    s_branch L_ng1
L_ns2:
    s_load_dwordx16 s[4:19], s[76:77], 0 glc
    s_waitcnt lgkmcnt(0)
    s_add_u32 s100, s100, 1
    s_cmp_lt_u32 s100, 1048576
    s_cbranch_scc1 L_nb2
    s_branch L_ng2
L_ns3:
    s_load_dwordx16 s[4:19], s[76:77], 0 glc
    s_waitcnt lgkmcnt(0)
    s_add_u32 s100, s100, 1
    s_cmp_lt_u32 s100, 1048576
    s_cbranch_scc1 L_nb3
    s_branch L_ng3
L_ns4:
    s_load_dwordx16 s[4:19], s[76:77], 0 glc
    s_waitcnt lgkmcnt(0)
    s_add_u32 s100, s100, 1
    s_cmp_lt_u32 s100, 1048576
    s_cbranch_scc1 L_nb4
    s_branch L_ng4
L_ns6:
    s_load_dwordx16 s[4:19], s[76:77], 0 glc
    s_waitcnt lgkmcnt(0)
    s_add_u32 s100, s100, 1
    s_cmp_lt_u32 s100, 1048576
    s_cbranch_scc1 L_nb6
    s_branch L_ng6
L_end:
    s_endpgm
L_codeend:
.section .rodata,"a"
.p2align 6
.amdhsa_kernel gated_mix__ssm_conv_h3__sliding_local_dilated__prompt_kernel
  .amdhsa_next_free_vgpr 168
  .amdhsa_next_free_sgpr 102
  .amdhsa_accum_offset 168
  .amdhsa_group_segment_fixed_size 0
  .amdhsa_kernarg_size 104
  .amdhsa_user_sgpr_count 2
  .amdhsa_user_sgpr_kernarg_segment_ptr 1
  .amdhsa_system_sgpr_workgroup_id_x 1
.end_amdhsa_kernel
.p2align 7
wg_table:
  .long 0, 0, 0, 96, 0, 0, 1985229328, 152
  .long 0, 5, 0, 206, 0, 0, 554272613, 67
  .long 5, 3, 3, 124, 0, 614400, 158762307, 33
  .long 5, 8, 3, 234, 0, 614400, 1411461272, 118
  .long 11, 0, 0, 151, 3, 1351680, 328730199, 66
  .long 11, 5, 0, 261, 3, 1351680, 1749242114, 151
  .long 21, 3, 3, 179, 4, 2580480, 1175660928, 117
  .long 21, 8, 3, 289, 4, 2580480, 2439541813, 32
  .long 0, 1, 1, 97, 0, 0, 2268413985, 150
  .long 0, 6, 1, 207, 0, 0, 847287670, 65
  .long 5, 4, 4, 125, 2, 614400, 2441569333, 32
  .long 5, 9, 4, 235, 2, 614400, 1177688448, 117
  .long 11, 1, 1, 152, 6, 1351680, 554272613, 67
  .long 11, 6, 1, 262, 6, 1351680, 1985229328, 152
  .long 21, 4, 4, 180, 8, 2580480, 1696675849, 116
  .long 21, 9, 4, 290, 8, 2580480, 276202324, 41
  .long 0, 2, 2, 98, 0, 0, 1749242114, 151
  .long 0, 7, 2, 208, 0, 0, 328730199, 66
  .long 6, 0, 0, 126, 7, 737280, 159868227, 33
  .long 6, 5, 0, 236, 7, 737280, 1412567192, 118
  .long 11, 2, 2, 153, 6, 1351680, 847287670, 65
  .long 11, 7, 2, 263, 6, 1351680, 2268413985, 150
  .long 17, 0, 0, 181, 0, 2088960, 1176582528, 117
  .long 17, 5, 0, 291, 0, 2088960, 2440463413, 32
  .long 0, 3, 3, 99, 3, 0, 1985229328, 152
  .long 0, 8, 3, 209, 3, 0, 554272613, 67
  .long 6, 1, 1, 127, 7, 737280, 275280724, 41
  .long 6, 6, 1, 237, 7, 737280, 1695754249, 116
  .long 11, 3, 3, 154, 6, 1351680, 328730199, 66
  .long 11, 8, 3, 264, 6, 1351680, 1749242114, 151
  .long 17, 1, 1, 182, 3, 2088960, 1412567192, 118
  .long 17, 6, 1, 292, 3, 2088960, 159868227, 33
  .long 0, 4, 4, 100, 3, 0, 2268413985, 150
  .long 0, 9, 4, 210, 3, 0, 847287670, 65
  .long 6, 2, 2, 128, 9, 737280, 2440463413, 32
  .long 6, 7, 2, 238, 9, 737280, 1176582528, 117
  .long 11, 4, 4, 155, 9, 1351680, 554272613, 67
  .long 11, 9, 4, 265, 9, 1351680, 1985229328, 152
  .long 17, 2, 2, 183, 3, 2088960, 1695754249, 116
  .long 17, 7, 2, 293, 3, 2088960, 275280724, 41
  .long 1, 0, 0, 101, 2, 122880, 2268413985, 150
  .long 1, 5, 0, 211, 2, 122880, 847287670, 65
  .long 6, 3, 3, 129, 0, 737280, 159868227, 33
  .long 6, 8, 3, 239, 0, 737280, 1412567192, 118
  .long 12, 0, 0, 156, 5, 1474560, 554272613, 67
  .long 12, 5, 0, 266, 5, 1474560, 1985229328, 152
  .long 17, 3, 3, 184, 3, 2088960, 1176582528, 117
  .long 17, 8, 3, 294, 3, 2088960, 2440463413, 32
  .long 1, 1, 1, 102, 2, 122880, 1749242114, 151
  .long 1, 6, 1, 212, 2, 122880, 328730199, 66
  .long 6, 4, 4, 130, 0, 737280, 275280724, 41
  .long 6, 9, 4, 240, 0, 737280, 1695754249, 116
  .long 12, 1, 1, 157, 8, 1474560, 847287670, 65
  .long 12, 6, 1, 267, 8, 1474560, 2268413985, 150
  .long 17, 4, 4, 185, 6, 2088960, 1412567192, 118
  .long 17, 9, 4, 295, 6, 2088960, 159868227, 33
  .long 1, 2, 2, 103, 2, 122880, 1985229328, 152
  .long 1, 7, 2, 213, 2, 122880, 554272613, 67
  .long 7, 0, 0, 131, 6, 860160, 275280724, 41
  .long 7, 5, 0, 241, 6, 860160, 1695754249, 116
  .long 12, 2, 2, 158, 8, 1474560, 328730199, 66
  .long 12, 7, 2, 268, 8, 1474560, 1749242114, 151
  .long 18, 0, 0, 186, 2, 2211840, 1412567192, 118
  .long 18, 5, 0, 296, 2, 2211840, 159868227, 33
  .long 1, 3, 3, 104, 5, 122880, 2268413985, 150
  .long 1, 8, 3, 214, 5, 122880, 847287670, 65
  .long 7, 1, 1, 132, 6, 860160, 2440463413, 32
  .long 7, 6, 1, 242, 6, 860160, 1176582528, 117
  .long 12, 3, 3, 159, 8, 1474560, 554272613, 67
  .long 12, 8, 3, 269, 8, 1474560, 1985229328, 152
  .long 18, 1, 1, 187, 5, 2211840, 1695754249, 116
  .long 18, 6, 1, 297, 5, 2211840, 275280724, 41
  .long 1, 4, 4, 105, 5, 122880, 1749242114, 151
  .long 1, 9, 4, 215, 5, 122880, 328730199, 66
  .long 7, 2, 2, 133, 9, 860160, 159868227, 33
  .long 7, 7, 2, 243, 9, 860160, 1412567192, 118
  .long 12, 4, 4, 160, 9, 1474560, 847287670, 65
  .long 12, 9, 4, 270, 9, 1474560, 2268413985, 150
  .long 18, 2, 2, 188, 5, 2211840, 1176582528, 117
  .long 18, 7, 2, 298, 5, 2211840, 2440463413, 32
  .long 2, 0, 0, 106, 1, 245760, 1749242114, 151
  .long 2, 5, 0, 216, 1, 245760, 328730199, 66
  .long 7, 3, 3, 134, 2, 860160, 275280724, 41
  .long 7, 8, 3, 244, 2, 860160, 1695754249, 116
  .long 13, 0, 0, 161, 4, 1597440, 847287670, 65
  .long 13, 5, 0, 271, 4, 1597440, 2268413985, 150
  .long 18, 3, 3, 189, 5, 2211840, 1412567192, 118
  .long 18, 8, 3, 299, 5, 2211840, 159868227, 33
  .long 2, 1, 1, 107, 1, 245760, 1985229328, 152
  .long 2, 6, 1, 217, 1, 245760, 554272613, 67
  .long 7, 4, 4, 135, 2, 860160, 2440463413, 32
  .long 7, 9, 4, 245, 2, 860160, 1176582528, 117
  .long 13, 1, 1, 162, 7, 1597440, 328730199, 66
  .long 13, 6, 1, 272, 7, 1597440, 1749242114, 151
  .long 18, 4, 4, 190, 8, 2211840, 1695754249, 116
  .long 18, 9, 4, 300, 8, 2211840, 275280724, 41
  .long 2, 2, 2, 108, 1, 245760, 2268413985, 150
  .long 2, 7, 2, 218, 1, 245760, 847287670, 65
  .long 8, 0, 0, 136, 8, 983040, 2440463413, 32
  .long 8, 5, 0, 246, 8, 983040, 1176582528, 117
  .long 13, 2, 2, 163, 7, 1597440, 554272613, 67
  .long 13, 7, 2, 273, 7, 1597440, 1985229328, 152
  .long 19, 0, 0, 191, 1, 2334720, 1695754249, 116
  .long 19, 5, 0, 301, 1, 2334720, 275280724, 41
  .long 2, 3, 3, 109, 4, 245760, 1749242114, 151
  .long 2, 8, 3, 219, 4, 245760, 328730199, 66
  .long 8, 1, 1, 137, 8, 983040, 159868227, 33
  .long 8, 6, 1, 247, 8, 983040, 1412567192, 118
  .long 13, 3, 3, 164, 7, 1597440, 847287670, 65
  .long 13, 8, 3, 274, 7, 1597440, 2268413985, 150
  .long 19, 1, 1, 192, 4, 2334720, 1176582528, 117
  .long 19, 6, 1, 302, 4, 2334720, 2440463413, 32
  .long 2, 4, 4, 110, 4, 245760, 1985229328, 152
  .long 2, 9, 4, 220, 4, 245760, 554272613, 67
  .long 8, 2, 2, 138, 9, 983040, 275280724, 41
  .long 8, 7, 2, 248, 9, 983040, 1695754249, 116
  .long 13, 4, 4, 165, 9, 1597440, 328730199, 66
  .long 13, 9, 4, 275, 9, 1597440, 1749242114, 151
  .long 19, 2, 2, 193, 4, 2334720, 1412567192, 118
  .long 19, 7, 2, 303, 4, 2334720, 159868227, 33
  .long 3, 0, 0, 111, 0, 368640, 1985229328, 152
  .long 3, 5, 0, 221, 0, 368640, 554272613, 67
  .long 8, 3, 3, 139, 1, 983040, 2440463413, 32
  .long 8, 8, 3, 249, 1, 983040, 1176582528, 117
  .long 14, 0, 0, 166, 3, 1720320, 328730199, 66
  .long 14, 5, 0, 276, 3, 1720320, 1749242114, 151
  .long 19, 3, 3, 194, 4, 2334720, 1695754249, 116
  .long 19, 8, 3, 304, 4, 2334720, 275280724, 41
  .long 3, 1, 1, 112, 0, 368640, 2268413985, 150
  .long 3, 6, 1, 222, 0, 368640, 847287670, 65
  .long 8, 4, 4, 140, 1, 983040, 159868227, 33
  .long 8, 9, 4, 250, 1, 983040, 1412567192, 118
  .long 14, 1, 1, 167, 6, 1720320, 554272613, 67
  .long 14, 6, 1, 277, 6, 1720320, 1985229328, 152
  .long 19, 4, 4, 195, 7, 2334720, 1176582528, 117
  .long 19, 9, 4, 305, 7, 2334720, 2440463413, 32
  .long 3, 2, 2, 113, 0, 368640, 1749242114, 151
  .long 3, 7, 2, 223, 0, 368640, 328730199, 66
  .long 9, 0, 0, 141, 7, 1105920, 159868227, 33
  .long 9, 5, 0, 251, 7, 1105920, 1412567192, 118
  .long 14, 2, 2, 168, 6, 1720320, 847287670, 65
  .long 14, 7, 2, 278, 6, 1720320, 2268413985, 150
  .long 20, 0, 0, 196, 0, 2457600, 1176582528, 117
  .long 20, 5, 0, 306, 0, 2457600, 2440463413, 32
  .long 3, 3, 3, 114, 3, 368640, 1985229328, 152
  .long 3, 8, 3, 224, 3, 368640, 554272613, 67
  .long 9, 1, 1, 142, 7, 1105920, 275280724, 41
  .long 9, 6, 1, 252, 7, 1105920, 1695754249, 116
  .long 14, 3, 3, 169, 6, 1720320, 328730199, 66
  .long 14, 8, 3, 279, 6, 1720320, 1749242114, 151
  .long 20, 1, 1, 197, 3, 2457600, 1412567192, 118
  .long 20, 6, 1, 307, 3, 2457600, 159868227, 33
  .long 3, 4, 4, 115, 3, 368640, 2268413985, 150
  .long 3, 9, 4, 225, 3, 368640, 847287670, 65
  .long 9, 2, 2, 143, 9, 1105920, 2440463413, 32
  .long 9, 7, 2, 253, 9, 1105920, 1176582528, 117
  .long 14, 4, 4, 170, 9, 1720320, 554272613, 67
  .long 14, 9, 4, 280, 9, 1720320, 1985229328, 152
  .long 20, 2, 2, 198, 3, 2457600, 1695754249, 116
  .long 20, 7, 2, 308, 3, 2457600, 275280724, 41
  .long 4, 0, 0, 116, 2, 491520, 2268413985, 150
  .long 4, 5, 0, 226, 2, 491520, 847287670, 65
  .long 9, 3, 3, 144, 0, 1105920, 159868227, 33
  .long 9, 8, 3, 254, 0, 1105920, 1412567192, 118
  .long 15, 0, 0, 171, 5, 1843200, 554272613, 67
  .long 15, 5, 0, 281, 5, 1843200, 1985229328, 152
  .long 20, 3, 3, 199, 3, 2457600, 1176582528, 117
  .long 20, 8, 3, 309, 3, 2457600, 2440463413, 32
  .long 4, 1, 1, 117, 2, 491520, 1749242114, 151
  .long 4, 6, 1, 227, 2, 491520, 328730199, 66
  .long 9, 4, 4, 145, 0, 1105920, 275280724, 41
  .long 9, 9, 4, 255, 0, 1105920, 1695754249, 116
  .long 15, 1, 1, 172, 8, 1843200, 847287670, 65
  .long 15, 6, 1, 282, 8, 1843200, 2268413985, 150
  .long 20, 4, 4, 200, 6, 2457600, 1412567192, 118
  .long 20, 9, 4, 310, 6, 2457600, 159868227, 33
  .long 4, 2, 2, 118, 2, 491520, 1985229328, 152
  .long 4, 7, 2, 228, 2, 491520, 554272613, 67
  .long 10, 0, 0, 146, 6, 1228800, 275280724, 41
  .long 10, 5, 0, 256, 6, 1228800, 1695754249, 116
  .long 15, 2, 2, 173, 8, 1843200, 328730199, 66
  .long 15, 7, 2, 283, 8, 1843200, 1749242114, 151
  .long 16, 0, 0, 201, 2, 1966080, 1412567192, 118
  .long 16, 5, 0, 311, 2, 1966080, 159868227, 33
  .long 4, 3, 3, 119, 5, 491520, 2268413985, 150
  .long 4, 8, 3, 229, 5, 491520, 847287670, 65
  .long 10, 1, 1, 147, 6, 1228800, 2440463413, 32
  .long 10, 6, 1, 257, 6, 1228800, 1176582528, 117
  .long 15, 3, 3, 174, 8, 1843200, 554272613, 67
  .long 15, 8, 3, 284, 8, 1843200, 1985229328, 152
  .long 16, 1, 1, 202, 5, 1966080, 1695754249, 116
  .long 16, 6, 1, 312, 5, 1966080, 275280724, 41
  .long 4, 4, 4, 120, 5, 491520, 1749242114, 151
  .long 4, 9, 4, 230, 5, 491520, 328730199, 66
  .long 10, 2, 2, 148, 9, 1228800, 159868227, 33
  .long 10, 7, 2, 258, 9, 1228800, 1412567192, 118
  .long 15, 4, 4, 175, 9, 1843200, 847287670, 65
  .long 15, 9, 4, 285, 9, 1843200, 2268413985, 150
  .long 16, 2, 2, 203, 5, 1966080, 1176582528, 117
  .long 16, 7, 2, 313, 5, 1966080, 2440463413, 32
  .long 5, 0, 0, 121, 1, 614400, 1749242114, 151
  .long 5, 5, 0, 231, 1, 614400, 328730199, 66
  .long 10, 3, 3, 149, 2, 1228800, 275280724, 41
  .long 10, 8, 3, 259, 2, 1228800, 1695754249, 116
  .long 21, 0, 0, 176, 4, 2580480, 847287670, 65
  .long 21, 5, 0, 286, 4, 2580480, 2268413985, 150
  .long 16, 3, 3, 204, 5, 1966080, 1412567192, 118
  .long 16, 8, 3, 314, 5, 1966080, 159868227, 33
  .long 5, 1, 1, 122, 1, 614400, 1985229328, 152
  .long 5, 6, 1, 232, 1, 614400, 554272613, 67
  .long 10, 4, 4, 150, 2, 1228800, 2440463413, 32
  .long 10, 9, 4, 260, 2, 1228800, 1176582528, 117
  .long 21, 1, 1, 177, 7, 2580480, 328730199, 66
  .long 21, 6, 1, 287, 7, 2580480, 1749242114, 151
  .long 16, 4, 4, 205, 8, 1966080, 1695754249, 116
  .long 16, 9, 4, 315, 8, 1966080, 275280724, 41
  .long 5, 2, 2, 123, 1, 614400, 2268413985, 150
  .long 5, 7, 2, 233, 1, 614400, 847287670, 65
  .long 0, 0, 0, 0, 38979, 0, 0, 0
  .long 0, 1, 0, 1, 38979, 0, 0, 0
  .long 21, 2, 2, 178, 7, 2580480, 554272613, 67
  .long 21, 7, 2, 288, 7, 2580480, 1985229328, 152
  .long 0, 0, 0, 2, 38979, 0, 0, 0
  .long 0, 1, 0, 3, 38979, 0, 0, 0
  .long 0, 0, 0, 4, 38979, 0, 0, 0
  .long 0, 1, 0, 5, 38979, 0, 0, 0
  .long 0, 0, 0, 6, 38979, 0, 0, 0
  .long 0, 1, 0, 7, 38979, 0, 0, 0
  .long 0, 0, 0, 8, 38979, 0, 0, 0
  .long 0, 1, 0, 9, 8566, 0, 0, 0
  .long 0, 0, 0, 10, 8566, 0, 0, 0
  .long 0, 1, 0, 11, 8566, 0, 0, 0
  .long 0, 0, 0, 12, 8566, 0, 0, 0
  .long 0, 1, 0, 13, 8566, 0, 0, 0
  .long 0, 0, 0, 14, 8566, 0, 0, 0
  .long 0, 1, 0, 15, 8566, 0, 0, 0
  .long 0, 0, 0, 16, 17304, 0, 0, 0
  .long 0, 1, 0, 17, 17304, 0, 0, 0
  .long 0, 0, 0, 18, 17304, 0, 0, 0
  .long 0, 1, 0, 19, 17304, 0, 0, 0
  .long 0, 0, 0, 20, 17304, 0, 0, 0
  .long 0, 1, 0, 21, 17304, 0, 0, 0
  .long 0, 0, 0, 22, 17304, 0, 0, 0
  .long 0, 1, 0, 23, 17304, 0, 0, 0
  .long 0, 0, 0, 24, 30241, 0, 0, 0
  .long 0, 1, 0, 25, 30241, 0, 0, 0
  .long 0, 0, 0, 26, 30241, 0, 0, 0
  .long 0, 1, 0, 27, 30241, 0, 0, 0
  .long 0, 0, 0, 316, 38979, 0, 0, 0
  .long 0, 1, 0, 317, 38979, 0, 0, 0
  .long 0, 0, 0, 318, 38979, 0, 0, 0
  .long 0, 1, 0, 319, 38979, 0, 0, 0
  .long 0, 0, 0, 28, 30241, 0, 0, 0
  .long 0, 1, 0, 29, 30241, 0, 0, 0
  .long 0, 0, 0, 30, 30241, 0, 0, 0
  .long 0, 1, 0, 31, 17304, 0, 0, 0
```
